```python
import torch

def _softmax(x, axis=-1):
    return torch.softmax(x, dim=axis)
def _gelu(x):
    return torch.nn.functional.gelu(x, approximate="tanh")
def _silu(x):
    return torch.nn.functional.silu(x)
def _sigmoid(x):
    return torch.sigmoid(x)
def _layernorm(x, axis=-1, eps=1e-5):
    m = x.mean(dim=axis, keepdim=True)
    v = x.var(dim=axis, keepdim=True, unbiased=False)
    return (x - m) / torch.sqrt(v + eps)
def _scatter_add(tgt, idx, src, axis=0):
    return tgt.clone().index_add_(axis, idx, src)
def _segment_sum(src, seg, n):
    out = torch.zeros((n,) + src.shape[1:], dtype=src.dtype)
    return out.index_add_(0, seg, src)
def _pad(x, pw):
    flat = tuple(v for pair in reversed(pw) for v in pair)
    return torch.nn.functional.pad(x, flat)

kernel_name = 'concat_heads__mha_block_cached__mha_block_cached__near_ridge'

def setup_inputs():

    _w = (lambda a: (lambda t: t.to(torch.bfloat16) if t.is_floating_point() else t)(torch.as_tensor(a)))
    def _A_setup():
        B, Sq, D = 16, 128, 640
        H, Sk, Dh = 32, 512, 128
        return {
            "x": _w((lambda *s: torch.randn(*s, dtype=torch.bfloat16) * 0.8)(B, Sq, D)),
            "k_cache": _w((lambda *s: torch.randn(*s, dtype=torch.bfloat16) * 0.8)(B, H, Sk, Dh)),
            "v_cache": _w((lambda *s: torch.randn(*s, dtype=torch.bfloat16) * 0.05)(B, H, Sk, Dh)),
            "wq": _w((lambda *s: torch.randn(*s, dtype=torch.bfloat16) * 0.8)(D, H * Dh) * (D ** -0.5)),
            "wo": _w((lambda *s: torch.randn(*s, dtype=torch.bfloat16) * 0.05)(H * Dh, D) * ((H * Dh) ** -0.5)),
        }
    _A_in = _A_setup()

    def _B_setup():
        B, Sq, D = 16, 128, 640
        H, Sk, Dh = 32, 512, 128
        return {
            "x": _w((lambda *s: torch.randn(*s, dtype=torch.bfloat16) * 0.8)(B, Sq, D)),
            "k_cache": _w((lambda *s: torch.randn(*s, dtype=torch.bfloat16) * 0.8)(B, H, Sk, Dh)),
            "v_cache": _w((lambda *s: torch.randn(*s, dtype=torch.bfloat16) * 0.05)(B, H, Sk, Dh)),
            "wq": _w((lambda *s: torch.randn(*s, dtype=torch.bfloat16) * 0.8)(D, H * Dh) * (D ** -0.5)),
            "wo": _w((lambda *s: torch.randn(*s, dtype=torch.bfloat16) * 0.05)(H * Dh, D) * ((H * Dh) ** -0.5)),
        }
    _B_in = _B_setup()

    return {
        "A_x": _A_in["x"],
        "A_k_cache": _A_in["k_cache"],
        "A_v_cache": _A_in["v_cache"],
        "A_wq": _A_in["wq"],
        "A_wo": _A_in["wo"],
        "B_x": _B_in["x"],
        "B_k_cache": _B_in["k_cache"],
        "B_v_cache": _B_in["v_cache"],
        "B_wq": _B_in["wq"],
        "B_wo": _B_in["wo"],
    }

def reference(A_x, A_k_cache, A_v_cache, A_wq, A_wo, B_x, B_k_cache, B_v_cache, B_wq, B_wo):
    def _A_ref(x, k_cache, v_cache, wq, wo):
        B, Sq, D = x.shape
        H, Dh = 32, 128
        q = (lambda x, *d: x.permute(*d))((x @ wq).reshape(B, Sq, H, Dh), 0, 2, 1, 3)
        scores = torch.einsum("bhqd,bhkd->bhqk", q, k_cache) * (Dh ** -0.5)
        p = _softmax(scores, axis=-1)
        o = torch.einsum("bhqk,bhkd->bhqd", p, v_cache)
        return (lambda x, *d: x.permute(*d))(o, 0, 2, 1, 3).reshape(B, Sq, H * Dh) @ wo

    def _B_ref(x, k_cache, v_cache, wq, wo):
        B, Sq, D = x.shape
        H, Dh = 32, 128
        q = (lambda x, *d: x.permute(*d))((x @ wq).reshape(B, Sq, H, Dh), 0, 2, 1, 3)
        scores = torch.einsum("bhqd,bhkd->bhqk", q, k_cache) * (Dh ** -0.5)
        p = _softmax(scores, axis=-1)
        o = torch.einsum("bhqk,bhkd->bhqd", p, v_cache)
        return (lambda x, *d: x.permute(*d))(o, 0, 2, 1, 3).reshape(B, Sq, H * Dh) @ wo

    a = _A_ref(A_x, A_k_cache, A_v_cache, A_wq, A_wo)
    b = _B_ref(B_x, B_k_cache, B_v_cache, B_wq, B_wo)
    return torch.concatenate([a, b], axis=-1)
```

```asm
; @launch grid=(256,1,1) block=(256,1,1) lds=163840
.amdgcn_target "amdgcn-amd-amdhsa--gfx950"
.text
.globl concat_heads__mha_block_cached__mha_block_cached__near_ridge_kernel
.p2align 8
.type concat_heads__mha_block_cached__mha_block_cached__near_ridge_kernel,@function
concat_heads__mha_block_cached__mha_block_cached__near_ridge_kernel:
  s_cmp_ge_u32 s2, 256
  s_cbranch_scc1 KEND
  s_load_dwordx16 s[68:83], s[0:1], 0
  s_load_dwordx8 s[84:91], s[0:1], 64
  s_load_dwordx2 s[52:53], s[0:1], 96
  v_lshrrev_b32 v1, 6, v0
  v_and_b32 v0, 63, v0
  v_readfirstlane_b32 s45, v1
  s_and_b32 s3, s2, 7
  s_lshr_b32 s4, s2, 3
  s_and_b32 s5, s3, 3
  s_lshl_b32 s5, s5, 1
  s_and_b32 s6, s4, 1
  s_or_b32 s5, s5, s6
  s_lshr_b32 s4, s4, 1
  s_lshr_b32 s3, s3, 2
  v_lshrrev_b32 v2, 4, v0
  v_and_b32 v3, 15, v0
  v_lshrrev_b32 v4, 3, v0
  v_lshl_add_u32 v4, v1, 5, v4
  v_mul_u32_u24 v4, 1280, v4
  v_and_b32 v5, 7, v0
  v_xor_b32 v5, v5, v2
  v_lshl_add_u32 v254, v5, 4, v4
  v_xor_b32 v255, 64, v254
  v_and_b32 v8, 1, v2
  v_lshrrev_b32 v9, 1, v2
  v_lshl_add_u32 v6, v8, 1, v9
  v_lshl_add_u32 v7, v1, 5, v3
  v_mul_u32_u24 v7, 1280, v7
  v_lshl_add_u32 v253, v6, 4, v7
  v_lshl_add_u32 v4, v1, 4, v2
  v_lshlrev_b32 v5, 2, v2
  v_xor_b32 v5, v3, v5
  v_and_b32 v6, 1, v1
  v_lshlrev_b32 v6, 1, v6
  v_xor_b32 v5, v5, v6
  v_lshlrev_b32 v5, 4, v5
  v_lshl_add_u32 v248, v4, 8, v5
  v_lshl_add_u32 v244, v4, 13, v5
  v_add_u32 v245, 31744, v244
  v_add_u32 v246, 63488, v244
  v_add_u32 v247, 95232, v244
  s_lshl_b32 s41, s45, 12
  s_sub_u32 s6, s4, 10
  s_min_u32 s6, s6, s4
  s_mul_i32 s6, s6, 1
  s_lshl_b32 s34, s6, 19
  s_lshl_b32 s39, s6, 7
  s_waitcnt lgkmcnt(0)
  s_cmp_eq_u32 s3, 0
  s_cselect_b64 s[68:69], s[68:69], s[78:79]
  s_cselect_b64 s[70:71], s[70:71], s[80:81]
  s_cselect_b64 s[72:73], s[72:73], s[82:83]
  s_cselect_b64 s[74:75], s[74:75], s[84:85]
  s_cselect_b64 s[76:77], s[76:77], s[86:87]
  s_lshl_b32 s6, s5, 10
  s_add_u32 s16, s74, s6
  s_addc_u32 s17, s75, 0
  s_mov_b32 s18, 0
  s_mov_b32 s19, 0x20000
  s_sub_u32 s18, 5242880, s6
  s_mul_i32 s6, s4, 163840
  s_add_u32 s20, s68, s6
  s_addc_u32 s21, s69, 0
  s_mov_b32 s22, 163840
  s_mov_b32 s23, 0x20000
  s_add_u32 s40, s39, 0
  s_sub_u32 s38, s40, 1280
  s_min_u32 s40, s40, s38
  s_add_u32 m0, s41, 0
  s_nop 0
  buffer_load_dwordx4 v254, s[20:23], s40 offen offset:0 nt lds
  s_add_u32 s38, s40, 9216
  buffer_load_dwordx4 v255, s[20:23], s38 offen offset:1024 nt lds
  s_add_u32 s38, s40, 18432
  buffer_load_dwordx4 v254, s[20:23], s38 offen offset:2048 nt lds
  s_add_u32 s38, s40, 27648
  buffer_load_dwordx4 v255, s[20:23], s38 offen offset:3072 nt lds
  s_add_u32 m0, s41, 65536
  s_nop 0
  buffer_load_dwordx4 v244, s[16:19], s34 offen offset:0 lds
  buffer_load_dwordx4 v245, s[16:19], s34 offen offset:1024 lds
  buffer_load_dwordx4 v246, s[16:19], s34 offen offset:2048 lds
  buffer_load_dwordx4 v247, s[16:19], s34 offen offset:3072 lds
  s_add_u32 s34, s34, 524288
  s_sub_u32 s38, s34, 5242880
  s_min_u32 s34, s34, s38
  s_add_u32 s40, s39, 128
  s_sub_u32 s38, s40, 1280
  s_min_u32 s40, s40, s38
  s_add_u32 m0, s41, 16384
  s_nop 0
  buffer_load_dwordx4 v254, s[20:23], s40 offen offset:0 nt lds
  s_add_u32 s38, s40, 9216
  buffer_load_dwordx4 v255, s[20:23], s38 offen offset:1024 nt lds
  s_add_u32 s38, s40, 18432
  buffer_load_dwordx4 v254, s[20:23], s38 offen offset:2048 nt lds
  s_add_u32 s38, s40, 27648
  buffer_load_dwordx4 v255, s[20:23], s38 offen offset:3072 nt lds
  s_add_u32 m0, s41, 81920
  s_nop 0
  buffer_load_dwordx4 v244, s[16:19], s34 offen offset:0 lds
  buffer_load_dwordx4 v245, s[16:19], s34 offen offset:1024 lds
  buffer_load_dwordx4 v246, s[16:19], s34 offen offset:2048 lds
  buffer_load_dwordx4 v247, s[16:19], s34 offen offset:3072 lds
  s_add_u32 s34, s34, 524288
  s_sub_u32 s38, s34, 5242880
  s_min_u32 s34, s34, s38
  s_add_u32 s40, s39, 256
  s_sub_u32 s38, s40, 1280
  s_min_u32 s40, s40, s38
  s_add_u32 m0, s41, 32768
  s_nop 0
  buffer_load_dwordx4 v254, s[20:23], s40 offen offset:0 lds
  s_add_u32 s38, s40, 9216
  buffer_load_dwordx4 v255, s[20:23], s38 offen offset:1024 lds
  s_add_u32 s38, s40, 18432
  buffer_load_dwordx4 v254, s[20:23], s38 offen offset:2048 lds
  s_add_u32 s38, s40, 27648
  buffer_load_dwordx4 v255, s[20:23], s38 offen offset:3072 lds
  s_add_u32 m0, s41, 98304
  s_nop 0
  buffer_load_dwordx4 v244, s[16:19], s34 offen offset:0 lds
  buffer_load_dwordx4 v245, s[16:19], s34 offen offset:1024 lds
  buffer_load_dwordx4 v246, s[16:19], s34 offen offset:2048 lds
  buffer_load_dwordx4 v247, s[16:19], s34 offen offset:3072 lds
  s_add_u32 s34, s34, 524288
  s_sub_u32 s38, s34, 5242880
  s_min_u32 s34, s34, s38
  s_add_u32 s40, s39, 384
  s_sub_u32 s38, s40, 1280
  s_min_u32 s40, s40, s38
  s_add_u32 m0, s41, 49152
  s_nop 0
  buffer_load_dwordx4 v254, s[20:23], s40 offen offset:0 lds
  s_add_u32 s38, s40, 9216
  buffer_load_dwordx4 v255, s[20:23], s38 offen offset:1024 lds
  s_add_u32 s38, s40, 18432
  buffer_load_dwordx4 v254, s[20:23], s38 offen offset:2048 lds
  s_add_u32 s38, s40, 27648
  buffer_load_dwordx4 v255, s[20:23], s38 offen offset:3072 lds
  s_add_u32 m0, s41, 114688
  s_nop 0
  buffer_load_dwordx4 v244, s[16:19], s34 offen offset:0 lds
  buffer_load_dwordx4 v245, s[16:19], s34 offen offset:1024 lds
  buffer_load_dwordx4 v246, s[16:19], s34 offen offset:2048 lds
  buffer_load_dwordx4 v247, s[16:19], s34 offen offset:3072 lds
  s_add_u32 s34, s34, 524288
  s_sub_u32 s38, s34, 5242880
  s_min_u32 s34, s34, s38
  s_add_u32 s40, s39, 512
  s_sub_u32 s38, s40, 1280
  s_min_u32 s40, s40, s38
  s_add_u32 m0, s41, 131072
  s_nop 0
  buffer_load_dwordx4 v254, s[20:23], s40 offen offset:0 nt lds
  s_add_u32 s38, s40, 9216
  buffer_load_dwordx4 v255, s[20:23], s38 offen offset:1024 nt lds
  s_add_u32 s38, s40, 18432
  buffer_load_dwordx4 v254, s[20:23], s38 offen offset:2048 nt lds
  s_add_u32 s38, s40, 27648
  buffer_load_dwordx4 v255, s[20:23], s38 offen offset:3072 nt lds
  s_add_u32 s40, s39, 640
  s_sub_u32 s38, s40, 1280
  s_min_u32 s40, s40, s38
  s_add_u32 m0, s41, 147456
  s_nop 0
  buffer_load_dwordx4 v254, s[20:23], s40 offen offset:0 nt lds
  s_add_u32 s38, s40, 9216
  buffer_load_dwordx4 v255, s[20:23], s38 offen offset:1024 nt lds
  s_add_u32 s38, s40, 18432
  buffer_load_dwordx4 v254, s[20:23], s38 offen offset:2048 nt lds
  s_add_u32 s38, s40, 27648
  buffer_load_dwordx4 v255, s[20:23], s38 offen offset:3072 nt lds
  s_getpc_b64 s[48:49]
PC0:
  s_lshr_b32 s6, s2, 3
  s_and_b32 s6, s6, 3
  s_lshl_b32 s6, s6, 2
  s_add_u32 s6, s6, s45
  s_lshl_b32 s6, s6, 13
  v_lshlrev_b32 v84, 7, v0
  v_add_u32 v84, s6, v84
  s_mov_b32 s7, CEND-PC0-4
  v_add_u32 v85, 0, v84
  v_min_u32 v85, s7, v85
  v_mov_b32 v87, s49
  v_add_co_u32 v86, vcc, s48, v85
  v_addc_co_u32 v87, vcc, 0, v87, vcc
  global_load_dword v83, v[86:87], off
  v_lshl_add_u32 v4, v1, 2, v2
  v_and_b32 v5, 11, v4
  v_xor_b32 v5, v3, v5
  v_lshlrev_b32 v5, 4, v5
  v_lshl_add_u32 v240, v4, 8, v5
  v_xor_b32 v241, 64, v240
  v_add_u32 v241, 3072, v241
  v_add_u32 v242, 6144, v240
  v_add_u32 v243, 6144, v241
  v_and_b32 v8, 1, v2
  v_lshrrev_b32 v9, 1, v2
  v_lshl_add_u32 v6, v8, 1, v9
  v_xor_b32 v5, v6, v3
  v_lshlrev_b32 v5, 4, v5
  v_and_b32 v7, 8, v3
  v_lshl_add_u32 v5, v7, 10, v5
  v_and_b32 v7, 7, v3
  v_lshl_add_u32 v224, v7, 8, v5
  v_xor_b32 v225, 64, v224
  v_xor_b32 v226, 128, v224
  v_xor_b32 v227, 192, v224
  v_lshrrev_b32 v4, 2, v3
  v_mul_u32_u24 v5, 320, v4
  v_lshl_add_u32 v5, v9, 11, v5
  v_mul_u32_u24 v7, 4128, v8
  v_add_u32 v5, v5, v7
  v_and_b32 v7, 3, v0
  v_lshl_add_u32 v5, v7, 3, v5
  v_add_u32 v232, 0x10000, v5
  v_xor_b32 v233, 32, v232
  v_xor_b32 v234, 64, v232
  v_xor_b32 v235, 96, v232
  v_xor_b32 v236, 128, v232
  v_xor_b32 v237, 160, v232
  v_xor_b32 v238, 192, v232
  v_xor_b32 v239, 224, v232
  v_add_u32 v200, 0x10000, v232
  v_add_u32 v201, 0x10000, v233
  v_add_u32 v202, 0x10000, v234
  v_add_u32 v203, 0x10000, v235
  v_add_u32 v204, 0x10000, v236
  v_add_u32 v205, 0x10000, v237
  v_add_u32 v206, 0x10000, v238
  v_add_u32 v207, 0x10000, v239
  v_bfe_u32 v5, v0, 1, 3
  v_xor_b32 v5, v5, v6
  v_lshlrev_b32 v5, 4, v5
  v_lshl_add_u32 v5, v3, 7, v5
  v_lshl_add_u32 v64, v1, 12, v5
  v_xor_b32 v65, 2048, v64
  v_xor_b32 v66, 64, v64
  v_xor_b32 v67, 2112, v64
  v_add_u32 v68, 0x10000, v64
  v_add_u32 v69, 0x10000, v65
  v_add_u32 v70, 0x10000, v66
  v_add_u32 v71, 0x10000, v67
  v_add_u32 v72, 0x10000, v68
  v_add_u32 v73, 0x10000, v69
  v_add_u32 v74, 0x10000, v70
  v_add_u32 v75, 0x10000, v71
  v_lshlrev_b32 v7, 4, v0
  v_lshl_add_u32 v251, v1, 13, v7
  v_mul_u32_u24 v8, 40960, v1
  v_add_u32 v252, v7, v8
  s_mov_b32 s32, 0
  s_mov_b32 s33, 0
  s_mov_b32 s42, 0x3e0293ee
  s_mov_b32 s43, 0xffff0000
  s_mov_b32 s35, 0x44800000
  s_lshl_b32 s6, s4, 3
  s_or_b32 s6, s6, s5
  s_lshl_b32 s7, s6, 19
  s_add_u32 s8, s70, s7
  s_addc_u32 s9, s71, 0
  s_mov_b32 s10, 524288
  s_mov_b32 s11, 0x20000
  s_add_u32 s12, s72, s7
  s_addc_u32 s13, s73, 0
  s_mov_b32 s14, 524288
  s_mov_b32 s15, 0x20000
  s_lshl_b32 s7, s3, 7
  s_or_b32 s37, s6, s7
  s_lshl_b32 s6, s37, 7
  s_add_u32 s6, s6, 67108864
  s_add_u32 s24, s52, s6
  s_addc_u32 s25, s53, 0
  s_mov_b32 s26, 32
  s_mov_b32 s27, 0x20000
  s_and_b32 s6, s37, 0xf8
  s_add_u32 s84, s90, s6
  s_addc_u32 s85, s91, 0
  s_mov_b32 s86, 0
  s_mov_b32 s87, 0x20000
  s_cmp_eq_u32 s45, 0
  s_cselect_b32 s86, 4, 0
  s_cselect_b32 s44, 8, 0
  v_lshlrev_b32 v80, 2, v0
  v_mov_b32 v81, 0
  v_mov_b32 v82, 1
  buffer_store_dword v81, v80, s[24:27], 0 offen sc1
  s_mul_i32 s6, s37, 163840
  s_add_u32 s28, s52, s6
  s_addc_u32 s29, s53, 0
  s_mov_b32 s30, 163840
  s_mov_b32 s31, 0x20000
  s_mul_i32 s6, s5, 655360
  s_add_u32 s64, s76, s6
  s_addc_u32 s65, s77, 0
  s_mov_b32 s66, 655360
  s_mov_b32 s67, 0x20000
  s_mul_i32 s6, s4, 52
  s_lshr_b32 s6, s6, 8
  s_mul_i32 s6, s6, 5
  s_sub_u32 s6, s4, s6
  s_mul_i32 s76, s6, 256
  s_add_u32 s77, s76, 256
  s_sub_u32 s6, s77, 1280
  s_min_u32 s77, s77, s6
  s_add_u32 s78, s77, 256
  s_sub_u32 s6, s78, 1280
  s_min_u32 s78, s78, s6
  s_add_u32 s79, s78, 256
  s_sub_u32 s6, s79, 1280
  s_min_u32 s79, s79, s6
  s_add_u32 s80, s79, 256
  s_sub_u32 s6, s80, 1280
  s_min_u32 s80, s80, s6
  s_waitcnt vmcnt(34)
  s_barrier
  ds_read_b128 a[0:3], v64 offset:0
  ds_read_b128 a[4:7], v65 offset:0
  ds_read_b128 a[8:11], v66 offset:0
  ds_read_b128 a[12:15], v67 offset:0
  ds_read_b64_tr_b16 a[160:161], v232 offset:0
  ds_read_b64_tr_b16 a[162:163], v232 offset:1024
  ds_read_b64_tr_b16 a[164:165], v233 offset:0
  ds_read_b64_tr_b16 a[166:167], v233 offset:1024
  ds_read_b64_tr_b16 a[168:169], v234 offset:0
  ds_read_b64_tr_b16 a[170:171], v234 offset:1024
  ds_read_b64_tr_b16 a[172:173], v235 offset:0
  ds_read_b64_tr_b16 a[174:175], v235 offset:1024
  ds_read_b64_tr_b16 a[176:177], v236 offset:0
  ds_read_b64_tr_b16 a[178:179], v236 offset:1024
  ds_read_b64_tr_b16 a[180:181], v237 offset:0
  ds_read_b64_tr_b16 a[182:183], v237 offset:1024
  s_waitcnt lgkmcnt(8)
  v_mfma_f32_16x16x32_bf16 v[0:3], a[160:163], a[0:3], 0
  ds_read_b64_tr_b16 a[184:185], v238 offset:0
  ds_read_b64_tr_b16 a[186:187], v238 offset:1024
  v_mfma_f32_16x16x32_bf16 v[8:11], a[160:163], a[4:7], 0
  v_mfma_f32_16x16x32_bf16 v[12:15], a[164:167], a[4:7], 0
  ds_read_b64_tr_b16 a[188:189], v239 offset:0
  ds_read_b64_tr_b16 a[190:191], v239 offset:1024
  v_mfma_f32_16x16x32_bf16 v[4:7], a[164:167], a[0:3], 0
  s_waitcnt lgkmcnt(8)
  v_mfma_f32_16x16x32_bf16 v[16:19], a[168:171], a[0:3], 0
  ds_read_b64_tr_b16 a[160:161], v232 offset:8192
  ds_read_b64_tr_b16 a[162:163], v232 offset:9216
  v_mfma_f32_16x16x32_bf16 v[24:27], a[168:171], a[4:7], 0
  v_mfma_f32_16x16x32_bf16 v[28:31], a[172:175], a[4:7], 0
  ds_read_b64_tr_b16 a[164:165], v233 offset:8192
  ds_read_b64_tr_b16 a[166:167], v233 offset:9216
  v_mfma_f32_16x16x32_bf16 v[20:23], a[172:175], a[0:3], 0
  s_waitcnt lgkmcnt(8)
  v_mfma_f32_16x16x32_bf16 v[32:35], a[176:179], a[0:3], 0
  ds_read_b64_tr_b16 a[168:169], v234 offset:8192
  ds_read_b64_tr_b16 a[170:171], v234 offset:9216
  v_mfma_f32_16x16x32_bf16 v[40:43], a[176:179], a[4:7], 0
  v_mfma_f32_16x16x32_bf16 v[44:47], a[180:183], a[4:7], 0
  ds_read_b64_tr_b16 a[172:173], v235 offset:8192
  ds_read_b64_tr_b16 a[174:175], v235 offset:9216
  v_mfma_f32_16x16x32_bf16 v[36:39], a[180:183], a[0:3], 0
  s_waitcnt lgkmcnt(8)
  v_mfma_f32_16x16x32_bf16 v[48:51], a[184:187], a[0:3], 0
  ds_read_b64_tr_b16 a[176:177], v236 offset:8192
  ds_read_b64_tr_b16 a[178:179], v236 offset:9216
  v_mfma_f32_16x16x32_bf16 v[56:59], a[184:187], a[4:7], 0
  v_mfma_f32_16x16x32_bf16 v[60:63], a[188:191], a[4:7], 0
  ds_read_b64_tr_b16 a[180:181], v237 offset:8192
  ds_read_b64_tr_b16 a[182:183], v237 offset:9216
  v_mfma_f32_16x16x32_bf16 v[52:55], a[188:191], a[0:3], 0
  s_waitcnt lgkmcnt(8)
  v_mfma_f32_16x16x32_bf16 v[0:3], a[160:163], a[8:11], v[0:3]
  ds_read_b64_tr_b16 a[184:185], v238 offset:8192
  ds_read_b64_tr_b16 a[186:187], v238 offset:9216
  v_mfma_f32_16x16x32_bf16 v[8:11], a[160:163], a[12:15], v[8:11]
  v_mfma_f32_16x16x32_bf16 v[12:15], a[164:167], a[12:15], v[12:15]
  ds_read_b64_tr_b16 a[188:189], v239 offset:8192
  ds_read_b64_tr_b16 a[190:191], v239 offset:9216
  v_mfma_f32_16x16x32_bf16 v[4:7], a[164:167], a[8:11], v[4:7]
  s_waitcnt lgkmcnt(8)
  v_mfma_f32_16x16x32_bf16 v[16:19], a[168:171], a[8:11], v[16:19]
  s_waitcnt vmcnt(2)
  s_barrier
  ds_read_b128 a[16:19], v64 offset:16384
  ds_read_b128 a[20:23], v65 offset:16384
  ds_read_b128 a[24:27], v66 offset:16384
  ds_read_b128 a[28:31], v67 offset:16384
  ds_read_b128 a[32:35], v64 offset:32768
  ds_read_b128 a[36:39], v65 offset:32768
  ds_read_b128 a[40:43], v66 offset:32768
  ds_read_b128 a[44:47], v67 offset:32768
  ds_read_b128 a[48:51], v64 offset:49152
  ds_read_b128 a[52:55], v65 offset:49152
  ds_read_b128 a[56:59], v66 offset:49152
  ds_read_b128 a[60:63], v67 offset:49152
  ds_read_b128 a[64:67], v72 offset:0
  ds_read_b128 a[68:71], v73 offset:0
  ds_read_b128 a[72:75], v74 offset:0
  ds_read_b128 a[76:79], v75 offset:0
  ds_read_b128 a[80:83], v72 offset:16384
  ds_read_b128 a[84:87], v73 offset:16384
  ds_read_b128 a[88:91], v74 offset:16384
  ds_read_b128 a[92:95], v75 offset:16384
  ds_read_b64_tr_b16 a[160:161], v232 offset:16384
  ds_read_b64_tr_b16 a[162:163], v232 offset:17408
  v_mfma_f32_16x16x32_bf16 v[24:27], a[168:171], a[12:15], v[24:27]
  v_mfma_f32_16x16x32_bf16 v[28:31], a[172:175], a[12:15], v[28:31]
  ds_read_b64_tr_b16 a[164:165], v233 offset:16384
  ds_read_b64_tr_b16 a[166:167], v233 offset:17408
  s_add_u32 s40, s39, 768
  s_sub_u32 s38, s40, 1280
  s_min_u32 s40, s40, s38
  s_add_u32 m0, s41, 0
  s_nop 0
  buffer_load_dwordx4 v254, s[20:23], s40 offen offset:0 nt lds
  v_mfma_f32_16x16x32_bf16 v[20:23], a[172:175], a[8:11], v[20:23]
  s_waitcnt lgkmcnt(15)
  v_mfma_f32_16x16x32_bf16 v[32:35], a[176:179], a[8:11], v[32:35]
  ds_read_b64_tr_b16 a[168:169], v234 offset:16384
  ds_read_b64_tr_b16 a[170:171], v234 offset:17408
  v_mfma_f32_16x16x32_bf16 v[40:43], a[176:179], a[12:15], v[40:43]
  v_mfma_f32_16x16x32_bf16 v[44:47], a[180:183], a[12:15], v[44:47]
  ds_read_b64_tr_b16 a[172:173], v235 offset:16384
  ds_read_b64_tr_b16 a[174:175], v235 offset:17408
  v_mfma_f32_16x16x32_bf16 v[36:39], a[180:183], a[8:11], v[36:39]
  v_mfma_f32_16x16x32_bf16 v[48:51], a[184:187], a[8:11], v[48:51]
  ds_read_b64_tr_b16 a[176:177], v236 offset:16384
  ds_read_b64_tr_b16 a[178:179], v236 offset:17408
  s_add_u32 s38, s40, 9216
  buffer_load_dwordx4 v255, s[20:23], s38 offen offset:1024 nt lds
  v_mfma_f32_16x16x32_bf16 v[56:59], a[184:187], a[12:15], v[56:59]
  v_mfma_f32_16x16x32_bf16 v[60:63], a[188:191], a[12:15], v[60:63]
  ds_read_b64_tr_b16 a[180:181], v237 offset:16384
  ds_read_b64_tr_b16 a[182:183], v237 offset:17408
  v_mfma_f32_16x16x32_bf16 v[52:55], a[188:191], a[8:11], v[52:55]
  s_waitcnt lgkmcnt(8)
  v_mfma_f32_16x16x32_bf16 v[0:3], a[160:163], a[16:19], v[0:3]
  ds_read_b64_tr_b16 a[184:185], v238 offset:16384
  ds_read_b64_tr_b16 a[186:187], v238 offset:17408
  v_mfma_f32_16x16x32_bf16 v[8:11], a[160:163], a[20:23], v[8:11]
  v_mfma_f32_16x16x32_bf16 v[12:15], a[164:167], a[20:23], v[12:15]
  ds_read_b64_tr_b16 a[188:189], v239 offset:16384
  ds_read_b64_tr_b16 a[190:191], v239 offset:17408
  s_add_u32 s38, s40, 18432
  buffer_load_dwordx4 v254, s[20:23], s38 offen offset:2048 nt lds
  v_mfma_f32_16x16x32_bf16 v[4:7], a[164:167], a[16:19], v[4:7]
  s_waitcnt lgkmcnt(8)
  v_mfma_f32_16x16x32_bf16 v[16:19], a[168:171], a[16:19], v[16:19]
  ds_read_b64_tr_b16 a[160:161], v232 offset:24576
  ds_read_b64_tr_b16 a[162:163], v232 offset:25600
  v_mfma_f32_16x16x32_bf16 v[24:27], a[168:171], a[20:23], v[24:27]
  v_mfma_f32_16x16x32_bf16 v[28:31], a[172:175], a[20:23], v[28:31]
  ds_read_b64_tr_b16 a[164:165], v233 offset:24576
  ds_read_b64_tr_b16 a[166:167], v233 offset:25600
  v_mfma_f32_16x16x32_bf16 v[20:23], a[172:175], a[16:19], v[20:23]
  s_waitcnt lgkmcnt(8)
  v_mfma_f32_16x16x32_bf16 v[32:35], a[176:179], a[16:19], v[32:35]
  ds_read_b64_tr_b16 a[168:169], v234 offset:24576
  ds_read_b64_tr_b16 a[170:171], v234 offset:25600
  s_add_u32 s38, s40, 27648
  buffer_load_dwordx4 v255, s[20:23], s38 offen offset:3072 nt lds
  v_mfma_f32_16x16x32_bf16 v[40:43], a[176:179], a[20:23], v[40:43]
  v_mfma_f32_16x16x32_bf16 v[44:47], a[180:183], a[20:23], v[44:47]
  ds_read_b64_tr_b16 a[172:173], v235 offset:24576
  ds_read_b64_tr_b16 a[174:175], v235 offset:25600
  v_mfma_f32_16x16x32_bf16 v[36:39], a[180:183], a[16:19], v[36:39]
  s_waitcnt lgkmcnt(8)
  v_mfma_f32_16x16x32_bf16 v[48:51], a[184:187], a[16:19], v[48:51]
  ds_read_b64_tr_b16 a[176:177], v236 offset:24576
  ds_read_b64_tr_b16 a[178:179], v236 offset:25600
  v_mfma_f32_16x16x32_bf16 v[56:59], a[184:187], a[20:23], v[56:59]
  v_mfma_f32_16x16x32_bf16 v[60:63], a[188:191], a[20:23], v[60:63]
  ds_read_b64_tr_b16 a[180:181], v237 offset:24576
  ds_read_b64_tr_b16 a[182:183], v237 offset:25600
  v_mfma_f32_16x16x32_bf16 v[52:55], a[188:191], a[16:19], v[52:55]
  s_waitcnt lgkmcnt(8)
  v_mfma_f32_16x16x32_bf16 v[0:3], a[160:163], a[24:27], v[0:3]
  ds_read_b64_tr_b16 a[184:185], v238 offset:24576
  ds_read_b64_tr_b16 a[186:187], v238 offset:25600
  v_mfma_f32_16x16x32_bf16 v[8:11], a[160:163], a[28:31], v[8:11]
  v_mfma_f32_16x16x32_bf16 v[12:15], a[164:167], a[28:31], v[12:15]
  ds_read_b64_tr_b16 a[188:189], v239 offset:24576
  ds_read_b64_tr_b16 a[190:191], v239 offset:25600
  v_mfma_f32_16x16x32_bf16 v[4:7], a[164:167], a[24:27], v[4:7]
  s_waitcnt lgkmcnt(8)
  v_mfma_f32_16x16x32_bf16 v[16:19], a[168:171], a[24:27], v[16:19]
  s_barrier
  ds_read_b64_tr_b16 a[160:161], v232 offset:32768
  ds_read_b64_tr_b16 a[162:163], v232 offset:33792
  v_mfma_f32_16x16x32_bf16 v[24:27], a[168:171], a[28:31], v[24:27]
  v_mfma_f32_16x16x32_bf16 v[28:31], a[172:175], a[28:31], v[28:31]
  ds_read_b64_tr_b16 a[164:165], v233 offset:32768
  ds_read_b64_tr_b16 a[166:167], v233 offset:33792
  s_add_u32 m0, s41, 65536
  s_nop 0
  buffer_load_dwordx4 v244, s[16:19], s34 offen offset:0 lds
  v_mfma_f32_16x16x32_bf16 v[20:23], a[172:175], a[24:27], v[20:23]
  s_waitcnt lgkmcnt(8)
  v_mfma_f32_16x16x32_bf16 v[32:35], a[176:179], a[24:27], v[32:35]
  ds_read_b64_tr_b16 a[168:169], v234 offset:32768
  ds_read_b64_tr_b16 a[170:171], v234 offset:33792
  buffer_load_dwordx4 v245, s[16:19], s34 offen offset:1024 lds
  v_mfma_f32_16x16x32_bf16 v[40:43], a[176:179], a[28:31], v[40:43]
  v_mfma_f32_16x16x32_bf16 v[44:47], a[180:183], a[28:31], v[44:47]
  ds_read_b64_tr_b16 a[172:173], v235 offset:32768
  ds_read_b64_tr_b16 a[174:175], v235 offset:33792
  buffer_load_dwordx4 v246, s[16:19], s34 offen offset:2048 lds
  v_mfma_f32_16x16x32_bf16 v[36:39], a[180:183], a[24:27], v[36:39]
  s_waitcnt lgkmcnt(8)
  v_mfma_f32_16x16x32_bf16 v[48:51], a[184:187], a[24:27], v[48:51]
  ds_read_b64_tr_b16 a[176:177], v236 offset:32768
  ds_read_b64_tr_b16 a[178:179], v236 offset:33792
  buffer_load_dwordx4 v247, s[16:19], s34 offen offset:3072 lds
  s_add_u32 s34, s34, 524288
  s_sub_u32 s38, s34, 5242880
  s_min_u32 s34, s34, s38
  v_mfma_f32_16x16x32_bf16 v[56:59], a[184:187], a[28:31], v[56:59]
  v_mfma_f32_16x16x32_bf16 v[60:63], a[188:191], a[28:31], v[60:63]
  ds_read_b64_tr_b16 a[180:181], v237 offset:32768
  ds_read_b64_tr_b16 a[182:183], v237 offset:33792
  s_add_u32 s40, s39, 896
  s_sub_u32 s38, s40, 1280
  s_min_u32 s40, s40, s38
  s_add_u32 m0, s41, 16384
  s_nop 0
  buffer_load_dwordx4 v254, s[20:23], s40 offen offset:0 nt lds
  v_mfma_f32_16x16x32_bf16 v[52:55], a[188:191], a[24:27], v[52:55]
  s_waitcnt lgkmcnt(8)
  v_mfma_f32_16x16x32_bf16 v[0:3], a[160:163], a[32:35], v[0:3]
  ds_read_b64_tr_b16 a[184:185], v238 offset:32768
  ds_read_b64_tr_b16 a[186:187], v238 offset:33792
  s_add_u32 s38, s40, 9216
  buffer_load_dwordx4 v255, s[20:23], s38 offen offset:1024 nt lds
  v_mfma_f32_16x16x32_bf16 v[8:11], a[160:163], a[36:39], v[8:11]
  v_mfma_f32_16x16x32_bf16 v[12:15], a[164:167], a[36:39], v[12:15]
  ds_read_b64_tr_b16 a[188:189], v239 offset:32768
  ds_read_b64_tr_b16 a[190:191], v239 offset:33792
  s_add_u32 s38, s40, 18432
  buffer_load_dwordx4 v254, s[20:23], s38 offen offset:2048 nt lds
  v_mfma_f32_16x16x32_bf16 v[4:7], a[164:167], a[32:35], v[4:7]
  s_waitcnt lgkmcnt(8)
  v_mfma_f32_16x16x32_bf16 v[16:19], a[168:171], a[32:35], v[16:19]
  ds_read_b64_tr_b16 a[160:161], v232 offset:40960
  ds_read_b64_tr_b16 a[162:163], v232 offset:41984
  s_add_u32 s38, s40, 27648
  buffer_load_dwordx4 v255, s[20:23], s38 offen offset:3072 nt lds
  v_mfma_f32_16x16x32_bf16 v[24:27], a[168:171], a[36:39], v[24:27]
  v_mfma_f32_16x16x32_bf16 v[28:31], a[172:175], a[36:39], v[28:31]
  ds_read_b64_tr_b16 a[164:165], v233 offset:40960
  ds_read_b64_tr_b16 a[166:167], v233 offset:41984
  s_add_u32 m0, s41, 131072
  s_nop 0
  buffer_load_dwordx4 v244, s[16:19], s34 offen offset:0 lds
  v_mfma_f32_16x16x32_bf16 v[20:23], a[172:175], a[32:35], v[20:23]
  s_waitcnt lgkmcnt(8)
  v_mfma_f32_16x16x32_bf16 v[32:35], a[176:179], a[32:35], v[32:35]
  ds_read_b64_tr_b16 a[168:169], v234 offset:40960
  ds_read_b64_tr_b16 a[170:171], v234 offset:41984
  buffer_load_dwordx4 v245, s[16:19], s34 offen offset:1024 lds
  v_mfma_f32_16x16x32_bf16 v[40:43], a[176:179], a[36:39], v[40:43]
  v_mfma_f32_16x16x32_bf16 v[44:47], a[180:183], a[36:39], v[44:47]
  ds_read_b64_tr_b16 a[172:173], v235 offset:40960
  ds_read_b64_tr_b16 a[174:175], v235 offset:41984
  buffer_load_dwordx4 v246, s[16:19], s34 offen offset:2048 lds
  v_mfma_f32_16x16x32_bf16 v[36:39], a[180:183], a[32:35], v[36:39]
  s_waitcnt lgkmcnt(8)
  v_mfma_f32_16x16x32_bf16 v[48:51], a[184:187], a[32:35], v[48:51]
  ds_read_b64_tr_b16 a[176:177], v236 offset:40960
  ds_read_b64_tr_b16 a[178:179], v236 offset:41984
  buffer_load_dwordx4 v247, s[16:19], s34 offen offset:3072 lds
  s_add_u32 s34, s34, 524288
  s_sub_u32 s38, s34, 5242880
  s_min_u32 s34, s34, s38
  v_mfma_f32_16x16x32_bf16 v[56:59], a[184:187], a[36:39], v[56:59]
  v_mfma_f32_16x16x32_bf16 v[60:63], a[188:191], a[36:39], v[60:63]
  ds_read_b64_tr_b16 a[180:181], v237 offset:40960
  ds_read_b64_tr_b16 a[182:183], v237 offset:41984
  v_mfma_f32_16x16x32_bf16 v[52:55], a[188:191], a[32:35], v[52:55]
  s_waitcnt lgkmcnt(8)
  v_mfma_f32_16x16x32_bf16 v[0:3], a[160:163], a[40:43], v[0:3]
  ds_read_b64_tr_b16 a[184:185], v238 offset:40960
  ds_read_b64_tr_b16 a[186:187], v238 offset:41984
  v_mfma_f32_16x16x32_bf16 v[8:11], a[160:163], a[44:47], v[8:11]
  v_mfma_f32_16x16x32_bf16 v[12:15], a[164:167], a[44:47], v[12:15]
  ds_read_b64_tr_b16 a[188:189], v239 offset:40960
  ds_read_b64_tr_b16 a[190:191], v239 offset:41984
  v_mfma_f32_16x16x32_bf16 v[4:7], a[164:167], a[40:43], v[4:7]
  s_waitcnt lgkmcnt(8)
  v_mfma_f32_16x16x32_bf16 v[16:19], a[168:171], a[40:43], v[16:19]
  s_barrier
  ds_read_b64_tr_b16 a[160:161], v232 offset:49152
  ds_read_b64_tr_b16 a[162:163], v232 offset:50176
  v_mfma_f32_16x16x32_bf16 v[24:27], a[168:171], a[44:47], v[24:27]
  v_mfma_f32_16x16x32_bf16 v[28:31], a[172:175], a[44:47], v[28:31]
  ds_read_b64_tr_b16 a[164:165], v233 offset:49152
  ds_read_b64_tr_b16 a[166:167], v233 offset:50176
  s_add_u32 s40, s39, 1024
  s_sub_u32 s38, s40, 1280
  s_min_u32 s40, s40, s38
  s_add_u32 m0, s41, 32768
  s_nop 0
  buffer_load_dwordx4 v254, s[20:23], s40 offen offset:0 nt lds
  v_mfma_f32_16x16x32_bf16 v[20:23], a[172:175], a[40:43], v[20:23]
  s_waitcnt lgkmcnt(8)
  v_mfma_f32_16x16x32_bf16 v[32:35], a[176:179], a[40:43], v[32:35]
  ds_read_b64_tr_b16 a[168:169], v234 offset:49152
  ds_read_b64_tr_b16 a[170:171], v234 offset:50176
  s_add_u32 s38, s40, 9216
  buffer_load_dwordx4 v255, s[20:23], s38 offen offset:1024 nt lds
  v_mfma_f32_16x16x32_bf16 v[40:43], a[176:179], a[44:47], v[40:43]
  v_mfma_f32_16x16x32_bf16 v[44:47], a[180:183], a[44:47], v[44:47]
  ds_read_b64_tr_b16 a[172:173], v235 offset:49152
  ds_read_b64_tr_b16 a[174:175], v235 offset:50176
  s_add_u32 s38, s40, 18432
  buffer_load_dwordx4 v254, s[20:23], s38 offen offset:2048 nt lds
  v_mfma_f32_16x16x32_bf16 v[36:39], a[180:183], a[40:43], v[36:39]
  s_waitcnt lgkmcnt(8)
  v_mfma_f32_16x16x32_bf16 v[48:51], a[184:187], a[40:43], v[48:51]
  ds_read_b64_tr_b16 a[176:177], v236 offset:49152
  ds_read_b64_tr_b16 a[178:179], v236 offset:50176
  s_add_u32 s38, s40, 27648
  buffer_load_dwordx4 v255, s[20:23], s38 offen offset:3072 nt lds
  v_mfma_f32_16x16x32_bf16 v[56:59], a[184:187], a[44:47], v[56:59]
  v_mfma_f32_16x16x32_bf16 v[60:63], a[188:191], a[44:47], v[60:63]
  ds_read_b64_tr_b16 a[180:181], v237 offset:49152
  ds_read_b64_tr_b16 a[182:183], v237 offset:50176
  s_add_u32 m0, s41, 147456
  s_nop 0
  buffer_load_dwordx4 v244, s[16:19], s34 offen offset:0 lds
  v_mfma_f32_16x16x32_bf16 v[52:55], a[188:191], a[40:43], v[52:55]
  s_waitcnt lgkmcnt(8)
  v_mfma_f32_16x16x32_bf16 v[0:3], a[160:163], a[48:51], v[0:3]
  ds_read_b64_tr_b16 a[184:185], v238 offset:49152
  ds_read_b64_tr_b16 a[186:187], v238 offset:50176
  buffer_load_dwordx4 v245, s[16:19], s34 offen offset:1024 lds
  v_mfma_f32_16x16x32_bf16 v[8:11], a[160:163], a[52:55], v[8:11]
  v_mfma_f32_16x16x32_bf16 v[12:15], a[164:167], a[52:55], v[12:15]
  ds_read_b64_tr_b16 a[188:189], v239 offset:49152
  ds_read_b64_tr_b16 a[190:191], v239 offset:50176
  buffer_load_dwordx4 v246, s[16:19], s34 offen offset:2048 lds
  v_mfma_f32_16x16x32_bf16 v[4:7], a[164:167], a[48:51], v[4:7]
  s_waitcnt lgkmcnt(8)
  v_mfma_f32_16x16x32_bf16 v[16:19], a[168:171], a[48:51], v[16:19]
  ds_read_b64_tr_b16 a[160:161], v232 offset:57344
  ds_read_b64_tr_b16 a[162:163], v232 offset:58368
  buffer_load_dwordx4 v247, s[16:19], s34 offen offset:3072 lds
  s_add_u32 s34, s34, 524288
  s_sub_u32 s38, s34, 5242880
  s_min_u32 s34, s34, s38
  v_mfma_f32_16x16x32_bf16 v[24:27], a[168:171], a[52:55], v[24:27]
  v_mfma_f32_16x16x32_bf16 v[28:31], a[172:175], a[52:55], v[28:31]
  ds_read_b64_tr_b16 a[164:165], v233 offset:57344
  ds_read_b64_tr_b16 a[166:167], v233 offset:58368
  s_add_u32 s40, s39, 1152
  s_sub_u32 s38, s40, 1280
  s_min_u32 s40, s40, s38
  s_add_u32 m0, s41, 49152
  s_nop 0
  buffer_load_dwordx4 v254, s[20:23], s40 offen offset:0 nt lds
  v_mfma_f32_16x16x32_bf16 v[20:23], a[172:175], a[48:51], v[20:23]
  s_waitcnt lgkmcnt(8)
  v_mfma_f32_16x16x32_bf16 v[32:35], a[176:179], a[48:51], v[32:35]
  ds_read_b64_tr_b16 a[168:169], v234 offset:57344
  ds_read_b64_tr_b16 a[170:171], v234 offset:58368
  s_add_u32 s38, s40, 9216
  buffer_load_dwordx4 v255, s[20:23], s38 offen offset:1024 nt lds
  v_mfma_f32_16x16x32_bf16 v[40:43], a[176:179], a[52:55], v[40:43]
  v_mfma_f32_16x16x32_bf16 v[44:47], a[180:183], a[52:55], v[44:47]
  ds_read_b64_tr_b16 a[172:173], v235 offset:57344
  ds_read_b64_tr_b16 a[174:175], v235 offset:58368
  s_add_u32 s38, s40, 18432
  buffer_load_dwordx4 v254, s[20:23], s38 offen offset:2048 nt lds
  v_mfma_f32_16x16x32_bf16 v[36:39], a[180:183], a[48:51], v[36:39]
  s_waitcnt lgkmcnt(8)
  v_mfma_f32_16x16x32_bf16 v[48:51], a[184:187], a[48:51], v[48:51]
  ds_read_b64_tr_b16 a[176:177], v236 offset:57344
  ds_read_b64_tr_b16 a[178:179], v236 offset:58368
  s_add_u32 s38, s40, 27648
  buffer_load_dwordx4 v255, s[20:23], s38 offen offset:3072 nt lds
  v_mfma_f32_16x16x32_bf16 v[56:59], a[184:187], a[52:55], v[56:59]
  v_mfma_f32_16x16x32_bf16 v[60:63], a[188:191], a[52:55], v[60:63]
  ds_read_b64_tr_b16 a[180:181], v237 offset:57344
  ds_read_b64_tr_b16 a[182:183], v237 offset:58368
  v_mfma_f32_16x16x32_bf16 v[52:55], a[188:191], a[48:51], v[52:55]
  s_waitcnt lgkmcnt(8)
  v_mfma_f32_16x16x32_bf16 v[0:3], a[160:163], a[56:59], v[0:3]
  ds_read_b64_tr_b16 a[184:185], v238 offset:57344
  ds_read_b64_tr_b16 a[186:187], v238 offset:58368
  v_mfma_f32_16x16x32_bf16 v[8:11], a[160:163], a[60:63], v[8:11]
  v_mfma_f32_16x16x32_bf16 v[12:15], a[164:167], a[60:63], v[12:15]
  ds_read_b64_tr_b16 a[188:189], v239 offset:57344
  ds_read_b64_tr_b16 a[190:191], v239 offset:58368
  v_mfma_f32_16x16x32_bf16 v[4:7], a[164:167], a[56:59], v[4:7]
  s_waitcnt lgkmcnt(8)
  v_mfma_f32_16x16x32_bf16 v[16:19], a[168:171], a[56:59], v[16:19]
  s_waitcnt vmcnt(20)
  s_barrier
  buffer_atomic_add v82, v80, s[84:87], 0 offen sc1
  ds_read_b128 a[96:99], v64 offset:0
  ds_read_b128 a[100:103], v65 offset:0
  ds_read_b128 a[104:107], v66 offset:0
  ds_read_b128 a[108:111], v67 offset:0
  ds_read_b64_tr_b16 a[160:161], v232 offset:0
  ds_read_b64_tr_b16 a[162:163], v232 offset:1024
  v_mfma_f32_16x16x32_bf16 v[24:27], a[168:171], a[60:63], v[24:27]
  v_mfma_f32_16x16x32_bf16 v[28:31], a[172:175], a[60:63], v[28:31]
  ds_read_b64_tr_b16 a[164:165], v233 offset:0
  ds_read_b64_tr_b16 a[166:167], v233 offset:1024
  s_add_u32 m0, s41, 81920
  s_nop 0
  buffer_load_dwordx4 v244, s[16:19], s34 offen offset:0 lds
  v_mfma_f32_16x16x32_bf16 v[20:23], a[172:175], a[56:59], v[20:23]
  s_waitcnt lgkmcnt(12)
  v_mfma_f32_16x16x32_bf16 v[32:35], a[176:179], a[56:59], v[32:35]
  ds_read_b64_tr_b16 a[168:169], v234 offset:0
  ds_read_b64_tr_b16 a[170:171], v234 offset:1024
  buffer_load_dwordx4 v245, s[16:19], s34 offen offset:1024 lds
  v_mfma_f32_16x16x32_bf16 v[40:43], a[176:179], a[60:63], v[40:43]
  v_mfma_f32_16x16x32_bf16 v[44:47], a[180:183], a[60:63], v[44:47]
  ds_read_b64_tr_b16 a[172:173], v235 offset:0
  ds_read_b64_tr_b16 a[174:175], v235 offset:1024
  buffer_load_dwordx4 v246, s[16:19], s34 offen offset:2048 lds
  v_mfma_f32_16x16x32_bf16 v[36:39], a[180:183], a[56:59], v[36:39]
  s_waitcnt lgkmcnt(12)
  v_mfma_f32_16x16x32_bf16 v[48:51], a[184:187], a[56:59], v[48:51]
  ds_read_b64_tr_b16 a[176:177], v236 offset:0
  ds_read_b64_tr_b16 a[178:179], v236 offset:1024
  buffer_load_dwordx4 v247, s[16:19], s34 offen offset:3072 lds
  s_add_u32 s34, s34, 524288
  s_sub_u32 s38, s34, 5242880
  s_min_u32 s34, s34, s38
  v_mfma_f32_16x16x32_bf16 v[56:59], a[184:187], a[60:63], v[56:59]
  v_mfma_f32_16x16x32_bf16 v[60:63], a[188:191], a[60:63], v[60:63]
  ds_read_b64_tr_b16 a[180:181], v237 offset:0
  ds_read_b64_tr_b16 a[182:183], v237 offset:1024
  s_add_u32 m0, s41, 98304
  s_nop 0
  buffer_load_dwordx4 v244, s[16:19], s34 offen offset:0 lds
  v_mfma_f32_16x16x32_bf16 v[52:55], a[188:191], a[56:59], v[52:55]
  s_waitcnt lgkmcnt(8)
  v_mfma_f32_16x16x32_bf16 v[0:3], a[160:163], a[64:67], v[0:3]
  ds_read_b64_tr_b16 a[184:185], v238 offset:0
  ds_read_b64_tr_b16 a[186:187], v238 offset:1024
  buffer_load_dwordx4 v245, s[16:19], s34 offen offset:1024 lds
  v_mfma_f32_16x16x32_bf16 v[8:11], a[160:163], a[68:71], v[8:11]
  v_mfma_f32_16x16x32_bf16 v[12:15], a[164:167], a[68:71], v[12:15]
  ds_read_b64_tr_b16 a[188:189], v239 offset:0
  ds_read_b64_tr_b16 a[190:191], v239 offset:1024
  buffer_load_dwordx4 v246, s[16:19], s34 offen offset:2048 lds
  v_mfma_f32_16x16x32_bf16 v[4:7], a[164:167], a[64:67], v[4:7]
  s_waitcnt lgkmcnt(8)
  v_mfma_f32_16x16x32_bf16 v[16:19], a[168:171], a[64:67], v[16:19]
  ds_read_b64_tr_b16 a[160:161], v232 offset:8192
  ds_read_b64_tr_b16 a[162:163], v232 offset:9216
  buffer_load_dwordx4 v247, s[16:19], s34 offen offset:3072 lds
  s_add_u32 s34, s34, 524288
  s_sub_u32 s38, s34, 5242880
  s_min_u32 s34, s34, s38
  v_mfma_f32_16x16x32_bf16 v[24:27], a[168:171], a[68:71], v[24:27]
  v_mfma_f32_16x16x32_bf16 v[28:31], a[172:175], a[68:71], v[28:31]
  ds_read_b64_tr_b16 a[164:165], v233 offset:8192
  ds_read_b64_tr_b16 a[166:167], v233 offset:9216
  v_mfma_f32_16x16x32_bf16 v[20:23], a[172:175], a[64:67], v[20:23]
  s_waitcnt lgkmcnt(8)
  v_mfma_f32_16x16x32_bf16 v[32:35], a[176:179], a[64:67], v[32:35]
  ds_read_b64_tr_b16 a[168:169], v234 offset:8192
  ds_read_b64_tr_b16 a[170:171], v234 offset:9216
  v_mfma_f32_16x16x32_bf16 v[40:43], a[176:179], a[68:71], v[40:43]
  v_mfma_f32_16x16x32_bf16 v[44:47], a[180:183], a[68:71], v[44:47]
  ds_read_b64_tr_b16 a[172:173], v235 offset:8192
  ds_read_b64_tr_b16 a[174:175], v235 offset:9216
  v_mfma_f32_16x16x32_bf16 v[36:39], a[180:183], a[64:67], v[36:39]
  s_waitcnt lgkmcnt(8)
  v_mfma_f32_16x16x32_bf16 v[48:51], a[184:187], a[64:67], v[48:51]
  ds_read_b64_tr_b16 a[176:177], v236 offset:8192
  ds_read_b64_tr_b16 a[178:179], v236 offset:9216
  v_mfma_f32_16x16x32_bf16 v[56:59], a[184:187], a[68:71], v[56:59]
  v_mfma_f32_16x16x32_bf16 v[60:63], a[188:191], a[68:71], v[60:63]
  ds_read_b64_tr_b16 a[180:181], v237 offset:8192
  ds_read_b64_tr_b16 a[182:183], v237 offset:9216
  v_mfma_f32_16x16x32_bf16 v[52:55], a[188:191], a[64:67], v[52:55]
  s_waitcnt lgkmcnt(8)
  v_mfma_f32_16x16x32_bf16 v[0:3], a[160:163], a[72:75], v[0:3]
  ds_read_b64_tr_b16 a[184:185], v238 offset:8192
  ds_read_b64_tr_b16 a[186:187], v238 offset:9216
  v_mfma_f32_16x16x32_bf16 v[8:11], a[160:163], a[76:79], v[8:11]
  v_mfma_f32_16x16x32_bf16 v[12:15], a[164:167], a[76:79], v[12:15]
  ds_read_b64_tr_b16 a[188:189], v239 offset:8192
  ds_read_b64_tr_b16 a[190:191], v239 offset:9216
  v_mfma_f32_16x16x32_bf16 v[4:7], a[164:167], a[72:75], v[4:7]
  s_waitcnt lgkmcnt(8)
  v_mfma_f32_16x16x32_bf16 v[16:19], a[168:171], a[72:75], v[16:19]
  s_waitcnt vmcnt(21)
  s_barrier
  ds_read_b128 a[112:115], v64 offset:16384
  ds_read_b128 a[116:119], v65 offset:16384
  ds_read_b128 a[120:123], v66 offset:16384
  ds_read_b128 a[124:127], v67 offset:16384
  ds_read_b64_tr_b16 a[160:161], v200 offset:0
  ds_read_b64_tr_b16 a[162:163], v200 offset:1024
  v_mfma_f32_16x16x32_bf16 v[24:27], a[168:171], a[76:79], v[24:27]
  v_mfma_f32_16x16x32_bf16 v[28:31], a[172:175], a[76:79], v[28:31]
  ds_read_b64_tr_b16 a[164:165], v201 offset:0
  ds_read_b64_tr_b16 a[166:167], v201 offset:1024
  s_add_u32 m0, s41, 114688
  s_nop 0
  buffer_load_dwordx4 v244, s[16:19], s34 offen offset:0 lds
  v_mfma_f32_16x16x32_bf16 v[20:23], a[172:175], a[72:75], v[20:23]
  s_waitcnt lgkmcnt(12)
  v_mfma_f32_16x16x32_bf16 v[32:35], a[176:179], a[72:75], v[32:35]
  ds_read_b64_tr_b16 a[168:169], v202 offset:0
  ds_read_b64_tr_b16 a[170:171], v202 offset:1024
  buffer_load_dwordx4 v245, s[16:19], s34 offen offset:1024 lds
  v_mfma_f32_16x16x32_bf16 v[40:43], a[176:179], a[76:79], v[40:43]
  v_mfma_f32_16x16x32_bf16 v[44:47], a[180:183], a[76:79], v[44:47]
  ds_read_b64_tr_b16 a[172:173], v203 offset:0
  ds_read_b64_tr_b16 a[174:175], v203 offset:1024
  buffer_load_dwordx4 v246, s[16:19], s34 offen offset:2048 lds
  v_mfma_f32_16x16x32_bf16 v[36:39], a[180:183], a[72:75], v[36:39]
  s_waitcnt lgkmcnt(12)
  v_mfma_f32_16x16x32_bf16 v[48:51], a[184:187], a[72:75], v[48:51]
  ds_read_b64_tr_b16 a[176:177], v204 offset:0
  ds_read_b64_tr_b16 a[178:179], v204 offset:1024
  buffer_load_dwordx4 v247, s[16:19], s34 offen offset:3072 lds
  s_add_u32 s34, s34, 524544
  s_sub_u32 s38, s34, 5242880
  s_min_u32 s34, s34, s38
  v_mfma_f32_16x16x32_bf16 v[56:59], a[184:187], a[76:79], v[56:59]
  v_mfma_f32_16x16x32_bf16 v[60:63], a[188:191], a[76:79], v[60:63]
  ds_read_b64_tr_b16 a[180:181], v205 offset:0
  ds_read_b64_tr_b16 a[182:183], v205 offset:1024
  s_add_u32 m0, s41, 0
  s_nop 0
  buffer_load_dwordx4 v240, s[8:11], s32 offen offset:0 nt lds
  v_mfma_f32_16x16x32_bf16 v[52:55], a[188:191], a[72:75], v[52:55]
  s_waitcnt lgkmcnt(8)
  v_mfma_f32_16x16x32_bf16 v[0:3], a[160:163], a[80:83], v[0:3]
  ds_read_b64_tr_b16 a[184:185], v206 offset:0
  ds_read_b64_tr_b16 a[186:187], v206 offset:1024
  buffer_load_dwordx4 v241, s[8:11], s32 offen offset:1024 nt lds
  v_mfma_f32_16x16x32_bf16 v[8:11], a[160:163], a[84:87], v[8:11]
  v_mfma_f32_16x16x32_bf16 v[12:15], a[164:167], a[84:87], v[12:15]
  ds_read_b64_tr_b16 a[188:189], v207 offset:0
  ds_read_b64_tr_b16 a[190:191], v207 offset:1024
  buffer_load_dwordx4 v242, s[8:11], s32 offen offset:2048 nt lds
  v_mfma_f32_16x16x32_bf16 v[4:7], a[164:167], a[80:83], v[4:7]
  s_waitcnt lgkmcnt(8)
  v_mfma_f32_16x16x32_bf16 v[16:19], a[168:171], a[80:83], v[16:19]
  ds_read_b64_tr_b16 a[160:161], v200 offset:8192
  ds_read_b64_tr_b16 a[162:163], v200 offset:9216
  buffer_load_dwordx4 v243, s[8:11], s32 offen offset:3072 nt lds
  s_add_u32 s32, s32, 0x4000
  v_mfma_f32_16x16x32_bf16 v[24:27], a[168:171], a[84:87], v[24:27]
  v_mfma_f32_16x16x32_bf16 v[28:31], a[172:175], a[84:87], v[28:31]
  ds_read_b64_tr_b16 a[164:165], v201 offset:8192
  ds_read_b64_tr_b16 a[166:167], v201 offset:9216
  v_mfma_f32_16x16x32_bf16 v[20:23], a[172:175], a[80:83], v[20:23]
  s_waitcnt lgkmcnt(8)
  v_mfma_f32_16x16x32_bf16 v[32:35], a[176:179], a[80:83], v[32:35]
  ds_read_b64_tr_b16 a[168:169], v202 offset:8192
  ds_read_b64_tr_b16 a[170:171], v202 offset:9216
  v_mfma_f32_16x16x32_bf16 v[40:43], a[176:179], a[84:87], v[40:43]
  v_mfma_f32_16x16x32_bf16 v[44:47], a[180:183], a[84:87], v[44:47]
  ds_read_b64_tr_b16 a[172:173], v203 offset:8192
  ds_read_b64_tr_b16 a[174:175], v203 offset:9216
  v_mfma_f32_16x16x32_bf16 v[36:39], a[180:183], a[80:83], v[36:39]
  s_waitcnt lgkmcnt(8)
  v_mfma_f32_16x16x32_bf16 v[48:51], a[184:187], a[80:83], v[48:51]
  ds_read_b64_tr_b16 a[176:177], v204 offset:8192
  ds_read_b64_tr_b16 a[178:179], v204 offset:9216
  v_mfma_f32_16x16x32_bf16 v[56:59], a[184:187], a[84:87], v[56:59]
  v_mfma_f32_16x16x32_bf16 v[60:63], a[188:191], a[84:87], v[60:63]
  ds_read_b64_tr_b16 a[180:181], v205 offset:8192
  ds_read_b64_tr_b16 a[182:183], v205 offset:9216
  v_mfma_f32_16x16x32_bf16 v[52:55], a[188:191], a[80:83], v[52:55]
  s_waitcnt lgkmcnt(8)
  v_mfma_f32_16x16x32_bf16 v[0:3], a[160:163], a[88:91], v[0:3]
  ds_read_b64_tr_b16 a[184:185], v206 offset:8192
  ds_read_b64_tr_b16 a[186:187], v206 offset:9216
  v_mfma_f32_16x16x32_bf16 v[8:11], a[160:163], a[92:95], v[8:11]
  v_mfma_f32_16x16x32_bf16 v[12:15], a[164:167], a[92:95], v[12:15]
  ds_read_b64_tr_b16 a[188:189], v207 offset:8192
  ds_read_b64_tr_b16 a[190:191], v207 offset:9216
  v_mfma_f32_16x16x32_bf16 v[4:7], a[164:167], a[88:91], v[4:7]
  s_waitcnt lgkmcnt(8)
  v_mfma_f32_16x16x32_bf16 v[16:19], a[168:171], a[88:91], v[16:19]
  s_waitcnt vmcnt(21)
  s_barrier
  ds_read_b128 a[128:131], v64 offset:32768
  ds_read_b128 a[132:135], v65 offset:32768
  ds_read_b128 a[136:139], v66 offset:32768
  ds_read_b128 a[140:143], v67 offset:32768
  ds_read_b64_tr_b16 a[160:161], v200 offset:16384
  ds_read_b64_tr_b16 a[162:163], v200 offset:17408
  v_mfma_f32_16x16x32_bf16 v[24:27], a[168:171], a[92:95], v[24:27]
  v_mfma_f32_16x16x32_bf16 v[28:31], a[172:175], a[92:95], v[28:31]
  ds_read_b64_tr_b16 a[164:165], v201 offset:16384
  ds_read_b64_tr_b16 a[166:167], v201 offset:17408
  s_add_u32 m0, s41, 65536
  s_nop 0
  buffer_load_dwordx4 v244, s[16:19], s34 offen offset:0 lds
  v_mfma_f32_16x16x32_bf16 v[20:23], a[172:175], a[88:91], v[20:23]
  s_waitcnt lgkmcnt(12)
  v_mfma_f32_16x16x32_bf16 v[32:35], a[176:179], a[88:91], v[32:35]
  ds_read_b64_tr_b16 a[168:169], v202 offset:16384
  ds_read_b64_tr_b16 a[170:171], v202 offset:17408
  buffer_load_dwordx4 v245, s[16:19], s34 offen offset:1024 lds
  v_mfma_f32_16x16x32_bf16 v[40:43], a[176:179], a[92:95], v[40:43]
  v_mfma_f32_16x16x32_bf16 v[44:47], a[180:183], a[92:95], v[44:47]
  ds_read_b64_tr_b16 a[172:173], v203 offset:16384
  ds_read_b64_tr_b16 a[174:175], v203 offset:17408
  buffer_load_dwordx4 v246, s[16:19], s34 offen offset:2048 lds
  v_mfma_f32_16x16x32_bf16 v[36:39], a[180:183], a[88:91], v[36:39]
  s_waitcnt lgkmcnt(12)
  v_mfma_f32_16x16x32_bf16 v[48:51], a[184:187], a[88:91], v[48:51]
  ds_read_b64_tr_b16 a[176:177], v204 offset:16384
  ds_read_b64_tr_b16 a[178:179], v204 offset:17408
  buffer_load_dwordx4 v247, s[16:19], s34 offen offset:3072 lds
  s_add_u32 s34, s34, 524288
  s_sub_u32 s38, s34, 5242880
  s_min_u32 s34, s34, s38
  v_mfma_f32_16x16x32_bf16 v[56:59], a[184:187], a[92:95], v[56:59]
  v_mfma_f32_16x16x32_bf16 v[60:63], a[188:191], a[92:95], v[60:63]
  ds_read_b64_tr_b16 a[180:181], v205 offset:16384
  ds_read_b64_tr_b16 a[182:183], v205 offset:17408
  s_add_u32 m0, s41, 16384
  s_nop 0
  buffer_load_dwordx4 v240, s[8:11], s32 offen offset:0 nt lds
  v_mfma_f32_16x16x32_bf16 v[52:55], a[188:191], a[88:91], v[52:55]
  s_waitcnt lgkmcnt(8)
  v_mfma_f32_16x16x32_bf16 v[0:3], a[160:163], a[96:99], v[0:3]
  ds_read_b64_tr_b16 a[184:185], v206 offset:16384
  ds_read_b64_tr_b16 a[186:187], v206 offset:17408
  buffer_load_dwordx4 v241, s[8:11], s32 offen offset:1024 nt lds
  v_mfma_f32_16x16x32_bf16 v[8:11], a[160:163], a[100:103], v[8:11]
  v_mfma_f32_16x16x32_bf16 v[12:15], a[164:167], a[100:103], v[12:15]
  ds_read_b64_tr_b16 a[188:189], v207 offset:16384
  ds_read_b64_tr_b16 a[190:191], v207 offset:17408
  buffer_load_dwordx4 v242, s[8:11], s32 offen offset:2048 nt lds
  v_mfma_f32_16x16x32_bf16 v[4:7], a[164:167], a[96:99], v[4:7]
  s_waitcnt lgkmcnt(8)
  v_mfma_f32_16x16x32_bf16 v[16:19], a[168:171], a[96:99], v[16:19]
  ds_read_b64_tr_b16 a[160:161], v200 offset:24576
  ds_read_b64_tr_b16 a[162:163], v200 offset:25600
  buffer_load_dwordx4 v243, s[8:11], s32 offen offset:3072 nt lds
  s_add_u32 s32, s32, 0x4000
  v_mfma_f32_16x16x32_bf16 v[24:27], a[168:171], a[100:103], v[24:27]
  v_mfma_f32_16x16x32_bf16 v[28:31], a[172:175], a[100:103], v[28:31]
  ds_read_b64_tr_b16 a[164:165], v201 offset:24576
  ds_read_b64_tr_b16 a[166:167], v201 offset:25600
  v_mfma_f32_16x16x32_bf16 v[20:23], a[172:175], a[96:99], v[20:23]
  s_waitcnt lgkmcnt(8)
  v_mfma_f32_16x16x32_bf16 v[32:35], a[176:179], a[96:99], v[32:35]
  ds_read_b64_tr_b16 a[168:169], v202 offset:24576
  ds_read_b64_tr_b16 a[170:171], v202 offset:25600
  v_mfma_f32_16x16x32_bf16 v[40:43], a[176:179], a[100:103], v[40:43]
  v_mfma_f32_16x16x32_bf16 v[44:47], a[180:183], a[100:103], v[44:47]
  ds_read_b64_tr_b16 a[172:173], v203 offset:24576
  ds_read_b64_tr_b16 a[174:175], v203 offset:25600
  v_mfma_f32_16x16x32_bf16 v[36:39], a[180:183], a[96:99], v[36:39]
  s_waitcnt lgkmcnt(8)
  v_mfma_f32_16x16x32_bf16 v[48:51], a[184:187], a[96:99], v[48:51]
  ds_read_b64_tr_b16 a[176:177], v204 offset:24576
  ds_read_b64_tr_b16 a[178:179], v204 offset:25600
  v_mfma_f32_16x16x32_bf16 v[56:59], a[184:187], a[100:103], v[56:59]
  v_mfma_f32_16x16x32_bf16 v[60:63], a[188:191], a[100:103], v[60:63]
  ds_read_b64_tr_b16 a[180:181], v205 offset:24576
  ds_read_b64_tr_b16 a[182:183], v205 offset:25600
  v_mfma_f32_16x16x32_bf16 v[52:55], a[188:191], a[96:99], v[52:55]
  s_waitcnt lgkmcnt(8)
  v_mfma_f32_16x16x32_bf16 v[0:3], a[160:163], a[104:107], v[0:3]
  ds_read_b64_tr_b16 a[184:185], v206 offset:24576
  ds_read_b64_tr_b16 a[186:187], v206 offset:25600
  v_mfma_f32_16x16x32_bf16 v[8:11], a[160:163], a[108:111], v[8:11]
  v_mfma_f32_16x16x32_bf16 v[12:15], a[164:167], a[108:111], v[12:15]
  ds_read_b64_tr_b16 a[188:189], v207 offset:24576
  ds_read_b64_tr_b16 a[190:191], v207 offset:25600
  v_mfma_f32_16x16x32_bf16 v[4:7], a[164:167], a[104:107], v[4:7]
  s_waitcnt lgkmcnt(8)
  v_mfma_f32_16x16x32_bf16 v[16:19], a[168:171], a[104:107], v[16:19]
  s_waitcnt vmcnt(20)
  s_barrier
  ds_read_b128 a[144:147], v64 offset:49152
  ds_read_b128 a[148:151], v65 offset:49152
  ds_read_b128 a[152:155], v66 offset:49152
  ds_read_b128 a[156:159], v67 offset:49152
  ds_read_b64_tr_b16 a[160:161], v232 offset:16384
  ds_read_b64_tr_b16 a[162:163], v232 offset:17408
  v_mfma_f32_16x16x32_bf16 v[24:27], a[168:171], a[108:111], v[24:27]
  v_mfma_f32_16x16x32_bf16 v[28:31], a[172:175], a[108:111], v[28:31]
  ds_read_b64_tr_b16 a[164:165], v233 offset:16384
  ds_read_b64_tr_b16 a[166:167], v233 offset:17408
  s_add_u32 m0, s41, 131072
  s_nop 0
  buffer_load_dwordx4 v244, s[16:19], s34 offen offset:0 lds
  v_mfma_f32_16x16x32_bf16 v[20:23], a[172:175], a[104:107], v[20:23]
  s_waitcnt lgkmcnt(12)
  v_mfma_f32_16x16x32_bf16 v[32:35], a[176:179], a[104:107], v[32:35]
  ds_read_b64_tr_b16 a[168:169], v234 offset:16384
  ds_read_b64_tr_b16 a[170:171], v234 offset:17408
  buffer_load_dwordx4 v245, s[16:19], s34 offen offset:1024 lds
  v_mfma_f32_16x16x32_bf16 v[40:43], a[176:179], a[108:111], v[40:43]
  v_mfma_f32_16x16x32_bf16 v[44:47], a[180:183], a[108:111], v[44:47]
  ds_read_b64_tr_b16 a[172:173], v235 offset:16384
  ds_read_b64_tr_b16 a[174:175], v235 offset:17408
  buffer_load_dwordx4 v246, s[16:19], s34 offen offset:2048 lds
  v_mfma_f32_16x16x32_bf16 v[36:39], a[180:183], a[104:107], v[36:39]
  s_waitcnt lgkmcnt(12)
  v_mfma_f32_16x16x32_bf16 v[48:51], a[184:187], a[104:107], v[48:51]
  ds_read_b64_tr_b16 a[176:177], v236 offset:16384
  ds_read_b64_tr_b16 a[178:179], v236 offset:17408
  buffer_load_dwordx4 v247, s[16:19], s34 offen offset:3072 lds
  s_add_u32 s34, s34, 524288
  s_sub_u32 s38, s34, 5242880
  s_min_u32 s34, s34, s38
  v_mfma_f32_16x16x32_bf16 v[56:59], a[184:187], a[108:111], v[56:59]
  v_mfma_f32_16x16x32_bf16 v[60:63], a[188:191], a[108:111], v[60:63]
  ds_read_b64_tr_b16 a[180:181], v237 offset:16384
  ds_read_b64_tr_b16 a[182:183], v237 offset:17408
  s_add_u32 m0, s41, 32768
  s_nop 0
  buffer_load_dwordx4 v240, s[8:11], s32 offen offset:0 nt lds
  v_mfma_f32_16x16x32_bf16 v[52:55], a[188:191], a[104:107], v[52:55]
  s_waitcnt lgkmcnt(8)
  v_mfma_f32_16x16x32_bf16 v[0:3], a[160:163], a[112:115], v[0:3]
  ds_read_b64_tr_b16 a[184:185], v238 offset:16384
  ds_read_b64_tr_b16 a[186:187], v238 offset:17408
  buffer_load_dwordx4 v241, s[8:11], s32 offen offset:1024 nt lds
  v_mfma_f32_16x16x32_bf16 v[8:11], a[160:163], a[116:119], v[8:11]
  v_mfma_f32_16x16x32_bf16 v[12:15], a[164:167], a[116:119], v[12:15]
  ds_read_b64_tr_b16 a[188:189], v239 offset:16384
  ds_read_b64_tr_b16 a[190:191], v239 offset:17408
  buffer_load_dwordx4 v242, s[8:11], s32 offen offset:2048 nt lds
  v_mfma_f32_16x16x32_bf16 v[4:7], a[164:167], a[112:115], v[4:7]
  s_waitcnt lgkmcnt(8)
  v_mfma_f32_16x16x32_bf16 v[16:19], a[168:171], a[112:115], v[16:19]
  ds_read_b64_tr_b16 a[160:161], v232 offset:24576
  ds_read_b64_tr_b16 a[162:163], v232 offset:25600
  buffer_load_dwordx4 v243, s[8:11], s32 offen offset:3072 nt lds
  s_add_u32 s32, s32, 0x4000
  v_mfma_f32_16x16x32_bf16 v[24:27], a[168:171], a[116:119], v[24:27]
  v_mfma_f32_16x16x32_bf16 v[28:31], a[172:175], a[116:119], v[28:31]
  ds_read_b64_tr_b16 a[164:165], v233 offset:24576
  ds_read_b64_tr_b16 a[166:167], v233 offset:25600
  v_mfma_f32_16x16x32_bf16 v[20:23], a[172:175], a[112:115], v[20:23]
  s_waitcnt lgkmcnt(8)
  v_mfma_f32_16x16x32_bf16 v[32:35], a[176:179], a[112:115], v[32:35]
  ds_read_b64_tr_b16 a[168:169], v234 offset:24576
  ds_read_b64_tr_b16 a[170:171], v234 offset:25600
  v_mfma_f32_16x16x32_bf16 v[40:43], a[176:179], a[116:119], v[40:43]
  v_mfma_f32_16x16x32_bf16 v[44:47], a[180:183], a[116:119], v[44:47]
  ds_read_b64_tr_b16 a[172:173], v235 offset:24576
  ds_read_b64_tr_b16 a[174:175], v235 offset:25600
  v_mfma_f32_16x16x32_bf16 v[36:39], a[180:183], a[112:115], v[36:39]
  s_waitcnt lgkmcnt(8)
  v_mfma_f32_16x16x32_bf16 v[48:51], a[184:187], a[112:115], v[48:51]
  ds_read_b64_tr_b16 a[176:177], v236 offset:24576
  ds_read_b64_tr_b16 a[178:179], v236 offset:25600
  v_mfma_f32_16x16x32_bf16 v[56:59], a[184:187], a[116:119], v[56:59]
  v_mfma_f32_16x16x32_bf16 v[60:63], a[188:191], a[116:119], v[60:63]
  ds_read_b64_tr_b16 a[180:181], v237 offset:24576
  ds_read_b64_tr_b16 a[182:183], v237 offset:25600
  v_mfma_f32_16x16x32_bf16 v[52:55], a[188:191], a[112:115], v[52:55]
  s_waitcnt lgkmcnt(8)
  v_mfma_f32_16x16x32_bf16 v[0:3], a[160:163], a[120:123], v[0:3]
  ds_read_b64_tr_b16 a[184:185], v238 offset:24576
  ds_read_b64_tr_b16 a[186:187], v238 offset:25600
  v_mfma_f32_16x16x32_bf16 v[8:11], a[160:163], a[124:127], v[8:11]
  v_mfma_f32_16x16x32_bf16 v[12:15], a[164:167], a[124:127], v[12:15]
  ds_read_b64_tr_b16 a[188:189], v239 offset:24576
  ds_read_b64_tr_b16 a[190:191], v239 offset:25600
  v_mfma_f32_16x16x32_bf16 v[4:7], a[164:167], a[120:123], v[4:7]
  s_waitcnt lgkmcnt(8)
  v_mfma_f32_16x16x32_bf16 v[16:19], a[168:171], a[120:123], v[16:19]
  s_waitcnt vmcnt(24)
  s_barrier
  ds_read_b64_tr_b16 a[160:161], v232 offset:32768
  ds_read_b64_tr_b16 a[162:163], v232 offset:33792
  v_mfma_f32_16x16x32_bf16 v[24:27], a[168:171], a[124:127], v[24:27]
  v_mfma_f32_16x16x32_bf16 v[28:31], a[172:175], a[124:127], v[28:31]
  ds_read_b64_tr_b16 a[164:165], v233 offset:32768
  ds_read_b64_tr_b16 a[166:167], v233 offset:33792
  s_add_u32 m0, s41, 147456
  s_nop 0
  buffer_load_dwordx4 v244, s[16:19], s34 offen offset:0 lds
  v_mfma_f32_16x16x32_bf16 v[20:23], a[172:175], a[120:123], v[20:23]
  s_waitcnt lgkmcnt(8)
  v_mfma_f32_16x16x32_bf16 v[32:35], a[176:179], a[120:123], v[32:35]
  ds_read_b64_tr_b16 a[168:169], v234 offset:32768
  ds_read_b64_tr_b16 a[170:171], v234 offset:33792
  buffer_load_dwordx4 v245, s[16:19], s34 offen offset:1024 lds
  v_mfma_f32_16x16x32_bf16 v[40:43], a[176:179], a[124:127], v[40:43]
  v_mfma_f32_16x16x32_bf16 v[44:47], a[180:183], a[124:127], v[44:47]
  ds_read_b64_tr_b16 a[172:173], v235 offset:32768
  ds_read_b64_tr_b16 a[174:175], v235 offset:33792
  buffer_load_dwordx4 v246, s[16:19], s34 offen offset:2048 lds
  v_mfma_f32_16x16x32_bf16 v[36:39], a[180:183], a[120:123], v[36:39]
  s_waitcnt lgkmcnt(8)
  v_mfma_f32_16x16x32_bf16 v[48:51], a[184:187], a[120:123], v[48:51]
  ds_read_b64_tr_b16 a[176:177], v236 offset:32768
  ds_read_b64_tr_b16 a[178:179], v236 offset:33792
  buffer_load_dwordx4 v247, s[16:19], s34 offen offset:3072 lds
  s_add_u32 s34, s34, 524288
  s_sub_u32 s38, s34, 5242880
  s_min_u32 s34, s34, s38
  v_mfma_f32_16x16x32_bf16 v[56:59], a[184:187], a[124:127], v[56:59]
  v_mfma_f32_16x16x32_bf16 v[60:63], a[188:191], a[124:127], v[60:63]
  ds_read_b64_tr_b16 a[180:181], v237 offset:32768
  ds_read_b64_tr_b16 a[182:183], v237 offset:33792
  s_add_u32 m0, s41, 49152
  s_nop 0
  buffer_load_dwordx4 v240, s[8:11], s32 offen offset:0 nt lds
  v_mfma_f32_16x16x32_bf16 v[52:55], a[188:191], a[120:123], v[52:55]
  s_waitcnt lgkmcnt(8)
  v_mfma_f32_16x16x32_bf16 v[0:3], a[160:163], a[128:131], v[0:3]
  ds_read_b64_tr_b16 a[184:185], v238 offset:32768
  ds_read_b64_tr_b16 a[186:187], v238 offset:33792
  buffer_load_dwordx4 v241, s[8:11], s32 offen offset:1024 nt lds
  v_mfma_f32_16x16x32_bf16 v[8:11], a[160:163], a[132:135], v[8:11]
  v_mfma_f32_16x16x32_bf16 v[12:15], a[164:167], a[132:135], v[12:15]
  ds_read_b64_tr_b16 a[188:189], v239 offset:32768
  ds_read_b64_tr_b16 a[190:191], v239 offset:33792
  buffer_load_dwordx4 v242, s[8:11], s32 offen offset:2048 nt lds
  v_mfma_f32_16x16x32_bf16 v[4:7], a[164:167], a[128:131], v[4:7]
  s_waitcnt lgkmcnt(8)
  v_mfma_f32_16x16x32_bf16 v[16:19], a[168:171], a[128:131], v[16:19]
  ds_read_b64_tr_b16 a[160:161], v232 offset:40960
  ds_read_b64_tr_b16 a[162:163], v232 offset:41984
  buffer_load_dwordx4 v243, s[8:11], s32 offen offset:3072 nt lds
  s_add_u32 s32, s32, 0x4000
  v_mfma_f32_16x16x32_bf16 v[24:27], a[168:171], a[132:135], v[24:27]
  v_mfma_f32_16x16x32_bf16 v[28:31], a[172:175], a[132:135], v[28:31]
  ds_read_b64_tr_b16 a[164:165], v233 offset:40960
  ds_read_b64_tr_b16 a[166:167], v233 offset:41984
  v_mfma_f32_16x16x32_bf16 v[20:23], a[172:175], a[128:131], v[20:23]
  s_waitcnt lgkmcnt(8)
  v_mfma_f32_16x16x32_bf16 v[32:35], a[176:179], a[128:131], v[32:35]
  ds_read_b64_tr_b16 a[168:169], v234 offset:40960
  ds_read_b64_tr_b16 a[170:171], v234 offset:41984
  v_mfma_f32_16x16x32_bf16 v[40:43], a[176:179], a[132:135], v[40:43]
  v_mfma_f32_16x16x32_bf16 v[44:47], a[180:183], a[132:135], v[44:47]
  ds_read_b64_tr_b16 a[172:173], v235 offset:40960
  ds_read_b64_tr_b16 a[174:175], v235 offset:41984
  v_mfma_f32_16x16x32_bf16 v[36:39], a[180:183], a[128:131], v[36:39]
  s_waitcnt lgkmcnt(8)
  v_mfma_f32_16x16x32_bf16 v[48:51], a[184:187], a[128:131], v[48:51]
  ds_read_b64_tr_b16 a[176:177], v236 offset:40960
  ds_read_b64_tr_b16 a[178:179], v236 offset:41984
  v_mfma_f32_16x16x32_bf16 v[56:59], a[184:187], a[132:135], v[56:59]
  v_mfma_f32_16x16x32_bf16 v[60:63], a[188:191], a[132:135], v[60:63]
  ds_read_b64_tr_b16 a[180:181], v237 offset:40960
  ds_read_b64_tr_b16 a[182:183], v237 offset:41984
  v_mfma_f32_16x16x32_bf16 v[52:55], a[188:191], a[128:131], v[52:55]
  s_waitcnt lgkmcnt(8)
  v_mfma_f32_16x16x32_bf16 v[0:3], a[160:163], a[136:139], v[0:3]
  ds_read_b64_tr_b16 a[184:185], v238 offset:40960
  ds_read_b64_tr_b16 a[186:187], v238 offset:41984
  v_mfma_f32_16x16x32_bf16 v[8:11], a[160:163], a[140:143], v[8:11]
  v_mfma_f32_16x16x32_bf16 v[12:15], a[164:167], a[140:143], v[12:15]
  ds_read_b64_tr_b16 a[188:189], v239 offset:40960
  ds_read_b64_tr_b16 a[190:191], v239 offset:41984
  v_mfma_f32_16x16x32_bf16 v[4:7], a[164:167], a[136:139], v[4:7]
  s_waitcnt lgkmcnt(8)
  v_mfma_f32_16x16x32_bf16 v[16:19], a[168:171], a[136:139], v[16:19]
  s_waitcnt vmcnt(28)
  s_barrier
  ds_read_b64_tr_b16 a[160:161], v232 offset:49152
  ds_read_b64_tr_b16 a[162:163], v232 offset:50176
  v_mfma_f32_16x16x32_bf16 v[24:27], a[168:171], a[140:143], v[24:27]
  v_mfma_f32_16x16x32_bf16 v[28:31], a[172:175], a[140:143], v[28:31]
  ds_read_b64_tr_b16 a[164:165], v233 offset:49152
  ds_read_b64_tr_b16 a[166:167], v233 offset:50176
  s_add_u32 m0, s41, 81920
  s_nop 0
  buffer_load_dwordx4 v244, s[16:19], s34 offen offset:0 lds
  v_mfma_f32_16x16x32_bf16 v[20:23], a[172:175], a[136:139], v[20:23]
  s_waitcnt lgkmcnt(8)
  v_mfma_f32_16x16x32_bf16 v[32:35], a[176:179], a[136:139], v[32:35]
  ds_read_b64_tr_b16 a[168:169], v232 offset:57344
  ds_read_b64_tr_b16 a[170:171], v232 offset:58368
  v_mfma_f32_16x16x32_bf16 v[40:43], a[176:179], a[140:143], v[40:43]
  v_mfma_f32_16x16x32_bf16 v[44:47], a[180:183], a[140:143], v[44:47]
  ds_read_b64_tr_b16 a[172:173], v233 offset:57344
  ds_read_b64_tr_b16 a[174:175], v233 offset:58368
  v_mfma_f32_16x16x32_bf16 v[36:39], a[180:183], a[136:139], v[36:39]
  s_waitcnt lgkmcnt(8)
  v_mfma_f32_16x16x32_bf16 v[48:51], a[184:187], a[136:139], v[48:51]
  ds_read_b64_tr_b16 a[176:177], v234 offset:49152
  ds_read_b64_tr_b16 a[178:179], v234 offset:50176
  buffer_load_dwordx4 v245, s[16:19], s34 offen offset:1024 lds
  v_mfma_f32_16x16x32_bf16 v[56:59], a[184:187], a[140:143], v[56:59]
  v_mfma_f32_16x16x32_bf16 v[60:63], a[188:191], a[140:143], v[60:63]
  ds_read_b64_tr_b16 a[180:181], v235 offset:49152
  ds_read_b64_tr_b16 a[182:183], v235 offset:50176
  v_mfma_f32_16x16x32_bf16 v[52:55], a[188:191], a[136:139], v[52:55]
  s_waitcnt lgkmcnt(8)
  v_mfma_f32_16x16x32_bf16 v[0:3], a[160:163], a[144:147], v[0:3]
  ds_read_b64_tr_b16 a[184:185], v234 offset:57344
  ds_read_b64_tr_b16 a[186:187], v234 offset:58368
  v_mfma_f32_16x16x32_bf16 v[8:11], a[160:163], a[148:151], v[8:11]
  v_mfma_f32_16x16x32_bf16 v[12:15], a[164:167], a[148:151], v[12:15]
  ds_read_b64_tr_b16 a[188:189], v235 offset:57344
  ds_read_b64_tr_b16 a[190:191], v235 offset:58368
  buffer_load_dwordx4 v246, s[16:19], s34 offen offset:2048 lds
  v_mfma_f32_16x16x32_bf16 v[4:7], a[164:167], a[144:147], v[4:7]
  s_waitcnt lgkmcnt(8)
  v_mfma_f32_16x16x32_bf16 v[0:3], a[168:171], a[152:155], v[0:3]
  ds_read_b64_tr_b16 a[160:161], v236 offset:49152
  ds_read_b64_tr_b16 a[162:163], v236 offset:50176
  v_mfma_f32_16x16x32_bf16 v[8:11], a[168:171], a[156:159], v[8:11]
  v_mfma_f32_16x16x32_bf16 v[12:15], a[172:175], a[156:159], v[12:15]
  ds_read_b64_tr_b16 a[164:165], v237 offset:49152
  ds_read_b64_tr_b16 a[166:167], v237 offset:50176
  v_mfma_f32_16x16x32_bf16 v[4:7], a[172:175], a[152:155], v[4:7]
  s_waitcnt lgkmcnt(8)
  v_mfma_f32_16x16x32_bf16 v[16:19], a[176:179], a[144:147], v[16:19]
  ds_read_b64_tr_b16 a[168:169], v236 offset:57344
  ds_read_b64_tr_b16 a[170:171], v236 offset:58368
  buffer_load_dwordx4 v247, s[16:19], s34 offen offset:3072 lds
  s_add_u32 s34, s34, 524288
  s_sub_u32 s38, s34, 5242880
  s_min_u32 s34, s34, s38
  v_mfma_f32_16x16x32_bf16 v[24:27], a[176:179], a[148:151], v[24:27]
  v_mfma_f32_16x16x32_bf16 v[28:31], a[180:183], a[148:151], v[28:31]
  ds_read_b64_tr_b16 a[172:173], v237 offset:57344
  ds_read_b64_tr_b16 a[174:175], v237 offset:58368
  v_mfma_f32_16x16x32_bf16 v[20:23], a[180:183], a[144:147], v[20:23]
  s_waitcnt lgkmcnt(8)
  v_mfma_f32_16x16x32_bf16 v[16:19], a[184:187], a[152:155], v[16:19]
  ds_read_b64_tr_b16 a[176:177], v238 offset:49152
  ds_read_b64_tr_b16 a[178:179], v238 offset:50176
  v_mul_f32 v0, s42, v0
  v_mul_f32 v1, s42, v1
  v_mul_f32 v2, s42, v2
  v_mul_f32 v3, s42, v3
  v_mul_f32 v4, s42, v4
  v_mul_f32 v5, s42, v5
  v_mul_f32 v6, s42, v6
  v_mul_f32 v7, s42, v7
  v_mfma_f32_16x16x32_bf16 v[24:27], a[184:187], a[156:159], v[24:27]
  v_mul_f32 v8, s42, v8
  v_mfma_f32_16x16x32_bf16 v[28:31], a[188:191], a[156:159], v[28:31]
  ds_read_b64_tr_b16 a[180:181], v239 offset:49152
  ds_read_b64_tr_b16 a[182:183], v239 offset:50176
  v_mul_f32 v9, s42, v9
  v_mul_f32 v10, s42, v10
  v_mul_f32 v11, s42, v11
  v_mul_f32 v12, s42, v12
  v_mul_f32 v13, s42, v13
  v_mul_f32 v14, s42, v14
  v_mul_f32 v15, s42, v15
  v_mfma_f32_16x16x32_bf16 v[20:23], a[188:191], a[152:155], v[20:23]
  s_waitcnt lgkmcnt(8)
  v_mfma_f32_16x16x32_bf16 v[32:35], a[160:163], a[144:147], v[32:35]
  ds_read_b64_tr_b16 a[184:185], v238 offset:57344
  ds_read_b64_tr_b16 a[186:187], v238 offset:58368
  v_cvt_pk_bf16_f32 v160, v0, v1
  v_cvt_pk_bf16_f32 v161, v2, v3
  v_cvt_pk_bf16_f32 v162, v4, v5
  v_cvt_pk_bf16_f32 v163, v6, v7
  v_cvt_pk_bf16_f32 v164, v8, v9
  v_cvt_pk_bf16_f32 v165, v10, v11
  v_cvt_pk_bf16_f32 v166, v12, v13
  v_mfma_f32_16x16x32_bf16 v[40:43], a[160:163], a[148:151], v[40:43]
  v_mfma_f32_16x16x32_bf16 v[44:47], a[164:167], a[148:151], v[44:47]
  ds_read_b64_tr_b16 a[188:189], v239 offset:57344
  ds_read_b64_tr_b16 a[190:191], v239 offset:58368
  v_cvt_pk_bf16_f32 v167, v14, v15
  v_permlane16_swap_b32 v160, v162
  v_permlane16_swap_b32 v161, v163
  v_permlane16_swap_b32 v164, v166
  v_permlane16_swap_b32 v165, v167
  v_mfma_f32_16x16x32_bf16 v[36:39], a[164:167], a[144:147], v[36:39]
  s_waitcnt lgkmcnt(8)
  v_mfma_f32_16x16x32_bf16 v[32:35], a[168:171], a[152:155], v[32:35]
  s_waitcnt vmcnt(28)
  s_barrier
  ds_read_b128 a[160:163], v224 offset:0
  v_mul_f32 v16, s42, v16
  v_mul_f32 v17, s42, v17
  v_mul_f32 v18, s42, v18
  v_mul_f32 v19, s42, v19
  v_mul_f32 v20, s42, v20
  v_mul_f32 v21, s42, v21
  v_mul_f32 v22, s42, v22
  v_mfma_f32_16x16x32_bf16 v[40:43], a[168:171], a[156:159], v[40:43]
  v_mul_f32 v23, s42, v23
  v_mfma_f32_16x16x32_bf16 v[44:47], a[172:175], a[156:159], v[44:47]
  ds_read_b128 a[164:167], v224 offset:4096
  s_add_u32 m0, s41, 98304
  s_nop 0
  buffer_load_dwordx4 v248, s[12:15], s33 offen offset:0 nt lds
  v_mul_f32 v24, s42, v24
  v_mul_f32 v25, s42, v25
  v_mul_f32 v26, s42, v26
  v_mfma_f32_16x16x32_bf16 v[36:39], a[172:175], a[152:155], v[36:39]
  v_mul_f32 v27, s42, v27
  v_mul_f32 v28, s42, v28
  s_waitcnt lgkmcnt(6)
  v_mfma_f32_16x16x32_bf16 v[48:51], a[176:179], a[144:147], v[48:51]
  ds_read_b128 a[168:171], v225 offset:0
  v_mul_f32 v29, s42, v29
  v_mul_f32 v30, s42, v30
  v_mul_f32 v31, s42, v31
  v_cvt_pk_bf16_f32 v168, v16, v17
  v_cvt_pk_bf16_f32 v169, v18, v19
  v_cvt_pk_bf16_f32 v170, v20, v21
  v_cvt_pk_bf16_f32 v171, v22, v23
  v_cvt_pk_bf16_f32 v172, v24, v25
  v_mfma_f32_16x16x32_bf16 v[56:59], a[176:179], a[148:151], v[56:59]
  v_mfma_f32_16x16x32_bf16 v[60:63], a[180:183], a[148:151], v[60:63]
  ds_read_b128 a[172:175], v225 offset:4096
  v_cvt_pk_bf16_f32 v173, v26, v27
  v_cvt_pk_bf16_f32 v174, v28, v29
  v_cvt_pk_bf16_f32 v175, v30, v31
  v_permlane16_swap_b32 v168, v170
  v_permlane16_swap_b32 v169, v171
  v_permlane16_swap_b32 v172, v174
  v_permlane16_swap_b32 v173, v175
  v_mfma_f32_16x16x32_bf16 v[52:55], a[180:183], a[144:147], v[52:55]
  s_waitcnt lgkmcnt(4)
  v_mfma_f32_16x16x32_bf16 v[48:51], a[184:187], a[152:155], v[48:51]
  ds_read_b128 a[176:179], v226 offset:0
  buffer_load_dwordx4 v248, s[12:15], s33 offen offset:1024 nt lds
  v_mul_f32 v32, s42, v32
  v_mul_f32 v33, s42, v33
  v_mul_f32 v34, s42, v34
  v_mul_f32 v35, s42, v35
  v_mul_f32 v36, s42, v36
  v_mfma_f32_16x16x32_bf16 v[56:59], a[184:187], a[156:159], v[56:59]
  v_mul_f32 v37, s42, v37
  v_mfma_f32_16x16x32_bf16 v[60:63], a[188:191], a[156:159], v[60:63]
  ds_read_b128 a[180:183], v226 offset:4096
  v_mul_f32 v38, s42, v38
  v_mul_f32 v39, s42, v39
  v_mul_f32 v40, s42, v40
  v_mul_f32 v41, s42, v41
  v_mul_f32 v42, s42, v42
  v_mul_f32 v43, s42, v43
  v_mul_f32 v44, s42, v44
  v_mul_f32 v45, s42, v45
  v_mfma_f32_16x16x32_bf16 v[52:55], a[188:191], a[152:155], v[52:55]
  s_waitcnt lgkmcnt(4)
  v_mfma_f32_16x16x32_bf16 v[64:67], a[160:163], v[160:163], 0
  ds_read_b128 a[184:187], v227 offset:0
  v_mul_f32 v46, s42, v46
  v_mul_f32 v47, s42, v47
  v_cvt_pk_bf16_f32 v176, v32, v33
  v_cvt_pk_bf16_f32 v177, v34, v35
  v_cvt_pk_bf16_f32 v178, v36, v37
  v_cvt_pk_bf16_f32 v179, v38, v39
  v_cvt_pk_bf16_f32 v180, v40, v41
  v_cvt_pk_bf16_f32 v181, v42, v43
  v_mfma_f32_16x16x32_bf16 v[72:75], a[160:163], v[164:167], 0
  v_mfma_f32_16x16x32_bf16 v[76:79], a[164:167], v[164:167], 0
  ds_read_b128 a[188:191], v227 offset:4096
  buffer_load_dwordx4 v248, s[12:15], s33 offen offset:2048 nt lds
  v_cvt_pk_bf16_f32 v182, v44, v45
  v_cvt_pk_bf16_f32 v183, v46, v47
  v_permlane16_swap_b32 v176, v178
  v_permlane16_swap_b32 v177, v179
  v_permlane16_swap_b32 v180, v182
  v_mfma_f32_16x16x32_bf16 v[68:71], a[164:167], v[160:163], 0
  s_waitcnt lgkmcnt(4)
  v_mfma_f32_16x16x32_bf16 v[64:67], a[168:171], v[168:171], v[64:67]
  ds_read_b128 a[160:163], v224 offset:2048
  v_permlane16_swap_b32 v181, v183
  v_mul_f32 v48, s42, v48
  v_mul_f32 v49, s42, v49
  v_mul_f32 v50, s42, v50
  v_mul_f32 v51, s42, v51
  v_mul_f32 v52, s42, v52
  v_mul_f32 v53, s42, v53
  v_mul_f32 v54, s42, v54
  v_mfma_f32_16x16x32_bf16 v[72:75], a[168:171], v[172:175], v[72:75]
  v_mfma_f32_16x16x32_bf16 v[76:79], a[172:175], v[172:175], v[76:79]
  ds_read_b128 a[164:167], v224 offset:6144
  v_mul_f32 v55, s42, v55
  v_mul_f32 v56, s42, v56
  v_mul_f32 v57, s42, v57
  v_mul_f32 v58, s42, v58
  v_mul_f32 v59, s42, v59
  v_mul_f32 v60, s42, v60
  v_mul_f32 v61, s42, v61
  v_mul_f32 v62, s42, v62
  v_mfma_f32_16x16x32_bf16 v[68:71], a[172:175], v[168:171], v[68:71]
  s_waitcnt lgkmcnt(4)
  v_mfma_f32_16x16x32_bf16 v[64:67], a[176:179], v[176:179], v[64:67]
  ds_read_b128 a[168:171], v225 offset:2048
  buffer_load_dwordx4 v248, s[12:15], s33 offen offset:3072 nt lds
  s_add_u32 s33, s33, 0x4000
  v_mul_f32 v63, s42, v63
  v_cvt_pk_bf16_f32 v184, v48, v49
  v_cvt_pk_bf16_f32 v185, v50, v51
  v_cvt_pk_bf16_f32 v186, v52, v53
  v_mfma_f32_16x16x32_bf16 v[72:75], a[176:179], v[180:183], v[72:75]
  v_cvt_pk_bf16_f32 v187, v54, v55
  v_mfma_f32_16x16x32_bf16 v[76:79], a[180:183], v[180:183], v[76:79]
  ds_read_b128 a[172:175], v225 offset:6144
  v_cvt_pk_bf16_f32 v188, v56, v57
  v_cvt_pk_bf16_f32 v189, v58, v59
  v_cvt_pk_bf16_f32 v190, v60, v61
  v_cvt_pk_bf16_f32 v191, v62, v63
  v_permlane16_swap_b32 v184, v186
  v_permlane16_swap_b32 v185, v187
  v_permlane16_swap_b32 v188, v190
  v_permlane16_swap_b32 v189, v191
  v_mfma_f32_16x16x32_bf16 v[68:71], a[180:183], v[176:179], v[68:71]
  s_waitcnt lgkmcnt(4)
  v_mfma_f32_16x16x32_bf16 v[64:67], a[184:187], v[184:187], v[64:67]
  ds_read_b128 a[176:179], v226 offset:2048
  v_mfma_f32_16x16x32_bf16 v[72:75], a[184:187], v[188:191], v[72:75]
  v_mfma_f32_16x16x32_bf16 v[76:79], a[188:191], v[188:191], v[76:79]
  ds_read_b128 a[180:183], v226 offset:6144
  v_mfma_f32_16x16x32_bf16 v[68:71], a[188:191], v[184:187], v[68:71]
  s_waitcnt lgkmcnt(4)
  v_mfma_f32_16x16x32_bf16 v[80:83], a[160:163], v[160:163], 0
  ds_read_b128 a[184:187], v227 offset:2048
  v_mfma_f32_16x16x32_bf16 v[88:91], a[160:163], v[164:167], 0
  v_mfma_f32_16x16x32_bf16 v[92:95], a[164:167], v[164:167], 0
  ds_read_b128 a[188:191], v227 offset:6144
  v_mfma_f32_16x16x32_bf16 v[84:87], a[164:167], v[160:163], 0
  s_waitcnt lgkmcnt(4)
  v_mfma_f32_16x16x32_bf16 v[80:83], a[168:171], v[168:171], v[80:83]
  s_waitcnt vmcnt(28)
  s_barrier
  ds_read_b64_tr_b16 a[160:161], v232 offset:0
  ds_read_b64_tr_b16 a[162:163], v232 offset:1024
  v_mfma_f32_16x16x32_bf16 v[88:91], a[168:171], v[172:175], v[88:91]
  v_mfma_f32_16x16x32_bf16 v[92:95], a[172:175], v[172:175], v[92:95]
  ds_read_b64_tr_b16 a[164:165], v233 offset:0
  ds_read_b64_tr_b16 a[166:167], v233 offset:1024
  s_add_u32 m0, s41, 114688
  s_nop 0
  buffer_load_dwordx4 v244, s[16:19], s34 offen offset:0 lds
  v_mfma_f32_16x16x32_bf16 v[84:87], a[172:175], v[168:171], v[84:87]
  s_waitcnt lgkmcnt(6)
  v_mfma_f32_16x16x32_bf16 v[80:83], a[176:179], v[176:179], v[80:83]
  ds_read_b64_tr_b16 a[168:169], v234 offset:0
  ds_read_b64_tr_b16 a[170:171], v234 offset:1024
  v_mfma_f32_16x16x32_bf16 v[88:91], a[176:179], v[180:183], v[88:91]
  v_mfma_f32_16x16x32_bf16 v[92:95], a[180:183], v[180:183], v[92:95]
  ds_read_b64_tr_b16 a[172:173], v235 offset:0
  ds_read_b64_tr_b16 a[174:175], v235 offset:1024
  v_mfma_f32_16x16x32_bf16 v[84:87], a[180:183], v[176:179], v[84:87]
  s_waitcnt lgkmcnt(8)
  v_mfma_f32_16x16x32_bf16 v[80:83], a[184:187], v[184:187], v[80:83]
  ds_read_b64_tr_b16 a[176:177], v236 offset:0
  ds_read_b64_tr_b16 a[178:179], v236 offset:1024
  buffer_load_dwordx4 v245, s[16:19], s34 offen offset:1024 lds
  v_mfma_f32_16x16x32_bf16 v[88:91], a[184:187], v[188:191], v[88:91]
  v_mfma_f32_16x16x32_bf16 v[92:95], a[188:191], v[188:191], v[92:95]
  ds_read_b64_tr_b16 a[180:181], v237 offset:0
  ds_read_b64_tr_b16 a[182:183], v237 offset:1024
  v_mfma_f32_16x16x32_bf16 v[84:87], a[188:191], v[184:187], v[84:87]
  s_waitcnt lgkmcnt(8)
  v_mfma_f32_16x16x32_bf16 v[0:3], a[160:163], a[0:3], 0
  ds_read_b64_tr_b16 a[184:185], v238 offset:0
  ds_read_b64_tr_b16 a[186:187], v238 offset:1024
  v_mfma_f32_16x16x32_bf16 v[8:11], a[160:163], a[4:7], 0
  v_mfma_f32_16x16x32_bf16 v[12:15], a[164:167], a[4:7], 0
  ds_read_b64_tr_b16 a[188:189], v239 offset:0
  ds_read_b64_tr_b16 a[190:191], v239 offset:1024
  buffer_load_dwordx4 v246, s[16:19], s34 offen offset:2048 lds
  v_mfma_f32_16x16x32_bf16 v[4:7], a[164:167], a[0:3], 0
  s_waitcnt lgkmcnt(8)
  v_mfma_f32_16x16x32_bf16 v[16:19], a[168:171], a[0:3], 0
  ds_read_b64_tr_b16 a[160:161], v232 offset:8192
  ds_read_b64_tr_b16 a[162:163], v232 offset:9216
  v_max3_f32 v214, v64, v65, v66
  v_max3_f32 v215, v72, v73, v74
  v_max3_f32 v214, v214, v67, v68
  v_max3_f32 v215, v215, v75, v76
  v_max3_f32 v214, v214, v69, v70
  v_mfma_f32_16x16x32_bf16 v[24:27], a[168:171], a[4:7], 0
  v_mfma_f32_16x16x32_bf16 v[28:31], a[172:175], a[4:7], 0
  ds_read_b64_tr_b16 a[164:165], v233 offset:8192
  ds_read_b64_tr_b16 a[166:167], v233 offset:9216
  v_max3_f32 v215, v215, v77, v78
  v_max3_f32 v214, v214, v71, v80
  v_mfma_f32_16x16x32_bf16 v[20:23], a[172:175], a[0:3], 0
  s_waitcnt lgkmcnt(8)
  v_mfma_f32_16x16x32_bf16 v[32:35], a[176:179], a[0:3], 0
  ds_read_b64_tr_b16 a[168:169], v234 offset:8192
  ds_read_b64_tr_b16 a[170:171], v234 offset:9216
  buffer_load_dwordx4 v247, s[16:19], s34 offen offset:3072 lds
  s_add_u32 s34, s34, 524288
  s_sub_u32 s38, s34, 5242880
  s_min_u32 s34, s34, s38
  v_max3_f32 v215, v215, v79, v88
  v_mfma_f32_16x16x32_bf16 v[40:43], a[176:179], a[4:7], 0
  v_mfma_f32_16x16x32_bf16 v[44:47], a[180:183], a[4:7], 0
  ds_read_b64_tr_b16 a[172:173], v235 offset:8192
  ds_read_b64_tr_b16 a[174:175], v235 offset:9216
  v_max3_f32 v214, v214, v81, v82
  v_max3_f32 v215, v215, v89, v90
  v_mfma_f32_16x16x32_bf16 v[36:39], a[180:183], a[0:3], 0
  s_waitcnt lgkmcnt(8)
  v_mfma_f32_16x16x32_bf16 v[48:51], a[184:187], a[0:3], 0
  ds_read_b64_tr_b16 a[176:177], v236 offset:8192
  ds_read_b64_tr_b16 a[178:179], v236 offset:9216
  v_max3_f32 v214, v214, v83, v84
  v_max3_f32 v215, v215, v91, v92
  v_max3_f32 v214, v214, v85, v86
  v_mfma_f32_16x16x32_bf16 v[56:59], a[184:187], a[4:7], 0
  v_mfma_f32_16x16x32_bf16 v[60:63], a[188:191], a[4:7], 0
  ds_read_b64_tr_b16 a[180:181], v237 offset:8192
  ds_read_b64_tr_b16 a[182:183], v237 offset:9216
  v_max3_f32 v215, v215, v93, v94
  v_max_f32 v214, v214, v87
  v_max_f32 v215, v215, v95
  v_mfma_f32_16x16x32_bf16 v[52:55], a[188:191], a[0:3], 0
  s_waitcnt lgkmcnt(8)
  v_mfma_f32_16x16x32_bf16 v[0:3], a[160:163], a[8:11], v[0:3]
  ds_read_b64_tr_b16 a[184:185], v238 offset:8192
  ds_read_b64_tr_b16 a[186:187], v238 offset:9216
  v_permlane16_swap_b32 v214, v215
  v_max_f32 v214, v214, v215
  v_mov_b32 v215, v214
  v_mfma_f32_16x16x32_bf16 v[8:11], a[160:163], a[12:15], v[8:11]
  v_mfma_f32_16x16x32_bf16 v[12:15], a[164:167], a[12:15], v[12:15]
  ds_read_b64_tr_b16 a[188:189], v239 offset:8192
  ds_read_b64_tr_b16 a[190:191], v239 offset:9216
  v_permlane32_swap_b32 v214, v215
  v_min_f32 v192, -v214, -v215
  v_mov_b32 v196, v192
  v_mfma_f32_16x16x32_bf16 v[4:7], a[164:167], a[8:11], v[4:7]
  s_waitcnt lgkmcnt(8)
  v_mfma_f32_16x16x32_bf16 v[16:19], a[168:171], a[8:11], v[16:19]
  s_waitcnt vmcnt(24)
  s_barrier
  ds_read_b64_tr_b16 a[160:161], v200 offset:0
  ds_read_b64_tr_b16 a[162:163], v200 offset:1024
  v_mfma_f32_16x16x32_bf16 v[24:27], a[168:171], a[12:15], v[24:27]
  v_mfma_f32_16x16x32_bf16 v[28:31], a[172:175], a[12:15], v[28:31]
  ds_read_b64_tr_b16 a[164:165], v201 offset:0
  ds_read_b64_tr_b16 a[166:167], v201 offset:1024
  s_add_u32 m0, s41, 0
  s_nop 0
  buffer_load_dwordx4 v240, s[8:11], s32 offen offset:0 nt lds
  v_permlane16_swap_b32 v192, v196
  v_mfma_f32_16x16x32_bf16 v[20:23], a[172:175], a[8:11], v[20:23]
  s_waitcnt lgkmcnt(8)
  v_mfma_f32_16x16x32_bf16 v[32:35], a[176:179], a[8:11], v[32:35]
  ds_read_b64_tr_b16 a[168:169], v202 offset:0
  ds_read_b64_tr_b16 a[170:171], v202 offset:1024
  v_mov_b32 v193, v192
  v_mov_b32 v194, v192
  v_mfma_f32_16x16x32_bf16 v[40:43], a[176:179], a[12:15], v[40:43]
  v_mfma_f32_16x16x32_bf16 v[44:47], a[180:183], a[12:15], v[44:47]
  ds_read_b64_tr_b16 a[172:173], v203 offset:0
  ds_read_b64_tr_b16 a[174:175], v203 offset:1024
  v_mov_b32 v195, v192
  v_mov_b32 v197, v196
  v_mov_b32 v198, v196
  v_mfma_f32_16x16x32_bf16 v[36:39], a[180:183], a[8:11], v[36:39]
  s_waitcnt lgkmcnt(8)
  v_mfma_f32_16x16x32_bf16 v[48:51], a[184:187], a[8:11], v[48:51]
  ds_read_b64_tr_b16 a[176:177], v204 offset:0
  ds_read_b64_tr_b16 a[178:179], v204 offset:1024
  buffer_load_dwordx4 v241, s[8:11], s32 offen offset:1024 nt lds
  v_mfma_f32_16x16x32_bf16 v[56:59], a[184:187], a[12:15], v[56:59]
  v_mfma_f32_16x16x32_bf16 v[60:63], a[188:191], a[12:15], v[60:63]
  ds_read_b64_tr_b16 a[180:181], v205 offset:0
  ds_read_b64_tr_b16 a[182:183], v205 offset:1024
  v_mov_b32 v199, v196
  v_add_f32 v208, v64, v192
  v_add_f32 v209, v65, v192
  v_mfma_f32_16x16x32_bf16 v[52:55], a[188:191], a[8:11], v[52:55]
  s_waitcnt lgkmcnt(8)
  v_mfma_f32_16x16x32_bf16 v[0:3], a[160:163], a[16:19], v[0:3]
  ds_read_b64_tr_b16 a[184:185], v206 offset:0
  ds_read_b64_tr_b16 a[186:187], v206 offset:1024
  v_exp_f32 v208, v208
  v_exp_f32 v209, v209
  v_mfma_f32_16x16x32_bf16 v[8:11], a[160:163], a[20:23], v[8:11]
  v_mfma_f32_16x16x32_bf16 v[12:15], a[164:167], a[20:23], v[12:15]
  ds_read_b64_tr_b16 a[188:189], v207 offset:0
  ds_read_b64_tr_b16 a[190:191], v207 offset:1024
  buffer_load_dwordx4 v242, s[8:11], s32 offen offset:2048 nt lds
  v_mfma_f32_16x16x32_bf16 v[4:7], a[164:167], a[16:19], v[4:7]
  s_waitcnt lgkmcnt(8)
  v_mfma_f32_16x16x32_bf16 v[16:19], a[168:171], a[16:19], v[16:19]
  ds_read_b64_tr_b16 a[160:161], v200 offset:8192
  ds_read_b64_tr_b16 a[162:163], v200 offset:9216
  v_add_f32 v210, v66, v192
  v_add_f32 v211, v67, v192
  v_mfma_f32_16x16x32_bf16 v[24:27], a[168:171], a[20:23], v[24:27]
  v_mfma_f32_16x16x32_bf16 v[28:31], a[172:175], a[20:23], v[28:31]
  ds_read_b64_tr_b16 a[164:165], v201 offset:8192
  ds_read_b64_tr_b16 a[166:167], v201 offset:9216
  v_exp_f32 v210, v210
  v_mfma_f32_16x16x32_bf16 v[20:23], a[172:175], a[16:19], v[20:23]
  s_waitcnt lgkmcnt(8)
  v_mfma_f32_16x16x32_bf16 v[32:35], a[176:179], a[16:19], v[32:35]
  ds_read_b64_tr_b16 a[168:169], v202 offset:8192
  ds_read_b64_tr_b16 a[170:171], v202 offset:9216
  buffer_load_dwordx4 v243, s[8:11], s32 offen offset:3072 nt lds
  s_add_u32 s32, s32, 0x4000
  v_exp_f32 v211, v211
  v_mfma_f32_16x16x32_bf16 v[40:43], a[176:179], a[20:23], v[40:43]
  v_mfma_f32_16x16x32_bf16 v[44:47], a[180:183], a[20:23], v[44:47]
  ds_read_b64_tr_b16 a[172:173], v203 offset:8192
  ds_read_b64_tr_b16 a[174:175], v203 offset:9216
  v_add_f32 v214, v208, v209
  v_cvt_pk_bf16_f32 v128, v208, v209
  v_mfma_f32_16x16x32_bf16 v[36:39], a[180:183], a[16:19], v[36:39]
  s_waitcnt lgkmcnt(8)
  v_mfma_f32_16x16x32_bf16 v[48:51], a[184:187], a[16:19], v[48:51]
  ds_read_b64_tr_b16 a[176:177], v204 offset:8192
  ds_read_b64_tr_b16 a[178:179], v204 offset:9216
  v_add_f32 v212, v68, v192
  v_add_f32 v213, v69, v192
  v_mfma_f32_16x16x32_bf16 v[56:59], a[184:187], a[20:23], v[56:59]
  v_mfma_f32_16x16x32_bf16 v[60:63], a[188:191], a[20:23], v[60:63]
  ds_read_b64_tr_b16 a[180:181], v205 offset:8192
  ds_read_b64_tr_b16 a[182:183], v205 offset:9216
  v_exp_f32 v212, v212
  v_exp_f32 v213, v213
  v_mfma_f32_16x16x32_bf16 v[52:55], a[188:191], a[16:19], v[52:55]
  s_waitcnt lgkmcnt(8)
  v_mfma_f32_16x16x32_bf16 v[0:3], a[160:163], a[24:27], v[0:3]
  ds_read_b64_tr_b16 a[184:185], v206 offset:8192
  ds_read_b64_tr_b16 a[186:187], v206 offset:9216
  v_add_f32 v214, v214, v210
  v_add_f32 v214, v214, v211
  v_mfma_f32_16x16x32_bf16 v[8:11], a[160:163], a[28:31], v[8:11]
  v_mfma_f32_16x16x32_bf16 v[12:15], a[164:167], a[28:31], v[12:15]
  ds_read_b64_tr_b16 a[188:189], v207 offset:8192
  ds_read_b64_tr_b16 a[190:191], v207 offset:9216
  v_cvt_pk_bf16_f32 v129, v210, v211
  v_add_f32 v208, v70, v192
  v_add_f32 v209, v71, v192
  v_mfma_f32_16x16x32_bf16 v[4:7], a[164:167], a[24:27], v[4:7]
  s_waitcnt lgkmcnt(8)
  v_mfma_f32_16x16x32_bf16 v[16:19], a[168:171], a[24:27], v[16:19]
  s_barrier
  ds_read_b128 a[160:163], v224 offset:16384
  v_exp_f32 v208, v208
  v_mfma_f32_16x16x32_bf16 v[24:27], a[168:171], a[28:31], v[24:27]
  v_mfma_f32_16x16x32_bf16 v[28:31], a[172:175], a[28:31], v[28:31]
  ds_read_b128 a[164:167], v224 offset:20480
  s_add_u32 m0, s41, 65536
  s_nop 0
  buffer_load_dwordx4 v248, s[12:15], s33 offen offset:0 nt lds
  v_exp_f32 v209, v209
  v_mfma_f32_16x16x32_bf16 v[20:23], a[172:175], a[24:27], v[20:23]
  s_waitcnt lgkmcnt(6)
  v_mfma_f32_16x16x32_bf16 v[32:35], a[176:179], a[24:27], v[32:35]
  ds_read_b128 a[168:171], v225 offset:16384
  v_add_f32 v214, v214, v212
  v_add_f32 v214, v214, v213
  v_cvt_pk_bf16_f32 v130, v212, v213
  v_mfma_f32_16x16x32_bf16 v[40:43], a[176:179], a[28:31], v[40:43]
  v_mfma_f32_16x16x32_bf16 v[44:47], a[180:183], a[28:31], v[44:47]
  ds_read_b128 a[172:175], v225 offset:20480
  v_add_f32 v210, v72, v196
  v_add_f32 v211, v73, v196
  v_exp_f32 v210, v210
  v_mfma_f32_16x16x32_bf16 v[36:39], a[180:183], a[24:27], v[36:39]
  s_waitcnt lgkmcnt(4)
  v_mfma_f32_16x16x32_bf16 v[48:51], a[184:187], a[24:27], v[48:51]
  ds_read_b128 a[176:179], v226 offset:16384
  buffer_load_dwordx4 v248, s[12:15], s33 offen offset:1024 nt lds
  v_mfma_f32_16x16x32_bf16 v[56:59], a[184:187], a[28:31], v[56:59]
  v_mfma_f32_16x16x32_bf16 v[60:63], a[188:191], a[28:31], v[60:63]
  ds_read_b128 a[180:183], v226 offset:20480
  v_exp_f32 v211, v211
  v_add_f32 v214, v214, v208
  v_add_f32 v214, v214, v209
  v_mfma_f32_16x16x32_bf16 v[52:55], a[188:191], a[24:27], v[52:55]
  s_waitcnt lgkmcnt(4)
  v_mfma_f32_16x16x32_bf16 v[96:99], a[160:163], v[160:163], v[192:195]
  ds_read_b128 a[184:187], v227 offset:16384
  v_cvt_pk_bf16_f32 v131, v208, v209
  v_add_f32 v212, v74, v196
  v_add_f32 v213, v75, v196
  v_mfma_f32_16x16x32_bf16 v[104:107], a[160:163], v[164:167], v[196:199]
  v_mfma_f32_16x16x32_bf16 v[108:111], a[164:167], v[164:167], v[196:199]
  ds_read_b128 a[188:191], v227 offset:20480
  buffer_load_dwordx4 v248, s[12:15], s33 offen offset:2048 nt lds
  v_mfma_f32_16x16x32_bf16 v[100:103], a[164:167], v[160:163], v[192:195]
  s_waitcnt lgkmcnt(4)
  v_mfma_f32_16x16x32_bf16 v[96:99], a[168:171], v[168:171], v[96:99]
  ds_read_b128 a[160:163], v224 offset:18432
  v_exp_f32 v212, v212
  v_exp_f32 v213, v213
  v_add_f32 v215, v210, v211
  v_mfma_f32_16x16x32_bf16 v[104:107], a[168:171], v[172:175], v[104:107]
  v_mfma_f32_16x16x32_bf16 v[108:111], a[172:175], v[172:175], v[108:111]
  ds_read_b128 a[164:167], v224 offset:22528
  v_cvt_pk_bf16_f32 v132, v210, v211
  v_add_f32 v208, v76, v196
  v_add_f32 v209, v77, v196
  v_mfma_f32_16x16x32_bf16 v[100:103], a[172:175], v[168:171], v[100:103]
  s_waitcnt lgkmcnt(4)
  v_mfma_f32_16x16x32_bf16 v[96:99], a[176:179], v[176:179], v[96:99]
  ds_read_b128 a[168:171], v225 offset:18432
  buffer_load_dwordx4 v248, s[12:15], s33 offen offset:3072 nt lds
  s_add_u32 s33, s33, 0x4000
  v_mfma_f32_16x16x32_bf16 v[104:107], a[176:179], v[180:183], v[104:107]
  v_mfma_f32_16x16x32_bf16 v[108:111], a[180:183], v[180:183], v[108:111]
  ds_read_b128 a[172:175], v225 offset:22528
  v_exp_f32 v208, v208
  v_exp_f32 v209, v209
  v_mfma_f32_16x16x32_bf16 v[100:103], a[180:183], v[176:179], v[100:103]
  s_waitcnt lgkmcnt(4)
  v_mfma_f32_16x16x32_bf16 v[96:99], a[184:187], v[184:187], v[96:99]
  ds_read_b128 a[176:179], v226 offset:18432
  v_add_f32 v215, v215, v212
  v_add_f32 v215, v215, v213
  v_cvt_pk_bf16_f32 v133, v212, v213
  v_add_f32 v210, v78, v196
  v_mfma_f32_16x16x32_bf16 v[104:107], a[184:187], v[188:191], v[104:107]
  v_mfma_f32_16x16x32_bf16 v[108:111], a[188:191], v[188:191], v[108:111]
  ds_read_b128 a[180:183], v226 offset:22528
  v_add_f32 v211, v79, v196
  v_exp_f32 v210, v210
  v_exp_f32 v211, v211
  v_mfma_f32_16x16x32_bf16 v[100:103], a[188:191], v[184:187], v[100:103]
  s_waitcnt lgkmcnt(4)
  v_mfma_f32_16x16x32_bf16 v[112:115], a[160:163], v[160:163], v[192:195]
  ds_read_b128 a[184:187], v227 offset:18432
  v_add_f32 v215, v215, v208
  v_add_f32 v215, v215, v209
  v_cvt_pk_bf16_f32 v134, v208, v209
  v_mfma_f32_16x16x32_bf16 v[120:123], a[160:163], v[164:167], v[196:199]
  v_mfma_f32_16x16x32_bf16 v[124:127], a[164:167], v[164:167], v[196:199]
  ds_read_b128 a[188:191], v227 offset:22528
  v_add_f32 v212, v80, v192
  v_add_f32 v213, v81, v192
  v_exp_f32 v212, v212
  v_mfma_f32_16x16x32_bf16 v[116:119], a[164:167], v[160:163], v[192:195]
  s_waitcnt lgkmcnt(4)
  v_mfma_f32_16x16x32_bf16 v[112:115], a[168:171], v[168:171], v[112:115]
  s_waitcnt vmcnt(24)
  s_barrier
  ds_read_b64_tr_b16 a[160:161], v200 offset:16384
  ds_read_b64_tr_b16 a[162:163], v200 offset:17408
  v_mfma_f32_16x16x32_bf16 v[120:123], a[168:171], v[172:175], v[120:123]
  v_mfma_f32_16x16x32_bf16 v[124:127], a[172:175], v[172:175], v[124:127]
  ds_read_b64_tr_b16 a[164:165], v201 offset:16384
  ds_read_b64_tr_b16 a[166:167], v201 offset:17408
  s_add_u32 m0, s41, 131072
  s_nop 0
  buffer_load_dwordx4 v244, s[16:19], s34 offen offset:0 lds
  v_mfma_f32_16x16x32_bf16 v[116:119], a[172:175], v[168:171], v[116:119]
  s_waitcnt lgkmcnt(6)
  v_mfma_f32_16x16x32_bf16 v[112:115], a[176:179], v[176:179], v[112:115]
  ds_read_b64_tr_b16 a[168:169], v202 offset:16384
  ds_read_b64_tr_b16 a[170:171], v202 offset:17408
  v_exp_f32 v213, v213
  v_add_f32 v215, v215, v210
  v_mfma_f32_16x16x32_bf16 v[120:123], a[176:179], v[180:183], v[120:123]
  v_mfma_f32_16x16x32_bf16 v[124:127], a[180:183], v[180:183], v[124:127]
  ds_read_b64_tr_b16 a[172:173], v203 offset:16384
  ds_read_b64_tr_b16 a[174:175], v203 offset:17408
  v_add_f32 v215, v215, v211
  v_cvt_pk_bf16_f32 v135, v210, v211
  v_add_f32 v208, v82, v192
  v_mfma_f32_16x16x32_bf16 v[116:119], a[180:183], v[176:179], v[116:119]
  s_waitcnt lgkmcnt(8)
  v_mfma_f32_16x16x32_bf16 v[112:115], a[184:187], v[184:187], v[112:115]
  ds_read_b64_tr_b16 a[176:177], v204 offset:16384
  ds_read_b64_tr_b16 a[178:179], v204 offset:17408
  buffer_load_dwordx4 v245, s[16:19], s34 offen offset:1024 lds
  v_add_f32 v209, v83, v192
  v_mfma_f32_16x16x32_bf16 v[120:123], a[184:187], v[188:191], v[120:123]
  v_mfma_f32_16x16x32_bf16 v[124:127], a[188:191], v[188:191], v[124:127]
  ds_read_b64_tr_b16 a[180:181], v205 offset:16384
  ds_read_b64_tr_b16 a[182:183], v205 offset:17408
  v_exp_f32 v208, v208
  v_mfma_f32_16x16x32_bf16 v[116:119], a[188:191], v[184:187], v[116:119]
  s_waitcnt lgkmcnt(8)
  v_mfma_f32_16x16x32_bf16 v[0:3], a[160:163], a[32:35], v[0:3]
  ds_read_b64_tr_b16 a[184:185], v206 offset:16384
  ds_read_b64_tr_b16 a[186:187], v206 offset:17408
  v_exp_f32 v209, v209
  v_add_f32 v214, v214, v212
  v_mfma_f32_16x16x32_bf16 v[8:11], a[160:163], a[36:39], v[8:11]
  v_mfma_f32_16x16x32_bf16 v[12:15], a[164:167], a[36:39], v[12:15]
  ds_read_b64_tr_b16 a[188:189], v207 offset:16384
  ds_read_b64_tr_b16 a[190:191], v207 offset:17408
  buffer_load_dwordx4 v246, s[16:19], s34 offen offset:2048 lds
  v_mfma_f32_16x16x32_bf16 v[4:7], a[164:167], a[32:35], v[4:7]
  s_waitcnt lgkmcnt(8)
  v_mfma_f32_16x16x32_bf16 v[16:19], a[168:171], a[32:35], v[16:19]
  ds_read_b64_tr_b16 a[160:161], v200 offset:24576
  ds_read_b64_tr_b16 a[162:163], v200 offset:25600
  v_add_f32 v214, v214, v213
  v_cvt_pk_bf16_f32 v136, v212, v213
  v_add_f32 v210, v84, v192
  v_mfma_f32_16x16x32_bf16 v[24:27], a[168:171], a[36:39], v[24:27]
  v_mfma_f32_16x16x32_bf16 v[28:31], a[172:175], a[36:39], v[28:31]
  ds_read_b64_tr_b16 a[164:165], v201 offset:24576
  ds_read_b64_tr_b16 a[166:167], v201 offset:25600
  v_add_f32 v211, v85, v192
  v_exp_f32 v210, v210
  v_mfma_f32_16x16x32_bf16 v[20:23], a[172:175], a[32:35], v[20:23]
  s_waitcnt lgkmcnt(8)
  v_mfma_f32_16x16x32_bf16 v[32:35], a[176:179], a[32:35], v[32:35]
  ds_read_b64_tr_b16 a[168:169], v202 offset:24576
  ds_read_b64_tr_b16 a[170:171], v202 offset:25600
  buffer_load_dwordx4 v247, s[16:19], s34 offen offset:3072 lds
  s_add_u32 s34, s34, 524288
  s_sub_u32 s38, s34, 5242880
  s_min_u32 s34, s34, s38
  v_mfma_f32_16x16x32_bf16 v[40:43], a[176:179], a[36:39], v[40:43]
  v_mfma_f32_16x16x32_bf16 v[44:47], a[180:183], a[36:39], v[44:47]
  ds_read_b64_tr_b16 a[172:173], v203 offset:24576
  ds_read_b64_tr_b16 a[174:175], v203 offset:25600
  v_exp_f32 v211, v211
  v_add_f32 v214, v214, v208
  v_mfma_f32_16x16x32_bf16 v[36:39], a[180:183], a[32:35], v[36:39]
  s_waitcnt lgkmcnt(8)
  v_mfma_f32_16x16x32_bf16 v[48:51], a[184:187], a[32:35], v[48:51]
  ds_read_b64_tr_b16 a[176:177], v204 offset:24576
  ds_read_b64_tr_b16 a[178:179], v204 offset:25600
  v_add_f32 v214, v214, v209
  v_cvt_pk_bf16_f32 v137, v208, v209
  v_add_f32 v212, v86, v192
  v_mfma_f32_16x16x32_bf16 v[56:59], a[184:187], a[36:39], v[56:59]
  v_mfma_f32_16x16x32_bf16 v[60:63], a[188:191], a[36:39], v[60:63]
  ds_read_b64_tr_b16 a[180:181], v205 offset:24576
  ds_read_b64_tr_b16 a[182:183], v205 offset:25600
  v_add_f32 v213, v87, v192
  v_exp_f32 v212, v212
  v_mfma_f32_16x16x32_bf16 v[52:55], a[188:191], a[32:35], v[52:55]
  s_waitcnt lgkmcnt(8)
  v_mfma_f32_16x16x32_bf16 v[0:3], a[160:163], a[40:43], v[0:3]
  ds_read_b64_tr_b16 a[184:185], v206 offset:24576
  ds_read_b64_tr_b16 a[186:187], v206 offset:25600
  v_exp_f32 v213, v213
  v_mfma_f32_16x16x32_bf16 v[8:11], a[160:163], a[44:47], v[8:11]
  v_mfma_f32_16x16x32_bf16 v[12:15], a[164:167], a[44:47], v[12:15]
  ds_read_b64_tr_b16 a[188:189], v207 offset:24576
  ds_read_b64_tr_b16 a[190:191], v207 offset:25600
  v_add_f32 v214, v214, v210
  v_add_f32 v214, v214, v211
  v_cvt_pk_bf16_f32 v138, v210, v211
  v_mfma_f32_16x16x32_bf16 v[4:7], a[164:167], a[40:43], v[4:7]
  s_waitcnt lgkmcnt(8)
  v_mfma_f32_16x16x32_bf16 v[16:19], a[168:171], a[40:43], v[16:19]
  s_waitcnt vmcnt(20)
  s_barrier
  ds_read_b64_tr_b16 a[160:161], v232 offset:16384
  ds_read_b64_tr_b16 a[162:163], v232 offset:17408
  v_add_f32 v208, v88, v196
  v_mfma_f32_16x16x32_bf16 v[24:27], a[168:171], a[44:47], v[24:27]
  v_mfma_f32_16x16x32_bf16 v[28:31], a[172:175], a[44:47], v[28:31]
  ds_read_b64_tr_b16 a[164:165], v233 offset:16384
  ds_read_b64_tr_b16 a[166:167], v233 offset:17408
  s_add_u32 m0, s41, 16384
  s_nop 0
  buffer_load_dwordx4 v240, s[8:11], s32 offen offset:0 nt lds
  v_mfma_f32_16x16x32_bf16 v[20:23], a[172:175], a[40:43], v[20:23]
  s_waitcnt lgkmcnt(8)
  v_mfma_f32_16x16x32_bf16 v[32:35], a[176:179], a[40:43], v[32:35]
  ds_read_b64_tr_b16 a[168:169], v234 offset:16384
  ds_read_b64_tr_b16 a[170:171], v234 offset:17408
  v_add_f32 v209, v89, v196
  v_exp_f32 v208, v208
  v_mfma_f32_16x16x32_bf16 v[40:43], a[176:179], a[44:47], v[40:43]
  v_mfma_f32_16x16x32_bf16 v[44:47], a[180:183], a[44:47], v[44:47]
  ds_read_b64_tr_b16 a[172:173], v235 offset:16384
  ds_read_b64_tr_b16 a[174:175], v235 offset:17408
  v_exp_f32 v209, v209
  v_add_f32 v214, v214, v212
  v_mfma_f32_16x16x32_bf16 v[36:39], a[180:183], a[40:43], v[36:39]
  s_waitcnt lgkmcnt(8)
  v_mfma_f32_16x16x32_bf16 v[48:51], a[184:187], a[40:43], v[48:51]
  ds_read_b64_tr_b16 a[176:177], v236 offset:16384
  ds_read_b64_tr_b16 a[178:179], v236 offset:17408
  buffer_load_dwordx4 v241, s[8:11], s32 offen offset:1024 nt lds
  v_mfma_f32_16x16x32_bf16 v[56:59], a[184:187], a[44:47], v[56:59]
  v_mfma_f32_16x16x32_bf16 v[60:63], a[188:191], a[44:47], v[60:63]
  ds_read_b64_tr_b16 a[180:181], v237 offset:16384
  ds_read_b64_tr_b16 a[182:183], v237 offset:17408
  v_add_f32 v214, v214, v213
  v_cvt_pk_bf16_f32 v139, v212, v213
  v_add_f32 v210, v90, v196
  v_mfma_f32_16x16x32_bf16 v[52:55], a[188:191], a[40:43], v[52:55]
  s_waitcnt lgkmcnt(8)
  v_mfma_f32_16x16x32_bf16 v[0:3], a[160:163], a[48:51], v[0:3]
  ds_read_b64_tr_b16 a[184:185], v238 offset:16384
  ds_read_b64_tr_b16 a[186:187], v238 offset:17408
  v_add_f32 v211, v91, v196
  v_exp_f32 v210, v210
  v_mfma_f32_16x16x32_bf16 v[8:11], a[160:163], a[52:55], v[8:11]
  v_mfma_f32_16x16x32_bf16 v[12:15], a[164:167], a[52:55], v[12:15]
  ds_read_b64_tr_b16 a[188:189], v239 offset:16384
  ds_read_b64_tr_b16 a[190:191], v239 offset:17408
  buffer_load_dwordx4 v242, s[8:11], s32 offen offset:2048 nt lds
  v_mfma_f32_16x16x32_bf16 v[4:7], a[164:167], a[48:51], v[4:7]
  s_waitcnt lgkmcnt(8)
  v_mfma_f32_16x16x32_bf16 v[16:19], a[168:171], a[48:51], v[16:19]
  ds_read_b64_tr_b16 a[160:161], v232 offset:24576
  ds_read_b64_tr_b16 a[162:163], v232 offset:25600
  v_exp_f32 v211, v211
  v_add_f32 v215, v215, v208
  v_mfma_f32_16x16x32_bf16 v[24:27], a[168:171], a[52:55], v[24:27]
  v_mfma_f32_16x16x32_bf16 v[28:31], a[172:175], a[52:55], v[28:31]
  ds_read_b64_tr_b16 a[164:165], v233 offset:24576
  ds_read_b64_tr_b16 a[166:167], v233 offset:25600
  v_add_f32 v215, v215, v209
  v_cvt_pk_bf16_f32 v140, v208, v209
  v_add_f32 v212, v92, v196
  v_mfma_f32_16x16x32_bf16 v[20:23], a[172:175], a[48:51], v[20:23]
  s_waitcnt lgkmcnt(8)
  v_mfma_f32_16x16x32_bf16 v[32:35], a[176:179], a[48:51], v[32:35]
  ds_read_b64_tr_b16 a[168:169], v234 offset:24576
  ds_read_b64_tr_b16 a[170:171], v234 offset:25600
  buffer_load_dwordx4 v243, s[8:11], s32 offen offset:3072 nt lds
  s_add_u32 s32, s32, 0x4000
  v_mfma_f32_16x16x32_bf16 v[40:43], a[176:179], a[52:55], v[40:43]
  v_mfma_f32_16x16x32_bf16 v[44:47], a[180:183], a[52:55], v[44:47]
  ds_read_b64_tr_b16 a[172:173], v235 offset:24576
  ds_read_b64_tr_b16 a[174:175], v235 offset:25600
  v_add_f32 v213, v93, v196
  v_exp_f32 v212, v212
  v_mfma_f32_16x16x32_bf16 v[36:39], a[180:183], a[48:51], v[36:39]
  s_waitcnt lgkmcnt(8)
  v_mfma_f32_16x16x32_bf16 v[48:51], a[184:187], a[48:51], v[48:51]
  ds_read_b64_tr_b16 a[176:177], v236 offset:24576
  ds_read_b64_tr_b16 a[178:179], v236 offset:25600
  v_exp_f32 v213, v213
  v_add_f32 v215, v215, v210
  v_mfma_f32_16x16x32_bf16 v[56:59], a[184:187], a[52:55], v[56:59]
  v_mfma_f32_16x16x32_bf16 v[60:63], a[188:191], a[52:55], v[60:63]
  ds_read_b64_tr_b16 a[180:181], v237 offset:24576
  ds_read_b64_tr_b16 a[182:183], v237 offset:25600
  v_add_f32 v215, v215, v211
  v_cvt_pk_bf16_f32 v141, v210, v211
  v_mfma_f32_16x16x32_bf16 v[52:55], a[188:191], a[48:51], v[52:55]
  s_waitcnt lgkmcnt(8)
  v_mfma_f32_16x16x32_bf16 v[0:3], a[160:163], a[56:59], v[0:3]
  ds_read_b64_tr_b16 a[184:185], v238 offset:24576
  ds_read_b64_tr_b16 a[186:187], v238 offset:25600
  v_add_f32 v208, v94, v196
  v_add_f32 v209, v95, v196
  v_exp_f32 v208, v208
  v_mfma_f32_16x16x32_bf16 v[8:11], a[160:163], a[60:63], v[8:11]
  v_mfma_f32_16x16x32_bf16 v[12:15], a[164:167], a[60:63], v[12:15]
  ds_read_b64_tr_b16 a[188:189], v239 offset:24576
  ds_read_b64_tr_b16 a[190:191], v239 offset:25600
  v_exp_f32 v209, v209
  v_mfma_f32_16x16x32_bf16 v[4:7], a[164:167], a[56:59], v[4:7]
  s_waitcnt lgkmcnt(8)
  v_mfma_f32_16x16x32_bf16 v[16:19], a[168:171], a[56:59], v[16:19]
  s_waitcnt vmcnt(20)
  s_barrier
  ds_read_b64_tr_b16 a[160:161], v232 offset:32768
  ds_read_b64_tr_b16 a[162:163], v232 offset:33792
  v_add_f32 v215, v215, v212
  v_mfma_f32_16x16x32_bf16 v[24:27], a[168:171], a[60:63], v[24:27]
  v_mfma_f32_16x16x32_bf16 v[28:31], a[172:175], a[60:63], v[28:31]
  ds_read_b64_tr_b16 a[164:165], v233 offset:32768
  ds_read_b64_tr_b16 a[166:167], v233 offset:33792
  s_add_u32 m0, s41, 147456
  s_nop 0
  buffer_load_dwordx4 v248, s[12:15], s33 offen offset:0 nt lds
  v_mfma_f32_16x16x32_bf16 v[20:23], a[172:175], a[56:59], v[20:23]
  s_waitcnt lgkmcnt(8)
  v_mfma_f32_16x16x32_bf16 v[32:35], a[176:179], a[56:59], v[32:35]
  ds_read_b64_tr_b16 a[168:169], v234 offset:32768
  ds_read_b64_tr_b16 a[170:171], v234 offset:33792
  v_add_f32 v215, v215, v213
  v_cvt_pk_bf16_f32 v142, v212, v213
  v_add_f32 v215, v215, v208
  v_mfma_f32_16x16x32_bf16 v[40:43], a[176:179], a[60:63], v[40:43]
  v_mfma_f32_16x16x32_bf16 v[44:47], a[180:183], a[60:63], v[44:47]
  ds_read_b64_tr_b16 a[172:173], v235 offset:32768
  ds_read_b64_tr_b16 a[174:175], v235 offset:33792
  v_add_f32 v215, v215, v209
  v_cvt_pk_bf16_f32 v143, v208, v209
  v_mov_b32 v249, v214
  v_mfma_f32_16x16x32_bf16 v[36:39], a[180:183], a[56:59], v[36:39]
  s_waitcnt lgkmcnt(8)
  v_mfma_f32_16x16x32_bf16 v[48:51], a[184:187], a[56:59], v[48:51]
  ds_read_b64_tr_b16 a[176:177], v236 offset:32768
  ds_read_b64_tr_b16 a[178:179], v236 offset:33792
  buffer_load_dwordx4 v248, s[12:15], s33 offen offset:1024 nt lds
  v_mfma_f32_16x16x32_bf16 v[56:59], a[184:187], a[60:63], v[56:59]
  v_mfma_f32_16x16x32_bf16 v[60:63], a[188:191], a[60:63], v[60:63]
  ds_read_b64_tr_b16 a[180:181], v237 offset:32768
  ds_read_b64_tr_b16 a[182:183], v237 offset:33792
  v_mov_b32 v254, v215
  v_exp_f32 v208, v96
  v_mfma_f32_16x16x32_bf16 v[52:55], a[188:191], a[56:59], v[52:55]
  s_waitcnt lgkmcnt(8)
  v_mfma_f32_16x16x32_bf16 a[192:195], a[160:163], v[128:131], 0
  ds_read_b64_tr_b16 a[184:185], v238 offset:32768
  ds_read_b64_tr_b16 a[186:187], v238 offset:33792
  v_exp_f32 v209, v97
  v_mfma_f32_16x16x32_bf16 a[200:203], a[160:163], v[132:135], 0
  v_mfma_f32_16x16x32_bf16 a[204:207], a[164:167], v[132:135], 0
  ds_read_b64_tr_b16 a[188:189], v239 offset:32768
  ds_read_b64_tr_b16 a[190:191], v239 offset:33792
  buffer_load_dwordx4 v248, s[12:15], s33 offen offset:2048 nt lds
  v_exp_f32 v210, v98
  v_mfma_f32_16x16x32_bf16 a[196:199], a[164:167], v[128:131], 0
  s_waitcnt lgkmcnt(8)
  v_mfma_f32_16x16x32_bf16 a[208:211], a[168:171], v[128:131], 0
  ds_read_b64_tr_b16 a[160:161], v232 offset:40960
  ds_read_b64_tr_b16 a[162:163], v232 offset:41984
  v_cvt_pk_bf16_f32 v144, v208, v209
  v_mfma_f32_16x16x32_bf16 a[216:219], a[168:171], v[132:135], 0
  v_mfma_f32_16x16x32_bf16 a[220:223], a[172:175], v[132:135], 0
  ds_read_b64_tr_b16 a[164:165], v233 offset:40960
  ds_read_b64_tr_b16 a[166:167], v233 offset:41984
  v_exp_f32 v211, v99
  v_add_f32 v214, v208, v209
  v_mfma_f32_16x16x32_bf16 a[212:215], a[172:175], v[128:131], 0
  s_waitcnt lgkmcnt(8)
  v_mfma_f32_16x16x32_bf16 a[224:227], a[176:179], v[128:131], 0
  ds_read_b64_tr_b16 a[168:169], v234 offset:40960
  ds_read_b64_tr_b16 a[170:171], v234 offset:41984
  buffer_load_dwordx4 v248, s[12:15], s33 offen offset:3072 nt lds
  s_add_u32 s33, s33, 0x4000
  v_mfma_f32_16x16x32_bf16 a[232:235], a[176:179], v[132:135], 0
  v_mfma_f32_16x16x32_bf16 a[236:239], a[180:183], v[132:135], 0
  ds_read_b64_tr_b16 a[172:173], v235 offset:40960
  ds_read_b64_tr_b16 a[174:175], v235 offset:41984
  v_exp_f32 v212, v100
  v_add_f32 v214, v214, v210
  v_cvt_pk_bf16_f32 v145, v210, v211
  v_mfma_f32_16x16x32_bf16 a[228:231], a[180:183], v[128:131], 0
  s_waitcnt lgkmcnt(8)
  v_mfma_f32_16x16x32_bf16 a[240:243], a[184:187], v[128:131], 0
  ds_read_b64_tr_b16 a[176:177], v236 offset:40960
  ds_read_b64_tr_b16 a[178:179], v236 offset:41984
  v_exp_f32 v213, v101
  v_add_f32 v214, v214, v211
  v_mfma_f32_16x16x32_bf16 a[248:251], a[184:187], v[132:135], 0
  v_mfma_f32_16x16x32_bf16 a[252:255], a[188:191], v[132:135], 0
  ds_read_b64_tr_b16 a[180:181], v237 offset:40960
  ds_read_b64_tr_b16 a[182:183], v237 offset:41984
  v_exp_f32 v208, v102
  v_mfma_f32_16x16x32_bf16 a[244:247], a[188:191], v[128:131], 0
  s_waitcnt lgkmcnt(8)
  v_mfma_f32_16x16x32_bf16 a[192:195], a[160:163], v[136:139], a[192:195]
  ds_read_b64_tr_b16 a[184:185], v238 offset:40960
  ds_read_b64_tr_b16 a[186:187], v238 offset:41984
  v_add_f32 v214, v214, v212
  v_cvt_pk_bf16_f32 v146, v212, v213
  v_exp_f32 v209, v103
  v_mfma_f32_16x16x32_bf16 a[200:203], a[160:163], v[140:143], a[200:203]
  v_mfma_f32_16x16x32_bf16 a[204:207], a[164:167], v[140:143], a[204:207]
  ds_read_b64_tr_b16 a[188:189], v239 offset:40960
  ds_read_b64_tr_b16 a[190:191], v239 offset:41984
  v_add_f32 v214, v214, v213
  v_exp_f32 v210, v104
  v_mfma_f32_16x16x32_bf16 a[196:199], a[164:167], v[136:139], a[196:199]
  s_waitcnt lgkmcnt(8)
  v_mfma_f32_16x16x32_bf16 a[208:211], a[168:171], v[136:139], a[208:211]
  s_barrier
  ds_read_b128 a[160:163], v224 offset:32768
  v_add_f32 v214, v214, v208
  v_cvt_pk_bf16_f32 v147, v208, v209
  v_mfma_f32_16x16x32_bf16 a[216:219], a[168:171], v[140:143], a[216:219]
  v_mfma_f32_16x16x32_bf16 a[220:223], a[172:175], v[140:143], a[220:223]
  ds_read_b128 a[164:167], v224 offset:36864
  s_add_u32 m0, s41, 81920
  s_nop 0
  buffer_load_dwordx4 v244, s[16:19], s34 offen offset:0 lds
  v_mfma_f32_16x16x32_bf16 a[212:215], a[172:175], v[136:139], a[212:215]
  s_waitcnt lgkmcnt(6)
  v_mfma_f32_16x16x32_bf16 a[224:227], a[176:179], v[136:139], a[224:227]
  ds_read_b128 a[168:171], v225 offset:32768
  v_exp_f32 v211, v105
  v_add_f32 v214, v214, v209
  v_mfma_f32_16x16x32_bf16 a[232:235], a[176:179], v[140:143], a[232:235]
  v_mfma_f32_16x16x32_bf16 a[236:239], a[180:183], v[140:143], a[236:239]
  ds_read_b128 a[172:175], v225 offset:36864
  v_exp_f32 v212, v106
  v_cvt_pk_bf16_f32 v148, v210, v211
  v_exp_f32 v213, v107
  v_mfma_f32_16x16x32_bf16 a[228:231], a[180:183], v[136:139], a[228:231]
  s_waitcnt lgkmcnt(4)
  v_mfma_f32_16x16x32_bf16 a[240:243], a[184:187], v[136:139], a[240:243]
  ds_read_b128 a[176:179], v226 offset:32768
  buffer_load_dwordx4 v245, s[16:19], s34 offen offset:1024 lds
  v_mfma_f32_16x16x32_bf16 a[248:251], a[184:187], v[140:143], a[248:251]
  v_mfma_f32_16x16x32_bf16 a[252:255], a[188:191], v[140:143], a[252:255]
  ds_read_b128 a[180:183], v226 offset:36864
  v_add_f32 v215, v210, v211
  v_exp_f32 v208, v108
  v_add_f32 v215, v215, v212
  v_mfma_f32_16x16x32_bf16 a[244:247], a[188:191], v[136:139], a[244:247]
  s_waitcnt lgkmcnt(4)
  v_mfma_f32_16x16x32_bf16 v[64:67], a[160:163], v[160:163], v[192:195]
  ds_read_b128 a[184:187], v227 offset:32768
  v_cvt_pk_bf16_f32 v149, v212, v213
  v_exp_f32 v209, v109
  v_add_f32 v215, v215, v213
  v_mfma_f32_16x16x32_bf16 v[72:75], a[160:163], v[164:167], v[196:199]
  v_mfma_f32_16x16x32_bf16 v[76:79], a[164:167], v[164:167], v[196:199]
  ds_read_b128 a[188:191], v227 offset:36864
  buffer_load_dwordx4 v246, s[16:19], s34 offen offset:2048 lds
  v_mfma_f32_16x16x32_bf16 v[68:71], a[164:167], v[160:163], v[192:195]
  s_waitcnt lgkmcnt(4)
  v_mfma_f32_16x16x32_bf16 v[64:67], a[168:171], v[168:171], v[64:67]
  ds_read_b128 a[160:163], v224 offset:34816
  v_exp_f32 v210, v110
  v_add_f32 v215, v215, v208
  v_cvt_pk_bf16_f32 v150, v208, v209
  v_mfma_f32_16x16x32_bf16 v[72:75], a[168:171], v[172:175], v[72:75]
  v_mfma_f32_16x16x32_bf16 v[76:79], a[172:175], v[172:175], v[76:79]
  ds_read_b128 a[164:167], v224 offset:38912
  v_exp_f32 v211, v111
  v_add_f32 v215, v215, v209
  v_mfma_f32_16x16x32_bf16 v[68:71], a[172:175], v[168:171], v[68:71]
  s_waitcnt lgkmcnt(4)
  v_mfma_f32_16x16x32_bf16 v[64:67], a[176:179], v[176:179], v[64:67]
  ds_read_b128 a[168:171], v225 offset:34816
  buffer_load_dwordx4 v247, s[16:19], s34 offen offset:3072 lds
  s_add_u32 s34, s34, 524288
  s_sub_u32 s38, s34, 5242880
  s_min_u32 s34, s34, s38
  v_mfma_f32_16x16x32_bf16 v[72:75], a[176:179], v[180:183], v[72:75]
  v_mfma_f32_16x16x32_bf16 v[76:79], a[180:183], v[180:183], v[76:79]
  ds_read_b128 a[172:175], v225 offset:38912
  v_exp_f32 v212, v112
  v_add_f32 v215, v215, v210
  v_cvt_pk_bf16_f32 v151, v210, v211
  v_mfma_f32_16x16x32_bf16 v[68:71], a[180:183], v[176:179], v[68:71]
  s_waitcnt lgkmcnt(4)
  v_mfma_f32_16x16x32_bf16 v[64:67], a[184:187], v[184:187], v[64:67]
  ds_read_b128 a[176:179], v226 offset:34816
  v_exp_f32 v213, v113
  v_add_f32 v215, v215, v211
  v_exp_f32 v208, v114
  v_mfma_f32_16x16x32_bf16 v[72:75], a[184:187], v[188:191], v[72:75]
  v_mfma_f32_16x16x32_bf16 v[76:79], a[188:191], v[188:191], v[76:79]
  ds_read_b128 a[180:183], v226 offset:38912
  v_add_f32 v214, v214, v212
  v_cvt_pk_bf16_f32 v152, v212, v213
  v_exp_f32 v209, v115
  v_mfma_f32_16x16x32_bf16 v[68:71], a[188:191], v[184:187], v[68:71]
  s_waitcnt lgkmcnt(4)
  v_mfma_f32_16x16x32_bf16 v[80:83], a[160:163], v[160:163], v[192:195]
  ds_read_b128 a[184:187], v227 offset:34816
  v_add_f32 v214, v214, v213
  v_exp_f32 v210, v116
  v_mfma_f32_16x16x32_bf16 v[88:91], a[160:163], v[164:167], v[196:199]
  v_mfma_f32_16x16x32_bf16 v[92:95], a[164:167], v[164:167], v[196:199]
  ds_read_b128 a[188:191], v227 offset:38912
  v_add_f32 v214, v214, v208
  v_cvt_pk_bf16_f32 v153, v208, v209
  v_exp_f32 v211, v117
  v_mfma_f32_16x16x32_bf16 v[84:87], a[164:167], v[160:163], v[192:195]
  s_waitcnt lgkmcnt(4)
  v_mfma_f32_16x16x32_bf16 v[80:83], a[168:171], v[168:171], v[80:83]
  s_waitcnt vmcnt(24)
  s_barrier
  ds_read_b64_tr_b16 a[160:161], v232 offset:49152
  ds_read_b64_tr_b16 a[162:163], v232 offset:50176
  v_add_f32 v214, v214, v209
  v_mfma_f32_16x16x32_bf16 v[88:91], a[168:171], v[172:175], v[88:91]
  v_mfma_f32_16x16x32_bf16 v[92:95], a[172:175], v[172:175], v[92:95]
  ds_read_b64_tr_b16 a[164:165], v233 offset:49152
  ds_read_b64_tr_b16 a[166:167], v233 offset:50176
  s_add_u32 m0, s41, 98304
  s_nop 0
  buffer_load_dwordx4 v248, s[12:15], s33 offen offset:0 nt lds
  v_mfma_f32_16x16x32_bf16 v[84:87], a[172:175], v[168:171], v[84:87]
  s_waitcnt lgkmcnt(6)
  v_mfma_f32_16x16x32_bf16 v[80:83], a[176:179], v[176:179], v[80:83]
  ds_read_b64_tr_b16 a[168:169], v234 offset:49152
  ds_read_b64_tr_b16 a[170:171], v234 offset:50176
  v_exp_f32 v212, v118
  v_add_f32 v214, v214, v210
  v_mfma_f32_16x16x32_bf16 v[88:91], a[176:179], v[180:183], v[88:91]
  v_mfma_f32_16x16x32_bf16 v[92:95], a[180:183], v[180:183], v[92:95]
  ds_read_b64_tr_b16 a[172:173], v235 offset:49152
  ds_read_b64_tr_b16 a[174:175], v235 offset:50176
  v_cvt_pk_bf16_f32 v154, v210, v211
  v_exp_f32 v213, v119
  v_mfma_f32_16x16x32_bf16 v[84:87], a[180:183], v[176:179], v[84:87]
  s_waitcnt lgkmcnt(8)
  v_mfma_f32_16x16x32_bf16 v[80:83], a[184:187], v[184:187], v[80:83]
  ds_read_b64_tr_b16 a[176:177], v236 offset:49152
  ds_read_b64_tr_b16 a[178:179], v236 offset:50176
  buffer_load_dwordx4 v248, s[12:15], s33 offen offset:1024 nt lds
  v_mfma_f32_16x16x32_bf16 v[88:91], a[184:187], v[188:191], v[88:91]
  v_mfma_f32_16x16x32_bf16 v[92:95], a[188:191], v[188:191], v[92:95]
  ds_read_b64_tr_b16 a[180:181], v237 offset:49152
  ds_read_b64_tr_b16 a[182:183], v237 offset:50176
  v_add_f32 v214, v214, v211
  v_exp_f32 v208, v120
  v_mfma_f32_16x16x32_bf16 v[84:87], a[188:191], v[184:187], v[84:87]
  s_waitcnt lgkmcnt(8)
  v_mfma_f32_16x16x32_bf16 v[0:3], a[160:163], a[64:67], v[0:3]
  ds_read_b64_tr_b16 a[184:185], v238 offset:49152
  ds_read_b64_tr_b16 a[186:187], v238 offset:50176
  v_add_f32 v214, v214, v212
  v_cvt_pk_bf16_f32 v155, v212, v213
  v_mfma_f32_16x16x32_bf16 v[8:11], a[160:163], a[68:71], v[8:11]
  v_mfma_f32_16x16x32_bf16 v[12:15], a[164:167], a[68:71], v[12:15]
  ds_read_b64_tr_b16 a[188:189], v239 offset:49152
  ds_read_b64_tr_b16 a[190:191], v239 offset:50176
  buffer_load_dwordx4 v248, s[12:15], s33 offen offset:2048 nt lds
  v_exp_f32 v209, v121
  v_mfma_f32_16x16x32_bf16 v[4:7], a[164:167], a[64:67], v[4:7]
  s_waitcnt lgkmcnt(8)
  v_mfma_f32_16x16x32_bf16 v[16:19], a[168:171], a[64:67], v[16:19]
  ds_read_b64_tr_b16 a[160:161], v232 offset:57344
  ds_read_b64_tr_b16 a[162:163], v232 offset:58368
  v_add_f32 v214, v214, v213
  v_mfma_f32_16x16x32_bf16 v[24:27], a[168:171], a[68:71], v[24:27]
  v_mfma_f32_16x16x32_bf16 v[28:31], a[172:175], a[68:71], v[28:31]
  ds_read_b64_tr_b16 a[164:165], v233 offset:57344
  ds_read_b64_tr_b16 a[166:167], v233 offset:58368
  v_exp_f32 v210, v122
  v_add_f32 v215, v215, v208
  v_cvt_pk_bf16_f32 v156, v208, v209
  v_mfma_f32_16x16x32_bf16 v[20:23], a[172:175], a[64:67], v[20:23]
  s_waitcnt lgkmcnt(8)
  v_mfma_f32_16x16x32_bf16 v[32:35], a[176:179], a[64:67], v[32:35]
  ds_read_b64_tr_b16 a[168:169], v234 offset:57344
  ds_read_b64_tr_b16 a[170:171], v234 offset:58368
  buffer_load_dwordx4 v248, s[12:15], s33 offen offset:3072 nt lds
  s_add_u32 s33, s33, 0x4000
  v_mfma_f32_16x16x32_bf16 v[40:43], a[176:179], a[68:71], v[40:43]
  v_mfma_f32_16x16x32_bf16 v[44:47], a[180:183], a[68:71], v[44:47]
  ds_read_b64_tr_b16 a[172:173], v235 offset:57344
  ds_read_b64_tr_b16 a[174:175], v235 offset:58368
  v_exp_f32 v211, v123
  v_add_f32 v215, v215, v209
  v_mfma_f32_16x16x32_bf16 v[36:39], a[180:183], a[64:67], v[36:39]
  s_waitcnt lgkmcnt(8)
  v_mfma_f32_16x16x32_bf16 v[48:51], a[184:187], a[64:67], v[48:51]
  ds_read_b64_tr_b16 a[176:177], v236 offset:57344
  ds_read_b64_tr_b16 a[178:179], v236 offset:58368
  v_exp_f32 v212, v124
  v_add_f32 v215, v215, v210
  v_mfma_f32_16x16x32_bf16 v[56:59], a[184:187], a[68:71], v[56:59]
  v_mfma_f32_16x16x32_bf16 v[60:63], a[188:191], a[68:71], v[60:63]
  ds_read_b64_tr_b16 a[180:181], v237 offset:57344
  ds_read_b64_tr_b16 a[182:183], v237 offset:58368
  v_cvt_pk_bf16_f32 v157, v210, v211
  v_exp_f32 v213, v125
  v_mfma_f32_16x16x32_bf16 v[52:55], a[188:191], a[64:67], v[52:55]
  s_waitcnt lgkmcnt(8)
  v_mfma_f32_16x16x32_bf16 v[0:3], a[160:163], a[72:75], v[0:3]
  ds_read_b64_tr_b16 a[184:185], v238 offset:57344
  ds_read_b64_tr_b16 a[186:187], v238 offset:58368
  v_add_f32 v215, v215, v211
  v_exp_f32 v208, v126
  v_mfma_f32_16x16x32_bf16 v[8:11], a[160:163], a[76:79], v[8:11]
  v_mfma_f32_16x16x32_bf16 v[12:15], a[164:167], a[76:79], v[12:15]
  ds_read_b64_tr_b16 a[188:189], v239 offset:57344
  ds_read_b64_tr_b16 a[190:191], v239 offset:58368
  v_add_f32 v215, v215, v212
  v_cvt_pk_bf16_f32 v158, v212, v213
  v_mfma_f32_16x16x32_bf16 v[4:7], a[164:167], a[72:75], v[4:7]
  s_waitcnt lgkmcnt(8)
  v_mfma_f32_16x16x32_bf16 v[16:19], a[168:171], a[72:75], v[16:19]
  s_waitcnt vmcnt(20)
  s_barrier
  ds_read_b64_tr_b16 a[160:161], v232 offset:0
  ds_read_b64_tr_b16 a[162:163], v232 offset:1024
  v_exp_f32 v209, v127
  v_mfma_f32_16x16x32_bf16 v[24:27], a[168:171], a[76:79], v[24:27]
  v_mfma_f32_16x16x32_bf16 v[28:31], a[172:175], a[76:79], v[28:31]
  ds_read_b64_tr_b16 a[164:165], v233 offset:0
  ds_read_b64_tr_b16 a[166:167], v233 offset:1024
  s_add_u32 m0, s41, 32768
  s_nop 0
  buffer_load_dwordx4 v240, s[8:11], s32 offen offset:0 nt lds
  v_mfma_f32_16x16x32_bf16 v[20:23], a[172:175], a[72:75], v[20:23]
  s_waitcnt lgkmcnt(8)
  v_mfma_f32_16x16x32_bf16 v[32:35], a[176:179], a[72:75], v[32:35]
  ds_read_b64_tr_b16 a[168:169], v234 offset:0
  ds_read_b64_tr_b16 a[170:171], v234 offset:1024
  v_add_f32 v215, v215, v213
  v_add_f32 v215, v215, v208
  v_mfma_f32_16x16x32_bf16 v[40:43], a[176:179], a[76:79], v[40:43]
  v_mfma_f32_16x16x32_bf16 v[44:47], a[180:183], a[76:79], v[44:47]
  ds_read_b64_tr_b16 a[172:173], v235 offset:0
  ds_read_b64_tr_b16 a[174:175], v235 offset:1024
  v_cvt_pk_bf16_f32 v159, v208, v209
  v_add_f32 v215, v215, v209
  v_add_f32 v210, v214, v215
  v_mfma_f32_16x16x32_bf16 v[36:39], a[180:183], a[72:75], v[36:39]
  s_waitcnt lgkmcnt(8)
  v_mfma_f32_16x16x32_bf16 v[48:51], a[184:187], a[72:75], v[48:51]
  ds_read_b64_tr_b16 a[176:177], v236 offset:0
  ds_read_b64_tr_b16 a[178:179], v236 offset:1024
  buffer_load_dwordx4 v241, s[8:11], s32 offen offset:1024 nt lds
  v_mfma_f32_16x16x32_bf16 v[56:59], a[184:187], a[76:79], v[56:59]
  v_mfma_f32_16x16x32_bf16 v[60:63], a[188:191], a[76:79], v[60:63]
  ds_read_b64_tr_b16 a[180:181], v237 offset:0
  ds_read_b64_tr_b16 a[182:183], v237 offset:1024
  v_cmp_lt_f32 vcc, s35, v210
  v_mfma_f32_16x16x32_bf16 v[52:55], a[188:191], a[72:75], v[52:55]
  s_cbranch_vccnz SITE19
BACK19:
  s_waitcnt lgkmcnt(8)
  v_mfma_f32_16x16x32_bf16 a[192:195], a[160:163], v[144:147], a[192:195]
  ds_read_b64_tr_b16 a[184:185], v238 offset:0
  ds_read_b64_tr_b16 a[186:187], v238 offset:1024
  v_add_f32 v249, v249, v214
  v_add_f32 v254, v254, v215
  v_exp_f32 v208, v64
  v_mfma_f32_16x16x32_bf16 a[200:203], a[160:163], v[148:151], a[200:203]
  v_mfma_f32_16x16x32_bf16 a[204:207], a[164:167], v[148:151], a[204:207]
  ds_read_b64_tr_b16 a[188:189], v239 offset:0
  ds_read_b64_tr_b16 a[190:191], v239 offset:1024
  buffer_load_dwordx4 v242, s[8:11], s32 offen offset:2048 nt lds
  v_mfma_f32_16x16x32_bf16 a[196:199], a[164:167], v[144:147], a[196:199]
  s_waitcnt lgkmcnt(8)
  v_mfma_f32_16x16x32_bf16 a[208:211], a[168:171], v[144:147], a[208:211]
  ds_read_b64_tr_b16 a[160:161], v232 offset:8192
  ds_read_b64_tr_b16 a[162:163], v232 offset:9216
  v_exp_f32 v209, v65
  v_exp_f32 v210, v66
  v_mfma_f32_16x16x32_bf16 a[216:219], a[168:171], v[148:151], a[216:219]
  v_mfma_f32_16x16x32_bf16 a[220:223], a[172:175], v[148:151], a[220:223]
  ds_read_b64_tr_b16 a[164:165], v233 offset:8192
  ds_read_b64_tr_b16 a[166:167], v233 offset:9216
  v_cvt_pk_bf16_f32 v128, v208, v209
  v_exp_f32 v211, v67
  v_mfma_f32_16x16x32_bf16 a[212:215], a[172:175], v[144:147], a[212:215]
  s_waitcnt lgkmcnt(8)
  v_mfma_f32_16x16x32_bf16 a[224:227], a[176:179], v[144:147], a[224:227]
  ds_read_b64_tr_b16 a[168:169], v234 offset:8192
  ds_read_b64_tr_b16 a[170:171], v234 offset:9216
  buffer_load_dwordx4 v243, s[8:11], s32 offen offset:3072 nt lds
  s_add_u32 s32, s32, 0x4000
  v_mfma_f32_16x16x32_bf16 a[232:235], a[176:179], v[148:151], a[232:235]
  v_mfma_f32_16x16x32_bf16 a[236:239], a[180:183], v[148:151], a[236:239]
  ds_read_b64_tr_b16 a[172:173], v235 offset:8192
  ds_read_b64_tr_b16 a[174:175], v235 offset:9216
  v_add_f32 v214, v208, v209
  v_exp_f32 v212, v68
  v_mfma_f32_16x16x32_bf16 a[228:231], a[180:183], v[144:147], a[228:231]
  s_waitcnt lgkmcnt(8)
  v_mfma_f32_16x16x32_bf16 a[240:243], a[184:187], v[144:147], a[240:243]
  ds_read_b64_tr_b16 a[176:177], v236 offset:8192
  ds_read_b64_tr_b16 a[178:179], v236 offset:9216
  v_add_f32 v214, v214, v210
  v_cvt_pk_bf16_f32 v129, v210, v211
  v_mfma_f32_16x16x32_bf16 a[248:251], a[184:187], v[148:151], a[248:251]
  v_mfma_f32_16x16x32_bf16 a[252:255], a[188:191], v[148:151], a[252:255]
  ds_read_b64_tr_b16 a[180:181], v237 offset:8192
  ds_read_b64_tr_b16 a[182:183], v237 offset:9216
  v_exp_f32 v213, v69
  v_add_f32 v214, v214, v211
  v_mfma_f32_16x16x32_bf16 a[244:247], a[188:191], v[144:147], a[244:247]
  s_waitcnt lgkmcnt(8)
  v_mfma_f32_16x16x32_bf16 a[192:195], a[160:163], v[152:155], a[192:195]
  ds_read_b64_tr_b16 a[184:185], v238 offset:8192
  ds_read_b64_tr_b16 a[186:187], v238 offset:9216
  v_exp_f32 v208, v70
  v_add_f32 v214, v214, v212
  v_mfma_f32_16x16x32_bf16 a[200:203], a[160:163], v[156:159], a[200:203]
  v_mfma_f32_16x16x32_bf16 a[204:207], a[164:167], v[156:159], a[204:207]
  ds_read_b64_tr_b16 a[188:189], v239 offset:8192
  ds_read_b64_tr_b16 a[190:191], v239 offset:9216
  v_cvt_pk_bf16_f32 v130, v212, v213
  v_exp_f32 v209, v71
  v_mfma_f32_16x16x32_bf16 a[196:199], a[164:167], v[152:155], a[196:199]
  s_waitcnt lgkmcnt(8)
  v_mfma_f32_16x16x32_bf16 a[208:211], a[168:171], v[152:155], a[208:211]
  s_barrier
  ds_read_b128 a[160:163], v224 offset:49152
  v_add_f32 v214, v214, v213
  v_exp_f32 v210, v72
  v_mfma_f32_16x16x32_bf16 a[216:219], a[168:171], v[156:159], a[216:219]
  v_mfma_f32_16x16x32_bf16 a[220:223], a[172:175], v[156:159], a[220:223]
  ds_read_b128 a[164:167], v224 offset:53248
  s_add_u32 m0, s41, 114688
  s_nop 0
  buffer_load_dwordx4 v248, s[12:15], s33 offen offset:0 nt lds
  v_mfma_f32_16x16x32_bf16 a[212:215], a[172:175], v[152:155], a[212:215]
  s_waitcnt lgkmcnt(6)
  v_mfma_f32_16x16x32_bf16 a[224:227], a[176:179], v[152:155], a[224:227]
  ds_read_b128 a[168:171], v225 offset:49152
  v_add_f32 v214, v214, v208
  v_cvt_pk_bf16_f32 v131, v208, v209
  v_exp_f32 v211, v73
  v_mfma_f32_16x16x32_bf16 a[232:235], a[176:179], v[156:159], a[232:235]
  v_mfma_f32_16x16x32_bf16 a[236:239], a[180:183], v[156:159], a[236:239]
  ds_read_b128 a[172:175], v225 offset:53248
  v_add_f32 v214, v214, v209
  v_exp_f32 v212, v74
  v_cvt_pk_bf16_f32 v132, v210, v211
  v_mfma_f32_16x16x32_bf16 a[228:231], a[180:183], v[152:155], a[228:231]
  s_waitcnt lgkmcnt(4)
  v_mfma_f32_16x16x32_bf16 a[240:243], a[184:187], v[152:155], a[240:243]
  ds_read_b128 a[176:179], v226 offset:49152
  buffer_load_dwordx4 v248, s[12:15], s33 offen offset:1024 nt lds
  v_mfma_f32_16x16x32_bf16 a[248:251], a[184:187], v[156:159], a[248:251]
  v_mfma_f32_16x16x32_bf16 a[252:255], a[188:191], v[156:159], a[252:255]
  ds_read_b128 a[180:183], v226 offset:53248
  v_exp_f32 v213, v75
  v_add_f32 v215, v210, v211
  v_exp_f32 v208, v76
  v_mfma_f32_16x16x32_bf16 a[244:247], a[188:191], v[152:155], a[244:247]
  s_waitcnt lgkmcnt(4)
  v_mfma_f32_16x16x32_bf16 v[96:99], a[160:163], v[160:163], v[192:195]
  ds_read_b128 a[184:187], v227 offset:49152
  v_add_f32 v215, v215, v212
  v_cvt_pk_bf16_f32 v133, v212, v213
  v_mfma_f32_16x16x32_bf16 v[104:107], a[160:163], v[164:167], v[196:199]
  v_mfma_f32_16x16x32_bf16 v[108:111], a[164:167], v[164:167], v[196:199]
  ds_read_b128 a[188:191], v227 offset:53248
  buffer_load_dwordx4 v248, s[12:15], s33 offen offset:2048 nt lds
  v_exp_f32 v209, v77
  v_mfma_f32_16x16x32_bf16 v[100:103], a[164:167], v[160:163], v[192:195]
  s_waitcnt lgkmcnt(4)
  v_mfma_f32_16x16x32_bf16 v[96:99], a[168:171], v[168:171], v[96:99]
  ds_read_b128 a[160:163], v224 offset:51200
  v_add_f32 v215, v215, v213
  v_exp_f32 v210, v78
  v_mfma_f32_16x16x32_bf16 v[104:107], a[168:171], v[172:175], v[104:107]
  v_mfma_f32_16x16x32_bf16 v[108:111], a[172:175], v[172:175], v[108:111]
  ds_read_b128 a[164:167], v224 offset:55296
  v_add_f32 v215, v215, v208
  v_cvt_pk_bf16_f32 v134, v208, v209
  v_exp_f32 v211, v79
  v_mfma_f32_16x16x32_bf16 v[100:103], a[172:175], v[168:171], v[100:103]
  s_waitcnt lgkmcnt(4)
  v_mfma_f32_16x16x32_bf16 v[96:99], a[176:179], v[176:179], v[96:99]
  ds_read_b128 a[168:171], v225 offset:51200
  buffer_load_dwordx4 v248, s[12:15], s33 offen offset:3072 nt lds
  s_add_u32 s33, s33, 0x4000
  v_mfma_f32_16x16x32_bf16 v[104:107], a[176:179], v[180:183], v[104:107]
  v_mfma_f32_16x16x32_bf16 v[108:111], a[180:183], v[180:183], v[108:111]
  ds_read_b128 a[172:175], v225 offset:55296
  v_add_f32 v215, v215, v209
  v_exp_f32 v212, v80
  v_add_f32 v215, v215, v210
  v_mfma_f32_16x16x32_bf16 v[100:103], a[180:183], v[176:179], v[100:103]
  s_waitcnt lgkmcnt(4)
  v_mfma_f32_16x16x32_bf16 v[96:99], a[184:187], v[184:187], v[96:99]
  ds_read_b128 a[176:179], v226 offset:51200
  v_cvt_pk_bf16_f32 v135, v210, v211
  v_exp_f32 v213, v81
  v_add_f32 v215, v215, v211
  v_mfma_f32_16x16x32_bf16 v[104:107], a[184:187], v[188:191], v[104:107]
  v_mfma_f32_16x16x32_bf16 v[108:111], a[188:191], v[188:191], v[108:111]
  ds_read_b128 a[180:183], v226 offset:55296
  v_exp_f32 v208, v82
  v_add_f32 v214, v214, v212
  v_cvt_pk_bf16_f32 v136, v212, v213
  v_mfma_f32_16x16x32_bf16 v[100:103], a[188:191], v[184:187], v[100:103]
  s_waitcnt lgkmcnt(4)
  v_mfma_f32_16x16x32_bf16 v[112:115], a[160:163], v[160:163], v[192:195]
  ds_read_b128 a[184:187], v227 offset:51200
  v_exp_f32 v209, v83
  v_add_f32 v214, v214, v213
  v_mfma_f32_16x16x32_bf16 v[120:123], a[160:163], v[164:167], v[196:199]
  v_mfma_f32_16x16x32_bf16 v[124:127], a[164:167], v[164:167], v[196:199]
  ds_read_b128 a[188:191], v227 offset:55296
  v_exp_f32 v210, v84
  v_add_f32 v214, v214, v208
  v_cvt_pk_bf16_f32 v137, v208, v209
  v_mfma_f32_16x16x32_bf16 v[116:119], a[164:167], v[160:163], v[192:195]
  s_waitcnt lgkmcnt(4)
  v_mfma_f32_16x16x32_bf16 v[112:115], a[168:171], v[168:171], v[112:115]
  s_waitcnt vmcnt(24)
  s_barrier
  ds_read_b64_tr_b16 a[160:161], v200 offset:0
  ds_read_b64_tr_b16 a[162:163], v200 offset:1024
  v_exp_f32 v211, v85
  v_mfma_f32_16x16x32_bf16 v[120:123], a[168:171], v[172:175], v[120:123]
  v_mfma_f32_16x16x32_bf16 v[124:127], a[172:175], v[172:175], v[124:127]
  ds_read_b64_tr_b16 a[164:165], v201 offset:0
  ds_read_b64_tr_b16 a[166:167], v201 offset:1024
  s_add_u32 m0, s41, 65536
  s_nop 0
  buffer_load_dwordx4 v244, s[16:19], s34 offen offset:0 lds
  v_mfma_f32_16x16x32_bf16 v[116:119], a[172:175], v[168:171], v[116:119]
  s_waitcnt lgkmcnt(6)
  v_mfma_f32_16x16x32_bf16 v[112:115], a[176:179], v[176:179], v[112:115]
  ds_read_b64_tr_b16 a[168:169], v202 offset:0
  ds_read_b64_tr_b16 a[170:171], v202 offset:1024
  v_add_f32 v214, v214, v209
  v_exp_f32 v212, v86
  v_mfma_f32_16x16x32_bf16 v[120:123], a[176:179], v[180:183], v[120:123]
  v_mfma_f32_16x16x32_bf16 v[124:127], a[180:183], v[180:183], v[124:127]
  ds_read_b64_tr_b16 a[172:173], v203 offset:0
  ds_read_b64_tr_b16 a[174:175], v203 offset:1024
  v_add_f32 v214, v214, v210
  v_cvt_pk_bf16_f32 v138, v210, v211
  v_mfma_f32_16x16x32_bf16 v[116:119], a[180:183], v[176:179], v[116:119]
  s_waitcnt lgkmcnt(8)
  v_mfma_f32_16x16x32_bf16 v[112:115], a[184:187], v[184:187], v[112:115]
  ds_read_b64_tr_b16 a[176:177], v204 offset:0
  ds_read_b64_tr_b16 a[178:179], v204 offset:1024
  buffer_load_dwordx4 v245, s[16:19], s34 offen offset:1024 lds
  v_mfma_f32_16x16x32_bf16 v[120:123], a[184:187], v[188:191], v[120:123]
  v_mfma_f32_16x16x32_bf16 v[124:127], a[188:191], v[188:191], v[124:127]
  ds_read_b64_tr_b16 a[180:181], v205 offset:0
  ds_read_b64_tr_b16 a[182:183], v205 offset:1024
  v_exp_f32 v213, v87
  v_add_f32 v214, v214, v211
  v_mfma_f32_16x16x32_bf16 v[116:119], a[188:191], v[184:187], v[116:119]
  s_waitcnt lgkmcnt(8)
  v_mfma_f32_16x16x32_bf16 v[0:3], a[160:163], a[80:83], v[0:3]
  ds_read_b64_tr_b16 a[184:185], v206 offset:0
  ds_read_b64_tr_b16 a[186:187], v206 offset:1024
  v_exp_f32 v208, v88
  v_add_f32 v214, v214, v212
  v_cvt_pk_bf16_f32 v139, v212, v213
  v_mfma_f32_16x16x32_bf16 v[8:11], a[160:163], a[84:87], v[8:11]
  v_mfma_f32_16x16x32_bf16 v[12:15], a[164:167], a[84:87], v[12:15]
  ds_read_b64_tr_b16 a[188:189], v207 offset:0
  ds_read_b64_tr_b16 a[190:191], v207 offset:1024
  buffer_load_dwordx4 v246, s[16:19], s34 offen offset:2048 lds
  v_mfma_f32_16x16x32_bf16 v[4:7], a[164:167], a[80:83], v[4:7]
  s_waitcnt lgkmcnt(8)
  v_mfma_f32_16x16x32_bf16 v[16:19], a[168:171], a[80:83], v[16:19]
  ds_read_b64_tr_b16 a[160:161], v200 offset:8192
  ds_read_b64_tr_b16 a[162:163], v200 offset:9216
  v_exp_f32 v209, v89
  v_add_f32 v214, v214, v213
  v_mfma_f32_16x16x32_bf16 v[24:27], a[168:171], a[84:87], v[24:27]
  v_mfma_f32_16x16x32_bf16 v[28:31], a[172:175], a[84:87], v[28:31]
  ds_read_b64_tr_b16 a[164:165], v201 offset:8192
  ds_read_b64_tr_b16 a[166:167], v201 offset:9216
  v_exp_f32 v210, v90
  v_add_f32 v215, v215, v208
  v_cvt_pk_bf16_f32 v140, v208, v209
  v_mfma_f32_16x16x32_bf16 v[20:23], a[172:175], a[80:83], v[20:23]
  s_waitcnt lgkmcnt(8)
  v_mfma_f32_16x16x32_bf16 v[32:35], a[176:179], a[80:83], v[32:35]
  ds_read_b64_tr_b16 a[168:169], v202 offset:8192
  ds_read_b64_tr_b16 a[170:171], v202 offset:9216
  buffer_load_dwordx4 v247, s[16:19], s34 offen offset:3072 lds
  s_add_u32 s34, s34, 524288
  s_sub_u32 s38, s34, 5242880
  s_min_u32 s34, s34, s38
  v_mfma_f32_16x16x32_bf16 v[40:43], a[176:179], a[84:87], v[40:43]
  v_mfma_f32_16x16x32_bf16 v[44:47], a[180:183], a[84:87], v[44:47]
  ds_read_b64_tr_b16 a[172:173], v203 offset:8192
  ds_read_b64_tr_b16 a[174:175], v203 offset:9216
  v_exp_f32 v211, v91
  v_add_f32 v215, v215, v209
  v_mfma_f32_16x16x32_bf16 v[36:39], a[180:183], a[80:83], v[36:39]
  s_waitcnt lgkmcnt(8)
  v_mfma_f32_16x16x32_bf16 v[48:51], a[184:187], a[80:83], v[48:51]
  ds_read_b64_tr_b16 a[176:177], v204 offset:8192
  ds_read_b64_tr_b16 a[178:179], v204 offset:9216
  v_exp_f32 v212, v92
  v_add_f32 v215, v215, v210
  v_cvt_pk_bf16_f32 v141, v210, v211
  v_mfma_f32_16x16x32_bf16 v[56:59], a[184:187], a[84:87], v[56:59]
  v_mfma_f32_16x16x32_bf16 v[60:63], a[188:191], a[84:87], v[60:63]
  ds_read_b64_tr_b16 a[180:181], v205 offset:8192
  ds_read_b64_tr_b16 a[182:183], v205 offset:9216
  v_exp_f32 v213, v93
  v_add_f32 v215, v215, v211
  v_mfma_f32_16x16x32_bf16 v[52:55], a[188:191], a[80:83], v[52:55]
  s_waitcnt lgkmcnt(8)
  v_mfma_f32_16x16x32_bf16 v[0:3], a[160:163], a[88:91], v[0:3]
  ds_read_b64_tr_b16 a[184:185], v206 offset:8192
  ds_read_b64_tr_b16 a[186:187], v206 offset:9216
  v_exp_f32 v208, v94
  v_add_f32 v215, v215, v212
  v_mfma_f32_16x16x32_bf16 v[8:11], a[160:163], a[92:95], v[8:11]
  v_mfma_f32_16x16x32_bf16 v[12:15], a[164:167], a[92:95], v[12:15]
  ds_read_b64_tr_b16 a[188:189], v207 offset:8192
  ds_read_b64_tr_b16 a[190:191], v207 offset:9216
  v_cvt_pk_bf16_f32 v142, v212, v213
  v_exp_f32 v209, v95
  v_add_f32 v215, v215, v213
  v_mfma_f32_16x16x32_bf16 v[4:7], a[164:167], a[88:91], v[4:7]
  s_waitcnt lgkmcnt(8)
  v_mfma_f32_16x16x32_bf16 v[16:19], a[168:171], a[88:91], v[16:19]
  s_waitcnt vmcnt(20)
  s_barrier
  ds_read_b64_tr_b16 a[160:161], v200 offset:16384
  ds_read_b64_tr_b16 a[162:163], v200 offset:17408
  v_add_f32 v215, v215, v208
  v_mfma_f32_16x16x32_bf16 v[24:27], a[168:171], a[92:95], v[24:27]
  v_mfma_f32_16x16x32_bf16 v[28:31], a[172:175], a[92:95], v[28:31]
  ds_read_b64_tr_b16 a[164:165], v201 offset:16384
  ds_read_b64_tr_b16 a[166:167], v201 offset:17408
  s_add_u32 m0, s41, 49152
  s_nop 0
  buffer_load_dwordx4 v240, s[8:11], s32 offen offset:0 nt lds
  v_mfma_f32_16x16x32_bf16 v[20:23], a[172:175], a[88:91], v[20:23]
  s_waitcnt lgkmcnt(8)
  v_mfma_f32_16x16x32_bf16 v[32:35], a[176:179], a[88:91], v[32:35]
  ds_read_b64_tr_b16 a[168:169], v202 offset:16384
  ds_read_b64_tr_b16 a[170:171], v202 offset:17408
  v_cvt_pk_bf16_f32 v143, v208, v209
  v_add_f32 v215, v215, v209
  v_add_f32 v210, v214, v215
  v_cmp_lt_f32 vcc, s35, v210
  v_mfma_f32_16x16x32_bf16 v[40:43], a[176:179], a[92:95], v[40:43]
  v_mfma_f32_16x16x32_bf16 v[44:47], a[180:183], a[92:95], v[44:47]
  ds_read_b64_tr_b16 a[172:173], v203 offset:16384
  ds_read_b64_tr_b16 a[174:175], v203 offset:17408
  v_mfma_f32_16x16x32_bf16 v[36:39], a[180:183], a[88:91], v[36:39]
  s_waitcnt lgkmcnt(8)
  v_mfma_f32_16x16x32_bf16 v[48:51], a[184:187], a[88:91], v[48:51]
  ds_read_b64_tr_b16 a[176:177], v204 offset:16384
  ds_read_b64_tr_b16 a[178:179], v204 offset:17408
  buffer_load_dwordx4 v241, s[8:11], s32 offen offset:1024 nt lds
  v_mfma_f32_16x16x32_bf16 v[56:59], a[184:187], a[92:95], v[56:59]
  v_mfma_f32_16x16x32_bf16 v[60:63], a[188:191], a[92:95], v[60:63]
  ds_read_b64_tr_b16 a[180:181], v205 offset:16384
  ds_read_b64_tr_b16 a[182:183], v205 offset:17408
  v_mfma_f32_16x16x32_bf16 v[52:55], a[188:191], a[88:91], v[52:55]
  s_cbranch_vccnz SITE22
BACK22:
  s_waitcnt lgkmcnt(8)
  v_mfma_f32_16x16x32_bf16 a[192:195], a[160:163], v[128:131], a[192:195]
  ds_read_b64_tr_b16 a[184:185], v206 offset:16384
  ds_read_b64_tr_b16 a[186:187], v206 offset:17408
  v_add_f32 v249, v249, v214
  v_add_f32 v254, v254, v215
  v_exp_f32 v208, v96
  v_exp_f32 v209, v97
  v_mfma_f32_16x16x32_bf16 a[200:203], a[160:163], v[132:135], a[200:203]
  v_mfma_f32_16x16x32_bf16 a[204:207], a[164:167], v[132:135], a[204:207]
  ds_read_b64_tr_b16 a[188:189], v207 offset:16384
  ds_read_b64_tr_b16 a[190:191], v207 offset:17408
  buffer_load_dwordx4 v242, s[8:11], s32 offen offset:2048 nt lds
  v_mfma_f32_16x16x32_bf16 a[196:199], a[164:167], v[128:131], a[196:199]
  s_waitcnt lgkmcnt(8)
  v_mfma_f32_16x16x32_bf16 a[208:211], a[168:171], v[128:131], a[208:211]
  ds_read_b64_tr_b16 a[160:161], v200 offset:24576
  ds_read_b64_tr_b16 a[162:163], v200 offset:25600
  v_exp_f32 v210, v98
  v_cvt_pk_bf16_f32 v144, v208, v209
  v_mfma_f32_16x16x32_bf16 a[216:219], a[168:171], v[132:135], a[216:219]
  v_mfma_f32_16x16x32_bf16 a[220:223], a[172:175], v[132:135], a[220:223]
  ds_read_b64_tr_b16 a[164:165], v201 offset:24576
  ds_read_b64_tr_b16 a[166:167], v201 offset:25600
  v_exp_f32 v211, v99
  v_add_f32 v214, v208, v209
  v_mfma_f32_16x16x32_bf16 a[212:215], a[172:175], v[128:131], a[212:215]
  s_waitcnt lgkmcnt(8)
  v_mfma_f32_16x16x32_bf16 a[224:227], a[176:179], v[128:131], a[224:227]
  ds_read_b64_tr_b16 a[168:169], v202 offset:24576
  ds_read_b64_tr_b16 a[170:171], v202 offset:25600
  buffer_load_dwordx4 v243, s[8:11], s32 offen offset:3072 nt lds
  s_add_u32 s32, s32, 0x4000
  v_exp_f32 v212, v100
  v_mfma_f32_16x16x32_bf16 a[232:235], a[176:179], v[132:135], a[232:235]
  v_mfma_f32_16x16x32_bf16 a[236:239], a[180:183], v[132:135], a[236:239]
  ds_read_b64_tr_b16 a[172:173], v203 offset:24576
  ds_read_b64_tr_b16 a[174:175], v203 offset:25600
  v_add_f32 v214, v214, v210
  v_cvt_pk_bf16_f32 v145, v210, v211
  v_mfma_f32_16x16x32_bf16 a[228:231], a[180:183], v[128:131], a[228:231]
  s_waitcnt lgkmcnt(8)
  v_mfma_f32_16x16x32_bf16 a[240:243], a[184:187], v[128:131], a[240:243]
  ds_read_b64_tr_b16 a[176:177], v204 offset:24576
  ds_read_b64_tr_b16 a[178:179], v204 offset:25600
  v_exp_f32 v213, v101
  v_add_f32 v214, v214, v211
  v_mfma_f32_16x16x32_bf16 a[248:251], a[184:187], v[132:135], a[248:251]
  v_mfma_f32_16x16x32_bf16 a[252:255], a[188:191], v[132:135], a[252:255]
  ds_read_b64_tr_b16 a[180:181], v205 offset:24576
  ds_read_b64_tr_b16 a[182:183], v205 offset:25600
  v_exp_f32 v208, v102
  v_add_f32 v214, v214, v212
  v_cvt_pk_bf16_f32 v146, v212, v213
  v_mfma_f32_16x16x32_bf16 a[244:247], a[188:191], v[128:131], a[244:247]
  s_waitcnt lgkmcnt(8)
  v_mfma_f32_16x16x32_bf16 a[192:195], a[160:163], v[136:139], a[192:195]
  ds_read_b64_tr_b16 a[184:185], v206 offset:24576
  ds_read_b64_tr_b16 a[186:187], v206 offset:25600
  v_exp_f32 v209, v103
  v_add_f32 v214, v214, v213
  v_mfma_f32_16x16x32_bf16 a[200:203], a[160:163], v[140:143], a[200:203]
  v_mfma_f32_16x16x32_bf16 a[204:207], a[164:167], v[140:143], a[204:207]
  ds_read_b64_tr_b16 a[188:189], v207 offset:24576
  ds_read_b64_tr_b16 a[190:191], v207 offset:25600
  v_exp_f32 v210, v104
  v_add_f32 v214, v214, v208
  v_mfma_f32_16x16x32_bf16 a[196:199], a[164:167], v[136:139], a[196:199]
  s_waitcnt lgkmcnt(8)
  v_mfma_f32_16x16x32_bf16 a[208:211], a[168:171], v[136:139], a[208:211]
  s_barrier
  ds_read_b128 a[160:163], v224 offset:0
  v_cvt_pk_bf16_f32 v147, v208, v209
  v_exp_f32 v211, v105
  v_add_f32 v214, v214, v209
  v_mfma_f32_16x16x32_bf16 a[216:219], a[168:171], v[140:143], a[216:219]
  v_mfma_f32_16x16x32_bf16 a[220:223], a[172:175], v[140:143], a[220:223]
  ds_read_b128 a[164:167], v224 offset:4096
  s_add_u32 m0, s41, 131072
  s_nop 0
  buffer_load_dwordx4 v248, s[12:15], s33 offen offset:0 nt lds
  v_mfma_f32_16x16x32_bf16 a[212:215], a[172:175], v[136:139], a[212:215]
  s_waitcnt lgkmcnt(6)
  v_mfma_f32_16x16x32_bf16 a[224:227], a[176:179], v[136:139], a[224:227]
  ds_read_b128 a[168:171], v225 offset:0
  v_exp_f32 v212, v106
  v_cvt_pk_bf16_f32 v148, v210, v211
  v_exp_f32 v213, v107
  v_mfma_f32_16x16x32_bf16 a[232:235], a[176:179], v[140:143], a[232:235]
  v_mfma_f32_16x16x32_bf16 a[236:239], a[180:183], v[140:143], a[236:239]
  ds_read_b128 a[172:175], v225 offset:4096
  v_add_f32 v215, v210, v211
  v_exp_f32 v208, v108
  v_add_f32 v215, v215, v212
  v_mfma_f32_16x16x32_bf16 a[228:231], a[180:183], v[136:139], a[228:231]
  s_waitcnt lgkmcnt(4)
  v_mfma_f32_16x16x32_bf16 a[240:243], a[184:187], v[136:139], a[240:243]
  ds_read_b128 a[176:179], v226 offset:0
  buffer_load_dwordx4 v248, s[12:15], s33 offen offset:1024 nt lds
  v_cvt_pk_bf16_f32 v149, v212, v213
  v_mfma_f32_16x16x32_bf16 a[248:251], a[184:187], v[140:143], a[248:251]
  v_mfma_f32_16x16x32_bf16 a[252:255], a[188:191], v[140:143], a[252:255]
  ds_read_b128 a[180:183], v226 offset:4096
  v_exp_f32 v209, v109
  v_add_f32 v215, v215, v213
  v_mfma_f32_16x16x32_bf16 a[244:247], a[188:191], v[136:139], a[244:247]
  s_waitcnt lgkmcnt(4)
  v_mfma_f32_16x16x32_bf16 v[64:67], a[160:163], v[160:163], v[192:195]
  ds_read_b128 a[184:187], v227 offset:0
  v_exp_f32 v210, v110
  v_add_f32 v215, v215, v208
  v_cvt_pk_bf16_f32 v150, v208, v209
  v_exp_f32 v211, v111
  v_mfma_f32_16x16x32_bf16 v[72:75], a[160:163], v[164:167], v[196:199]
  v_mfma_f32_16x16x32_bf16 v[76:79], a[164:167], v[164:167], v[196:199]
  ds_read_b128 a[188:191], v227 offset:4096
  buffer_load_dwordx4 v248, s[12:15], s33 offen offset:2048 nt lds
  v_mfma_f32_16x16x32_bf16 v[68:71], a[164:167], v[160:163], v[192:195]
  s_waitcnt lgkmcnt(4)
  v_mfma_f32_16x16x32_bf16 v[64:67], a[168:171], v[168:171], v[64:67]
  ds_read_b128 a[160:163], v224 offset:2048
  v_add_f32 v215, v215, v209
  v_exp_f32 v212, v112
  v_add_f32 v215, v215, v210
  v_mfma_f32_16x16x32_bf16 v[72:75], a[168:171], v[172:175], v[72:75]
  v_mfma_f32_16x16x32_bf16 v[76:79], a[172:175], v[172:175], v[76:79]
  ds_read_b128 a[164:167], v224 offset:6144
  v_cvt_pk_bf16_f32 v151, v210, v211
  v_exp_f32 v213, v113
  v_add_f32 v215, v215, v211
  v_mfma_f32_16x16x32_bf16 v[68:71], a[172:175], v[168:171], v[68:71]
  s_waitcnt lgkmcnt(4)
  v_mfma_f32_16x16x32_bf16 v[64:67], a[176:179], v[176:179], v[64:67]
  ds_read_b128 a[168:171], v225 offset:2048
  buffer_load_dwordx4 v248, s[12:15], s33 offen offset:3072 nt lds
  s_add_u32 s33, s33, 0x4000
  v_exp_f32 v208, v114
  v_mfma_f32_16x16x32_bf16 v[72:75], a[176:179], v[180:183], v[72:75]
  v_mfma_f32_16x16x32_bf16 v[76:79], a[180:183], v[180:183], v[76:79]
  ds_read_b128 a[172:175], v225 offset:6144
  v_add_f32 v214, v214, v212
  v_cvt_pk_bf16_f32 v152, v212, v213
  v_exp_f32 v209, v115
  v_mfma_f32_16x16x32_bf16 v[68:71], a[180:183], v[176:179], v[68:71]
  s_waitcnt lgkmcnt(4)
  v_mfma_f32_16x16x32_bf16 v[64:67], a[184:187], v[184:187], v[64:67]
  ds_read_b128 a[176:179], v226 offset:2048
  v_add_f32 v214, v214, v213
  v_exp_f32 v210, v116
  v_add_f32 v214, v214, v208
  v_mfma_f32_16x16x32_bf16 v[72:75], a[184:187], v[188:191], v[72:75]
  v_mfma_f32_16x16x32_bf16 v[76:79], a[188:191], v[188:191], v[76:79]
  ds_read_b128 a[180:183], v226 offset:6144
  v_cvt_pk_bf16_f32 v153, v208, v209
  v_exp_f32 v211, v117
  v_add_f32 v214, v214, v209
  v_mfma_f32_16x16x32_bf16 v[68:71], a[188:191], v[184:187], v[68:71]
  s_waitcnt lgkmcnt(4)
  v_mfma_f32_16x16x32_bf16 v[80:83], a[160:163], v[160:163], v[192:195]
  ds_read_b128 a[184:187], v227 offset:2048
  v_exp_f32 v212, v118
  v_add_f32 v214, v214, v210
  v_cvt_pk_bf16_f32 v154, v210, v211
  v_mfma_f32_16x16x32_bf16 v[88:91], a[160:163], v[164:167], v[196:199]
  v_mfma_f32_16x16x32_bf16 v[92:95], a[164:167], v[164:167], v[196:199]
  ds_read_b128 a[188:191], v227 offset:6144
  v_exp_f32 v213, v119
  v_add_f32 v214, v214, v211
  v_exp_f32 v208, v120
  v_mfma_f32_16x16x32_bf16 v[84:87], a[164:167], v[160:163], v[192:195]
  s_waitcnt lgkmcnt(4)
  v_mfma_f32_16x16x32_bf16 v[80:83], a[168:171], v[168:171], v[80:83]
  s_waitcnt vmcnt(24)
  s_barrier
  ds_read_b64_tr_b16 a[160:161], v232 offset:16384
  ds_read_b64_tr_b16 a[162:163], v232 offset:17408
  v_add_f32 v214, v214, v212
  v_mfma_f32_16x16x32_bf16 v[88:91], a[168:171], v[172:175], v[88:91]
  v_mfma_f32_16x16x32_bf16 v[92:95], a[172:175], v[172:175], v[92:95]
  ds_read_b64_tr_b16 a[164:165], v233 offset:16384
  ds_read_b64_tr_b16 a[166:167], v233 offset:17408
  s_add_u32 m0, s41, 147456
  s_nop 0
  buffer_load_dwordx4 v244, s[16:19], s34 offen offset:0 lds
  v_mfma_f32_16x16x32_bf16 v[84:87], a[172:175], v[168:171], v[84:87]
  s_waitcnt lgkmcnt(6)
  v_mfma_f32_16x16x32_bf16 v[80:83], a[176:179], v[176:179], v[80:83]
  ds_read_b64_tr_b16 a[168:169], v234 offset:16384
  ds_read_b64_tr_b16 a[170:171], v234 offset:17408
  v_cvt_pk_bf16_f32 v155, v212, v213
  v_exp_f32 v209, v121
  v_add_f32 v214, v214, v213
  v_mfma_f32_16x16x32_bf16 v[88:91], a[176:179], v[180:183], v[88:91]
  v_mfma_f32_16x16x32_bf16 v[92:95], a[180:183], v[180:183], v[92:95]
  ds_read_b64_tr_b16 a[172:173], v235 offset:16384
  ds_read_b64_tr_b16 a[174:175], v235 offset:17408
  v_exp_f32 v210, v122
  v_add_f32 v215, v215, v208
  v_mfma_f32_16x16x32_bf16 v[84:87], a[180:183], v[176:179], v[84:87]
  s_waitcnt lgkmcnt(8)
  v_mfma_f32_16x16x32_bf16 v[80:83], a[184:187], v[184:187], v[80:83]
  ds_read_b64_tr_b16 a[176:177], v236 offset:16384
  ds_read_b64_tr_b16 a[178:179], v236 offset:17408
  buffer_load_dwordx4 v245, s[16:19], s34 offen offset:1024 lds
  v_cvt_pk_bf16_f32 v156, v208, v209
  v_mfma_f32_16x16x32_bf16 v[88:91], a[184:187], v[188:191], v[88:91]
  v_mfma_f32_16x16x32_bf16 v[92:95], a[188:191], v[188:191], v[92:95]
  ds_read_b64_tr_b16 a[180:181], v237 offset:16384
  ds_read_b64_tr_b16 a[182:183], v237 offset:17408
  v_exp_f32 v211, v123
  v_add_f32 v215, v215, v209
  v_mfma_f32_16x16x32_bf16 v[84:87], a[188:191], v[184:187], v[84:87]
  s_waitcnt lgkmcnt(8)
  v_mfma_f32_16x16x32_bf16 v[0:3], a[160:163], a[96:99], v[0:3]
  ds_read_b64_tr_b16 a[184:185], v238 offset:16384
  ds_read_b64_tr_b16 a[186:187], v238 offset:17408
  v_exp_f32 v212, v124
  v_add_f32 v215, v215, v210
  v_mfma_f32_16x16x32_bf16 v[8:11], a[160:163], a[100:103], v[8:11]
  v_mfma_f32_16x16x32_bf16 v[12:15], a[164:167], a[100:103], v[12:15]
  ds_read_b64_tr_b16 a[188:189], v239 offset:16384
  ds_read_b64_tr_b16 a[190:191], v239 offset:17408
  buffer_load_dwordx4 v246, s[16:19], s34 offen offset:2048 lds
  v_cvt_pk_bf16_f32 v157, v210, v211
  v_mfma_f32_16x16x32_bf16 v[4:7], a[164:167], a[96:99], v[4:7]
  s_waitcnt lgkmcnt(8)
  v_mfma_f32_16x16x32_bf16 v[16:19], a[168:171], a[96:99], v[16:19]
  ds_read_b64_tr_b16 a[160:161], v232 offset:24576
  ds_read_b64_tr_b16 a[162:163], v232 offset:25600
  v_exp_f32 v213, v125
  v_add_f32 v215, v215, v211
  v_mfma_f32_16x16x32_bf16 v[24:27], a[168:171], a[100:103], v[24:27]
  v_mfma_f32_16x16x32_bf16 v[28:31], a[172:175], a[100:103], v[28:31]
  ds_read_b64_tr_b16 a[164:165], v233 offset:24576
  ds_read_b64_tr_b16 a[166:167], v233 offset:25600
  v_exp_f32 v208, v126
  v_add_f32 v215, v215, v212
  v_mfma_f32_16x16x32_bf16 v[20:23], a[172:175], a[96:99], v[20:23]
  s_waitcnt lgkmcnt(8)
  v_mfma_f32_16x16x32_bf16 v[32:35], a[176:179], a[96:99], v[32:35]
  ds_read_b64_tr_b16 a[168:169], v234 offset:24576
  ds_read_b64_tr_b16 a[170:171], v234 offset:25600
  buffer_load_dwordx4 v247, s[16:19], s34 offen offset:3072 lds
  s_add_u32 s34, s34, 524288
  s_sub_u32 s38, s34, 5242880
  s_min_u32 s34, s34, s38
  v_cvt_pk_bf16_f32 v158, v212, v213
  v_mfma_f32_16x16x32_bf16 v[40:43], a[176:179], a[100:103], v[40:43]
  v_mfma_f32_16x16x32_bf16 v[44:47], a[180:183], a[100:103], v[44:47]
  ds_read_b64_tr_b16 a[172:173], v235 offset:24576
  ds_read_b64_tr_b16 a[174:175], v235 offset:25600
  v_exp_f32 v209, v127
  v_add_f32 v215, v215, v213
  v_mfma_f32_16x16x32_bf16 v[36:39], a[180:183], a[96:99], v[36:39]
  s_waitcnt lgkmcnt(8)
  v_mfma_f32_16x16x32_bf16 v[48:51], a[184:187], a[96:99], v[48:51]
  ds_read_b64_tr_b16 a[176:177], v236 offset:24576
  ds_read_b64_tr_b16 a[178:179], v236 offset:25600
  v_add_f32 v215, v215, v208
  v_cvt_pk_bf16_f32 v159, v208, v209
  v_add_f32 v215, v215, v209
  v_add_f32 v210, v214, v215
  v_mfma_f32_16x16x32_bf16 v[56:59], a[184:187], a[100:103], v[56:59]
  v_mfma_f32_16x16x32_bf16 v[60:63], a[188:191], a[100:103], v[60:63]
  ds_read_b64_tr_b16 a[180:181], v237 offset:24576
  ds_read_b64_tr_b16 a[182:183], v237 offset:25600
  v_cmp_lt_f32 vcc, s35, v210
  v_mfma_f32_16x16x32_bf16 v[52:55], a[188:191], a[96:99], v[52:55]
  s_waitcnt lgkmcnt(8)
  v_mfma_f32_16x16x32_bf16 v[0:3], a[160:163], a[104:107], v[0:3]
  ds_read_b64_tr_b16 a[184:185], v238 offset:24576
  ds_read_b64_tr_b16 a[186:187], v238 offset:25600
  v_mfma_f32_16x16x32_bf16 v[8:11], a[160:163], a[108:111], v[8:11]
  v_mfma_f32_16x16x32_bf16 v[12:15], a[164:167], a[108:111], v[12:15]
  ds_read_b64_tr_b16 a[188:189], v239 offset:24576
  ds_read_b64_tr_b16 a[190:191], v239 offset:25600
  v_mfma_f32_16x16x32_bf16 v[4:7], a[164:167], a[104:107], v[4:7]
  s_waitcnt lgkmcnt(8)
  v_mfma_f32_16x16x32_bf16 v[16:19], a[168:171], a[104:107], v[16:19]
  s_waitcnt vmcnt(24)
  s_barrier
  ds_read_b64_tr_b16 a[160:161], v232 offset:32768
  ds_read_b64_tr_b16 a[162:163], v232 offset:33792
  v_mfma_f32_16x16x32_bf16 v[24:27], a[168:171], a[108:111], v[24:27]
  v_mfma_f32_16x16x32_bf16 v[28:31], a[172:175], a[108:111], v[28:31]
  ds_read_b64_tr_b16 a[164:165], v233 offset:32768
  ds_read_b64_tr_b16 a[166:167], v233 offset:33792
  s_add_u32 m0, s41, 0
  s_nop 0
  buffer_load_dwordx4 v240, s[8:11], s32 offen offset:0 nt lds
  v_mfma_f32_16x16x32_bf16 v[20:23], a[172:175], a[104:107], v[20:23]
  s_waitcnt lgkmcnt(8)
  v_mfma_f32_16x16x32_bf16 v[32:35], a[176:179], a[104:107], v[32:35]
  ds_read_b64_tr_b16 a[168:169], v234 offset:32768
  ds_read_b64_tr_b16 a[170:171], v234 offset:33792
  v_mfma_f32_16x16x32_bf16 v[40:43], a[176:179], a[108:111], v[40:43]
  v_mfma_f32_16x16x32_bf16 v[44:47], a[180:183], a[108:111], v[44:47]
  ds_read_b64_tr_b16 a[172:173], v235 offset:32768
  ds_read_b64_tr_b16 a[174:175], v235 offset:33792
  v_mfma_f32_16x16x32_bf16 v[36:39], a[180:183], a[104:107], v[36:39]
  s_waitcnt lgkmcnt(8)
  v_mfma_f32_16x16x32_bf16 v[48:51], a[184:187], a[104:107], v[48:51]
  ds_read_b64_tr_b16 a[176:177], v236 offset:32768
  ds_read_b64_tr_b16 a[178:179], v236 offset:33792
  buffer_load_dwordx4 v241, s[8:11], s32 offen offset:1024 nt lds
  v_mfma_f32_16x16x32_bf16 v[56:59], a[184:187], a[108:111], v[56:59]
  v_mfma_f32_16x16x32_bf16 v[60:63], a[188:191], a[108:111], v[60:63]
  ds_read_b64_tr_b16 a[180:181], v237 offset:32768
  ds_read_b64_tr_b16 a[182:183], v237 offset:33792
  v_mfma_f32_16x16x32_bf16 v[52:55], a[188:191], a[104:107], v[52:55]
  s_cbranch_vccnz SITE25
BACK25:
  s_waitcnt lgkmcnt(8)
  v_mfma_f32_16x16x32_bf16 a[192:195], a[160:163], v[144:147], a[192:195]
  ds_read_b64_tr_b16 a[184:185], v238 offset:32768
  ds_read_b64_tr_b16 a[186:187], v238 offset:33792
  v_add_f32 v249, v249, v214
  v_add_f32 v254, v254, v215
  v_exp_f32 v208, v64
  v_exp_f32 v209, v65
  v_mfma_f32_16x16x32_bf16 a[200:203], a[160:163], v[148:151], a[200:203]
  v_mfma_f32_16x16x32_bf16 a[204:207], a[164:167], v[148:151], a[204:207]
  ds_read_b64_tr_b16 a[188:189], v239 offset:32768
  ds_read_b64_tr_b16 a[190:191], v239 offset:33792
  buffer_load_dwordx4 v242, s[8:11], s32 offen offset:2048 nt lds
  v_mfma_f32_16x16x32_bf16 a[196:199], a[164:167], v[144:147], a[196:199]
  s_waitcnt lgkmcnt(8)
  v_mfma_f32_16x16x32_bf16 a[208:211], a[168:171], v[144:147], a[208:211]
  ds_read_b64_tr_b16 a[160:161], v232 offset:40960
  ds_read_b64_tr_b16 a[162:163], v232 offset:41984
  v_exp_f32 v210, v66
  v_cvt_pk_bf16_f32 v128, v208, v209
  v_exp_f32 v211, v67
  v_mfma_f32_16x16x32_bf16 a[216:219], a[168:171], v[148:151], a[216:219]
  v_mfma_f32_16x16x32_bf16 a[220:223], a[172:175], v[148:151], a[220:223]
  ds_read_b64_tr_b16 a[164:165], v233 offset:40960
  ds_read_b64_tr_b16 a[166:167], v233 offset:41984
  v_add_f32 v214, v208, v209
  v_exp_f32 v212, v68
  v_add_f32 v214, v214, v210
  v_mfma_f32_16x16x32_bf16 a[212:215], a[172:175], v[144:147], a[212:215]
  s_waitcnt lgkmcnt(8)
  v_mfma_f32_16x16x32_bf16 a[224:227], a[176:179], v[144:147], a[224:227]
  ds_read_b64_tr_b16 a[168:169], v234 offset:40960
  ds_read_b64_tr_b16 a[170:171], v234 offset:41984
  buffer_load_dwordx4 v243, s[8:11], s32 offen offset:3072 nt lds
  s_add_u32 s32, s32, 0x4000
  v_cvt_pk_bf16_f32 v129, v210, v211
  v_mfma_f32_16x16x32_bf16 a[232:235], a[176:179], v[148:151], a[232:235]
  v_mfma_f32_16x16x32_bf16 a[236:239], a[180:183], v[148:151], a[236:239]
  ds_read_b64_tr_b16 a[172:173], v235 offset:40960
  ds_read_b64_tr_b16 a[174:175], v235 offset:41984
  v_exp_f32 v213, v69
  v_add_f32 v214, v214, v211
  v_mfma_f32_16x16x32_bf16 a[228:231], a[180:183], v[144:147], a[228:231]
  s_waitcnt lgkmcnt(8)
  v_mfma_f32_16x16x32_bf16 a[240:243], a[184:187], v[144:147], a[240:243]
  ds_read_b64_tr_b16 a[176:177], v236 offset:40960
  ds_read_b64_tr_b16 a[178:179], v236 offset:41984
  v_exp_f32 v208, v70
  v_add_f32 v214, v214, v212
  v_cvt_pk_bf16_f32 v130, v212, v213
  v_mfma_f32_16x16x32_bf16 a[248:251], a[184:187], v[148:151], a[248:251]
  v_mfma_f32_16x16x32_bf16 a[252:255], a[188:191], v[148:151], a[252:255]
  ds_read_b64_tr_b16 a[180:181], v237 offset:40960
  ds_read_b64_tr_b16 a[182:183], v237 offset:41984
  v_exp_f32 v209, v71
  v_add_f32 v214, v214, v213
  v_exp_f32 v210, v72
  v_mfma_f32_16x16x32_bf16 a[244:247], a[188:191], v[144:147], a[244:247]
  s_waitcnt lgkmcnt(8)
  v_mfma_f32_16x16x32_bf16 a[192:195], a[160:163], v[152:155], a[192:195]
  ds_read_b64_tr_b16 a[184:185], v238 offset:40960
  ds_read_b64_tr_b16 a[186:187], v238 offset:41984
  v_add_f32 v214, v214, v208
  v_cvt_pk_bf16_f32 v131, v208, v209
  v_exp_f32 v211, v73
  v_mfma_f32_16x16x32_bf16 a[200:203], a[160:163], v[156:159], a[200:203]
  v_mfma_f32_16x16x32_bf16 a[204:207], a[164:167], v[156:159], a[204:207]
  ds_read_b64_tr_b16 a[188:189], v239 offset:40960
  ds_read_b64_tr_b16 a[190:191], v239 offset:41984
  v_add_f32 v214, v214, v209
  v_exp_f32 v212, v74
  v_mfma_f32_16x16x32_bf16 a[196:199], a[164:167], v[152:155], a[196:199]
  s_waitcnt lgkmcnt(8)
  v_mfma_f32_16x16x32_bf16 a[208:211], a[168:171], v[152:155], a[208:211]
  s_barrier
  ds_read_b128 a[160:163], v224 offset:16384
  v_cvt_pk_bf16_f32 v132, v210, v211
  v_exp_f32 v213, v75
  v_add_f32 v215, v210, v211
  v_mfma_f32_16x16x32_bf16 a[216:219], a[168:171], v[156:159], a[216:219]
  v_mfma_f32_16x16x32_bf16 a[220:223], a[172:175], v[156:159], a[220:223]
  ds_read_b128 a[164:167], v224 offset:20480
  s_add_u32 m0, s41, 81920
  s_nop 0
  buffer_load_dwordx4 v244, s[16:19], s34 offen offset:0 lds
  v_exp_f32 v208, v76
  v_mfma_f32_16x16x32_bf16 a[212:215], a[172:175], v[152:155], a[212:215]
  s_waitcnt lgkmcnt(6)
  v_mfma_f32_16x16x32_bf16 a[224:227], a[176:179], v[152:155], a[224:227]
  ds_read_b128 a[168:171], v225 offset:16384
  v_add_f32 v215, v215, v212
  v_cvt_pk_bf16_f32 v133, v212, v213
  v_exp_f32 v209, v77
  v_mfma_f32_16x16x32_bf16 a[232:235], a[176:179], v[156:159], a[232:235]
  v_mfma_f32_16x16x32_bf16 a[236:239], a[180:183], v[156:159], a[236:239]
  ds_read_b128 a[172:175], v225 offset:20480
  v_add_f32 v215, v215, v213
  v_exp_f32 v210, v78
  v_add_f32 v215, v215, v208
  v_cvt_pk_bf16_f32 v134, v208, v209
  v_mfma_f32_16x16x32_bf16 a[228:231], a[180:183], v[152:155], a[228:231]
  s_waitcnt lgkmcnt(4)
  v_mfma_f32_16x16x32_bf16 a[240:243], a[184:187], v[152:155], a[240:243]
  ds_read_b128 a[176:179], v226 offset:16384
  buffer_load_dwordx4 v245, s[16:19], s34 offen offset:1024 lds
  v_exp_f32 v211, v79
  v_mfma_f32_16x16x32_bf16 a[248:251], a[184:187], v[156:159], a[248:251]
  v_mfma_f32_16x16x32_bf16 a[252:255], a[188:191], v[156:159], a[252:255]
  ds_read_b128 a[180:183], v226 offset:20480
  v_add_f32 v215, v215, v209
  v_exp_f32 v212, v80
  v_add_f32 v215, v215, v210
  v_mfma_f32_16x16x32_bf16 a[244:247], a[188:191], v[152:155], a[244:247]
  s_waitcnt lgkmcnt(4)
  v_mfma_f32_16x16x32_bf16 v[96:99], a[160:163], v[160:163], v[192:195]
  ds_read_b128 a[184:187], v227 offset:16384
  v_cvt_pk_bf16_f32 v135, v210, v211
  v_exp_f32 v213, v81
  v_add_f32 v215, v215, v211
  v_exp_f32 v208, v82
  v_mfma_f32_16x16x32_bf16 v[104:107], a[160:163], v[164:167], v[196:199]
  v_mfma_f32_16x16x32_bf16 v[108:111], a[164:167], v[164:167], v[196:199]
  ds_read_b128 a[188:191], v227 offset:20480
  buffer_load_dwordx4 v246, s[16:19], s34 offen offset:2048 lds
  v_add_f32 v214, v214, v212
  v_mfma_f32_16x16x32_bf16 v[100:103], a[164:167], v[160:163], v[192:195]
  s_waitcnt lgkmcnt(4)
  v_mfma_f32_16x16x32_bf16 v[96:99], a[168:171], v[168:171], v[96:99]
  ds_read_b128 a[160:163], v224 offset:18432
  v_cvt_pk_bf16_f32 v136, v212, v213
  v_exp_f32 v209, v83
  v_add_f32 v214, v214, v213
  v_mfma_f32_16x16x32_bf16 v[104:107], a[168:171], v[172:175], v[104:107]
  v_mfma_f32_16x16x32_bf16 v[108:111], a[172:175], v[172:175], v[108:111]
  ds_read_b128 a[164:167], v224 offset:22528
  v_exp_f32 v210, v84
  v_add_f32 v214, v214, v208
  v_cvt_pk_bf16_f32 v137, v208, v209
  v_exp_f32 v211, v85
  v_mfma_f32_16x16x32_bf16 v[100:103], a[172:175], v[168:171], v[100:103]
  s_waitcnt lgkmcnt(4)
  v_mfma_f32_16x16x32_bf16 v[96:99], a[176:179], v[176:179], v[96:99]
  ds_read_b128 a[168:171], v225 offset:18432
  buffer_load_dwordx4 v247, s[16:19], s34 offen offset:3072 lds
  s_add_u32 s34, s34, 524544
  s_sub_u32 s38, s34, 5242880
  s_min_u32 s34, s34, s38
  v_add_f32 v214, v214, v209
  v_mfma_f32_16x16x32_bf16 v[104:107], a[176:179], v[180:183], v[104:107]
  v_mfma_f32_16x16x32_bf16 v[108:111], a[180:183], v[180:183], v[108:111]
  ds_read_b128 a[172:175], v225 offset:22528
  v_exp_f32 v212, v86
  v_add_f32 v214, v214, v210
  v_cvt_pk_bf16_f32 v138, v210, v211
  v_mfma_f32_16x16x32_bf16 v[100:103], a[180:183], v[176:179], v[100:103]
  s_waitcnt lgkmcnt(4)
  v_mfma_f32_16x16x32_bf16 v[96:99], a[184:187], v[184:187], v[96:99]
  ds_read_b128 a[176:179], v226 offset:18432
  v_exp_f32 v213, v87
  v_add_f32 v214, v214, v211
  v_exp_f32 v208, v88
  v_mfma_f32_16x16x32_bf16 v[104:107], a[184:187], v[188:191], v[104:107]
  v_mfma_f32_16x16x32_bf16 v[108:111], a[188:191], v[188:191], v[108:111]
  ds_read_b128 a[180:183], v226 offset:22528
  v_add_f32 v214, v214, v212
  v_cvt_pk_bf16_f32 v139, v212, v213
  v_exp_f32 v209, v89
  v_add_f32 v214, v214, v213
  v_mfma_f32_16x16x32_bf16 v[100:103], a[188:191], v[184:187], v[100:103]
  s_waitcnt lgkmcnt(4)
  v_mfma_f32_16x16x32_bf16 v[112:115], a[160:163], v[160:163], v[192:195]
  ds_read_b128 a[184:187], v227 offset:18432
  v_exp_f32 v210, v90
  v_add_f32 v215, v215, v208
  v_cvt_pk_bf16_f32 v140, v208, v209
  v_exp_f32 v211, v91
  v_mfma_f32_16x16x32_bf16 v[120:123], a[160:163], v[164:167], v[196:199]
  v_mfma_f32_16x16x32_bf16 v[124:127], a[164:167], v[164:167], v[196:199]
  ds_read_b128 a[188:191], v227 offset:22528
  v_add_f32 v215, v215, v209
  v_exp_f32 v212, v92
  v_add_f32 v215, v215, v210
  v_mfma_f32_16x16x32_bf16 v[116:119], a[164:167], v[160:163], v[192:195]
  s_waitcnt lgkmcnt(4)
  v_mfma_f32_16x16x32_bf16 v[112:115], a[168:171], v[168:171], v[112:115]
  s_waitcnt vmcnt(24)
  s_barrier
  ds_read_b64_tr_b16 a[160:161], v232 offset:49152
  ds_read_b64_tr_b16 a[162:163], v232 offset:50176
  v_cvt_pk_bf16_f32 v141, v210, v211
  v_mfma_f32_16x16x32_bf16 v[120:123], a[168:171], v[172:175], v[120:123]
  v_mfma_f32_16x16x32_bf16 v[124:127], a[172:175], v[172:175], v[124:127]
  ds_read_b64_tr_b16 a[164:165], v233 offset:49152
  ds_read_b64_tr_b16 a[166:167], v233 offset:50176
  s_add_u32 m0, s41, 98304
  s_nop 0
  buffer_load_dwordx4 v248, s[12:15], s33 offen offset:0 nt lds
  v_exp_f32 v213, v93
  v_mfma_f32_16x16x32_bf16 v[116:119], a[172:175], v[168:171], v[116:119]
  s_waitcnt lgkmcnt(6)
  v_mfma_f32_16x16x32_bf16 v[112:115], a[176:179], v[176:179], v[112:115]
  ds_read_b64_tr_b16 a[168:169], v234 offset:49152
  ds_read_b64_tr_b16 a[170:171], v234 offset:50176
  v_add_f32 v215, v215, v211
  v_exp_f32 v208, v94
  v_add_f32 v215, v215, v212
  v_mfma_f32_16x16x32_bf16 v[120:123], a[176:179], v[180:183], v[120:123]
  v_mfma_f32_16x16x32_bf16 v[124:127], a[180:183], v[180:183], v[124:127]
  ds_read_b64_tr_b16 a[172:173], v235 offset:49152
  ds_read_b64_tr_b16 a[174:175], v235 offset:50176
  v_cvt_pk_bf16_f32 v142, v212, v213
  v_exp_f32 v209, v95
  v_add_f32 v215, v215, v213
  v_mfma_f32_16x16x32_bf16 v[116:119], a[180:183], v[176:179], v[116:119]
  s_waitcnt lgkmcnt(8)
  v_mfma_f32_16x16x32_bf16 v[112:115], a[184:187], v[184:187], v[112:115]
  ds_read_b64_tr_b16 a[176:177], v236 offset:49152
  ds_read_b64_tr_b16 a[178:179], v236 offset:50176
  buffer_load_dwordx4 v248, s[12:15], s33 offen offset:1024 nt lds
  v_add_f32 v215, v215, v208
  v_mfma_f32_16x16x32_bf16 v[120:123], a[184:187], v[188:191], v[120:123]
  v_mfma_f32_16x16x32_bf16 v[124:127], a[188:191], v[188:191], v[124:127]
  ds_read_b64_tr_b16 a[180:181], v237 offset:49152
  ds_read_b64_tr_b16 a[182:183], v237 offset:50176
  v_cvt_pk_bf16_f32 v143, v208, v209
  v_add_f32 v215, v215, v209
  v_add_f32 v210, v214, v215
  v_cmp_lt_f32 vcc, s35, v210
  v_mfma_f32_16x16x32_bf16 v[116:119], a[188:191], v[184:187], v[116:119]
  s_cbranch_vccnz SITE27
BACK27:
  s_waitcnt lgkmcnt(8)
  v_mfma_f32_16x16x32_bf16 a[192:195], a[160:163], v[128:131], a[192:195]
  ds_read_b64_tr_b16 a[184:185], v238 offset:49152
  ds_read_b64_tr_b16 a[186:187], v238 offset:50176
  v_mfma_f32_16x16x32_bf16 a[200:203], a[160:163], v[132:135], a[200:203]
  v_mfma_f32_16x16x32_bf16 a[204:207], a[164:167], v[132:135], a[204:207]
  ds_read_b64_tr_b16 a[188:189], v239 offset:49152
  ds_read_b64_tr_b16 a[190:191], v239 offset:50176
  buffer_load_dwordx4 v248, s[12:15], s33 offen offset:2048 nt lds
  v_mfma_f32_16x16x32_bf16 a[196:199], a[164:167], v[128:131], a[196:199]
  s_waitcnt lgkmcnt(8)
  v_mfma_f32_16x16x32_bf16 a[208:211], a[168:171], v[128:131], a[208:211]
  ds_read_b64_tr_b16 a[160:161], v232 offset:57344
  ds_read_b64_tr_b16 a[162:163], v232 offset:58368
  v_add_f32 v249, v249, v214
  v_add_f32 v254, v254, v215
  v_exp_f32 v208, v96
  v_exp_f32 v209, v97
  v_mfma_f32_16x16x32_bf16 a[216:219], a[168:171], v[132:135], a[216:219]
  v_mfma_f32_16x16x32_bf16 a[220:223], a[172:175], v[132:135], a[220:223]
  ds_read_b64_tr_b16 a[164:165], v233 offset:57344
  ds_read_b64_tr_b16 a[166:167], v233 offset:58368
  v_exp_f32 v210, v98
  v_mfma_f32_16x16x32_bf16 a[212:215], a[172:175], v[128:131], a[212:215]
  s_waitcnt lgkmcnt(8)
  v_mfma_f32_16x16x32_bf16 a[224:227], a[176:179], v[128:131], a[224:227]
  ds_read_b64_tr_b16 a[168:169], v234 offset:57344
  ds_read_b64_tr_b16 a[170:171], v234 offset:58368
  buffer_load_dwordx4 v248, s[12:15], s33 offen offset:3072 nt lds
  s_add_u32 s33, s33, 0x4000
  v_cvt_pk_bf16_f32 v144, v208, v209
  v_mfma_f32_16x16x32_bf16 a[232:235], a[176:179], v[132:135], a[232:235]
  v_mfma_f32_16x16x32_bf16 a[236:239], a[180:183], v[132:135], a[236:239]
  ds_read_b64_tr_b16 a[172:173], v235 offset:57344
  ds_read_b64_tr_b16 a[174:175], v235 offset:58368
  v_exp_f32 v211, v99
  v_add_f32 v214, v208, v209
  v_mfma_f32_16x16x32_bf16 a[228:231], a[180:183], v[128:131], a[228:231]
  s_waitcnt lgkmcnt(8)
  v_mfma_f32_16x16x32_bf16 a[240:243], a[184:187], v[128:131], a[240:243]
  ds_read_b64_tr_b16 a[176:177], v236 offset:57344
  ds_read_b64_tr_b16 a[178:179], v236 offset:58368
  v_exp_f32 v212, v100
  v_add_f32 v214, v214, v210
  v_cvt_pk_bf16_f32 v145, v210, v211
  v_mfma_f32_16x16x32_bf16 a[248:251], a[184:187], v[132:135], a[248:251]
  v_mfma_f32_16x16x32_bf16 a[252:255], a[188:191], v[132:135], a[252:255]
  ds_read_b64_tr_b16 a[180:181], v237 offset:57344
  ds_read_b64_tr_b16 a[182:183], v237 offset:58368
  v_exp_f32 v213, v101
  v_add_f32 v214, v214, v211
  v_mfma_f32_16x16x32_bf16 a[244:247], a[188:191], v[128:131], a[244:247]
  s_waitcnt lgkmcnt(8)
  v_mfma_f32_16x16x32_bf16 a[192:195], a[160:163], v[136:139], a[192:195]
  ds_read_b64_tr_b16 a[184:185], v238 offset:57344
  ds_read_b64_tr_b16 a[186:187], v238 offset:58368
  v_exp_f32 v208, v102
  v_add_f32 v214, v214, v212
  v_mfma_f32_16x16x32_bf16 a[200:203], a[160:163], v[140:143], a[200:203]
  v_mfma_f32_16x16x32_bf16 a[204:207], a[164:167], v[140:143], a[204:207]
  ds_read_b64_tr_b16 a[188:189], v239 offset:57344
  ds_read_b64_tr_b16 a[190:191], v239 offset:58368
  v_cvt_pk_bf16_f32 v146, v212, v213
  v_exp_f32 v209, v103
  v_add_f32 v214, v214, v213
  v_mfma_f32_16x16x32_bf16 a[196:199], a[164:167], v[136:139], a[196:199]
  s_waitcnt lgkmcnt(8)
  v_mfma_f32_16x16x32_bf16 a[208:211], a[168:171], v[136:139], a[208:211]
  s_barrier
  ds_read_b128 a[160:163], v224 offset:32768
  v_exp_f32 v210, v104
  v_add_f32 v214, v214, v208
  v_mfma_f32_16x16x32_bf16 a[216:219], a[168:171], v[140:143], a[216:219]
  v_mfma_f32_16x16x32_bf16 a[220:223], a[172:175], v[140:143], a[220:223]
  ds_read_b128 a[164:167], v224 offset:36864
  s_add_u32 m0, s41, 16384
  s_nop 0
  buffer_load_dwordx4 v240, s[8:11], s32 offen offset:0 nt lds
  v_cvt_pk_bf16_f32 v147, v208, v209
  v_mfma_f32_16x16x32_bf16 a[212:215], a[172:175], v[136:139], a[212:215]
  s_waitcnt lgkmcnt(6)
  v_mfma_f32_16x16x32_bf16 a[224:227], a[176:179], v[136:139], a[224:227]
  ds_read_b128 a[168:171], v225 offset:32768
  v_exp_f32 v211, v105
  v_add_f32 v214, v214, v209
  v_exp_f32 v212, v106
  v_mfma_f32_16x16x32_bf16 a[232:235], a[176:179], v[140:143], a[232:235]
  v_mfma_f32_16x16x32_bf16 a[236:239], a[180:183], v[140:143], a[236:239]
  ds_read_b128 a[172:175], v225 offset:36864
  v_cvt_pk_bf16_f32 v148, v210, v211
  v_exp_f32 v213, v107
  v_mfma_f32_16x16x32_bf16 a[228:231], a[180:183], v[136:139], a[228:231]
  s_waitcnt lgkmcnt(4)
  v_mfma_f32_16x16x32_bf16 a[240:243], a[184:187], v[136:139], a[240:243]
  ds_read_b128 a[176:179], v226 offset:32768
  buffer_load_dwordx4 v241, s[8:11], s32 offen offset:1024 nt lds
  v_add_f32 v215, v210, v211
  v_mfma_f32_16x16x32_bf16 a[248:251], a[184:187], v[140:143], a[248:251]
  v_mfma_f32_16x16x32_bf16 a[252:255], a[188:191], v[140:143], a[252:255]
  ds_read_b128 a[180:183], v226 offset:36864
  v_exp_f32 v208, v108
  v_add_f32 v215, v215, v212
  v_cvt_pk_bf16_f32 v149, v212, v213
  v_mfma_f32_16x16x32_bf16 a[244:247], a[188:191], v[136:139], a[244:247]
  s_waitcnt lgkmcnt(4)
  v_mfma_f32_16x16x32_bf16 v[64:67], a[160:163], v[160:163], v[192:195]
  ds_read_b128 a[184:187], v227 offset:32768
  v_exp_f32 v209, v109
  v_add_f32 v215, v215, v213
  v_exp_f32 v210, v110
  v_mfma_f32_16x16x32_bf16 v[72:75], a[160:163], v[164:167], v[196:199]
  v_mfma_f32_16x16x32_bf16 v[76:79], a[164:167], v[164:167], v[196:199]
  ds_read_b128 a[188:191], v227 offset:36864
  buffer_load_dwordx4 v242, s[8:11], s32 offen offset:2048 nt lds
  v_add_f32 v215, v215, v208
  v_mfma_f32_16x16x32_bf16 v[68:71], a[164:167], v[160:163], v[192:195]
  s_waitcnt lgkmcnt(4)
  v_mfma_f32_16x16x32_bf16 v[64:67], a[168:171], v[168:171], v[64:67]
  ds_read_b128 a[160:163], v224 offset:34816
  v_cvt_pk_bf16_f32 v150, v208, v209
  v_exp_f32 v211, v111
  v_add_f32 v215, v215, v209
  v_mfma_f32_16x16x32_bf16 v[72:75], a[168:171], v[172:175], v[72:75]
  v_mfma_f32_16x16x32_bf16 v[76:79], a[172:175], v[172:175], v[76:79]
  ds_read_b128 a[164:167], v224 offset:38912
  v_exp_f32 v212, v112
  v_add_f32 v215, v215, v210
  v_cvt_pk_bf16_f32 v151, v210, v211
  v_mfma_f32_16x16x32_bf16 v[68:71], a[172:175], v[168:171], v[68:71]
  s_waitcnt lgkmcnt(4)
  v_mfma_f32_16x16x32_bf16 v[64:67], a[176:179], v[176:179], v[64:67]
  ds_read_b128 a[168:171], v225 offset:34816
  buffer_load_dwordx4 v243, s[8:11], s32 offen offset:3072 nt lds
  s_add_u32 s32, s32, 0x4000
  v_exp_f32 v213, v113
  v_mfma_f32_16x16x32_bf16 v[72:75], a[176:179], v[180:183], v[72:75]
  v_mfma_f32_16x16x32_bf16 v[76:79], a[180:183], v[180:183], v[76:79]
  ds_read_b128 a[172:175], v225 offset:38912
  v_add_f32 v215, v215, v211
  v_exp_f32 v208, v114
  v_mfma_f32_16x16x32_bf16 v[68:71], a[180:183], v[176:179], v[68:71]
  s_waitcnt lgkmcnt(4)
  v_mfma_f32_16x16x32_bf16 v[64:67], a[184:187], v[184:187], v[64:67]
  ds_read_b128 a[176:179], v226 offset:34816
  v_add_f32 v214, v214, v212
  v_cvt_pk_bf16_f32 v152, v212, v213
  v_exp_f32 v209, v115
  v_add_f32 v214, v214, v213
  v_mfma_f32_16x16x32_bf16 v[72:75], a[184:187], v[188:191], v[72:75]
  v_mfma_f32_16x16x32_bf16 v[76:79], a[188:191], v[188:191], v[76:79]
  ds_read_b128 a[180:183], v226 offset:38912
  v_exp_f32 v210, v116
  v_add_f32 v214, v214, v208
  v_cvt_pk_bf16_f32 v153, v208, v209
  v_mfma_f32_16x16x32_bf16 v[68:71], a[188:191], v[184:187], v[68:71]
  s_waitcnt lgkmcnt(4)
  v_mfma_f32_16x16x32_bf16 v[80:83], a[160:163], v[160:163], v[192:195]
  ds_read_b128 a[184:187], v227 offset:34816
  v_exp_f32 v211, v117
  v_add_f32 v214, v214, v209
  v_exp_f32 v212, v118
  v_mfma_f32_16x16x32_bf16 v[88:91], a[160:163], v[164:167], v[196:199]
  v_mfma_f32_16x16x32_bf16 v[92:95], a[164:167], v[164:167], v[196:199]
  ds_read_b128 a[188:191], v227 offset:38912
  v_add_f32 v214, v214, v210
  v_cvt_pk_bf16_f32 v154, v210, v211
  v_exp_f32 v213, v119
  v_mfma_f32_16x16x32_bf16 v[84:87], a[164:167], v[160:163], v[192:195]
  s_waitcnt lgkmcnt(4)
  v_mfma_f32_16x16x32_bf16 v[80:83], a[168:171], v[168:171], v[80:83]
  s_waitcnt vmcnt(28)
  s_barrier
  ds_read_b64_tr_b16 a[160:161], v232 offset:0
  ds_read_b64_tr_b16 a[162:163], v232 offset:1024
  v_add_f32 v214, v214, v211
  v_mfma_f32_16x16x32_bf16 v[88:91], a[168:171], v[172:175], v[88:91]
  v_mfma_f32_16x16x32_bf16 v[92:95], a[172:175], v[172:175], v[92:95]
  ds_read_b64_tr_b16 a[164:165], v233 offset:0
  ds_read_b64_tr_b16 a[166:167], v233 offset:1024
  s_add_u32 m0, s41, 114688
  s_nop 0
  buffer_load_dwordx4 v248, s[12:15], s33 offen offset:0 nt lds
  v_mfma_f32_16x16x32_bf16 v[84:87], a[172:175], v[168:171], v[84:87]
  s_waitcnt lgkmcnt(6)
  v_mfma_f32_16x16x32_bf16 v[80:83], a[176:179], v[176:179], v[80:83]
  ds_read_b64_tr_b16 a[168:169], v234 offset:0
  ds_read_b64_tr_b16 a[170:171], v234 offset:1024
  v_exp_f32 v208, v120
  v_add_f32 v214, v214, v212
  v_cvt_pk_bf16_f32 v155, v212, v213
  v_mfma_f32_16x16x32_bf16 v[88:91], a[176:179], v[180:183], v[88:91]
  v_mfma_f32_16x16x32_bf16 v[92:95], a[180:183], v[180:183], v[92:95]
  ds_read_b64_tr_b16 a[172:173], v235 offset:0
  ds_read_b64_tr_b16 a[174:175], v235 offset:1024
  v_exp_f32 v209, v121
  v_add_f32 v214, v214, v213
  v_mfma_f32_16x16x32_bf16 v[84:87], a[180:183], v[176:179], v[84:87]
  s_waitcnt lgkmcnt(8)
  v_mfma_f32_16x16x32_bf16 v[80:83], a[184:187], v[184:187], v[80:83]
  ds_read_b64_tr_b16 a[176:177], v236 offset:0
  ds_read_b64_tr_b16 a[178:179], v236 offset:1024
  buffer_load_dwordx4 v248, s[12:15], s33 offen offset:1024 nt lds
  v_exp_f32 v210, v122
  v_mfma_f32_16x16x32_bf16 v[88:91], a[184:187], v[188:191], v[88:91]
  v_mfma_f32_16x16x32_bf16 v[92:95], a[188:191], v[188:191], v[92:95]
  ds_read_b64_tr_b16 a[180:181], v237 offset:0
  ds_read_b64_tr_b16 a[182:183], v237 offset:1024
  v_add_f32 v215, v215, v208
  v_cvt_pk_bf16_f32 v156, v208, v209
  v_mfma_f32_16x16x32_bf16 v[84:87], a[188:191], v[184:187], v[84:87]
  s_waitcnt lgkmcnt(8)
  v_mfma_f32_16x16x32_bf16 v[0:3], a[160:163], a[112:115], v[0:3]
  ds_read_b64_tr_b16 a[184:185], v238 offset:0
  ds_read_b64_tr_b16 a[186:187], v238 offset:1024
  v_exp_f32 v211, v123
  v_add_f32 v215, v215, v209
  v_mfma_f32_16x16x32_bf16 v[8:11], a[160:163], a[116:119], v[8:11]
  v_mfma_f32_16x16x32_bf16 v[12:15], a[164:167], a[116:119], v[12:15]
  ds_read_b64_tr_b16 a[188:189], v239 offset:0
  ds_read_b64_tr_b16 a[190:191], v239 offset:1024
  buffer_load_dwordx4 v248, s[12:15], s33 offen offset:2048 nt lds
  v_exp_f32 v212, v124
  v_mfma_f32_16x16x32_bf16 v[4:7], a[164:167], a[112:115], v[4:7]
  s_waitcnt lgkmcnt(8)
  v_mfma_f32_16x16x32_bf16 v[16:19], a[168:171], a[112:115], v[16:19]
  ds_read_b64_tr_b16 a[160:161], v232 offset:8192
  ds_read_b64_tr_b16 a[162:163], v232 offset:9216
  v_add_f32 v215, v215, v210
  v_cvt_pk_bf16_f32 v157, v210, v211
  v_mfma_f32_16x16x32_bf16 v[24:27], a[168:171], a[116:119], v[24:27]
  v_mfma_f32_16x16x32_bf16 v[28:31], a[172:175], a[116:119], v[28:31]
  ds_read_b64_tr_b16 a[164:165], v233 offset:8192
  ds_read_b64_tr_b16 a[166:167], v233 offset:9216
  v_exp_f32 v213, v125
  v_add_f32 v215, v215, v211
  v_exp_f32 v208, v126
  v_mfma_f32_16x16x32_bf16 v[20:23], a[172:175], a[112:115], v[20:23]
  s_waitcnt lgkmcnt(8)
  v_mfma_f32_16x16x32_bf16 v[32:35], a[176:179], a[112:115], v[32:35]
  ds_read_b64_tr_b16 a[168:169], v234 offset:8192
  ds_read_b64_tr_b16 a[170:171], v234 offset:9216
  buffer_load_dwordx4 v248, s[12:15], s33 offen offset:3072 nt lds
  s_add_u32 s33, s33, 0x4000
  v_mfma_f32_16x16x32_bf16 v[40:43], a[176:179], a[116:119], v[40:43]
  v_mfma_f32_16x16x32_bf16 v[44:47], a[180:183], a[116:119], v[44:47]
  ds_read_b64_tr_b16 a[172:173], v235 offset:8192
  ds_read_b64_tr_b16 a[174:175], v235 offset:9216
  v_add_f32 v215, v215, v212
  v_cvt_pk_bf16_f32 v158, v212, v213
  v_exp_f32 v209, v127
  v_mfma_f32_16x16x32_bf16 v[36:39], a[180:183], a[112:115], v[36:39]
  s_waitcnt lgkmcnt(8)
  v_mfma_f32_16x16x32_bf16 v[48:51], a[184:187], a[112:115], v[48:51]
  ds_read_b64_tr_b16 a[176:177], v236 offset:8192
  ds_read_b64_tr_b16 a[178:179], v236 offset:9216
  v_add_f32 v215, v215, v213
  v_add_f32 v215, v215, v208
  v_mfma_f32_16x16x32_bf16 v[56:59], a[184:187], a[116:119], v[56:59]
  v_mfma_f32_16x16x32_bf16 v[60:63], a[188:191], a[116:119], v[60:63]
  ds_read_b64_tr_b16 a[180:181], v237 offset:8192
  ds_read_b64_tr_b16 a[182:183], v237 offset:9216
  v_cvt_pk_bf16_f32 v159, v208, v209
  v_add_f32 v215, v215, v209
  v_add_f32 v210, v214, v215
  v_cmp_lt_f32 vcc, s35, v210
  v_mfma_f32_16x16x32_bf16 v[52:55], a[188:191], a[112:115], v[52:55]
  s_waitcnt lgkmcnt(8)
  v_mfma_f32_16x16x32_bf16 v[0:3], a[160:163], a[120:123], v[0:3]
  ds_read_b64_tr_b16 a[184:185], v238 offset:8192
  ds_read_b64_tr_b16 a[186:187], v238 offset:9216
  v_mfma_f32_16x16x32_bf16 v[8:11], a[160:163], a[124:127], v[8:11]
  v_mfma_f32_16x16x32_bf16 v[12:15], a[164:167], a[124:127], v[12:15]
  ds_read_b64_tr_b16 a[188:189], v239 offset:8192
  ds_read_b64_tr_b16 a[190:191], v239 offset:9216
  v_mfma_f32_16x16x32_bf16 v[4:7], a[164:167], a[120:123], v[4:7]
  s_waitcnt lgkmcnt(8)
  v_mfma_f32_16x16x32_bf16 v[16:19], a[168:171], a[120:123], v[16:19]
  s_waitcnt vmcnt(24)
  s_barrier
  ds_read_b64_tr_b16 a[160:161], v200 offset:0
  ds_read_b64_tr_b16 a[162:163], v200 offset:1024
  v_mfma_f32_16x16x32_bf16 v[24:27], a[168:171], a[124:127], v[24:27]
  v_mfma_f32_16x16x32_bf16 v[28:31], a[172:175], a[124:127], v[28:31]
  ds_read_b64_tr_b16 a[164:165], v201 offset:0
  ds_read_b64_tr_b16 a[166:167], v201 offset:1024
  s_add_u32 m0, s41, 32768
  s_nop 0
  buffer_load_dwordx4 v240, s[8:11], s32 offen offset:0 nt lds
  v_mfma_f32_16x16x32_bf16 v[20:23], a[172:175], a[120:123], v[20:23]
  s_waitcnt lgkmcnt(8)
  v_mfma_f32_16x16x32_bf16 v[32:35], a[176:179], a[120:123], v[32:35]
  ds_read_b64_tr_b16 a[168:169], v202 offset:0
  ds_read_b64_tr_b16 a[170:171], v202 offset:1024
  v_mfma_f32_16x16x32_bf16 v[40:43], a[176:179], a[124:127], v[40:43]
  v_mfma_f32_16x16x32_bf16 v[44:47], a[180:183], a[124:127], v[44:47]
  ds_read_b64_tr_b16 a[172:173], v203 offset:0
  ds_read_b64_tr_b16 a[174:175], v203 offset:1024
  v_mfma_f32_16x16x32_bf16 v[36:39], a[180:183], a[120:123], v[36:39]
  s_waitcnt lgkmcnt(8)
  v_mfma_f32_16x16x32_bf16 v[48:51], a[184:187], a[120:123], v[48:51]
  ds_read_b64_tr_b16 a[176:177], v204 offset:0
  ds_read_b64_tr_b16 a[178:179], v204 offset:1024
  buffer_load_dwordx4 v241, s[8:11], s32 offen offset:1024 nt lds
  v_mfma_f32_16x16x32_bf16 v[56:59], a[184:187], a[124:127], v[56:59]
  v_mfma_f32_16x16x32_bf16 v[60:63], a[188:191], a[124:127], v[60:63]
  ds_read_b64_tr_b16 a[180:181], v205 offset:0
  ds_read_b64_tr_b16 a[182:183], v205 offset:1024
  v_mfma_f32_16x16x32_bf16 v[52:55], a[188:191], a[120:123], v[52:55]
  s_cbranch_vccnz SITE30
BACK30:
  s_waitcnt lgkmcnt(8)
  v_mfma_f32_16x16x32_bf16 a[192:195], a[160:163], v[144:147], a[192:195]
  ds_read_b64_tr_b16 a[184:185], v206 offset:0
  ds_read_b64_tr_b16 a[186:187], v206 offset:1024
  v_add_f32 v249, v249, v214
  v_add_f32 v254, v254, v215
  v_exp_f32 v208, v64
  v_exp_f32 v209, v65
  v_mfma_f32_16x16x32_bf16 a[200:203], a[160:163], v[148:151], a[200:203]
  v_mfma_f32_16x16x32_bf16 a[204:207], a[164:167], v[148:151], a[204:207]
  ds_read_b64_tr_b16 a[188:189], v207 offset:0
  ds_read_b64_tr_b16 a[190:191], v207 offset:1024
  buffer_load_dwordx4 v242, s[8:11], s32 offen offset:2048 nt lds
  v_mfma_f32_16x16x32_bf16 a[196:199], a[164:167], v[144:147], a[196:199]
  s_waitcnt lgkmcnt(8)
  v_mfma_f32_16x16x32_bf16 a[208:211], a[168:171], v[144:147], a[208:211]
  ds_read_b64_tr_b16 a[160:161], v200 offset:8192
  ds_read_b64_tr_b16 a[162:163], v200 offset:9216
  v_exp_f32 v210, v66
  v_cvt_pk_bf16_f32 v128, v208, v209
  v_exp_f32 v211, v67
  v_mfma_f32_16x16x32_bf16 a[216:219], a[168:171], v[148:151], a[216:219]
  v_mfma_f32_16x16x32_bf16 a[220:223], a[172:175], v[148:151], a[220:223]
  ds_read_b64_tr_b16 a[164:165], v201 offset:8192
  ds_read_b64_tr_b16 a[166:167], v201 offset:9216
  v_add_f32 v214, v208, v209
  v_exp_f32 v212, v68
  v_add_f32 v214, v214, v210
  v_mfma_f32_16x16x32_bf16 a[212:215], a[172:175], v[144:147], a[212:215]
  s_waitcnt lgkmcnt(8)
  v_mfma_f32_16x16x32_bf16 a[224:227], a[176:179], v[144:147], a[224:227]
  ds_read_b64_tr_b16 a[168:169], v202 offset:8192
  ds_read_b64_tr_b16 a[170:171], v202 offset:9216
  buffer_load_dwordx4 v243, s[8:11], s32 offen offset:3072 nt lds
  s_add_u32 s32, s32, 0x4000
  v_cvt_pk_bf16_f32 v129, v210, v211
  v_mfma_f32_16x16x32_bf16 a[232:235], a[176:179], v[148:151], a[232:235]
  v_mfma_f32_16x16x32_bf16 a[236:239], a[180:183], v[148:151], a[236:239]
  ds_read_b64_tr_b16 a[172:173], v203 offset:8192
  ds_read_b64_tr_b16 a[174:175], v203 offset:9216
  v_exp_f32 v213, v69
  v_add_f32 v214, v214, v211
  v_mfma_f32_16x16x32_bf16 a[228:231], a[180:183], v[144:147], a[228:231]
  s_waitcnt lgkmcnt(8)
  v_mfma_f32_16x16x32_bf16 a[240:243], a[184:187], v[144:147], a[240:243]
  ds_read_b64_tr_b16 a[176:177], v204 offset:8192
  ds_read_b64_tr_b16 a[178:179], v204 offset:9216
  v_exp_f32 v208, v70
  v_add_f32 v214, v214, v212
  v_cvt_pk_bf16_f32 v130, v212, v213
  v_mfma_f32_16x16x32_bf16 a[248:251], a[184:187], v[148:151], a[248:251]
  v_mfma_f32_16x16x32_bf16 a[252:255], a[188:191], v[148:151], a[252:255]
  ds_read_b64_tr_b16 a[180:181], v205 offset:8192
  ds_read_b64_tr_b16 a[182:183], v205 offset:9216
  v_exp_f32 v209, v71
  v_add_f32 v214, v214, v213
  v_exp_f32 v210, v72
  v_mfma_f32_16x16x32_bf16 a[244:247], a[188:191], v[144:147], a[244:247]
  s_waitcnt lgkmcnt(8)
  v_mfma_f32_16x16x32_bf16 a[192:195], a[160:163], v[152:155], a[192:195]
  ds_read_b64_tr_b16 a[184:185], v206 offset:8192
  ds_read_b64_tr_b16 a[186:187], v206 offset:9216
  v_add_f32 v214, v214, v208
  v_cvt_pk_bf16_f32 v131, v208, v209
  v_exp_f32 v211, v73
  v_mfma_f32_16x16x32_bf16 a[200:203], a[160:163], v[156:159], a[200:203]
  v_mfma_f32_16x16x32_bf16 a[204:207], a[164:167], v[156:159], a[204:207]
  ds_read_b64_tr_b16 a[188:189], v207 offset:8192
  ds_read_b64_tr_b16 a[190:191], v207 offset:9216
  v_add_f32 v214, v214, v209
  v_exp_f32 v212, v74
  v_mfma_f32_16x16x32_bf16 a[196:199], a[164:167], v[152:155], a[196:199]
  s_waitcnt lgkmcnt(8)
  v_mfma_f32_16x16x32_bf16 a[208:211], a[168:171], v[152:155], a[208:211]
  s_barrier
  ds_read_b128 a[160:163], v224 offset:49152
  v_cvt_pk_bf16_f32 v132, v210, v211
  v_exp_f32 v213, v75
  v_add_f32 v215, v210, v211
  v_mfma_f32_16x16x32_bf16 a[216:219], a[168:171], v[156:159], a[216:219]
  v_mfma_f32_16x16x32_bf16 a[220:223], a[172:175], v[156:159], a[220:223]
  ds_read_b128 a[164:167], v224 offset:53248
  s_add_u32 m0, s41, 65536
  s_nop 0
  buffer_load_dwordx4 v244, s[16:19], s34 offen offset:0 lds
  v_exp_f32 v208, v76
  v_mfma_f32_16x16x32_bf16 a[212:215], a[172:175], v[152:155], a[212:215]
  s_waitcnt lgkmcnt(6)
  v_mfma_f32_16x16x32_bf16 a[224:227], a[176:179], v[152:155], a[224:227]
  ds_read_b128 a[168:171], v225 offset:49152
  v_add_f32 v215, v215, v212
  v_cvt_pk_bf16_f32 v133, v212, v213
  v_exp_f32 v209, v77
  v_mfma_f32_16x16x32_bf16 a[232:235], a[176:179], v[156:159], a[232:235]
  v_mfma_f32_16x16x32_bf16 a[236:239], a[180:183], v[156:159], a[236:239]
  ds_read_b128 a[172:175], v225 offset:53248
  v_add_f32 v215, v215, v213
  v_exp_f32 v210, v78
  v_add_f32 v215, v215, v208
  v_cvt_pk_bf16_f32 v134, v208, v209
  v_mfma_f32_16x16x32_bf16 a[228:231], a[180:183], v[152:155], a[228:231]
  s_waitcnt lgkmcnt(4)
  v_mfma_f32_16x16x32_bf16 a[240:243], a[184:187], v[152:155], a[240:243]
  ds_read_b128 a[176:179], v226 offset:49152
  buffer_load_dwordx4 v245, s[16:19], s34 offen offset:1024 lds
  v_exp_f32 v211, v79
  v_mfma_f32_16x16x32_bf16 a[248:251], a[184:187], v[156:159], a[248:251]
  v_mfma_f32_16x16x32_bf16 a[252:255], a[188:191], v[156:159], a[252:255]
  ds_read_b128 a[180:183], v226 offset:53248
  v_add_f32 v215, v215, v209
  v_exp_f32 v212, v80
  v_add_f32 v215, v215, v210
  v_cvt_pk_bf16_f32 v135, v210, v211
  v_mfma_f32_16x16x32_bf16 a[244:247], a[188:191], v[152:155], a[244:247]
  s_waitcnt lgkmcnt(4)
  v_mfma_f32_16x16x32_bf16 v[96:99], a[160:163], v[160:163], v[192:195]
  ds_read_b128 a[184:187], v227 offset:49152
  v_exp_f32 v213, v81
  v_add_f32 v215, v215, v211
  v_exp_f32 v208, v82
  v_mfma_f32_16x16x32_bf16 v[104:107], a[160:163], v[164:167], v[196:199]
  v_mfma_f32_16x16x32_bf16 v[108:111], a[164:167], v[164:167], v[196:199]
  ds_read_b128 a[188:191], v227 offset:53248
  buffer_load_dwordx4 v246, s[16:19], s34 offen offset:2048 lds
  v_add_f32 v214, v214, v212
  v_mfma_f32_16x16x32_bf16 v[100:103], a[164:167], v[160:163], v[192:195]
  s_waitcnt lgkmcnt(4)
  v_mfma_f32_16x16x32_bf16 v[96:99], a[168:171], v[168:171], v[96:99]
  ds_read_b128 a[160:163], v224 offset:51200
  v_cvt_pk_bf16_f32 v136, v212, v213
  v_exp_f32 v209, v83
  v_add_f32 v214, v214, v213
  v_exp_f32 v210, v84
  v_mfma_f32_16x16x32_bf16 v[104:107], a[168:171], v[172:175], v[104:107]
  v_mfma_f32_16x16x32_bf16 v[108:111], a[172:175], v[172:175], v[108:111]
  ds_read_b128 a[164:167], v224 offset:55296
  v_add_f32 v214, v214, v208
  v_cvt_pk_bf16_f32 v137, v208, v209
  v_exp_f32 v211, v85
  v_mfma_f32_16x16x32_bf16 v[100:103], a[172:175], v[168:171], v[100:103]
  s_waitcnt lgkmcnt(4)
  v_mfma_f32_16x16x32_bf16 v[96:99], a[176:179], v[176:179], v[96:99]
  ds_read_b128 a[168:171], v225 offset:51200
  buffer_load_dwordx4 v247, s[16:19], s34 offen offset:3072 lds
  s_add_u32 s34, s34, 524288
  s_sub_u32 s38, s34, 5242880
  s_min_u32 s34, s34, s38
  v_add_f32 v214, v214, v209
  v_mfma_f32_16x16x32_bf16 v[104:107], a[176:179], v[180:183], v[104:107]
  v_mfma_f32_16x16x32_bf16 v[108:111], a[180:183], v[180:183], v[108:111]
  ds_read_b128 a[172:175], v225 offset:55296
  v_exp_f32 v212, v86
  v_add_f32 v214, v214, v210
  v_cvt_pk_bf16_f32 v138, v210, v211
  v_exp_f32 v213, v87
  v_mfma_f32_16x16x32_bf16 v[100:103], a[180:183], v[176:179], v[100:103]
  s_waitcnt lgkmcnt(4)
  v_mfma_f32_16x16x32_bf16 v[96:99], a[184:187], v[184:187], v[96:99]
  ds_read_b128 a[176:179], v226 offset:51200
  v_add_f32 v214, v214, v211
  v_exp_f32 v208, v88
  v_add_f32 v214, v214, v212
  v_cvt_pk_bf16_f32 v139, v212, v213
  v_mfma_f32_16x16x32_bf16 v[104:107], a[184:187], v[188:191], v[104:107]
  v_mfma_f32_16x16x32_bf16 v[108:111], a[188:191], v[188:191], v[108:111]
  ds_read_b128 a[180:183], v226 offset:55296
  v_exp_f32 v209, v89
  v_add_f32 v214, v214, v213
  v_exp_f32 v210, v90
  v_mfma_f32_16x16x32_bf16 v[100:103], a[188:191], v[184:187], v[100:103]
  s_waitcnt lgkmcnt(4)
  v_mfma_f32_16x16x32_bf16 v[112:115], a[160:163], v[160:163], v[192:195]
  ds_read_b128 a[184:187], v227 offset:51200
  v_add_f32 v215, v215, v208
  v_cvt_pk_bf16_f32 v140, v208, v209
  v_exp_f32 v211, v91
  v_add_f32 v215, v215, v209
  v_mfma_f32_16x16x32_bf16 v[120:123], a[160:163], v[164:167], v[196:199]
  v_mfma_f32_16x16x32_bf16 v[124:127], a[164:167], v[164:167], v[196:199]
  ds_read_b128 a[188:191], v227 offset:55296
  v_exp_f32 v212, v92
  v_add_f32 v215, v215, v210
  v_cvt_pk_bf16_f32 v141, v210, v211
  v_exp_f32 v213, v93
  v_mfma_f32_16x16x32_bf16 v[116:119], a[164:167], v[160:163], v[192:195]
  s_waitcnt lgkmcnt(4)
  v_mfma_f32_16x16x32_bf16 v[112:115], a[168:171], v[168:171], v[112:115]
  s_waitcnt vmcnt(28)
  s_barrier
  ds_read_b64_tr_b16 a[160:161], v200 offset:16384
  ds_read_b64_tr_b16 a[162:163], v200 offset:17408
  v_add_f32 v215, v215, v211
  v_mfma_f32_16x16x32_bf16 v[120:123], a[168:171], v[172:175], v[120:123]
  v_mfma_f32_16x16x32_bf16 v[124:127], a[172:175], v[172:175], v[124:127]
  ds_read_b64_tr_b16 a[164:165], v201 offset:16384
  ds_read_b64_tr_b16 a[166:167], v201 offset:17408
  s_add_u32 m0, s41, 131072
  s_nop 0
  buffer_load_dwordx4 v244, s[16:19], s34 offen offset:0 lds
  v_exp_f32 v208, v94
  v_mfma_f32_16x16x32_bf16 v[116:119], a[172:175], v[168:171], v[116:119]
  s_waitcnt lgkmcnt(6)
  v_mfma_f32_16x16x32_bf16 v[112:115], a[176:179], v[176:179], v[112:115]
  ds_read_b64_tr_b16 a[168:169], v202 offset:16384
  ds_read_b64_tr_b16 a[170:171], v202 offset:17408
  v_add_f32 v215, v215, v212
  v_cvt_pk_bf16_f32 v142, v212, v213
  v_exp_f32 v209, v95
  v_add_f32 v215, v215, v213
  v_mfma_f32_16x16x32_bf16 v[120:123], a[176:179], v[180:183], v[120:123]
  v_mfma_f32_16x16x32_bf16 v[124:127], a[180:183], v[180:183], v[124:127]
  ds_read_b64_tr_b16 a[172:173], v203 offset:16384
  ds_read_b64_tr_b16 a[174:175], v203 offset:17408
  v_add_f32 v215, v215, v208
  v_cvt_pk_bf16_f32 v143, v208, v209
  v_add_f32 v215, v215, v209
  v_add_f32 v210, v214, v215
  v_mfma_f32_16x16x32_bf16 v[116:119], a[180:183], v[176:179], v[116:119]
  s_waitcnt lgkmcnt(8)
  v_mfma_f32_16x16x32_bf16 v[112:115], a[184:187], v[184:187], v[112:115]
  ds_read_b64_tr_b16 a[176:177], v204 offset:16384
  ds_read_b64_tr_b16 a[178:179], v204 offset:17408
  buffer_load_dwordx4 v245, s[16:19], s34 offen offset:1024 lds
  v_cmp_lt_f32 vcc, s35, v210
  v_mfma_f32_16x16x32_bf16 v[120:123], a[184:187], v[188:191], v[120:123]
  v_mfma_f32_16x16x32_bf16 v[124:127], a[188:191], v[188:191], v[124:127]
  ds_read_b64_tr_b16 a[180:181], v205 offset:16384
  ds_read_b64_tr_b16 a[182:183], v205 offset:17408
  v_mfma_f32_16x16x32_bf16 v[116:119], a[188:191], v[184:187], v[116:119]
  s_cbranch_vccnz SITE32
BACK32:
  s_waitcnt lgkmcnt(8)
  v_mfma_f32_16x16x32_bf16 v[0:3], a[160:163], a[128:131], v[0:3]
  ds_read_b64_tr_b16 a[184:185], v206 offset:16384
  ds_read_b64_tr_b16 a[186:187], v206 offset:17408
  v_mfma_f32_16x16x32_bf16 v[8:11], a[160:163], a[132:135], v[8:11]
  v_mfma_f32_16x16x32_bf16 v[12:15], a[164:167], a[132:135], v[12:15]
  ds_read_b64_tr_b16 a[188:189], v207 offset:16384
  ds_read_b64_tr_b16 a[190:191], v207 offset:17408
  buffer_load_dwordx4 v246, s[16:19], s34 offen offset:2048 lds
  v_mfma_f32_16x16x32_bf16 v[4:7], a[164:167], a[128:131], v[4:7]
  s_waitcnt lgkmcnt(8)
  v_mfma_f32_16x16x32_bf16 v[16:19], a[168:171], a[128:131], v[16:19]
  ds_read_b64_tr_b16 a[160:161], v200 offset:24576
  ds_read_b64_tr_b16 a[162:163], v200 offset:25600
  v_add_f32 v249, v249, v214
  v_add_f32 v254, v254, v215
  v_exp_f32 v208, v96
  v_exp_f32 v209, v97
  v_mfma_f32_16x16x32_bf16 v[24:27], a[168:171], a[132:135], v[24:27]
  v_mfma_f32_16x16x32_bf16 v[28:31], a[172:175], a[132:135], v[28:31]
  ds_read_b64_tr_b16 a[164:165], v201 offset:24576
  ds_read_b64_tr_b16 a[166:167], v201 offset:25600
  v_exp_f32 v210, v98
  v_cvt_pk_bf16_f32 v144, v208, v209
  v_exp_f32 v211, v99
  v_mfma_f32_16x16x32_bf16 v[20:23], a[172:175], a[128:131], v[20:23]
  s_waitcnt lgkmcnt(8)
  v_mfma_f32_16x16x32_bf16 v[32:35], a[176:179], a[128:131], v[32:35]
  ds_read_b64_tr_b16 a[168:169], v202 offset:24576
  ds_read_b64_tr_b16 a[170:171], v202 offset:25600
  buffer_load_dwordx4 v247, s[16:19], s34 offen offset:3072 lds
  s_add_u32 s34, s34, 524288
  s_sub_u32 s38, s34, 5242880
  s_min_u32 s34, s34, s38
  v_add_f32 v214, v208, v209
  v_mfma_f32_16x16x32_bf16 v[40:43], a[176:179], a[132:135], v[40:43]
  v_mfma_f32_16x16x32_bf16 v[44:47], a[180:183], a[132:135], v[44:47]
  ds_read_b64_tr_b16 a[172:173], v203 offset:24576
  ds_read_b64_tr_b16 a[174:175], v203 offset:25600
  v_exp_f32 v212, v100
  v_add_f32 v214, v214, v210
  v_cvt_pk_bf16_f32 v145, v210, v211
  v_mfma_f32_16x16x32_bf16 v[36:39], a[180:183], a[128:131], v[36:39]
  s_waitcnt lgkmcnt(8)
  v_mfma_f32_16x16x32_bf16 v[48:51], a[184:187], a[128:131], v[48:51]
  ds_read_b64_tr_b16 a[176:177], v204 offset:24576
  ds_read_b64_tr_b16 a[178:179], v204 offset:25600
  v_exp_f32 v213, v101
  v_add_f32 v214, v214, v211
  v_exp_f32 v208, v102
  v_mfma_f32_16x16x32_bf16 v[56:59], a[184:187], a[132:135], v[56:59]
  v_mfma_f32_16x16x32_bf16 v[60:63], a[188:191], a[132:135], v[60:63]
  ds_read_b64_tr_b16 a[180:181], v205 offset:24576
  ds_read_b64_tr_b16 a[182:183], v205 offset:25600
  v_add_f32 v214, v214, v212
  v_cvt_pk_bf16_f32 v146, v212, v213
  v_exp_f32 v209, v103
  v_mfma_f32_16x16x32_bf16 v[52:55], a[188:191], a[128:131], v[52:55]
  s_waitcnt lgkmcnt(8)
  v_mfma_f32_16x16x32_bf16 v[0:3], a[160:163], a[136:139], v[0:3]
  ds_read_b64_tr_b16 a[184:185], v206 offset:24576
  ds_read_b64_tr_b16 a[186:187], v206 offset:25600
  v_add_f32 v214, v214, v213
  v_exp_f32 v210, v104
  v_add_f32 v214, v214, v208
  v_mfma_f32_16x16x32_bf16 v[8:11], a[160:163], a[140:143], v[8:11]
  v_mfma_f32_16x16x32_bf16 v[12:15], a[164:167], a[140:143], v[12:15]
  ds_read_b64_tr_b16 a[188:189], v207 offset:24576
  ds_read_b64_tr_b16 a[190:191], v207 offset:25600
  v_cvt_pk_bf16_f32 v147, v208, v209
  v_exp_f32 v211, v105
  v_add_f32 v214, v214, v209
  v_mfma_f32_16x16x32_bf16 v[4:7], a[164:167], a[136:139], v[4:7]
  s_waitcnt lgkmcnt(8)
  v_mfma_f32_16x16x32_bf16 v[16:19], a[168:171], a[136:139], v[16:19]
  s_waitcnt vmcnt(24)
  s_barrier
  ds_read_b64_tr_b16 a[160:161], v232 offset:16384
  ds_read_b64_tr_b16 a[162:163], v232 offset:17408
  v_exp_f32 v212, v106
  v_cvt_pk_bf16_f32 v148, v210, v211
  v_mfma_f32_16x16x32_bf16 v[24:27], a[168:171], a[140:143], v[24:27]
  v_mfma_f32_16x16x32_bf16 v[28:31], a[172:175], a[140:143], v[28:31]
  ds_read_b64_tr_b16 a[164:165], v233 offset:16384
  ds_read_b64_tr_b16 a[166:167], v233 offset:17408
  s_add_u32 m0, s41, 49152
  s_nop 0
  buffer_load_dwordx4 v240, s[8:11], s32 offen offset:0 nt lds
  v_exp_f32 v213, v107
  v_mfma_f32_16x16x32_bf16 v[20:23], a[172:175], a[136:139], v[20:23]
  s_waitcnt lgkmcnt(8)
  v_mfma_f32_16x16x32_bf16 v[32:35], a[176:179], a[136:139], v[32:35]
  ds_read_b64_tr_b16 a[168:169], v232 offset:24576
  ds_read_b64_tr_b16 a[170:171], v232 offset:25600
  v_add_f32 v215, v210, v211
  v_exp_f32 v208, v108
  v_add_f32 v215, v215, v212
  v_mfma_f32_16x16x32_bf16 v[40:43], a[176:179], a[140:143], v[40:43]
  v_mfma_f32_16x16x32_bf16 v[44:47], a[180:183], a[140:143], v[44:47]
  ds_read_b64_tr_b16 a[172:173], v233 offset:24576
  ds_read_b64_tr_b16 a[174:175], v233 offset:25600
  v_cvt_pk_bf16_f32 v149, v212, v213
  v_exp_f32 v209, v109
  v_add_f32 v215, v215, v213
  v_mfma_f32_16x16x32_bf16 v[36:39], a[180:183], a[136:139], v[36:39]
  s_waitcnt lgkmcnt(8)
  v_mfma_f32_16x16x32_bf16 v[48:51], a[184:187], a[136:139], v[48:51]
  ds_read_b64_tr_b16 a[176:177], v234 offset:16384
  ds_read_b64_tr_b16 a[178:179], v234 offset:17408
  buffer_load_dwordx4 v241, s[8:11], s32 offen offset:1024 nt lds
  v_exp_f32 v210, v110
  v_mfma_f32_16x16x32_bf16 v[56:59], a[184:187], a[140:143], v[56:59]
  v_mfma_f32_16x16x32_bf16 v[60:63], a[188:191], a[140:143], v[60:63]
  ds_read_b64_tr_b16 a[180:181], v235 offset:16384
  ds_read_b64_tr_b16 a[182:183], v235 offset:17408
  v_add_f32 v215, v215, v208
  v_cvt_pk_bf16_f32 v150, v208, v209
  v_exp_f32 v211, v111
  v_mfma_f32_16x16x32_bf16 v[52:55], a[188:191], a[136:139], v[52:55]
  s_waitcnt lgkmcnt(8)
  v_mfma_f32_16x16x32_bf16 v[0:3], a[160:163], a[144:147], v[0:3]
  ds_read_b64_tr_b16 a[184:185], v234 offset:24576
  ds_read_b64_tr_b16 a[186:187], v234 offset:25600
  v_add_f32 v215, v215, v209
  v_exp_f32 v212, v112
  v_add_f32 v215, v215, v210
  v_cvt_pk_bf16_f32 v151, v210, v211
  v_mfma_f32_16x16x32_bf16 v[8:11], a[160:163], a[148:151], v[8:11]
  v_mfma_f32_16x16x32_bf16 v[12:15], a[164:167], a[148:151], v[12:15]
  ds_read_b64_tr_b16 a[188:189], v235 offset:24576
  ds_read_b64_tr_b16 a[190:191], v235 offset:25600
  buffer_load_dwordx4 v242, s[8:11], s32 offen offset:2048 nt lds
  v_exp_f32 v213, v113
  v_mfma_f32_16x16x32_bf16 v[4:7], a[164:167], a[144:147], v[4:7]
  s_waitcnt lgkmcnt(8)
  v_mfma_f32_16x16x32_bf16 v[0:3], a[168:171], a[152:155], v[0:3]
  ds_read_b64_tr_b16 a[160:161], v236 offset:16384
  ds_read_b64_tr_b16 a[162:163], v236 offset:17408
  v_add_f32 v215, v215, v211
  v_exp_f32 v208, v114
  v_add_f32 v214, v214, v212
  v_mfma_f32_16x16x32_bf16 v[8:11], a[168:171], a[156:159], v[8:11]
  v_mfma_f32_16x16x32_bf16 v[12:15], a[172:175], a[156:159], v[12:15]
  ds_read_b64_tr_b16 a[164:165], v237 offset:16384
  ds_read_b64_tr_b16 a[166:167], v237 offset:17408
  v_cvt_pk_bf16_f32 v152, v212, v213
  v_exp_f32 v209, v115
  v_add_f32 v214, v214, v213
  v_mfma_f32_16x16x32_bf16 v[4:7], a[172:175], a[152:155], v[4:7]
  s_waitcnt lgkmcnt(8)
  v_mfma_f32_16x16x32_bf16 v[16:19], a[176:179], a[144:147], v[16:19]
  ds_read_b64_tr_b16 a[168:169], v236 offset:24576
  ds_read_b64_tr_b16 a[170:171], v236 offset:25600
  buffer_load_dwordx4 v243, s[8:11], s32 offen offset:3072 nt lds
  s_add_u32 s32, s32, 0x4000
  v_exp_f32 v210, v116
  v_add_f32 v214, v214, v208
  v_mfma_f32_16x16x32_bf16 v[24:27], a[176:179], a[148:151], v[24:27]
  v_mfma_f32_16x16x32_bf16 v[28:31], a[180:183], a[148:151], v[28:31]
  ds_read_b64_tr_b16 a[172:173], v237 offset:24576
  ds_read_b64_tr_b16 a[174:175], v237 offset:25600
  v_cvt_pk_bf16_f32 v153, v208, v209
  v_exp_f32 v211, v117
  v_add_f32 v214, v214, v209
  v_mfma_f32_16x16x32_bf16 v[20:23], a[180:183], a[144:147], v[20:23]
  s_waitcnt lgkmcnt(8)
  v_mfma_f32_16x16x32_bf16 v[16:19], a[184:187], a[152:155], v[16:19]
  ds_read_b64_tr_b16 a[176:177], v238 offset:16384
  ds_read_b64_tr_b16 a[178:179], v238 offset:17408
  v_exp_f32 v212, v118
  v_add_f32 v214, v214, v210
  v_cvt_pk_bf16_f32 v154, v210, v211
  v_exp_f32 v213, v119
  v_mfma_f32_16x16x32_bf16 v[24:27], a[184:187], a[156:159], v[24:27]
  v_mfma_f32_16x16x32_bf16 v[28:31], a[188:191], a[156:159], v[28:31]
  ds_read_b64_tr_b16 a[180:181], v239 offset:16384
  ds_read_b64_tr_b16 a[182:183], v239 offset:17408
  v_add_f32 v214, v214, v211
  v_exp_f32 v208, v120
  v_add_f32 v214, v214, v212
  v_mfma_f32_16x16x32_bf16 v[20:23], a[188:191], a[152:155], v[20:23]
  s_waitcnt lgkmcnt(8)
  v_mfma_f32_16x16x32_bf16 v[32:35], a[160:163], a[144:147], v[32:35]
  ds_read_b64_tr_b16 a[184:185], v238 offset:24576
  ds_read_b64_tr_b16 a[186:187], v238 offset:25600
  v_cvt_pk_bf16_f32 v155, v212, v213
  v_exp_f32 v209, v121
  v_add_f32 v214, v214, v213
  v_mfma_f32_16x16x32_bf16 v[40:43], a[160:163], a[148:151], v[40:43]
  v_mfma_f32_16x16x32_bf16 v[44:47], a[164:167], a[148:151], v[44:47]
  ds_read_b64_tr_b16 a[188:189], v239 offset:24576
  ds_read_b64_tr_b16 a[190:191], v239 offset:25600
  v_exp_f32 v210, v122
  v_add_f32 v215, v215, v208
  v_cvt_pk_bf16_f32 v156, v208, v209
  v_exp_f32 v211, v123
  v_mfma_f32_16x16x32_bf16 v[36:39], a[164:167], a[144:147], v[36:39]
  s_waitcnt lgkmcnt(8)
  v_mfma_f32_16x16x32_bf16 v[32:35], a[168:171], a[152:155], v[32:35]
  s_waitcnt vmcnt(24)
  s_barrier
  ds_read_b64_tr_b16 a[160:161], v232 offset:32768
  ds_read_b64_tr_b16 a[162:163], v232 offset:33792
  v_add_f32 v215, v215, v209
  v_exp_f32 v212, v124
  v_mfma_f32_16x16x32_bf16 v[40:43], a[168:171], a[156:159], v[40:43]
  v_mfma_f32_16x16x32_bf16 v[44:47], a[172:175], a[156:159], v[44:47]
  ds_read_b64_tr_b16 a[164:165], v233 offset:32768
  ds_read_b64_tr_b16 a[166:167], v233 offset:33792
  s_add_u32 m0, s41, 147456
  s_nop 0
  buffer_load_dwordx4 v244, s[16:19], s34 offen offset:0 lds
  v_add_f32 v215, v215, v210
  v_mfma_f32_16x16x32_bf16 v[36:39], a[172:175], a[152:155], v[36:39]
  s_waitcnt lgkmcnt(8)
  v_mfma_f32_16x16x32_bf16 v[48:51], a[176:179], a[144:147], v[48:51]
  ds_read_b64_tr_b16 a[168:169], v234 offset:32768
  ds_read_b64_tr_b16 a[170:171], v234 offset:33792
  v_cvt_pk_bf16_f32 v157, v210, v211
  v_exp_f32 v213, v125
  v_add_f32 v215, v215, v211
  v_exp_f32 v208, v126
  v_mfma_f32_16x16x32_bf16 v[56:59], a[176:179], a[148:151], v[56:59]
  v_mfma_f32_16x16x32_bf16 v[60:63], a[180:183], a[148:151], v[60:63]
  ds_read_b64_tr_b16 a[172:173], v235 offset:32768
  ds_read_b64_tr_b16 a[174:175], v235 offset:33792
  v_add_f32 v215, v215, v212
  v_cvt_pk_bf16_f32 v158, v212, v213
  v_exp_f32 v209, v127
  v_mfma_f32_16x16x32_bf16 v[52:55], a[180:183], a[144:147], v[52:55]
  s_waitcnt lgkmcnt(8)
  v_mfma_f32_16x16x32_bf16 v[48:51], a[184:187], a[152:155], v[48:51]
  ds_read_b64_tr_b16 a[176:177], v236 offset:32768
  ds_read_b64_tr_b16 a[178:179], v236 offset:33792
  buffer_load_dwordx4 v245, s[16:19], s34 offen offset:1024 lds
  v_add_f32 v215, v215, v213
  v_add_f32 v215, v215, v208
  v_mfma_f32_16x16x32_bf16 v[56:59], a[184:187], a[156:159], v[56:59]
  v_mfma_f32_16x16x32_bf16 v[60:63], a[188:191], a[156:159], v[60:63]
  ds_read_b64_tr_b16 a[180:181], v237 offset:32768
  ds_read_b64_tr_b16 a[182:183], v237 offset:33792
  v_cvt_pk_bf16_f32 v159, v208, v209
  v_add_f32 v215, v215, v209
  v_add_f32 v210, v214, v215
  v_cmp_lt_f32 vcc, s35, v210
  v_mul_f32 v0, s42, v0
  v_mfma_f32_16x16x32_bf16 v[52:55], a[188:191], a[152:155], v[52:55]
  s_waitcnt lgkmcnt(8)
  v_mfma_f32_16x16x32_bf16 a[192:195], a[160:163], v[128:131], a[192:195]
  ds_read_b64_tr_b16 a[184:185], v238 offset:32768
  ds_read_b64_tr_b16 a[186:187], v238 offset:33792
  v_mul_f32 v1, s42, v1
  v_mul_f32 v2, s42, v2
  v_mul_f32 v3, s42, v3
  v_mul_f32 v4, s42, v4
  v_mfma_f32_16x16x32_bf16 a[200:203], a[160:163], v[132:135], a[200:203]
  v_mfma_f32_16x16x32_bf16 a[204:207], a[164:167], v[132:135], a[204:207]
  ds_read_b64_tr_b16 a[188:189], v239 offset:32768
  ds_read_b64_tr_b16 a[190:191], v239 offset:33792
  buffer_load_dwordx4 v246, s[16:19], s34 offen offset:2048 lds
  v_mul_f32 v5, s42, v5
  v_mul_f32 v6, s42, v6
  v_mfma_f32_16x16x32_bf16 a[196:199], a[164:167], v[128:131], a[196:199]
  s_waitcnt lgkmcnt(8)
  v_mfma_f32_16x16x32_bf16 a[208:211], a[168:171], v[128:131], a[208:211]
  ds_read_b64_tr_b16 a[160:161], v232 offset:40960
  ds_read_b64_tr_b16 a[162:163], v232 offset:41984
  v_mul_f32 v7, s42, v7
  v_mul_f32 v8, s42, v8
  v_mul_f32 v9, s42, v9
  v_mul_f32 v10, s42, v10
  v_mul_f32 v11, s42, v11
  v_mfma_f32_16x16x32_bf16 a[216:219], a[168:171], v[132:135], a[216:219]
  v_mfma_f32_16x16x32_bf16 a[220:223], a[172:175], v[132:135], a[220:223]
  ds_read_b64_tr_b16 a[164:165], v233 offset:40960
  ds_read_b64_tr_b16 a[166:167], v233 offset:41984
  v_mul_f32 v12, s42, v12
  v_mul_f32 v13, s42, v13
  v_mul_f32 v14, s42, v14
  v_mul_f32 v15, s42, v15
  v_cvt_pk_bf16_f32 v160, v0, v1
  v_mfma_f32_16x16x32_bf16 a[212:215], a[172:175], v[128:131], a[212:215]
  s_waitcnt lgkmcnt(8)
  v_mfma_f32_16x16x32_bf16 a[224:227], a[176:179], v[128:131], a[224:227]
  ds_read_b64_tr_b16 a[168:169], v234 offset:40960
  ds_read_b64_tr_b16 a[170:171], v234 offset:41984
  buffer_load_dwordx4 v247, s[16:19], s34 offen offset:3072 lds
  s_add_u32 s34, s34, 524288
  s_sub_u32 s38, s34, 5242880
  s_min_u32 s34, s34, s38
  v_cvt_pk_bf16_f32 v161, v2, v3
  v_mfma_f32_16x16x32_bf16 a[232:235], a[176:179], v[132:135], a[232:235]
  v_cvt_pk_bf16_f32 v162, v4, v5
  v_mfma_f32_16x16x32_bf16 a[236:239], a[180:183], v[132:135], a[236:239]
  ds_read_b64_tr_b16 a[172:173], v235 offset:40960
  ds_read_b64_tr_b16 a[174:175], v235 offset:41984
  v_cvt_pk_bf16_f32 v163, v6, v7
  v_cvt_pk_bf16_f32 v164, v8, v9
  v_cvt_pk_bf16_f32 v165, v10, v11
  v_cvt_pk_bf16_f32 v166, v12, v13
  v_cvt_pk_bf16_f32 v167, v14, v15
  v_mfma_f32_16x16x32_bf16 a[228:231], a[180:183], v[128:131], a[228:231]
  s_waitcnt lgkmcnt(8)
  v_mfma_f32_16x16x32_bf16 a[240:243], a[184:187], v[128:131], a[240:243]
  ds_read_b64_tr_b16 a[176:177], v236 offset:40960
  ds_read_b64_tr_b16 a[178:179], v236 offset:41984
  v_permlane16_swap_b32 v160, v162
  v_permlane16_swap_b32 v161, v163
  v_permlane16_swap_b32 v164, v166
  v_permlane16_swap_b32 v165, v167
  v_mfma_f32_16x16x32_bf16 a[248:251], a[184:187], v[132:135], a[248:251]
  v_mfma_f32_16x16x32_bf16 a[252:255], a[188:191], v[132:135], a[252:255]
  ds_read_b64_tr_b16 a[180:181], v237 offset:40960
  ds_read_b64_tr_b16 a[182:183], v237 offset:41984
  v_mul_f32 v16, s42, v16
  v_mul_f32 v17, s42, v17
  v_mul_f32 v18, s42, v18
  v_mul_f32 v19, s42, v19
  v_mul_f32 v20, s42, v20
  v_mfma_f32_16x16x32_bf16 a[244:247], a[188:191], v[128:131], a[244:247]
  s_waitcnt lgkmcnt(8)
  v_mfma_f32_16x16x32_bf16 a[192:195], a[160:163], v[136:139], a[192:195]
  ds_read_b64_tr_b16 a[184:185], v238 offset:40960
  ds_read_b64_tr_b16 a[186:187], v238 offset:41984
  v_mul_f32 v21, s42, v21
  v_mul_f32 v22, s42, v22
  v_mul_f32 v23, s42, v23
  v_mul_f32 v24, s42, v24
  v_mul_f32 v25, s42, v25
  v_mfma_f32_16x16x32_bf16 a[200:203], a[160:163], v[140:143], a[200:203]
  v_mfma_f32_16x16x32_bf16 a[204:207], a[164:167], v[140:143], a[204:207]
  ds_read_b64_tr_b16 a[188:189], v239 offset:40960
  ds_read_b64_tr_b16 a[190:191], v239 offset:41984
  v_mul_f32 v26, s42, v26
  v_mul_f32 v27, s42, v27
  v_mul_f32 v28, s42, v28
  v_mul_f32 v29, s42, v29
  v_mfma_f32_16x16x32_bf16 a[196:199], a[164:167], v[136:139], a[196:199]
  s_waitcnt lgkmcnt(8)
  v_mfma_f32_16x16x32_bf16 a[208:211], a[168:171], v[136:139], a[208:211]
  s_waitcnt vmcnt(20)
  s_barrier
  ds_read_b64_tr_b16 a[160:161], v232 offset:49152
  ds_read_b64_tr_b16 a[162:163], v232 offset:50176
  v_mul_f32 v30, s42, v30
  v_mul_f32 v31, s42, v31
  v_cvt_pk_bf16_f32 v168, v16, v17
  v_mfma_f32_16x16x32_bf16 a[216:219], a[168:171], v[140:143], a[216:219]
  v_mfma_f32_16x16x32_bf16 a[220:223], a[172:175], v[140:143], a[220:223]
  ds_read_b64_tr_b16 a[164:165], v233 offset:49152
  ds_read_b64_tr_b16 a[166:167], v233 offset:50176
  s_add_u32 m0, s41, 81920
  s_nop 0
  buffer_load_dwordx4 v244, s[16:19], s34 offen offset:0 lds
  v_cvt_pk_bf16_f32 v169, v18, v19
  v_cvt_pk_bf16_f32 v170, v20, v21
  v_mfma_f32_16x16x32_bf16 a[212:215], a[172:175], v[136:139], a[212:215]
  s_waitcnt lgkmcnt(8)
  v_mfma_f32_16x16x32_bf16 a[224:227], a[176:179], v[136:139], a[224:227]
  ds_read_b64_tr_b16 a[168:169], v234 offset:49152
  ds_read_b64_tr_b16 a[170:171], v234 offset:50176
  v_cvt_pk_bf16_f32 v171, v22, v23
  v_cvt_pk_bf16_f32 v172, v24, v25
  v_cvt_pk_bf16_f32 v173, v26, v27
  v_cvt_pk_bf16_f32 v174, v28, v29
  v_cvt_pk_bf16_f32 v175, v30, v31
  v_mfma_f32_16x16x32_bf16 a[232:235], a[176:179], v[140:143], a[232:235]
  v_mfma_f32_16x16x32_bf16 a[236:239], a[180:183], v[140:143], a[236:239]
  ds_read_b64_tr_b16 a[172:173], v235 offset:49152
  ds_read_b64_tr_b16 a[174:175], v235 offset:50176
  v_permlane16_swap_b32 v168, v170
  v_permlane16_swap_b32 v169, v171
  v_permlane16_swap_b32 v172, v174
  v_permlane16_swap_b32 v173, v175
  v_mul_f32 v32, s42, v32
  v_mfma_f32_16x16x32_bf16 a[228:231], a[180:183], v[136:139], a[228:231]
  s_waitcnt lgkmcnt(8)
  v_mfma_f32_16x16x32_bf16 a[240:243], a[184:187], v[136:139], a[240:243]
  ds_read_b64_tr_b16 a[176:177], v236 offset:49152
  ds_read_b64_tr_b16 a[178:179], v236 offset:50176
  buffer_load_dwordx4 v245, s[16:19], s34 offen offset:1024 lds
  v_mul_f32 v33, s42, v33
  v_mul_f32 v34, s42, v34
  v_mfma_f32_16x16x32_bf16 a[248:251], a[184:187], v[140:143], a[248:251]
  v_mfma_f32_16x16x32_bf16 a[252:255], a[188:191], v[140:143], a[252:255]
  ds_read_b64_tr_b16 a[180:181], v237 offset:49152
  ds_read_b64_tr_b16 a[182:183], v237 offset:50176
  v_mul_f32 v35, s42, v35
  v_mul_f32 v36, s42, v36
  v_mul_f32 v37, s42, v37
  v_mul_f32 v38, s42, v38
  v_mul_f32 v39, s42, v39
  v_mfma_f32_16x16x32_bf16 a[244:247], a[188:191], v[136:139], a[244:247]
  s_cbranch_vccnz SITE35
BACK35:
  s_waitcnt lgkmcnt(8)
  v_mfma_f32_16x16x32_bf16 a[192:195], a[160:163], v[144:147], a[192:195]
  ds_read_b64_tr_b16 a[184:185], v238 offset:49152
  ds_read_b64_tr_b16 a[186:187], v238 offset:50176
  v_add_f32 v249, v249, v214
  v_add_f32 v254, v254, v215
  s_add_u32 s40, s39, 256
  s_sub_u32 s38, s40, 1280
  s_min_u32 s40, s40, s38
  s_add_u32 s38, s40, 20480
  buffer_load_dwordx4 v[96:99], v253, s[20:23], s40 offen offset:0
  buffer_load_dwordx4 v[100:103], v253, s[20:23], s38 offen offset:0
  buffer_load_dwordx4 v[104:107], v253, s[20:23], s40 offen offset:64
  buffer_load_dwordx4 v[108:111], v253, s[20:23], s38 offen offset:64
  v_mfma_f32_16x16x32_bf16 a[200:203], a[160:163], v[148:151], a[200:203]
  v_mfma_f32_16x16x32_bf16 a[204:207], a[164:167], v[148:151], a[204:207]
  ds_read_b64_tr_b16 a[188:189], v239 offset:49152
  ds_read_b64_tr_b16 a[190:191], v239 offset:50176
  buffer_load_dwordx4 v246, s[16:19], s34 offen offset:2048 lds
  v_mfma_f32_16x16x32_bf16 a[196:199], a[164:167], v[144:147], a[196:199]
  s_waitcnt lgkmcnt(8)
  v_mfma_f32_16x16x32_bf16 a[208:211], a[168:171], v[144:147], a[208:211]
  ds_read_b64_tr_b16 a[160:161], v232 offset:57344
  ds_read_b64_tr_b16 a[162:163], v232 offset:58368
  v_mul_f32 v40, s42, v40
  v_mul_f32 v41, s42, v41
  v_mul_f32 v42, s42, v42
  v_mul_f32 v43, s42, v43
  v_mfma_f32_16x16x32_bf16 a[216:219], a[168:171], v[148:151], a[216:219]
  v_mfma_f32_16x16x32_bf16 a[220:223], a[172:175], v[148:151], a[220:223]
  ds_read_b64_tr_b16 a[164:165], v233 offset:57344
  ds_read_b64_tr_b16 a[166:167], v233 offset:58368
  v_mul_f32 v44, s42, v44
  v_mul_f32 v45, s42, v45
  v_mul_f32 v46, s42, v46
  v_mul_f32 v47, s42, v47
  v_cvt_pk_bf16_f32 v176, v32, v33
  v_mfma_f32_16x16x32_bf16 a[212:215], a[172:175], v[144:147], a[212:215]
  s_waitcnt lgkmcnt(8)
  v_mfma_f32_16x16x32_bf16 a[224:227], a[176:179], v[144:147], a[224:227]
  ds_read_b64_tr_b16 a[168:169], v234 offset:57344
  ds_read_b64_tr_b16 a[170:171], v234 offset:58368
  buffer_load_dwordx4 v247, s[16:19], s34 offen offset:3072 lds
  s_add_u32 s34, s34, 524288
  s_sub_u32 s38, s34, 5242880
  s_min_u32 s34, s34, s38
  s_add_u32 s40, s39, 384
  s_sub_u32 s38, s40, 1280
  s_min_u32 s40, s40, s38
  s_add_u32 s38, s40, 20480
  buffer_load_dwordx4 v[112:115], v253, s[20:23], s40 offen offset:0
  buffer_load_dwordx4 v[116:119], v253, s[20:23], s38 offen offset:0
  buffer_load_dwordx4 v[120:123], v253, s[20:23], s40 offen offset:64
  buffer_load_dwordx4 v[124:127], v253, s[20:23], s38 offen offset:64
  v_mfma_f32_16x16x32_bf16 a[232:235], a[176:179], v[148:151], a[232:235]
  v_mfma_f32_16x16x32_bf16 a[236:239], a[180:183], v[148:151], a[236:239]
  ds_read_b64_tr_b16 a[172:173], v235 offset:57344
  ds_read_b64_tr_b16 a[174:175], v235 offset:58368
  v_cvt_pk_bf16_f32 v177, v34, v35
  v_cvt_pk_bf16_f32 v178, v36, v37
  v_mfma_f32_16x16x32_bf16 a[228:231], a[180:183], v[144:147], a[228:231]
  s_waitcnt lgkmcnt(8)
  v_mfma_f32_16x16x32_bf16 a[240:243], a[184:187], v[144:147], a[240:243]
  ds_read_b64_tr_b16 a[176:177], v236 offset:57344
  ds_read_b64_tr_b16 a[178:179], v236 offset:58368
  v_cvt_pk_bf16_f32 v179, v38, v39
  v_cvt_pk_bf16_f32 v180, v40, v41
  v_cvt_pk_bf16_f32 v181, v42, v43
  v_cvt_pk_bf16_f32 v182, v44, v45
  v_cvt_pk_bf16_f32 v183, v46, v47
  v_mfma_f32_16x16x32_bf16 a[248:251], a[184:187], v[148:151], a[248:251]
  v_mfma_f32_16x16x32_bf16 a[252:255], a[188:191], v[148:151], a[252:255]
  ds_read_b64_tr_b16 a[180:181], v237 offset:57344
  ds_read_b64_tr_b16 a[182:183], v237 offset:58368
  v_permlane16_swap_b32 v176, v178
  v_permlane16_swap_b32 v177, v179
  v_permlane16_swap_b32 v180, v182
  v_permlane16_swap_b32 v181, v183
  v_mfma_f32_16x16x32_bf16 a[244:247], a[188:191], v[144:147], a[244:247]
  s_waitcnt lgkmcnt(8)
  v_mfma_f32_16x16x32_bf16 a[192:195], a[160:163], v[152:155], a[192:195]
  ds_read_b64_tr_b16 a[184:185], v238 offset:57344
  ds_read_b64_tr_b16 a[186:187], v238 offset:58368
  v_mul_f32 v48, s42, v48
  v_mul_f32 v49, s42, v49
  v_mul_f32 v50, s42, v50
  v_mul_f32 v51, s42, v51
  v_mul_f32 v52, s42, v52
  v_mfma_f32_16x16x32_bf16 a[200:203], a[160:163], v[156:159], a[200:203]
  v_mfma_f32_16x16x32_bf16 a[204:207], a[164:167], v[156:159], a[204:207]
  ds_read_b64_tr_b16 a[188:189], v239 offset:57344
  ds_read_b64_tr_b16 a[190:191], v239 offset:58368
  v_mul_f32 v53, s42, v53
  v_mul_f32 v54, s42, v54
  v_mul_f32 v55, s42, v55
  v_mul_f32 v56, s42, v56
  v_mfma_f32_16x16x32_bf16 a[196:199], a[164:167], v[152:155], a[196:199]
  s_waitcnt lgkmcnt(8)
  v_mfma_f32_16x16x32_bf16 a[208:211], a[168:171], v[152:155], a[208:211]
  s_barrier
  ds_read_b128 a[160:163], v224 offset:0
  v_mul_f32 v57, s42, v57
  v_mul_f32 v58, s42, v58
  v_mul_f32 v59, s42, v59
  v_mul_f32 v60, s42, v60
  v_mul_f32 v61, s42, v61
  v_mfma_f32_16x16x32_bf16 a[216:219], a[168:171], v[156:159], a[216:219]
  v_mfma_f32_16x16x32_bf16 a[220:223], a[172:175], v[156:159], a[220:223]
  ds_read_b128 a[164:167], v224 offset:4096
  s_add_u32 m0, s41, 98304
  s_nop 0
  buffer_load_dwordx4 v248, s[12:15], s33 offen offset:0 nt lds
  v_mul_f32 v62, s42, v62
  v_mul_f32 v63, s42, v63
  v_mfma_f32_16x16x32_bf16 a[212:215], a[172:175], v[152:155], a[212:215]
  s_waitcnt lgkmcnt(6)
  v_mfma_f32_16x16x32_bf16 a[224:227], a[176:179], v[152:155], a[224:227]
  ds_read_b128 a[168:171], v225 offset:0
  v_cvt_pk_bf16_f32 v184, v48, v49
  v_cvt_pk_bf16_f32 v185, v50, v51
  v_cvt_pk_bf16_f32 v186, v52, v53
  v_cvt_pk_bf16_f32 v187, v54, v55
  v_cvt_pk_bf16_f32 v188, v56, v57
  v_cvt_pk_bf16_f32 v189, v58, v59
  v_mfma_f32_16x16x32_bf16 a[232:235], a[176:179], v[156:159], a[232:235]
  v_mfma_f32_16x16x32_bf16 a[236:239], a[180:183], v[156:159], a[236:239]
  ds_read_b128 a[172:175], v225 offset:4096
  v_cvt_pk_bf16_f32 v190, v60, v61
  v_cvt_pk_bf16_f32 v191, v62, v63
  v_permlane16_swap_b32 v184, v186
  v_permlane16_swap_b32 v185, v187
  v_permlane16_swap_b32 v188, v190
  v_mfma_f32_16x16x32_bf16 a[228:231], a[180:183], v[152:155], a[228:231]
  s_waitcnt lgkmcnt(4)
  v_mfma_f32_16x16x32_bf16 a[240:243], a[184:187], v[152:155], a[240:243]
  ds_read_b128 a[176:179], v226 offset:0
  buffer_load_dwordx4 v248, s[12:15], s33 offen offset:1024 nt lds
  v_permlane16_swap_b32 v189, v191
  v_mfma_f32_16x16x32_bf16 a[248:251], a[184:187], v[156:159], a[248:251]
  v_mfma_f32_16x16x32_bf16 a[252:255], a[188:191], v[156:159], a[252:255]
  ds_read_b128 a[180:183], v226 offset:4096
  v_mfma_f32_16x16x32_bf16 a[244:247], a[188:191], v[152:155], a[244:247]
  s_waitcnt lgkmcnt(4)
  v_mfma_f32_16x16x32_bf16 v[64:67], a[160:163], v[160:163], 0
  ds_read_b128 a[184:187], v227 offset:0
  v_mov_b32 v216, v249
  v_mov_b32 v217, v254
  s_nop 1
  v_permlane16_swap_b32 v216, v217
  v_add_f32 v216, v216, v217
  v_mov_b32 v217, v216
  v_mfma_f32_16x16x32_bf16 v[72:75], a[160:163], v[164:167], 0
  v_mfma_f32_16x16x32_bf16 v[76:79], a[164:167], v[164:167], 0
  ds_read_b128 a[188:191], v227 offset:4096
  buffer_load_dwordx4 v248, s[12:15], s33 offen offset:2048 nt lds
  v_permlane32_swap_b32 v216, v217
  v_add_f32 v216, v216, v217
  v_mfma_f32_16x16x32_bf16 v[68:71], a[164:167], v[160:163], 0
  s_waitcnt lgkmcnt(4)
  v_mfma_f32_16x16x32_bf16 v[64:67], a[168:171], v[168:171], v[64:67]
  ds_read_b128 a[160:163], v224 offset:2048
  v_rcp_f32 v250, v216
  s_nop 0
  v_mov_b32 v255, v250
  s_nop 1
  v_permlane16_swap_b32 v250, v255
  v_mfma_f32_16x16x32_bf16 v[72:75], a[168:171], v[172:175], v[72:75]
  v_mfma_f32_16x16x32_bf16 v[76:79], a[172:175], v[172:175], v[76:79]
  ds_read_b128 a[164:167], v224 offset:6144
  v_accvgpr_read_b32 v220, a196
  v_accvgpr_read_b32 v221, a197
  v_accvgpr_read_b32 v222, a198
  v_accvgpr_read_b32 v223, a199
  v_accvgpr_read_b32 v216, a192
  v_mfma_f32_16x16x32_bf16 v[68:71], a[172:175], v[168:171], v[68:71]
  s_waitcnt lgkmcnt(4)
  v_mfma_f32_16x16x32_bf16 v[64:67], a[176:179], v[176:179], v[64:67]
  ds_read_b128 a[168:171], v225 offset:2048
  buffer_load_dwordx4 v248, s[12:15], s33 offen offset:3072 nt lds
  s_add_u32 s33, s33, 0x4000
  v_accvgpr_read_b32 v217, a193
  v_accvgpr_read_b32 v218, a194
  v_mfma_f32_16x16x32_bf16 v[72:75], a[176:179], v[180:183], v[72:75]
  v_mfma_f32_16x16x32_bf16 v[76:79], a[180:183], v[180:183], v[76:79]
  ds_read_b128 a[172:175], v225 offset:6144
  v_accvgpr_read_b32 v219, a195
  v_mul_f32 v220, v250, v220
  v_mul_f32 v221, v250, v221
  v_mul_f32 v222, v250, v222
  v_mul_f32 v223, v250, v223
  v_mul_f32 v216, v250, v216
  v_mfma_f32_16x16x32_bf16 v[68:71], a[180:183], v[176:179], v[68:71]
  s_waitcnt lgkmcnt(4)
  v_mfma_f32_16x16x32_bf16 v[64:67], a[184:187], v[184:187], v[64:67]
  ds_read_b128 a[176:179], v226 offset:2048
  v_mul_f32 v217, v250, v217
  v_mul_f32 v218, v250, v218
  v_mul_f32 v219, v250, v219
  v_cvt_pk_bf16_f32 v216, v216, v217
  v_cvt_pk_bf16_f32 v217, v218, v219
  v_mfma_f32_16x16x32_bf16 v[72:75], a[184:187], v[188:191], v[72:75]
  v_mfma_f32_16x16x32_bf16 v[76:79], a[188:191], v[188:191], v[76:79]
  ds_read_b128 a[180:183], v226 offset:6144
  v_cvt_pk_bf16_f32 v218, v220, v221
  v_cvt_pk_bf16_f32 v219, v222, v223
  s_nop 0
  v_permlane16_swap_b32 v216, v218
  v_permlane16_swap_b32 v217, v219
  v_accvgpr_write_b32 a32, v216
  v_mfma_f32_16x16x32_bf16 v[68:71], a[188:191], v[184:187], v[68:71]
  s_waitcnt lgkmcnt(4)
  v_mfma_f32_16x16x32_bf16 v[80:83], a[160:163], v[160:163], 0
  ds_read_b128 a[184:187], v227 offset:2048
  v_accvgpr_write_b32 a33, v217
  v_accvgpr_write_b32 a34, v218
  v_accvgpr_write_b32 a35, v219
  v_accvgpr_read_b32 v220, a204
  v_accvgpr_read_b32 v221, a205
  v_mfma_f32_16x16x32_bf16 v[88:91], a[160:163], v[164:167], 0
  v_mfma_f32_16x16x32_bf16 v[92:95], a[164:167], v[164:167], 0
  ds_read_b128 a[188:191], v227 offset:6144
  v_accvgpr_read_b32 v222, a206
  v_accvgpr_read_b32 v223, a207
  v_accvgpr_read_b32 v216, a200
  v_accvgpr_read_b32 v217, a201
  v_accvgpr_read_b32 v218, a202
  v_accvgpr_read_b32 v219, a203
  v_mfma_f32_16x16x32_bf16 v[84:87], a[164:167], v[160:163], 0
  s_waitcnt lgkmcnt(4)
  v_mfma_f32_16x16x32_bf16 v[80:83], a[168:171], v[168:171], v[80:83]
  s_waitcnt vmcnt(28)
  s_barrier
  ds_read_b64_tr_b16 a[160:161], v232 offset:0
  ds_read_b64_tr_b16 a[162:163], v232 offset:1024
  v_mul_f32 v220, v255, v220
  v_mul_f32 v221, v255, v221
  v_mul_f32 v222, v255, v222
  v_mfma_f32_16x16x32_bf16 v[88:91], a[168:171], v[172:175], v[88:91]
  v_mfma_f32_16x16x32_bf16 v[92:95], a[172:175], v[172:175], v[92:95]
  ds_read_b64_tr_b16 a[164:165], v233 offset:0
  ds_read_b64_tr_b16 a[166:167], v233 offset:1024
  s_add_u32 m0, s41, 114688
  s_nop 0
  buffer_load_dwordx4 v244, s[16:19], s34 offen offset:0 lds
  v_mul_f32 v223, v255, v223
  v_mul_f32 v216, v255, v216
  v_mfma_f32_16x16x32_bf16 v[84:87], a[172:175], v[168:171], v[84:87]
  s_waitcnt lgkmcnt(6)
  v_mfma_f32_16x16x32_bf16 v[80:83], a[176:179], v[176:179], v[80:83]
  ds_read_b64_tr_b16 a[168:169], v234 offset:0
  ds_read_b64_tr_b16 a[170:171], v234 offset:1024
  v_mul_f32 v217, v255, v217
  v_mul_f32 v218, v255, v218
  v_mul_f32 v219, v255, v219
  v_cvt_pk_bf16_f32 v216, v216, v217
  v_cvt_pk_bf16_f32 v217, v218, v219
  v_mfma_f32_16x16x32_bf16 v[88:91], a[176:179], v[180:183], v[88:91]
  v_mfma_f32_16x16x32_bf16 v[92:95], a[180:183], v[180:183], v[92:95]
  ds_read_b64_tr_b16 a[172:173], v235 offset:0
  ds_read_b64_tr_b16 a[174:175], v235 offset:1024
  v_cvt_pk_bf16_f32 v218, v220, v221
  v_cvt_pk_bf16_f32 v219, v222, v223
  s_nop 0
  v_permlane16_swap_b32 v216, v218
  v_mfma_f32_16x16x32_bf16 v[84:87], a[180:183], v[176:179], v[84:87]
  s_waitcnt lgkmcnt(8)
  v_mfma_f32_16x16x32_bf16 v[80:83], a[184:187], v[184:187], v[80:83]
  ds_read_b64_tr_b16 a[176:177], v236 offset:0
  ds_read_b64_tr_b16 a[178:179], v236 offset:1024
  buffer_load_dwordx4 v245, s[16:19], s34 offen offset:1024 lds
  v_permlane16_swap_b32 v217, v219
  v_accvgpr_write_b32 a36, v216
  v_mfma_f32_16x16x32_bf16 v[88:91], a[184:187], v[188:191], v[88:91]
  v_mfma_f32_16x16x32_bf16 v[92:95], a[188:191], v[188:191], v[92:95]
  ds_read_b64_tr_b16 a[180:181], v237 offset:0
  ds_read_b64_tr_b16 a[182:183], v237 offset:1024
  v_accvgpr_write_b32 a37, v217
  v_accvgpr_write_b32 a38, v218
  v_accvgpr_write_b32 a39, v219
  v_accvgpr_read_b32 v220, a212
  v_accvgpr_read_b32 v221, a213
  v_mfma_f32_16x16x32_bf16 v[84:87], a[188:191], v[184:187], v[84:87]
  s_waitcnt lgkmcnt(8)
  v_mfma_f32_16x16x32_bf16 v[0:3], a[160:163], a[0:3], 0
  ds_read_b64_tr_b16 a[184:185], v238 offset:0
  ds_read_b64_tr_b16 a[186:187], v238 offset:1024
  v_accvgpr_read_b32 v222, a214
  v_accvgpr_read_b32 v223, a215
  v_accvgpr_read_b32 v216, a208
  v_accvgpr_read_b32 v217, a209
  v_accvgpr_read_b32 v218, a210
  v_mfma_f32_16x16x32_bf16 v[8:11], a[160:163], a[4:7], 0
  v_mfma_f32_16x16x32_bf16 v[12:15], a[164:167], a[4:7], 0
  ds_read_b64_tr_b16 a[188:189], v239 offset:0
  ds_read_b64_tr_b16 a[190:191], v239 offset:1024
  buffer_load_dwordx4 v246, s[16:19], s34 offen offset:2048 lds
  v_accvgpr_read_b32 v219, a211
  v_mul_f32 v220, v250, v220
  v_mfma_f32_16x16x32_bf16 v[4:7], a[164:167], a[0:3], 0
  s_waitcnt lgkmcnt(8)
  v_mfma_f32_16x16x32_bf16 v[16:19], a[168:171], a[0:3], 0
  ds_read_b64_tr_b16 a[160:161], v232 offset:8192
  ds_read_b64_tr_b16 a[162:163], v232 offset:9216
  v_max3_f32 v214, v64, v65, v66
  v_max3_f32 v215, v72, v73, v74
  v_max3_f32 v214, v214, v67, v68
  v_max3_f32 v215, v215, v75, v76
  v_max3_f32 v214, v214, v69, v70
  v_mfma_f32_16x16x32_bf16 v[24:27], a[168:171], a[4:7], 0
  v_mfma_f32_16x16x32_bf16 v[28:31], a[172:175], a[4:7], 0
  ds_read_b64_tr_b16 a[164:165], v233 offset:8192
  ds_read_b64_tr_b16 a[166:167], v233 offset:9216
  v_max3_f32 v215, v215, v77, v78
  v_max3_f32 v214, v214, v71, v80
  v_max3_f32 v215, v215, v79, v88
  v_max3_f32 v214, v214, v81, v82
  v_mfma_f32_16x16x32_bf16 v[20:23], a[172:175], a[0:3], 0
  s_waitcnt lgkmcnt(8)
  v_mfma_f32_16x16x32_bf16 v[32:35], a[176:179], a[0:3], 0
  ds_read_b64_tr_b16 a[168:169], v234 offset:8192
  ds_read_b64_tr_b16 a[170:171], v234 offset:9216
  buffer_load_dwordx4 v247, s[16:19], s34 offen offset:3072 lds
  s_add_u32 s34, s34, 524288
  s_sub_u32 s38, s34, 5242880
  s_min_u32 s34, s34, s38
  v_max3_f32 v215, v215, v89, v90
  v_mfma_f32_16x16x32_bf16 v[40:43], a[176:179], a[4:7], 0
  v_max3_f32 v214, v214, v83, v84
  v_max3_f32 v215, v215, v91, v92
  v_mfma_f32_16x16x32_bf16 v[44:47], a[180:183], a[4:7], 0
  ds_read_b64_tr_b16 a[172:173], v235 offset:8192
  ds_read_b64_tr_b16 a[174:175], v235 offset:9216
  v_max3_f32 v214, v214, v85, v86
  v_max3_f32 v215, v215, v93, v94
  v_max_f32 v214, v214, v87
  v_max_f32 v215, v215, v95
  v_mfma_f32_16x16x32_bf16 v[36:39], a[180:183], a[0:3], 0
  s_waitcnt lgkmcnt(8)
  v_mfma_f32_16x16x32_bf16 v[48:51], a[184:187], a[0:3], 0
  ds_read_b64_tr_b16 a[176:177], v236 offset:8192
  ds_read_b64_tr_b16 a[178:179], v236 offset:9216
  v_permlane16_swap_b32 v214, v215
  v_max_f32 v214, v214, v215
  v_mov_b32 v215, v214
  s_nop 1
  v_permlane32_swap_b32 v214, v215
  v_mfma_f32_16x16x32_bf16 v[56:59], a[184:187], a[4:7], 0
  v_mfma_f32_16x16x32_bf16 v[60:63], a[188:191], a[4:7], 0
  ds_read_b64_tr_b16 a[180:181], v237 offset:8192
  ds_read_b64_tr_b16 a[182:183], v237 offset:9216
  v_min_f32 v192, -v214, -v215
  v_mov_b32 v196, v192
  s_nop 1
  v_permlane16_swap_b32 v192, v196
  v_mfma_f32_16x16x32_bf16 v[52:55], a[188:191], a[0:3], 0
  s_waitcnt lgkmcnt(8)
  v_mfma_f32_16x16x32_bf16 v[0:3], a[160:163], a[8:11], v[0:3]
  ds_read_b64_tr_b16 a[184:185], v238 offset:8192
  ds_read_b64_tr_b16 a[186:187], v238 offset:9216
  v_mov_b32 v193, v192
  v_mov_b32 v194, v192
  v_mov_b32 v195, v192
  v_mfma_f32_16x16x32_bf16 v[8:11], a[160:163], a[12:15], v[8:11]
  v_mfma_f32_16x16x32_bf16 v[12:15], a[164:167], a[12:15], v[12:15]
  ds_read_b64_tr_b16 a[188:189], v239 offset:8192
  ds_read_b64_tr_b16 a[190:191], v239 offset:9216
  v_mov_b32 v197, v196
  v_mov_b32 v198, v196
  v_mov_b32 v199, v196
  v_mul_f32 v221, v250, v221
  v_mul_f32 v222, v250, v222
  v_mfma_f32_16x16x32_bf16 v[4:7], a[164:167], a[8:11], v[4:7]
  s_waitcnt lgkmcnt(8)
  v_mfma_f32_16x16x32_bf16 v[16:19], a[168:171], a[8:11], v[16:19]
  s_waitcnt vmcnt(28)
  s_barrier
  ds_read_b64_tr_b16 a[160:161], v200 offset:0
  ds_read_b64_tr_b16 a[162:163], v200 offset:1024
  v_mul_f32 v223, v250, v223
  v_mul_f32 v216, v250, v216
  v_mul_f32 v217, v250, v217
  v_mfma_f32_16x16x32_bf16 v[24:27], a[168:171], a[12:15], v[24:27]
  v_mfma_f32_16x16x32_bf16 v[28:31], a[172:175], a[12:15], v[28:31]
  ds_read_b64_tr_b16 a[164:165], v201 offset:0
  ds_read_b64_tr_b16 a[166:167], v201 offset:1024
  s_add_u32 m0, s41, 0
  s_nop 0
  buffer_load_dwordx4 v240, s[8:11], s32 offen offset:0 nt lds
  v_mul_f32 v218, v250, v218
  v_mul_f32 v219, v250, v219
  v_mfma_f32_16x16x32_bf16 v[20:23], a[172:175], a[8:11], v[20:23]
  s_waitcnt lgkmcnt(8)
  v_mfma_f32_16x16x32_bf16 v[32:35], a[176:179], a[8:11], v[32:35]
  ds_read_b64_tr_b16 a[168:169], v202 offset:0
  ds_read_b64_tr_b16 a[170:171], v202 offset:1024
  v_cvt_pk_bf16_f32 v216, v216, v217
  v_cvt_pk_bf16_f32 v217, v218, v219
  v_cvt_pk_bf16_f32 v218, v220, v221
  v_cvt_pk_bf16_f32 v219, v222, v223
  s_nop 0
  v_permlane16_swap_b32 v216, v218
  v_mfma_f32_16x16x32_bf16 v[40:43], a[176:179], a[12:15], v[40:43]
  v_mfma_f32_16x16x32_bf16 v[44:47], a[180:183], a[12:15], v[44:47]
  ds_read_b64_tr_b16 a[172:173], v203 offset:0
  ds_read_b64_tr_b16 a[174:175], v203 offset:1024
  v_permlane16_swap_b32 v217, v219
  v_accvgpr_write_b32 a40, v216
  v_accvgpr_write_b32 a41, v217
  v_mfma_f32_16x16x32_bf16 v[36:39], a[180:183], a[8:11], v[36:39]
  s_waitcnt lgkmcnt(8)
  v_mfma_f32_16x16x32_bf16 v[48:51], a[184:187], a[8:11], v[48:51]
  ds_read_b64_tr_b16 a[176:177], v204 offset:0
  ds_read_b64_tr_b16 a[178:179], v204 offset:1024
  buffer_load_dwordx4 v241, s[8:11], s32 offen offset:1024 nt lds
  v_accvgpr_write_b32 a42, v218
  v_accvgpr_write_b32 a43, v219
  v_accvgpr_read_b32 v220, a220
  v_mfma_f32_16x16x32_bf16 v[56:59], a[184:187], a[12:15], v[56:59]
  v_mfma_f32_16x16x32_bf16 v[60:63], a[188:191], a[12:15], v[60:63]
  ds_read_b64_tr_b16 a[180:181], v205 offset:0
  ds_read_b64_tr_b16 a[182:183], v205 offset:1024
  v_accvgpr_read_b32 v221, a221
  v_accvgpr_read_b32 v222, a222
  v_accvgpr_read_b32 v223, a223
  v_accvgpr_read_b32 v216, a216
  v_mfma_f32_16x16x32_bf16 v[52:55], a[188:191], a[8:11], v[52:55]
  s_waitcnt lgkmcnt(8)
  v_mfma_f32_16x16x32_bf16 v[0:3], a[160:163], a[16:19], v[0:3]
  ds_read_b64_tr_b16 a[184:185], v206 offset:0
  ds_read_b64_tr_b16 a[186:187], v206 offset:1024
  v_accvgpr_read_b32 v217, a217
  v_accvgpr_read_b32 v218, a218
  v_accvgpr_read_b32 v219, a219
  v_mul_f32 v220, v255, v220
  v_mul_f32 v221, v255, v221
  v_mfma_f32_16x16x32_bf16 v[8:11], a[160:163], a[20:23], v[8:11]
  v_mfma_f32_16x16x32_bf16 v[12:15], a[164:167], a[20:23], v[12:15]
  ds_read_b64_tr_b16 a[188:189], v207 offset:0
  ds_read_b64_tr_b16 a[190:191], v207 offset:1024
  buffer_load_dwordx4 v242, s[8:11], s32 offen offset:2048 nt lds
  v_mul_f32 v222, v255, v222
  v_mul_f32 v223, v255, v223
  v_mfma_f32_16x16x32_bf16 v[4:7], a[164:167], a[16:19], v[4:7]
  s_waitcnt lgkmcnt(8)
  v_mfma_f32_16x16x32_bf16 v[16:19], a[168:171], a[16:19], v[16:19]
  ds_read_b64_tr_b16 a[160:161], v200 offset:8192
  ds_read_b64_tr_b16 a[162:163], v200 offset:9216
  v_mul_f32 v216, v255, v216
  v_mul_f32 v217, v255, v217
  v_mul_f32 v218, v255, v218
  v_mul_f32 v219, v255, v219
  v_cvt_pk_bf16_f32 v216, v216, v217
  v_mfma_f32_16x16x32_bf16 v[24:27], a[168:171], a[20:23], v[24:27]
  v_mfma_f32_16x16x32_bf16 v[28:31], a[172:175], a[20:23], v[28:31]
  ds_read_b64_tr_b16 a[164:165], v201 offset:8192
  ds_read_b64_tr_b16 a[166:167], v201 offset:9216
  v_cvt_pk_bf16_f32 v217, v218, v219
  v_cvt_pk_bf16_f32 v218, v220, v221
  v_cvt_pk_bf16_f32 v219, v222, v223
  s_nop 0
  v_permlane16_swap_b32 v216, v218
  v_mfma_f32_16x16x32_bf16 v[20:23], a[172:175], a[16:19], v[20:23]
  s_waitcnt lgkmcnt(8)
  v_mfma_f32_16x16x32_bf16 v[32:35], a[176:179], a[16:19], v[32:35]
  ds_read_b64_tr_b16 a[168:169], v202 offset:8192
  ds_read_b64_tr_b16 a[170:171], v202 offset:9216
  buffer_load_dwordx4 v243, s[8:11], s32 offen offset:3072 nt lds
  s_add_u32 s32, s32, 0x4000
  v_permlane16_swap_b32 v217, v219
  v_accvgpr_write_b32 a44, v216
  v_mfma_f32_16x16x32_bf16 v[40:43], a[176:179], a[20:23], v[40:43]
  v_mfma_f32_16x16x32_bf16 v[44:47], a[180:183], a[20:23], v[44:47]
  ds_read_b64_tr_b16 a[172:173], v203 offset:8192
  ds_read_b64_tr_b16 a[174:175], v203 offset:9216
  v_accvgpr_write_b32 a45, v217
  v_accvgpr_write_b32 a46, v218
  v_accvgpr_write_b32 a47, v219
  v_accvgpr_read_b32 v220, a228
  v_accvgpr_read_b32 v221, a229
  v_mfma_f32_16x16x32_bf16 v[36:39], a[180:183], a[16:19], v[36:39]
  s_waitcnt lgkmcnt(8)
  v_mfma_f32_16x16x32_bf16 v[48:51], a[184:187], a[16:19], v[48:51]
  ds_read_b64_tr_b16 a[176:177], v204 offset:8192
  ds_read_b64_tr_b16 a[178:179], v204 offset:9216
  v_accvgpr_read_b32 v222, a230
  v_accvgpr_read_b32 v223, a231
  v_accvgpr_read_b32 v216, a224
  v_accvgpr_read_b32 v217, a225
  v_accvgpr_read_b32 v218, a226
  v_mfma_f32_16x16x32_bf16 v[56:59], a[184:187], a[20:23], v[56:59]
  v_mfma_f32_16x16x32_bf16 v[60:63], a[188:191], a[20:23], v[60:63]
  ds_read_b64_tr_b16 a[180:181], v205 offset:8192
  ds_read_b64_tr_b16 a[182:183], v205 offset:9216
  v_accvgpr_read_b32 v219, a227
  v_mul_f32 v220, v250, v220
  v_mul_f32 v221, v250, v221
  v_mul_f32 v222, v250, v222
  v_mfma_f32_16x16x32_bf16 v[52:55], a[188:191], a[16:19], v[52:55]
  s_waitcnt lgkmcnt(8)
  v_mfma_f32_16x16x32_bf16 v[0:3], a[160:163], a[24:27], v[0:3]
  ds_read_b64_tr_b16 a[184:185], v206 offset:8192
  ds_read_b64_tr_b16 a[186:187], v206 offset:9216
  v_mul_f32 v223, v250, v223
  v_mul_f32 v216, v250, v216
  v_mul_f32 v217, v250, v217
  v_mul_f32 v218, v250, v218
  v_mul_f32 v219, v250, v219
  v_mfma_f32_16x16x32_bf16 v[8:11], a[160:163], a[28:31], v[8:11]
  v_mfma_f32_16x16x32_bf16 v[12:15], a[164:167], a[28:31], v[12:15]
  ds_read_b64_tr_b16 a[188:189], v207 offset:8192
  ds_read_b64_tr_b16 a[190:191], v207 offset:9216
  v_cvt_pk_bf16_f32 v216, v216, v217
  v_cvt_pk_bf16_f32 v217, v218, v219
  v_cvt_pk_bf16_f32 v218, v220, v221
  v_cvt_pk_bf16_f32 v219, v222, v223
  s_nop 0
  v_permlane16_swap_b32 v216, v218
  v_mfma_f32_16x16x32_bf16 v[4:7], a[164:167], a[24:27], v[4:7]
  s_waitcnt lgkmcnt(8)
  v_mfma_f32_16x16x32_bf16 v[16:19], a[168:171], a[24:27], v[16:19]
  s_waitcnt vmcnt(24)
  s_barrier
  ds_read_b64_tr_b16 a[160:161], v200 offset:16384
  ds_read_b64_tr_b16 a[162:163], v200 offset:17408
  v_permlane16_swap_b32 v217, v219
  v_accvgpr_write_b32 a48, v216
  v_mfma_f32_16x16x32_bf16 v[24:27], a[168:171], a[28:31], v[24:27]
  v_mfma_f32_16x16x32_bf16 v[28:31], a[172:175], a[28:31], v[28:31]
  ds_read_b64_tr_b16 a[164:165], v201 offset:16384
  ds_read_b64_tr_b16 a[166:167], v201 offset:17408
  s_add_u32 m0, s41, 65536
  s_nop 0
  buffer_load_dwordx4 v248, s[12:15], s33 offen offset:0 nt lds
  v_accvgpr_write_b32 a49, v217
  v_accvgpr_write_b32 a50, v218
  v_mfma_f32_16x16x32_bf16 v[20:23], a[172:175], a[24:27], v[20:23]
  s_waitcnt lgkmcnt(8)
  v_mfma_f32_16x16x32_bf16 v[32:35], a[176:179], a[24:27], v[32:35]
  ds_read_b64_tr_b16 a[168:169], v202 offset:16384
  ds_read_b64_tr_b16 a[170:171], v202 offset:17408
  v_accvgpr_write_b32 a51, v219
  v_accvgpr_read_b32 v220, a236
  v_accvgpr_read_b32 v221, a237
  v_accvgpr_read_b32 v222, a238
  v_accvgpr_read_b32 v223, a239
  v_mfma_f32_16x16x32_bf16 v[40:43], a[176:179], a[28:31], v[40:43]
  v_mfma_f32_16x16x32_bf16 v[44:47], a[180:183], a[28:31], v[44:47]
  ds_read_b64_tr_b16 a[172:173], v203 offset:16384
  ds_read_b64_tr_b16 a[174:175], v203 offset:17408
  v_accvgpr_read_b32 v216, a232
  v_accvgpr_read_b32 v217, a233
  v_accvgpr_read_b32 v218, a234
  v_accvgpr_read_b32 v219, a235
  v_mul_f32 v220, v255, v220
  v_mfma_f32_16x16x32_bf16 v[36:39], a[180:183], a[24:27], v[36:39]
  s_waitcnt lgkmcnt(8)
  v_mfma_f32_16x16x32_bf16 v[48:51], a[184:187], a[24:27], v[48:51]
  ds_read_b64_tr_b16 a[176:177], v204 offset:16384
  ds_read_b64_tr_b16 a[178:179], v204 offset:17408
  buffer_load_dwordx4 v248, s[12:15], s33 offen offset:1024 nt lds
  v_mul_f32 v221, v255, v221
  v_mul_f32 v222, v255, v222
  v_mfma_f32_16x16x32_bf16 v[56:59], a[184:187], a[28:31], v[56:59]
  v_mfma_f32_16x16x32_bf16 v[60:63], a[188:191], a[28:31], v[60:63]
  ds_read_b64_tr_b16 a[180:181], v205 offset:16384
  ds_read_b64_tr_b16 a[182:183], v205 offset:17408
  v_mul_f32 v223, v255, v223
  v_mul_f32 v216, v255, v216
  v_mul_f32 v217, v255, v217
  v_mul_f32 v218, v255, v218
  v_mul_f32 v219, v255, v219
  v_mfma_f32_16x16x32_bf16 v[52:55], a[188:191], a[24:27], v[52:55]
  s_waitcnt lgkmcnt(8)
  s_waitcnt vmcnt(23)
  v_mfma_f32_16x16x32_bf16 v[0:3], a[160:163], v[96:99], v[0:3]
  ds_read_b64_tr_b16 a[184:185], v206 offset:16384
  ds_read_b64_tr_b16 a[186:187], v206 offset:17408
  v_cvt_pk_bf16_f32 v216, v216, v217
  v_cvt_pk_bf16_f32 v217, v218, v219
  v_cvt_pk_bf16_f32 v218, v220, v221
  v_cvt_pk_bf16_f32 v219, v222, v223
  s_waitcnt vmcnt(22)
  v_mfma_f32_16x16x32_bf16 v[8:11], a[160:163], v[100:103], v[8:11]
  v_mfma_f32_16x16x32_bf16 v[12:15], a[164:167], v[100:103], v[12:15]
  ds_read_b64_tr_b16 a[188:189], v207 offset:16384
  ds_read_b64_tr_b16 a[190:191], v207 offset:17408
  buffer_load_dwordx4 v248, s[12:15], s33 offen offset:2048 nt lds
  v_permlane16_swap_b32 v216, v218
  v_permlane16_swap_b32 v217, v219
  v_accvgpr_write_b32 a52, v216
  v_mfma_f32_16x16x32_bf16 v[4:7], a[164:167], v[96:99], v[4:7]
  s_waitcnt lgkmcnt(8)
  v_mfma_f32_16x16x32_bf16 v[16:19], a[168:171], v[96:99], v[16:19]
  ds_read_b64_tr_b16 a[160:161], v200 offset:24576
  ds_read_b64_tr_b16 a[162:163], v200 offset:25600
  v_accvgpr_write_b32 a53, v217
  v_accvgpr_write_b32 a54, v218
  v_accvgpr_write_b32 a55, v219
  v_accvgpr_read_b32 v220, a244
  v_mfma_f32_16x16x32_bf16 v[24:27], a[168:171], v[100:103], v[24:27]
  v_mfma_f32_16x16x32_bf16 v[28:31], a[172:175], v[100:103], v[28:31]
  ds_read_b64_tr_b16 a[164:165], v201 offset:24576
  ds_read_b64_tr_b16 a[166:167], v201 offset:25600
  v_accvgpr_read_b32 v221, a245
  v_accvgpr_read_b32 v222, a246
  v_accvgpr_read_b32 v223, a247
  v_accvgpr_read_b32 v216, a240
  v_accvgpr_read_b32 v217, a241
  v_mfma_f32_16x16x32_bf16 v[20:23], a[172:175], v[96:99], v[20:23]
  s_waitcnt lgkmcnt(8)
  v_mfma_f32_16x16x32_bf16 v[32:35], a[176:179], v[96:99], v[32:35]
  ds_read_b64_tr_b16 a[168:169], v202 offset:24576
  ds_read_b64_tr_b16 a[170:171], v202 offset:25600
  buffer_load_dwordx4 v248, s[12:15], s33 offen offset:3072 nt lds
  s_add_u32 s33, s33, 0x4000
  v_accvgpr_read_b32 v218, a242
  v_accvgpr_read_b32 v219, a243
  v_mfma_f32_16x16x32_bf16 v[40:43], a[176:179], v[100:103], v[40:43]
  v_mfma_f32_16x16x32_bf16 v[44:47], a[180:183], v[100:103], v[44:47]
  ds_read_b64_tr_b16 a[172:173], v203 offset:24576
  ds_read_b64_tr_b16 a[174:175], v203 offset:25600
  v_mul_f32 v220, v250, v220
  v_mul_f32 v221, v250, v221
  v_mul_f32 v222, v250, v222
  v_mul_f32 v223, v250, v223
  v_mul_f32 v216, v250, v216
  v_mfma_f32_16x16x32_bf16 v[36:39], a[180:183], v[96:99], v[36:39]
  s_waitcnt lgkmcnt(8)
  v_mfma_f32_16x16x32_bf16 v[48:51], a[184:187], v[96:99], v[48:51]
  ds_read_b64_tr_b16 a[176:177], v204 offset:24576
  ds_read_b64_tr_b16 a[178:179], v204 offset:25600
  v_mul_f32 v217, v250, v217
  v_mul_f32 v218, v250, v218
  v_mul_f32 v219, v250, v219
  v_cvt_pk_bf16_f32 v216, v216, v217
  v_cvt_pk_bf16_f32 v217, v218, v219
  v_mfma_f32_16x16x32_bf16 v[56:59], a[184:187], v[100:103], v[56:59]
  v_mfma_f32_16x16x32_bf16 v[60:63], a[188:191], v[100:103], v[60:63]
  ds_read_b64_tr_b16 a[180:181], v205 offset:24576
  ds_read_b64_tr_b16 a[182:183], v205 offset:25600
  v_cvt_pk_bf16_f32 v218, v220, v221
  v_cvt_pk_bf16_f32 v219, v222, v223
  s_nop 0
  v_permlane16_swap_b32 v216, v218
  v_permlane16_swap_b32 v217, v219
  v_mfma_f32_16x16x32_bf16 v[52:55], a[188:191], v[96:99], v[52:55]
  s_waitcnt lgkmcnt(8)
  s_waitcnt vmcnt(23)
  v_mfma_f32_16x16x32_bf16 v[0:3], a[160:163], v[104:107], v[0:3]
  ds_read_b64_tr_b16 a[184:185], v206 offset:24576
  ds_read_b64_tr_b16 a[186:187], v206 offset:25600
  v_accvgpr_write_b32 a56, v216
  v_accvgpr_write_b32 a57, v217
  v_accvgpr_write_b32 a58, v218
  v_accvgpr_write_b32 a59, v219
  v_accvgpr_read_b32 v220, a252
  s_waitcnt vmcnt(22)
  v_mfma_f32_16x16x32_bf16 v[8:11], a[160:163], v[108:111], v[8:11]
  v_mfma_f32_16x16x32_bf16 v[12:15], a[164:167], v[108:111], v[12:15]
  ds_read_b64_tr_b16 a[188:189], v207 offset:24576
  ds_read_b64_tr_b16 a[190:191], v207 offset:25600
  v_accvgpr_read_b32 v221, a253
  v_accvgpr_read_b32 v222, a254
  v_accvgpr_read_b32 v223, a255
  v_accvgpr_read_b32 v216, a248
  v_mfma_f32_16x16x32_bf16 v[4:7], a[164:167], v[104:107], v[4:7]
  s_waitcnt lgkmcnt(8)
  v_mfma_f32_16x16x32_bf16 v[16:19], a[168:171], v[104:107], v[16:19]
  s_waitcnt vmcnt(20)
  s_barrier
  ds_read_b64_tr_b16 a[160:161], v232 offset:16384
  ds_read_b64_tr_b16 a[162:163], v232 offset:17408
  v_accvgpr_read_b32 v217, a249
  v_accvgpr_read_b32 v218, a250
  v_accvgpr_read_b32 v219, a251
  v_mfma_f32_16x16x32_bf16 v[24:27], a[168:171], v[108:111], v[24:27]
  v_mfma_f32_16x16x32_bf16 v[28:31], a[172:175], v[108:111], v[28:31]
  ds_read_b64_tr_b16 a[164:165], v233 offset:16384
  ds_read_b64_tr_b16 a[166:167], v233 offset:17408
  s_add_u32 m0, s41, 131072
  s_nop 0
  buffer_load_dwordx4 v244, s[16:19], s34 offen offset:0 lds
  v_mul_f32 v220, v255, v220
  v_mul_f32 v221, v255, v221
  v_mfma_f32_16x16x32_bf16 v[20:23], a[172:175], v[104:107], v[20:23]
  v_mul_f32 v222, v255, v222
  s_waitcnt lgkmcnt(8)
  v_mfma_f32_16x16x32_bf16 v[32:35], a[176:179], v[104:107], v[32:35]
  ds_read_b64_tr_b16 a[168:169], v234 offset:16384
  ds_read_b64_tr_b16 a[170:171], v234 offset:17408
  v_mul_f32 v223, v255, v223
  v_mul_f32 v216, v255, v216
  v_mul_f32 v217, v255, v217
  v_mul_f32 v218, v255, v218
  v_mfma_f32_16x16x32_bf16 v[40:43], a[176:179], v[108:111], v[40:43]
  v_mfma_f32_16x16x32_bf16 v[44:47], a[180:183], v[108:111], v[44:47]
  ds_read_b64_tr_b16 a[172:173], v235 offset:16384
  ds_read_b64_tr_b16 a[174:175], v235 offset:17408
  v_mul_f32 v219, v255, v219
  v_cvt_pk_bf16_f32 v216, v216, v217
  v_cvt_pk_bf16_f32 v217, v218, v219
  v_cvt_pk_bf16_f32 v218, v220, v221
  v_cvt_pk_bf16_f32 v219, v222, v223
  v_mfma_f32_16x16x32_bf16 v[36:39], a[180:183], v[104:107], v[36:39]
  s_waitcnt lgkmcnt(8)
  v_mfma_f32_16x16x32_bf16 v[48:51], a[184:187], v[104:107], v[48:51]
  ds_read_b64_tr_b16 a[176:177], v236 offset:16384
  ds_read_b64_tr_b16 a[178:179], v236 offset:17408
  buffer_load_dwordx4 v245, s[16:19], s34 offen offset:1024 lds
  v_permlane16_swap_b32 v216, v218
  v_permlane16_swap_b32 v217, v219
  v_mfma_f32_16x16x32_bf16 v[56:59], a[184:187], v[108:111], v[56:59]
  v_mfma_f32_16x16x32_bf16 v[60:63], a[188:191], v[108:111], v[60:63]
  ds_read_b64_tr_b16 a[180:181], v237 offset:16384
  ds_read_b64_tr_b16 a[182:183], v237 offset:17408
  v_accvgpr_write_b32 a60, v216
  v_accvgpr_write_b32 a61, v217
  v_accvgpr_write_b32 a62, v218
  v_accvgpr_write_b32 a63, v219
  v_add_f32 v208, v64, v192
  v_mfma_f32_16x16x32_bf16 v[52:55], a[188:191], v[104:107], v[52:55]
  s_waitcnt lgkmcnt(8)
  s_waitcnt vmcnt(21)
  v_mfma_f32_16x16x32_bf16 v[0:3], a[160:163], v[112:115], v[0:3]
  ds_read_b64_tr_b16 a[184:185], v238 offset:16384
  ds_read_b64_tr_b16 a[186:187], v238 offset:17408
  v_add_f32 v209, v65, v192
  v_exp_f32 v208, v208
  v_exp_f32 v209, v209
  s_waitcnt vmcnt(20)
  v_mfma_f32_16x16x32_bf16 v[8:11], a[160:163], v[116:119], v[8:11]
  v_mfma_f32_16x16x32_bf16 v[12:15], a[164:167], v[116:119], v[12:15]
  ds_read_b64_tr_b16 a[188:189], v239 offset:16384
  ds_read_b64_tr_b16 a[190:191], v239 offset:17408
  buffer_load_dwordx4 v246, s[16:19], s34 offen offset:2048 lds
  v_add_f32 v210, v66, v192
  v_add_f32 v211, v67, v192
  v_mfma_f32_16x16x32_bf16 v[4:7], a[164:167], v[112:115], v[4:7]
  s_waitcnt lgkmcnt(8)
  v_mfma_f32_16x16x32_bf16 v[16:19], a[168:171], v[112:115], v[16:19]
  ds_read_b64_tr_b16 a[160:161], v232 offset:24576
  ds_read_b64_tr_b16 a[162:163], v232 offset:25600
  v_exp_f32 v210, v210
  v_exp_f32 v211, v211
  v_add_f32 v214, v208, v209
  v_mfma_f32_16x16x32_bf16 v[24:27], a[168:171], v[116:119], v[24:27]
  v_mfma_f32_16x16x32_bf16 v[28:31], a[172:175], v[116:119], v[28:31]
  ds_read_b64_tr_b16 a[164:165], v233 offset:24576
  ds_read_b64_tr_b16 a[166:167], v233 offset:25600
  v_cvt_pk_bf16_f32 v128, v208, v209
  v_add_f32 v212, v68, v192
  v_add_f32 v213, v69, v192
  v_exp_f32 v212, v212
  v_mfma_f32_16x16x32_bf16 v[20:23], a[172:175], v[112:115], v[20:23]
  s_waitcnt lgkmcnt(8)
  v_mfma_f32_16x16x32_bf16 v[32:35], a[176:179], v[112:115], v[32:35]
  ds_read_b64_tr_b16 a[168:169], v234 offset:24576
  ds_read_b64_tr_b16 a[170:171], v234 offset:25600
  buffer_load_dwordx4 v247, s[16:19], s34 offen offset:3072 lds
  s_add_u32 s34, s34, 524288
  s_sub_u32 s38, s34, 5242880
  s_min_u32 s34, s34, s38
  v_exp_f32 v213, v213
  v_mfma_f32_16x16x32_bf16 v[40:43], a[176:179], v[116:119], v[40:43]
  v_mfma_f32_16x16x32_bf16 v[44:47], a[180:183], v[116:119], v[44:47]
  ds_read_b64_tr_b16 a[172:173], v235 offset:24576
  ds_read_b64_tr_b16 a[174:175], v235 offset:25600
  v_add_f32 v214, v214, v210
  v_add_f32 v214, v214, v211
  v_cvt_pk_bf16_f32 v129, v210, v211
  v_add_f32 v208, v70, v192
  v_add_f32 v209, v71, v192
  v_mfma_f32_16x16x32_bf16 v[36:39], a[180:183], v[112:115], v[36:39]
  s_waitcnt lgkmcnt(8)
  v_mfma_f32_16x16x32_bf16 v[48:51], a[184:187], v[112:115], v[48:51]
  ds_read_b64_tr_b16 a[176:177], v236 offset:24576
  ds_read_b64_tr_b16 a[178:179], v236 offset:25600
  v_exp_f32 v208, v208
  v_exp_f32 v209, v209
  v_add_f32 v214, v214, v212
  v_mfma_f32_16x16x32_bf16 v[56:59], a[184:187], v[116:119], v[56:59]
  v_mfma_f32_16x16x32_bf16 v[60:63], a[188:191], v[116:119], v[60:63]
  ds_read_b64_tr_b16 a[180:181], v237 offset:24576
  ds_read_b64_tr_b16 a[182:183], v237 offset:25600
  v_add_f32 v214, v214, v213
  v_cvt_pk_bf16_f32 v130, v212, v213
  v_add_f32 v210, v72, v196
  v_add_f32 v211, v73, v196
  v_mfma_f32_16x16x32_bf16 v[52:55], a[188:191], v[112:115], v[52:55]
  s_waitcnt lgkmcnt(8)
  s_waitcnt vmcnt(21)
  v_mfma_f32_16x16x32_bf16 v[0:3], a[160:163], v[120:123], v[0:3]
  ds_read_b64_tr_b16 a[184:185], v238 offset:24576
  ds_read_b64_tr_b16 a[186:187], v238 offset:25600
  v_exp_f32 v210, v210
  v_exp_f32 v211, v211
  v_add_f32 v214, v214, v208
  v_add_f32 v214, v214, v209
  s_waitcnt vmcnt(20)
  v_mfma_f32_16x16x32_bf16 v[8:11], a[160:163], v[124:127], v[8:11]
  v_mfma_f32_16x16x32_bf16 v[12:15], a[164:167], v[124:127], v[12:15]
  ds_read_b64_tr_b16 a[188:189], v239 offset:24576
  ds_read_b64_tr_b16 a[190:191], v239 offset:25600
  v_cvt_pk_bf16_f32 v131, v208, v209
  v_add_f32 v212, v74, v196
  v_add_f32 v213, v75, v196
  v_exp_f32 v212, v212
  v_mfma_f32_16x16x32_bf16 v[4:7], a[164:167], v[120:123], v[4:7]
  s_waitcnt lgkmcnt(8)
  v_mfma_f32_16x16x32_bf16 v[16:19], a[168:171], v[120:123], v[16:19]
  s_barrier
  ds_read_b128 a[160:163], v224 offset:16384
  v_exp_f32 v213, v213
  v_add_f32 v215, v210, v211
  v_cvt_pk_bf16_f32 v132, v210, v211
  v_mfma_f32_16x16x32_bf16 v[24:27], a[168:171], v[124:127], v[24:27]
  v_mfma_f32_16x16x32_bf16 v[28:31], a[172:175], v[124:127], v[28:31]
  ds_read_b128 a[164:167], v224 offset:20480
  s_add_u32 m0, s41, 147456
  s_nop 0
  buffer_load_dwordx4 v248, s[12:15], s33 offen offset:0 nt lds
  v_add_f32 v208, v76, v196
  v_add_f32 v209, v77, v196
  v_mfma_f32_16x16x32_bf16 v[20:23], a[172:175], v[120:123], v[20:23]
  s_waitcnt lgkmcnt(6)
  v_mfma_f32_16x16x32_bf16 v[32:35], a[176:179], v[120:123], v[32:35]
  ds_read_b128 a[168:171], v225 offset:16384
  v_exp_f32 v208, v208
  v_exp_f32 v209, v209
  v_add_f32 v215, v215, v212
  v_add_f32 v215, v215, v213
  v_mfma_f32_16x16x32_bf16 v[40:43], a[176:179], v[124:127], v[40:43]
  v_mfma_f32_16x16x32_bf16 v[44:47], a[180:183], v[124:127], v[44:47]
  ds_read_b128 a[172:175], v225 offset:20480
  v_cvt_pk_bf16_f32 v133, v212, v213
  v_add_f32 v210, v78, v196
  v_add_f32 v211, v79, v196
  v_exp_f32 v210, v210
  v_exp_f32 v211, v211
  v_mfma_f32_16x16x32_bf16 v[36:39], a[180:183], v[120:123], v[36:39]
  s_waitcnt lgkmcnt(4)
  v_mfma_f32_16x16x32_bf16 v[48:51], a[184:187], v[120:123], v[48:51]
  ds_read_b128 a[176:179], v226 offset:16384
  buffer_load_dwordx4 v248, s[12:15], s33 offen offset:1024 nt lds
  v_add_f32 v215, v215, v208
  v_mfma_f32_16x16x32_bf16 v[56:59], a[184:187], v[124:127], v[56:59]
  v_mfma_f32_16x16x32_bf16 v[60:63], a[188:191], v[124:127], v[60:63]
  ds_read_b128 a[180:183], v226 offset:20480
  v_add_f32 v215, v215, v209
  v_cvt_pk_bf16_f32 v134, v208, v209
  v_add_f32 v212, v80, v192
  v_add_f32 v213, v81, v192
  v_exp_f32 v212, v212
  v_mfma_f32_16x16x32_bf16 v[52:55], a[188:191], v[120:123], v[52:55]
  s_waitcnt lgkmcnt(4)
  v_mfma_f32_16x16x32_bf16 v[96:99], a[160:163], v[160:163], v[192:195]
  ds_read_b128 a[184:187], v227 offset:16384
  v_exp_f32 v213, v213
  v_add_f32 v215, v215, v210
  v_add_f32 v215, v215, v211
  v_cvt_pk_bf16_f32 v135, v210, v211
  v_add_f32 v208, v82, v192
  v_mfma_f32_16x16x32_bf16 v[104:107], a[160:163], v[164:167], v[196:199]
  v_mfma_f32_16x16x32_bf16 v[108:111], a[164:167], v[164:167], v[196:199]
  ds_read_b128 a[188:191], v227 offset:20480
  buffer_load_dwordx4 v248, s[12:15], s33 offen offset:2048 nt lds
  v_add_f32 v209, v83, v192
  v_exp_f32 v208, v208
  v_mfma_f32_16x16x32_bf16 v[100:103], a[164:167], v[160:163], v[192:195]
  s_waitcnt lgkmcnt(4)
  v_mfma_f32_16x16x32_bf16 v[96:99], a[168:171], v[168:171], v[96:99]
  ds_read_b128 a[160:163], v224 offset:18432
  v_exp_f32 v209, v209
  v_add_f32 v214, v214, v212
  v_add_f32 v214, v214, v213
  v_cvt_pk_bf16_f32 v136, v212, v213
  v_mfma_f32_16x16x32_bf16 v[104:107], a[168:171], v[172:175], v[104:107]
  v_mfma_f32_16x16x32_bf16 v[108:111], a[172:175], v[172:175], v[108:111]
  ds_read_b128 a[164:167], v224 offset:22528
  v_add_f32 v210, v84, v192
  v_add_f32 v211, v85, v192
  v_exp_f32 v210, v210
  v_exp_f32 v211, v211
  v_mfma_f32_16x16x32_bf16 v[100:103], a[172:175], v[168:171], v[100:103]
  s_waitcnt lgkmcnt(4)
  v_mfma_f32_16x16x32_bf16 v[96:99], a[176:179], v[176:179], v[96:99]
  ds_read_b128 a[168:171], v225 offset:18432
  buffer_load_dwordx4 v248, s[12:15], s33 offen offset:3072 nt lds
  s_add_u32 s33, s33, 0x4000
  v_add_f32 v214, v214, v208
  v_add_f32 v214, v214, v209
  v_mfma_f32_16x16x32_bf16 v[104:107], a[176:179], v[180:183], v[104:107]
  v_mfma_f32_16x16x32_bf16 v[108:111], a[180:183], v[180:183], v[108:111]
  ds_read_b128 a[172:175], v225 offset:22528
  v_cvt_pk_bf16_f32 v137, v208, v209
  v_add_f32 v212, v86, v192
  v_add_f32 v213, v87, v192
  v_exp_f32 v212, v212
  v_mfma_f32_16x16x32_bf16 v[100:103], a[180:183], v[176:179], v[100:103]
  s_waitcnt lgkmcnt(4)
  v_mfma_f32_16x16x32_bf16 v[96:99], a[184:187], v[184:187], v[96:99]
  ds_read_b128 a[176:179], v226 offset:18432
  v_exp_f32 v213, v213
  v_add_f32 v214, v214, v210
  v_add_f32 v214, v214, v211
  v_cvt_pk_bf16_f32 v138, v210, v211
  v_add_f32 v208, v88, v196
  v_add_f32 v209, v89, v196
  v_mfma_f32_16x16x32_bf16 v[104:107], a[184:187], v[188:191], v[104:107]
  v_mfma_f32_16x16x32_bf16 v[108:111], a[188:191], v[188:191], v[108:111]
  ds_read_b128 a[180:183], v226 offset:22528
  v_exp_f32 v208, v208
  v_exp_f32 v209, v209
  v_add_f32 v214, v214, v212
  v_add_f32 v214, v214, v213
  v_mfma_f32_16x16x32_bf16 v[100:103], a[188:191], v[184:187], v[100:103]
  s_waitcnt lgkmcnt(4)
  v_mfma_f32_16x16x32_bf16 v[112:115], a[160:163], v[160:163], v[192:195]
  ds_read_b128 a[184:187], v227 offset:18432
  v_cvt_pk_bf16_f32 v139, v212, v213
  v_add_f32 v210, v90, v196
  v_add_f32 v211, v91, v196
  v_exp_f32 v210, v210
  v_mfma_f32_16x16x32_bf16 v[120:123], a[160:163], v[164:167], v[196:199]
  v_mfma_f32_16x16x32_bf16 v[124:127], a[164:167], v[164:167], v[196:199]
  ds_read_b128 a[188:191], v227 offset:22528
  v_exp_f32 v211, v211
  v_add_f32 v215, v215, v208
  v_add_f32 v215, v215, v209
  v_cvt_pk_bf16_f32 v140, v208, v209
  v_add_f32 v212, v92, v196
  v_mfma_f32_16x16x32_bf16 v[116:119], a[164:167], v[160:163], v[192:195]
  s_waitcnt lgkmcnt(4)
  v_mfma_f32_16x16x32_bf16 v[112:115], a[168:171], v[168:171], v[112:115]
  s_waitcnt vmcnt(20)
  s_barrier
  ds_read_b64_tr_b16 a[160:161], v232 offset:32768
  ds_read_b64_tr_b16 a[162:163], v232 offset:33792
  v_add_f32 v213, v93, v196
  v_exp_f32 v212, v212
  v_mfma_f32_16x16x32_bf16 v[120:123], a[168:171], v[172:175], v[120:123]
  v_mfma_f32_16x16x32_bf16 v[124:127], a[172:175], v[172:175], v[124:127]
  ds_read_b64_tr_b16 a[164:165], v233 offset:32768
  ds_read_b64_tr_b16 a[166:167], v233 offset:33792
  s_add_u32 m0, s41, 81920
  s_nop 0
  buffer_load_dwordx4 v244, s[16:19], s34 offen offset:0 lds
  v_exp_f32 v213, v213
  v_mfma_f32_16x16x32_bf16 v[116:119], a[172:175], v[168:171], v[116:119]
  s_waitcnt lgkmcnt(6)
  v_mfma_f32_16x16x32_bf16 v[112:115], a[176:179], v[176:179], v[112:115]
  ds_read_b64_tr_b16 a[168:169], v234 offset:32768
  ds_read_b64_tr_b16 a[170:171], v234 offset:33792
  v_add_f32 v215, v215, v210
  v_add_f32 v215, v215, v211
  v_cvt_pk_bf16_f32 v141, v210, v211
  v_add_f32 v208, v94, v196
  v_add_f32 v209, v95, v196
  v_mfma_f32_16x16x32_bf16 v[120:123], a[176:179], v[180:183], v[120:123]
  v_mfma_f32_16x16x32_bf16 v[124:127], a[180:183], v[180:183], v[124:127]
  ds_read_b64_tr_b16 a[172:173], v235 offset:32768
  ds_read_b64_tr_b16 a[174:175], v235 offset:33792
  v_exp_f32 v208, v208
  v_exp_f32 v209, v209
  v_add_f32 v215, v215, v212
  v_mfma_f32_16x16x32_bf16 v[116:119], a[180:183], v[176:179], v[116:119]
  s_waitcnt lgkmcnt(8)
  v_mfma_f32_16x16x32_bf16 v[112:115], a[184:187], v[184:187], v[112:115]
  ds_read_b64_tr_b16 a[176:177], v236 offset:32768
  ds_read_b64_tr_b16 a[178:179], v236 offset:33792
  buffer_load_dwordx4 v245, s[16:19], s34 offen offset:1024 lds
  v_add_f32 v215, v215, v213
  v_cvt_pk_bf16_f32 v142, v212, v213
  v_mfma_f32_16x16x32_bf16 v[120:123], a[184:187], v[188:191], v[120:123]
  v_mfma_f32_16x16x32_bf16 v[124:127], a[188:191], v[188:191], v[124:127]
  ds_read_b64_tr_b16 a[180:181], v237 offset:32768
  ds_read_b64_tr_b16 a[182:183], v237 offset:33792
  v_add_f32 v215, v215, v208
  v_add_f32 v215, v215, v209
  v_cvt_pk_bf16_f32 v143, v208, v209
  v_mov_b32 v249, v214
  v_mov_b32 v254, v215
  v_mfma_f32_16x16x32_bf16 v[116:119], a[188:191], v[184:187], v[116:119]
  s_waitcnt lgkmcnt(8)
  v_mfma_f32_16x16x32_bf16 a[192:195], a[160:163], v[128:131], 0
  ds_read_b64_tr_b16 a[184:185], v238 offset:32768
  ds_read_b64_tr_b16 a[186:187], v238 offset:33792
  v_mfma_f32_16x16x32_bf16 a[200:203], a[160:163], v[132:135], 0
  v_mfma_f32_16x16x32_bf16 a[204:207], a[164:167], v[132:135], 0
  ds_read_b64_tr_b16 a[188:189], v239 offset:32768
  ds_read_b64_tr_b16 a[190:191], v239 offset:33792
  buffer_load_dwordx4 v246, s[16:19], s34 offen offset:2048 lds
  v_mfma_f32_16x16x32_bf16 a[196:199], a[164:167], v[128:131], 0
  s_waitcnt lgkmcnt(8)
  v_mfma_f32_16x16x32_bf16 a[208:211], a[168:171], v[128:131], 0
  ds_read_b64_tr_b16 a[160:161], v232 offset:40960
  ds_read_b64_tr_b16 a[162:163], v232 offset:41984
  v_exp_f32 v208, v96
  v_exp_f32 v209, v97
  v_mfma_f32_16x16x32_bf16 a[216:219], a[168:171], v[132:135], 0
  v_mfma_f32_16x16x32_bf16 a[220:223], a[172:175], v[132:135], 0
  ds_read_b64_tr_b16 a[164:165], v233 offset:40960
  ds_read_b64_tr_b16 a[166:167], v233 offset:41984
  v_exp_f32 v210, v98
  v_cvt_pk_bf16_f32 v144, v208, v209
  v_mfma_f32_16x16x32_bf16 a[212:215], a[172:175], v[128:131], 0
  s_waitcnt lgkmcnt(8)
  v_mfma_f32_16x16x32_bf16 a[224:227], a[176:179], v[128:131], 0
  ds_read_b64_tr_b16 a[168:169], v234 offset:40960
  ds_read_b64_tr_b16 a[170:171], v234 offset:41984
  buffer_load_dwordx4 v247, s[16:19], s34 offen offset:3072 lds
  s_add_u32 s34, s34, 524288
  s_sub_u32 s38, s34, 5242880
  s_min_u32 s34, s34, s38
  v_mfma_f32_16x16x32_bf16 a[232:235], a[176:179], v[132:135], 0
  v_mfma_f32_16x16x32_bf16 a[236:239], a[180:183], v[132:135], 0
  ds_read_b64_tr_b16 a[172:173], v235 offset:40960
  ds_read_b64_tr_b16 a[174:175], v235 offset:41984
  v_exp_f32 v211, v99
  v_add_f32 v214, v208, v209
  v_mfma_f32_16x16x32_bf16 a[228:231], a[180:183], v[128:131], 0
  s_waitcnt lgkmcnt(8)
  v_mfma_f32_16x16x32_bf16 a[240:243], a[184:187], v[128:131], 0
  ds_read_b64_tr_b16 a[176:177], v236 offset:40960
  ds_read_b64_tr_b16 a[178:179], v236 offset:41984
  v_exp_f32 v212, v100
  v_add_f32 v214, v214, v210
  v_cvt_pk_bf16_f32 v145, v210, v211
  v_mfma_f32_16x16x32_bf16 a[248:251], a[184:187], v[132:135], 0
  v_mfma_f32_16x16x32_bf16 a[252:255], a[188:191], v[132:135], 0
  ds_read_b64_tr_b16 a[180:181], v237 offset:40960
  ds_read_b64_tr_b16 a[182:183], v237 offset:41984
  v_exp_f32 v213, v101
  v_mfma_f32_16x16x32_bf16 a[244:247], a[188:191], v[128:131], 0
  s_waitcnt lgkmcnt(8)
  v_mfma_f32_16x16x32_bf16 a[192:195], a[160:163], v[136:139], a[192:195]
  ds_read_b64_tr_b16 a[184:185], v238 offset:40960
  ds_read_b64_tr_b16 a[186:187], v238 offset:41984
  v_add_f32 v214, v214, v211
  v_exp_f32 v208, v102
  v_mfma_f32_16x16x32_bf16 a[200:203], a[160:163], v[140:143], a[200:203]
  v_mfma_f32_16x16x32_bf16 a[204:207], a[164:167], v[140:143], a[204:207]
  ds_read_b64_tr_b16 a[188:189], v239 offset:40960
  ds_read_b64_tr_b16 a[190:191], v239 offset:41984
  v_add_f32 v214, v214, v212
  v_cvt_pk_bf16_f32 v146, v212, v213
  v_exp_f32 v209, v103
  v_mfma_f32_16x16x32_bf16 a[196:199], a[164:167], v[136:139], a[196:199]
  s_waitcnt lgkmcnt(8)
  v_mfma_f32_16x16x32_bf16 a[208:211], a[168:171], v[136:139], a[208:211]
  s_barrier
  ds_read_b128 a[160:163], v224 offset:32768
  v_add_f32 v214, v214, v213
  v_mfma_f32_16x16x32_bf16 a[216:219], a[168:171], v[140:143], a[216:219]
  v_mfma_f32_16x16x32_bf16 a[220:223], a[172:175], v[140:143], a[220:223]
  ds_read_b128 a[164:167], v224 offset:36864
  s_add_u32 m0, s41, 16384
  s_nop 0
  buffer_load_dwordx4 v240, s[8:11], s32 offen offset:0 nt lds
  v_exp_f32 v210, v104
  v_mfma_f32_16x16x32_bf16 a[212:215], a[172:175], v[136:139], a[212:215]
  s_waitcnt lgkmcnt(6)
  v_mfma_f32_16x16x32_bf16 a[224:227], a[176:179], v[136:139], a[224:227]
  ds_read_b128 a[168:171], v225 offset:32768
  v_add_f32 v214, v214, v208
  v_cvt_pk_bf16_f32 v147, v208, v209
  v_exp_f32 v211, v105
  v_mfma_f32_16x16x32_bf16 a[232:235], a[176:179], v[140:143], a[232:235]
  v_mfma_f32_16x16x32_bf16 a[236:239], a[180:183], v[140:143], a[236:239]
  ds_read_b128 a[172:175], v225 offset:36864
  v_add_f32 v214, v214, v209
  v_exp_f32 v212, v106
  v_mfma_f32_16x16x32_bf16 a[228:231], a[180:183], v[136:139], a[228:231]
  s_waitcnt lgkmcnt(4)
  v_mfma_f32_16x16x32_bf16 a[240:243], a[184:187], v[136:139], a[240:243]
  ds_read_b128 a[176:179], v226 offset:32768
  buffer_load_dwordx4 v241, s[8:11], s32 offen offset:1024 nt lds
  v_mfma_f32_16x16x32_bf16 a[248:251], a[184:187], v[140:143], a[248:251]
  v_mfma_f32_16x16x32_bf16 a[252:255], a[188:191], v[140:143], a[252:255]
  ds_read_b128 a[180:183], v226 offset:36864
  v_cvt_pk_bf16_f32 v148, v210, v211
  v_exp_f32 v213, v107
  v_add_f32 v215, v210, v211
  v_mfma_f32_16x16x32_bf16 a[244:247], a[188:191], v[136:139], a[244:247]
  s_waitcnt lgkmcnt(4)
  v_mfma_f32_16x16x32_bf16 v[64:67], a[160:163], v[160:163], v[192:195]
  ds_read_b128 a[184:187], v227 offset:32768
  v_exp_f32 v208, v108
  v_add_f32 v215, v215, v212
  v_cvt_pk_bf16_f32 v149, v212, v213
  v_mfma_f32_16x16x32_bf16 v[72:75], a[160:163], v[164:167], v[196:199]
  v_mfma_f32_16x16x32_bf16 v[76:79], a[164:167], v[164:167], v[196:199]
  ds_read_b128 a[188:191], v227 offset:36864
  buffer_load_dwordx4 v242, s[8:11], s32 offen offset:2048 nt lds
  v_mfma_f32_16x16x32_bf16 v[68:71], a[164:167], v[160:163], v[192:195]
  s_waitcnt lgkmcnt(4)
  v_mfma_f32_16x16x32_bf16 v[64:67], a[168:171], v[168:171], v[64:67]
  ds_read_b128 a[160:163], v224 offset:34816
  v_exp_f32 v209, v109
  v_add_f32 v215, v215, v213
  v_exp_f32 v210, v110
  v_mfma_f32_16x16x32_bf16 v[72:75], a[168:171], v[172:175], v[72:75]
  v_mfma_f32_16x16x32_bf16 v[76:79], a[172:175], v[172:175], v[76:79]
  ds_read_b128 a[164:167], v224 offset:38912
  v_add_f32 v215, v215, v208
  v_cvt_pk_bf16_f32 v150, v208, v209
  v_exp_f32 v211, v111
  v_mfma_f32_16x16x32_bf16 v[68:71], a[172:175], v[168:171], v[68:71]
  s_waitcnt lgkmcnt(4)
  v_mfma_f32_16x16x32_bf16 v[64:67], a[176:179], v[176:179], v[64:67]
  ds_read_b128 a[168:171], v225 offset:34816
  buffer_load_dwordx4 v243, s[8:11], s32 offen offset:3072 nt lds
  s_add_u32 s32, s32, 0x4000
  v_mfma_f32_16x16x32_bf16 v[72:75], a[176:179], v[180:183], v[72:75]
  v_mfma_f32_16x16x32_bf16 v[76:79], a[180:183], v[180:183], v[76:79]
  ds_read_b128 a[172:175], v225 offset:38912
  v_add_f32 v215, v215, v209
  v_exp_f32 v212, v112
  v_mfma_f32_16x16x32_bf16 v[68:71], a[180:183], v[176:179], v[68:71]
  s_waitcnt lgkmcnt(4)
  v_mfma_f32_16x16x32_bf16 v[64:67], a[184:187], v[184:187], v[64:67]
  ds_read_b128 a[176:179], v226 offset:34816
  v_add_f32 v215, v215, v210
  v_cvt_pk_bf16_f32 v151, v210, v211
  v_exp_f32 v213, v113
  v_mfma_f32_16x16x32_bf16 v[72:75], a[184:187], v[188:191], v[72:75]
  v_mfma_f32_16x16x32_bf16 v[76:79], a[188:191], v[188:191], v[76:79]
  ds_read_b128 a[180:183], v226 offset:38912
  v_add_f32 v215, v215, v211
  v_exp_f32 v208, v114
  v_add_f32 v214, v214, v212
  v_mfma_f32_16x16x32_bf16 v[68:71], a[188:191], v[184:187], v[68:71]
  s_waitcnt lgkmcnt(4)
  v_mfma_f32_16x16x32_bf16 v[80:83], a[160:163], v[160:163], v[192:195]
  ds_read_b128 a[184:187], v227 offset:34816
  v_cvt_pk_bf16_f32 v152, v212, v213
  v_exp_f32 v209, v115
  v_add_f32 v214, v214, v213
  v_mfma_f32_16x16x32_bf16 v[88:91], a[160:163], v[164:167], v[196:199]
  v_mfma_f32_16x16x32_bf16 v[92:95], a[164:167], v[164:167], v[196:199]
  ds_read_b128 a[188:191], v227 offset:38912
  v_exp_f32 v210, v116
  v_add_f32 v214, v214, v208
  v_cvt_pk_bf16_f32 v153, v208, v209
  v_mfma_f32_16x16x32_bf16 v[84:87], a[164:167], v[160:163], v[192:195]
  s_waitcnt lgkmcnt(4)
  v_mfma_f32_16x16x32_bf16 v[80:83], a[168:171], v[168:171], v[80:83]
  s_waitcnt vmcnt(24)
  s_barrier
  ds_read_b64_tr_b16 a[160:161], v232 offset:49152
  ds_read_b64_tr_b16 a[162:163], v232 offset:50176
  v_mfma_f32_16x16x32_bf16 v[88:91], a[168:171], v[172:175], v[88:91]
  v_mfma_f32_16x16x32_bf16 v[92:95], a[172:175], v[172:175], v[92:95]
  ds_read_b64_tr_b16 a[164:165], v233 offset:49152
  ds_read_b64_tr_b16 a[166:167], v233 offset:50176
  s_add_u32 m0, s41, 98304
  s_nop 0
  buffer_load_dwordx4 v248, s[12:15], s33 offen offset:0 nt lds
  v_mfma_f32_16x16x32_bf16 v[84:87], a[172:175], v[168:171], v[84:87]
  s_waitcnt lgkmcnt(6)
  v_mfma_f32_16x16x32_bf16 v[80:83], a[176:179], v[176:179], v[80:83]
  ds_read_b64_tr_b16 a[168:169], v234 offset:49152
  ds_read_b64_tr_b16 a[170:171], v234 offset:50176
  v_exp_f32 v211, v117
  v_add_f32 v214, v214, v209
  v_mfma_f32_16x16x32_bf16 v[88:91], a[176:179], v[180:183], v[88:91]
  v_mfma_f32_16x16x32_bf16 v[92:95], a[180:183], v[180:183], v[92:95]
  ds_read_b64_tr_b16 a[172:173], v235 offset:49152
  ds_read_b64_tr_b16 a[174:175], v235 offset:50176
  v_exp_f32 v212, v118
  v_add_f32 v214, v214, v210
  v_cvt_pk_bf16_f32 v154, v210, v211
  v_mfma_f32_16x16x32_bf16 v[84:87], a[180:183], v[176:179], v[84:87]
  s_waitcnt lgkmcnt(8)
  v_mfma_f32_16x16x32_bf16 v[80:83], a[184:187], v[184:187], v[80:83]
  ds_read_b64_tr_b16 a[176:177], v236 offset:49152
  ds_read_b64_tr_b16 a[178:179], v236 offset:50176
  buffer_load_dwordx4 v248, s[12:15], s33 offen offset:1024 nt lds
  v_mfma_f32_16x16x32_bf16 v[88:91], a[184:187], v[188:191], v[88:91]
  v_mfma_f32_16x16x32_bf16 v[92:95], a[188:191], v[188:191], v[92:95]
  ds_read_b64_tr_b16 a[180:181], v237 offset:49152
  ds_read_b64_tr_b16 a[182:183], v237 offset:50176
  v_exp_f32 v213, v119
  v_add_f32 v214, v214, v211
  v_mfma_f32_16x16x32_bf16 v[84:87], a[188:191], v[184:187], v[84:87]
  s_waitcnt lgkmcnt(8)
  v_mfma_f32_16x16x32_bf16 v[0:3], a[160:163], a[64:67], v[0:3]
  ds_read_b64_tr_b16 a[184:185], v238 offset:49152
  ds_read_b64_tr_b16 a[186:187], v238 offset:50176
  v_exp_f32 v208, v120
  v_add_f32 v214, v214, v212
  v_mfma_f32_16x16x32_bf16 v[8:11], a[160:163], a[68:71], v[8:11]
  v_mfma_f32_16x16x32_bf16 v[12:15], a[164:167], a[68:71], v[12:15]
  ds_read_b64_tr_b16 a[188:189], v239 offset:49152
  ds_read_b64_tr_b16 a[190:191], v239 offset:50176
  buffer_load_dwordx4 v248, s[12:15], s33 offen offset:2048 nt lds
  v_mfma_f32_16x16x32_bf16 v[4:7], a[164:167], a[64:67], v[4:7]
  s_waitcnt lgkmcnt(8)
  v_mfma_f32_16x16x32_bf16 v[16:19], a[168:171], a[64:67], v[16:19]
  ds_read_b64_tr_b16 a[160:161], v232 offset:57344
  ds_read_b64_tr_b16 a[162:163], v232 offset:58368
  v_cvt_pk_bf16_f32 v155, v212, v213
  v_exp_f32 v209, v121
  v_mfma_f32_16x16x32_bf16 v[24:27], a[168:171], a[68:71], v[24:27]
  v_mfma_f32_16x16x32_bf16 v[28:31], a[172:175], a[68:71], v[28:31]
  ds_read_b64_tr_b16 a[164:165], v233 offset:57344
  ds_read_b64_tr_b16 a[166:167], v233 offset:58368
  v_add_f32 v214, v214, v213
  v_exp_f32 v210, v122
  v_mfma_f32_16x16x32_bf16 v[20:23], a[172:175], a[64:67], v[20:23]
  s_waitcnt lgkmcnt(8)
  v_mfma_f32_16x16x32_bf16 v[32:35], a[176:179], a[64:67], v[32:35]
  ds_read_b64_tr_b16 a[168:169], v234 offset:57344
  ds_read_b64_tr_b16 a[170:171], v234 offset:58368
  buffer_load_dwordx4 v248, s[12:15], s33 offen offset:3072 nt lds
  s_add_u32 s33, s33, 0x4000
  v_mfma_f32_16x16x32_bf16 v[40:43], a[176:179], a[68:71], v[40:43]
  v_mfma_f32_16x16x32_bf16 v[44:47], a[180:183], a[68:71], v[44:47]
  ds_read_b64_tr_b16 a[172:173], v235 offset:57344
  ds_read_b64_tr_b16 a[174:175], v235 offset:58368
  v_add_f32 v215, v215, v208
  v_cvt_pk_bf16_f32 v156, v208, v209
  v_mfma_f32_16x16x32_bf16 v[36:39], a[180:183], a[64:67], v[36:39]
  s_waitcnt lgkmcnt(8)
  v_mfma_f32_16x16x32_bf16 v[48:51], a[184:187], a[64:67], v[48:51]
  ds_read_b64_tr_b16 a[176:177], v236 offset:57344
  ds_read_b64_tr_b16 a[178:179], v236 offset:58368
  v_exp_f32 v211, v123
  v_add_f32 v215, v215, v209
  v_mfma_f32_16x16x32_bf16 v[56:59], a[184:187], a[68:71], v[56:59]
  v_mfma_f32_16x16x32_bf16 v[60:63], a[188:191], a[68:71], v[60:63]
  ds_read_b64_tr_b16 a[180:181], v237 offset:57344
  ds_read_b64_tr_b16 a[182:183], v237 offset:58368
  v_exp_f32 v212, v124
  v_add_f32 v215, v215, v210
  v_cvt_pk_bf16_f32 v157, v210, v211
  v_mfma_f32_16x16x32_bf16 v[52:55], a[188:191], a[64:67], v[52:55]
  s_waitcnt lgkmcnt(8)
  v_mfma_f32_16x16x32_bf16 v[0:3], a[160:163], a[72:75], v[0:3]
  ds_read_b64_tr_b16 a[184:185], v238 offset:57344
  ds_read_b64_tr_b16 a[186:187], v238 offset:58368
  v_exp_f32 v213, v125
  v_mfma_f32_16x16x32_bf16 v[8:11], a[160:163], a[76:79], v[8:11]
  v_mfma_f32_16x16x32_bf16 v[12:15], a[164:167], a[76:79], v[12:15]
  ds_read_b64_tr_b16 a[188:189], v239 offset:57344
  ds_read_b64_tr_b16 a[190:191], v239 offset:58368
  v_add_f32 v215, v215, v211
  v_exp_f32 v208, v126
  v_mfma_f32_16x16x32_bf16 v[4:7], a[164:167], a[72:75], v[4:7]
  s_waitcnt lgkmcnt(8)
  v_mfma_f32_16x16x32_bf16 v[16:19], a[168:171], a[72:75], v[16:19]
  s_waitcnt vmcnt(20)
  s_barrier
  ds_read_b64_tr_b16 a[160:161], v232 offset:0
  ds_read_b64_tr_b16 a[162:163], v232 offset:1024
  v_add_f32 v215, v215, v212
  v_mfma_f32_16x16x32_bf16 v[24:27], a[168:171], a[76:79], v[24:27]
  v_mfma_f32_16x16x32_bf16 v[28:31], a[172:175], a[76:79], v[28:31]
  ds_read_b64_tr_b16 a[164:165], v233 offset:0
  ds_read_b64_tr_b16 a[166:167], v233 offset:1024
  s_add_u32 m0, s41, 32768
  s_nop 0
  buffer_load_dwordx4 v240, s[8:11], s32 offen offset:0 nt lds
  v_cvt_pk_bf16_f32 v158, v212, v213
  v_mfma_f32_16x16x32_bf16 v[20:23], a[172:175], a[72:75], v[20:23]
  s_waitcnt lgkmcnt(8)
  v_mfma_f32_16x16x32_bf16 v[32:35], a[176:179], a[72:75], v[32:35]
  ds_read_b64_tr_b16 a[168:169], v234 offset:0
  ds_read_b64_tr_b16 a[170:171], v234 offset:1024
  v_exp_f32 v209, v127
  v_mfma_f32_16x16x32_bf16 v[40:43], a[176:179], a[76:79], v[40:43]
  v_mfma_f32_16x16x32_bf16 v[44:47], a[180:183], a[76:79], v[44:47]
  ds_read_b64_tr_b16 a[172:173], v235 offset:0
  ds_read_b64_tr_b16 a[174:175], v235 offset:1024
  v_add_f32 v215, v215, v213
  v_add_f32 v215, v215, v208
  v_cvt_pk_bf16_f32 v159, v208, v209
  v_mfma_f32_16x16x32_bf16 v[36:39], a[180:183], a[72:75], v[36:39]
  s_waitcnt lgkmcnt(8)
  v_mfma_f32_16x16x32_bf16 v[48:51], a[184:187], a[72:75], v[48:51]
  ds_read_b64_tr_b16 a[176:177], v236 offset:0
  ds_read_b64_tr_b16 a[178:179], v236 offset:1024
  buffer_load_dwordx4 v241, s[8:11], s32 offen offset:1024 nt lds
  v_add_f32 v215, v215, v209
  v_mfma_f32_16x16x32_bf16 v[56:59], a[184:187], a[76:79], v[56:59]
  v_mfma_f32_16x16x32_bf16 v[60:63], a[188:191], a[76:79], v[60:63]
  ds_read_b64_tr_b16 a[180:181], v237 offset:0
  ds_read_b64_tr_b16 a[182:183], v237 offset:1024
  v_add_f32 v210, v214, v215
  v_cmp_lt_f32 vcc, s35, v210
  v_mfma_f32_16x16x32_bf16 v[52:55], a[188:191], a[72:75], v[52:55]
  s_cbranch_vccnz SITE45
BACK45:
  s_waitcnt lgkmcnt(8)
  v_mfma_f32_16x16x32_bf16 a[192:195], a[160:163], v[144:147], a[192:195]
  ds_read_b64_tr_b16 a[184:185], v238 offset:0
  ds_read_b64_tr_b16 a[186:187], v238 offset:1024
  v_add_f32 v249, v249, v214
  v_add_f32 v254, v254, v215
  v_exp_f32 v208, v64
  v_mfma_f32_16x16x32_bf16 a[200:203], a[160:163], v[148:151], a[200:203]
  v_mfma_f32_16x16x32_bf16 a[204:207], a[164:167], v[148:151], a[204:207]
  ds_read_b64_tr_b16 a[188:189], v239 offset:0
  ds_read_b64_tr_b16 a[190:191], v239 offset:1024
  buffer_load_dwordx4 v242, s[8:11], s32 offen offset:2048 nt lds
  v_mfma_f32_16x16x32_bf16 a[196:199], a[164:167], v[144:147], a[196:199]
  s_waitcnt lgkmcnt(8)
  v_mfma_f32_16x16x32_bf16 a[208:211], a[168:171], v[144:147], a[208:211]
  ds_read_b64_tr_b16 a[160:161], v232 offset:8192
  ds_read_b64_tr_b16 a[162:163], v232 offset:9216
  v_exp_f32 v209, v65
  v_mfma_f32_16x16x32_bf16 a[216:219], a[168:171], v[148:151], a[216:219]
  v_mfma_f32_16x16x32_bf16 a[220:223], a[172:175], v[148:151], a[220:223]
  ds_read_b64_tr_b16 a[164:165], v233 offset:8192
  ds_read_b64_tr_b16 a[166:167], v233 offset:9216
  v_exp_f32 v210, v66
  v_cvt_pk_bf16_f32 v128, v208, v209
  v_mfma_f32_16x16x32_bf16 a[212:215], a[172:175], v[144:147], a[212:215]
  s_waitcnt lgkmcnt(8)
  v_mfma_f32_16x16x32_bf16 a[224:227], a[176:179], v[144:147], a[224:227]
  ds_read_b64_tr_b16 a[168:169], v234 offset:8192
  ds_read_b64_tr_b16 a[170:171], v234 offset:9216
  buffer_load_dwordx4 v243, s[8:11], s32 offen offset:3072 nt lds
  s_add_u32 s32, s32, 0x4000
  v_mfma_f32_16x16x32_bf16 a[232:235], a[176:179], v[148:151], a[232:235]
  v_mfma_f32_16x16x32_bf16 a[236:239], a[180:183], v[148:151], a[236:239]
  ds_read_b64_tr_b16 a[172:173], v235 offset:8192
  ds_read_b64_tr_b16 a[174:175], v235 offset:9216
  v_exp_f32 v211, v67
  v_add_f32 v214, v208, v209
  v_mfma_f32_16x16x32_bf16 a[228:231], a[180:183], v[144:147], a[228:231]
  s_waitcnt lgkmcnt(8)
  v_mfma_f32_16x16x32_bf16 a[240:243], a[184:187], v[144:147], a[240:243]
  ds_read_b64_tr_b16 a[176:177], v236 offset:8192
  ds_read_b64_tr_b16 a[178:179], v236 offset:9216
  v_exp_f32 v212, v68
  v_add_f32 v214, v214, v210
  v_mfma_f32_16x16x32_bf16 a[248:251], a[184:187], v[148:151], a[248:251]
  v_mfma_f32_16x16x32_bf16 a[252:255], a[188:191], v[148:151], a[252:255]
  ds_read_b64_tr_b16 a[180:181], v237 offset:8192
  ds_read_b64_tr_b16 a[182:183], v237 offset:9216
  v_cvt_pk_bf16_f32 v129, v210, v211
  v_exp_f32 v213, v69
  v_mfma_f32_16x16x32_bf16 a[244:247], a[188:191], v[144:147], a[244:247]
  s_waitcnt lgkmcnt(8)
  v_mfma_f32_16x16x32_bf16 a[192:195], a[160:163], v[152:155], a[192:195]
  ds_read_b64_tr_b16 a[184:185], v238 offset:8192
  ds_read_b64_tr_b16 a[186:187], v238 offset:9216
  v_add_f32 v214, v214, v211
  v_exp_f32 v208, v70
  v_mfma_f32_16x16x32_bf16 a[200:203], a[160:163], v[156:159], a[200:203]
  v_mfma_f32_16x16x32_bf16 a[204:207], a[164:167], v[156:159], a[204:207]
  ds_read_b64_tr_b16 a[188:189], v239 offset:8192
  ds_read_b64_tr_b16 a[190:191], v239 offset:9216
  v_add_f32 v214, v214, v212
  v_cvt_pk_bf16_f32 v130, v212, v213
  v_mfma_f32_16x16x32_bf16 a[196:199], a[164:167], v[152:155], a[196:199]
  s_waitcnt lgkmcnt(8)
  v_mfma_f32_16x16x32_bf16 a[208:211], a[168:171], v[152:155], a[208:211]
  s_barrier
  ds_read_b128 a[160:163], v224 offset:49152
  v_exp_f32 v209, v71
  v_add_f32 v214, v214, v213
  v_mfma_f32_16x16x32_bf16 a[216:219], a[168:171], v[156:159], a[216:219]
  v_mfma_f32_16x16x32_bf16 a[220:223], a[172:175], v[156:159], a[220:223]
  ds_read_b128 a[164:167], v224 offset:53248
  s_add_u32 m0, s41, 114688
  s_nop 0
  buffer_load_dwordx4 v248, s[12:15], s33 offen offset:0 nt lds
  v_exp_f32 v210, v72
  v_mfma_f32_16x16x32_bf16 a[212:215], a[172:175], v[152:155], a[212:215]
  s_waitcnt lgkmcnt(6)
  v_mfma_f32_16x16x32_bf16 a[224:227], a[176:179], v[152:155], a[224:227]
  ds_read_b128 a[168:171], v225 offset:49152
  v_add_f32 v214, v214, v208
  v_cvt_pk_bf16_f32 v131, v208, v209
  v_exp_f32 v211, v73
  v_mfma_f32_16x16x32_bf16 a[232:235], a[176:179], v[156:159], a[232:235]
  v_mfma_f32_16x16x32_bf16 a[236:239], a[180:183], v[156:159], a[236:239]
  ds_read_b128 a[172:175], v225 offset:53248
  v_add_f32 v214, v214, v209
  v_exp_f32 v212, v74
  v_mfma_f32_16x16x32_bf16 a[228:231], a[180:183], v[152:155], a[228:231]
  s_waitcnt lgkmcnt(4)
  v_mfma_f32_16x16x32_bf16 a[240:243], a[184:187], v[152:155], a[240:243]
  ds_read_b128 a[176:179], v226 offset:49152
  buffer_load_dwordx4 v248, s[12:15], s33 offen offset:1024 nt lds
  v_mfma_f32_16x16x32_bf16 a[248:251], a[184:187], v[156:159], a[248:251]
  v_mfma_f32_16x16x32_bf16 a[252:255], a[188:191], v[156:159], a[252:255]
  ds_read_b128 a[180:183], v226 offset:53248
  v_cvt_pk_bf16_f32 v132, v210, v211
  v_exp_f32 v213, v75
  v_add_f32 v215, v210, v211
  v_mfma_f32_16x16x32_bf16 a[244:247], a[188:191], v[152:155], a[244:247]
  s_waitcnt lgkmcnt(4)
  v_mfma_f32_16x16x32_bf16 v[96:99], a[160:163], v[160:163], v[192:195]
  ds_read_b128 a[184:187], v227 offset:49152
  v_exp_f32 v208, v76
  v_add_f32 v215, v215, v212
  v_cvt_pk_bf16_f32 v133, v212, v213
  v_mfma_f32_16x16x32_bf16 v[104:107], a[160:163], v[164:167], v[196:199]
  v_mfma_f32_16x16x32_bf16 v[108:111], a[164:167], v[164:167], v[196:199]
  ds_read_b128 a[188:191], v227 offset:53248
  buffer_load_dwordx4 v248, s[12:15], s33 offen offset:2048 nt lds
  v_mfma_f32_16x16x32_bf16 v[100:103], a[164:167], v[160:163], v[192:195]
  s_waitcnt lgkmcnt(4)
  v_mfma_f32_16x16x32_bf16 v[96:99], a[168:171], v[168:171], v[96:99]
  ds_read_b128 a[160:163], v224 offset:51200
  v_exp_f32 v209, v77
  v_add_f32 v215, v215, v213
  v_exp_f32 v210, v78
  v_mfma_f32_16x16x32_bf16 v[104:107], a[168:171], v[172:175], v[104:107]
  v_mfma_f32_16x16x32_bf16 v[108:111], a[172:175], v[172:175], v[108:111]
  ds_read_b128 a[164:167], v224 offset:55296
  v_add_f32 v215, v215, v208
  v_cvt_pk_bf16_f32 v134, v208, v209
  v_mfma_f32_16x16x32_bf16 v[100:103], a[172:175], v[168:171], v[100:103]
  s_waitcnt lgkmcnt(4)
  v_mfma_f32_16x16x32_bf16 v[96:99], a[176:179], v[176:179], v[96:99]
  ds_read_b128 a[168:171], v225 offset:51200
  buffer_load_dwordx4 v248, s[12:15], s33 offen offset:3072 nt lds
  s_add_u32 s33, s33, 0x4000
  v_exp_f32 v211, v79
  v_mfma_f32_16x16x32_bf16 v[104:107], a[176:179], v[180:183], v[104:107]
  v_mfma_f32_16x16x32_bf16 v[108:111], a[180:183], v[180:183], v[108:111]
  ds_read_b128 a[172:175], v225 offset:55296
  v_add_f32 v215, v215, v209
  v_exp_f32 v212, v80
  v_mfma_f32_16x16x32_bf16 v[100:103], a[180:183], v[176:179], v[100:103]
  s_waitcnt lgkmcnt(4)
  v_mfma_f32_16x16x32_bf16 v[96:99], a[184:187], v[184:187], v[96:99]
  ds_read_b128 a[176:179], v226 offset:51200
  v_add_f32 v215, v215, v210
  v_cvt_pk_bf16_f32 v135, v210, v211
  v_exp_f32 v213, v81
  v_mfma_f32_16x16x32_bf16 v[104:107], a[184:187], v[188:191], v[104:107]
  v_mfma_f32_16x16x32_bf16 v[108:111], a[188:191], v[188:191], v[108:111]
  ds_read_b128 a[180:183], v226 offset:55296
  v_add_f32 v215, v215, v211
  v_exp_f32 v208, v82
  v_add_f32 v214, v214, v212
  v_mfma_f32_16x16x32_bf16 v[100:103], a[188:191], v[184:187], v[100:103]
  s_waitcnt lgkmcnt(4)
  v_mfma_f32_16x16x32_bf16 v[112:115], a[160:163], v[160:163], v[192:195]
  ds_read_b128 a[184:187], v227 offset:51200
  v_cvt_pk_bf16_f32 v136, v212, v213
  v_exp_f32 v209, v83
  v_add_f32 v214, v214, v213
  v_mfma_f32_16x16x32_bf16 v[120:123], a[160:163], v[164:167], v[196:199]
  v_mfma_f32_16x16x32_bf16 v[124:127], a[164:167], v[164:167], v[196:199]
  ds_read_b128 a[188:191], v227 offset:55296
  v_exp_f32 v210, v84
  v_add_f32 v214, v214, v208
  v_cvt_pk_bf16_f32 v137, v208, v209
  v_mfma_f32_16x16x32_bf16 v[116:119], a[164:167], v[160:163], v[192:195]
  s_waitcnt lgkmcnt(4)
  v_mfma_f32_16x16x32_bf16 v[112:115], a[168:171], v[168:171], v[112:115]
  s_waitcnt vmcnt(24)
  s_barrier
  ds_read_b64_tr_b16 a[160:161], v200 offset:0
  ds_read_b64_tr_b16 a[162:163], v200 offset:1024
  v_mfma_f32_16x16x32_bf16 v[120:123], a[168:171], v[172:175], v[120:123]
  v_mfma_f32_16x16x32_bf16 v[124:127], a[172:175], v[172:175], v[124:127]
  ds_read_b64_tr_b16 a[164:165], v201 offset:0
  ds_read_b64_tr_b16 a[166:167], v201 offset:1024
  s_add_u32 m0, s41, 65536
  s_nop 0
  buffer_load_dwordx4 v244, s[16:19], s34 offen offset:0 lds
  v_mfma_f32_16x16x32_bf16 v[116:119], a[172:175], v[168:171], v[116:119]
  s_waitcnt lgkmcnt(6)
  v_mfma_f32_16x16x32_bf16 v[112:115], a[176:179], v[176:179], v[112:115]
  ds_read_b64_tr_b16 a[168:169], v202 offset:0
  ds_read_b64_tr_b16 a[170:171], v202 offset:1024
  v_exp_f32 v211, v85
  v_add_f32 v214, v214, v209
  v_mfma_f32_16x16x32_bf16 v[120:123], a[176:179], v[180:183], v[120:123]
  v_mfma_f32_16x16x32_bf16 v[124:127], a[180:183], v[180:183], v[124:127]
  ds_read_b64_tr_b16 a[172:173], v203 offset:0
  ds_read_b64_tr_b16 a[174:175], v203 offset:1024
  v_exp_f32 v212, v86
  v_add_f32 v214, v214, v210
  v_cvt_pk_bf16_f32 v138, v210, v211
  v_mfma_f32_16x16x32_bf16 v[116:119], a[180:183], v[176:179], v[116:119]
  s_waitcnt lgkmcnt(8)
  v_mfma_f32_16x16x32_bf16 v[112:115], a[184:187], v[184:187], v[112:115]
  ds_read_b64_tr_b16 a[176:177], v204 offset:0
  ds_read_b64_tr_b16 a[178:179], v204 offset:1024
  buffer_load_dwordx4 v245, s[16:19], s34 offen offset:1024 lds
  v_mfma_f32_16x16x32_bf16 v[120:123], a[184:187], v[188:191], v[120:123]
  v_mfma_f32_16x16x32_bf16 v[124:127], a[188:191], v[188:191], v[124:127]
  ds_read_b64_tr_b16 a[180:181], v205 offset:0
  ds_read_b64_tr_b16 a[182:183], v205 offset:1024
  v_exp_f32 v213, v87
  v_add_f32 v214, v214, v211
  v_mfma_f32_16x16x32_bf16 v[116:119], a[188:191], v[184:187], v[116:119]
  s_waitcnt lgkmcnt(8)
  v_mfma_f32_16x16x32_bf16 v[0:3], a[160:163], a[80:83], v[0:3]
  ds_read_b64_tr_b16 a[184:185], v206 offset:0
  ds_read_b64_tr_b16 a[186:187], v206 offset:1024
  v_exp_f32 v208, v88
  v_add_f32 v214, v214, v212
  v_mfma_f32_16x16x32_bf16 v[8:11], a[160:163], a[84:87], v[8:11]
  v_mfma_f32_16x16x32_bf16 v[12:15], a[164:167], a[84:87], v[12:15]
  ds_read_b64_tr_b16 a[188:189], v207 offset:0
  ds_read_b64_tr_b16 a[190:191], v207 offset:1024
  buffer_load_dwordx4 v246, s[16:19], s34 offen offset:2048 lds
  v_cvt_pk_bf16_f32 v139, v212, v213
  v_mfma_f32_16x16x32_bf16 v[4:7], a[164:167], a[80:83], v[4:7]
  s_waitcnt lgkmcnt(8)
  v_mfma_f32_16x16x32_bf16 v[16:19], a[168:171], a[80:83], v[16:19]
  ds_read_b64_tr_b16 a[160:161], v200 offset:8192
  ds_read_b64_tr_b16 a[162:163], v200 offset:9216
  v_exp_f32 v209, v89
  v_add_f32 v214, v214, v213
  v_mfma_f32_16x16x32_bf16 v[24:27], a[168:171], a[84:87], v[24:27]
  v_mfma_f32_16x16x32_bf16 v[28:31], a[172:175], a[84:87], v[28:31]
  ds_read_b64_tr_b16 a[164:165], v201 offset:8192
  ds_read_b64_tr_b16 a[166:167], v201 offset:9216
  v_exp_f32 v210, v90
  v_add_f32 v215, v215, v208
  v_mfma_f32_16x16x32_bf16 v[20:23], a[172:175], a[80:83], v[20:23]
  s_waitcnt lgkmcnt(8)
  v_mfma_f32_16x16x32_bf16 v[32:35], a[176:179], a[80:83], v[32:35]
  ds_read_b64_tr_b16 a[168:169], v202 offset:8192
  ds_read_b64_tr_b16 a[170:171], v202 offset:9216
  buffer_load_dwordx4 v247, s[16:19], s34 offen offset:3072 lds
  s_add_u32 s34, s34, 524288
  s_sub_u32 s38, s34, 5242880
  s_min_u32 s34, s34, s38
  v_cvt_pk_bf16_f32 v140, v208, v209
  v_mfma_f32_16x16x32_bf16 v[40:43], a[176:179], a[84:87], v[40:43]
  v_mfma_f32_16x16x32_bf16 v[44:47], a[180:183], a[84:87], v[44:47]
  ds_read_b64_tr_b16 a[172:173], v203 offset:8192
  ds_read_b64_tr_b16 a[174:175], v203 offset:9216
  v_exp_f32 v211, v91
  v_add_f32 v215, v215, v209
  v_mfma_f32_16x16x32_bf16 v[36:39], a[180:183], a[80:83], v[36:39]
  s_waitcnt lgkmcnt(8)
  v_mfma_f32_16x16x32_bf16 v[48:51], a[184:187], a[80:83], v[48:51]
  ds_read_b64_tr_b16 a[176:177], v204 offset:8192
  ds_read_b64_tr_b16 a[178:179], v204 offset:9216
  v_exp_f32 v212, v92
  v_add_f32 v215, v215, v210
  v_mfma_f32_16x16x32_bf16 v[56:59], a[184:187], a[84:87], v[56:59]
  v_mfma_f32_16x16x32_bf16 v[60:63], a[188:191], a[84:87], v[60:63]
  ds_read_b64_tr_b16 a[180:181], v205 offset:8192
  ds_read_b64_tr_b16 a[182:183], v205 offset:9216
  v_cvt_pk_bf16_f32 v141, v210, v211
  v_exp_f32 v213, v93
  v_mfma_f32_16x16x32_bf16 v[52:55], a[188:191], a[80:83], v[52:55]
  s_waitcnt lgkmcnt(8)
  v_mfma_f32_16x16x32_bf16 v[0:3], a[160:163], a[88:91], v[0:3]
  ds_read_b64_tr_b16 a[184:185], v206 offset:8192
  ds_read_b64_tr_b16 a[186:187], v206 offset:9216
  v_add_f32 v215, v215, v211
  v_exp_f32 v208, v94
  v_add_f32 v215, v215, v212
  v_mfma_f32_16x16x32_bf16 v[8:11], a[160:163], a[92:95], v[8:11]
  v_mfma_f32_16x16x32_bf16 v[12:15], a[164:167], a[92:95], v[12:15]
  ds_read_b64_tr_b16 a[188:189], v207 offset:8192
  ds_read_b64_tr_b16 a[190:191], v207 offset:9216
  v_cvt_pk_bf16_f32 v142, v212, v213
  v_exp_f32 v209, v95
  v_mfma_f32_16x16x32_bf16 v[4:7], a[164:167], a[88:91], v[4:7]
  s_waitcnt lgkmcnt(8)
  v_mfma_f32_16x16x32_bf16 v[16:19], a[168:171], a[88:91], v[16:19]
  s_waitcnt vmcnt(24)
  s_barrier
  ds_read_b64_tr_b16 a[160:161], v200 offset:16384
  ds_read_b64_tr_b16 a[162:163], v200 offset:17408
  v_add_f32 v215, v215, v213
  v_mfma_f32_16x16x32_bf16 v[24:27], a[168:171], a[92:95], v[24:27]
  v_mfma_f32_16x16x32_bf16 v[28:31], a[172:175], a[92:95], v[28:31]
  ds_read_b64_tr_b16 a[164:165], v201 offset:16384
  ds_read_b64_tr_b16 a[166:167], v201 offset:17408
  s_add_u32 m0, s41, 49152
  s_nop 0
  buffer_load_dwordx4 v240, s[8:11], s32 offen offset:0 nt lds
  v_add_f32 v215, v215, v208
  v_mfma_f32_16x16x32_bf16 v[20:23], a[172:175], a[88:91], v[20:23]
  s_waitcnt lgkmcnt(8)
  v_mfma_f32_16x16x32_bf16 v[32:35], a[176:179], a[88:91], v[32:35]
  ds_read_b64_tr_b16 a[168:169], v202 offset:16384
  ds_read_b64_tr_b16 a[170:171], v202 offset:17408
  v_cvt_pk_bf16_f32 v143, v208, v209
  v_add_f32 v215, v215, v209
  v_add_f32 v210, v214, v215
  v_mfma_f32_16x16x32_bf16 v[40:43], a[176:179], a[92:95], v[40:43]
  v_mfma_f32_16x16x32_bf16 v[44:47], a[180:183], a[92:95], v[44:47]
  ds_read_b64_tr_b16 a[172:173], v203 offset:16384
  ds_read_b64_tr_b16 a[174:175], v203 offset:17408
  v_cmp_lt_f32 vcc, s35, v210
  v_mfma_f32_16x16x32_bf16 v[36:39], a[180:183], a[88:91], v[36:39]
  s_waitcnt lgkmcnt(8)
  v_mfma_f32_16x16x32_bf16 v[48:51], a[184:187], a[88:91], v[48:51]
  ds_read_b64_tr_b16 a[176:177], v204 offset:16384
  ds_read_b64_tr_b16 a[178:179], v204 offset:17408
  buffer_load_dwordx4 v241, s[8:11], s32 offen offset:1024 nt lds
  v_mfma_f32_16x16x32_bf16 v[56:59], a[184:187], a[92:95], v[56:59]
  v_mfma_f32_16x16x32_bf16 v[60:63], a[188:191], a[92:95], v[60:63]
  ds_read_b64_tr_b16 a[180:181], v205 offset:16384
  ds_read_b64_tr_b16 a[182:183], v205 offset:17408
  v_mfma_f32_16x16x32_bf16 v[52:55], a[188:191], a[88:91], v[52:55]
  s_cbranch_vccnz SITE48
BACK48:
  s_waitcnt lgkmcnt(8)
  v_mfma_f32_16x16x32_bf16 a[192:195], a[160:163], v[128:131], a[192:195]
  ds_read_b64_tr_b16 a[184:185], v206 offset:16384
  ds_read_b64_tr_b16 a[186:187], v206 offset:17408
  v_add_f32 v249, v249, v214
  v_add_f32 v254, v254, v215
  v_exp_f32 v208, v96
  v_exp_f32 v209, v97
  v_mfma_f32_16x16x32_bf16 a[200:203], a[160:163], v[132:135], a[200:203]
  v_mfma_f32_16x16x32_bf16 a[204:207], a[164:167], v[132:135], a[204:207]
  ds_read_b64_tr_b16 a[188:189], v207 offset:16384
  ds_read_b64_tr_b16 a[190:191], v207 offset:17408
  buffer_load_dwordx4 v242, s[8:11], s32 offen offset:2048 nt lds
  v_mfma_f32_16x16x32_bf16 a[196:199], a[164:167], v[128:131], a[196:199]
  s_waitcnt lgkmcnt(8)
  v_mfma_f32_16x16x32_bf16 a[208:211], a[168:171], v[128:131], a[208:211]
  ds_read_b64_tr_b16 a[160:161], v200 offset:24576
  ds_read_b64_tr_b16 a[162:163], v200 offset:25600
  v_exp_f32 v210, v98
  v_cvt_pk_bf16_f32 v144, v208, v209
  v_mfma_f32_16x16x32_bf16 a[216:219], a[168:171], v[132:135], a[216:219]
  v_mfma_f32_16x16x32_bf16 a[220:223], a[172:175], v[132:135], a[220:223]
  ds_read_b64_tr_b16 a[164:165], v201 offset:24576
  ds_read_b64_tr_b16 a[166:167], v201 offset:25600
  v_exp_f32 v211, v99
  v_add_f32 v214, v208, v209
  v_mfma_f32_16x16x32_bf16 a[212:215], a[172:175], v[128:131], a[212:215]
  s_waitcnt lgkmcnt(8)
  v_mfma_f32_16x16x32_bf16 a[224:227], a[176:179], v[128:131], a[224:227]
  ds_read_b64_tr_b16 a[168:169], v202 offset:24576
  ds_read_b64_tr_b16 a[170:171], v202 offset:25600
  buffer_load_dwordx4 v243, s[8:11], s32 offen offset:3072 nt lds
  s_add_u32 s32, s32, 0x4000
  v_exp_f32 v212, v100
  v_mfma_f32_16x16x32_bf16 a[232:235], a[176:179], v[132:135], a[232:235]
  v_mfma_f32_16x16x32_bf16 a[236:239], a[180:183], v[132:135], a[236:239]
  ds_read_b64_tr_b16 a[172:173], v203 offset:24576
  ds_read_b64_tr_b16 a[174:175], v203 offset:25600
  v_add_f32 v214, v214, v210
  v_cvt_pk_bf16_f32 v145, v210, v211
  v_mfma_f32_16x16x32_bf16 a[228:231], a[180:183], v[128:131], a[228:231]
  s_waitcnt lgkmcnt(8)
  v_mfma_f32_16x16x32_bf16 a[240:243], a[184:187], v[128:131], a[240:243]
  ds_read_b64_tr_b16 a[176:177], v204 offset:24576
  ds_read_b64_tr_b16 a[178:179], v204 offset:25600
  v_exp_f32 v213, v101
  v_add_f32 v214, v214, v211
  v_mfma_f32_16x16x32_bf16 a[248:251], a[184:187], v[132:135], a[248:251]
  v_mfma_f32_16x16x32_bf16 a[252:255], a[188:191], v[132:135], a[252:255]
  ds_read_b64_tr_b16 a[180:181], v205 offset:24576
  ds_read_b64_tr_b16 a[182:183], v205 offset:25600
  v_exp_f32 v208, v102
  v_add_f32 v214, v214, v212
  v_cvt_pk_bf16_f32 v146, v212, v213
  v_mfma_f32_16x16x32_bf16 a[244:247], a[188:191], v[128:131], a[244:247]
  s_waitcnt lgkmcnt(8)
  v_mfma_f32_16x16x32_bf16 a[192:195], a[160:163], v[136:139], a[192:195]
  ds_read_b64_tr_b16 a[184:185], v206 offset:24576
  ds_read_b64_tr_b16 a[186:187], v206 offset:25600
  v_exp_f32 v209, v103
  v_add_f32 v214, v214, v213
  v_mfma_f32_16x16x32_bf16 a[200:203], a[160:163], v[140:143], a[200:203]
  v_mfma_f32_16x16x32_bf16 a[204:207], a[164:167], v[140:143], a[204:207]
  ds_read_b64_tr_b16 a[188:189], v207 offset:24576
  ds_read_b64_tr_b16 a[190:191], v207 offset:25600
  v_exp_f32 v210, v104
  v_add_f32 v214, v214, v208
  v_mfma_f32_16x16x32_bf16 a[196:199], a[164:167], v[136:139], a[196:199]
  s_waitcnt lgkmcnt(8)
  v_mfma_f32_16x16x32_bf16 a[208:211], a[168:171], v[136:139], a[208:211]
  s_barrier
  ds_read_b128 a[160:163], v224 offset:0
  v_cvt_pk_bf16_f32 v147, v208, v209
  v_exp_f32 v211, v105
  v_add_f32 v214, v214, v209
  v_mfma_f32_16x16x32_bf16 a[216:219], a[168:171], v[140:143], a[216:219]
  v_mfma_f32_16x16x32_bf16 a[220:223], a[172:175], v[140:143], a[220:223]
  ds_read_b128 a[164:167], v224 offset:4096
  s_add_u32 m0, s41, 131072
  s_nop 0
  buffer_load_dwordx4 v248, s[12:15], s33 offen offset:0 nt lds
  v_mfma_f32_16x16x32_bf16 a[212:215], a[172:175], v[136:139], a[212:215]
  s_waitcnt lgkmcnt(6)
  v_mfma_f32_16x16x32_bf16 a[224:227], a[176:179], v[136:139], a[224:227]
  ds_read_b128 a[168:171], v225 offset:0
  v_exp_f32 v212, v106
  v_cvt_pk_bf16_f32 v148, v210, v211
  v_exp_f32 v213, v107
  v_mfma_f32_16x16x32_bf16 a[232:235], a[176:179], v[140:143], a[232:235]
  v_mfma_f32_16x16x32_bf16 a[236:239], a[180:183], v[140:143], a[236:239]
  ds_read_b128 a[172:175], v225 offset:4096
  v_add_f32 v215, v210, v211
  v_exp_f32 v208, v108
  v_add_f32 v215, v215, v212
  v_mfma_f32_16x16x32_bf16 a[228:231], a[180:183], v[136:139], a[228:231]
  s_waitcnt lgkmcnt(4)
  v_mfma_f32_16x16x32_bf16 a[240:243], a[184:187], v[136:139], a[240:243]
  ds_read_b128 a[176:179], v226 offset:0
  buffer_load_dwordx4 v248, s[12:15], s33 offen offset:1024 nt lds
  v_cvt_pk_bf16_f32 v149, v212, v213
  v_mfma_f32_16x16x32_bf16 a[248:251], a[184:187], v[140:143], a[248:251]
  v_mfma_f32_16x16x32_bf16 a[252:255], a[188:191], v[140:143], a[252:255]
  ds_read_b128 a[180:183], v226 offset:4096
  v_exp_f32 v209, v109
  v_add_f32 v215, v215, v213
  v_mfma_f32_16x16x32_bf16 a[244:247], a[188:191], v[136:139], a[244:247]
  s_waitcnt lgkmcnt(4)
  v_mfma_f32_16x16x32_bf16 v[64:67], a[160:163], v[160:163], v[192:195]
  ds_read_b128 a[184:187], v227 offset:0
  v_exp_f32 v210, v110
  v_add_f32 v215, v215, v208
  v_cvt_pk_bf16_f32 v150, v208, v209
  v_exp_f32 v211, v111
  v_mfma_f32_16x16x32_bf16 v[72:75], a[160:163], v[164:167], v[196:199]
  v_mfma_f32_16x16x32_bf16 v[76:79], a[164:167], v[164:167], v[196:199]
  ds_read_b128 a[188:191], v227 offset:4096
  buffer_load_dwordx4 v248, s[12:15], s33 offen offset:2048 nt lds
  v_mfma_f32_16x16x32_bf16 v[68:71], a[164:167], v[160:163], v[192:195]
  s_waitcnt lgkmcnt(4)
  v_mfma_f32_16x16x32_bf16 v[64:67], a[168:171], v[168:171], v[64:67]
  ds_read_b128 a[160:163], v224 offset:2048
  v_add_f32 v215, v215, v209
  v_exp_f32 v212, v112
  v_add_f32 v215, v215, v210
  v_mfma_f32_16x16x32_bf16 v[72:75], a[168:171], v[172:175], v[72:75]
  v_mfma_f32_16x16x32_bf16 v[76:79], a[172:175], v[172:175], v[76:79]
  ds_read_b128 a[164:167], v224 offset:6144
  v_cvt_pk_bf16_f32 v151, v210, v211
  v_exp_f32 v213, v113
  v_add_f32 v215, v215, v211
  v_mfma_f32_16x16x32_bf16 v[68:71], a[172:175], v[168:171], v[68:71]
  s_waitcnt lgkmcnt(4)
  v_mfma_f32_16x16x32_bf16 v[64:67], a[176:179], v[176:179], v[64:67]
  ds_read_b128 a[168:171], v225 offset:2048
  buffer_load_dwordx4 v248, s[12:15], s33 offen offset:3072 nt lds
  s_add_u32 s33, s33, 0x4000
  v_exp_f32 v208, v114
  v_mfma_f32_16x16x32_bf16 v[72:75], a[176:179], v[180:183], v[72:75]
  v_mfma_f32_16x16x32_bf16 v[76:79], a[180:183], v[180:183], v[76:79]
  ds_read_b128 a[172:175], v225 offset:6144
  v_add_f32 v214, v214, v212
  v_cvt_pk_bf16_f32 v152, v212, v213
  v_exp_f32 v209, v115
  v_mfma_f32_16x16x32_bf16 v[68:71], a[180:183], v[176:179], v[68:71]
  s_waitcnt lgkmcnt(4)
  v_mfma_f32_16x16x32_bf16 v[64:67], a[184:187], v[184:187], v[64:67]
  ds_read_b128 a[176:179], v226 offset:2048
  v_add_f32 v214, v214, v213
  v_exp_f32 v210, v116
  v_add_f32 v214, v214, v208
  v_mfma_f32_16x16x32_bf16 v[72:75], a[184:187], v[188:191], v[72:75]
  v_mfma_f32_16x16x32_bf16 v[76:79], a[188:191], v[188:191], v[76:79]
  ds_read_b128 a[180:183], v226 offset:6144
  v_cvt_pk_bf16_f32 v153, v208, v209
  v_exp_f32 v211, v117
  v_add_f32 v214, v214, v209
  v_mfma_f32_16x16x32_bf16 v[68:71], a[188:191], v[184:187], v[68:71]
  s_waitcnt lgkmcnt(4)
  v_mfma_f32_16x16x32_bf16 v[80:83], a[160:163], v[160:163], v[192:195]
  ds_read_b128 a[184:187], v227 offset:2048
  v_exp_f32 v212, v118
  v_add_f32 v214, v214, v210
  v_cvt_pk_bf16_f32 v154, v210, v211
  v_mfma_f32_16x16x32_bf16 v[88:91], a[160:163], v[164:167], v[196:199]
  v_mfma_f32_16x16x32_bf16 v[92:95], a[164:167], v[164:167], v[196:199]
  ds_read_b128 a[188:191], v227 offset:6144
  v_exp_f32 v213, v119
  v_add_f32 v214, v214, v211
  v_exp_f32 v208, v120
  v_mfma_f32_16x16x32_bf16 v[84:87], a[164:167], v[160:163], v[192:195]
  s_waitcnt lgkmcnt(4)
  v_mfma_f32_16x16x32_bf16 v[80:83], a[168:171], v[168:171], v[80:83]
  s_waitcnt vmcnt(28)
  s_barrier
  ds_read_b64_tr_b16 a[160:161], v232 offset:16384
  ds_read_b64_tr_b16 a[162:163], v232 offset:17408
  v_add_f32 v214, v214, v212
  v_mfma_f32_16x16x32_bf16 v[88:91], a[168:171], v[172:175], v[88:91]
  v_mfma_f32_16x16x32_bf16 v[92:95], a[172:175], v[172:175], v[92:95]
  ds_read_b64_tr_b16 a[164:165], v233 offset:16384
  ds_read_b64_tr_b16 a[166:167], v233 offset:17408
  s_add_u32 m0, s41, 147456
  s_nop 0
  buffer_load_dwordx4 v244, s[16:19], s34 offen offset:0 lds
  v_mfma_f32_16x16x32_bf16 v[84:87], a[172:175], v[168:171], v[84:87]
  s_waitcnt lgkmcnt(6)
  v_mfma_f32_16x16x32_bf16 v[80:83], a[176:179], v[176:179], v[80:83]
  ds_read_b64_tr_b16 a[168:169], v234 offset:16384
  ds_read_b64_tr_b16 a[170:171], v234 offset:17408
  v_cvt_pk_bf16_f32 v155, v212, v213
  v_exp_f32 v209, v121
  v_add_f32 v214, v214, v213
  v_mfma_f32_16x16x32_bf16 v[88:91], a[176:179], v[180:183], v[88:91]
  v_mfma_f32_16x16x32_bf16 v[92:95], a[180:183], v[180:183], v[92:95]
  ds_read_b64_tr_b16 a[172:173], v235 offset:16384
  ds_read_b64_tr_b16 a[174:175], v235 offset:17408
  v_exp_f32 v210, v122
  v_add_f32 v215, v215, v208
  v_mfma_f32_16x16x32_bf16 v[84:87], a[180:183], v[176:179], v[84:87]
  s_waitcnt lgkmcnt(8)
  v_mfma_f32_16x16x32_bf16 v[80:83], a[184:187], v[184:187], v[80:83]
  ds_read_b64_tr_b16 a[176:177], v236 offset:16384
  ds_read_b64_tr_b16 a[178:179], v236 offset:17408
  buffer_load_dwordx4 v245, s[16:19], s34 offen offset:1024 lds
  v_cvt_pk_bf16_f32 v156, v208, v209
  v_mfma_f32_16x16x32_bf16 v[88:91], a[184:187], v[188:191], v[88:91]
  v_mfma_f32_16x16x32_bf16 v[92:95], a[188:191], v[188:191], v[92:95]
  ds_read_b64_tr_b16 a[180:181], v237 offset:16384
  ds_read_b64_tr_b16 a[182:183], v237 offset:17408
  v_exp_f32 v211, v123
  v_add_f32 v215, v215, v209
  v_mfma_f32_16x16x32_bf16 v[84:87], a[188:191], v[184:187], v[84:87]
  s_waitcnt lgkmcnt(8)
  v_mfma_f32_16x16x32_bf16 v[0:3], a[160:163], a[96:99], v[0:3]
  ds_read_b64_tr_b16 a[184:185], v238 offset:16384
  ds_read_b64_tr_b16 a[186:187], v238 offset:17408
  v_exp_f32 v212, v124
  v_add_f32 v215, v215, v210
  v_mfma_f32_16x16x32_bf16 v[8:11], a[160:163], a[100:103], v[8:11]
  v_mfma_f32_16x16x32_bf16 v[12:15], a[164:167], a[100:103], v[12:15]
  ds_read_b64_tr_b16 a[188:189], v239 offset:16384
  ds_read_b64_tr_b16 a[190:191], v239 offset:17408
  buffer_load_dwordx4 v246, s[16:19], s34 offen offset:2048 lds
  v_cvt_pk_bf16_f32 v157, v210, v211
  v_mfma_f32_16x16x32_bf16 v[4:7], a[164:167], a[96:99], v[4:7]
  s_waitcnt lgkmcnt(8)
  v_mfma_f32_16x16x32_bf16 v[16:19], a[168:171], a[96:99], v[16:19]
  ds_read_b64_tr_b16 a[160:161], v232 offset:24576
  ds_read_b64_tr_b16 a[162:163], v232 offset:25600
  v_exp_f32 v213, v125
  v_add_f32 v215, v215, v211
  v_mfma_f32_16x16x32_bf16 v[24:27], a[168:171], a[100:103], v[24:27]
  v_mfma_f32_16x16x32_bf16 v[28:31], a[172:175], a[100:103], v[28:31]
  ds_read_b64_tr_b16 a[164:165], v233 offset:24576
  ds_read_b64_tr_b16 a[166:167], v233 offset:25600
  v_exp_f32 v208, v126
  v_add_f32 v215, v215, v212
  v_mfma_f32_16x16x32_bf16 v[20:23], a[172:175], a[96:99], v[20:23]
  s_waitcnt lgkmcnt(8)
  v_mfma_f32_16x16x32_bf16 v[32:35], a[176:179], a[96:99], v[32:35]
  ds_read_b64_tr_b16 a[168:169], v234 offset:24576
  ds_read_b64_tr_b16 a[170:171], v234 offset:25600
  buffer_load_dwordx4 v247, s[16:19], s34 offen offset:3072 lds
  s_add_u32 s34, s34, 524288
  s_sub_u32 s38, s34, 5242880
  s_min_u32 s34, s34, s38
  v_cvt_pk_bf16_f32 v158, v212, v213
  v_mfma_f32_16x16x32_bf16 v[40:43], a[176:179], a[100:103], v[40:43]
  v_mfma_f32_16x16x32_bf16 v[44:47], a[180:183], a[100:103], v[44:47]
  ds_read_b64_tr_b16 a[172:173], v235 offset:24576
  ds_read_b64_tr_b16 a[174:175], v235 offset:25600
  v_exp_f32 v209, v127
  v_add_f32 v215, v215, v213
  v_mfma_f32_16x16x32_bf16 v[36:39], a[180:183], a[96:99], v[36:39]
  s_waitcnt lgkmcnt(8)
  v_mfma_f32_16x16x32_bf16 v[48:51], a[184:187], a[96:99], v[48:51]
  ds_read_b64_tr_b16 a[176:177], v236 offset:24576
  ds_read_b64_tr_b16 a[178:179], v236 offset:25600
  v_add_f32 v215, v215, v208
  v_cvt_pk_bf16_f32 v159, v208, v209
  v_add_f32 v215, v215, v209
  v_add_f32 v210, v214, v215
  v_mfma_f32_16x16x32_bf16 v[56:59], a[184:187], a[100:103], v[56:59]
  v_mfma_f32_16x16x32_bf16 v[60:63], a[188:191], a[100:103], v[60:63]
  ds_read_b64_tr_b16 a[180:181], v237 offset:24576
  ds_read_b64_tr_b16 a[182:183], v237 offset:25600
  v_cmp_lt_f32 vcc, s35, v210
  v_mfma_f32_16x16x32_bf16 v[52:55], a[188:191], a[96:99], v[52:55]
  s_waitcnt lgkmcnt(8)
  v_mfma_f32_16x16x32_bf16 v[0:3], a[160:163], a[104:107], v[0:3]
  ds_read_b64_tr_b16 a[184:185], v238 offset:24576
  ds_read_b64_tr_b16 a[186:187], v238 offset:25600
  v_mfma_f32_16x16x32_bf16 v[8:11], a[160:163], a[108:111], v[8:11]
  v_mfma_f32_16x16x32_bf16 v[12:15], a[164:167], a[108:111], v[12:15]
  ds_read_b64_tr_b16 a[188:189], v239 offset:24576
  ds_read_b64_tr_b16 a[190:191], v239 offset:25600
  v_mfma_f32_16x16x32_bf16 v[4:7], a[164:167], a[104:107], v[4:7]
  s_waitcnt lgkmcnt(8)
  v_mfma_f32_16x16x32_bf16 v[16:19], a[168:171], a[104:107], v[16:19]
  s_waitcnt vmcnt(24)
  s_barrier
  ds_read_b64_tr_b16 a[160:161], v232 offset:32768
  ds_read_b64_tr_b16 a[162:163], v232 offset:33792
  v_mfma_f32_16x16x32_bf16 v[24:27], a[168:171], a[108:111], v[24:27]
  v_mfma_f32_16x16x32_bf16 v[28:31], a[172:175], a[108:111], v[28:31]
  ds_read_b64_tr_b16 a[164:165], v233 offset:32768
  ds_read_b64_tr_b16 a[166:167], v233 offset:33792
  s_add_u32 m0, s41, 0
  s_nop 0
  buffer_load_dwordx4 v240, s[8:11], s32 offen offset:0 nt lds
  v_mfma_f32_16x16x32_bf16 v[20:23], a[172:175], a[104:107], v[20:23]
  s_waitcnt lgkmcnt(8)
  v_mfma_f32_16x16x32_bf16 v[32:35], a[176:179], a[104:107], v[32:35]
  ds_read_b64_tr_b16 a[168:169], v234 offset:32768
  ds_read_b64_tr_b16 a[170:171], v234 offset:33792
  v_mfma_f32_16x16x32_bf16 v[40:43], a[176:179], a[108:111], v[40:43]
  v_mfma_f32_16x16x32_bf16 v[44:47], a[180:183], a[108:111], v[44:47]
  ds_read_b64_tr_b16 a[172:173], v235 offset:32768
  ds_read_b64_tr_b16 a[174:175], v235 offset:33792
  v_mfma_f32_16x16x32_bf16 v[36:39], a[180:183], a[104:107], v[36:39]
  s_waitcnt lgkmcnt(8)
  v_mfma_f32_16x16x32_bf16 v[48:51], a[184:187], a[104:107], v[48:51]
  ds_read_b64_tr_b16 a[176:177], v236 offset:32768
  ds_read_b64_tr_b16 a[178:179], v236 offset:33792
  buffer_load_dwordx4 v241, s[8:11], s32 offen offset:1024 nt lds
  v_mfma_f32_16x16x32_bf16 v[56:59], a[184:187], a[108:111], v[56:59]
  v_mfma_f32_16x16x32_bf16 v[60:63], a[188:191], a[108:111], v[60:63]
  ds_read_b64_tr_b16 a[180:181], v237 offset:32768
  ds_read_b64_tr_b16 a[182:183], v237 offset:33792
  v_mfma_f32_16x16x32_bf16 v[52:55], a[188:191], a[104:107], v[52:55]
  s_cbranch_vccnz SITE51
BACK51:
  s_waitcnt lgkmcnt(8)
  v_mfma_f32_16x16x32_bf16 a[192:195], a[160:163], v[144:147], a[192:195]
  ds_read_b64_tr_b16 a[184:185], v238 offset:32768
  ds_read_b64_tr_b16 a[186:187], v238 offset:33792
  v_add_f32 v249, v249, v214
  v_add_f32 v254, v254, v215
  v_exp_f32 v208, v64
  v_exp_f32 v209, v65
  v_mfma_f32_16x16x32_bf16 a[200:203], a[160:163], v[148:151], a[200:203]
  v_mfma_f32_16x16x32_bf16 a[204:207], a[164:167], v[148:151], a[204:207]
  ds_read_b64_tr_b16 a[188:189], v239 offset:32768
  ds_read_b64_tr_b16 a[190:191], v239 offset:33792
  buffer_load_dwordx4 v242, s[8:11], s32 offen offset:2048 nt lds
  v_mfma_f32_16x16x32_bf16 a[196:199], a[164:167], v[144:147], a[196:199]
  s_waitcnt lgkmcnt(8)
  v_mfma_f32_16x16x32_bf16 a[208:211], a[168:171], v[144:147], a[208:211]
  ds_read_b64_tr_b16 a[160:161], v232 offset:40960
  ds_read_b64_tr_b16 a[162:163], v232 offset:41984
  v_exp_f32 v210, v66
  v_cvt_pk_bf16_f32 v128, v208, v209
  v_exp_f32 v211, v67
  v_mfma_f32_16x16x32_bf16 a[216:219], a[168:171], v[148:151], a[216:219]
  v_mfma_f32_16x16x32_bf16 a[220:223], a[172:175], v[148:151], a[220:223]
  ds_read_b64_tr_b16 a[164:165], v233 offset:40960
  ds_read_b64_tr_b16 a[166:167], v233 offset:41984
  v_add_f32 v214, v208, v209
  v_exp_f32 v212, v68
  v_add_f32 v214, v214, v210
  v_mfma_f32_16x16x32_bf16 a[212:215], a[172:175], v[144:147], a[212:215]
  s_waitcnt lgkmcnt(8)
  v_mfma_f32_16x16x32_bf16 a[224:227], a[176:179], v[144:147], a[224:227]
  ds_read_b64_tr_b16 a[168:169], v234 offset:40960
  ds_read_b64_tr_b16 a[170:171], v234 offset:41984
  buffer_load_dwordx4 v243, s[8:11], s32 offen offset:3072 nt lds
  s_add_u32 s32, s32, 0x4000
  v_cvt_pk_bf16_f32 v129, v210, v211
  v_mfma_f32_16x16x32_bf16 a[232:235], a[176:179], v[148:151], a[232:235]
  v_mfma_f32_16x16x32_bf16 a[236:239], a[180:183], v[148:151], a[236:239]
  ds_read_b64_tr_b16 a[172:173], v235 offset:40960
  ds_read_b64_tr_b16 a[174:175], v235 offset:41984
  v_exp_f32 v213, v69
  v_add_f32 v214, v214, v211
  v_mfma_f32_16x16x32_bf16 a[228:231], a[180:183], v[144:147], a[228:231]
  s_waitcnt lgkmcnt(8)
  v_mfma_f32_16x16x32_bf16 a[240:243], a[184:187], v[144:147], a[240:243]
  ds_read_b64_tr_b16 a[176:177], v236 offset:40960
  ds_read_b64_tr_b16 a[178:179], v236 offset:41984
  v_exp_f32 v208, v70
  v_add_f32 v214, v214, v212
  v_cvt_pk_bf16_f32 v130, v212, v213
  v_mfma_f32_16x16x32_bf16 a[248:251], a[184:187], v[148:151], a[248:251]
  v_mfma_f32_16x16x32_bf16 a[252:255], a[188:191], v[148:151], a[252:255]
  ds_read_b64_tr_b16 a[180:181], v237 offset:40960
  ds_read_b64_tr_b16 a[182:183], v237 offset:41984
  v_exp_f32 v209, v71
  v_add_f32 v214, v214, v213
  v_exp_f32 v210, v72
  v_mfma_f32_16x16x32_bf16 a[244:247], a[188:191], v[144:147], a[244:247]
  s_waitcnt lgkmcnt(8)
  v_mfma_f32_16x16x32_bf16 a[192:195], a[160:163], v[152:155], a[192:195]
  ds_read_b64_tr_b16 a[184:185], v238 offset:40960
  ds_read_b64_tr_b16 a[186:187], v238 offset:41984
  v_add_f32 v214, v214, v208
  v_cvt_pk_bf16_f32 v131, v208, v209
  v_exp_f32 v211, v73
  v_mfma_f32_16x16x32_bf16 a[200:203], a[160:163], v[156:159], a[200:203]
  v_mfma_f32_16x16x32_bf16 a[204:207], a[164:167], v[156:159], a[204:207]
  ds_read_b64_tr_b16 a[188:189], v239 offset:40960
  ds_read_b64_tr_b16 a[190:191], v239 offset:41984
  v_add_f32 v214, v214, v209
  v_exp_f32 v212, v74
  v_mfma_f32_16x16x32_bf16 a[196:199], a[164:167], v[152:155], a[196:199]
  s_waitcnt lgkmcnt(8)
  v_mfma_f32_16x16x32_bf16 a[208:211], a[168:171], v[152:155], a[208:211]
  s_barrier
  ds_read_b128 a[160:163], v224 offset:16384
  v_cvt_pk_bf16_f32 v132, v210, v211
  v_exp_f32 v213, v75
  v_add_f32 v215, v210, v211
  v_mfma_f32_16x16x32_bf16 a[216:219], a[168:171], v[156:159], a[216:219]
  v_mfma_f32_16x16x32_bf16 a[220:223], a[172:175], v[156:159], a[220:223]
  ds_read_b128 a[164:167], v224 offset:20480
  s_add_u32 m0, s41, 81920
  s_nop 0
  buffer_load_dwordx4 v244, s[16:19], s34 offen offset:0 lds
  v_exp_f32 v208, v76
  v_mfma_f32_16x16x32_bf16 a[212:215], a[172:175], v[152:155], a[212:215]
  s_waitcnt lgkmcnt(6)
  v_mfma_f32_16x16x32_bf16 a[224:227], a[176:179], v[152:155], a[224:227]
  ds_read_b128 a[168:171], v225 offset:16384
  v_add_f32 v215, v215, v212
  v_cvt_pk_bf16_f32 v133, v212, v213
  v_exp_f32 v209, v77
  v_mfma_f32_16x16x32_bf16 a[232:235], a[176:179], v[156:159], a[232:235]
  v_mfma_f32_16x16x32_bf16 a[236:239], a[180:183], v[156:159], a[236:239]
  ds_read_b128 a[172:175], v225 offset:20480
  v_add_f32 v215, v215, v213
  v_exp_f32 v210, v78
  v_add_f32 v215, v215, v208
  v_cvt_pk_bf16_f32 v134, v208, v209
  v_mfma_f32_16x16x32_bf16 a[228:231], a[180:183], v[152:155], a[228:231]
  s_waitcnt lgkmcnt(4)
  v_mfma_f32_16x16x32_bf16 a[240:243], a[184:187], v[152:155], a[240:243]
  ds_read_b128 a[176:179], v226 offset:16384
  buffer_load_dwordx4 v245, s[16:19], s34 offen offset:1024 lds
  v_exp_f32 v211, v79
  v_mfma_f32_16x16x32_bf16 a[248:251], a[184:187], v[156:159], a[248:251]
  v_mfma_f32_16x16x32_bf16 a[252:255], a[188:191], v[156:159], a[252:255]
  ds_read_b128 a[180:183], v226 offset:20480
  v_add_f32 v215, v215, v209
  v_exp_f32 v212, v80
  v_add_f32 v215, v215, v210
  v_mfma_f32_16x16x32_bf16 a[244:247], a[188:191], v[152:155], a[244:247]
  s_waitcnt lgkmcnt(4)
  v_mfma_f32_16x16x32_bf16 v[96:99], a[160:163], v[160:163], v[192:195]
  ds_read_b128 a[184:187], v227 offset:16384
  v_cvt_pk_bf16_f32 v135, v210, v211
  v_exp_f32 v213, v81
  v_add_f32 v215, v215, v211
  v_exp_f32 v208, v82
  v_mfma_f32_16x16x32_bf16 v[104:107], a[160:163], v[164:167], v[196:199]
  v_mfma_f32_16x16x32_bf16 v[108:111], a[164:167], v[164:167], v[196:199]
  ds_read_b128 a[188:191], v227 offset:20480
  buffer_load_dwordx4 v246, s[16:19], s34 offen offset:2048 lds
  v_add_f32 v214, v214, v212
  v_mfma_f32_16x16x32_bf16 v[100:103], a[164:167], v[160:163], v[192:195]
  s_waitcnt lgkmcnt(4)
  v_mfma_f32_16x16x32_bf16 v[96:99], a[168:171], v[168:171], v[96:99]
  ds_read_b128 a[160:163], v224 offset:18432
  v_cvt_pk_bf16_f32 v136, v212, v213
  v_exp_f32 v209, v83
  v_add_f32 v214, v214, v213
  v_mfma_f32_16x16x32_bf16 v[104:107], a[168:171], v[172:175], v[104:107]
  v_mfma_f32_16x16x32_bf16 v[108:111], a[172:175], v[172:175], v[108:111]
  ds_read_b128 a[164:167], v224 offset:22528
  v_exp_f32 v210, v84
  v_add_f32 v214, v214, v208
  v_cvt_pk_bf16_f32 v137, v208, v209
  v_exp_f32 v211, v85
  v_mfma_f32_16x16x32_bf16 v[100:103], a[172:175], v[168:171], v[100:103]
  s_waitcnt lgkmcnt(4)
  v_mfma_f32_16x16x32_bf16 v[96:99], a[176:179], v[176:179], v[96:99]
  ds_read_b128 a[168:171], v225 offset:18432
  buffer_load_dwordx4 v247, s[16:19], s34 offen offset:3072 lds
  s_add_u32 s34, s34, 524544
  s_sub_u32 s38, s34, 5242880
  s_min_u32 s34, s34, s38
  v_add_f32 v214, v214, v209
  v_mfma_f32_16x16x32_bf16 v[104:107], a[176:179], v[180:183], v[104:107]
  v_mfma_f32_16x16x32_bf16 v[108:111], a[180:183], v[180:183], v[108:111]
  ds_read_b128 a[172:175], v225 offset:22528
  v_exp_f32 v212, v86
  v_add_f32 v214, v214, v210
  v_cvt_pk_bf16_f32 v138, v210, v211
  v_mfma_f32_16x16x32_bf16 v[100:103], a[180:183], v[176:179], v[100:103]
  s_waitcnt lgkmcnt(4)
  v_mfma_f32_16x16x32_bf16 v[96:99], a[184:187], v[184:187], v[96:99]
  ds_read_b128 a[176:179], v226 offset:18432
  v_exp_f32 v213, v87
  v_add_f32 v214, v214, v211
  v_exp_f32 v208, v88
  v_mfma_f32_16x16x32_bf16 v[104:107], a[184:187], v[188:191], v[104:107]
  v_mfma_f32_16x16x32_bf16 v[108:111], a[188:191], v[188:191], v[108:111]
  ds_read_b128 a[180:183], v226 offset:22528
  v_add_f32 v214, v214, v212
  v_cvt_pk_bf16_f32 v139, v212, v213
  v_exp_f32 v209, v89
  v_add_f32 v214, v214, v213
  v_mfma_f32_16x16x32_bf16 v[100:103], a[188:191], v[184:187], v[100:103]
  s_waitcnt lgkmcnt(4)
  v_mfma_f32_16x16x32_bf16 v[112:115], a[160:163], v[160:163], v[192:195]
  ds_read_b128 a[184:187], v227 offset:18432
  v_exp_f32 v210, v90
  v_add_f32 v215, v215, v208
  v_cvt_pk_bf16_f32 v140, v208, v209
  v_exp_f32 v211, v91
  v_mfma_f32_16x16x32_bf16 v[120:123], a[160:163], v[164:167], v[196:199]
  v_mfma_f32_16x16x32_bf16 v[124:127], a[164:167], v[164:167], v[196:199]
  ds_read_b128 a[188:191], v227 offset:22528
  v_add_f32 v215, v215, v209
  v_exp_f32 v212, v92
  v_add_f32 v215, v215, v210
  v_mfma_f32_16x16x32_bf16 v[116:119], a[164:167], v[160:163], v[192:195]
  s_waitcnt lgkmcnt(4)
  v_mfma_f32_16x16x32_bf16 v[112:115], a[168:171], v[168:171], v[112:115]
  s_waitcnt vmcnt(24)
  s_barrier
  ds_read_b64_tr_b16 a[160:161], v232 offset:49152
  ds_read_b64_tr_b16 a[162:163], v232 offset:50176
  v_cvt_pk_bf16_f32 v141, v210, v211
  v_mfma_f32_16x16x32_bf16 v[120:123], a[168:171], v[172:175], v[120:123]
  v_mfma_f32_16x16x32_bf16 v[124:127], a[172:175], v[172:175], v[124:127]
  ds_read_b64_tr_b16 a[164:165], v233 offset:49152
  ds_read_b64_tr_b16 a[166:167], v233 offset:50176
  s_add_u32 m0, s41, 98304
  s_nop 0
  buffer_load_dwordx4 v248, s[12:15], s33 offen offset:0 nt lds
  v_exp_f32 v213, v93
  v_mfma_f32_16x16x32_bf16 v[116:119], a[172:175], v[168:171], v[116:119]
  s_waitcnt lgkmcnt(6)
  v_mfma_f32_16x16x32_bf16 v[112:115], a[176:179], v[176:179], v[112:115]
  ds_read_b64_tr_b16 a[168:169], v234 offset:49152
  ds_read_b64_tr_b16 a[170:171], v234 offset:50176
  v_add_f32 v215, v215, v211
  v_exp_f32 v208, v94
  v_add_f32 v215, v215, v212
  v_mfma_f32_16x16x32_bf16 v[120:123], a[176:179], v[180:183], v[120:123]
  v_mfma_f32_16x16x32_bf16 v[124:127], a[180:183], v[180:183], v[124:127]
  ds_read_b64_tr_b16 a[172:173], v235 offset:49152
  ds_read_b64_tr_b16 a[174:175], v235 offset:50176
  v_cvt_pk_bf16_f32 v142, v212, v213
  v_exp_f32 v209, v95
  v_add_f32 v215, v215, v213
  v_mfma_f32_16x16x32_bf16 v[116:119], a[180:183], v[176:179], v[116:119]
  s_waitcnt lgkmcnt(8)
  v_mfma_f32_16x16x32_bf16 v[112:115], a[184:187], v[184:187], v[112:115]
  ds_read_b64_tr_b16 a[176:177], v236 offset:49152
  ds_read_b64_tr_b16 a[178:179], v236 offset:50176
  buffer_load_dwordx4 v248, s[12:15], s33 offen offset:1024 nt lds
  v_add_f32 v215, v215, v208
  v_mfma_f32_16x16x32_bf16 v[120:123], a[184:187], v[188:191], v[120:123]
  v_mfma_f32_16x16x32_bf16 v[124:127], a[188:191], v[188:191], v[124:127]
  ds_read_b64_tr_b16 a[180:181], v237 offset:49152
  ds_read_b64_tr_b16 a[182:183], v237 offset:50176
  v_cvt_pk_bf16_f32 v143, v208, v209
  v_add_f32 v215, v215, v209
  v_add_f32 v210, v214, v215
  v_cmp_lt_f32 vcc, s35, v210
  v_mfma_f32_16x16x32_bf16 v[116:119], a[188:191], v[184:187], v[116:119]
  s_cbranch_vccnz SITE53
BACK53:
  s_waitcnt lgkmcnt(8)
  v_mfma_f32_16x16x32_bf16 a[192:195], a[160:163], v[128:131], a[192:195]
  ds_read_b64_tr_b16 a[184:185], v238 offset:49152
  ds_read_b64_tr_b16 a[186:187], v238 offset:50176
  v_mfma_f32_16x16x32_bf16 a[200:203], a[160:163], v[132:135], a[200:203]
  v_mfma_f32_16x16x32_bf16 a[204:207], a[164:167], v[132:135], a[204:207]
  ds_read_b64_tr_b16 a[188:189], v239 offset:49152
  ds_read_b64_tr_b16 a[190:191], v239 offset:50176
  buffer_load_dwordx4 v248, s[12:15], s33 offen offset:2048 nt lds
  v_mfma_f32_16x16x32_bf16 a[196:199], a[164:167], v[128:131], a[196:199]
  s_waitcnt lgkmcnt(8)
  v_mfma_f32_16x16x32_bf16 a[208:211], a[168:171], v[128:131], a[208:211]
  ds_read_b64_tr_b16 a[160:161], v232 offset:57344
  ds_read_b64_tr_b16 a[162:163], v232 offset:58368
  v_add_f32 v249, v249, v214
  v_add_f32 v254, v254, v215
  v_exp_f32 v208, v96
  v_exp_f32 v209, v97
  v_mfma_f32_16x16x32_bf16 a[216:219], a[168:171], v[132:135], a[216:219]
  v_mfma_f32_16x16x32_bf16 a[220:223], a[172:175], v[132:135], a[220:223]
  ds_read_b64_tr_b16 a[164:165], v233 offset:57344
  ds_read_b64_tr_b16 a[166:167], v233 offset:58368
  v_exp_f32 v210, v98
  v_mfma_f32_16x16x32_bf16 a[212:215], a[172:175], v[128:131], a[212:215]
  s_waitcnt lgkmcnt(8)
  v_mfma_f32_16x16x32_bf16 a[224:227], a[176:179], v[128:131], a[224:227]
  ds_read_b64_tr_b16 a[168:169], v234 offset:57344
  ds_read_b64_tr_b16 a[170:171], v234 offset:58368
  buffer_load_dwordx4 v248, s[12:15], s33 offen offset:3072 nt lds
  s_add_u32 s33, s33, 0x4000
  v_cvt_pk_bf16_f32 v144, v208, v209
  v_mfma_f32_16x16x32_bf16 a[232:235], a[176:179], v[132:135], a[232:235]
  v_mfma_f32_16x16x32_bf16 a[236:239], a[180:183], v[132:135], a[236:239]
  ds_read_b64_tr_b16 a[172:173], v235 offset:57344
  ds_read_b64_tr_b16 a[174:175], v235 offset:58368
  v_exp_f32 v211, v99
  v_add_f32 v214, v208, v209
  v_mfma_f32_16x16x32_bf16 a[228:231], a[180:183], v[128:131], a[228:231]
  s_waitcnt lgkmcnt(8)
  v_mfma_f32_16x16x32_bf16 a[240:243], a[184:187], v[128:131], a[240:243]
  ds_read_b64_tr_b16 a[176:177], v236 offset:57344
  ds_read_b64_tr_b16 a[178:179], v236 offset:58368
  v_exp_f32 v212, v100
  v_add_f32 v214, v214, v210
  v_cvt_pk_bf16_f32 v145, v210, v211
  v_mfma_f32_16x16x32_bf16 a[248:251], a[184:187], v[132:135], a[248:251]
  v_mfma_f32_16x16x32_bf16 a[252:255], a[188:191], v[132:135], a[252:255]
  ds_read_b64_tr_b16 a[180:181], v237 offset:57344
  ds_read_b64_tr_b16 a[182:183], v237 offset:58368
  v_exp_f32 v213, v101
  v_add_f32 v214, v214, v211
  v_mfma_f32_16x16x32_bf16 a[244:247], a[188:191], v[128:131], a[244:247]
  s_waitcnt lgkmcnt(8)
  v_mfma_f32_16x16x32_bf16 a[192:195], a[160:163], v[136:139], a[192:195]
  ds_read_b64_tr_b16 a[184:185], v238 offset:57344
  ds_read_b64_tr_b16 a[186:187], v238 offset:58368
  v_exp_f32 v208, v102
  v_add_f32 v214, v214, v212
  v_mfma_f32_16x16x32_bf16 a[200:203], a[160:163], v[140:143], a[200:203]
  v_mfma_f32_16x16x32_bf16 a[204:207], a[164:167], v[140:143], a[204:207]
  ds_read_b64_tr_b16 a[188:189], v239 offset:57344
  ds_read_b64_tr_b16 a[190:191], v239 offset:58368
  v_cvt_pk_bf16_f32 v146, v212, v213
  v_exp_f32 v209, v103
  v_add_f32 v214, v214, v213
  v_mfma_f32_16x16x32_bf16 a[196:199], a[164:167], v[136:139], a[196:199]
  s_waitcnt lgkmcnt(8)
  v_mfma_f32_16x16x32_bf16 a[208:211], a[168:171], v[136:139], a[208:211]
  s_barrier
  ds_read_b128 a[160:163], v224 offset:32768
  v_exp_f32 v210, v104
  v_add_f32 v214, v214, v208
  v_mfma_f32_16x16x32_bf16 a[216:219], a[168:171], v[140:143], a[216:219]
  v_mfma_f32_16x16x32_bf16 a[220:223], a[172:175], v[140:143], a[220:223]
  ds_read_b128 a[164:167], v224 offset:36864
  s_add_u32 m0, s41, 16384
  s_nop 0
  buffer_load_dwordx4 v240, s[8:11], s32 offen offset:0 nt lds
  v_cvt_pk_bf16_f32 v147, v208, v209
  v_mfma_f32_16x16x32_bf16 a[212:215], a[172:175], v[136:139], a[212:215]
  s_waitcnt lgkmcnt(6)
  v_mfma_f32_16x16x32_bf16 a[224:227], a[176:179], v[136:139], a[224:227]
  ds_read_b128 a[168:171], v225 offset:32768
  v_exp_f32 v211, v105
  v_add_f32 v214, v214, v209
  v_exp_f32 v212, v106
  v_mfma_f32_16x16x32_bf16 a[232:235], a[176:179], v[140:143], a[232:235]
  v_mfma_f32_16x16x32_bf16 a[236:239], a[180:183], v[140:143], a[236:239]
  ds_read_b128 a[172:175], v225 offset:36864
  v_cvt_pk_bf16_f32 v148, v210, v211
  v_exp_f32 v213, v107
  v_mfma_f32_16x16x32_bf16 a[228:231], a[180:183], v[136:139], a[228:231]
  s_waitcnt lgkmcnt(4)
  v_mfma_f32_16x16x32_bf16 a[240:243], a[184:187], v[136:139], a[240:243]
  ds_read_b128 a[176:179], v226 offset:32768
  buffer_load_dwordx4 v241, s[8:11], s32 offen offset:1024 nt lds
  v_add_f32 v215, v210, v211
  v_mfma_f32_16x16x32_bf16 a[248:251], a[184:187], v[140:143], a[248:251]
  v_mfma_f32_16x16x32_bf16 a[252:255], a[188:191], v[140:143], a[252:255]
  ds_read_b128 a[180:183], v226 offset:36864
  v_exp_f32 v208, v108
  v_add_f32 v215, v215, v212
  v_cvt_pk_bf16_f32 v149, v212, v213
  v_mfma_f32_16x16x32_bf16 a[244:247], a[188:191], v[136:139], a[244:247]
  s_waitcnt lgkmcnt(4)
  v_mfma_f32_16x16x32_bf16 v[64:67], a[160:163], v[160:163], v[192:195]
  ds_read_b128 a[184:187], v227 offset:32768
  v_exp_f32 v209, v109
  v_add_f32 v215, v215, v213
  v_exp_f32 v210, v110
  v_mfma_f32_16x16x32_bf16 v[72:75], a[160:163], v[164:167], v[196:199]
  v_mfma_f32_16x16x32_bf16 v[76:79], a[164:167], v[164:167], v[196:199]
  ds_read_b128 a[188:191], v227 offset:36864
  buffer_load_dwordx4 v242, s[8:11], s32 offen offset:2048 nt lds
  v_add_f32 v215, v215, v208
  v_mfma_f32_16x16x32_bf16 v[68:71], a[164:167], v[160:163], v[192:195]
  s_waitcnt lgkmcnt(4)
  v_mfma_f32_16x16x32_bf16 v[64:67], a[168:171], v[168:171], v[64:67]
  ds_read_b128 a[160:163], v224 offset:34816
  v_cvt_pk_bf16_f32 v150, v208, v209
  v_exp_f32 v211, v111
  v_add_f32 v215, v215, v209
  v_mfma_f32_16x16x32_bf16 v[72:75], a[168:171], v[172:175], v[72:75]
  v_mfma_f32_16x16x32_bf16 v[76:79], a[172:175], v[172:175], v[76:79]
  ds_read_b128 a[164:167], v224 offset:38912
  v_exp_f32 v212, v112
  v_add_f32 v215, v215, v210
  v_cvt_pk_bf16_f32 v151, v210, v211
  v_mfma_f32_16x16x32_bf16 v[68:71], a[172:175], v[168:171], v[68:71]
  s_waitcnt lgkmcnt(4)
  v_mfma_f32_16x16x32_bf16 v[64:67], a[176:179], v[176:179], v[64:67]
  ds_read_b128 a[168:171], v225 offset:34816
  buffer_load_dwordx4 v243, s[8:11], s32 offen offset:3072 nt lds
  s_add_u32 s32, s32, 0x4000
  v_exp_f32 v213, v113
  v_mfma_f32_16x16x32_bf16 v[72:75], a[176:179], v[180:183], v[72:75]
  v_mfma_f32_16x16x32_bf16 v[76:79], a[180:183], v[180:183], v[76:79]
  ds_read_b128 a[172:175], v225 offset:38912
  v_add_f32 v215, v215, v211
  v_exp_f32 v208, v114
  v_mfma_f32_16x16x32_bf16 v[68:71], a[180:183], v[176:179], v[68:71]
  s_waitcnt lgkmcnt(4)
  v_mfma_f32_16x16x32_bf16 v[64:67], a[184:187], v[184:187], v[64:67]
  ds_read_b128 a[176:179], v226 offset:34816
  v_add_f32 v214, v214, v212
  v_cvt_pk_bf16_f32 v152, v212, v213
  v_exp_f32 v209, v115
  v_add_f32 v214, v214, v213
  v_mfma_f32_16x16x32_bf16 v[72:75], a[184:187], v[188:191], v[72:75]
  v_mfma_f32_16x16x32_bf16 v[76:79], a[188:191], v[188:191], v[76:79]
  ds_read_b128 a[180:183], v226 offset:38912
  v_exp_f32 v210, v116
  v_add_f32 v214, v214, v208
  v_cvt_pk_bf16_f32 v153, v208, v209
  v_mfma_f32_16x16x32_bf16 v[68:71], a[188:191], v[184:187], v[68:71]
  s_waitcnt lgkmcnt(4)
  v_mfma_f32_16x16x32_bf16 v[80:83], a[160:163], v[160:163], v[192:195]
  ds_read_b128 a[184:187], v227 offset:34816
  v_exp_f32 v211, v117
  v_add_f32 v214, v214, v209
  v_exp_f32 v212, v118
  v_mfma_f32_16x16x32_bf16 v[88:91], a[160:163], v[164:167], v[196:199]
  v_mfma_f32_16x16x32_bf16 v[92:95], a[164:167], v[164:167], v[196:199]
  ds_read_b128 a[188:191], v227 offset:38912
  v_add_f32 v214, v214, v210
  v_cvt_pk_bf16_f32 v154, v210, v211
  v_exp_f32 v213, v119
  v_mfma_f32_16x16x32_bf16 v[84:87], a[164:167], v[160:163], v[192:195]
  s_waitcnt lgkmcnt(4)
  v_mfma_f32_16x16x32_bf16 v[80:83], a[168:171], v[168:171], v[80:83]
  s_waitcnt vmcnt(28)
  s_barrier
  ds_read_b64_tr_b16 a[160:161], v232 offset:0
  ds_read_b64_tr_b16 a[162:163], v232 offset:1024
  v_add_f32 v214, v214, v211
  v_mfma_f32_16x16x32_bf16 v[88:91], a[168:171], v[172:175], v[88:91]
  v_mfma_f32_16x16x32_bf16 v[92:95], a[172:175], v[172:175], v[92:95]
  ds_read_b64_tr_b16 a[164:165], v233 offset:0
  ds_read_b64_tr_b16 a[166:167], v233 offset:1024
  s_add_u32 m0, s41, 114688
  s_nop 0
  buffer_load_dwordx4 v248, s[12:15], s33 offen offset:0 nt lds
  v_mfma_f32_16x16x32_bf16 v[84:87], a[172:175], v[168:171], v[84:87]
  s_waitcnt lgkmcnt(6)
  v_mfma_f32_16x16x32_bf16 v[80:83], a[176:179], v[176:179], v[80:83]
  ds_read_b64_tr_b16 a[168:169], v234 offset:0
  ds_read_b64_tr_b16 a[170:171], v234 offset:1024
  v_exp_f32 v208, v120
  v_add_f32 v214, v214, v212
  v_cvt_pk_bf16_f32 v155, v212, v213
  v_mfma_f32_16x16x32_bf16 v[88:91], a[176:179], v[180:183], v[88:91]
  v_mfma_f32_16x16x32_bf16 v[92:95], a[180:183], v[180:183], v[92:95]
  ds_read_b64_tr_b16 a[172:173], v235 offset:0
  ds_read_b64_tr_b16 a[174:175], v235 offset:1024
  v_exp_f32 v209, v121
  v_add_f32 v214, v214, v213
  v_mfma_f32_16x16x32_bf16 v[84:87], a[180:183], v[176:179], v[84:87]
  s_waitcnt lgkmcnt(8)
  v_mfma_f32_16x16x32_bf16 v[80:83], a[184:187], v[184:187], v[80:83]
  ds_read_b64_tr_b16 a[176:177], v236 offset:0
  ds_read_b64_tr_b16 a[178:179], v236 offset:1024
  buffer_load_dwordx4 v248, s[12:15], s33 offen offset:1024 nt lds
  v_exp_f32 v210, v122
  v_mfma_f32_16x16x32_bf16 v[88:91], a[184:187], v[188:191], v[88:91]
  v_mfma_f32_16x16x32_bf16 v[92:95], a[188:191], v[188:191], v[92:95]
  ds_read_b64_tr_b16 a[180:181], v237 offset:0
  ds_read_b64_tr_b16 a[182:183], v237 offset:1024
  v_add_f32 v215, v215, v208
  v_cvt_pk_bf16_f32 v156, v208, v209
  v_mfma_f32_16x16x32_bf16 v[84:87], a[188:191], v[184:187], v[84:87]
  s_waitcnt lgkmcnt(8)
  v_mfma_f32_16x16x32_bf16 v[0:3], a[160:163], a[112:115], v[0:3]
  ds_read_b64_tr_b16 a[184:185], v238 offset:0
  ds_read_b64_tr_b16 a[186:187], v238 offset:1024
  v_exp_f32 v211, v123
  v_add_f32 v215, v215, v209
  v_mfma_f32_16x16x32_bf16 v[8:11], a[160:163], a[116:119], v[8:11]
  v_mfma_f32_16x16x32_bf16 v[12:15], a[164:167], a[116:119], v[12:15]
  ds_read_b64_tr_b16 a[188:189], v239 offset:0
  ds_read_b64_tr_b16 a[190:191], v239 offset:1024
  buffer_load_dwordx4 v248, s[12:15], s33 offen offset:2048 nt lds
  v_exp_f32 v212, v124
  v_mfma_f32_16x16x32_bf16 v[4:7], a[164:167], a[112:115], v[4:7]
  s_waitcnt lgkmcnt(8)
  v_mfma_f32_16x16x32_bf16 v[16:19], a[168:171], a[112:115], v[16:19]
  ds_read_b64_tr_b16 a[160:161], v232 offset:8192
  ds_read_b64_tr_b16 a[162:163], v232 offset:9216
  v_add_f32 v215, v215, v210
  v_cvt_pk_bf16_f32 v157, v210, v211
  v_mfma_f32_16x16x32_bf16 v[24:27], a[168:171], a[116:119], v[24:27]
  v_mfma_f32_16x16x32_bf16 v[28:31], a[172:175], a[116:119], v[28:31]
  ds_read_b64_tr_b16 a[164:165], v233 offset:8192
  ds_read_b64_tr_b16 a[166:167], v233 offset:9216
  v_exp_f32 v213, v125
  v_add_f32 v215, v215, v211
  v_exp_f32 v208, v126
  v_mfma_f32_16x16x32_bf16 v[20:23], a[172:175], a[112:115], v[20:23]
  s_waitcnt lgkmcnt(8)
  v_mfma_f32_16x16x32_bf16 v[32:35], a[176:179], a[112:115], v[32:35]
  ds_read_b64_tr_b16 a[168:169], v234 offset:8192
  ds_read_b64_tr_b16 a[170:171], v234 offset:9216
  buffer_load_dwordx4 v248, s[12:15], s33 offen offset:3072 nt lds
  s_add_u32 s33, s33, 0x4000
  v_mfma_f32_16x16x32_bf16 v[40:43], a[176:179], a[116:119], v[40:43]
  v_mfma_f32_16x16x32_bf16 v[44:47], a[180:183], a[116:119], v[44:47]
  ds_read_b64_tr_b16 a[172:173], v235 offset:8192
  ds_read_b64_tr_b16 a[174:175], v235 offset:9216
  v_add_f32 v215, v215, v212
  v_cvt_pk_bf16_f32 v158, v212, v213
  v_exp_f32 v209, v127
  v_mfma_f32_16x16x32_bf16 v[36:39], a[180:183], a[112:115], v[36:39]
  s_waitcnt lgkmcnt(8)
  v_mfma_f32_16x16x32_bf16 v[48:51], a[184:187], a[112:115], v[48:51]
  ds_read_b64_tr_b16 a[176:177], v236 offset:8192
  ds_read_b64_tr_b16 a[178:179], v236 offset:9216
  v_add_f32 v215, v215, v213
  v_add_f32 v215, v215, v208
  v_mfma_f32_16x16x32_bf16 v[56:59], a[184:187], a[116:119], v[56:59]
  v_mfma_f32_16x16x32_bf16 v[60:63], a[188:191], a[116:119], v[60:63]
  ds_read_b64_tr_b16 a[180:181], v237 offset:8192
  ds_read_b64_tr_b16 a[182:183], v237 offset:9216
  v_cvt_pk_bf16_f32 v159, v208, v209
  v_add_f32 v215, v215, v209
  v_add_f32 v210, v214, v215
  v_cmp_lt_f32 vcc, s35, v210
  v_mfma_f32_16x16x32_bf16 v[52:55], a[188:191], a[112:115], v[52:55]
  s_waitcnt lgkmcnt(8)
  v_mfma_f32_16x16x32_bf16 v[0:3], a[160:163], a[120:123], v[0:3]
  ds_read_b64_tr_b16 a[184:185], v238 offset:8192
  ds_read_b64_tr_b16 a[186:187], v238 offset:9216
  v_mfma_f32_16x16x32_bf16 v[8:11], a[160:163], a[124:127], v[8:11]
  v_mfma_f32_16x16x32_bf16 v[12:15], a[164:167], a[124:127], v[12:15]
  ds_read_b64_tr_b16 a[188:189], v239 offset:8192
  ds_read_b64_tr_b16 a[190:191], v239 offset:9216
  v_mfma_f32_16x16x32_bf16 v[4:7], a[164:167], a[120:123], v[4:7]
  s_waitcnt lgkmcnt(8)
  v_mfma_f32_16x16x32_bf16 v[16:19], a[168:171], a[120:123], v[16:19]
  s_waitcnt vmcnt(24)
  s_barrier
  ds_read_b64_tr_b16 a[160:161], v200 offset:0
  ds_read_b64_tr_b16 a[162:163], v200 offset:1024
  v_mfma_f32_16x16x32_bf16 v[24:27], a[168:171], a[124:127], v[24:27]
  v_mfma_f32_16x16x32_bf16 v[28:31], a[172:175], a[124:127], v[28:31]
  ds_read_b64_tr_b16 a[164:165], v201 offset:0
  ds_read_b64_tr_b16 a[166:167], v201 offset:1024
  s_add_u32 m0, s41, 32768
  s_nop 0
  buffer_load_dwordx4 v240, s[8:11], s32 offen offset:0 nt lds
  v_mfma_f32_16x16x32_bf16 v[20:23], a[172:175], a[120:123], v[20:23]
  s_waitcnt lgkmcnt(8)
  v_mfma_f32_16x16x32_bf16 v[32:35], a[176:179], a[120:123], v[32:35]
  ds_read_b64_tr_b16 a[168:169], v202 offset:0
  ds_read_b64_tr_b16 a[170:171], v202 offset:1024
  v_mfma_f32_16x16x32_bf16 v[40:43], a[176:179], a[124:127], v[40:43]
  v_mfma_f32_16x16x32_bf16 v[44:47], a[180:183], a[124:127], v[44:47]
  ds_read_b64_tr_b16 a[172:173], v203 offset:0
  ds_read_b64_tr_b16 a[174:175], v203 offset:1024
  v_mfma_f32_16x16x32_bf16 v[36:39], a[180:183], a[120:123], v[36:39]
  s_waitcnt lgkmcnt(8)
  v_mfma_f32_16x16x32_bf16 v[48:51], a[184:187], a[120:123], v[48:51]
  ds_read_b64_tr_b16 a[176:177], v204 offset:0
  ds_read_b64_tr_b16 a[178:179], v204 offset:1024
  buffer_load_dwordx4 v241, s[8:11], s32 offen offset:1024 nt lds
  v_mfma_f32_16x16x32_bf16 v[56:59], a[184:187], a[124:127], v[56:59]
  v_mfma_f32_16x16x32_bf16 v[60:63], a[188:191], a[124:127], v[60:63]
  ds_read_b64_tr_b16 a[180:181], v205 offset:0
  ds_read_b64_tr_b16 a[182:183], v205 offset:1024
  v_mfma_f32_16x16x32_bf16 v[52:55], a[188:191], a[120:123], v[52:55]
  s_cbranch_vccnz SITE56
BACK56:
  s_waitcnt lgkmcnt(8)
  v_mfma_f32_16x16x32_bf16 a[192:195], a[160:163], v[144:147], a[192:195]
  ds_read_b64_tr_b16 a[184:185], v206 offset:0
  ds_read_b64_tr_b16 a[186:187], v206 offset:1024
  v_add_f32 v249, v249, v214
  v_add_f32 v254, v254, v215
  v_exp_f32 v208, v64
  v_exp_f32 v209, v65
  v_mfma_f32_16x16x32_bf16 a[200:203], a[160:163], v[148:151], a[200:203]
  v_mfma_f32_16x16x32_bf16 a[204:207], a[164:167], v[148:151], a[204:207]
  ds_read_b64_tr_b16 a[188:189], v207 offset:0
  ds_read_b64_tr_b16 a[190:191], v207 offset:1024
  buffer_load_dwordx4 v242, s[8:11], s32 offen offset:2048 nt lds
  v_mfma_f32_16x16x32_bf16 a[196:199], a[164:167], v[144:147], a[196:199]
  s_waitcnt lgkmcnt(8)
  v_mfma_f32_16x16x32_bf16 a[208:211], a[168:171], v[144:147], a[208:211]
  ds_read_b64_tr_b16 a[160:161], v200 offset:8192
  ds_read_b64_tr_b16 a[162:163], v200 offset:9216
  v_exp_f32 v210, v66
  v_cvt_pk_bf16_f32 v128, v208, v209
  v_exp_f32 v211, v67
  v_mfma_f32_16x16x32_bf16 a[216:219], a[168:171], v[148:151], a[216:219]
  v_mfma_f32_16x16x32_bf16 a[220:223], a[172:175], v[148:151], a[220:223]
  ds_read_b64_tr_b16 a[164:165], v201 offset:8192
  ds_read_b64_tr_b16 a[166:167], v201 offset:9216
  v_add_f32 v214, v208, v209
  v_exp_f32 v212, v68
  v_add_f32 v214, v214, v210
  v_mfma_f32_16x16x32_bf16 a[212:215], a[172:175], v[144:147], a[212:215]
  s_waitcnt lgkmcnt(8)
  v_mfma_f32_16x16x32_bf16 a[224:227], a[176:179], v[144:147], a[224:227]
  ds_read_b64_tr_b16 a[168:169], v202 offset:8192
  ds_read_b64_tr_b16 a[170:171], v202 offset:9216
  buffer_load_dwordx4 v243, s[8:11], s32 offen offset:3072 nt lds
  s_add_u32 s32, s32, 0x4000
  v_cvt_pk_bf16_f32 v129, v210, v211
  v_mfma_f32_16x16x32_bf16 a[232:235], a[176:179], v[148:151], a[232:235]
  v_mfma_f32_16x16x32_bf16 a[236:239], a[180:183], v[148:151], a[236:239]
  ds_read_b64_tr_b16 a[172:173], v203 offset:8192
  ds_read_b64_tr_b16 a[174:175], v203 offset:9216
  v_exp_f32 v213, v69
  v_add_f32 v214, v214, v211
  v_mfma_f32_16x16x32_bf16 a[228:231], a[180:183], v[144:147], a[228:231]
  s_waitcnt lgkmcnt(8)
  v_mfma_f32_16x16x32_bf16 a[240:243], a[184:187], v[144:147], a[240:243]
  ds_read_b64_tr_b16 a[176:177], v204 offset:8192
  ds_read_b64_tr_b16 a[178:179], v204 offset:9216
  v_exp_f32 v208, v70
  v_add_f32 v214, v214, v212
  v_cvt_pk_bf16_f32 v130, v212, v213
  v_mfma_f32_16x16x32_bf16 a[248:251], a[184:187], v[148:151], a[248:251]
  v_mfma_f32_16x16x32_bf16 a[252:255], a[188:191], v[148:151], a[252:255]
  ds_read_b64_tr_b16 a[180:181], v205 offset:8192
  ds_read_b64_tr_b16 a[182:183], v205 offset:9216
  v_exp_f32 v209, v71
  v_add_f32 v214, v214, v213
  v_exp_f32 v210, v72
  v_mfma_f32_16x16x32_bf16 a[244:247], a[188:191], v[144:147], a[244:247]
  s_waitcnt lgkmcnt(8)
  v_mfma_f32_16x16x32_bf16 a[192:195], a[160:163], v[152:155], a[192:195]
  ds_read_b64_tr_b16 a[184:185], v206 offset:8192
  ds_read_b64_tr_b16 a[186:187], v206 offset:9216
  v_add_f32 v214, v214, v208
  v_cvt_pk_bf16_f32 v131, v208, v209
  v_exp_f32 v211, v73
  v_mfma_f32_16x16x32_bf16 a[200:203], a[160:163], v[156:159], a[200:203]
  v_mfma_f32_16x16x32_bf16 a[204:207], a[164:167], v[156:159], a[204:207]
  ds_read_b64_tr_b16 a[188:189], v207 offset:8192
  ds_read_b64_tr_b16 a[190:191], v207 offset:9216
  v_add_f32 v214, v214, v209
  v_exp_f32 v212, v74
  v_mfma_f32_16x16x32_bf16 a[196:199], a[164:167], v[152:155], a[196:199]
  s_waitcnt lgkmcnt(8)
  v_mfma_f32_16x16x32_bf16 a[208:211], a[168:171], v[152:155], a[208:211]
  s_barrier
  ds_read_b128 a[160:163], v224 offset:49152
  v_cvt_pk_bf16_f32 v132, v210, v211
  v_exp_f32 v213, v75
  v_add_f32 v215, v210, v211
  v_mfma_f32_16x16x32_bf16 a[216:219], a[168:171], v[156:159], a[216:219]
  v_mfma_f32_16x16x32_bf16 a[220:223], a[172:175], v[156:159], a[220:223]
  ds_read_b128 a[164:167], v224 offset:53248
  s_add_u32 m0, s41, 65536
  s_nop 0
  buffer_load_dwordx4 v244, s[16:19], s34 offen offset:0 lds
  v_exp_f32 v208, v76
  v_mfma_f32_16x16x32_bf16 a[212:215], a[172:175], v[152:155], a[212:215]
  s_waitcnt lgkmcnt(6)
  v_mfma_f32_16x16x32_bf16 a[224:227], a[176:179], v[152:155], a[224:227]
  ds_read_b128 a[168:171], v225 offset:49152
  v_add_f32 v215, v215, v212
  v_cvt_pk_bf16_f32 v133, v212, v213
  v_exp_f32 v209, v77
  v_mfma_f32_16x16x32_bf16 a[232:235], a[176:179], v[156:159], a[232:235]
  v_mfma_f32_16x16x32_bf16 a[236:239], a[180:183], v[156:159], a[236:239]
  ds_read_b128 a[172:175], v225 offset:53248
  v_add_f32 v215, v215, v213
  v_exp_f32 v210, v78
  v_add_f32 v215, v215, v208
  v_cvt_pk_bf16_f32 v134, v208, v209
  v_mfma_f32_16x16x32_bf16 a[228:231], a[180:183], v[152:155], a[228:231]
  s_waitcnt lgkmcnt(4)
  v_mfma_f32_16x16x32_bf16 a[240:243], a[184:187], v[152:155], a[240:243]
  ds_read_b128 a[176:179], v226 offset:49152
  buffer_load_dwordx4 v245, s[16:19], s34 offen offset:1024 lds
  v_exp_f32 v211, v79
  v_mfma_f32_16x16x32_bf16 a[248:251], a[184:187], v[156:159], a[248:251]
  v_mfma_f32_16x16x32_bf16 a[252:255], a[188:191], v[156:159], a[252:255]
  ds_read_b128 a[180:183], v226 offset:53248
  v_add_f32 v215, v215, v209
  v_exp_f32 v212, v80
  v_add_f32 v215, v215, v210
  v_cvt_pk_bf16_f32 v135, v210, v211
  v_mfma_f32_16x16x32_bf16 a[244:247], a[188:191], v[152:155], a[244:247]
  s_waitcnt lgkmcnt(4)
  v_mfma_f32_16x16x32_bf16 v[96:99], a[160:163], v[160:163], v[192:195]
  ds_read_b128 a[184:187], v227 offset:49152
  v_exp_f32 v213, v81
  v_add_f32 v215, v215, v211
  v_exp_f32 v208, v82
  v_mfma_f32_16x16x32_bf16 v[104:107], a[160:163], v[164:167], v[196:199]
  v_mfma_f32_16x16x32_bf16 v[108:111], a[164:167], v[164:167], v[196:199]
  ds_read_b128 a[188:191], v227 offset:53248
  buffer_load_dwordx4 v246, s[16:19], s34 offen offset:2048 lds
  v_add_f32 v214, v214, v212
  v_mfma_f32_16x16x32_bf16 v[100:103], a[164:167], v[160:163], v[192:195]
  s_waitcnt lgkmcnt(4)
  v_mfma_f32_16x16x32_bf16 v[96:99], a[168:171], v[168:171], v[96:99]
  ds_read_b128 a[160:163], v224 offset:51200
  v_cvt_pk_bf16_f32 v136, v212, v213
  v_exp_f32 v209, v83
  v_add_f32 v214, v214, v213
  v_exp_f32 v210, v84
  v_mfma_f32_16x16x32_bf16 v[104:107], a[168:171], v[172:175], v[104:107]
  v_mfma_f32_16x16x32_bf16 v[108:111], a[172:175], v[172:175], v[108:111]
  ds_read_b128 a[164:167], v224 offset:55296
  v_add_f32 v214, v214, v208
  v_cvt_pk_bf16_f32 v137, v208, v209
  v_exp_f32 v211, v85
  v_mfma_f32_16x16x32_bf16 v[100:103], a[172:175], v[168:171], v[100:103]
  s_waitcnt lgkmcnt(4)
  v_mfma_f32_16x16x32_bf16 v[96:99], a[176:179], v[176:179], v[96:99]
  ds_read_b128 a[168:171], v225 offset:51200
  buffer_load_dwordx4 v247, s[16:19], s34 offen offset:3072 lds
  s_add_u32 s34, s34, 524288
  s_sub_u32 s38, s34, 5242880
  s_min_u32 s34, s34, s38
  v_add_f32 v214, v214, v209
  v_mfma_f32_16x16x32_bf16 v[104:107], a[176:179], v[180:183], v[104:107]
  v_mfma_f32_16x16x32_bf16 v[108:111], a[180:183], v[180:183], v[108:111]
  ds_read_b128 a[172:175], v225 offset:55296
  v_exp_f32 v212, v86
  v_add_f32 v214, v214, v210
  v_cvt_pk_bf16_f32 v138, v210, v211
  v_exp_f32 v213, v87
  v_mfma_f32_16x16x32_bf16 v[100:103], a[180:183], v[176:179], v[100:103]
  s_waitcnt lgkmcnt(4)
  v_mfma_f32_16x16x32_bf16 v[96:99], a[184:187], v[184:187], v[96:99]
  ds_read_b128 a[176:179], v226 offset:51200
  v_add_f32 v214, v214, v211
  v_exp_f32 v208, v88
  v_add_f32 v214, v214, v212
  v_cvt_pk_bf16_f32 v139, v212, v213
  v_mfma_f32_16x16x32_bf16 v[104:107], a[184:187], v[188:191], v[104:107]
  v_mfma_f32_16x16x32_bf16 v[108:111], a[188:191], v[188:191], v[108:111]
  ds_read_b128 a[180:183], v226 offset:55296
  v_exp_f32 v209, v89
  v_add_f32 v214, v214, v213
  v_exp_f32 v210, v90
  v_mfma_f32_16x16x32_bf16 v[100:103], a[188:191], v[184:187], v[100:103]
  s_waitcnt lgkmcnt(4)
  v_mfma_f32_16x16x32_bf16 v[112:115], a[160:163], v[160:163], v[192:195]
  ds_read_b128 a[184:187], v227 offset:51200
  v_add_f32 v215, v215, v208
  v_cvt_pk_bf16_f32 v140, v208, v209
  v_exp_f32 v211, v91
  v_add_f32 v215, v215, v209
  v_mfma_f32_16x16x32_bf16 v[120:123], a[160:163], v[164:167], v[196:199]
  v_mfma_f32_16x16x32_bf16 v[124:127], a[164:167], v[164:167], v[196:199]
  ds_read_b128 a[188:191], v227 offset:55296
  v_exp_f32 v212, v92
  v_add_f32 v215, v215, v210
  v_cvt_pk_bf16_f32 v141, v210, v211
  v_exp_f32 v213, v93
  v_mfma_f32_16x16x32_bf16 v[116:119], a[164:167], v[160:163], v[192:195]
  s_waitcnt lgkmcnt(4)
  v_mfma_f32_16x16x32_bf16 v[112:115], a[168:171], v[168:171], v[112:115]
  s_waitcnt vmcnt(28)
  s_barrier
  ds_read_b64_tr_b16 a[160:161], v200 offset:16384
  ds_read_b64_tr_b16 a[162:163], v200 offset:17408
  v_add_f32 v215, v215, v211
  v_mfma_f32_16x16x32_bf16 v[120:123], a[168:171], v[172:175], v[120:123]
  v_mfma_f32_16x16x32_bf16 v[124:127], a[172:175], v[172:175], v[124:127]
  ds_read_b64_tr_b16 a[164:165], v201 offset:16384
  ds_read_b64_tr_b16 a[166:167], v201 offset:17408
  s_add_u32 m0, s41, 131072
  s_nop 0
  buffer_load_dwordx4 v244, s[16:19], s34 offen offset:0 lds
  v_exp_f32 v208, v94
  v_mfma_f32_16x16x32_bf16 v[116:119], a[172:175], v[168:171], v[116:119]
  s_waitcnt lgkmcnt(6)
  v_mfma_f32_16x16x32_bf16 v[112:115], a[176:179], v[176:179], v[112:115]
  ds_read_b64_tr_b16 a[168:169], v202 offset:16384
  ds_read_b64_tr_b16 a[170:171], v202 offset:17408
  v_add_f32 v215, v215, v212
  v_cvt_pk_bf16_f32 v142, v212, v213
  v_exp_f32 v209, v95
  v_add_f32 v215, v215, v213
  v_mfma_f32_16x16x32_bf16 v[120:123], a[176:179], v[180:183], v[120:123]
  v_mfma_f32_16x16x32_bf16 v[124:127], a[180:183], v[180:183], v[124:127]
  ds_read_b64_tr_b16 a[172:173], v203 offset:16384
  ds_read_b64_tr_b16 a[174:175], v203 offset:17408
  v_add_f32 v215, v215, v208
  v_cvt_pk_bf16_f32 v143, v208, v209
  v_add_f32 v215, v215, v209
  v_add_f32 v210, v214, v215
  v_mfma_f32_16x16x32_bf16 v[116:119], a[180:183], v[176:179], v[116:119]
  s_waitcnt lgkmcnt(8)
  v_mfma_f32_16x16x32_bf16 v[112:115], a[184:187], v[184:187], v[112:115]
  ds_read_b64_tr_b16 a[176:177], v204 offset:16384
  ds_read_b64_tr_b16 a[178:179], v204 offset:17408
  buffer_load_dwordx4 v245, s[16:19], s34 offen offset:1024 lds
  v_cmp_lt_f32 vcc, s35, v210
  v_mfma_f32_16x16x32_bf16 v[120:123], a[184:187], v[188:191], v[120:123]
  v_mfma_f32_16x16x32_bf16 v[124:127], a[188:191], v[188:191], v[124:127]
  ds_read_b64_tr_b16 a[180:181], v205 offset:16384
  ds_read_b64_tr_b16 a[182:183], v205 offset:17408
  v_mfma_f32_16x16x32_bf16 v[116:119], a[188:191], v[184:187], v[116:119]
  s_cbranch_vccnz SITE58
BACK58:
  s_waitcnt lgkmcnt(8)
  v_mfma_f32_16x16x32_bf16 v[0:3], a[160:163], a[128:131], v[0:3]
  ds_read_b64_tr_b16 a[184:185], v206 offset:16384
  ds_read_b64_tr_b16 a[186:187], v206 offset:17408
  v_mfma_f32_16x16x32_bf16 v[8:11], a[160:163], a[132:135], v[8:11]
  v_mfma_f32_16x16x32_bf16 v[12:15], a[164:167], a[132:135], v[12:15]
  ds_read_b64_tr_b16 a[188:189], v207 offset:16384
  ds_read_b64_tr_b16 a[190:191], v207 offset:17408
  buffer_load_dwordx4 v246, s[16:19], s34 offen offset:2048 lds
  v_mfma_f32_16x16x32_bf16 v[4:7], a[164:167], a[128:131], v[4:7]
  s_waitcnt lgkmcnt(8)
  v_mfma_f32_16x16x32_bf16 v[16:19], a[168:171], a[128:131], v[16:19]
  ds_read_b64_tr_b16 a[160:161], v200 offset:24576
  ds_read_b64_tr_b16 a[162:163], v200 offset:25600
  v_add_f32 v249, v249, v214
  v_add_f32 v254, v254, v215
  v_exp_f32 v208, v96
  v_exp_f32 v209, v97
  v_mfma_f32_16x16x32_bf16 v[24:27], a[168:171], a[132:135], v[24:27]
  v_mfma_f32_16x16x32_bf16 v[28:31], a[172:175], a[132:135], v[28:31]
  ds_read_b64_tr_b16 a[164:165], v201 offset:24576
  ds_read_b64_tr_b16 a[166:167], v201 offset:25600
  v_exp_f32 v210, v98
  v_cvt_pk_bf16_f32 v144, v208, v209
  v_exp_f32 v211, v99
  v_mfma_f32_16x16x32_bf16 v[20:23], a[172:175], a[128:131], v[20:23]
  s_waitcnt lgkmcnt(8)
  v_mfma_f32_16x16x32_bf16 v[32:35], a[176:179], a[128:131], v[32:35]
  ds_read_b64_tr_b16 a[168:169], v202 offset:24576
  ds_read_b64_tr_b16 a[170:171], v202 offset:25600
  buffer_load_dwordx4 v247, s[16:19], s34 offen offset:3072 lds
  s_add_u32 s34, s34, 524288
  s_sub_u32 s38, s34, 5242880
  s_min_u32 s34, s34, s38
  v_add_f32 v214, v208, v209
  v_mfma_f32_16x16x32_bf16 v[40:43], a[176:179], a[132:135], v[40:43]
  v_mfma_f32_16x16x32_bf16 v[44:47], a[180:183], a[132:135], v[44:47]
  ds_read_b64_tr_b16 a[172:173], v203 offset:24576
  ds_read_b64_tr_b16 a[174:175], v203 offset:25600
  v_exp_f32 v212, v100
  v_add_f32 v214, v214, v210
  v_cvt_pk_bf16_f32 v145, v210, v211
  v_mfma_f32_16x16x32_bf16 v[36:39], a[180:183], a[128:131], v[36:39]
  s_waitcnt lgkmcnt(8)
  v_mfma_f32_16x16x32_bf16 v[48:51], a[184:187], a[128:131], v[48:51]
  ds_read_b64_tr_b16 a[176:177], v204 offset:24576
  ds_read_b64_tr_b16 a[178:179], v204 offset:25600
  v_exp_f32 v213, v101
  v_add_f32 v214, v214, v211
  v_exp_f32 v208, v102
  v_mfma_f32_16x16x32_bf16 v[56:59], a[184:187], a[132:135], v[56:59]
  v_mfma_f32_16x16x32_bf16 v[60:63], a[188:191], a[132:135], v[60:63]
  ds_read_b64_tr_b16 a[180:181], v205 offset:24576
  ds_read_b64_tr_b16 a[182:183], v205 offset:25600
  v_add_f32 v214, v214, v212
  v_cvt_pk_bf16_f32 v146, v212, v213
  v_exp_f32 v209, v103
  v_mfma_f32_16x16x32_bf16 v[52:55], a[188:191], a[128:131], v[52:55]
  s_waitcnt lgkmcnt(8)
  v_mfma_f32_16x16x32_bf16 v[0:3], a[160:163], a[136:139], v[0:3]
  ds_read_b64_tr_b16 a[184:185], v206 offset:24576
  ds_read_b64_tr_b16 a[186:187], v206 offset:25600
  v_add_f32 v214, v214, v213
  v_exp_f32 v210, v104
  v_add_f32 v214, v214, v208
  v_mfma_f32_16x16x32_bf16 v[8:11], a[160:163], a[140:143], v[8:11]
  v_mfma_f32_16x16x32_bf16 v[12:15], a[164:167], a[140:143], v[12:15]
  ds_read_b64_tr_b16 a[188:189], v207 offset:24576
  ds_read_b64_tr_b16 a[190:191], v207 offset:25600
  v_cvt_pk_bf16_f32 v147, v208, v209
  v_exp_f32 v211, v105
  v_add_f32 v214, v214, v209
  v_mfma_f32_16x16x32_bf16 v[4:7], a[164:167], a[136:139], v[4:7]
  s_waitcnt lgkmcnt(8)
  v_mfma_f32_16x16x32_bf16 v[16:19], a[168:171], a[136:139], v[16:19]
  s_waitcnt vmcnt(24)
  s_barrier
  ds_read_b64_tr_b16 a[160:161], v232 offset:16384
  ds_read_b64_tr_b16 a[162:163], v232 offset:17408
  v_exp_f32 v212, v106
  v_cvt_pk_bf16_f32 v148, v210, v211
  v_mfma_f32_16x16x32_bf16 v[24:27], a[168:171], a[140:143], v[24:27]
  v_mfma_f32_16x16x32_bf16 v[28:31], a[172:175], a[140:143], v[28:31]
  ds_read_b64_tr_b16 a[164:165], v233 offset:16384
  ds_read_b64_tr_b16 a[166:167], v233 offset:17408
  s_add_u32 m0, s41, 49152
  s_nop 0
  buffer_load_dwordx4 v240, s[8:11], s32 offen offset:0 nt lds
  v_exp_f32 v213, v107
  v_mfma_f32_16x16x32_bf16 v[20:23], a[172:175], a[136:139], v[20:23]
  s_waitcnt lgkmcnt(8)
  v_mfma_f32_16x16x32_bf16 v[32:35], a[176:179], a[136:139], v[32:35]
  ds_read_b64_tr_b16 a[168:169], v232 offset:24576
  ds_read_b64_tr_b16 a[170:171], v232 offset:25600
  v_add_f32 v215, v210, v211
  v_exp_f32 v208, v108
  v_add_f32 v215, v215, v212
  v_mfma_f32_16x16x32_bf16 v[40:43], a[176:179], a[140:143], v[40:43]
  v_mfma_f32_16x16x32_bf16 v[44:47], a[180:183], a[140:143], v[44:47]
  ds_read_b64_tr_b16 a[172:173], v233 offset:24576
  ds_read_b64_tr_b16 a[174:175], v233 offset:25600
  v_cvt_pk_bf16_f32 v149, v212, v213
  v_exp_f32 v209, v109
  v_add_f32 v215, v215, v213
  v_mfma_f32_16x16x32_bf16 v[36:39], a[180:183], a[136:139], v[36:39]
  s_waitcnt lgkmcnt(8)
  v_mfma_f32_16x16x32_bf16 v[48:51], a[184:187], a[136:139], v[48:51]
  ds_read_b64_tr_b16 a[176:177], v234 offset:16384
  ds_read_b64_tr_b16 a[178:179], v234 offset:17408
  buffer_load_dwordx4 v241, s[8:11], s32 offen offset:1024 nt lds
  v_exp_f32 v210, v110
  v_mfma_f32_16x16x32_bf16 v[56:59], a[184:187], a[140:143], v[56:59]
  v_mfma_f32_16x16x32_bf16 v[60:63], a[188:191], a[140:143], v[60:63]
  ds_read_b64_tr_b16 a[180:181], v235 offset:16384
  ds_read_b64_tr_b16 a[182:183], v235 offset:17408
  v_add_f32 v215, v215, v208
  v_cvt_pk_bf16_f32 v150, v208, v209
  v_exp_f32 v211, v111
  v_mfma_f32_16x16x32_bf16 v[52:55], a[188:191], a[136:139], v[52:55]
  s_waitcnt lgkmcnt(8)
  v_mfma_f32_16x16x32_bf16 v[0:3], a[160:163], a[144:147], v[0:3]
  ds_read_b64_tr_b16 a[184:185], v234 offset:24576
  ds_read_b64_tr_b16 a[186:187], v234 offset:25600
  v_add_f32 v215, v215, v209
  v_exp_f32 v212, v112
  v_add_f32 v215, v215, v210
  v_cvt_pk_bf16_f32 v151, v210, v211
  v_mfma_f32_16x16x32_bf16 v[8:11], a[160:163], a[148:151], v[8:11]
  v_mfma_f32_16x16x32_bf16 v[12:15], a[164:167], a[148:151], v[12:15]
  ds_read_b64_tr_b16 a[188:189], v235 offset:24576
  ds_read_b64_tr_b16 a[190:191], v235 offset:25600
  buffer_load_dwordx4 v242, s[8:11], s32 offen offset:2048 nt lds
  v_exp_f32 v213, v113
  v_mfma_f32_16x16x32_bf16 v[4:7], a[164:167], a[144:147], v[4:7]
  s_waitcnt lgkmcnt(8)
  v_mfma_f32_16x16x32_bf16 v[0:3], a[168:171], a[152:155], v[0:3]
  ds_read_b64_tr_b16 a[160:161], v236 offset:16384
  ds_read_b64_tr_b16 a[162:163], v236 offset:17408
  v_add_f32 v215, v215, v211
  v_exp_f32 v208, v114
  v_add_f32 v214, v214, v212
  v_mfma_f32_16x16x32_bf16 v[8:11], a[168:171], a[156:159], v[8:11]
  v_mfma_f32_16x16x32_bf16 v[12:15], a[172:175], a[156:159], v[12:15]
  ds_read_b64_tr_b16 a[164:165], v237 offset:16384
  ds_read_b64_tr_b16 a[166:167], v237 offset:17408
  v_cvt_pk_bf16_f32 v152, v212, v213
  v_exp_f32 v209, v115
  v_add_f32 v214, v214, v213
  v_mfma_f32_16x16x32_bf16 v[4:7], a[172:175], a[152:155], v[4:7]
  s_waitcnt lgkmcnt(8)
  v_mfma_f32_16x16x32_bf16 v[16:19], a[176:179], a[144:147], v[16:19]
  ds_read_b64_tr_b16 a[168:169], v236 offset:24576
  ds_read_b64_tr_b16 a[170:171], v236 offset:25600
  buffer_load_dwordx4 v243, s[8:11], s32 offen offset:3072 nt lds
  s_add_u32 s32, s32, 0x4000
  v_exp_f32 v210, v116
  v_mfma_f32_16x16x32_bf16 v[24:27], a[176:179], a[148:151], v[24:27]
  v_mfma_f32_16x16x32_bf16 v[28:31], a[180:183], a[148:151], v[28:31]
  ds_read_b64_tr_b16 a[172:173], v237 offset:24576
  ds_read_b64_tr_b16 a[174:175], v237 offset:25600
  v_add_f32 v214, v214, v208
  v_cvt_pk_bf16_f32 v153, v208, v209
  v_exp_f32 v211, v117
  v_mfma_f32_16x16x32_bf16 v[20:23], a[180:183], a[144:147], v[20:23]
  s_waitcnt lgkmcnt(8)
  v_mfma_f32_16x16x32_bf16 v[16:19], a[184:187], a[152:155], v[16:19]
  ds_read_b64_tr_b16 a[176:177], v238 offset:16384
  ds_read_b64_tr_b16 a[178:179], v238 offset:17408
  v_add_f32 v214, v214, v209
  v_exp_f32 v212, v118
  v_add_f32 v214, v214, v210
  v_cvt_pk_bf16_f32 v154, v210, v211
  v_mfma_f32_16x16x32_bf16 v[24:27], a[184:187], a[156:159], v[24:27]
  v_mfma_f32_16x16x32_bf16 v[28:31], a[188:191], a[156:159], v[28:31]
  ds_read_b64_tr_b16 a[180:181], v239 offset:16384
  ds_read_b64_tr_b16 a[182:183], v239 offset:17408
  v_exp_f32 v213, v119
  v_add_f32 v214, v214, v211
  v_mfma_f32_16x16x32_bf16 v[20:23], a[188:191], a[152:155], v[20:23]
  s_waitcnt lgkmcnt(8)
  v_mfma_f32_16x16x32_bf16 v[32:35], a[160:163], a[144:147], v[32:35]
  ds_read_b64_tr_b16 a[184:185], v238 offset:24576
  ds_read_b64_tr_b16 a[186:187], v238 offset:25600
  v_exp_f32 v208, v120
  v_add_f32 v214, v214, v212
  v_cvt_pk_bf16_f32 v155, v212, v213
  v_exp_f32 v209, v121
  v_mfma_f32_16x16x32_bf16 v[40:43], a[160:163], a[148:151], v[40:43]
  v_mfma_f32_16x16x32_bf16 v[44:47], a[164:167], a[148:151], v[44:47]
  ds_read_b64_tr_b16 a[188:189], v239 offset:24576
  ds_read_b64_tr_b16 a[190:191], v239 offset:25600
  v_add_f32 v214, v214, v213
  v_exp_f32 v210, v122
  v_mfma_f32_16x16x32_bf16 v[36:39], a[164:167], a[144:147], v[36:39]
  s_waitcnt lgkmcnt(8)
  v_mfma_f32_16x16x32_bf16 v[32:35], a[168:171], a[152:155], v[32:35]
  s_waitcnt vmcnt(24)
  s_barrier
  ds_read_b64_tr_b16 a[160:161], v232 offset:32768
  ds_read_b64_tr_b16 a[162:163], v232 offset:33792
  v_add_f32 v215, v215, v208
  v_cvt_pk_bf16_f32 v156, v208, v209
  v_mfma_f32_16x16x32_bf16 v[40:43], a[168:171], a[156:159], v[40:43]
  v_mfma_f32_16x16x32_bf16 v[44:47], a[172:175], a[156:159], v[44:47]
  ds_read_b64_tr_b16 a[164:165], v233 offset:32768
  ds_read_b64_tr_b16 a[166:167], v233 offset:33792
  s_add_u32 m0, s41, 147456
  s_nop 0
  buffer_load_dwordx4 v244, s[16:19], s34 offen offset:0 lds
  v_exp_f32 v211, v123
  v_mfma_f32_16x16x32_bf16 v[36:39], a[172:175], a[152:155], v[36:39]
  s_waitcnt lgkmcnt(8)
  v_mfma_f32_16x16x32_bf16 v[48:51], a[176:179], a[144:147], v[48:51]
  ds_read_b64_tr_b16 a[168:169], v234 offset:32768
  ds_read_b64_tr_b16 a[170:171], v234 offset:33792
  v_add_f32 v215, v215, v209
  v_exp_f32 v212, v124
  v_add_f32 v215, v215, v210
  v_cvt_pk_bf16_f32 v157, v210, v211
  v_mfma_f32_16x16x32_bf16 v[56:59], a[176:179], a[148:151], v[56:59]
  v_mfma_f32_16x16x32_bf16 v[60:63], a[180:183], a[148:151], v[60:63]
  ds_read_b64_tr_b16 a[172:173], v235 offset:32768
  ds_read_b64_tr_b16 a[174:175], v235 offset:33792
  v_exp_f32 v213, v125
  v_add_f32 v215, v215, v211
  v_exp_f32 v208, v126
  v_mfma_f32_16x16x32_bf16 v[52:55], a[180:183], a[144:147], v[52:55]
  s_waitcnt lgkmcnt(8)
  v_mfma_f32_16x16x32_bf16 v[48:51], a[184:187], a[152:155], v[48:51]
  ds_read_b64_tr_b16 a[176:177], v236 offset:32768
  ds_read_b64_tr_b16 a[178:179], v236 offset:33792
  buffer_load_dwordx4 v245, s[16:19], s34 offen offset:1024 lds
  v_add_f32 v215, v215, v212
  v_mfma_f32_16x16x32_bf16 v[56:59], a[184:187], a[156:159], v[56:59]
  v_mfma_f32_16x16x32_bf16 v[60:63], a[188:191], a[156:159], v[60:63]
  ds_read_b64_tr_b16 a[180:181], v237 offset:32768
  ds_read_b64_tr_b16 a[182:183], v237 offset:33792
  v_cvt_pk_bf16_f32 v158, v212, v213
  v_exp_f32 v209, v127
  v_add_f32 v215, v215, v213
  v_mfma_f32_16x16x32_bf16 v[52:55], a[188:191], a[152:155], v[52:55]
  s_waitcnt lgkmcnt(8)
  v_mfma_f32_16x16x32_bf16 a[192:195], a[160:163], v[128:131], a[192:195]
  ds_read_b64_tr_b16 a[184:185], v238 offset:32768
  ds_read_b64_tr_b16 a[186:187], v238 offset:33792
  v_add_f32 v215, v215, v208
  v_cvt_pk_bf16_f32 v159, v208, v209
  v_add_f32 v215, v215, v209
  v_add_f32 v210, v214, v215
  v_mfma_f32_16x16x32_bf16 a[200:203], a[160:163], v[132:135], a[200:203]
  v_mfma_f32_16x16x32_bf16 a[204:207], a[164:167], v[132:135], a[204:207]
  ds_read_b64_tr_b16 a[188:189], v239 offset:32768
  ds_read_b64_tr_b16 a[190:191], v239 offset:33792
  buffer_load_dwordx4 v246, s[16:19], s34 offen offset:2048 lds
  v_cmp_lt_f32 vcc, s35, v210
  v_mul_f32 v0, s42, v0
  v_mfma_f32_16x16x32_bf16 a[196:199], a[164:167], v[128:131], a[196:199]
  s_waitcnt lgkmcnt(8)
  v_mfma_f32_16x16x32_bf16 a[208:211], a[168:171], v[128:131], a[208:211]
  ds_read_b64_tr_b16 a[160:161], v232 offset:40960
  ds_read_b64_tr_b16 a[162:163], v232 offset:41984
  v_mul_f32 v1, s42, v1
  v_mul_f32 v2, s42, v2
  v_mul_f32 v3, s42, v3
  v_mul_f32 v4, s42, v4
  v_mul_f32 v5, s42, v5
  v_mfma_f32_16x16x32_bf16 a[216:219], a[168:171], v[132:135], a[216:219]
  v_mfma_f32_16x16x32_bf16 a[220:223], a[172:175], v[132:135], a[220:223]
  ds_read_b64_tr_b16 a[164:165], v233 offset:40960
  ds_read_b64_tr_b16 a[166:167], v233 offset:41984
  v_mul_f32 v6, s42, v6
  v_mul_f32 v7, s42, v7
  v_mul_f32 v8, s42, v8
  v_mul_f32 v9, s42, v9
  v_mfma_f32_16x16x32_bf16 a[212:215], a[172:175], v[128:131], a[212:215]
  s_waitcnt lgkmcnt(8)
  v_mfma_f32_16x16x32_bf16 a[224:227], a[176:179], v[128:131], a[224:227]
  ds_read_b64_tr_b16 a[168:169], v234 offset:40960
  ds_read_b64_tr_b16 a[170:171], v234 offset:41984
  buffer_load_dwordx4 v247, s[16:19], s34 offen offset:3072 lds
  s_add_u32 s34, s34, 524288
  s_sub_u32 s38, s34, 5242880
  s_min_u32 s34, s34, s38
  v_mul_f32 v10, s42, v10
  v_mfma_f32_16x16x32_bf16 a[232:235], a[176:179], v[132:135], a[232:235]
  v_mul_f32 v11, s42, v11
  v_mfma_f32_16x16x32_bf16 a[236:239], a[180:183], v[132:135], a[236:239]
  ds_read_b64_tr_b16 a[172:173], v235 offset:40960
  ds_read_b64_tr_b16 a[174:175], v235 offset:41984
  v_mul_f32 v12, s42, v12
  v_mul_f32 v13, s42, v13
  v_mul_f32 v14, s42, v14
  v_mul_f32 v15, s42, v15
  v_mfma_f32_16x16x32_bf16 a[228:231], a[180:183], v[128:131], a[228:231]
  s_waitcnt lgkmcnt(8)
  v_mfma_f32_16x16x32_bf16 a[240:243], a[184:187], v[128:131], a[240:243]
  ds_read_b64_tr_b16 a[176:177], v236 offset:40960
  ds_read_b64_tr_b16 a[178:179], v236 offset:41984
  v_cvt_pk_bf16_f32 v160, v0, v1
  v_cvt_pk_bf16_f32 v161, v2, v3
  v_cvt_pk_bf16_f32 v162, v4, v5
  v_cvt_pk_bf16_f32 v163, v6, v7
  v_mfma_f32_16x16x32_bf16 a[248:251], a[184:187], v[132:135], a[248:251]
  v_mfma_f32_16x16x32_bf16 a[252:255], a[188:191], v[132:135], a[252:255]
  ds_read_b64_tr_b16 a[180:181], v237 offset:40960
  ds_read_b64_tr_b16 a[182:183], v237 offset:41984
  v_cvt_pk_bf16_f32 v164, v8, v9
  v_cvt_pk_bf16_f32 v165, v10, v11
  v_cvt_pk_bf16_f32 v166, v12, v13
  v_cvt_pk_bf16_f32 v167, v14, v15
  v_permlane16_swap_b32 v160, v162
  v_mfma_f32_16x16x32_bf16 a[244:247], a[188:191], v[128:131], a[244:247]
  s_waitcnt lgkmcnt(8)
  v_mfma_f32_16x16x32_bf16 a[192:195], a[160:163], v[136:139], a[192:195]
  ds_read_b64_tr_b16 a[184:185], v238 offset:40960
  ds_read_b64_tr_b16 a[186:187], v238 offset:41984
  v_permlane16_swap_b32 v161, v163
  v_permlane16_swap_b32 v164, v166
  v_permlane16_swap_b32 v165, v167
  v_mul_f32 v16, s42, v16
  v_mfma_f32_16x16x32_bf16 a[200:203], a[160:163], v[140:143], a[200:203]
  v_mfma_f32_16x16x32_bf16 a[204:207], a[164:167], v[140:143], a[204:207]
  ds_read_b64_tr_b16 a[188:189], v239 offset:40960
  ds_read_b64_tr_b16 a[190:191], v239 offset:41984
  v_mul_f32 v17, s42, v17
  v_mul_f32 v18, s42, v18
  v_mul_f32 v19, s42, v19
  v_mul_f32 v20, s42, v20
  v_mfma_f32_16x16x32_bf16 a[196:199], a[164:167], v[136:139], a[196:199]
  s_waitcnt lgkmcnt(8)
  v_mfma_f32_16x16x32_bf16 a[208:211], a[168:171], v[136:139], a[208:211]
  s_waitcnt vmcnt(20)
  s_barrier
  ds_read_b64_tr_b16 a[160:161], v232 offset:49152
  ds_read_b64_tr_b16 a[162:163], v232 offset:50176
  v_mul_f32 v21, s42, v21
  v_mul_f32 v22, s42, v22
  v_mfma_f32_16x16x32_bf16 a[216:219], a[168:171], v[140:143], a[216:219]
  v_mfma_f32_16x16x32_bf16 a[220:223], a[172:175], v[140:143], a[220:223]
  ds_read_b64_tr_b16 a[164:165], v233 offset:49152
  ds_read_b64_tr_b16 a[166:167], v233 offset:50176
  s_add_u32 m0, s41, 81920
  s_nop 0
  buffer_load_dwordx4 v244, s[16:19], s34 offen offset:0 lds
  v_mul_f32 v23, s42, v23
  v_mul_f32 v24, s42, v24
  v_mfma_f32_16x16x32_bf16 a[212:215], a[172:175], v[136:139], a[212:215]
  s_waitcnt lgkmcnt(8)
  v_mfma_f32_16x16x32_bf16 a[224:227], a[176:179], v[136:139], a[224:227]
  ds_read_b64_tr_b16 a[168:169], v234 offset:49152
  ds_read_b64_tr_b16 a[170:171], v234 offset:50176
  v_mul_f32 v25, s42, v25
  v_mul_f32 v26, s42, v26
  v_mul_f32 v27, s42, v27
  v_mul_f32 v28, s42, v28
  v_mul_f32 v29, s42, v29
  v_mfma_f32_16x16x32_bf16 a[232:235], a[176:179], v[140:143], a[232:235]
  v_mfma_f32_16x16x32_bf16 a[236:239], a[180:183], v[140:143], a[236:239]
  ds_read_b64_tr_b16 a[172:173], v235 offset:49152
  ds_read_b64_tr_b16 a[174:175], v235 offset:50176
  v_mul_f32 v30, s42, v30
  v_mul_f32 v31, s42, v31
  v_cvt_pk_bf16_f32 v168, v16, v17
  v_cvt_pk_bf16_f32 v169, v18, v19
  v_mfma_f32_16x16x32_bf16 a[228:231], a[180:183], v[136:139], a[228:231]
  s_waitcnt lgkmcnt(8)
  v_mfma_f32_16x16x32_bf16 a[240:243], a[184:187], v[136:139], a[240:243]
  ds_read_b64_tr_b16 a[176:177], v236 offset:49152
  ds_read_b64_tr_b16 a[178:179], v236 offset:50176
  buffer_load_dwordx4 v245, s[16:19], s34 offen offset:1024 lds
  v_cvt_pk_bf16_f32 v170, v20, v21
  v_cvt_pk_bf16_f32 v171, v22, v23
  v_mfma_f32_16x16x32_bf16 a[248:251], a[184:187], v[140:143], a[248:251]
  v_mfma_f32_16x16x32_bf16 a[252:255], a[188:191], v[140:143], a[252:255]
  ds_read_b64_tr_b16 a[180:181], v237 offset:49152
  ds_read_b64_tr_b16 a[182:183], v237 offset:50176
  v_cvt_pk_bf16_f32 v172, v24, v25
  v_cvt_pk_bf16_f32 v173, v26, v27
  v_cvt_pk_bf16_f32 v174, v28, v29
  v_cvt_pk_bf16_f32 v175, v30, v31
  v_mfma_f32_16x16x32_bf16 a[244:247], a[188:191], v[136:139], a[244:247]
  s_cbranch_vccnz SITE61
BACK61:
  s_waitcnt lgkmcnt(8)
  v_mfma_f32_16x16x32_bf16 a[192:195], a[160:163], v[144:147], a[192:195]
  ds_read_b64_tr_b16 a[184:185], v238 offset:49152
  ds_read_b64_tr_b16 a[186:187], v238 offset:50176
  v_add_f32 v249, v249, v214
  v_add_f32 v254, v254, v215
  s_add_u32 s40, s39, 256
  s_sub_u32 s38, s40, 1280
  s_min_u32 s40, s40, s38
  s_add_u32 s38, s40, 20480
  buffer_load_dwordx4 v[96:99], v253, s[20:23], s40 offen offset:0
  buffer_load_dwordx4 v[100:103], v253, s[20:23], s38 offen offset:0
  buffer_load_dwordx4 v[104:107], v253, s[20:23], s40 offen offset:64
  buffer_load_dwordx4 v[108:111], v253, s[20:23], s38 offen offset:64
  v_mfma_f32_16x16x32_bf16 a[200:203], a[160:163], v[148:151], a[200:203]
  v_mfma_f32_16x16x32_bf16 a[204:207], a[164:167], v[148:151], a[204:207]
  ds_read_b64_tr_b16 a[188:189], v239 offset:49152
  ds_read_b64_tr_b16 a[190:191], v239 offset:50176
  buffer_load_dwordx4 v246, s[16:19], s34 offen offset:2048 lds
  v_mfma_f32_16x16x32_bf16 a[196:199], a[164:167], v[144:147], a[196:199]
  s_waitcnt lgkmcnt(8)
  v_mfma_f32_16x16x32_bf16 a[208:211], a[168:171], v[144:147], a[208:211]
  ds_read_b64_tr_b16 a[160:161], v232 offset:57344
  ds_read_b64_tr_b16 a[162:163], v232 offset:58368
  v_permlane16_swap_b32 v168, v170
  v_permlane16_swap_b32 v169, v171
  v_permlane16_swap_b32 v172, v174
  v_mfma_f32_16x16x32_bf16 a[216:219], a[168:171], v[148:151], a[216:219]
  v_mfma_f32_16x16x32_bf16 a[220:223], a[172:175], v[148:151], a[220:223]
  ds_read_b64_tr_b16 a[164:165], v233 offset:57344
  ds_read_b64_tr_b16 a[166:167], v233 offset:58368
  v_permlane16_swap_b32 v173, v175
  v_mul_f32 v32, s42, v32
  v_mul_f32 v33, s42, v33
  v_mul_f32 v34, s42, v34
  v_mul_f32 v35, s42, v35
  v_mfma_f32_16x16x32_bf16 a[212:215], a[172:175], v[144:147], a[212:215]
  s_waitcnt lgkmcnt(8)
  v_mfma_f32_16x16x32_bf16 a[224:227], a[176:179], v[144:147], a[224:227]
  ds_read_b64_tr_b16 a[168:169], v234 offset:57344
  ds_read_b64_tr_b16 a[170:171], v234 offset:58368
  buffer_load_dwordx4 v247, s[16:19], s34 offen offset:3072 lds
  s_add_u32 s34, s34, 524288
  s_sub_u32 s38, s34, 5242880
  s_min_u32 s34, s34, s38
  s_add_u32 s40, s39, 384
  s_sub_u32 s38, s40, 1280
  s_min_u32 s40, s40, s38
  s_add_u32 s38, s40, 20480
  buffer_load_dwordx4 v[112:115], v253, s[20:23], s40 offen offset:0
  buffer_load_dwordx4 v[116:119], v253, s[20:23], s38 offen offset:0
  buffer_load_dwordx4 v[120:123], v253, s[20:23], s40 offen offset:64
  buffer_load_dwordx4 v[124:127], v253, s[20:23], s38 offen offset:64
  v_mfma_f32_16x16x32_bf16 a[232:235], a[176:179], v[148:151], a[232:235]
  v_mfma_f32_16x16x32_bf16 a[236:239], a[180:183], v[148:151], a[236:239]
  ds_read_b64_tr_b16 a[172:173], v235 offset:57344
  ds_read_b64_tr_b16 a[174:175], v235 offset:58368
  v_mul_f32 v36, s42, v36
  v_mul_f32 v37, s42, v37
  v_mfma_f32_16x16x32_bf16 a[228:231], a[180:183], v[144:147], a[228:231]
  s_waitcnt lgkmcnt(8)
  v_mfma_f32_16x16x32_bf16 a[240:243], a[184:187], v[144:147], a[240:243]
  ds_read_b64_tr_b16 a[176:177], v236 offset:57344
  ds_read_b64_tr_b16 a[178:179], v236 offset:58368
  v_mul_f32 v38, s42, v38
  v_mul_f32 v39, s42, v39
  v_mul_f32 v40, s42, v40
  v_mul_f32 v41, s42, v41
  v_mul_f32 v42, s42, v42
  v_mfma_f32_16x16x32_bf16 a[248:251], a[184:187], v[148:151], a[248:251]
  v_mfma_f32_16x16x32_bf16 a[252:255], a[188:191], v[148:151], a[252:255]
  ds_read_b64_tr_b16 a[180:181], v237 offset:57344
  ds_read_b64_tr_b16 a[182:183], v237 offset:58368
  v_mul_f32 v43, s42, v43
  v_mul_f32 v44, s42, v44
  v_mul_f32 v45, s42, v45
  v_mul_f32 v46, s42, v46
  v_mul_f32 v47, s42, v47
  v_mfma_f32_16x16x32_bf16 a[244:247], a[188:191], v[144:147], a[244:247]
  s_waitcnt lgkmcnt(8)
  v_mfma_f32_16x16x32_bf16 a[192:195], a[160:163], v[152:155], a[192:195]
  ds_read_b64_tr_b16 a[184:185], v238 offset:57344
  ds_read_b64_tr_b16 a[186:187], v238 offset:58368
  v_cvt_pk_bf16_f32 v176, v32, v33
  v_cvt_pk_bf16_f32 v177, v34, v35
  v_cvt_pk_bf16_f32 v178, v36, v37
  v_cvt_pk_bf16_f32 v179, v38, v39
  v_mfma_f32_16x16x32_bf16 a[200:203], a[160:163], v[156:159], a[200:203]
  v_mfma_f32_16x16x32_bf16 a[204:207], a[164:167], v[156:159], a[204:207]
  ds_read_b64_tr_b16 a[188:189], v239 offset:57344
  ds_read_b64_tr_b16 a[190:191], v239 offset:58368
  v_cvt_pk_bf16_f32 v180, v40, v41
  v_cvt_pk_bf16_f32 v181, v42, v43
  v_cvt_pk_bf16_f32 v182, v44, v45
  v_cvt_pk_bf16_f32 v183, v46, v47
  v_permlane16_swap_b32 v176, v178
  v_mfma_f32_16x16x32_bf16 a[196:199], a[164:167], v[152:155], a[196:199]
  s_waitcnt lgkmcnt(8)
  v_mfma_f32_16x16x32_bf16 a[208:211], a[168:171], v[152:155], a[208:211]
  s_barrier
  ds_read_b128 a[160:163], v224 offset:0
  v_permlane16_swap_b32 v177, v179
  v_permlane16_swap_b32 v180, v182
  v_permlane16_swap_b32 v181, v183
  v_mul_f32 v48, s42, v48
  v_mul_f32 v49, s42, v49
  v_mfma_f32_16x16x32_bf16 a[216:219], a[168:171], v[156:159], a[216:219]
  v_mfma_f32_16x16x32_bf16 a[220:223], a[172:175], v[156:159], a[220:223]
  ds_read_b128 a[164:167], v224 offset:4096
  s_add_u32 m0, s41, 98304
  s_nop 0
  buffer_load_dwordx4 v248, s[12:15], s33 offen offset:0 nt lds
  v_mul_f32 v50, s42, v50
  v_mul_f32 v51, s42, v51
  v_mfma_f32_16x16x32_bf16 a[212:215], a[172:175], v[152:155], a[212:215]
  s_waitcnt lgkmcnt(6)
  v_mfma_f32_16x16x32_bf16 a[224:227], a[176:179], v[152:155], a[224:227]
  ds_read_b128 a[168:171], v225 offset:0
  v_mul_f32 v52, s42, v52
  v_mul_f32 v53, s42, v53
  v_mul_f32 v54, s42, v54
  v_mul_f32 v55, s42, v55
  v_mul_f32 v56, s42, v56
  v_mul_f32 v57, s42, v57
  v_mfma_f32_16x16x32_bf16 a[232:235], a[176:179], v[156:159], a[232:235]
  v_mfma_f32_16x16x32_bf16 a[236:239], a[180:183], v[156:159], a[236:239]
  ds_read_b128 a[172:175], v225 offset:4096
  v_mul_f32 v58, s42, v58
  v_mul_f32 v59, s42, v59
  v_mul_f32 v60, s42, v60
  v_mul_f32 v61, s42, v61
  v_mul_f32 v62, s42, v62
  v_mfma_f32_16x16x32_bf16 a[228:231], a[180:183], v[152:155], a[228:231]
  s_waitcnt lgkmcnt(4)
  v_mfma_f32_16x16x32_bf16 a[240:243], a[184:187], v[152:155], a[240:243]
  ds_read_b128 a[176:179], v226 offset:0
  buffer_load_dwordx4 v248, s[12:15], s33 offen offset:1024 nt lds
  v_mul_f32 v63, s42, v63
  v_cvt_pk_bf16_f32 v184, v48, v49
  v_mfma_f32_16x16x32_bf16 a[248:251], a[184:187], v[156:159], a[248:251]
  v_mfma_f32_16x16x32_bf16 a[252:255], a[188:191], v[156:159], a[252:255]
  ds_read_b128 a[180:183], v226 offset:4096
  v_cvt_pk_bf16_f32 v185, v50, v51
  v_cvt_pk_bf16_f32 v186, v52, v53
  v_cvt_pk_bf16_f32 v187, v54, v55
  v_cvt_pk_bf16_f32 v188, v56, v57
  v_cvt_pk_bf16_f32 v189, v58, v59
  v_cvt_pk_bf16_f32 v190, v60, v61
  v_mfma_f32_16x16x32_bf16 a[244:247], a[188:191], v[152:155], a[244:247]
  s_waitcnt lgkmcnt(4)
  v_mfma_f32_16x16x32_bf16 v[64:67], a[160:163], v[160:163], 0
  ds_read_b128 a[184:187], v227 offset:0
  v_cvt_pk_bf16_f32 v191, v62, v63
  v_permlane16_swap_b32 v184, v186
  v_permlane16_swap_b32 v185, v187
  v_permlane16_swap_b32 v188, v190
  v_permlane16_swap_b32 v189, v191
  v_mov_b32 v216, v249
  v_mfma_f32_16x16x32_bf16 v[72:75], a[160:163], v[164:167], 0
  v_mfma_f32_16x16x32_bf16 v[76:79], a[164:167], v[164:167], 0
  ds_read_b128 a[188:191], v227 offset:4096
  buffer_load_dwordx4 v248, s[12:15], s33 offen offset:2048 nt lds
  v_mov_b32 v217, v254
  s_nop 1
  v_permlane16_swap_b32 v216, v217
  v_mfma_f32_16x16x32_bf16 v[68:71], a[164:167], v[160:163], 0
  s_waitcnt lgkmcnt(4)
  v_mfma_f32_16x16x32_bf16 v[64:67], a[168:171], v[168:171], v[64:67]
  ds_read_b128 a[160:163], v224 offset:2048
  v_add_f32 v216, v216, v217
  v_mov_b32 v217, v216
  s_nop 1
  v_permlane32_swap_b32 v216, v217
  v_mfma_f32_16x16x32_bf16 v[72:75], a[168:171], v[172:175], v[72:75]
  v_mfma_f32_16x16x32_bf16 v[76:79], a[172:175], v[172:175], v[76:79]
  ds_read_b128 a[164:167], v224 offset:6144
  v_add_f32 v216, v216, v217
  v_rcp_f32 v250, v216
  s_nop 0
  v_mov_b32 v255, v250
  v_mfma_f32_16x16x32_bf16 v[68:71], a[172:175], v[168:171], v[68:71]
  s_waitcnt lgkmcnt(4)
  v_mfma_f32_16x16x32_bf16 v[64:67], a[176:179], v[176:179], v[64:67]
  ds_read_b128 a[168:171], v225 offset:2048
  buffer_load_dwordx4 v248, s[12:15], s33 offen offset:3072 nt lds
  s_add_u32 s33, s33, 0x4000
  v_permlane16_swap_b32 v250, v255
  v_mfma_f32_16x16x32_bf16 v[72:75], a[176:179], v[180:183], v[72:75]
  v_mfma_f32_16x16x32_bf16 v[76:79], a[180:183], v[180:183], v[76:79]
  ds_read_b128 a[172:175], v225 offset:6144
  v_mfma_f32_16x16x32_bf16 v[68:71], a[180:183], v[176:179], v[68:71]
  s_waitcnt lgkmcnt(4)
  v_mfma_f32_16x16x32_bf16 v[64:67], a[184:187], v[184:187], v[64:67]
  ds_read_b128 a[176:179], v226 offset:2048
  v_mfma_f32_16x16x32_bf16 v[72:75], a[184:187], v[188:191], v[72:75]
  v_mfma_f32_16x16x32_bf16 v[76:79], a[188:191], v[188:191], v[76:79]
  ds_read_b128 a[180:183], v226 offset:6144
  v_mfma_f32_16x16x32_bf16 v[68:71], a[188:191], v[184:187], v[68:71]
  s_waitcnt lgkmcnt(4)
  v_mfma_f32_16x16x32_bf16 v[80:83], a[160:163], v[160:163], 0
  ds_read_b128 a[184:187], v227 offset:2048
  v_mfma_f32_16x16x32_bf16 v[88:91], a[160:163], v[164:167], 0
  v_mfma_f32_16x16x32_bf16 v[92:95], a[164:167], v[164:167], 0
  ds_read_b128 a[188:191], v227 offset:6144
  v_mfma_f32_16x16x32_bf16 v[84:87], a[164:167], v[160:163], 0
  s_waitcnt lgkmcnt(4)
  v_mfma_f32_16x16x32_bf16 v[80:83], a[168:171], v[168:171], v[80:83]
  s_waitcnt vmcnt(28)
  s_barrier
  ds_read_b64_tr_b16 a[160:161], v232 offset:0
  ds_read_b64_tr_b16 a[162:163], v232 offset:1024
  v_mfma_f32_16x16x32_bf16 v[88:91], a[168:171], v[172:175], v[88:91]
  v_mfma_f32_16x16x32_bf16 v[92:95], a[172:175], v[172:175], v[92:95]
  ds_read_b64_tr_b16 a[164:165], v233 offset:0
  ds_read_b64_tr_b16 a[166:167], v233 offset:1024
  s_add_u32 m0, s41, 114688
  s_nop 0
  buffer_load_dwordx4 v244, s[16:19], s34 offen offset:0 lds
  v_mfma_f32_16x16x32_bf16 v[84:87], a[172:175], v[168:171], v[84:87]
  s_waitcnt lgkmcnt(6)
  v_mfma_f32_16x16x32_bf16 v[80:83], a[176:179], v[176:179], v[80:83]
  ds_read_b64_tr_b16 a[168:169], v234 offset:0
  ds_read_b64_tr_b16 a[170:171], v234 offset:1024
  v_mfma_f32_16x16x32_bf16 v[88:91], a[176:179], v[180:183], v[88:91]
  v_mfma_f32_16x16x32_bf16 v[92:95], a[180:183], v[180:183], v[92:95]
  ds_read_b64_tr_b16 a[172:173], v235 offset:0
  ds_read_b64_tr_b16 a[174:175], v235 offset:1024
  v_mfma_f32_16x16x32_bf16 v[84:87], a[180:183], v[176:179], v[84:87]
  s_waitcnt lgkmcnt(8)
  v_mfma_f32_16x16x32_bf16 v[80:83], a[184:187], v[184:187], v[80:83]
  ds_read_b64_tr_b16 a[176:177], v236 offset:0
  ds_read_b64_tr_b16 a[178:179], v236 offset:1024
  buffer_load_dwordx4 v245, s[16:19], s34 offen offset:1024 lds
  v_mfma_f32_16x16x32_bf16 v[88:91], a[184:187], v[188:191], v[88:91]
  v_mfma_f32_16x16x32_bf16 v[92:95], a[188:191], v[188:191], v[92:95]
  ds_read_b64_tr_b16 a[180:181], v237 offset:0
  ds_read_b64_tr_b16 a[182:183], v237 offset:1024
  v_mfma_f32_16x16x32_bf16 v[84:87], a[188:191], v[184:187], v[84:87]
  s_waitcnt lgkmcnt(8)
  v_mfma_f32_16x16x32_bf16 v[0:3], a[160:163], a[0:3], 0
  ds_read_b64_tr_b16 a[184:185], v238 offset:0
  ds_read_b64_tr_b16 a[186:187], v238 offset:1024
  v_mfma_f32_16x16x32_bf16 v[8:11], a[160:163], a[4:7], 0
  v_mfma_f32_16x16x32_bf16 v[12:15], a[164:167], a[4:7], 0
  ds_read_b64_tr_b16 a[188:189], v239 offset:0
  ds_read_b64_tr_b16 a[190:191], v239 offset:1024
  buffer_load_dwordx4 v246, s[16:19], s34 offen offset:2048 lds
  v_mfma_f32_16x16x32_bf16 v[4:7], a[164:167], a[0:3], 0
  s_waitcnt lgkmcnt(8)
  v_mfma_f32_16x16x32_bf16 v[16:19], a[168:171], a[0:3], 0
  ds_read_b64_tr_b16 a[160:161], v232 offset:8192
  ds_read_b64_tr_b16 a[162:163], v232 offset:9216
  v_max3_f32 v214, v64, v65, v66
  v_max3_f32 v215, v72, v73, v74
  v_max3_f32 v214, v214, v67, v68
  v_max3_f32 v215, v215, v75, v76
  v_max3_f32 v214, v214, v69, v70
  v_max3_f32 v215, v215, v77, v78
  v_max3_f32 v214, v214, v71, v80
  v_mfma_f32_16x16x32_bf16 v[24:27], a[168:171], a[4:7], 0
  v_mfma_f32_16x16x32_bf16 v[28:31], a[172:175], a[4:7], 0
  ds_read_b64_tr_b16 a[164:165], v233 offset:8192
  ds_read_b64_tr_b16 a[166:167], v233 offset:9216
  v_max3_f32 v215, v215, v79, v88
  v_max3_f32 v214, v214, v81, v82
  v_max3_f32 v215, v215, v89, v90
  v_max3_f32 v214, v214, v83, v84
  v_max3_f32 v215, v215, v91, v92
  v_max3_f32 v214, v214, v85, v86
  v_mfma_f32_16x16x32_bf16 v[20:23], a[172:175], a[0:3], 0
  s_waitcnt lgkmcnt(8)
  v_mfma_f32_16x16x32_bf16 v[32:35], a[176:179], a[0:3], 0
  ds_read_b64_tr_b16 a[168:169], v234 offset:8192
  ds_read_b64_tr_b16 a[170:171], v234 offset:9216
  buffer_load_dwordx4 v247, s[16:19], s34 offen offset:3072 lds
  s_add_u32 s34, s34, 524288
  s_sub_u32 s38, s34, 5242880
  s_min_u32 s34, s34, s38
  v_max3_f32 v215, v215, v93, v94
  v_mfma_f32_16x16x32_bf16 v[40:43], a[176:179], a[4:7], 0
  v_max_f32 v214, v214, v87
  v_max_f32 v215, v215, v95
  v_mfma_f32_16x16x32_bf16 v[44:47], a[180:183], a[4:7], 0
  ds_read_b64_tr_b16 a[172:173], v235 offset:8192
  ds_read_b64_tr_b16 a[174:175], v235 offset:9216
  v_permlane16_swap_b32 v214, v215
  v_max_f32 v214, v214, v215
  v_mov_b32 v215, v214
  s_nop 1
  v_permlane32_swap_b32 v214, v215
  v_mfma_f32_16x16x32_bf16 v[36:39], a[180:183], a[0:3], 0
  s_waitcnt lgkmcnt(8)
  v_mfma_f32_16x16x32_bf16 v[48:51], a[184:187], a[0:3], 0
  ds_read_b64_tr_b16 a[176:177], v236 offset:8192
  ds_read_b64_tr_b16 a[178:179], v236 offset:9216
  v_min_f32 v192, -v214, -v215
  v_mov_b32 v196, v192
  s_nop 1
  v_permlane16_swap_b32 v192, v196
  v_mfma_f32_16x16x32_bf16 v[56:59], a[184:187], a[4:7], 0
  v_mfma_f32_16x16x32_bf16 v[60:63], a[188:191], a[4:7], 0
  ds_read_b64_tr_b16 a[180:181], v237 offset:8192
  ds_read_b64_tr_b16 a[182:183], v237 offset:9216
  v_mov_b32 v193, v192
  v_mov_b32 v194, v192
  v_mov_b32 v195, v192
  v_mov_b32 v197, v196
  v_mov_b32 v198, v196
  v_mfma_f32_16x16x32_bf16 v[52:55], a[188:191], a[0:3], 0
  s_waitcnt lgkmcnt(8)
  v_mfma_f32_16x16x32_bf16 v[0:3], a[160:163], a[8:11], v[0:3]
  ds_read_b64_tr_b16 a[184:185], v238 offset:8192
  ds_read_b64_tr_b16 a[186:187], v238 offset:9216
  v_mov_b32 v199, v196
  v_add_f32 v208, v64, v192
  v_add_f32 v209, v65, v192
  v_exp_f32 v208, v208
  v_mfma_f32_16x16x32_bf16 v[8:11], a[160:163], a[12:15], v[8:11]
  v_mfma_f32_16x16x32_bf16 v[12:15], a[164:167], a[12:15], v[12:15]
  ds_read_b64_tr_b16 a[188:189], v239 offset:8192
  ds_read_b64_tr_b16 a[190:191], v239 offset:9216
  v_exp_f32 v209, v209
  v_add_f32 v210, v66, v192
  v_add_f32 v211, v67, v192
  v_exp_f32 v210, v210
  v_mfma_f32_16x16x32_bf16 v[4:7], a[164:167], a[8:11], v[4:7]
  s_waitcnt lgkmcnt(8)
  v_mfma_f32_16x16x32_bf16 v[16:19], a[168:171], a[8:11], v[16:19]
  s_waitcnt vmcnt(28)
  s_barrier
  ds_read_b64_tr_b16 a[160:161], v200 offset:0
  ds_read_b64_tr_b16 a[162:163], v200 offset:1024
  v_exp_f32 v211, v211
  v_add_f32 v214, v208, v209
  v_mfma_f32_16x16x32_bf16 v[24:27], a[168:171], a[12:15], v[24:27]
  v_mfma_f32_16x16x32_bf16 v[28:31], a[172:175], a[12:15], v[28:31]
  ds_read_b64_tr_b16 a[164:165], v201 offset:0
  ds_read_b64_tr_b16 a[166:167], v201 offset:1024
  s_add_u32 m0, s41, 0
  s_nop 0
  buffer_load_dwordx4 v240, s[8:11], s32 offen offset:0 nt lds
  v_cvt_pk_bf16_f32 v128, v208, v209
  v_add_f32 v212, v68, v192
  v_mfma_f32_16x16x32_bf16 v[20:23], a[172:175], a[8:11], v[20:23]
  v_add_f32 v213, v69, v192
  s_waitcnt lgkmcnt(8)
  v_mfma_f32_16x16x32_bf16 v[32:35], a[176:179], a[8:11], v[32:35]
  ds_read_b64_tr_b16 a[168:169], v202 offset:0
  ds_read_b64_tr_b16 a[170:171], v202 offset:1024
  v_exp_f32 v212, v212
  v_exp_f32 v213, v213
  v_add_f32 v214, v214, v210
  v_add_f32 v214, v214, v211
  v_mfma_f32_16x16x32_bf16 v[40:43], a[176:179], a[12:15], v[40:43]
  v_mfma_f32_16x16x32_bf16 v[44:47], a[180:183], a[12:15], v[44:47]
  ds_read_b64_tr_b16 a[172:173], v203 offset:0
  ds_read_b64_tr_b16 a[174:175], v203 offset:1024
  v_cvt_pk_bf16_f32 v129, v210, v211
  v_add_f32 v208, v70, v192
  v_add_f32 v209, v71, v192
  v_exp_f32 v208, v208
  v_mfma_f32_16x16x32_bf16 v[36:39], a[180:183], a[8:11], v[36:39]
  s_waitcnt lgkmcnt(8)
  v_mfma_f32_16x16x32_bf16 v[48:51], a[184:187], a[8:11], v[48:51]
  ds_read_b64_tr_b16 a[176:177], v204 offset:0
  ds_read_b64_tr_b16 a[178:179], v204 offset:1024
  buffer_load_dwordx4 v241, s[8:11], s32 offen offset:1024 nt lds
  v_exp_f32 v209, v209
  v_add_f32 v214, v214, v212
  v_mfma_f32_16x16x32_bf16 v[56:59], a[184:187], a[12:15], v[56:59]
  v_mfma_f32_16x16x32_bf16 v[60:63], a[188:191], a[12:15], v[60:63]
  ds_read_b64_tr_b16 a[180:181], v205 offset:0
  ds_read_b64_tr_b16 a[182:183], v205 offset:1024
  v_add_f32 v214, v214, v213
  v_cvt_pk_bf16_f32 v130, v212, v213
  v_add_f32 v210, v72, v196
  v_add_f32 v211, v73, v196
  v_exp_f32 v210, v210
  v_mfma_f32_16x16x32_bf16 v[52:55], a[188:191], a[8:11], v[52:55]
  s_waitcnt lgkmcnt(8)
  v_mfma_f32_16x16x32_bf16 v[0:3], a[160:163], a[16:19], v[0:3]
  ds_read_b64_tr_b16 a[184:185], v206 offset:0
  ds_read_b64_tr_b16 a[186:187], v206 offset:1024
  v_exp_f32 v211, v211
  v_add_f32 v214, v214, v208
  v_add_f32 v214, v214, v209
  v_cvt_pk_bf16_f32 v131, v208, v209
  v_mfma_f32_16x16x32_bf16 v[8:11], a[160:163], a[20:23], v[8:11]
  v_mfma_f32_16x16x32_bf16 v[12:15], a[164:167], a[20:23], v[12:15]
  ds_read_b64_tr_b16 a[188:189], v207 offset:0
  ds_read_b64_tr_b16 a[190:191], v207 offset:1024
  buffer_load_dwordx4 v242, s[8:11], s32 offen offset:2048 nt lds
  v_add_f32 v212, v74, v196
  v_add_f32 v213, v75, v196
  v_exp_f32 v212, v212
  v_mfma_f32_16x16x32_bf16 v[4:7], a[164:167], a[16:19], v[4:7]
  s_waitcnt lgkmcnt(8)
  v_mfma_f32_16x16x32_bf16 v[16:19], a[168:171], a[16:19], v[16:19]
  ds_read_b64_tr_b16 a[160:161], v200 offset:8192
  ds_read_b64_tr_b16 a[162:163], v200 offset:9216
  v_exp_f32 v213, v213
  v_add_f32 v215, v210, v211
  v_cvt_pk_bf16_f32 v132, v210, v211
  v_add_f32 v208, v76, v196
  v_mfma_f32_16x16x32_bf16 v[24:27], a[168:171], a[20:23], v[24:27]
  v_mfma_f32_16x16x32_bf16 v[28:31], a[172:175], a[20:23], v[28:31]
  ds_read_b64_tr_b16 a[164:165], v201 offset:8192
  ds_read_b64_tr_b16 a[166:167], v201 offset:9216
  v_accvgpr_read_b32 v220, a196
  v_accvgpr_read_b32 v221, a197
  v_accvgpr_read_b32 v222, a198
  v_accvgpr_read_b32 v223, a199
  v_accvgpr_read_b32 v216, a192
  v_mfma_f32_16x16x32_bf16 v[20:23], a[172:175], a[16:19], v[20:23]
  s_waitcnt lgkmcnt(8)
  v_mfma_f32_16x16x32_bf16 v[32:35], a[176:179], a[16:19], v[32:35]
  ds_read_b64_tr_b16 a[168:169], v202 offset:8192
  ds_read_b64_tr_b16 a[170:171], v202 offset:9216
  buffer_load_dwordx4 v243, s[8:11], s32 offen offset:3072 nt lds
  s_add_u32 s32, s32, 0x4000
  v_accvgpr_read_b32 v217, a193
  v_accvgpr_read_b32 v218, a194
  v_accvgpr_read_b32 v219, a195
  v_mfma_f32_16x16x32_bf16 v[40:43], a[176:179], a[20:23], v[40:43]
  v_mfma_f32_16x16x32_bf16 v[44:47], a[180:183], a[20:23], v[44:47]
  ds_read_b64_tr_b16 a[172:173], v203 offset:8192
  ds_read_b64_tr_b16 a[174:175], v203 offset:9216
  v_mul_f32 v220, v250, v220
  v_mul_f32 v221, v250, v221
  v_mul_f32 v222, v250, v222
  v_mul_f32 v223, v250, v223
  v_mul_f32 v216, v250, v216
  v_mul_f32 v217, v250, v217
  v_mfma_f32_16x16x32_bf16 v[36:39], a[180:183], a[16:19], v[36:39]
  s_waitcnt lgkmcnt(8)
  v_mfma_f32_16x16x32_bf16 v[48:51], a[184:187], a[16:19], v[48:51]
  ds_read_b64_tr_b16 a[176:177], v204 offset:8192
  ds_read_b64_tr_b16 a[178:179], v204 offset:9216
  v_mul_f32 v218, v250, v218
  v_mul_f32 v219, v250, v219
  v_cvt_pk_bf16_f32 v216, v216, v217
  v_cvt_pk_bf16_f32 v217, v218, v219
  v_cvt_pk_bf16_f32 v218, v220, v221
  v_mfma_f32_16x16x32_bf16 v[56:59], a[184:187], a[20:23], v[56:59]
  v_mfma_f32_16x16x32_bf16 v[60:63], a[188:191], a[20:23], v[60:63]
  ds_read_b64_tr_b16 a[180:181], v205 offset:8192
  ds_read_b64_tr_b16 a[182:183], v205 offset:9216
  v_cvt_pk_bf16_f32 v219, v222, v223
  v_permlane16_swap_b32 v216, v218
  s_nop 0
  v_permlane16_swap_b32 v217, v219
  v_accvgpr_write_b32 a0, v216
  v_accvgpr_write_b32 a1, v217
  v_mfma_f32_16x16x32_bf16 v[52:55], a[188:191], a[16:19], v[52:55]
  s_waitcnt lgkmcnt(8)
  v_mfma_f32_16x16x32_bf16 v[0:3], a[160:163], a[24:27], v[0:3]
  ds_read_b64_tr_b16 a[184:185], v206 offset:8192
  ds_read_b64_tr_b16 a[186:187], v206 offset:9216
  v_accvgpr_write_b32 a2, v218
  v_accvgpr_write_b32 a3, v219
  v_accvgpr_read_b32 v220, a204
  v_accvgpr_read_b32 v221, a205
  v_accvgpr_read_b32 v222, a206
  v_mfma_f32_16x16x32_bf16 v[8:11], a[160:163], a[28:31], v[8:11]
  v_mfma_f32_16x16x32_bf16 v[12:15], a[164:167], a[28:31], v[12:15]
  ds_read_b64_tr_b16 a[188:189], v207 offset:8192
  ds_read_b64_tr_b16 a[190:191], v207 offset:9216
  v_accvgpr_read_b32 v223, a207
  v_accvgpr_read_b32 v216, a200
  v_accvgpr_read_b32 v217, a201
  v_accvgpr_read_b32 v218, a202
  v_accvgpr_read_b32 v219, a203
  v_mul_f32 v220, v255, v220
  v_mfma_f32_16x16x32_bf16 v[4:7], a[164:167], a[24:27], v[4:7]
  s_waitcnt lgkmcnt(8)
  v_mfma_f32_16x16x32_bf16 v[16:19], a[168:171], a[24:27], v[16:19]
  s_waitcnt vmcnt(24)
  s_barrier
  ds_read_b64_tr_b16 a[160:161], v200 offset:16384
  ds_read_b64_tr_b16 a[162:163], v200 offset:17408
  v_mul_f32 v221, v255, v221
  v_mul_f32 v222, v255, v222
  v_mul_f32 v223, v255, v223
  v_mfma_f32_16x16x32_bf16 v[24:27], a[168:171], a[28:31], v[24:27]
  v_mfma_f32_16x16x32_bf16 v[28:31], a[172:175], a[28:31], v[28:31]
  ds_read_b64_tr_b16 a[164:165], v201 offset:16384
  ds_read_b64_tr_b16 a[166:167], v201 offset:17408
  s_add_u32 m0, s41, 65536
  s_nop 0
  buffer_load_dwordx4 v248, s[12:15], s33 offen offset:0 nt lds
  v_mul_f32 v216, v255, v216
  v_mul_f32 v217, v255, v217
  v_mfma_f32_16x16x32_bf16 v[20:23], a[172:175], a[24:27], v[20:23]
  v_mul_f32 v218, v255, v218
  s_waitcnt lgkmcnt(8)
  v_mfma_f32_16x16x32_bf16 v[32:35], a[176:179], a[24:27], v[32:35]
  ds_read_b64_tr_b16 a[168:169], v202 offset:16384
  ds_read_b64_tr_b16 a[170:171], v202 offset:17408
  v_mul_f32 v219, v255, v219
  v_cvt_pk_bf16_f32 v216, v216, v217
  v_cvt_pk_bf16_f32 v217, v218, v219
  v_cvt_pk_bf16_f32 v218, v220, v221
  v_cvt_pk_bf16_f32 v219, v222, v223
  s_nop 0
  v_permlane16_swap_b32 v216, v218
  v_mfma_f32_16x16x32_bf16 v[40:43], a[176:179], a[28:31], v[40:43]
  v_mfma_f32_16x16x32_bf16 v[44:47], a[180:183], a[28:31], v[44:47]
  ds_read_b64_tr_b16 a[172:173], v203 offset:16384
  ds_read_b64_tr_b16 a[174:175], v203 offset:17408
  v_permlane16_swap_b32 v217, v219
  v_accvgpr_write_b32 a4, v216
  v_accvgpr_write_b32 a5, v217
  v_accvgpr_write_b32 a6, v218
  v_mfma_f32_16x16x32_bf16 v[36:39], a[180:183], a[24:27], v[36:39]
  s_waitcnt lgkmcnt(8)
  v_mfma_f32_16x16x32_bf16 v[48:51], a[184:187], a[24:27], v[48:51]
  ds_read_b64_tr_b16 a[176:177], v204 offset:16384
  ds_read_b64_tr_b16 a[178:179], v204 offset:17408
  buffer_load_dwordx4 v248, s[12:15], s33 offen offset:1024 nt lds
  v_accvgpr_write_b32 a7, v219
  v_accvgpr_read_b32 v220, a212
  v_accvgpr_read_b32 v221, a213
  v_mfma_f32_16x16x32_bf16 v[56:59], a[184:187], a[28:31], v[56:59]
  v_mfma_f32_16x16x32_bf16 v[60:63], a[188:191], a[28:31], v[60:63]
  ds_read_b64_tr_b16 a[180:181], v205 offset:16384
  ds_read_b64_tr_b16 a[182:183], v205 offset:17408
  v_accvgpr_read_b32 v222, a214
  v_accvgpr_read_b32 v223, a215
  v_accvgpr_read_b32 v216, a208
  v_accvgpr_read_b32 v217, a209
  v_accvgpr_read_b32 v218, a210
  v_accvgpr_read_b32 v219, a211
  v_mfma_f32_16x16x32_bf16 v[52:55], a[188:191], a[24:27], v[52:55]
  s_waitcnt lgkmcnt(8)
  s_waitcnt vmcnt(23)
  v_mfma_f32_16x16x32_bf16 v[0:3], a[160:163], v[96:99], v[0:3]
  ds_read_b64_tr_b16 a[184:185], v206 offset:16384
  ds_read_b64_tr_b16 a[186:187], v206 offset:17408
  v_mul_f32 v220, v250, v220
  v_mul_f32 v221, v250, v221
  v_mul_f32 v222, v250, v222
  v_mul_f32 v223, v250, v223
  v_mul_f32 v216, v250, v216
  s_waitcnt vmcnt(22)
  v_mfma_f32_16x16x32_bf16 v[8:11], a[160:163], v[100:103], v[8:11]
  v_mfma_f32_16x16x32_bf16 v[12:15], a[164:167], v[100:103], v[12:15]
  ds_read_b64_tr_b16 a[188:189], v207 offset:16384
  ds_read_b64_tr_b16 a[190:191], v207 offset:17408
  buffer_load_dwordx4 v248, s[12:15], s33 offen offset:2048 nt lds
  v_mul_f32 v217, v250, v217
  v_mul_f32 v218, v250, v218
  v_mul_f32 v219, v250, v219
  v_mfma_f32_16x16x32_bf16 v[4:7], a[164:167], v[96:99], v[4:7]
  s_waitcnt lgkmcnt(8)
  v_mfma_f32_16x16x32_bf16 v[16:19], a[168:171], v[96:99], v[16:19]
  ds_read_b64_tr_b16 a[160:161], v200 offset:24576
  ds_read_b64_tr_b16 a[162:163], v200 offset:25600
  v_cvt_pk_bf16_f32 v216, v216, v217
  v_cvt_pk_bf16_f32 v217, v218, v219
  v_cvt_pk_bf16_f32 v218, v220, v221
  v_cvt_pk_bf16_f32 v219, v222, v223
  s_nop 0
  v_permlane16_swap_b32 v216, v218
  v_mfma_f32_16x16x32_bf16 v[24:27], a[168:171], v[100:103], v[24:27]
  v_mfma_f32_16x16x32_bf16 v[28:31], a[172:175], v[100:103], v[28:31]
  ds_read_b64_tr_b16 a[164:165], v201 offset:24576
  ds_read_b64_tr_b16 a[166:167], v201 offset:25600
  v_permlane16_swap_b32 v217, v219
  v_accvgpr_write_b32 a8, v216
  v_accvgpr_write_b32 a9, v217
  v_accvgpr_write_b32 a10, v218
  v_accvgpr_write_b32 a11, v219
  v_mfma_f32_16x16x32_bf16 v[20:23], a[172:175], v[96:99], v[20:23]
  s_waitcnt lgkmcnt(8)
  v_mfma_f32_16x16x32_bf16 v[32:35], a[176:179], v[96:99], v[32:35]
  ds_read_b64_tr_b16 a[168:169], v202 offset:24576
  ds_read_b64_tr_b16 a[170:171], v202 offset:25600
  buffer_load_dwordx4 v248, s[12:15], s33 offen offset:3072 nt lds
  s_add_u32 s33, s33, 0x4000
  v_accvgpr_read_b32 v220, a220
  v_accvgpr_read_b32 v221, a221
  v_accvgpr_read_b32 v222, a222
  v_mfma_f32_16x16x32_bf16 v[40:43], a[176:179], v[100:103], v[40:43]
  v_accvgpr_read_b32 v223, a223
  v_mfma_f32_16x16x32_bf16 v[44:47], a[180:183], v[100:103], v[44:47]
  ds_read_b64_tr_b16 a[172:173], v203 offset:24576
  ds_read_b64_tr_b16 a[174:175], v203 offset:25600
  v_accvgpr_read_b32 v216, a216
  v_accvgpr_read_b32 v217, a217
  v_accvgpr_read_b32 v218, a218
  v_accvgpr_read_b32 v219, a219
  v_mul_f32 v220, v255, v220
  v_mfma_f32_16x16x32_bf16 v[36:39], a[180:183], v[96:99], v[36:39]
  s_waitcnt lgkmcnt(8)
  v_mfma_f32_16x16x32_bf16 v[48:51], a[184:187], v[96:99], v[48:51]
  ds_read_b64_tr_b16 a[176:177], v204 offset:24576
  ds_read_b64_tr_b16 a[178:179], v204 offset:25600
  v_mul_f32 v221, v255, v221
  v_mul_f32 v222, v255, v222
  v_mul_f32 v223, v255, v223
  v_mul_f32 v216, v255, v216
  v_mul_f32 v217, v255, v217
  v_mul_f32 v218, v255, v218
  v_mfma_f32_16x16x32_bf16 v[56:59], a[184:187], v[100:103], v[56:59]
  v_mfma_f32_16x16x32_bf16 v[60:63], a[188:191], v[100:103], v[60:63]
  ds_read_b64_tr_b16 a[180:181], v205 offset:24576
  ds_read_b64_tr_b16 a[182:183], v205 offset:25600
  v_mul_f32 v219, v255, v219
  v_cvt_pk_bf16_f32 v216, v216, v217
  v_cvt_pk_bf16_f32 v217, v218, v219
  v_cvt_pk_bf16_f32 v218, v220, v221
  v_cvt_pk_bf16_f32 v219, v222, v223
  v_mfma_f32_16x16x32_bf16 v[52:55], a[188:191], v[96:99], v[52:55]
  s_waitcnt lgkmcnt(8)
  s_waitcnt vmcnt(23)
  v_mfma_f32_16x16x32_bf16 v[0:3], a[160:163], v[104:107], v[0:3]
  ds_read_b64_tr_b16 a[184:185], v206 offset:24576
  ds_read_b64_tr_b16 a[186:187], v206 offset:25600
  v_permlane16_swap_b32 v216, v218
  v_permlane16_swap_b32 v217, v219
  v_accvgpr_write_b32 a12, v216
  v_accvgpr_write_b32 a13, v217
  v_accvgpr_write_b32 a14, v218
  v_accvgpr_write_b32 a15, v219
  s_waitcnt vmcnt(22)
  v_mfma_f32_16x16x32_bf16 v[8:11], a[160:163], v[108:111], v[8:11]
  v_mfma_f32_16x16x32_bf16 v[12:15], a[164:167], v[108:111], v[12:15]
  ds_read_b64_tr_b16 a[188:189], v207 offset:24576
  ds_read_b64_tr_b16 a[190:191], v207 offset:25600
  v_accvgpr_read_b32 v220, a228
  v_accvgpr_read_b32 v221, a229
  v_accvgpr_read_b32 v222, a230
  v_accvgpr_read_b32 v223, a231
  v_accvgpr_read_b32 v216, a224
  v_mfma_f32_16x16x32_bf16 v[4:7], a[164:167], v[104:107], v[4:7]
  s_waitcnt lgkmcnt(8)
  v_mfma_f32_16x16x32_bf16 v[16:19], a[168:171], v[104:107], v[16:19]
  s_waitcnt vmcnt(20)
  s_barrier
  ds_read_b64_tr_b16 a[160:161], v232 offset:16384
  ds_read_b64_tr_b16 a[162:163], v232 offset:17408
  v_accvgpr_read_b32 v217, a225
  v_accvgpr_read_b32 v218, a226
  v_accvgpr_read_b32 v219, a227
  v_mul_f32 v220, v250, v220
  v_mfma_f32_16x16x32_bf16 v[24:27], a[168:171], v[108:111], v[24:27]
  v_mfma_f32_16x16x32_bf16 v[28:31], a[172:175], v[108:111], v[28:31]
  ds_read_b64_tr_b16 a[164:165], v233 offset:16384
  ds_read_b64_tr_b16 a[166:167], v233 offset:17408
  s_add_u32 m0, s41, 131072
  s_nop 0
  buffer_load_dwordx4 v244, s[16:19], s34 offen offset:0 lds
  v_mul_f32 v221, v250, v221
  v_mul_f32 v222, v250, v222
  v_mfma_f32_16x16x32_bf16 v[20:23], a[172:175], v[104:107], v[20:23]
  v_mul_f32 v223, v250, v223
  s_waitcnt lgkmcnt(8)
  v_mfma_f32_16x16x32_bf16 v[32:35], a[176:179], v[104:107], v[32:35]
  ds_read_b64_tr_b16 a[168:169], v234 offset:16384
  ds_read_b64_tr_b16 a[170:171], v234 offset:17408
  v_mul_f32 v216, v250, v216
  v_mul_f32 v217, v250, v217
  v_mul_f32 v218, v250, v218
  v_mul_f32 v219, v250, v219
  v_cvt_pk_bf16_f32 v216, v216, v217
  v_mfma_f32_16x16x32_bf16 v[40:43], a[176:179], v[108:111], v[40:43]
  v_mfma_f32_16x16x32_bf16 v[44:47], a[180:183], v[108:111], v[44:47]
  ds_read_b64_tr_b16 a[172:173], v235 offset:16384
  ds_read_b64_tr_b16 a[174:175], v235 offset:17408
  v_cvt_pk_bf16_f32 v217, v218, v219
  v_cvt_pk_bf16_f32 v218, v220, v221
  v_cvt_pk_bf16_f32 v219, v222, v223
  s_nop 0
  v_permlane16_swap_b32 v216, v218
  v_permlane16_swap_b32 v217, v219
  v_mfma_f32_16x16x32_bf16 v[36:39], a[180:183], v[104:107], v[36:39]
  s_waitcnt lgkmcnt(8)
  v_mfma_f32_16x16x32_bf16 v[48:51], a[184:187], v[104:107], v[48:51]
  ds_read_b64_tr_b16 a[176:177], v236 offset:16384
  ds_read_b64_tr_b16 a[178:179], v236 offset:17408
  buffer_load_dwordx4 v245, s[16:19], s34 offen offset:1024 lds
  v_accvgpr_write_b32 a16, v216
  v_accvgpr_write_b32 a17, v217
  v_accvgpr_write_b32 a18, v218
  v_mfma_f32_16x16x32_bf16 v[56:59], a[184:187], v[108:111], v[56:59]
  v_mfma_f32_16x16x32_bf16 v[60:63], a[188:191], v[108:111], v[60:63]
  ds_read_b64_tr_b16 a[180:181], v237 offset:16384
  ds_read_b64_tr_b16 a[182:183], v237 offset:17408
  v_accvgpr_write_b32 a19, v219
  v_accvgpr_read_b32 v220, a236
  v_accvgpr_read_b32 v221, a237
  v_accvgpr_read_b32 v222, a238
  v_accvgpr_read_b32 v223, a239
  v_accvgpr_read_b32 v216, a232
  v_mfma_f32_16x16x32_bf16 v[52:55], a[188:191], v[104:107], v[52:55]
  s_waitcnt lgkmcnt(8)
  s_waitcnt vmcnt(21)
  v_mfma_f32_16x16x32_bf16 v[0:3], a[160:163], v[112:115], v[0:3]
  ds_read_b64_tr_b16 a[184:185], v238 offset:16384
  ds_read_b64_tr_b16 a[186:187], v238 offset:17408
  v_accvgpr_read_b32 v217, a233
  v_accvgpr_read_b32 v218, a234
  v_accvgpr_read_b32 v219, a235
  v_mul_f32 v220, v255, v220
  v_mul_f32 v221, v255, v221
  s_waitcnt vmcnt(20)
  v_mfma_f32_16x16x32_bf16 v[8:11], a[160:163], v[116:119], v[8:11]
  v_mfma_f32_16x16x32_bf16 v[12:15], a[164:167], v[116:119], v[12:15]
  ds_read_b64_tr_b16 a[188:189], v239 offset:16384
  ds_read_b64_tr_b16 a[190:191], v239 offset:17408
  buffer_load_dwordx4 v246, s[16:19], s34 offen offset:2048 lds
  v_mul_f32 v222, v255, v222
  v_mul_f32 v223, v255, v223
  v_mul_f32 v216, v255, v216
  v_mfma_f32_16x16x32_bf16 v[4:7], a[164:167], v[112:115], v[4:7]
  s_waitcnt lgkmcnt(8)
  v_mfma_f32_16x16x32_bf16 v[16:19], a[168:171], v[112:115], v[16:19]
  ds_read_b64_tr_b16 a[160:161], v232 offset:24576
  ds_read_b64_tr_b16 a[162:163], v232 offset:25600
  v_mul_f32 v217, v255, v217
  v_mul_f32 v218, v255, v218
  v_mul_f32 v219, v255, v219
  v_cvt_pk_bf16_f32 v216, v216, v217
  v_cvt_pk_bf16_f32 v217, v218, v219
  v_cvt_pk_bf16_f32 v218, v220, v221
  v_mfma_f32_16x16x32_bf16 v[24:27], a[168:171], v[116:119], v[24:27]
  v_mfma_f32_16x16x32_bf16 v[28:31], a[172:175], v[116:119], v[28:31]
  ds_read_b64_tr_b16 a[164:165], v233 offset:24576
  ds_read_b64_tr_b16 a[166:167], v233 offset:25600
  v_cvt_pk_bf16_f32 v219, v222, v223
  v_permlane16_swap_b32 v216, v218
  s_nop 0
  v_permlane16_swap_b32 v217, v219
  v_accvgpr_write_b32 a20, v216
  v_mfma_f32_16x16x32_bf16 v[20:23], a[172:175], v[112:115], v[20:23]
  s_waitcnt lgkmcnt(8)
  v_mfma_f32_16x16x32_bf16 v[32:35], a[176:179], v[112:115], v[32:35]
  ds_read_b64_tr_b16 a[168:169], v234 offset:24576
  ds_read_b64_tr_b16 a[170:171], v234 offset:25600
  buffer_load_dwordx4 v247, s[16:19], s34 offen offset:3072 lds
  s_add_u32 s34, s34, 524288
  s_sub_u32 s38, s34, 5242880
  s_min_u32 s34, s34, s38
  v_accvgpr_write_b32 a21, v217
  v_mfma_f32_16x16x32_bf16 v[40:43], a[176:179], v[116:119], v[40:43]
  v_accvgpr_write_b32 a22, v218
  v_accvgpr_write_b32 a23, v219
  v_mfma_f32_16x16x32_bf16 v[44:47], a[180:183], v[116:119], v[44:47]
  ds_read_b64_tr_b16 a[172:173], v235 offset:24576
  ds_read_b64_tr_b16 a[174:175], v235 offset:25600
  v_accvgpr_read_b32 v220, a244
  v_accvgpr_read_b32 v221, a245
  v_accvgpr_read_b32 v222, a246
  v_accvgpr_read_b32 v223, a247
  v_accvgpr_read_b32 v216, a240
  v_accvgpr_read_b32 v217, a241
  v_mfma_f32_16x16x32_bf16 v[36:39], a[180:183], v[112:115], v[36:39]
  s_waitcnt lgkmcnt(8)
  v_mfma_f32_16x16x32_bf16 v[48:51], a[184:187], v[112:115], v[48:51]
  ds_read_b64_tr_b16 a[176:177], v236 offset:24576
  ds_read_b64_tr_b16 a[178:179], v236 offset:25600
  v_accvgpr_read_b32 v218, a242
  v_accvgpr_read_b32 v219, a243
  v_mul_f32 v220, v250, v220
  v_mul_f32 v221, v250, v221
  v_mul_f32 v222, v250, v222
  v_mul_f32 v223, v250, v223
  v_mfma_f32_16x16x32_bf16 v[56:59], a[184:187], v[116:119], v[56:59]
  v_mfma_f32_16x16x32_bf16 v[60:63], a[188:191], v[116:119], v[60:63]
  ds_read_b64_tr_b16 a[180:181], v237 offset:24576
  ds_read_b64_tr_b16 a[182:183], v237 offset:25600
  v_mul_f32 v216, v250, v216
  v_mul_f32 v217, v250, v217
  v_mul_f32 v218, v250, v218
  v_mul_f32 v219, v250, v219
  v_cvt_pk_bf16_f32 v216, v216, v217
  v_mfma_f32_16x16x32_bf16 v[52:55], a[188:191], v[112:115], v[52:55]
  s_waitcnt lgkmcnt(8)
  s_waitcnt vmcnt(21)
  v_mfma_f32_16x16x32_bf16 v[0:3], a[160:163], v[120:123], v[0:3]
  ds_read_b64_tr_b16 a[184:185], v238 offset:24576
  ds_read_b64_tr_b16 a[186:187], v238 offset:25600
  v_cvt_pk_bf16_f32 v217, v218, v219
  v_cvt_pk_bf16_f32 v218, v220, v221
  v_cvt_pk_bf16_f32 v219, v222, v223
  s_nop 0
  v_permlane16_swap_b32 v216, v218
  v_permlane16_swap_b32 v217, v219
  s_waitcnt vmcnt(20)
  v_mfma_f32_16x16x32_bf16 v[8:11], a[160:163], v[124:127], v[8:11]
  v_mfma_f32_16x16x32_bf16 v[12:15], a[164:167], v[124:127], v[12:15]
  ds_read_b64_tr_b16 a[188:189], v239 offset:24576
  ds_read_b64_tr_b16 a[190:191], v239 offset:25600
  v_accvgpr_write_b32 a24, v216
  v_accvgpr_write_b32 a25, v217
  v_accvgpr_write_b32 a26, v218
  v_accvgpr_write_b32 a27, v219
  v_accvgpr_read_b32 v220, a252
  v_accvgpr_read_b32 v221, a253
  v_mfma_f32_16x16x32_bf16 v[4:7], a[164:167], v[120:123], v[4:7]
  s_waitcnt lgkmcnt(8)
  v_mfma_f32_16x16x32_bf16 v[16:19], a[168:171], v[120:123], v[16:19]
  s_barrier
  ds_read_b128 a[160:163], v224 offset:16384
  v_accvgpr_read_b32 v222, a254
  v_accvgpr_read_b32 v223, a255
  v_accvgpr_read_b32 v216, a248
  v_accvgpr_read_b32 v217, a249
  v_accvgpr_read_b32 v218, a250
  v_mfma_f32_16x16x32_bf16 v[24:27], a[168:171], v[124:127], v[24:27]
  v_mfma_f32_16x16x32_bf16 v[28:31], a[172:175], v[124:127], v[28:31]
  ds_read_b128 a[164:167], v224 offset:20480
  s_add_u32 m0, s41, 147456
  s_nop 0
  buffer_load_dwordx4 v248, s[12:15], s33 offen offset:0 nt lds
  v_accvgpr_read_b32 v219, a251
  v_mul_f32 v220, v255, v220
  v_mul_f32 v221, v255, v221
  v_mfma_f32_16x16x32_bf16 v[20:23], a[172:175], v[120:123], v[20:23]
  s_waitcnt lgkmcnt(6)
  v_mfma_f32_16x16x32_bf16 v[32:35], a[176:179], v[120:123], v[32:35]
  ds_read_b128 a[168:171], v225 offset:16384
  v_mul_f32 v222, v255, v222
  v_mul_f32 v223, v255, v223
  v_mul_f32 v216, v255, v216
  v_mul_f32 v217, v255, v217
  v_mul_f32 v218, v255, v218
  v_mul_f32 v219, v255, v219
  v_cvt_pk_bf16_f32 v216, v216, v217
  v_mfma_f32_16x16x32_bf16 v[40:43], a[176:179], v[124:127], v[40:43]
  v_mfma_f32_16x16x32_bf16 v[44:47], a[180:183], v[124:127], v[44:47]
  ds_read_b128 a[172:175], v225 offset:20480
  v_cvt_pk_bf16_f32 v217, v218, v219
  v_cvt_pk_bf16_f32 v218, v220, v221
  v_cvt_pk_bf16_f32 v219, v222, v223
  s_nop 0
  v_permlane16_swap_b32 v216, v218
  v_permlane16_swap_b32 v217, v219
  v_accvgpr_write_b32 a28, v216
  v_mfma_f32_16x16x32_bf16 v[36:39], a[180:183], v[120:123], v[36:39]
  s_waitcnt lgkmcnt(4)
  v_mfma_f32_16x16x32_bf16 v[48:51], a[184:187], v[120:123], v[48:51]
  ds_read_b128 a[176:179], v226 offset:16384
  buffer_load_dwordx4 v248, s[12:15], s33 offen offset:1024 nt lds
  v_accvgpr_write_b32 a29, v217
  v_accvgpr_write_b32 a30, v218
  v_accvgpr_write_b32 a31, v219
  v_mfma_f32_16x16x32_bf16 v[56:59], a[184:187], v[124:127], v[56:59]
  v_mfma_f32_16x16x32_bf16 v[60:63], a[188:191], v[124:127], v[60:63]
  ds_read_b128 a[180:183], v226 offset:20480
  v_add_f32 v209, v77, v196
  v_exp_f32 v208, v208
  v_exp_f32 v209, v209
  v_add_f32 v215, v215, v212
  v_add_f32 v215, v215, v213
  v_mfma_f32_16x16x32_bf16 v[52:55], a[188:191], v[120:123], v[52:55]
  s_waitcnt lgkmcnt(4)
  v_mfma_f32_16x16x32_bf16 v[96:99], a[160:163], v[160:163], v[192:195]
  ds_read_b128 a[184:187], v227 offset:16384
  v_cvt_pk_bf16_f32 v133, v212, v213
  v_add_f32 v210, v78, v196
  v_add_f32 v211, v79, v196
  v_exp_f32 v210, v210
  v_exp_f32 v211, v211
  v_mfma_f32_16x16x32_bf16 v[104:107], a[160:163], v[164:167], v[196:199]
  v_mfma_f32_16x16x32_bf16 v[108:111], a[164:167], v[164:167], v[196:199]
  ds_read_b128 a[188:191], v227 offset:20480
  buffer_load_dwordx4 v248, s[12:15], s33 offen offset:2048 nt lds
  v_add_f32 v215, v215, v208
  v_add_f32 v215, v215, v209
  v_mfma_f32_16x16x32_bf16 v[100:103], a[164:167], v[160:163], v[192:195]
  s_waitcnt lgkmcnt(4)
  v_mfma_f32_16x16x32_bf16 v[96:99], a[168:171], v[168:171], v[96:99]
  ds_read_b128 a[160:163], v224 offset:18432
  v_cvt_pk_bf16_f32 v134, v208, v209
  v_add_f32 v212, v80, v192
  v_add_f32 v213, v81, v192
  v_exp_f32 v212, v212
  v_exp_f32 v213, v213
  v_mfma_f32_16x16x32_bf16 v[104:107], a[168:171], v[172:175], v[104:107]
  v_mfma_f32_16x16x32_bf16 v[108:111], a[172:175], v[172:175], v[108:111]
  ds_read_b128 a[164:167], v224 offset:22528
  v_add_f32 v215, v215, v210
  v_add_f32 v215, v215, v211
  v_cvt_pk_bf16_f32 v135, v210, v211
  v_add_f32 v208, v82, v192
  v_add_f32 v209, v83, v192
  v_exp_f32 v208, v208
  v_mfma_f32_16x16x32_bf16 v[100:103], a[172:175], v[168:171], v[100:103]
  s_waitcnt lgkmcnt(4)
  v_mfma_f32_16x16x32_bf16 v[96:99], a[176:179], v[176:179], v[96:99]
  ds_read_b128 a[168:171], v225 offset:18432
  buffer_load_dwordx4 v248, s[12:15], s33 offen offset:3072 nt lds
  s_add_u32 s33, s33, 0x4000
  v_exp_f32 v209, v209
  v_add_f32 v214, v214, v212
  v_mfma_f32_16x16x32_bf16 v[104:107], a[176:179], v[180:183], v[104:107]
  v_mfma_f32_16x16x32_bf16 v[108:111], a[180:183], v[180:183], v[108:111]
  ds_read_b128 a[172:175], v225 offset:22528
  v_add_f32 v214, v214, v213
  v_cvt_pk_bf16_f32 v136, v212, v213
  v_add_f32 v210, v84, v192
  v_add_f32 v211, v85, v192
  v_exp_f32 v210, v210
  v_mfma_f32_16x16x32_bf16 v[100:103], a[180:183], v[176:179], v[100:103]
  s_waitcnt lgkmcnt(4)
  v_mfma_f32_16x16x32_bf16 v[96:99], a[184:187], v[184:187], v[96:99]
  ds_read_b128 a[176:179], v226 offset:18432
  v_exp_f32 v211, v211
  v_add_f32 v214, v214, v208
  v_add_f32 v214, v214, v209
  v_cvt_pk_bf16_f32 v137, v208, v209
  v_add_f32 v212, v86, v192
  v_add_f32 v213, v87, v192
  v_mfma_f32_16x16x32_bf16 v[104:107], a[184:187], v[188:191], v[104:107]
  v_mfma_f32_16x16x32_bf16 v[108:111], a[188:191], v[188:191], v[108:111]
  ds_read_b128 a[180:183], v226 offset:22528
  v_exp_f32 v212, v212
  v_exp_f32 v213, v213
  v_add_f32 v214, v214, v210
  v_add_f32 v214, v214, v211
  v_cvt_pk_bf16_f32 v138, v210, v211
  v_mfma_f32_16x16x32_bf16 v[100:103], a[188:191], v[184:187], v[100:103]
  s_waitcnt lgkmcnt(4)
  v_mfma_f32_16x16x32_bf16 v[112:115], a[160:163], v[160:163], v[192:195]
  ds_read_b128 a[184:187], v227 offset:18432
  v_add_f32 v208, v88, v196
  v_add_f32 v209, v89, v196
  v_exp_f32 v208, v208
  v_exp_f32 v209, v209
  v_add_f32 v214, v214, v212
  v_mfma_f32_16x16x32_bf16 v[120:123], a[160:163], v[164:167], v[196:199]
  v_mfma_f32_16x16x32_bf16 v[124:127], a[164:167], v[164:167], v[196:199]
  ds_read_b128 a[188:191], v227 offset:22528
  v_add_f32 v214, v214, v213
  v_cvt_pk_bf16_f32 v139, v212, v213
  v_add_f32 v210, v90, v196
  v_add_f32 v211, v91, v196
  v_exp_f32 v210, v210
  v_mfma_f32_16x16x32_bf16 v[116:119], a[164:167], v[160:163], v[192:195]
  s_waitcnt lgkmcnt(4)
  v_mfma_f32_16x16x32_bf16 v[112:115], a[168:171], v[168:171], v[112:115]
  s_waitcnt vmcnt(20)
  s_barrier
  ds_read_b64_tr_b16 a[160:161], v232 offset:32768
  ds_read_b64_tr_b16 a[162:163], v232 offset:33792
  v_exp_f32 v211, v211
  v_add_f32 v215, v215, v208
  v_add_f32 v215, v215, v209
  v_cvt_pk_bf16_f32 v140, v208, v209
  v_mfma_f32_16x16x32_bf16 v[120:123], a[168:171], v[172:175], v[120:123]
  v_mfma_f32_16x16x32_bf16 v[124:127], a[172:175], v[172:175], v[124:127]
  ds_read_b64_tr_b16 a[164:165], v233 offset:32768
  ds_read_b64_tr_b16 a[166:167], v233 offset:33792
  s_add_u32 m0, s41, 81920
  s_nop 0
  buffer_load_dwordx4 v244, s[16:19], s34 offen offset:0 lds
  v_add_f32 v212, v92, v196
  v_add_f32 v213, v93, v196
  v_mfma_f32_16x16x32_bf16 v[116:119], a[172:175], v[168:171], v[116:119]
  s_waitcnt lgkmcnt(6)
  v_mfma_f32_16x16x32_bf16 v[112:115], a[176:179], v[176:179], v[112:115]
  ds_read_b64_tr_b16 a[168:169], v234 offset:32768
  ds_read_b64_tr_b16 a[170:171], v234 offset:33792
  v_exp_f32 v212, v212
  v_exp_f32 v213, v213
  v_add_f32 v215, v215, v210
  v_add_f32 v215, v215, v211
  v_cvt_pk_bf16_f32 v141, v210, v211
  v_mfma_f32_16x16x32_bf16 v[120:123], a[176:179], v[180:183], v[120:123]
  v_mfma_f32_16x16x32_bf16 v[124:127], a[180:183], v[180:183], v[124:127]
  ds_read_b64_tr_b16 a[172:173], v235 offset:32768
  ds_read_b64_tr_b16 a[174:175], v235 offset:33792
  v_add_f32 v208, v94, v196
  v_add_f32 v209, v95, v196
  v_exp_f32 v208, v208
  v_exp_f32 v209, v209
  v_mfma_f32_16x16x32_bf16 v[116:119], a[180:183], v[176:179], v[116:119]
  s_waitcnt lgkmcnt(8)
  v_mfma_f32_16x16x32_bf16 v[112:115], a[184:187], v[184:187], v[112:115]
  ds_read_b64_tr_b16 a[176:177], v236 offset:32768
  ds_read_b64_tr_b16 a[178:179], v236 offset:33792
  buffer_load_dwordx4 v245, s[16:19], s34 offen offset:1024 lds
  v_add_f32 v215, v215, v212
  v_add_f32 v215, v215, v213
  v_mfma_f32_16x16x32_bf16 v[120:123], a[184:187], v[188:191], v[120:123]
  v_mfma_f32_16x16x32_bf16 v[124:127], a[188:191], v[188:191], v[124:127]
  ds_read_b64_tr_b16 a[180:181], v237 offset:32768
  ds_read_b64_tr_b16 a[182:183], v237 offset:33792
  v_cvt_pk_bf16_f32 v142, v212, v213
  v_add_f32 v215, v215, v208
  v_add_f32 v215, v215, v209
  v_cvt_pk_bf16_f32 v143, v208, v209
  v_mov_b32 v249, v214
  v_mov_b32 v254, v215
  v_mfma_f32_16x16x32_bf16 v[116:119], a[188:191], v[184:187], v[116:119]
  s_waitcnt lgkmcnt(8)
  v_mfma_f32_16x16x32_bf16 a[192:195], a[160:163], v[128:131], 0
  ds_read_b64_tr_b16 a[184:185], v238 offset:32768
  ds_read_b64_tr_b16 a[186:187], v238 offset:33792
  v_mfma_f32_16x16x32_bf16 a[200:203], a[160:163], v[132:135], 0
  v_mfma_f32_16x16x32_bf16 a[204:207], a[164:167], v[132:135], 0
  ds_read_b64_tr_b16 a[188:189], v239 offset:32768
  ds_read_b64_tr_b16 a[190:191], v239 offset:33792
  buffer_load_dwordx4 v246, s[16:19], s34 offen offset:2048 lds
  v_mfma_f32_16x16x32_bf16 a[196:199], a[164:167], v[128:131], 0
  s_waitcnt lgkmcnt(8)
  v_mfma_f32_16x16x32_bf16 a[208:211], a[168:171], v[128:131], 0
  ds_read_b64_tr_b16 a[160:161], v232 offset:40960
  ds_read_b64_tr_b16 a[162:163], v232 offset:41984
  v_exp_f32 v208, v96
  v_exp_f32 v209, v97
  v_mfma_f32_16x16x32_bf16 a[216:219], a[168:171], v[132:135], 0
  v_mfma_f32_16x16x32_bf16 a[220:223], a[172:175], v[132:135], 0
  ds_read_b64_tr_b16 a[164:165], v233 offset:40960
  ds_read_b64_tr_b16 a[166:167], v233 offset:41984
  v_exp_f32 v210, v98
  v_cvt_pk_bf16_f32 v144, v208, v209
  v_mfma_f32_16x16x32_bf16 a[212:215], a[172:175], v[128:131], 0
  s_waitcnt lgkmcnt(8)
  v_mfma_f32_16x16x32_bf16 a[224:227], a[176:179], v[128:131], 0
  ds_read_b64_tr_b16 a[168:169], v234 offset:40960
  ds_read_b64_tr_b16 a[170:171], v234 offset:41984
  buffer_load_dwordx4 v247, s[16:19], s34 offen offset:3072 lds
  s_add_u32 s34, s34, 524288
  s_sub_u32 s38, s34, 5242880
  s_min_u32 s34, s34, s38
  v_mfma_f32_16x16x32_bf16 a[232:235], a[176:179], v[132:135], 0
  v_mfma_f32_16x16x32_bf16 a[236:239], a[180:183], v[132:135], 0
  ds_read_b64_tr_b16 a[172:173], v235 offset:40960
  ds_read_b64_tr_b16 a[174:175], v235 offset:41984
  v_exp_f32 v211, v99
  v_add_f32 v214, v208, v209
  v_mfma_f32_16x16x32_bf16 a[228:231], a[180:183], v[128:131], 0
  s_waitcnt lgkmcnt(8)
  v_mfma_f32_16x16x32_bf16 a[240:243], a[184:187], v[128:131], 0
  ds_read_b64_tr_b16 a[176:177], v236 offset:40960
  ds_read_b64_tr_b16 a[178:179], v236 offset:41984
  v_exp_f32 v212, v100
  v_add_f32 v214, v214, v210
  v_cvt_pk_bf16_f32 v145, v210, v211
  v_mfma_f32_16x16x32_bf16 a[248:251], a[184:187], v[132:135], 0
  v_mfma_f32_16x16x32_bf16 a[252:255], a[188:191], v[132:135], 0
  ds_read_b64_tr_b16 a[180:181], v237 offset:40960
  ds_read_b64_tr_b16 a[182:183], v237 offset:41984
  v_exp_f32 v213, v101
  v_mfma_f32_16x16x32_bf16 a[244:247], a[188:191], v[128:131], 0
  s_waitcnt lgkmcnt(8)
  v_mfma_f32_16x16x32_bf16 a[192:195], a[160:163], v[136:139], a[192:195]
  ds_read_b64_tr_b16 a[184:185], v238 offset:40960
  ds_read_b64_tr_b16 a[186:187], v238 offset:41984
  v_add_f32 v214, v214, v211
  v_exp_f32 v208, v102
  v_mfma_f32_16x16x32_bf16 a[200:203], a[160:163], v[140:143], a[200:203]
  v_mfma_f32_16x16x32_bf16 a[204:207], a[164:167], v[140:143], a[204:207]
  ds_read_b64_tr_b16 a[188:189], v239 offset:40960
  ds_read_b64_tr_b16 a[190:191], v239 offset:41984
  v_add_f32 v214, v214, v212
  v_cvt_pk_bf16_f32 v146, v212, v213
  v_exp_f32 v209, v103
  v_mfma_f32_16x16x32_bf16 a[196:199], a[164:167], v[136:139], a[196:199]
  s_waitcnt lgkmcnt(8)
  v_mfma_f32_16x16x32_bf16 a[208:211], a[168:171], v[136:139], a[208:211]
  s_barrier
  ds_read_b128 a[160:163], v224 offset:32768
  v_add_f32 v214, v214, v213
  v_mfma_f32_16x16x32_bf16 a[216:219], a[168:171], v[140:143], a[216:219]
  v_mfma_f32_16x16x32_bf16 a[220:223], a[172:175], v[140:143], a[220:223]
  ds_read_b128 a[164:167], v224 offset:36864
  s_add_u32 m0, s41, 16384
  s_nop 0
  buffer_load_dwordx4 v240, s[8:11], s32 offen offset:0 nt lds
  v_exp_f32 v210, v104
  v_mfma_f32_16x16x32_bf16 a[212:215], a[172:175], v[136:139], a[212:215]
  s_waitcnt lgkmcnt(6)
  v_mfma_f32_16x16x32_bf16 a[224:227], a[176:179], v[136:139], a[224:227]
  ds_read_b128 a[168:171], v225 offset:32768
  v_add_f32 v214, v214, v208
  v_cvt_pk_bf16_f32 v147, v208, v209
  v_exp_f32 v211, v105
  v_mfma_f32_16x16x32_bf16 a[232:235], a[176:179], v[140:143], a[232:235]
  v_mfma_f32_16x16x32_bf16 a[236:239], a[180:183], v[140:143], a[236:239]
  ds_read_b128 a[172:175], v225 offset:36864
  v_add_f32 v214, v214, v209
  v_exp_f32 v212, v106
  v_mfma_f32_16x16x32_bf16 a[228:231], a[180:183], v[136:139], a[228:231]
  s_waitcnt lgkmcnt(4)
  v_mfma_f32_16x16x32_bf16 a[240:243], a[184:187], v[136:139], a[240:243]
  ds_read_b128 a[176:179], v226 offset:32768
  buffer_load_dwordx4 v241, s[8:11], s32 offen offset:1024 nt lds
  v_mfma_f32_16x16x32_bf16 a[248:251], a[184:187], v[140:143], a[248:251]
  v_mfma_f32_16x16x32_bf16 a[252:255], a[188:191], v[140:143], a[252:255]
  ds_read_b128 a[180:183], v226 offset:36864
  v_cvt_pk_bf16_f32 v148, v210, v211
  v_exp_f32 v213, v107
  v_add_f32 v215, v210, v211
  v_mfma_f32_16x16x32_bf16 a[244:247], a[188:191], v[136:139], a[244:247]
  s_waitcnt lgkmcnt(4)
  v_mfma_f32_16x16x32_bf16 v[64:67], a[160:163], v[160:163], v[192:195]
  ds_read_b128 a[184:187], v227 offset:32768
  v_exp_f32 v208, v108
  v_add_f32 v215, v215, v212
  v_cvt_pk_bf16_f32 v149, v212, v213
  v_mfma_f32_16x16x32_bf16 v[72:75], a[160:163], v[164:167], v[196:199]
  v_mfma_f32_16x16x32_bf16 v[76:79], a[164:167], v[164:167], v[196:199]
  ds_read_b128 a[188:191], v227 offset:36864
  buffer_load_dwordx4 v242, s[8:11], s32 offen offset:2048 nt lds
  v_mfma_f32_16x16x32_bf16 v[68:71], a[164:167], v[160:163], v[192:195]
  s_waitcnt lgkmcnt(4)
  v_mfma_f32_16x16x32_bf16 v[64:67], a[168:171], v[168:171], v[64:67]
  ds_read_b128 a[160:163], v224 offset:34816
  v_exp_f32 v209, v109
  v_add_f32 v215, v215, v213
  v_exp_f32 v210, v110
  v_mfma_f32_16x16x32_bf16 v[72:75], a[168:171], v[172:175], v[72:75]
  v_mfma_f32_16x16x32_bf16 v[76:79], a[172:175], v[172:175], v[76:79]
  ds_read_b128 a[164:167], v224 offset:38912
  v_add_f32 v215, v215, v208
  v_cvt_pk_bf16_f32 v150, v208, v209
  v_exp_f32 v211, v111
  v_mfma_f32_16x16x32_bf16 v[68:71], a[172:175], v[168:171], v[68:71]
  s_waitcnt lgkmcnt(4)
  v_mfma_f32_16x16x32_bf16 v[64:67], a[176:179], v[176:179], v[64:67]
  ds_read_b128 a[168:171], v225 offset:34816
  buffer_load_dwordx4 v243, s[8:11], s32 offen offset:3072 nt lds
  s_add_u32 s32, s32, 0x4000
  v_mfma_f32_16x16x32_bf16 v[72:75], a[176:179], v[180:183], v[72:75]
  v_mfma_f32_16x16x32_bf16 v[76:79], a[180:183], v[180:183], v[76:79]
  ds_read_b128 a[172:175], v225 offset:38912
  v_add_f32 v215, v215, v209
  v_exp_f32 v212, v112
  v_mfma_f32_16x16x32_bf16 v[68:71], a[180:183], v[176:179], v[68:71]
  s_waitcnt lgkmcnt(4)
  v_mfma_f32_16x16x32_bf16 v[64:67], a[184:187], v[184:187], v[64:67]
  ds_read_b128 a[176:179], v226 offset:34816
  v_add_f32 v215, v215, v210
  v_cvt_pk_bf16_f32 v151, v210, v211
  v_exp_f32 v213, v113
  v_mfma_f32_16x16x32_bf16 v[72:75], a[184:187], v[188:191], v[72:75]
  v_mfma_f32_16x16x32_bf16 v[76:79], a[188:191], v[188:191], v[76:79]
  ds_read_b128 a[180:183], v226 offset:38912
  v_add_f32 v215, v215, v211
  v_exp_f32 v208, v114
  v_add_f32 v214, v214, v212
  v_mfma_f32_16x16x32_bf16 v[68:71], a[188:191], v[184:187], v[68:71]
  s_waitcnt lgkmcnt(4)
  v_mfma_f32_16x16x32_bf16 v[80:83], a[160:163], v[160:163], v[192:195]
  ds_read_b128 a[184:187], v227 offset:34816
  v_cvt_pk_bf16_f32 v152, v212, v213
  v_exp_f32 v209, v115
  v_add_f32 v214, v214, v213
  v_mfma_f32_16x16x32_bf16 v[88:91], a[160:163], v[164:167], v[196:199]
  v_mfma_f32_16x16x32_bf16 v[92:95], a[164:167], v[164:167], v[196:199]
  ds_read_b128 a[188:191], v227 offset:38912
  v_exp_f32 v210, v116
  v_add_f32 v214, v214, v208
  v_cvt_pk_bf16_f32 v153, v208, v209
  v_mfma_f32_16x16x32_bf16 v[84:87], a[164:167], v[160:163], v[192:195]
  s_waitcnt lgkmcnt(4)
  v_mfma_f32_16x16x32_bf16 v[80:83], a[168:171], v[168:171], v[80:83]
  s_waitcnt vmcnt(24)
  s_barrier
  ds_read_b64_tr_b16 a[160:161], v232 offset:49152
  ds_read_b64_tr_b16 a[162:163], v232 offset:50176
  v_mfma_f32_16x16x32_bf16 v[88:91], a[168:171], v[172:175], v[88:91]
  v_mfma_f32_16x16x32_bf16 v[92:95], a[172:175], v[172:175], v[92:95]
  ds_read_b64_tr_b16 a[164:165], v233 offset:49152
  ds_read_b64_tr_b16 a[166:167], v233 offset:50176
  s_add_u32 m0, s41, 98304
  s_nop 0
  buffer_load_dwordx4 v248, s[12:15], s33 offen offset:0 nt lds
  v_mfma_f32_16x16x32_bf16 v[84:87], a[172:175], v[168:171], v[84:87]
  s_waitcnt lgkmcnt(6)
  v_mfma_f32_16x16x32_bf16 v[80:83], a[176:179], v[176:179], v[80:83]
  ds_read_b64_tr_b16 a[168:169], v234 offset:49152
  ds_read_b64_tr_b16 a[170:171], v234 offset:50176
  v_exp_f32 v211, v117
  v_add_f32 v214, v214, v209
  v_mfma_f32_16x16x32_bf16 v[88:91], a[176:179], v[180:183], v[88:91]
  v_mfma_f32_16x16x32_bf16 v[92:95], a[180:183], v[180:183], v[92:95]
  ds_read_b64_tr_b16 a[172:173], v235 offset:49152
  ds_read_b64_tr_b16 a[174:175], v235 offset:50176
  v_exp_f32 v212, v118
  v_add_f32 v214, v214, v210
  v_cvt_pk_bf16_f32 v154, v210, v211
  v_mfma_f32_16x16x32_bf16 v[84:87], a[180:183], v[176:179], v[84:87]
  s_waitcnt lgkmcnt(8)
  v_mfma_f32_16x16x32_bf16 v[80:83], a[184:187], v[184:187], v[80:83]
  ds_read_b64_tr_b16 a[176:177], v236 offset:49152
  ds_read_b64_tr_b16 a[178:179], v236 offset:50176
  buffer_load_dwordx4 v248, s[12:15], s33 offen offset:1024 nt lds
  v_mfma_f32_16x16x32_bf16 v[88:91], a[184:187], v[188:191], v[88:91]
  v_mfma_f32_16x16x32_bf16 v[92:95], a[188:191], v[188:191], v[92:95]
  ds_read_b64_tr_b16 a[180:181], v237 offset:49152
  ds_read_b64_tr_b16 a[182:183], v237 offset:50176
  v_exp_f32 v213, v119
  v_add_f32 v214, v214, v211
  v_mfma_f32_16x16x32_bf16 v[84:87], a[188:191], v[184:187], v[84:87]
  s_waitcnt lgkmcnt(8)
  v_mfma_f32_16x16x32_bf16 v[0:3], a[160:163], a[64:67], v[0:3]
  ds_read_b64_tr_b16 a[184:185], v238 offset:49152
  ds_read_b64_tr_b16 a[186:187], v238 offset:50176
  v_exp_f32 v208, v120
  v_add_f32 v214, v214, v212
  v_mfma_f32_16x16x32_bf16 v[8:11], a[160:163], a[68:71], v[8:11]
  v_mfma_f32_16x16x32_bf16 v[12:15], a[164:167], a[68:71], v[12:15]
  ds_read_b64_tr_b16 a[188:189], v239 offset:49152
  ds_read_b64_tr_b16 a[190:191], v239 offset:50176
  buffer_load_dwordx4 v248, s[12:15], s33 offen offset:2048 nt lds
  v_mfma_f32_16x16x32_bf16 v[4:7], a[164:167], a[64:67], v[4:7]
  s_waitcnt lgkmcnt(8)
  v_mfma_f32_16x16x32_bf16 v[16:19], a[168:171], a[64:67], v[16:19]
  ds_read_b64_tr_b16 a[160:161], v232 offset:57344
  ds_read_b64_tr_b16 a[162:163], v232 offset:58368
  v_cvt_pk_bf16_f32 v155, v212, v213
  v_exp_f32 v209, v121
  v_mfma_f32_16x16x32_bf16 v[24:27], a[168:171], a[68:71], v[24:27]
  v_mfma_f32_16x16x32_bf16 v[28:31], a[172:175], a[68:71], v[28:31]
  ds_read_b64_tr_b16 a[164:165], v233 offset:57344
  ds_read_b64_tr_b16 a[166:167], v233 offset:58368
  v_add_f32 v214, v214, v213
  v_exp_f32 v210, v122
  v_mfma_f32_16x16x32_bf16 v[20:23], a[172:175], a[64:67], v[20:23]
  s_waitcnt lgkmcnt(8)
  v_mfma_f32_16x16x32_bf16 v[32:35], a[176:179], a[64:67], v[32:35]
  ds_read_b64_tr_b16 a[168:169], v234 offset:57344
  ds_read_b64_tr_b16 a[170:171], v234 offset:58368
  buffer_load_dwordx4 v248, s[12:15], s33 offen offset:3072 nt lds
  s_add_u32 s33, s33, 0x4000
  v_mfma_f32_16x16x32_bf16 v[40:43], a[176:179], a[68:71], v[40:43]
  v_mfma_f32_16x16x32_bf16 v[44:47], a[180:183], a[68:71], v[44:47]
  ds_read_b64_tr_b16 a[172:173], v235 offset:57344
  ds_read_b64_tr_b16 a[174:175], v235 offset:58368
  v_add_f32 v215, v215, v208
  v_cvt_pk_bf16_f32 v156, v208, v209
  v_mfma_f32_16x16x32_bf16 v[36:39], a[180:183], a[64:67], v[36:39]
  s_waitcnt lgkmcnt(8)
  v_mfma_f32_16x16x32_bf16 v[48:51], a[184:187], a[64:67], v[48:51]
  ds_read_b64_tr_b16 a[176:177], v236 offset:57344
  ds_read_b64_tr_b16 a[178:179], v236 offset:58368
  v_exp_f32 v211, v123
  v_add_f32 v215, v215, v209
  v_mfma_f32_16x16x32_bf16 v[56:59], a[184:187], a[68:71], v[56:59]
  v_mfma_f32_16x16x32_bf16 v[60:63], a[188:191], a[68:71], v[60:63]
  ds_read_b64_tr_b16 a[180:181], v237 offset:57344
  ds_read_b64_tr_b16 a[182:183], v237 offset:58368
  v_exp_f32 v212, v124
  v_add_f32 v215, v215, v210
  v_cvt_pk_bf16_f32 v157, v210, v211
  v_mfma_f32_16x16x32_bf16 v[52:55], a[188:191], a[64:67], v[52:55]
  s_waitcnt lgkmcnt(8)
  v_mfma_f32_16x16x32_bf16 v[0:3], a[160:163], a[72:75], v[0:3]
  ds_read_b64_tr_b16 a[184:185], v238 offset:57344
  ds_read_b64_tr_b16 a[186:187], v238 offset:58368
  v_exp_f32 v213, v125
  v_mfma_f32_16x16x32_bf16 v[8:11], a[160:163], a[76:79], v[8:11]
  v_mfma_f32_16x16x32_bf16 v[12:15], a[164:167], a[76:79], v[12:15]
  ds_read_b64_tr_b16 a[188:189], v239 offset:57344
  ds_read_b64_tr_b16 a[190:191], v239 offset:58368
  v_add_f32 v215, v215, v211
  v_exp_f32 v208, v126
  v_mfma_f32_16x16x32_bf16 v[4:7], a[164:167], a[72:75], v[4:7]
  s_waitcnt lgkmcnt(8)
  v_mfma_f32_16x16x32_bf16 v[16:19], a[168:171], a[72:75], v[16:19]
  s_waitcnt vmcnt(20)
  s_barrier
  ds_read_b64_tr_b16 a[160:161], v232 offset:0
  ds_read_b64_tr_b16 a[162:163], v232 offset:1024
  v_add_f32 v215, v215, v212
  v_mfma_f32_16x16x32_bf16 v[24:27], a[168:171], a[76:79], v[24:27]
  v_mfma_f32_16x16x32_bf16 v[28:31], a[172:175], a[76:79], v[28:31]
  ds_read_b64_tr_b16 a[164:165], v233 offset:0
  ds_read_b64_tr_b16 a[166:167], v233 offset:1024
  s_add_u32 m0, s41, 32768
  s_nop 0
  buffer_load_dwordx4 v240, s[8:11], s32 offen offset:0 nt lds
  v_cvt_pk_bf16_f32 v158, v212, v213
  v_mfma_f32_16x16x32_bf16 v[20:23], a[172:175], a[72:75], v[20:23]
  s_waitcnt lgkmcnt(8)
  v_mfma_f32_16x16x32_bf16 v[32:35], a[176:179], a[72:75], v[32:35]
  ds_read_b64_tr_b16 a[168:169], v234 offset:0
  ds_read_b64_tr_b16 a[170:171], v234 offset:1024
  v_exp_f32 v209, v127
  v_mfma_f32_16x16x32_bf16 v[40:43], a[176:179], a[76:79], v[40:43]
  v_mfma_f32_16x16x32_bf16 v[44:47], a[180:183], a[76:79], v[44:47]
  ds_read_b64_tr_b16 a[172:173], v235 offset:0
  ds_read_b64_tr_b16 a[174:175], v235 offset:1024
  v_add_f32 v215, v215, v213
  v_add_f32 v215, v215, v208
  v_cvt_pk_bf16_f32 v159, v208, v209
  v_mfma_f32_16x16x32_bf16 v[36:39], a[180:183], a[72:75], v[36:39]
  s_waitcnt lgkmcnt(8)
  v_mfma_f32_16x16x32_bf16 v[48:51], a[184:187], a[72:75], v[48:51]
  ds_read_b64_tr_b16 a[176:177], v236 offset:0
  ds_read_b64_tr_b16 a[178:179], v236 offset:1024
  buffer_load_dwordx4 v241, s[8:11], s32 offen offset:1024 nt lds
  v_add_f32 v215, v215, v209
  v_mfma_f32_16x16x32_bf16 v[56:59], a[184:187], a[76:79], v[56:59]
  v_mfma_f32_16x16x32_bf16 v[60:63], a[188:191], a[76:79], v[60:63]
  ds_read_b64_tr_b16 a[180:181], v237 offset:0
  ds_read_b64_tr_b16 a[182:183], v237 offset:1024
  v_add_f32 v210, v214, v215
  v_cmp_lt_f32 vcc, s35, v210
  v_mfma_f32_16x16x32_bf16 v[52:55], a[188:191], a[72:75], v[52:55]
  s_cbranch_vccnz SITE71
BACK71:
  s_waitcnt lgkmcnt(8)
  v_mfma_f32_16x16x32_bf16 a[192:195], a[160:163], v[144:147], a[192:195]
  ds_read_b64_tr_b16 a[184:185], v238 offset:0
  ds_read_b64_tr_b16 a[186:187], v238 offset:1024
  v_add_f32 v249, v249, v214
  v_add_f32 v254, v254, v215
  v_exp_f32 v208, v64
  v_mfma_f32_16x16x32_bf16 a[200:203], a[160:163], v[148:151], a[200:203]
  v_mfma_f32_16x16x32_bf16 a[204:207], a[164:167], v[148:151], a[204:207]
  ds_read_b64_tr_b16 a[188:189], v239 offset:0
  ds_read_b64_tr_b16 a[190:191], v239 offset:1024
  buffer_load_dwordx4 v242, s[8:11], s32 offen offset:2048 nt lds
  v_mfma_f32_16x16x32_bf16 a[196:199], a[164:167], v[144:147], a[196:199]
  s_waitcnt lgkmcnt(8)
  v_mfma_f32_16x16x32_bf16 a[208:211], a[168:171], v[144:147], a[208:211]
  ds_read_b64_tr_b16 a[160:161], v232 offset:8192
  ds_read_b64_tr_b16 a[162:163], v232 offset:9216
  v_exp_f32 v209, v65
  v_mfma_f32_16x16x32_bf16 a[216:219], a[168:171], v[148:151], a[216:219]
  v_mfma_f32_16x16x32_bf16 a[220:223], a[172:175], v[148:151], a[220:223]
  ds_read_b64_tr_b16 a[164:165], v233 offset:8192
  ds_read_b64_tr_b16 a[166:167], v233 offset:9216
  v_exp_f32 v210, v66
  v_cvt_pk_bf16_f32 v128, v208, v209
  v_mfma_f32_16x16x32_bf16 a[212:215], a[172:175], v[144:147], a[212:215]
  s_waitcnt lgkmcnt(8)
  v_mfma_f32_16x16x32_bf16 a[224:227], a[176:179], v[144:147], a[224:227]
  ds_read_b64_tr_b16 a[168:169], v234 offset:8192
  ds_read_b64_tr_b16 a[170:171], v234 offset:9216
  buffer_load_dwordx4 v243, s[8:11], s32 offen offset:3072 nt lds
  s_add_u32 s32, s32, 0x4000
  v_mfma_f32_16x16x32_bf16 a[232:235], a[176:179], v[148:151], a[232:235]
  v_mfma_f32_16x16x32_bf16 a[236:239], a[180:183], v[148:151], a[236:239]
  ds_read_b64_tr_b16 a[172:173], v235 offset:8192
  ds_read_b64_tr_b16 a[174:175], v235 offset:9216
  v_exp_f32 v211, v67
  v_add_f32 v214, v208, v209
  v_mfma_f32_16x16x32_bf16 a[228:231], a[180:183], v[144:147], a[228:231]
  s_waitcnt lgkmcnt(8)
  v_mfma_f32_16x16x32_bf16 a[240:243], a[184:187], v[144:147], a[240:243]
  ds_read_b64_tr_b16 a[176:177], v236 offset:8192
  ds_read_b64_tr_b16 a[178:179], v236 offset:9216
  v_exp_f32 v212, v68
  v_add_f32 v214, v214, v210
  v_mfma_f32_16x16x32_bf16 a[248:251], a[184:187], v[148:151], a[248:251]
  v_mfma_f32_16x16x32_bf16 a[252:255], a[188:191], v[148:151], a[252:255]
  ds_read_b64_tr_b16 a[180:181], v237 offset:8192
  ds_read_b64_tr_b16 a[182:183], v237 offset:9216
  v_cvt_pk_bf16_f32 v129, v210, v211
  v_exp_f32 v213, v69
  v_mfma_f32_16x16x32_bf16 a[244:247], a[188:191], v[144:147], a[244:247]
  s_waitcnt lgkmcnt(8)
  v_mfma_f32_16x16x32_bf16 a[192:195], a[160:163], v[152:155], a[192:195]
  ds_read_b64_tr_b16 a[184:185], v238 offset:8192
  ds_read_b64_tr_b16 a[186:187], v238 offset:9216
  v_add_f32 v214, v214, v211
  v_exp_f32 v208, v70
  v_mfma_f32_16x16x32_bf16 a[200:203], a[160:163], v[156:159], a[200:203]
  v_mfma_f32_16x16x32_bf16 a[204:207], a[164:167], v[156:159], a[204:207]
  ds_read_b64_tr_b16 a[188:189], v239 offset:8192
  ds_read_b64_tr_b16 a[190:191], v239 offset:9216
  v_add_f32 v214, v214, v212
  v_cvt_pk_bf16_f32 v130, v212, v213
  v_mfma_f32_16x16x32_bf16 a[196:199], a[164:167], v[152:155], a[196:199]
  s_waitcnt lgkmcnt(8)
  v_mfma_f32_16x16x32_bf16 a[208:211], a[168:171], v[152:155], a[208:211]
  s_barrier
  ds_read_b128 a[160:163], v224 offset:49152
  v_exp_f32 v209, v71
  v_add_f32 v214, v214, v213
  v_mfma_f32_16x16x32_bf16 a[216:219], a[168:171], v[156:159], a[216:219]
  v_mfma_f32_16x16x32_bf16 a[220:223], a[172:175], v[156:159], a[220:223]
  ds_read_b128 a[164:167], v224 offset:53248
  s_add_u32 m0, s41, 114688
  s_nop 0
  buffer_load_dwordx4 v248, s[12:15], s33 offen offset:0 nt lds
  v_exp_f32 v210, v72
  v_mfma_f32_16x16x32_bf16 a[212:215], a[172:175], v[152:155], a[212:215]
  s_waitcnt lgkmcnt(6)
  v_mfma_f32_16x16x32_bf16 a[224:227], a[176:179], v[152:155], a[224:227]
  ds_read_b128 a[168:171], v225 offset:49152
  v_add_f32 v214, v214, v208
  v_cvt_pk_bf16_f32 v131, v208, v209
  v_exp_f32 v211, v73
  v_mfma_f32_16x16x32_bf16 a[232:235], a[176:179], v[156:159], a[232:235]
  v_mfma_f32_16x16x32_bf16 a[236:239], a[180:183], v[156:159], a[236:239]
  ds_read_b128 a[172:175], v225 offset:53248
  v_add_f32 v214, v214, v209
  v_exp_f32 v212, v74
  v_mfma_f32_16x16x32_bf16 a[228:231], a[180:183], v[152:155], a[228:231]
  s_waitcnt lgkmcnt(4)
  v_mfma_f32_16x16x32_bf16 a[240:243], a[184:187], v[152:155], a[240:243]
  ds_read_b128 a[176:179], v226 offset:49152
  buffer_load_dwordx4 v248, s[12:15], s33 offen offset:1024 nt lds
  v_mfma_f32_16x16x32_bf16 a[248:251], a[184:187], v[156:159], a[248:251]
  v_mfma_f32_16x16x32_bf16 a[252:255], a[188:191], v[156:159], a[252:255]
  ds_read_b128 a[180:183], v226 offset:53248
  v_cvt_pk_bf16_f32 v132, v210, v211
  v_exp_f32 v213, v75
  v_add_f32 v215, v210, v211
  v_mfma_f32_16x16x32_bf16 a[244:247], a[188:191], v[152:155], a[244:247]
  s_waitcnt lgkmcnt(4)
  v_mfma_f32_16x16x32_bf16 v[96:99], a[160:163], v[160:163], v[192:195]
  ds_read_b128 a[184:187], v227 offset:49152
  v_exp_f32 v208, v76
  v_add_f32 v215, v215, v212
  v_cvt_pk_bf16_f32 v133, v212, v213
  v_mfma_f32_16x16x32_bf16 v[104:107], a[160:163], v[164:167], v[196:199]
  v_mfma_f32_16x16x32_bf16 v[108:111], a[164:167], v[164:167], v[196:199]
  ds_read_b128 a[188:191], v227 offset:53248
  buffer_load_dwordx4 v248, s[12:15], s33 offen offset:2048 nt lds
  v_mfma_f32_16x16x32_bf16 v[100:103], a[164:167], v[160:163], v[192:195]
  s_waitcnt lgkmcnt(4)
  v_mfma_f32_16x16x32_bf16 v[96:99], a[168:171], v[168:171], v[96:99]
  ds_read_b128 a[160:163], v224 offset:51200
  v_exp_f32 v209, v77
  v_add_f32 v215, v215, v213
  v_exp_f32 v210, v78
  v_mfma_f32_16x16x32_bf16 v[104:107], a[168:171], v[172:175], v[104:107]
  v_mfma_f32_16x16x32_bf16 v[108:111], a[172:175], v[172:175], v[108:111]
  ds_read_b128 a[164:167], v224 offset:55296
  v_add_f32 v215, v215, v208
  v_cvt_pk_bf16_f32 v134, v208, v209
  v_mfma_f32_16x16x32_bf16 v[100:103], a[172:175], v[168:171], v[100:103]
  s_waitcnt lgkmcnt(4)
  v_mfma_f32_16x16x32_bf16 v[96:99], a[176:179], v[176:179], v[96:99]
  ds_read_b128 a[168:171], v225 offset:51200
  buffer_load_dwordx4 v248, s[12:15], s33 offen offset:3072 nt lds
  s_add_u32 s33, s33, 0x4000
  v_exp_f32 v211, v79
  v_mfma_f32_16x16x32_bf16 v[104:107], a[176:179], v[180:183], v[104:107]
  v_mfma_f32_16x16x32_bf16 v[108:111], a[180:183], v[180:183], v[108:111]
  ds_read_b128 a[172:175], v225 offset:55296
  v_add_f32 v215, v215, v209
  v_exp_f32 v212, v80
  v_mfma_f32_16x16x32_bf16 v[100:103], a[180:183], v[176:179], v[100:103]
  s_waitcnt lgkmcnt(4)
  v_mfma_f32_16x16x32_bf16 v[96:99], a[184:187], v[184:187], v[96:99]
  ds_read_b128 a[176:179], v226 offset:51200
  v_add_f32 v215, v215, v210
  v_cvt_pk_bf16_f32 v135, v210, v211
  v_exp_f32 v213, v81
  v_mfma_f32_16x16x32_bf16 v[104:107], a[184:187], v[188:191], v[104:107]
  v_mfma_f32_16x16x32_bf16 v[108:111], a[188:191], v[188:191], v[108:111]
  ds_read_b128 a[180:183], v226 offset:55296
  v_add_f32 v215, v215, v211
  v_exp_f32 v208, v82
  v_add_f32 v214, v214, v212
  v_mfma_f32_16x16x32_bf16 v[100:103], a[188:191], v[184:187], v[100:103]
  s_waitcnt lgkmcnt(4)
  v_mfma_f32_16x16x32_bf16 v[112:115], a[160:163], v[160:163], v[192:195]
  ds_read_b128 a[184:187], v227 offset:51200
  v_cvt_pk_bf16_f32 v136, v212, v213
  v_exp_f32 v209, v83
  v_add_f32 v214, v214, v213
  v_mfma_f32_16x16x32_bf16 v[120:123], a[160:163], v[164:167], v[196:199]
  v_mfma_f32_16x16x32_bf16 v[124:127], a[164:167], v[164:167], v[196:199]
  ds_read_b128 a[188:191], v227 offset:55296
  v_exp_f32 v210, v84
  v_add_f32 v214, v214, v208
  v_cvt_pk_bf16_f32 v137, v208, v209
  v_mfma_f32_16x16x32_bf16 v[116:119], a[164:167], v[160:163], v[192:195]
  s_waitcnt lgkmcnt(4)
  v_mfma_f32_16x16x32_bf16 v[112:115], a[168:171], v[168:171], v[112:115]
  s_waitcnt vmcnt(24)
  s_barrier
  ds_read_b64_tr_b16 a[160:161], v200 offset:0
  ds_read_b64_tr_b16 a[162:163], v200 offset:1024
  v_mfma_f32_16x16x32_bf16 v[120:123], a[168:171], v[172:175], v[120:123]
  v_mfma_f32_16x16x32_bf16 v[124:127], a[172:175], v[172:175], v[124:127]
  ds_read_b64_tr_b16 a[164:165], v201 offset:0
  ds_read_b64_tr_b16 a[166:167], v201 offset:1024
  s_add_u32 m0, s41, 65536
  s_nop 0
  buffer_load_dwordx4 v244, s[16:19], s34 offen offset:0 lds
  v_mfma_f32_16x16x32_bf16 v[116:119], a[172:175], v[168:171], v[116:119]
  s_waitcnt lgkmcnt(6)
  v_mfma_f32_16x16x32_bf16 v[112:115], a[176:179], v[176:179], v[112:115]
  ds_read_b64_tr_b16 a[168:169], v202 offset:0
  ds_read_b64_tr_b16 a[170:171], v202 offset:1024
  v_exp_f32 v211, v85
  v_add_f32 v214, v214, v209
  v_mfma_f32_16x16x32_bf16 v[120:123], a[176:179], v[180:183], v[120:123]
  v_mfma_f32_16x16x32_bf16 v[124:127], a[180:183], v[180:183], v[124:127]
  ds_read_b64_tr_b16 a[172:173], v203 offset:0
  ds_read_b64_tr_b16 a[174:175], v203 offset:1024
  v_exp_f32 v212, v86
  v_add_f32 v214, v214, v210
  v_cvt_pk_bf16_f32 v138, v210, v211
  v_mfma_f32_16x16x32_bf16 v[116:119], a[180:183], v[176:179], v[116:119]
  s_waitcnt lgkmcnt(8)
  v_mfma_f32_16x16x32_bf16 v[112:115], a[184:187], v[184:187], v[112:115]
  ds_read_b64_tr_b16 a[176:177], v204 offset:0
  ds_read_b64_tr_b16 a[178:179], v204 offset:1024
  buffer_load_dwordx4 v245, s[16:19], s34 offen offset:1024 lds
  v_mfma_f32_16x16x32_bf16 v[120:123], a[184:187], v[188:191], v[120:123]
  v_mfma_f32_16x16x32_bf16 v[124:127], a[188:191], v[188:191], v[124:127]
  ds_read_b64_tr_b16 a[180:181], v205 offset:0
  ds_read_b64_tr_b16 a[182:183], v205 offset:1024
  v_exp_f32 v213, v87
  v_add_f32 v214, v214, v211
  v_mfma_f32_16x16x32_bf16 v[116:119], a[188:191], v[184:187], v[116:119]
  s_waitcnt lgkmcnt(8)
  v_mfma_f32_16x16x32_bf16 v[0:3], a[160:163], a[80:83], v[0:3]
  ds_read_b64_tr_b16 a[184:185], v206 offset:0
  ds_read_b64_tr_b16 a[186:187], v206 offset:1024
  v_exp_f32 v208, v88
  v_add_f32 v214, v214, v212
  v_mfma_f32_16x16x32_bf16 v[8:11], a[160:163], a[84:87], v[8:11]
  v_mfma_f32_16x16x32_bf16 v[12:15], a[164:167], a[84:87], v[12:15]
  ds_read_b64_tr_b16 a[188:189], v207 offset:0
  ds_read_b64_tr_b16 a[190:191], v207 offset:1024
  buffer_load_dwordx4 v246, s[16:19], s34 offen offset:2048 lds
  v_cvt_pk_bf16_f32 v139, v212, v213
  v_mfma_f32_16x16x32_bf16 v[4:7], a[164:167], a[80:83], v[4:7]
  s_waitcnt lgkmcnt(8)
  v_mfma_f32_16x16x32_bf16 v[16:19], a[168:171], a[80:83], v[16:19]
  ds_read_b64_tr_b16 a[160:161], v200 offset:8192
  ds_read_b64_tr_b16 a[162:163], v200 offset:9216
  v_exp_f32 v209, v89
  v_add_f32 v214, v214, v213
  v_mfma_f32_16x16x32_bf16 v[24:27], a[168:171], a[84:87], v[24:27]
  v_mfma_f32_16x16x32_bf16 v[28:31], a[172:175], a[84:87], v[28:31]
  ds_read_b64_tr_b16 a[164:165], v201 offset:8192
  ds_read_b64_tr_b16 a[166:167], v201 offset:9216
  v_exp_f32 v210, v90
  v_add_f32 v215, v215, v208
  v_mfma_f32_16x16x32_bf16 v[20:23], a[172:175], a[80:83], v[20:23]
  s_waitcnt lgkmcnt(8)
  v_mfma_f32_16x16x32_bf16 v[32:35], a[176:179], a[80:83], v[32:35]
  ds_read_b64_tr_b16 a[168:169], v202 offset:8192
  ds_read_b64_tr_b16 a[170:171], v202 offset:9216
  buffer_load_dwordx4 v247, s[16:19], s34 offen offset:3072 lds
  s_add_u32 s34, s34, 524288
  s_sub_u32 s38, s34, 5242880
  s_min_u32 s34, s34, s38
  v_cvt_pk_bf16_f32 v140, v208, v209
  v_mfma_f32_16x16x32_bf16 v[40:43], a[176:179], a[84:87], v[40:43]
  v_mfma_f32_16x16x32_bf16 v[44:47], a[180:183], a[84:87], v[44:47]
  ds_read_b64_tr_b16 a[172:173], v203 offset:8192
  ds_read_b64_tr_b16 a[174:175], v203 offset:9216
  v_exp_f32 v211, v91
  v_add_f32 v215, v215, v209
  v_mfma_f32_16x16x32_bf16 v[36:39], a[180:183], a[80:83], v[36:39]
  s_waitcnt lgkmcnt(8)
  v_mfma_f32_16x16x32_bf16 v[48:51], a[184:187], a[80:83], v[48:51]
  ds_read_b64_tr_b16 a[176:177], v204 offset:8192
  ds_read_b64_tr_b16 a[178:179], v204 offset:9216
  v_exp_f32 v212, v92
  v_add_f32 v215, v215, v210
  v_mfma_f32_16x16x32_bf16 v[56:59], a[184:187], a[84:87], v[56:59]
  v_mfma_f32_16x16x32_bf16 v[60:63], a[188:191], a[84:87], v[60:63]
  ds_read_b64_tr_b16 a[180:181], v205 offset:8192
  ds_read_b64_tr_b16 a[182:183], v205 offset:9216
  v_cvt_pk_bf16_f32 v141, v210, v211
  v_exp_f32 v213, v93
  v_mfma_f32_16x16x32_bf16 v[52:55], a[188:191], a[80:83], v[52:55]
  s_waitcnt lgkmcnt(8)
  v_mfma_f32_16x16x32_bf16 v[0:3], a[160:163], a[88:91], v[0:3]
  ds_read_b64_tr_b16 a[184:185], v206 offset:8192
  ds_read_b64_tr_b16 a[186:187], v206 offset:9216
  v_add_f32 v215, v215, v211
  v_exp_f32 v208, v94
  v_add_f32 v215, v215, v212
  v_mfma_f32_16x16x32_bf16 v[8:11], a[160:163], a[92:95], v[8:11]
  v_mfma_f32_16x16x32_bf16 v[12:15], a[164:167], a[92:95], v[12:15]
  ds_read_b64_tr_b16 a[188:189], v207 offset:8192
  ds_read_b64_tr_b16 a[190:191], v207 offset:9216
  v_cvt_pk_bf16_f32 v142, v212, v213
  v_exp_f32 v209, v95
  v_mfma_f32_16x16x32_bf16 v[4:7], a[164:167], a[88:91], v[4:7]
  s_waitcnt lgkmcnt(8)
  v_mfma_f32_16x16x32_bf16 v[16:19], a[168:171], a[88:91], v[16:19]
  s_waitcnt vmcnt(24)
  s_barrier
  ds_read_b64_tr_b16 a[160:161], v200 offset:16384
  ds_read_b64_tr_b16 a[162:163], v200 offset:17408
  v_add_f32 v215, v215, v213
  v_mfma_f32_16x16x32_bf16 v[24:27], a[168:171], a[92:95], v[24:27]
  v_mfma_f32_16x16x32_bf16 v[28:31], a[172:175], a[92:95], v[28:31]
  ds_read_b64_tr_b16 a[164:165], v201 offset:16384
  ds_read_b64_tr_b16 a[166:167], v201 offset:17408
  s_add_u32 m0, s41, 49152
  s_nop 0
  buffer_load_dwordx4 v240, s[8:11], s32 offen offset:0 nt lds
  v_add_f32 v215, v215, v208
  v_mfma_f32_16x16x32_bf16 v[20:23], a[172:175], a[88:91], v[20:23]
  s_waitcnt lgkmcnt(8)
  v_mfma_f32_16x16x32_bf16 v[32:35], a[176:179], a[88:91], v[32:35]
  ds_read_b64_tr_b16 a[168:169], v202 offset:16384
  ds_read_b64_tr_b16 a[170:171], v202 offset:17408
  v_cvt_pk_bf16_f32 v143, v208, v209
  v_add_f32 v215, v215, v209
  v_add_f32 v210, v214, v215
  v_mfma_f32_16x16x32_bf16 v[40:43], a[176:179], a[92:95], v[40:43]
  v_mfma_f32_16x16x32_bf16 v[44:47], a[180:183], a[92:95], v[44:47]
  ds_read_b64_tr_b16 a[172:173], v203 offset:16384
  ds_read_b64_tr_b16 a[174:175], v203 offset:17408
  v_cmp_lt_f32 vcc, s35, v210
  v_mfma_f32_16x16x32_bf16 v[36:39], a[180:183], a[88:91], v[36:39]
  s_waitcnt lgkmcnt(8)
  v_mfma_f32_16x16x32_bf16 v[48:51], a[184:187], a[88:91], v[48:51]
  ds_read_b64_tr_b16 a[176:177], v204 offset:16384
  ds_read_b64_tr_b16 a[178:179], v204 offset:17408
  buffer_load_dwordx4 v241, s[8:11], s32 offen offset:1024 nt lds
  v_mfma_f32_16x16x32_bf16 v[56:59], a[184:187], a[92:95], v[56:59]
  v_mfma_f32_16x16x32_bf16 v[60:63], a[188:191], a[92:95], v[60:63]
  ds_read_b64_tr_b16 a[180:181], v205 offset:16384
  ds_read_b64_tr_b16 a[182:183], v205 offset:17408
  v_mfma_f32_16x16x32_bf16 v[52:55], a[188:191], a[88:91], v[52:55]
  s_cbranch_vccnz SITE74
BACK74:
  s_waitcnt lgkmcnt(8)
  v_mfma_f32_16x16x32_bf16 a[192:195], a[160:163], v[128:131], a[192:195]
  ds_read_b64_tr_b16 a[184:185], v206 offset:16384
  ds_read_b64_tr_b16 a[186:187], v206 offset:17408
  v_add_f32 v249, v249, v214
  v_add_f32 v254, v254, v215
  v_exp_f32 v208, v96
  v_exp_f32 v209, v97
  v_mfma_f32_16x16x32_bf16 a[200:203], a[160:163], v[132:135], a[200:203]
  v_mfma_f32_16x16x32_bf16 a[204:207], a[164:167], v[132:135], a[204:207]
  ds_read_b64_tr_b16 a[188:189], v207 offset:16384
  ds_read_b64_tr_b16 a[190:191], v207 offset:17408
  buffer_load_dwordx4 v242, s[8:11], s32 offen offset:2048 nt lds
  v_mfma_f32_16x16x32_bf16 a[196:199], a[164:167], v[128:131], a[196:199]
  s_waitcnt lgkmcnt(8)
  v_mfma_f32_16x16x32_bf16 a[208:211], a[168:171], v[128:131], a[208:211]
  ds_read_b64_tr_b16 a[160:161], v200 offset:24576
  ds_read_b64_tr_b16 a[162:163], v200 offset:25600
  v_exp_f32 v210, v98
  v_cvt_pk_bf16_f32 v144, v208, v209
  v_mfma_f32_16x16x32_bf16 a[216:219], a[168:171], v[132:135], a[216:219]
  v_mfma_f32_16x16x32_bf16 a[220:223], a[172:175], v[132:135], a[220:223]
  ds_read_b64_tr_b16 a[164:165], v201 offset:24576
  ds_read_b64_tr_b16 a[166:167], v201 offset:25600
  v_exp_f32 v211, v99
  v_add_f32 v214, v208, v209
  v_mfma_f32_16x16x32_bf16 a[212:215], a[172:175], v[128:131], a[212:215]
  s_waitcnt lgkmcnt(8)
  v_mfma_f32_16x16x32_bf16 a[224:227], a[176:179], v[128:131], a[224:227]
  ds_read_b64_tr_b16 a[168:169], v202 offset:24576
  ds_read_b64_tr_b16 a[170:171], v202 offset:25600
  buffer_load_dwordx4 v243, s[8:11], s32 offen offset:3072 nt lds
  s_add_u32 s32, s32, 0x4000
  v_exp_f32 v212, v100
  v_mfma_f32_16x16x32_bf16 a[232:235], a[176:179], v[132:135], a[232:235]
  v_mfma_f32_16x16x32_bf16 a[236:239], a[180:183], v[132:135], a[236:239]
  ds_read_b64_tr_b16 a[172:173], v203 offset:24576
  ds_read_b64_tr_b16 a[174:175], v203 offset:25600
  v_add_f32 v214, v214, v210
  v_cvt_pk_bf16_f32 v145, v210, v211
  v_mfma_f32_16x16x32_bf16 a[228:231], a[180:183], v[128:131], a[228:231]
  s_waitcnt lgkmcnt(8)
  v_mfma_f32_16x16x32_bf16 a[240:243], a[184:187], v[128:131], a[240:243]
  ds_read_b64_tr_b16 a[176:177], v204 offset:24576
  ds_read_b64_tr_b16 a[178:179], v204 offset:25600
  v_exp_f32 v213, v101
  v_add_f32 v214, v214, v211
  v_mfma_f32_16x16x32_bf16 a[248:251], a[184:187], v[132:135], a[248:251]
  v_mfma_f32_16x16x32_bf16 a[252:255], a[188:191], v[132:135], a[252:255]
  ds_read_b64_tr_b16 a[180:181], v205 offset:24576
  ds_read_b64_tr_b16 a[182:183], v205 offset:25600
  v_exp_f32 v208, v102
  v_add_f32 v214, v214, v212
  v_cvt_pk_bf16_f32 v146, v212, v213
  v_mfma_f32_16x16x32_bf16 a[244:247], a[188:191], v[128:131], a[244:247]
  s_waitcnt lgkmcnt(8)
  v_mfma_f32_16x16x32_bf16 a[192:195], a[160:163], v[136:139], a[192:195]
  ds_read_b64_tr_b16 a[184:185], v206 offset:24576
  ds_read_b64_tr_b16 a[186:187], v206 offset:25600
  v_exp_f32 v209, v103
  v_add_f32 v214, v214, v213
  v_mfma_f32_16x16x32_bf16 a[200:203], a[160:163], v[140:143], a[200:203]
  v_mfma_f32_16x16x32_bf16 a[204:207], a[164:167], v[140:143], a[204:207]
  ds_read_b64_tr_b16 a[188:189], v207 offset:24576
  ds_read_b64_tr_b16 a[190:191], v207 offset:25600
  v_exp_f32 v210, v104
  v_add_f32 v214, v214, v208
  v_mfma_f32_16x16x32_bf16 a[196:199], a[164:167], v[136:139], a[196:199]
  s_waitcnt lgkmcnt(8)
  v_mfma_f32_16x16x32_bf16 a[208:211], a[168:171], v[136:139], a[208:211]
  s_barrier
  ds_read_b128 a[160:163], v224 offset:0
  v_cvt_pk_bf16_f32 v147, v208, v209
  v_exp_f32 v211, v105
  v_add_f32 v214, v214, v209
  v_mfma_f32_16x16x32_bf16 a[216:219], a[168:171], v[140:143], a[216:219]
  v_mfma_f32_16x16x32_bf16 a[220:223], a[172:175], v[140:143], a[220:223]
  ds_read_b128 a[164:167], v224 offset:4096
  s_add_u32 m0, s41, 131072
  s_nop 0
  buffer_load_dwordx4 v248, s[12:15], s33 offen offset:0 nt lds
  v_mfma_f32_16x16x32_bf16 a[212:215], a[172:175], v[136:139], a[212:215]
  s_waitcnt lgkmcnt(6)
  v_mfma_f32_16x16x32_bf16 a[224:227], a[176:179], v[136:139], a[224:227]
  ds_read_b128 a[168:171], v225 offset:0
  v_exp_f32 v212, v106
  v_cvt_pk_bf16_f32 v148, v210, v211
  v_exp_f32 v213, v107
  v_mfma_f32_16x16x32_bf16 a[232:235], a[176:179], v[140:143], a[232:235]
  v_mfma_f32_16x16x32_bf16 a[236:239], a[180:183], v[140:143], a[236:239]
  ds_read_b128 a[172:175], v225 offset:4096
  v_add_f32 v215, v210, v211
  v_exp_f32 v208, v108
  v_add_f32 v215, v215, v212
  v_mfma_f32_16x16x32_bf16 a[228:231], a[180:183], v[136:139], a[228:231]
  s_waitcnt lgkmcnt(4)
  v_mfma_f32_16x16x32_bf16 a[240:243], a[184:187], v[136:139], a[240:243]
  ds_read_b128 a[176:179], v226 offset:0
  buffer_load_dwordx4 v248, s[12:15], s33 offen offset:1024 nt lds
  v_cvt_pk_bf16_f32 v149, v212, v213
  v_mfma_f32_16x16x32_bf16 a[248:251], a[184:187], v[140:143], a[248:251]
  v_mfma_f32_16x16x32_bf16 a[252:255], a[188:191], v[140:143], a[252:255]
  ds_read_b128 a[180:183], v226 offset:4096
  v_exp_f32 v209, v109
  v_add_f32 v215, v215, v213
  v_mfma_f32_16x16x32_bf16 a[244:247], a[188:191], v[136:139], a[244:247]
  s_getpc_b64 s[48:49]
PC1:
  s_lshr_b32 s6, s2, 3
  s_and_b32 s6, s6, 1
  s_lshl_b32 s6, s6, 15
  s_add_u32 s6, s6, CST-PC1
  s_mov_b32 s7, CEND-PC1-4
  v_and_b32 v216, 0x3ff, v251
  v_mul_u32_u24 v216, 7, v216
  v_add3_u32 v216, v216, v251, s6
  v_min_u32 v216, s7, v216
  v_mov_b32 v219, s49
  v_add_co_u32 v218, s[6:7], s48, v216
  s_nop 1
  v_addc_co_u32 v219, s[6:7], 0, v219, s[6:7]
  global_load_dword v217, v[218:219], off
  s_waitcnt lgkmcnt(4)
  v_mfma_f32_16x16x32_bf16 v[64:67], a[160:163], v[160:163], v[192:195]
  ds_read_b128 a[184:187], v227 offset:0
  v_exp_f32 v210, v110
  v_add_f32 v215, v215, v208
  v_cvt_pk_bf16_f32 v150, v208, v209
  v_exp_f32 v211, v111
  v_mfma_f32_16x16x32_bf16 v[72:75], a[160:163], v[164:167], v[196:199]
  v_mfma_f32_16x16x32_bf16 v[76:79], a[164:167], v[164:167], v[196:199]
  ds_read_b128 a[188:191], v227 offset:4096
  buffer_load_dwordx4 v248, s[12:15], s33 offen offset:2048 nt lds
  v_mfma_f32_16x16x32_bf16 v[68:71], a[164:167], v[160:163], v[192:195]
  s_waitcnt lgkmcnt(4)
  v_mfma_f32_16x16x32_bf16 v[64:67], a[168:171], v[168:171], v[64:67]
  ds_read_b128 a[160:163], v224 offset:2048
  v_add_f32 v215, v215, v209
  v_exp_f32 v212, v112
  v_add_f32 v215, v215, v210
  v_mfma_f32_16x16x32_bf16 v[72:75], a[168:171], v[172:175], v[72:75]
  v_mfma_f32_16x16x32_bf16 v[76:79], a[172:175], v[172:175], v[76:79]
  ds_read_b128 a[164:167], v224 offset:6144
  v_cvt_pk_bf16_f32 v151, v210, v211
  v_exp_f32 v213, v113
  v_add_f32 v215, v215, v211
  v_mfma_f32_16x16x32_bf16 v[68:71], a[172:175], v[168:171], v[68:71]
  s_waitcnt lgkmcnt(4)
  v_mfma_f32_16x16x32_bf16 v[64:67], a[176:179], v[176:179], v[64:67]
  ds_read_b128 a[168:171], v225 offset:2048
  buffer_load_dwordx4 v248, s[12:15], s33 offen offset:3072 nt lds
  s_add_u32 s33, s33, 0x4000
  v_exp_f32 v208, v114
  v_mfma_f32_16x16x32_bf16 v[72:75], a[176:179], v[180:183], v[72:75]
  v_mfma_f32_16x16x32_bf16 v[76:79], a[180:183], v[180:183], v[76:79]
  ds_read_b128 a[172:175], v225 offset:6144
  v_add_f32 v214, v214, v212
  v_cvt_pk_bf16_f32 v152, v212, v213
  v_exp_f32 v209, v115
  v_mfma_f32_16x16x32_bf16 v[68:71], a[180:183], v[176:179], v[68:71]
  s_waitcnt lgkmcnt(4)
  v_mfma_f32_16x16x32_bf16 v[64:67], a[184:187], v[184:187], v[64:67]
  ds_read_b128 a[176:179], v226 offset:2048
  v_add_f32 v214, v214, v213
  v_exp_f32 v210, v116
  v_add_f32 v214, v214, v208
  v_mfma_f32_16x16x32_bf16 v[72:75], a[184:187], v[188:191], v[72:75]
  v_mfma_f32_16x16x32_bf16 v[76:79], a[188:191], v[188:191], v[76:79]
  ds_read_b128 a[180:183], v226 offset:6144
  v_cvt_pk_bf16_f32 v153, v208, v209
  v_exp_f32 v211, v117
  v_add_f32 v214, v214, v209
  v_mfma_f32_16x16x32_bf16 v[68:71], a[188:191], v[184:187], v[68:71]
  s_waitcnt lgkmcnt(4)
  v_mfma_f32_16x16x32_bf16 v[80:83], a[160:163], v[160:163], v[192:195]
  ds_read_b128 a[184:187], v227 offset:2048
  v_exp_f32 v212, v118
  v_add_f32 v214, v214, v210
  v_cvt_pk_bf16_f32 v154, v210, v211
  v_mfma_f32_16x16x32_bf16 v[88:91], a[160:163], v[164:167], v[196:199]
  v_mfma_f32_16x16x32_bf16 v[92:95], a[164:167], v[164:167], v[196:199]
  ds_read_b128 a[188:191], v227 offset:6144
  v_exp_f32 v213, v119
  v_add_f32 v214, v214, v211
  v_exp_f32 v208, v120
  v_mfma_f32_16x16x32_bf16 v[84:87], a[164:167], v[160:163], v[192:195]
  s_waitcnt lgkmcnt(4)
  v_mfma_f32_16x16x32_bf16 v[80:83], a[168:171], v[168:171], v[80:83]
  s_waitcnt vmcnt(29)
  s_barrier
  ds_read_b64_tr_b16 a[160:161], v232 offset:16384
  ds_read_b64_tr_b16 a[162:163], v232 offset:17408
  v_add_f32 v214, v214, v212
  v_mfma_f32_16x16x32_bf16 v[88:91], a[168:171], v[172:175], v[88:91]
  v_mfma_f32_16x16x32_bf16 v[92:95], a[172:175], v[172:175], v[92:95]
  ds_read_b64_tr_b16 a[164:165], v233 offset:16384
  ds_read_b64_tr_b16 a[166:167], v233 offset:17408
  s_add_u32 m0, s41, 147456
  s_nop 0
  buffer_load_dwordx4 v244, s[16:19], s34 offen offset:0 lds
  v_mfma_f32_16x16x32_bf16 v[84:87], a[172:175], v[168:171], v[84:87]
  s_waitcnt lgkmcnt(6)
  v_mfma_f32_16x16x32_bf16 v[80:83], a[176:179], v[176:179], v[80:83]
  ds_read_b64_tr_b16 a[168:169], v234 offset:16384
  ds_read_b64_tr_b16 a[170:171], v234 offset:17408
  v_cvt_pk_bf16_f32 v155, v212, v213
  v_exp_f32 v209, v121
  v_add_f32 v214, v214, v213
  v_mfma_f32_16x16x32_bf16 v[88:91], a[176:179], v[180:183], v[88:91]
  v_mfma_f32_16x16x32_bf16 v[92:95], a[180:183], v[180:183], v[92:95]
  ds_read_b64_tr_b16 a[172:173], v235 offset:16384
  ds_read_b64_tr_b16 a[174:175], v235 offset:17408
  v_exp_f32 v210, v122
  v_add_f32 v215, v215, v208
  v_mfma_f32_16x16x32_bf16 v[84:87], a[180:183], v[176:179], v[84:87]
  s_waitcnt lgkmcnt(8)
  v_mfma_f32_16x16x32_bf16 v[80:83], a[184:187], v[184:187], v[80:83]
  ds_read_b64_tr_b16 a[176:177], v236 offset:16384
  ds_read_b64_tr_b16 a[178:179], v236 offset:17408
  buffer_load_dwordx4 v245, s[16:19], s34 offen offset:1024 lds
  v_cvt_pk_bf16_f32 v156, v208, v209
  v_mfma_f32_16x16x32_bf16 v[88:91], a[184:187], v[188:191], v[88:91]
  v_mfma_f32_16x16x32_bf16 v[92:95], a[188:191], v[188:191], v[92:95]
  ds_read_b64_tr_b16 a[180:181], v237 offset:16384
  ds_read_b64_tr_b16 a[182:183], v237 offset:17408
  v_exp_f32 v211, v123
  v_add_f32 v215, v215, v209
  v_mfma_f32_16x16x32_bf16 v[84:87], a[188:191], v[184:187], v[84:87]
  s_waitcnt lgkmcnt(8)
  v_mfma_f32_16x16x32_bf16 v[0:3], a[160:163], a[96:99], v[0:3]
  ds_read_b64_tr_b16 a[184:185], v238 offset:16384
  ds_read_b64_tr_b16 a[186:187], v238 offset:17408
  v_exp_f32 v212, v124
  v_add_f32 v215, v215, v210
  v_mfma_f32_16x16x32_bf16 v[8:11], a[160:163], a[100:103], v[8:11]
  v_mfma_f32_16x16x32_bf16 v[12:15], a[164:167], a[100:103], v[12:15]
  ds_read_b64_tr_b16 a[188:189], v239 offset:16384
  ds_read_b64_tr_b16 a[190:191], v239 offset:17408
  buffer_load_dwordx4 v246, s[16:19], s34 offen offset:2048 lds
  v_cvt_pk_bf16_f32 v157, v210, v211
  v_mfma_f32_16x16x32_bf16 v[4:7], a[164:167], a[96:99], v[4:7]
  s_waitcnt lgkmcnt(8)
  v_mfma_f32_16x16x32_bf16 v[16:19], a[168:171], a[96:99], v[16:19]
  ds_read_b64_tr_b16 a[160:161], v232 offset:24576
  ds_read_b64_tr_b16 a[162:163], v232 offset:25600
  v_exp_f32 v213, v125
  v_add_f32 v215, v215, v211
  v_mfma_f32_16x16x32_bf16 v[24:27], a[168:171], a[100:103], v[24:27]
  v_mfma_f32_16x16x32_bf16 v[28:31], a[172:175], a[100:103], v[28:31]
  ds_read_b64_tr_b16 a[164:165], v233 offset:24576
  ds_read_b64_tr_b16 a[166:167], v233 offset:25600
  v_exp_f32 v208, v126
  v_add_f32 v215, v215, v212
  v_mfma_f32_16x16x32_bf16 v[20:23], a[172:175], a[96:99], v[20:23]
  s_waitcnt lgkmcnt(8)
  v_mfma_f32_16x16x32_bf16 v[32:35], a[176:179], a[96:99], v[32:35]
  ds_read_b64_tr_b16 a[168:169], v234 offset:24576
  ds_read_b64_tr_b16 a[170:171], v234 offset:25600
  buffer_load_dwordx4 v247, s[16:19], s34 offen offset:3072 lds
  s_add_u32 s34, s34, 524288
  s_sub_u32 s38, s34, 5242880
  s_min_u32 s34, s34, s38
  v_cvt_pk_bf16_f32 v158, v212, v213
  v_mfma_f32_16x16x32_bf16 v[40:43], a[176:179], a[100:103], v[40:43]
  v_mfma_f32_16x16x32_bf16 v[44:47], a[180:183], a[100:103], v[44:47]
  ds_read_b64_tr_b16 a[172:173], v235 offset:24576
  ds_read_b64_tr_b16 a[174:175], v235 offset:25600
  v_exp_f32 v209, v127
  v_add_f32 v215, v215, v213
  v_mfma_f32_16x16x32_bf16 v[36:39], a[180:183], a[96:99], v[36:39]
  s_waitcnt lgkmcnt(8)
  v_mfma_f32_16x16x32_bf16 v[48:51], a[184:187], a[96:99], v[48:51]
  ds_read_b64_tr_b16 a[176:177], v236 offset:24576
  ds_read_b64_tr_b16 a[178:179], v236 offset:25600
  v_add_f32 v215, v215, v208
  v_cvt_pk_bf16_f32 v159, v208, v209
  v_add_f32 v215, v215, v209
  v_add_f32 v210, v214, v215
  v_mfma_f32_16x16x32_bf16 v[56:59], a[184:187], a[100:103], v[56:59]
  v_mfma_f32_16x16x32_bf16 v[60:63], a[188:191], a[100:103], v[60:63]
  ds_read_b64_tr_b16 a[180:181], v237 offset:24576
  ds_read_b64_tr_b16 a[182:183], v237 offset:25600
  v_cmp_lt_f32 vcc, s35, v210
  v_mfma_f32_16x16x32_bf16 v[52:55], a[188:191], a[96:99], v[52:55]
  s_waitcnt lgkmcnt(8)
  v_mfma_f32_16x16x32_bf16 v[0:3], a[160:163], a[104:107], v[0:3]
  ds_read_b64_tr_b16 a[184:185], v238 offset:24576
  ds_read_b64_tr_b16 a[186:187], v238 offset:25600
  v_mfma_f32_16x16x32_bf16 v[8:11], a[160:163], a[108:111], v[8:11]
  v_mfma_f32_16x16x32_bf16 v[12:15], a[164:167], a[108:111], v[12:15]
  ds_read_b64_tr_b16 a[188:189], v239 offset:24576
  ds_read_b64_tr_b16 a[190:191], v239 offset:25600
  v_mfma_f32_16x16x32_bf16 v[4:7], a[164:167], a[104:107], v[4:7]
  s_waitcnt lgkmcnt(8)
  v_mfma_f32_16x16x32_bf16 v[16:19], a[168:171], a[104:107], v[16:19]
  s_waitcnt vmcnt(25)
  s_barrier
  ds_read_b64_tr_b16 a[160:161], v232 offset:32768
  ds_read_b64_tr_b16 a[162:163], v232 offset:33792
  v_mfma_f32_16x16x32_bf16 v[24:27], a[168:171], a[108:111], v[24:27]
  v_mfma_f32_16x16x32_bf16 v[28:31], a[172:175], a[108:111], v[28:31]
  ds_read_b64_tr_b16 a[164:165], v233 offset:32768
  ds_read_b64_tr_b16 a[166:167], v233 offset:33792
  s_add_u32 m0, s41, 0
  s_nop 0
  buffer_load_dwordx4 v240, s[8:11], s32 offen offset:0 nt lds
  v_mfma_f32_16x16x32_bf16 v[20:23], a[172:175], a[104:107], v[20:23]
  s_waitcnt lgkmcnt(8)
  v_mfma_f32_16x16x32_bf16 v[32:35], a[176:179], a[104:107], v[32:35]
  ds_read_b64_tr_b16 a[168:169], v234 offset:32768
  ds_read_b64_tr_b16 a[170:171], v234 offset:33792
  v_mfma_f32_16x16x32_bf16 v[40:43], a[176:179], a[108:111], v[40:43]
  v_mfma_f32_16x16x32_bf16 v[44:47], a[180:183], a[108:111], v[44:47]
  ds_read_b64_tr_b16 a[172:173], v235 offset:32768
  ds_read_b64_tr_b16 a[174:175], v235 offset:33792
  v_mfma_f32_16x16x32_bf16 v[36:39], a[180:183], a[104:107], v[36:39]
  s_waitcnt lgkmcnt(8)
  v_mfma_f32_16x16x32_bf16 v[48:51], a[184:187], a[104:107], v[48:51]
  ds_read_b64_tr_b16 a[176:177], v236 offset:32768
  ds_read_b64_tr_b16 a[178:179], v236 offset:33792
  buffer_load_dwordx4 v241, s[8:11], s32 offen offset:1024 nt lds
  v_mfma_f32_16x16x32_bf16 v[56:59], a[184:187], a[108:111], v[56:59]
  v_mfma_f32_16x16x32_bf16 v[60:63], a[188:191], a[108:111], v[60:63]
  ds_read_b64_tr_b16 a[180:181], v237 offset:32768
  ds_read_b64_tr_b16 a[182:183], v237 offset:33792
  v_mfma_f32_16x16x32_bf16 v[52:55], a[188:191], a[104:107], v[52:55]
  s_cbranch_vccnz SITE77
BACK77:
  s_waitcnt lgkmcnt(8)
  v_mfma_f32_16x16x32_bf16 a[192:195], a[160:163], v[144:147], a[192:195]
  ds_read_b64_tr_b16 a[184:185], v238 offset:32768
  ds_read_b64_tr_b16 a[186:187], v238 offset:33792
  v_add_f32 v249, v249, v214
  v_add_f32 v254, v254, v215
  v_exp_f32 v208, v64
  v_exp_f32 v209, v65
  v_mfma_f32_16x16x32_bf16 a[200:203], a[160:163], v[148:151], a[200:203]
  v_mfma_f32_16x16x32_bf16 a[204:207], a[164:167], v[148:151], a[204:207]
  ds_read_b64_tr_b16 a[188:189], v239 offset:32768
  ds_read_b64_tr_b16 a[190:191], v239 offset:33792
  buffer_load_dwordx4 v242, s[8:11], s32 offen offset:2048 nt lds
  v_mfma_f32_16x16x32_bf16 a[196:199], a[164:167], v[144:147], a[196:199]
  s_waitcnt lgkmcnt(8)
  v_mfma_f32_16x16x32_bf16 a[208:211], a[168:171], v[144:147], a[208:211]
  ds_read_b64_tr_b16 a[160:161], v232 offset:40960
  ds_read_b64_tr_b16 a[162:163], v232 offset:41984
  v_exp_f32 v210, v66
  v_cvt_pk_bf16_f32 v128, v208, v209
  v_exp_f32 v211, v67
  v_mfma_f32_16x16x32_bf16 a[216:219], a[168:171], v[148:151], a[216:219]
  v_mfma_f32_16x16x32_bf16 a[220:223], a[172:175], v[148:151], a[220:223]
  ds_read_b64_tr_b16 a[164:165], v233 offset:40960
  ds_read_b64_tr_b16 a[166:167], v233 offset:41984
  v_add_f32 v214, v208, v209
  v_exp_f32 v212, v68
  v_add_f32 v214, v214, v210
  v_mfma_f32_16x16x32_bf16 a[212:215], a[172:175], v[144:147], a[212:215]
  s_waitcnt lgkmcnt(8)
  v_mfma_f32_16x16x32_bf16 a[224:227], a[176:179], v[144:147], a[224:227]
  ds_read_b64_tr_b16 a[168:169], v234 offset:40960
  ds_read_b64_tr_b16 a[170:171], v234 offset:41984
  buffer_load_dwordx4 v243, s[8:11], s32 offen offset:3072 nt lds
  s_add_u32 s32, s32, 0x4000
  v_cvt_pk_bf16_f32 v129, v210, v211
  v_mfma_f32_16x16x32_bf16 a[232:235], a[176:179], v[148:151], a[232:235]
  v_mfma_f32_16x16x32_bf16 a[236:239], a[180:183], v[148:151], a[236:239]
  ds_read_b64_tr_b16 a[172:173], v235 offset:40960
  ds_read_b64_tr_b16 a[174:175], v235 offset:41984
  v_exp_f32 v213, v69
  v_add_f32 v214, v214, v211
  v_mfma_f32_16x16x32_bf16 a[228:231], a[180:183], v[144:147], a[228:231]
  s_waitcnt lgkmcnt(8)
  v_mfma_f32_16x16x32_bf16 a[240:243], a[184:187], v[144:147], a[240:243]
  ds_read_b64_tr_b16 a[176:177], v236 offset:40960
  ds_read_b64_tr_b16 a[178:179], v236 offset:41984
  v_exp_f32 v208, v70
  v_add_f32 v214, v214, v212
  v_cvt_pk_bf16_f32 v130, v212, v213
  v_mfma_f32_16x16x32_bf16 a[248:251], a[184:187], v[148:151], a[248:251]
  v_mfma_f32_16x16x32_bf16 a[252:255], a[188:191], v[148:151], a[252:255]
  ds_read_b64_tr_b16 a[180:181], v237 offset:40960
  ds_read_b64_tr_b16 a[182:183], v237 offset:41984
  v_exp_f32 v209, v71
  v_add_f32 v214, v214, v213
  v_exp_f32 v210, v72
  v_mfma_f32_16x16x32_bf16 a[244:247], a[188:191], v[144:147], a[244:247]
  s_waitcnt lgkmcnt(8)
  v_mfma_f32_16x16x32_bf16 a[192:195], a[160:163], v[152:155], a[192:195]
  ds_read_b64_tr_b16 a[184:185], v238 offset:40960
  ds_read_b64_tr_b16 a[186:187], v238 offset:41984
  v_add_f32 v214, v214, v208
  v_cvt_pk_bf16_f32 v131, v208, v209
  v_exp_f32 v211, v73
  v_mfma_f32_16x16x32_bf16 a[200:203], a[160:163], v[156:159], a[200:203]
  v_mfma_f32_16x16x32_bf16 a[204:207], a[164:167], v[156:159], a[204:207]
  ds_read_b64_tr_b16 a[188:189], v239 offset:40960
  ds_read_b64_tr_b16 a[190:191], v239 offset:41984
  v_add_f32 v214, v214, v209
  v_exp_f32 v212, v74
  v_mfma_f32_16x16x32_bf16 a[196:199], a[164:167], v[152:155], a[196:199]
  s_waitcnt lgkmcnt(8)
  v_mfma_f32_16x16x32_bf16 a[208:211], a[168:171], v[152:155], a[208:211]
  s_barrier
  ds_read_b128 a[160:163], v224 offset:16384
  v_cvt_pk_bf16_f32 v132, v210, v211
  v_exp_f32 v213, v75
  v_add_f32 v215, v210, v211
  v_mfma_f32_16x16x32_bf16 a[216:219], a[168:171], v[156:159], a[216:219]
  v_mfma_f32_16x16x32_bf16 a[220:223], a[172:175], v[156:159], a[220:223]
  ds_read_b128 a[164:167], v224 offset:20480
  s_add_u32 m0, s41, 81920
  s_nop 0
  buffer_load_dwordx4 v244, s[16:19], s34 offen offset:0 lds
  v_exp_f32 v208, v76
  v_mfma_f32_16x16x32_bf16 a[212:215], a[172:175], v[152:155], a[212:215]
  s_waitcnt lgkmcnt(6)
  v_mfma_f32_16x16x32_bf16 a[224:227], a[176:179], v[152:155], a[224:227]
  ds_read_b128 a[168:171], v225 offset:16384
  v_add_f32 v215, v215, v212
  v_cvt_pk_bf16_f32 v133, v212, v213
  v_exp_f32 v209, v77
  v_mfma_f32_16x16x32_bf16 a[232:235], a[176:179], v[156:159], a[232:235]
  v_mfma_f32_16x16x32_bf16 a[236:239], a[180:183], v[156:159], a[236:239]
  ds_read_b128 a[172:175], v225 offset:20480
  v_add_f32 v215, v215, v213
  v_exp_f32 v210, v78
  v_add_f32 v215, v215, v208
  v_cvt_pk_bf16_f32 v134, v208, v209
  v_mfma_f32_16x16x32_bf16 a[228:231], a[180:183], v[152:155], a[228:231]
  s_waitcnt lgkmcnt(4)
  v_mfma_f32_16x16x32_bf16 a[240:243], a[184:187], v[152:155], a[240:243]
  ds_read_b128 a[176:179], v226 offset:16384
  buffer_load_dwordx4 v245, s[16:19], s34 offen offset:1024 lds
  v_exp_f32 v211, v79
  v_mfma_f32_16x16x32_bf16 a[248:251], a[184:187], v[156:159], a[248:251]
  v_mfma_f32_16x16x32_bf16 a[252:255], a[188:191], v[156:159], a[252:255]
  ds_read_b128 a[180:183], v226 offset:20480
  v_add_f32 v215, v215, v209
  v_exp_f32 v212, v80
  v_add_f32 v215, v215, v210
  v_mfma_f32_16x16x32_bf16 a[244:247], a[188:191], v[152:155], a[244:247]
  s_waitcnt lgkmcnt(4)
  v_mfma_f32_16x16x32_bf16 v[96:99], a[160:163], v[160:163], v[192:195]
  ds_read_b128 a[184:187], v227 offset:16384
  v_cvt_pk_bf16_f32 v135, v210, v211
  v_exp_f32 v213, v81
  v_add_f32 v215, v215, v211
  v_exp_f32 v208, v82
  v_mfma_f32_16x16x32_bf16 v[104:107], a[160:163], v[164:167], v[196:199]
  v_mfma_f32_16x16x32_bf16 v[108:111], a[164:167], v[164:167], v[196:199]
  ds_read_b128 a[188:191], v227 offset:20480
  buffer_load_dwordx4 v246, s[16:19], s34 offen offset:2048 lds
  v_add_f32 v214, v214, v212
  v_mfma_f32_16x16x32_bf16 v[100:103], a[164:167], v[160:163], v[192:195]
  s_waitcnt lgkmcnt(4)
  v_mfma_f32_16x16x32_bf16 v[96:99], a[168:171], v[168:171], v[96:99]
  ds_read_b128 a[160:163], v224 offset:18432
  v_cvt_pk_bf16_f32 v136, v212, v213
  v_exp_f32 v209, v83
  v_add_f32 v214, v214, v213
  v_mfma_f32_16x16x32_bf16 v[104:107], a[168:171], v[172:175], v[104:107]
  v_mfma_f32_16x16x32_bf16 v[108:111], a[172:175], v[172:175], v[108:111]
  ds_read_b128 a[164:167], v224 offset:22528
  v_exp_f32 v210, v84
  v_add_f32 v214, v214, v208
  v_cvt_pk_bf16_f32 v137, v208, v209
  v_exp_f32 v211, v85
  v_mfma_f32_16x16x32_bf16 v[100:103], a[172:175], v[168:171], v[100:103]
  s_waitcnt lgkmcnt(4)
  v_mfma_f32_16x16x32_bf16 v[96:99], a[176:179], v[176:179], v[96:99]
  ds_read_b128 a[168:171], v225 offset:18432
  buffer_load_dwordx4 v247, s[16:19], s34 offen offset:3072 lds
  s_add_u32 s34, s34, 524544
  s_sub_u32 s38, s34, 5242880
  s_min_u32 s34, s34, s38
  v_add_f32 v214, v214, v209
  v_mfma_f32_16x16x32_bf16 v[104:107], a[176:179], v[180:183], v[104:107]
  v_mfma_f32_16x16x32_bf16 v[108:111], a[180:183], v[180:183], v[108:111]
  ds_read_b128 a[172:175], v225 offset:22528
  v_exp_f32 v212, v86
  v_add_f32 v214, v214, v210
  v_cvt_pk_bf16_f32 v138, v210, v211
  v_mfma_f32_16x16x32_bf16 v[100:103], a[180:183], v[176:179], v[100:103]
  s_waitcnt lgkmcnt(4)
  v_mfma_f32_16x16x32_bf16 v[96:99], a[184:187], v[184:187], v[96:99]
  ds_read_b128 a[176:179], v226 offset:18432
  v_exp_f32 v213, v87
  v_add_f32 v214, v214, v211
  v_exp_f32 v208, v88
  v_mfma_f32_16x16x32_bf16 v[104:107], a[184:187], v[188:191], v[104:107]
  v_mfma_f32_16x16x32_bf16 v[108:111], a[188:191], v[188:191], v[108:111]
  ds_read_b128 a[180:183], v226 offset:22528
  v_add_f32 v214, v214, v212
  v_cvt_pk_bf16_f32 v139, v212, v213
  v_exp_f32 v209, v89
  v_add_f32 v214, v214, v213
  v_mfma_f32_16x16x32_bf16 v[100:103], a[188:191], v[184:187], v[100:103]
  s_waitcnt lgkmcnt(4)
  v_mfma_f32_16x16x32_bf16 v[112:115], a[160:163], v[160:163], v[192:195]
  ds_read_b128 a[184:187], v227 offset:18432
  v_exp_f32 v210, v90
  v_add_f32 v215, v215, v208
  v_cvt_pk_bf16_f32 v140, v208, v209
  v_exp_f32 v211, v91
  v_mfma_f32_16x16x32_bf16 v[120:123], a[160:163], v[164:167], v[196:199]
  v_mfma_f32_16x16x32_bf16 v[124:127], a[164:167], v[164:167], v[196:199]
  ds_read_b128 a[188:191], v227 offset:22528
  v_add_f32 v215, v215, v209
  v_exp_f32 v212, v92
  v_add_f32 v215, v215, v210
  v_mfma_f32_16x16x32_bf16 v[116:119], a[164:167], v[160:163], v[192:195]
  s_waitcnt lgkmcnt(4)
  v_mfma_f32_16x16x32_bf16 v[112:115], a[168:171], v[168:171], v[112:115]
  s_waitcnt vmcnt(25)
  s_barrier
  ds_read_b64_tr_b16 a[160:161], v232 offset:49152
  ds_read_b64_tr_b16 a[162:163], v232 offset:50176
  v_cvt_pk_bf16_f32 v141, v210, v211
  v_mfma_f32_16x16x32_bf16 v[120:123], a[168:171], v[172:175], v[120:123]
  v_mfma_f32_16x16x32_bf16 v[124:127], a[172:175], v[172:175], v[124:127]
  ds_read_b64_tr_b16 a[164:165], v233 offset:49152
  ds_read_b64_tr_b16 a[166:167], v233 offset:50176
  s_add_u32 m0, s41, 98304
  s_nop 0
  buffer_load_dwordx4 v248, s[12:15], s33 offen offset:0 nt lds
  v_exp_f32 v213, v93
  v_mfma_f32_16x16x32_bf16 v[116:119], a[172:175], v[168:171], v[116:119]
  s_waitcnt lgkmcnt(6)
  v_mfma_f32_16x16x32_bf16 v[112:115], a[176:179], v[176:179], v[112:115]
  ds_read_b64_tr_b16 a[168:169], v234 offset:49152
  ds_read_b64_tr_b16 a[170:171], v234 offset:50176
  v_add_f32 v215, v215, v211
  v_exp_f32 v208, v94
  v_add_f32 v215, v215, v212
  v_mfma_f32_16x16x32_bf16 v[120:123], a[176:179], v[180:183], v[120:123]
  v_mfma_f32_16x16x32_bf16 v[124:127], a[180:183], v[180:183], v[124:127]
  ds_read_b64_tr_b16 a[172:173], v235 offset:49152
  ds_read_b64_tr_b16 a[174:175], v235 offset:50176
  v_cvt_pk_bf16_f32 v142, v212, v213
  v_exp_f32 v209, v95
  v_add_f32 v215, v215, v213
  v_mfma_f32_16x16x32_bf16 v[116:119], a[180:183], v[176:179], v[116:119]
  s_waitcnt lgkmcnt(8)
  v_mfma_f32_16x16x32_bf16 v[112:115], a[184:187], v[184:187], v[112:115]
  ds_read_b64_tr_b16 a[176:177], v236 offset:49152
  ds_read_b64_tr_b16 a[178:179], v236 offset:50176
  buffer_load_dwordx4 v248, s[12:15], s33 offen offset:1024 nt lds
  v_add_f32 v215, v215, v208
  v_mfma_f32_16x16x32_bf16 v[120:123], a[184:187], v[188:191], v[120:123]
  v_mfma_f32_16x16x32_bf16 v[124:127], a[188:191], v[188:191], v[124:127]
  ds_read_b64_tr_b16 a[180:181], v237 offset:49152
  ds_read_b64_tr_b16 a[182:183], v237 offset:50176
  v_cvt_pk_bf16_f32 v143, v208, v209
  v_add_f32 v215, v215, v209
  v_add_f32 v210, v214, v215
  v_cmp_lt_f32 vcc, s35, v210
  v_mfma_f32_16x16x32_bf16 v[116:119], a[188:191], v[184:187], v[116:119]
  s_cbranch_vccnz SITE79
BACK79:
  s_waitcnt lgkmcnt(8)
  v_mfma_f32_16x16x32_bf16 a[192:195], a[160:163], v[128:131], a[192:195]
  ds_read_b64_tr_b16 a[184:185], v238 offset:49152
  ds_read_b64_tr_b16 a[186:187], v238 offset:50176
  v_mfma_f32_16x16x32_bf16 a[200:203], a[160:163], v[132:135], a[200:203]
  v_mfma_f32_16x16x32_bf16 a[204:207], a[164:167], v[132:135], a[204:207]
  ds_read_b64_tr_b16 a[188:189], v239 offset:49152
  ds_read_b64_tr_b16 a[190:191], v239 offset:50176
  buffer_load_dwordx4 v248, s[12:15], s33 offen offset:2048 nt lds
  v_mfma_f32_16x16x32_bf16 a[196:199], a[164:167], v[128:131], a[196:199]
  s_waitcnt lgkmcnt(8)
  v_mfma_f32_16x16x32_bf16 a[208:211], a[168:171], v[128:131], a[208:211]
  ds_read_b64_tr_b16 a[160:161], v232 offset:57344
  ds_read_b64_tr_b16 a[162:163], v232 offset:58368
  v_add_f32 v249, v249, v214
  v_add_f32 v254, v254, v215
  v_exp_f32 v208, v96
  v_exp_f32 v209, v97
  v_mfma_f32_16x16x32_bf16 a[216:219], a[168:171], v[132:135], a[216:219]
  v_mfma_f32_16x16x32_bf16 a[220:223], a[172:175], v[132:135], a[220:223]
  ds_read_b64_tr_b16 a[164:165], v233 offset:57344
  ds_read_b64_tr_b16 a[166:167], v233 offset:58368
  v_exp_f32 v210, v98
  v_mfma_f32_16x16x32_bf16 a[212:215], a[172:175], v[128:131], a[212:215]
  s_waitcnt lgkmcnt(8)
  v_mfma_f32_16x16x32_bf16 a[224:227], a[176:179], v[128:131], a[224:227]
  ds_read_b64_tr_b16 a[168:169], v234 offset:57344
  ds_read_b64_tr_b16 a[170:171], v234 offset:58368
  buffer_load_dwordx4 v248, s[12:15], s33 offen offset:3072 nt lds
  s_add_u32 s33, s33, 0x4000
  v_cvt_pk_bf16_f32 v144, v208, v209
  v_mfma_f32_16x16x32_bf16 a[232:235], a[176:179], v[132:135], a[232:235]
  v_mfma_f32_16x16x32_bf16 a[236:239], a[180:183], v[132:135], a[236:239]
  ds_read_b64_tr_b16 a[172:173], v235 offset:57344
  ds_read_b64_tr_b16 a[174:175], v235 offset:58368
  v_exp_f32 v211, v99
  v_add_f32 v214, v208, v209
  v_mfma_f32_16x16x32_bf16 a[228:231], a[180:183], v[128:131], a[228:231]
  s_waitcnt lgkmcnt(8)
  v_mfma_f32_16x16x32_bf16 a[240:243], a[184:187], v[128:131], a[240:243]
  ds_read_b64_tr_b16 a[176:177], v236 offset:57344
  ds_read_b64_tr_b16 a[178:179], v236 offset:58368
  v_exp_f32 v212, v100
  v_add_f32 v214, v214, v210
  v_cvt_pk_bf16_f32 v145, v210, v211
  v_mfma_f32_16x16x32_bf16 a[248:251], a[184:187], v[132:135], a[248:251]
  v_mfma_f32_16x16x32_bf16 a[252:255], a[188:191], v[132:135], a[252:255]
  ds_read_b64_tr_b16 a[180:181], v237 offset:57344
  ds_read_b64_tr_b16 a[182:183], v237 offset:58368
  v_exp_f32 v213, v101
  v_add_f32 v214, v214, v211
  v_mfma_f32_16x16x32_bf16 a[244:247], a[188:191], v[128:131], a[244:247]
  s_waitcnt lgkmcnt(8)
  v_mfma_f32_16x16x32_bf16 a[192:195], a[160:163], v[136:139], a[192:195]
  ds_read_b64_tr_b16 a[184:185], v238 offset:57344
  ds_read_b64_tr_b16 a[186:187], v238 offset:58368
  v_exp_f32 v208, v102
  v_add_f32 v214, v214, v212
  v_mfma_f32_16x16x32_bf16 a[200:203], a[160:163], v[140:143], a[200:203]
  v_mfma_f32_16x16x32_bf16 a[204:207], a[164:167], v[140:143], a[204:207]
  ds_read_b64_tr_b16 a[188:189], v239 offset:57344
  ds_read_b64_tr_b16 a[190:191], v239 offset:58368
  v_cvt_pk_bf16_f32 v146, v212, v213
  v_exp_f32 v209, v103
  v_add_f32 v214, v214, v213
  v_mfma_f32_16x16x32_bf16 a[196:199], a[164:167], v[136:139], a[196:199]
  s_waitcnt lgkmcnt(8)
  v_mfma_f32_16x16x32_bf16 a[208:211], a[168:171], v[136:139], a[208:211]
  s_barrier
  ds_read_b128 a[160:163], v224 offset:32768
  v_exp_f32 v210, v104
  v_add_f32 v214, v214, v208
  v_mfma_f32_16x16x32_bf16 a[216:219], a[168:171], v[140:143], a[216:219]
  v_mfma_f32_16x16x32_bf16 a[220:223], a[172:175], v[140:143], a[220:223]
  ds_read_b128 a[164:167], v224 offset:36864
  s_add_u32 m0, s41, 16384
  s_nop 0
  buffer_load_dwordx4 v240, s[8:11], s32 offen offset:0 nt lds
  v_cvt_pk_bf16_f32 v147, v208, v209
  v_mfma_f32_16x16x32_bf16 a[212:215], a[172:175], v[136:139], a[212:215]
  s_waitcnt lgkmcnt(6)
  v_mfma_f32_16x16x32_bf16 a[224:227], a[176:179], v[136:139], a[224:227]
  ds_read_b128 a[168:171], v225 offset:32768
  v_exp_f32 v211, v105
  v_add_f32 v214, v214, v209
  v_exp_f32 v212, v106
  v_mfma_f32_16x16x32_bf16 a[232:235], a[176:179], v[140:143], a[232:235]
  v_mfma_f32_16x16x32_bf16 a[236:239], a[180:183], v[140:143], a[236:239]
  ds_read_b128 a[172:175], v225 offset:36864
  v_cvt_pk_bf16_f32 v148, v210, v211
  v_exp_f32 v213, v107
  v_mfma_f32_16x16x32_bf16 a[228:231], a[180:183], v[136:139], a[228:231]
  s_waitcnt lgkmcnt(4)
  v_mfma_f32_16x16x32_bf16 a[240:243], a[184:187], v[136:139], a[240:243]
  ds_read_b128 a[176:179], v226 offset:32768
  buffer_load_dwordx4 v241, s[8:11], s32 offen offset:1024 nt lds
  v_add_f32 v215, v210, v211
  v_mfma_f32_16x16x32_bf16 a[248:251], a[184:187], v[140:143], a[248:251]
  v_mfma_f32_16x16x32_bf16 a[252:255], a[188:191], v[140:143], a[252:255]
  ds_read_b128 a[180:183], v226 offset:36864
  v_exp_f32 v208, v108
  v_add_f32 v215, v215, v212
  v_cvt_pk_bf16_f32 v149, v212, v213
  v_mfma_f32_16x16x32_bf16 a[244:247], a[188:191], v[136:139], a[244:247]
  s_waitcnt lgkmcnt(4)
  v_mfma_f32_16x16x32_bf16 v[64:67], a[160:163], v[160:163], v[192:195]
  ds_read_b128 a[184:187], v227 offset:32768
  v_exp_f32 v209, v109
  v_add_f32 v215, v215, v213
  v_exp_f32 v210, v110
  v_mfma_f32_16x16x32_bf16 v[72:75], a[160:163], v[164:167], v[196:199]
  v_mfma_f32_16x16x32_bf16 v[76:79], a[164:167], v[164:167], v[196:199]
  ds_read_b128 a[188:191], v227 offset:36864
  buffer_load_dwordx4 v242, s[8:11], s32 offen offset:2048 nt lds
  v_add_f32 v215, v215, v208
  v_mfma_f32_16x16x32_bf16 v[68:71], a[164:167], v[160:163], v[192:195]
  s_waitcnt lgkmcnt(4)
  v_mfma_f32_16x16x32_bf16 v[64:67], a[168:171], v[168:171], v[64:67]
  ds_read_b128 a[160:163], v224 offset:34816
  v_cvt_pk_bf16_f32 v150, v208, v209
  v_exp_f32 v211, v111
  v_add_f32 v215, v215, v209
  v_mfma_f32_16x16x32_bf16 v[72:75], a[168:171], v[172:175], v[72:75]
  v_mfma_f32_16x16x32_bf16 v[76:79], a[172:175], v[172:175], v[76:79]
  ds_read_b128 a[164:167], v224 offset:38912
  v_exp_f32 v212, v112
  v_add_f32 v215, v215, v210
  v_cvt_pk_bf16_f32 v151, v210, v211
  v_mfma_f32_16x16x32_bf16 v[68:71], a[172:175], v[168:171], v[68:71]
  s_waitcnt lgkmcnt(4)
  v_mfma_f32_16x16x32_bf16 v[64:67], a[176:179], v[176:179], v[64:67]
  ds_read_b128 a[168:171], v225 offset:34816
  buffer_load_dwordx4 v243, s[8:11], s32 offen offset:3072 nt lds
  s_add_u32 s32, s32, 0x4000
  v_exp_f32 v213, v113
  v_mfma_f32_16x16x32_bf16 v[72:75], a[176:179], v[180:183], v[72:75]
  v_mfma_f32_16x16x32_bf16 v[76:79], a[180:183], v[180:183], v[76:79]
  ds_read_b128 a[172:175], v225 offset:38912
  v_add_f32 v215, v215, v211
  v_exp_f32 v208, v114
  v_mfma_f32_16x16x32_bf16 v[68:71], a[180:183], v[176:179], v[68:71]
  s_waitcnt lgkmcnt(4)
  v_mfma_f32_16x16x32_bf16 v[64:67], a[184:187], v[184:187], v[64:67]
  ds_read_b128 a[176:179], v226 offset:34816
  v_add_f32 v214, v214, v212
  v_cvt_pk_bf16_f32 v152, v212, v213
  v_exp_f32 v209, v115
  v_add_f32 v214, v214, v213
  v_mfma_f32_16x16x32_bf16 v[72:75], a[184:187], v[188:191], v[72:75]
  v_mfma_f32_16x16x32_bf16 v[76:79], a[188:191], v[188:191], v[76:79]
  ds_read_b128 a[180:183], v226 offset:38912
  v_exp_f32 v210, v116
  v_add_f32 v214, v214, v208
  v_cvt_pk_bf16_f32 v153, v208, v209
  v_mfma_f32_16x16x32_bf16 v[68:71], a[188:191], v[184:187], v[68:71]
  s_waitcnt lgkmcnt(4)
  v_mfma_f32_16x16x32_bf16 v[80:83], a[160:163], v[160:163], v[192:195]
  ds_read_b128 a[184:187], v227 offset:34816
  v_exp_f32 v211, v117
  v_add_f32 v214, v214, v209
  v_exp_f32 v212, v118
  v_mfma_f32_16x16x32_bf16 v[88:91], a[160:163], v[164:167], v[196:199]
  v_mfma_f32_16x16x32_bf16 v[92:95], a[164:167], v[164:167], v[196:199]
  ds_read_b128 a[188:191], v227 offset:38912
  v_add_f32 v214, v214, v210
  v_cvt_pk_bf16_f32 v154, v210, v211
  v_exp_f32 v213, v119
  v_mfma_f32_16x16x32_bf16 v[84:87], a[164:167], v[160:163], v[192:195]
  s_waitcnt lgkmcnt(4)
  v_mfma_f32_16x16x32_bf16 v[80:83], a[168:171], v[168:171], v[80:83]
  s_waitcnt vmcnt(29)
  s_barrier
  ds_read_b64_tr_b16 a[160:161], v232 offset:0
  ds_read_b64_tr_b16 a[162:163], v232 offset:1024
  v_add_f32 v214, v214, v211
  v_mfma_f32_16x16x32_bf16 v[88:91], a[168:171], v[172:175], v[88:91]
  v_mfma_f32_16x16x32_bf16 v[92:95], a[172:175], v[172:175], v[92:95]
  ds_read_b64_tr_b16 a[164:165], v233 offset:0
  ds_read_b64_tr_b16 a[166:167], v233 offset:1024
  s_add_u32 m0, s41, 114688
  s_nop 0
  buffer_load_dwordx4 v248, s[12:15], s33 offen offset:0 nt lds
  v_mfma_f32_16x16x32_bf16 v[84:87], a[172:175], v[168:171], v[84:87]
  s_waitcnt lgkmcnt(6)
  v_mfma_f32_16x16x32_bf16 v[80:83], a[176:179], v[176:179], v[80:83]
  ds_read_b64_tr_b16 a[168:169], v234 offset:0
  ds_read_b64_tr_b16 a[170:171], v234 offset:1024
  v_exp_f32 v208, v120
  v_add_f32 v214, v214, v212
  v_cvt_pk_bf16_f32 v155, v212, v213
  v_mfma_f32_16x16x32_bf16 v[88:91], a[176:179], v[180:183], v[88:91]
  v_mfma_f32_16x16x32_bf16 v[92:95], a[180:183], v[180:183], v[92:95]
  ds_read_b64_tr_b16 a[172:173], v235 offset:0
  ds_read_b64_tr_b16 a[174:175], v235 offset:1024
  v_exp_f32 v209, v121
  v_add_f32 v214, v214, v213
  v_mfma_f32_16x16x32_bf16 v[84:87], a[180:183], v[176:179], v[84:87]
  s_waitcnt lgkmcnt(8)
  v_mfma_f32_16x16x32_bf16 v[80:83], a[184:187], v[184:187], v[80:83]
  ds_read_b64_tr_b16 a[176:177], v236 offset:0
  ds_read_b64_tr_b16 a[178:179], v236 offset:1024
  buffer_load_dwordx4 v248, s[12:15], s33 offen offset:1024 nt lds
  v_exp_f32 v210, v122
  v_mfma_f32_16x16x32_bf16 v[88:91], a[184:187], v[188:191], v[88:91]
  v_mfma_f32_16x16x32_bf16 v[92:95], a[188:191], v[188:191], v[92:95]
  ds_read_b64_tr_b16 a[180:181], v237 offset:0
  ds_read_b64_tr_b16 a[182:183], v237 offset:1024
  v_add_f32 v215, v215, v208
  v_cvt_pk_bf16_f32 v156, v208, v209
  v_mfma_f32_16x16x32_bf16 v[84:87], a[188:191], v[184:187], v[84:87]
  s_waitcnt lgkmcnt(8)
  v_mfma_f32_16x16x32_bf16 v[0:3], a[160:163], a[112:115], v[0:3]
  ds_read_b64_tr_b16 a[184:185], v238 offset:0
  ds_read_b64_tr_b16 a[186:187], v238 offset:1024
  v_exp_f32 v211, v123
  v_add_f32 v215, v215, v209
  v_mfma_f32_16x16x32_bf16 v[8:11], a[160:163], a[116:119], v[8:11]
  v_mfma_f32_16x16x32_bf16 v[12:15], a[164:167], a[116:119], v[12:15]
  ds_read_b64_tr_b16 a[188:189], v239 offset:0
  ds_read_b64_tr_b16 a[190:191], v239 offset:1024
  buffer_load_dwordx4 v248, s[12:15], s33 offen offset:2048 nt lds
  v_exp_f32 v212, v124
  v_mfma_f32_16x16x32_bf16 v[4:7], a[164:167], a[112:115], v[4:7]
  s_waitcnt lgkmcnt(8)
  v_mfma_f32_16x16x32_bf16 v[16:19], a[168:171], a[112:115], v[16:19]
  ds_read_b64_tr_b16 a[160:161], v232 offset:8192
  ds_read_b64_tr_b16 a[162:163], v232 offset:9216
  v_add_f32 v215, v215, v210
  v_cvt_pk_bf16_f32 v157, v210, v211
  v_mfma_f32_16x16x32_bf16 v[24:27], a[168:171], a[116:119], v[24:27]
  v_mfma_f32_16x16x32_bf16 v[28:31], a[172:175], a[116:119], v[28:31]
  ds_read_b64_tr_b16 a[164:165], v233 offset:8192
  ds_read_b64_tr_b16 a[166:167], v233 offset:9216
  v_exp_f32 v213, v125
  v_add_f32 v215, v215, v211
  v_exp_f32 v208, v126
  v_mfma_f32_16x16x32_bf16 v[20:23], a[172:175], a[112:115], v[20:23]
  s_waitcnt lgkmcnt(8)
  v_mfma_f32_16x16x32_bf16 v[32:35], a[176:179], a[112:115], v[32:35]
  ds_read_b64_tr_b16 a[168:169], v234 offset:8192
  ds_read_b64_tr_b16 a[170:171], v234 offset:9216
  buffer_load_dwordx4 v248, s[12:15], s33 offen offset:3072 nt lds
  s_add_u32 s33, s33, 0x4000
  v_mfma_f32_16x16x32_bf16 v[40:43], a[176:179], a[116:119], v[40:43]
  v_mfma_f32_16x16x32_bf16 v[44:47], a[180:183], a[116:119], v[44:47]
  ds_read_b64_tr_b16 a[172:173], v235 offset:8192
  ds_read_b64_tr_b16 a[174:175], v235 offset:9216
  v_add_f32 v215, v215, v212
  v_cvt_pk_bf16_f32 v158, v212, v213
  v_exp_f32 v209, v127
  v_mfma_f32_16x16x32_bf16 v[36:39], a[180:183], a[112:115], v[36:39]
  s_waitcnt lgkmcnt(8)
  v_mfma_f32_16x16x32_bf16 v[48:51], a[184:187], a[112:115], v[48:51]
  ds_read_b64_tr_b16 a[176:177], v236 offset:8192
  ds_read_b64_tr_b16 a[178:179], v236 offset:9216
  v_add_f32 v215, v215, v213
  v_add_f32 v215, v215, v208
  v_mfma_f32_16x16x32_bf16 v[56:59], a[184:187], a[116:119], v[56:59]
  v_mfma_f32_16x16x32_bf16 v[60:63], a[188:191], a[116:119], v[60:63]
  ds_read_b64_tr_b16 a[180:181], v237 offset:8192
  ds_read_b64_tr_b16 a[182:183], v237 offset:9216
  v_cvt_pk_bf16_f32 v159, v208, v209
  v_add_f32 v215, v215, v209
  v_add_f32 v210, v214, v215
  v_cmp_lt_f32 vcc, s35, v210
  v_mfma_f32_16x16x32_bf16 v[52:55], a[188:191], a[112:115], v[52:55]
  s_waitcnt lgkmcnt(8)
  v_mfma_f32_16x16x32_bf16 v[0:3], a[160:163], a[120:123], v[0:3]
  ds_read_b64_tr_b16 a[184:185], v238 offset:8192
  ds_read_b64_tr_b16 a[186:187], v238 offset:9216
  v_mfma_f32_16x16x32_bf16 v[8:11], a[160:163], a[124:127], v[8:11]
  v_mfma_f32_16x16x32_bf16 v[12:15], a[164:167], a[124:127], v[12:15]
  ds_read_b64_tr_b16 a[188:189], v239 offset:8192
  ds_read_b64_tr_b16 a[190:191], v239 offset:9216
  v_mfma_f32_16x16x32_bf16 v[4:7], a[164:167], a[120:123], v[4:7]
  s_waitcnt lgkmcnt(8)
  v_mfma_f32_16x16x32_bf16 v[16:19], a[168:171], a[120:123], v[16:19]
  s_waitcnt vmcnt(24)
  s_barrier
  ds_read_b64_tr_b16 a[160:161], v200 offset:0
  ds_read_b64_tr_b16 a[162:163], v200 offset:1024
  v_mfma_f32_16x16x32_bf16 v[24:27], a[168:171], a[124:127], v[24:27]
  v_mfma_f32_16x16x32_bf16 v[28:31], a[172:175], a[124:127], v[28:31]
  ds_read_b64_tr_b16 a[164:165], v201 offset:0
  ds_read_b64_tr_b16 a[166:167], v201 offset:1024
  s_add_u32 m0, s41, 32768
  s_nop 0
  buffer_load_dwordx4 v240, s[8:11], s32 offen offset:0 nt lds
  v_mfma_f32_16x16x32_bf16 v[20:23], a[172:175], a[120:123], v[20:23]
  s_waitcnt lgkmcnt(8)
  v_mfma_f32_16x16x32_bf16 v[32:35], a[176:179], a[120:123], v[32:35]
  ds_read_b64_tr_b16 a[168:169], v202 offset:0
  ds_read_b64_tr_b16 a[170:171], v202 offset:1024
  v_mfma_f32_16x16x32_bf16 v[40:43], a[176:179], a[124:127], v[40:43]
  v_mfma_f32_16x16x32_bf16 v[44:47], a[180:183], a[124:127], v[44:47]
  ds_read_b64_tr_b16 a[172:173], v203 offset:0
  ds_read_b64_tr_b16 a[174:175], v203 offset:1024
  v_mfma_f32_16x16x32_bf16 v[36:39], a[180:183], a[120:123], v[36:39]
  s_waitcnt lgkmcnt(8)
  v_mfma_f32_16x16x32_bf16 v[48:51], a[184:187], a[120:123], v[48:51]
  ds_read_b64_tr_b16 a[176:177], v204 offset:0
  ds_read_b64_tr_b16 a[178:179], v204 offset:1024
  buffer_load_dwordx4 v241, s[8:11], s32 offen offset:1024 nt lds
  v_mfma_f32_16x16x32_bf16 v[56:59], a[184:187], a[124:127], v[56:59]
  v_mfma_f32_16x16x32_bf16 v[60:63], a[188:191], a[124:127], v[60:63]
  ds_read_b64_tr_b16 a[180:181], v205 offset:0
  ds_read_b64_tr_b16 a[182:183], v205 offset:1024
  v_mfma_f32_16x16x32_bf16 v[52:55], a[188:191], a[120:123], v[52:55]
  s_cbranch_vccnz SITE82
BACK82:
  s_waitcnt lgkmcnt(8)
  v_mfma_f32_16x16x32_bf16 a[192:195], a[160:163], v[144:147], a[192:195]
  ds_read_b64_tr_b16 a[184:185], v206 offset:0
  ds_read_b64_tr_b16 a[186:187], v206 offset:1024
  v_add_f32 v249, v249, v214
  v_add_f32 v254, v254, v215
  v_exp_f32 v208, v64
  v_exp_f32 v209, v65
  v_mfma_f32_16x16x32_bf16 a[200:203], a[160:163], v[148:151], a[200:203]
  v_mfma_f32_16x16x32_bf16 a[204:207], a[164:167], v[148:151], a[204:207]
  ds_read_b64_tr_b16 a[188:189], v207 offset:0
  ds_read_b64_tr_b16 a[190:191], v207 offset:1024
  buffer_load_dwordx4 v242, s[8:11], s32 offen offset:2048 nt lds
  v_mfma_f32_16x16x32_bf16 a[196:199], a[164:167], v[144:147], a[196:199]
  s_waitcnt lgkmcnt(8)
  v_mfma_f32_16x16x32_bf16 a[208:211], a[168:171], v[144:147], a[208:211]
  ds_read_b64_tr_b16 a[160:161], v200 offset:8192
  ds_read_b64_tr_b16 a[162:163], v200 offset:9216
  v_exp_f32 v210, v66
  v_cvt_pk_bf16_f32 v128, v208, v209
  v_exp_f32 v211, v67
  v_mfma_f32_16x16x32_bf16 a[216:219], a[168:171], v[148:151], a[216:219]
  v_mfma_f32_16x16x32_bf16 a[220:223], a[172:175], v[148:151], a[220:223]
  ds_read_b64_tr_b16 a[164:165], v201 offset:8192
  ds_read_b64_tr_b16 a[166:167], v201 offset:9216
  v_add_f32 v214, v208, v209
  v_exp_f32 v212, v68
  v_add_f32 v214, v214, v210
  v_mfma_f32_16x16x32_bf16 a[212:215], a[172:175], v[144:147], a[212:215]
  s_waitcnt lgkmcnt(8)
  v_mfma_f32_16x16x32_bf16 a[224:227], a[176:179], v[144:147], a[224:227]
  ds_read_b64_tr_b16 a[168:169], v202 offset:8192
  ds_read_b64_tr_b16 a[170:171], v202 offset:9216
  buffer_load_dwordx4 v243, s[8:11], s32 offen offset:3072 nt lds
  s_add_u32 s32, s32, 0x4000
  v_cvt_pk_bf16_f32 v129, v210, v211
  v_mfma_f32_16x16x32_bf16 a[232:235], a[176:179], v[148:151], a[232:235]
  v_mfma_f32_16x16x32_bf16 a[236:239], a[180:183], v[148:151], a[236:239]
  ds_read_b64_tr_b16 a[172:173], v203 offset:8192
  ds_read_b64_tr_b16 a[174:175], v203 offset:9216
  v_exp_f32 v213, v69
  v_add_f32 v214, v214, v211
  v_mfma_f32_16x16x32_bf16 a[228:231], a[180:183], v[144:147], a[228:231]
  s_waitcnt lgkmcnt(8)
  v_mfma_f32_16x16x32_bf16 a[240:243], a[184:187], v[144:147], a[240:243]
  ds_read_b64_tr_b16 a[176:177], v204 offset:8192
  ds_read_b64_tr_b16 a[178:179], v204 offset:9216
  v_exp_f32 v208, v70
  v_add_f32 v214, v214, v212
  v_cvt_pk_bf16_f32 v130, v212, v213
  v_mfma_f32_16x16x32_bf16 a[248:251], a[184:187], v[148:151], a[248:251]
  v_mfma_f32_16x16x32_bf16 a[252:255], a[188:191], v[148:151], a[252:255]
  ds_read_b64_tr_b16 a[180:181], v205 offset:8192
  ds_read_b64_tr_b16 a[182:183], v205 offset:9216
  v_exp_f32 v209, v71
  v_add_f32 v214, v214, v213
  v_exp_f32 v210, v72
  v_mfma_f32_16x16x32_bf16 a[244:247], a[188:191], v[144:147], a[244:247]
  s_waitcnt lgkmcnt(8)
  v_mfma_f32_16x16x32_bf16 a[192:195], a[160:163], v[152:155], a[192:195]
  ds_read_b64_tr_b16 a[184:185], v206 offset:8192
  ds_read_b64_tr_b16 a[186:187], v206 offset:9216
  v_add_f32 v214, v214, v208
  v_cvt_pk_bf16_f32 v131, v208, v209
  v_exp_f32 v211, v73
  v_mfma_f32_16x16x32_bf16 a[200:203], a[160:163], v[156:159], a[200:203]
  v_mfma_f32_16x16x32_bf16 a[204:207], a[164:167], v[156:159], a[204:207]
  ds_read_b64_tr_b16 a[188:189], v207 offset:8192
  ds_read_b64_tr_b16 a[190:191], v207 offset:9216
  v_add_f32 v214, v214, v209
  v_exp_f32 v212, v74
  v_mfma_f32_16x16x32_bf16 a[196:199], a[164:167], v[152:155], a[196:199]
  s_waitcnt lgkmcnt(8)
  v_mfma_f32_16x16x32_bf16 a[208:211], a[168:171], v[152:155], a[208:211]
  s_barrier
  ds_read_b128 a[160:163], v224 offset:49152
  v_cvt_pk_bf16_f32 v132, v210, v211
  v_exp_f32 v213, v75
  v_add_f32 v215, v210, v211
  v_mfma_f32_16x16x32_bf16 a[216:219], a[168:171], v[156:159], a[216:219]
  v_mfma_f32_16x16x32_bf16 a[220:223], a[172:175], v[156:159], a[220:223]
  ds_read_b128 a[164:167], v224 offset:53248
  v_lshrrev_b32 v245, 8, v248
  v_and_b32 v244, 255, v248
  v_mul_u32_u24 v245, 1280, v245
  v_add_u32 v244, v244, v245
  v_add_u32 v245, 4096, v244
  v_add_u32 v246, 8192, v244
  v_add_u32 v247, 12288, v244
  s_add_u32 s34, s76, 0
  s_add_u32 m0, s41, 65536
  s_nop 0
  buffer_load_dwordx4 v244, s[64:67], s34 offen offset:0 lds
  v_mfma_f32_16x16x32_bf16 a[212:215], a[172:175], v[152:155], a[212:215]
  v_exp_f32 v208, v76
  s_waitcnt lgkmcnt(6)
  v_mfma_f32_16x16x32_bf16 a[224:227], a[176:179], v[152:155], a[224:227]
  ds_read_b128 a[168:171], v225 offset:49152
  v_add_f32 v215, v215, v212
  v_cvt_pk_bf16_f32 v133, v212, v213
  v_exp_f32 v209, v77
  v_mfma_f32_16x16x32_bf16 a[232:235], a[176:179], v[156:159], a[232:235]
  v_mfma_f32_16x16x32_bf16 a[236:239], a[180:183], v[156:159], a[236:239]
  ds_read_b128 a[172:175], v225 offset:53248
  v_add_f32 v215, v215, v213
  v_exp_f32 v210, v78
  v_add_f32 v215, v215, v208
  v_cvt_pk_bf16_f32 v134, v208, v209
  v_mfma_f32_16x16x32_bf16 a[228:231], a[180:183], v[152:155], a[228:231]
  s_waitcnt lgkmcnt(4)
  v_mfma_f32_16x16x32_bf16 a[240:243], a[184:187], v[152:155], a[240:243]
  ds_read_b128 a[176:179], v226 offset:49152
  buffer_load_dwordx4 v245, s[64:67], s34 offen offset:1024 lds
  v_exp_f32 v211, v79
  v_mfma_f32_16x16x32_bf16 a[248:251], a[184:187], v[156:159], a[248:251]
  v_mfma_f32_16x16x32_bf16 a[252:255], a[188:191], v[156:159], a[252:255]
  ds_read_b128 a[180:183], v226 offset:53248
  v_add_f32 v215, v215, v209
  v_exp_f32 v212, v80
  v_add_f32 v215, v215, v210
  v_cvt_pk_bf16_f32 v135, v210, v211
  v_mfma_f32_16x16x32_bf16 a[244:247], a[188:191], v[152:155], a[244:247]
  s_waitcnt lgkmcnt(4)
  v_mfma_f32_16x16x32_bf16 v[96:99], a[160:163], v[160:163], v[192:195]
  ds_read_b128 a[184:187], v227 offset:49152
  v_exp_f32 v213, v81
  v_add_f32 v215, v215, v211
  v_exp_f32 v208, v82
  v_mfma_f32_16x16x32_bf16 v[104:107], a[160:163], v[164:167], v[196:199]
  v_mfma_f32_16x16x32_bf16 v[108:111], a[164:167], v[164:167], v[196:199]
  ds_read_b128 a[188:191], v227 offset:53248
  buffer_load_dwordx4 v246, s[64:67], s34 offen offset:2048 lds
  v_add_f32 v214, v214, v212
  v_mfma_f32_16x16x32_bf16 v[100:103], a[164:167], v[160:163], v[192:195]
  s_waitcnt lgkmcnt(4)
  v_mfma_f32_16x16x32_bf16 v[96:99], a[168:171], v[168:171], v[96:99]
  ds_read_b128 a[160:163], v224 offset:51200
  v_cvt_pk_bf16_f32 v136, v212, v213
  v_exp_f32 v209, v83
  v_add_f32 v214, v214, v213
  v_mfma_f32_16x16x32_bf16 v[104:107], a[168:171], v[172:175], v[104:107]
  v_mfma_f32_16x16x32_bf16 v[108:111], a[172:175], v[172:175], v[108:111]
  ds_read_b128 a[164:167], v224 offset:55296
  v_exp_f32 v210, v84
  v_add_f32 v214, v214, v208
  v_cvt_pk_bf16_f32 v137, v208, v209
  v_exp_f32 v211, v85
  v_mfma_f32_16x16x32_bf16 v[100:103], a[172:175], v[168:171], v[100:103]
  s_waitcnt lgkmcnt(4)
  v_mfma_f32_16x16x32_bf16 v[96:99], a[176:179], v[176:179], v[96:99]
  ds_read_b128 a[168:171], v225 offset:51200
  buffer_load_dwordx4 v247, s[64:67], s34 offen offset:3072 lds
  v_add_f32 v214, v214, v209
  v_mfma_f32_16x16x32_bf16 v[104:107], a[176:179], v[180:183], v[104:107]
  v_mfma_f32_16x16x32_bf16 v[108:111], a[180:183], v[180:183], v[108:111]
  ds_read_b128 a[172:175], v225 offset:55296
  v_exp_f32 v212, v86
  v_add_f32 v214, v214, v210
  v_cvt_pk_bf16_f32 v138, v210, v211
  v_mfma_f32_16x16x32_bf16 v[100:103], a[180:183], v[176:179], v[100:103]
  s_waitcnt lgkmcnt(4)
  v_mfma_f32_16x16x32_bf16 v[96:99], a[184:187], v[184:187], v[96:99]
  ds_read_b128 a[176:179], v226 offset:51200
  v_exp_f32 v213, v87
  v_add_f32 v214, v214, v211
  v_exp_f32 v208, v88
  v_add_f32 v214, v214, v212
  v_mfma_f32_16x16x32_bf16 v[104:107], a[184:187], v[188:191], v[104:107]
  v_mfma_f32_16x16x32_bf16 v[108:111], a[188:191], v[188:191], v[108:111]
  ds_read_b128 a[180:183], v226 offset:55296
  v_cvt_pk_bf16_f32 v139, v212, v213
  v_exp_f32 v209, v89
  v_add_f32 v214, v214, v213
  v_mfma_f32_16x16x32_bf16 v[100:103], a[188:191], v[184:187], v[100:103]
  s_waitcnt lgkmcnt(4)
  v_mfma_f32_16x16x32_bf16 v[112:115], a[160:163], v[160:163], v[192:195]
  ds_read_b128 a[184:187], v227 offset:51200
  v_exp_f32 v210, v90
  v_add_f32 v215, v215, v208
  v_cvt_pk_bf16_f32 v140, v208, v209
  v_exp_f32 v211, v91
  v_mfma_f32_16x16x32_bf16 v[120:123], a[160:163], v[164:167], v[196:199]
  v_mfma_f32_16x16x32_bf16 v[124:127], a[164:167], v[164:167], v[196:199]
  ds_read_b128 a[188:191], v227 offset:55296
  v_add_f32 v215, v215, v209
  v_exp_f32 v212, v92
  v_add_f32 v215, v215, v210
  v_mfma_f32_16x16x32_bf16 v[116:119], a[164:167], v[160:163], v[192:195]
  s_waitcnt lgkmcnt(4)
  v_mfma_f32_16x16x32_bf16 v[112:115], a[168:171], v[168:171], v[112:115]
  s_waitcnt vmcnt(28)
  s_barrier
  ds_read_b64_tr_b16 a[160:161], v200 offset:16384
  ds_read_b64_tr_b16 a[162:163], v200 offset:17408
  v_cvt_pk_bf16_f32 v141, v210, v211
  v_exp_f32 v213, v93
  v_mfma_f32_16x16x32_bf16 v[120:123], a[168:171], v[172:175], v[120:123]
  v_mfma_f32_16x16x32_bf16 v[124:127], a[172:175], v[172:175], v[124:127]
  ds_read_b64_tr_b16 a[164:165], v201 offset:16384
  ds_read_b64_tr_b16 a[166:167], v201 offset:17408
  s_add_u32 s34, s76, 81920
  s_add_u32 m0, s41, 131072
  s_nop 0
  buffer_load_dwordx4 v244, s[64:67], s34 offen offset:0 lds
  v_add_f32 v215, v215, v211
  v_mfma_f32_16x16x32_bf16 v[116:119], a[172:175], v[168:171], v[116:119]
  s_waitcnt lgkmcnt(6)
  v_mfma_f32_16x16x32_bf16 v[112:115], a[176:179], v[176:179], v[112:115]
  ds_read_b64_tr_b16 a[168:169], v202 offset:16384
  ds_read_b64_tr_b16 a[170:171], v202 offset:17408
  v_exp_f32 v208, v94
  v_add_f32 v215, v215, v212
  v_mfma_f32_16x16x32_bf16 v[120:123], a[176:179], v[180:183], v[120:123]
  v_mfma_f32_16x16x32_bf16 v[124:127], a[180:183], v[180:183], v[124:127]
  ds_read_b64_tr_b16 a[172:173], v203 offset:16384
  ds_read_b64_tr_b16 a[174:175], v203 offset:17408
  v_cvt_pk_bf16_f32 v142, v212, v213
  v_exp_f32 v209, v95
  v_add_f32 v215, v215, v213
  v_mfma_f32_16x16x32_bf16 v[116:119], a[180:183], v[176:179], v[116:119]
  s_waitcnt lgkmcnt(8)
  v_mfma_f32_16x16x32_bf16 v[112:115], a[184:187], v[184:187], v[112:115]
  ds_read_b64_tr_b16 a[176:177], v204 offset:16384
  ds_read_b64_tr_b16 a[178:179], v204 offset:17408
  buffer_load_dwordx4 v245, s[64:67], s34 offen offset:1024 lds
  v_add_f32 v215, v215, v208
  v_cvt_pk_bf16_f32 v143, v208, v209
  v_mfma_f32_16x16x32_bf16 v[120:123], a[184:187], v[188:191], v[120:123]
  v_mfma_f32_16x16x32_bf16 v[124:127], a[188:191], v[188:191], v[124:127]
  ds_read_b64_tr_b16 a[180:181], v205 offset:16384
  ds_read_b64_tr_b16 a[182:183], v205 offset:17408
  v_add_f32 v215, v215, v209
  v_add_f32 v210, v214, v215
  v_cmp_lt_f32 vcc, s35, v210
  v_mfma_f32_16x16x32_bf16 v[116:119], a[188:191], v[184:187], v[116:119]
  s_cbranch_vccnz SITE84
BACK84:
  s_waitcnt lgkmcnt(8)
  v_mfma_f32_16x16x32_bf16 v[0:3], a[160:163], a[128:131], v[0:3]
  ds_read_b64_tr_b16 a[184:185], v206 offset:16384
  ds_read_b64_tr_b16 a[186:187], v206 offset:17408
  v_mfma_f32_16x16x32_bf16 v[8:11], a[160:163], a[132:135], v[8:11]
  v_mfma_f32_16x16x32_bf16 v[12:15], a[164:167], a[132:135], v[12:15]
  ds_read_b64_tr_b16 a[188:189], v207 offset:16384
  ds_read_b64_tr_b16 a[190:191], v207 offset:17408
  buffer_load_dwordx4 v246, s[64:67], s34 offen offset:2048 lds
  v_mfma_f32_16x16x32_bf16 v[4:7], a[164:167], a[128:131], v[4:7]
  s_waitcnt lgkmcnt(8)
  v_mfma_f32_16x16x32_bf16 v[16:19], a[168:171], a[128:131], v[16:19]
  ds_read_b64_tr_b16 a[160:161], v200 offset:24576
  ds_read_b64_tr_b16 a[162:163], v200 offset:25600
  v_add_f32 v249, v249, v214
  v_add_f32 v254, v254, v215
  v_exp_f32 v208, v96
  v_exp_f32 v209, v97
  v_mfma_f32_16x16x32_bf16 v[24:27], a[168:171], a[132:135], v[24:27]
  v_mfma_f32_16x16x32_bf16 v[28:31], a[172:175], a[132:135], v[28:31]
  ds_read_b64_tr_b16 a[164:165], v201 offset:24576
  ds_read_b64_tr_b16 a[166:167], v201 offset:25600
  v_exp_f32 v210, v98
  v_cvt_pk_bf16_f32 v144, v208, v209
  v_mfma_f32_16x16x32_bf16 v[20:23], a[172:175], a[128:131], v[20:23]
  s_waitcnt lgkmcnt(8)
  v_mfma_f32_16x16x32_bf16 v[32:35], a[176:179], a[128:131], v[32:35]
  ds_read_b64_tr_b16 a[168:169], v202 offset:24576
  ds_read_b64_tr_b16 a[170:171], v202 offset:25600
  buffer_load_dwordx4 v247, s[64:67], s34 offen offset:3072 lds
  v_exp_f32 v211, v99
  v_mfma_f32_16x16x32_bf16 v[40:43], a[176:179], a[132:135], v[40:43]
  v_mfma_f32_16x16x32_bf16 v[44:47], a[180:183], a[132:135], v[44:47]
  ds_read_b64_tr_b16 a[172:173], v203 offset:24576
  ds_read_b64_tr_b16 a[174:175], v203 offset:25600
  v_add_f32 v214, v208, v209
  v_exp_f32 v212, v100
  v_add_f32 v214, v214, v210
  v_mfma_f32_16x16x32_bf16 v[36:39], a[180:183], a[128:131], v[36:39]
  s_waitcnt lgkmcnt(8)
  v_mfma_f32_16x16x32_bf16 v[48:51], a[184:187], a[128:131], v[48:51]
  ds_read_b64_tr_b16 a[176:177], v204 offset:24576
  ds_read_b64_tr_b16 a[178:179], v204 offset:25600
  v_cvt_pk_bf16_f32 v145, v210, v211
  v_exp_f32 v213, v101
  v_add_f32 v214, v214, v211
  v_mfma_f32_16x16x32_bf16 v[56:59], a[184:187], a[132:135], v[56:59]
  v_mfma_f32_16x16x32_bf16 v[60:63], a[188:191], a[132:135], v[60:63]
  ds_read_b64_tr_b16 a[180:181], v205 offset:24576
  ds_read_b64_tr_b16 a[182:183], v205 offset:25600
  v_exp_f32 v208, v102
  v_add_f32 v214, v214, v212
  v_cvt_pk_bf16_f32 v146, v212, v213
  v_mfma_f32_16x16x32_bf16 v[52:55], a[188:191], a[128:131], v[52:55]
  s_waitcnt lgkmcnt(8)
  v_mfma_f32_16x16x32_bf16 v[0:3], a[160:163], a[136:139], v[0:3]
  ds_read_b64_tr_b16 a[184:185], v206 offset:24576
  ds_read_b64_tr_b16 a[186:187], v206 offset:25600
  v_exp_f32 v209, v103
  v_add_f32 v214, v214, v213
  v_mfma_f32_16x16x32_bf16 v[8:11], a[160:163], a[140:143], v[8:11]
  v_mfma_f32_16x16x32_bf16 v[12:15], a[164:167], a[140:143], v[12:15]
  ds_read_b64_tr_b16 a[188:189], v207 offset:24576
  ds_read_b64_tr_b16 a[190:191], v207 offset:25600
  v_exp_f32 v210, v104
  v_add_f32 v214, v214, v208
  v_cvt_pk_bf16_f32 v147, v208, v209
  v_mfma_f32_16x16x32_bf16 v[4:7], a[164:167], a[136:139], v[4:7]
  s_waitcnt lgkmcnt(8)
  v_mfma_f32_16x16x32_bf16 v[16:19], a[168:171], a[136:139], v[16:19]
  s_waitcnt vmcnt(24)
  s_barrier
  ds_read_b64_tr_b16 a[160:161], v232 offset:16384
  ds_read_b64_tr_b16 a[162:163], v232 offset:17408
  v_exp_f32 v211, v105
  v_add_f32 v214, v214, v209
  v_mfma_f32_16x16x32_bf16 v[24:27], a[168:171], a[140:143], v[24:27]
  v_mfma_f32_16x16x32_bf16 v[28:31], a[172:175], a[140:143], v[28:31]
  ds_read_b64_tr_b16 a[164:165], v233 offset:16384
  ds_read_b64_tr_b16 a[166:167], v233 offset:17408
  s_add_u32 m0, s41, 49152
  s_nop 0
  buffer_load_dwordx4 v240, s[8:11], s32 offen offset:0 nt lds
  v_exp_f32 v212, v106
  v_mfma_f32_16x16x32_bf16 v[20:23], a[172:175], a[136:139], v[20:23]
  s_waitcnt lgkmcnt(8)
  v_mfma_f32_16x16x32_bf16 v[32:35], a[176:179], a[136:139], v[32:35]
  ds_read_b64_tr_b16 a[168:169], v232 offset:24576
  ds_read_b64_tr_b16 a[170:171], v232 offset:25600
  v_cvt_pk_bf16_f32 v148, v210, v211
  v_exp_f32 v213, v107
  v_mfma_f32_16x16x32_bf16 v[40:43], a[176:179], a[140:143], v[40:43]
  v_mfma_f32_16x16x32_bf16 v[44:47], a[180:183], a[140:143], v[44:47]
  ds_read_b64_tr_b16 a[172:173], v233 offset:24576
  ds_read_b64_tr_b16 a[174:175], v233 offset:25600
  v_add_f32 v215, v210, v211
  v_exp_f32 v208, v108
  v_add_f32 v215, v215, v212
  v_mfma_f32_16x16x32_bf16 v[36:39], a[180:183], a[136:139], v[36:39]
  s_waitcnt lgkmcnt(8)
  v_mfma_f32_16x16x32_bf16 v[48:51], a[184:187], a[136:139], v[48:51]
  ds_read_b64_tr_b16 a[176:177], v234 offset:16384
  ds_read_b64_tr_b16 a[178:179], v234 offset:17408
  buffer_load_dwordx4 v241, s[8:11], s32 offen offset:1024 nt lds
  v_cvt_pk_bf16_f32 v149, v212, v213
  v_mfma_f32_16x16x32_bf16 v[56:59], a[184:187], a[140:143], v[56:59]
  v_mfma_f32_16x16x32_bf16 v[60:63], a[188:191], a[140:143], v[60:63]
  ds_read_b64_tr_b16 a[180:181], v235 offset:16384
  ds_read_b64_tr_b16 a[182:183], v235 offset:17408
  v_exp_f32 v209, v109
  v_add_f32 v215, v215, v213
  v_exp_f32 v210, v110
  v_mfma_f32_16x16x32_bf16 v[52:55], a[188:191], a[136:139], v[52:55]
  s_waitcnt lgkmcnt(8)
  v_mfma_f32_16x16x32_bf16 v[0:3], a[160:163], a[144:147], v[0:3]
  ds_read_b64_tr_b16 a[184:185], v234 offset:24576
  ds_read_b64_tr_b16 a[186:187], v234 offset:25600
  v_add_f32 v215, v215, v208
  v_cvt_pk_bf16_f32 v150, v208, v209
  v_exp_f32 v211, v111
  v_mfma_f32_16x16x32_bf16 v[8:11], a[160:163], a[148:151], v[8:11]
  v_mfma_f32_16x16x32_bf16 v[12:15], a[164:167], a[148:151], v[12:15]
  ds_read_b64_tr_b16 a[188:189], v235 offset:24576
  ds_read_b64_tr_b16 a[190:191], v235 offset:25600
  buffer_load_dwordx4 v242, s[8:11], s32 offen offset:2048 nt lds
  v_add_f32 v215, v215, v209
  v_mfma_f32_16x16x32_bf16 v[4:7], a[164:167], a[144:147], v[4:7]
  s_waitcnt lgkmcnt(8)
  v_mfma_f32_16x16x32_bf16 v[0:3], a[168:171], a[152:155], v[0:3]
  ds_read_b64_tr_b16 a[160:161], v236 offset:16384
  ds_read_b64_tr_b16 a[162:163], v236 offset:17408
  v_exp_f32 v212, v112
  v_add_f32 v215, v215, v210
  v_cvt_pk_bf16_f32 v151, v210, v211
  v_mfma_f32_16x16x32_bf16 v[8:11], a[168:171], a[156:159], v[8:11]
  v_mfma_f32_16x16x32_bf16 v[12:15], a[172:175], a[156:159], v[12:15]
  ds_read_b64_tr_b16 a[164:165], v237 offset:16384
  ds_read_b64_tr_b16 a[166:167], v237 offset:17408
  v_exp_f32 v213, v113
  v_add_f32 v215, v215, v211
  v_exp_f32 v208, v114
  v_mfma_f32_16x16x32_bf16 v[4:7], a[172:175], a[152:155], v[4:7]
  s_waitcnt lgkmcnt(8)
  v_mfma_f32_16x16x32_bf16 v[16:19], a[176:179], a[144:147], v[16:19]
  ds_read_b64_tr_b16 a[168:169], v236 offset:24576
  ds_read_b64_tr_b16 a[170:171], v236 offset:25600
  buffer_load_dwordx4 v243, s[8:11], s32 offen offset:3072 nt lds
  s_add_u32 s32, s32, 0x4000
  v_add_f32 v214, v214, v212
  v_cvt_pk_bf16_f32 v152, v212, v213
  v_mfma_f32_16x16x32_bf16 v[24:27], a[176:179], a[148:151], v[24:27]
  v_mfma_f32_16x16x32_bf16 v[28:31], a[180:183], a[148:151], v[28:31]
  ds_read_b64_tr_b16 a[172:173], v237 offset:24576
  ds_read_b64_tr_b16 a[174:175], v237 offset:25600
  v_exp_f32 v209, v115
  v_add_f32 v214, v214, v213
  v_exp_f32 v210, v116
  v_mfma_f32_16x16x32_bf16 v[20:23], a[180:183], a[144:147], v[20:23]
  s_waitcnt lgkmcnt(8)
  v_mfma_f32_16x16x32_bf16 v[16:19], a[184:187], a[152:155], v[16:19]
  ds_read_b64_tr_b16 a[176:177], v238 offset:16384
  ds_read_b64_tr_b16 a[178:179], v238 offset:17408
  v_add_f32 v214, v214, v208
  v_cvt_pk_bf16_f32 v153, v208, v209
  v_exp_f32 v211, v117
  v_mfma_f32_16x16x32_bf16 v[24:27], a[184:187], a[156:159], v[24:27]
  v_mfma_f32_16x16x32_bf16 v[28:31], a[188:191], a[156:159], v[28:31]
  ds_read_b64_tr_b16 a[180:181], v239 offset:16384
  ds_read_b64_tr_b16 a[182:183], v239 offset:17408
  v_add_f32 v214, v214, v209
  v_exp_f32 v212, v118
  v_add_f32 v214, v214, v210
  v_cvt_pk_bf16_f32 v154, v210, v211
  v_mfma_f32_16x16x32_bf16 v[20:23], a[188:191], a[152:155], v[20:23]
  s_waitcnt lgkmcnt(8)
  v_mfma_f32_16x16x32_bf16 v[32:35], a[160:163], a[144:147], v[32:35]
  ds_read_b64_tr_b16 a[184:185], v238 offset:24576
  ds_read_b64_tr_b16 a[186:187], v238 offset:25600
  v_exp_f32 v213, v119
  v_add_f32 v214, v214, v211
  v_exp_f32 v208, v120
  v_mfma_f32_16x16x32_bf16 v[40:43], a[160:163], a[148:151], v[40:43]
  v_mfma_f32_16x16x32_bf16 v[44:47], a[164:167], a[148:151], v[44:47]
  ds_read_b64_tr_b16 a[188:189], v239 offset:24576
  ds_read_b64_tr_b16 a[190:191], v239 offset:25600
  v_add_f32 v214, v214, v212
  v_cvt_pk_bf16_f32 v155, v212, v213
  v_exp_f32 v209, v121
  v_mfma_f32_16x16x32_bf16 v[36:39], a[164:167], a[144:147], v[36:39]
  s_waitcnt lgkmcnt(8)
  v_mfma_f32_16x16x32_bf16 v[32:35], a[168:171], a[152:155], v[32:35]
  s_waitcnt vmcnt(24)
  s_barrier
  ds_read_b64_tr_b16 a[160:161], v232 offset:32768
  ds_read_b64_tr_b16 a[162:163], v232 offset:33792
  v_add_f32 v214, v214, v213
  v_exp_f32 v210, v122
  v_mfma_f32_16x16x32_bf16 v[40:43], a[168:171], a[156:159], v[40:43]
  v_mfma_f32_16x16x32_bf16 v[44:47], a[172:175], a[156:159], v[44:47]
  ds_read_b64_tr_b16 a[164:165], v233 offset:32768
  ds_read_b64_tr_b16 a[166:167], v233 offset:33792
  s_add_u32 s34, s76, 163840
  s_add_u32 m0, s41, 147456
  s_nop 0
  buffer_load_dwordx4 v244, s[64:67], s34 offen offset:0 lds
  v_add_f32 v215, v215, v208
  v_mfma_f32_16x16x32_bf16 v[36:39], a[172:175], a[152:155], v[36:39]
  v_cvt_pk_bf16_f32 v156, v208, v209
  s_waitcnt lgkmcnt(8)
  v_mfma_f32_16x16x32_bf16 v[48:51], a[176:179], a[144:147], v[48:51]
  ds_read_b64_tr_b16 a[168:169], v234 offset:32768
  ds_read_b64_tr_b16 a[170:171], v234 offset:33792
  v_exp_f32 v211, v123
  v_add_f32 v215, v215, v209
  v_exp_f32 v212, v124
  v_mfma_f32_16x16x32_bf16 v[56:59], a[176:179], a[148:151], v[56:59]
  v_mfma_f32_16x16x32_bf16 v[60:63], a[180:183], a[148:151], v[60:63]
  ds_read_b64_tr_b16 a[172:173], v235 offset:32768
  ds_read_b64_tr_b16 a[174:175], v235 offset:33792
  v_add_f32 v215, v215, v210
  v_cvt_pk_bf16_f32 v157, v210, v211
  v_exp_f32 v213, v125
  v_mfma_f32_16x16x32_bf16 v[52:55], a[180:183], a[144:147], v[52:55]
  s_waitcnt lgkmcnt(8)
  v_mfma_f32_16x16x32_bf16 v[48:51], a[184:187], a[152:155], v[48:51]
  ds_read_b64_tr_b16 a[176:177], v236 offset:32768
  ds_read_b64_tr_b16 a[178:179], v236 offset:33792
  buffer_load_dwordx4 v245, s[64:67], s34 offen offset:1024 lds
  v_add_f32 v215, v215, v211
  v_mfma_f32_16x16x32_bf16 v[56:59], a[184:187], a[156:159], v[56:59]
  v_mfma_f32_16x16x32_bf16 v[60:63], a[188:191], a[156:159], v[60:63]
  ds_read_b64_tr_b16 a[180:181], v237 offset:32768
  ds_read_b64_tr_b16 a[182:183], v237 offset:33792
  v_exp_f32 v208, v126
  v_add_f32 v215, v215, v212
  v_cvt_pk_bf16_f32 v158, v212, v213
  v_exp_f32 v209, v127
  v_mfma_f32_16x16x32_bf16 v[52:55], a[188:191], a[152:155], v[52:55]
  s_waitcnt lgkmcnt(8)
  v_mfma_f32_16x16x32_bf16 a[192:195], a[160:163], v[128:131], a[192:195]
  ds_read_b64_tr_b16 a[184:185], v238 offset:32768
  ds_read_b64_tr_b16 a[186:187], v238 offset:33792
  v_add_f32 v215, v215, v213
  v_add_f32 v215, v215, v208
  v_cvt_pk_bf16_f32 v159, v208, v209
  v_add_f32 v215, v215, v209
  v_mfma_f32_16x16x32_bf16 a[200:203], a[160:163], v[132:135], a[200:203]
  v_mfma_f32_16x16x32_bf16 a[204:207], a[164:167], v[132:135], a[204:207]
  ds_read_b64_tr_b16 a[188:189], v239 offset:32768
  ds_read_b64_tr_b16 a[190:191], v239 offset:33792
  buffer_load_dwordx4 v246, s[64:67], s34 offen offset:2048 lds
  v_add_f32 v210, v214, v215
  v_cmp_lt_f32 vcc, s35, v210
  v_mfma_f32_16x16x32_bf16 a[196:199], a[164:167], v[128:131], a[196:199]
  s_waitcnt lgkmcnt(8)
  v_mfma_f32_16x16x32_bf16 a[208:211], a[168:171], v[128:131], a[208:211]
  ds_read_b64_tr_b16 a[160:161], v232 offset:40960
  ds_read_b64_tr_b16 a[162:163], v232 offset:41984
  v_mul_f32 v0, s42, v0
  v_mul_f32 v1, s42, v1
  v_mul_f32 v2, s42, v2
  v_mul_f32 v3, s42, v3
  v_mfma_f32_16x16x32_bf16 a[216:219], a[168:171], v[132:135], a[216:219]
  v_mfma_f32_16x16x32_bf16 a[220:223], a[172:175], v[132:135], a[220:223]
  ds_read_b64_tr_b16 a[164:165], v233 offset:40960
  ds_read_b64_tr_b16 a[166:167], v233 offset:41984
  v_mul_f32 v4, s42, v4
  v_mul_f32 v5, s42, v5
  v_mul_f32 v6, s42, v6
  v_mul_f32 v7, s42, v7
  v_mul_f32 v8, s42, v8
  v_mfma_f32_16x16x32_bf16 a[212:215], a[172:175], v[128:131], a[212:215]
  s_waitcnt lgkmcnt(8)
  v_mfma_f32_16x16x32_bf16 a[224:227], a[176:179], v[128:131], a[224:227]
  ds_read_b64_tr_b16 a[168:169], v234 offset:40960
  ds_read_b64_tr_b16 a[170:171], v234 offset:41984
  buffer_load_dwordx4 v247, s[64:67], s34 offen offset:3072 lds
  v_mul_f32 v9, s42, v9
  v_mul_f32 v10, s42, v10
  v_mfma_f32_16x16x32_bf16 a[232:235], a[176:179], v[132:135], a[232:235]
  v_mfma_f32_16x16x32_bf16 a[236:239], a[180:183], v[132:135], a[236:239]
  ds_read_b64_tr_b16 a[172:173], v235 offset:40960
  ds_read_b64_tr_b16 a[174:175], v235 offset:41984
  v_mul_f32 v11, s42, v11
  v_mul_f32 v12, s42, v12
  v_mul_f32 v13, s42, v13
  v_mul_f32 v14, s42, v14
  v_mul_f32 v15, s42, v15
  v_mfma_f32_16x16x32_bf16 a[228:231], a[180:183], v[128:131], a[228:231]
  s_waitcnt lgkmcnt(8)
  v_mfma_f32_16x16x32_bf16 a[240:243], a[184:187], v[128:131], a[240:243]
  ds_read_b64_tr_b16 a[176:177], v236 offset:40960
  ds_read_b64_tr_b16 a[178:179], v236 offset:41984
  v_cvt_pk_bf16_f32 v160, v0, v1
  v_cvt_pk_bf16_f32 v161, v2, v3
  v_cvt_pk_bf16_f32 v162, v4, v5
  v_cvt_pk_bf16_f32 v163, v6, v7
  v_mfma_f32_16x16x32_bf16 a[248:251], a[184:187], v[132:135], a[248:251]
  v_mfma_f32_16x16x32_bf16 a[252:255], a[188:191], v[132:135], a[252:255]
  ds_read_b64_tr_b16 a[180:181], v237 offset:40960
  ds_read_b64_tr_b16 a[182:183], v237 offset:41984
  v_cvt_pk_bf16_f32 v164, v8, v9
  v_cvt_pk_bf16_f32 v165, v10, v11
  v_cvt_pk_bf16_f32 v166, v12, v13
  v_cvt_pk_bf16_f32 v167, v14, v15
  v_permlane16_swap_b32 v160, v162
  v_mfma_f32_16x16x32_bf16 a[244:247], a[188:191], v[128:131], a[244:247]
  s_waitcnt lgkmcnt(8)
  v_mfma_f32_16x16x32_bf16 a[192:195], a[160:163], v[136:139], a[192:195]
  ds_read_b64_tr_b16 a[184:185], v238 offset:40960
  ds_read_b64_tr_b16 a[186:187], v238 offset:41984
  v_permlane16_swap_b32 v161, v163
  v_permlane16_swap_b32 v164, v166
  v_permlane16_swap_b32 v165, v167
  v_mul_f32 v16, s42, v16
  v_mfma_f32_16x16x32_bf16 a[200:203], a[160:163], v[140:143], a[200:203]
  v_mfma_f32_16x16x32_bf16 a[204:207], a[164:167], v[140:143], a[204:207]
  ds_read_b64_tr_b16 a[188:189], v239 offset:40960
  ds_read_b64_tr_b16 a[190:191], v239 offset:41984
  v_mul_f32 v17, s42, v17
  v_mul_f32 v18, s42, v18
  v_mul_f32 v19, s42, v19
  v_mul_f32 v20, s42, v20
  v_mul_f32 v21, s42, v21
  v_mfma_f32_16x16x32_bf16 a[196:199], a[164:167], v[136:139], a[196:199]
  s_waitcnt lgkmcnt(8)
  v_mfma_f32_16x16x32_bf16 a[208:211], a[168:171], v[136:139], a[208:211]
  s_waitcnt vmcnt(20)
  s_barrier
  ds_read_b64_tr_b16 a[160:161], v232 offset:49152
  ds_read_b64_tr_b16 a[162:163], v232 offset:50176
  v_mul_f32 v22, s42, v22
  v_mul_f32 v23, s42, v23
  v_mfma_f32_16x16x32_bf16 a[216:219], a[168:171], v[140:143], a[216:219]
  v_mfma_f32_16x16x32_bf16 a[220:223], a[172:175], v[140:143], a[220:223]
  ds_read_b64_tr_b16 a[164:165], v233 offset:49152
  ds_read_b64_tr_b16 a[166:167], v233 offset:50176
  s_add_u32 s34, s76, 245760
  s_add_u32 m0, s41, 81920
  s_nop 0
  buffer_load_dwordx4 v244, s[64:67], s34 offen offset:0 lds
  v_mul_f32 v24, s42, v24
  v_mfma_f32_16x16x32_bf16 a[212:215], a[172:175], v[136:139], a[212:215]
  v_mul_f32 v25, s42, v25
  s_waitcnt lgkmcnt(8)
  v_mfma_f32_16x16x32_bf16 a[224:227], a[176:179], v[136:139], a[224:227]
  ds_read_b64_tr_b16 a[168:169], v234 offset:49152
  ds_read_b64_tr_b16 a[170:171], v234 offset:50176
  v_mul_f32 v26, s42, v26
  v_mul_f32 v27, s42, v27
  v_mul_f32 v28, s42, v28
  v_mul_f32 v29, s42, v29
  v_mul_f32 v30, s42, v30
  v_mfma_f32_16x16x32_bf16 a[232:235], a[176:179], v[140:143], a[232:235]
  v_mfma_f32_16x16x32_bf16 a[236:239], a[180:183], v[140:143], a[236:239]
  ds_read_b64_tr_b16 a[172:173], v235 offset:49152
  ds_read_b64_tr_b16 a[174:175], v235 offset:50176
  v_mul_f32 v31, s42, v31
  v_cvt_pk_bf16_f32 v168, v16, v17
  v_cvt_pk_bf16_f32 v169, v18, v19
  v_cvt_pk_bf16_f32 v170, v20, v21
  v_cvt_pk_bf16_f32 v171, v22, v23
  v_mfma_f32_16x16x32_bf16 a[228:231], a[180:183], v[136:139], a[228:231]
  s_waitcnt lgkmcnt(8)
  v_mfma_f32_16x16x32_bf16 a[240:243], a[184:187], v[136:139], a[240:243]
  ds_read_b64_tr_b16 a[176:177], v236 offset:49152
  ds_read_b64_tr_b16 a[178:179], v236 offset:50176
  buffer_load_dwordx4 v245, s[64:67], s34 offen offset:1024 lds
  v_cvt_pk_bf16_f32 v172, v24, v25
  v_cvt_pk_bf16_f32 v173, v26, v27
  v_mfma_f32_16x16x32_bf16 a[248:251], a[184:187], v[140:143], a[248:251]
  v_mfma_f32_16x16x32_bf16 a[252:255], a[188:191], v[140:143], a[252:255]
  ds_read_b64_tr_b16 a[180:181], v237 offset:49152
  ds_read_b64_tr_b16 a[182:183], v237 offset:50176
  v_cvt_pk_bf16_f32 v174, v28, v29
  v_cvt_pk_bf16_f32 v175, v30, v31
  v_permlane16_swap_b32 v168, v170
  v_permlane16_swap_b32 v169, v171
  v_mfma_f32_16x16x32_bf16 a[244:247], a[188:191], v[136:139], a[244:247]
  s_cbranch_vccnz SITE87
BACK87:
  s_waitcnt lgkmcnt(8)
  v_mfma_f32_16x16x32_bf16 a[192:195], a[160:163], v[144:147], a[192:195]
  ds_read_b64_tr_b16 a[184:185], v238 offset:49152
  ds_read_b64_tr_b16 a[186:187], v238 offset:50176
  v_add_f32 v249, v249, v214
  v_add_f32 v254, v254, v215
  v_permlane16_swap_b32 v172, v174
  v_permlane16_swap_b32 v173, v175
  v_mul_f32 v32, s42, v32
  v_mfma_f32_16x16x32_bf16 a[200:203], a[160:163], v[148:151], a[200:203]
  v_mfma_f32_16x16x32_bf16 a[204:207], a[164:167], v[148:151], a[204:207]
  ds_read_b64_tr_b16 a[188:189], v239 offset:49152
  ds_read_b64_tr_b16 a[190:191], v239 offset:50176
  buffer_load_dwordx4 v246, s[64:67], s34 offen offset:2048 lds
  v_mul_f32 v33, s42, v33
  v_mul_f32 v34, s42, v34
  v_mfma_f32_16x16x32_bf16 a[196:199], a[164:167], v[144:147], a[196:199]
  s_waitcnt lgkmcnt(8)
  v_mfma_f32_16x16x32_bf16 a[208:211], a[168:171], v[144:147], a[208:211]
  ds_read_b64_tr_b16 a[160:161], v232 offset:57344
  ds_read_b64_tr_b16 a[162:163], v232 offset:58368
  v_mul_f32 v35, s42, v35
  v_mul_f32 v36, s42, v36
  v_mul_f32 v37, s42, v37
  v_mul_f32 v38, s42, v38
  v_mfma_f32_16x16x32_bf16 a[216:219], a[168:171], v[148:151], a[216:219]
  v_mfma_f32_16x16x32_bf16 a[220:223], a[172:175], v[148:151], a[220:223]
  ds_read_b64_tr_b16 a[164:165], v233 offset:57344
  ds_read_b64_tr_b16 a[166:167], v233 offset:58368
  v_mul_f32 v39, s42, v39
  v_mul_f32 v40, s42, v40
  v_mul_f32 v41, s42, v41
  v_mul_f32 v42, s42, v42
  v_mul_f32 v43, s42, v43
  v_mfma_f32_16x16x32_bf16 a[212:215], a[172:175], v[144:147], a[212:215]
  s_waitcnt lgkmcnt(8)
  v_mfma_f32_16x16x32_bf16 a[224:227], a[176:179], v[144:147], a[224:227]
  ds_read_b64_tr_b16 a[168:169], v234 offset:57344
  ds_read_b64_tr_b16 a[170:171], v234 offset:58368
  buffer_load_dwordx4 v247, s[64:67], s34 offen offset:3072 lds
  v_mul_f32 v44, s42, v44
  v_mul_f32 v45, s42, v45
  v_mfma_f32_16x16x32_bf16 a[232:235], a[176:179], v[148:151], a[232:235]
  v_mfma_f32_16x16x32_bf16 a[236:239], a[180:183], v[148:151], a[236:239]
  ds_read_b64_tr_b16 a[172:173], v235 offset:57344
  ds_read_b64_tr_b16 a[174:175], v235 offset:58368
  v_mul_f32 v46, s42, v46
  v_mul_f32 v47, s42, v47
  v_cvt_pk_bf16_f32 v176, v32, v33
  v_cvt_pk_bf16_f32 v177, v34, v35
  v_mfma_f32_16x16x32_bf16 a[228:231], a[180:183], v[144:147], a[228:231]
  s_waitcnt lgkmcnt(8)
  v_mfma_f32_16x16x32_bf16 a[240:243], a[184:187], v[144:147], a[240:243]
  ds_read_b64_tr_b16 a[176:177], v236 offset:57344
  ds_read_b64_tr_b16 a[178:179], v236 offset:58368
  v_cvt_pk_bf16_f32 v178, v36, v37
  v_cvt_pk_bf16_f32 v179, v38, v39
  v_cvt_pk_bf16_f32 v180, v40, v41
  v_cvt_pk_bf16_f32 v181, v42, v43
  v_cvt_pk_bf16_f32 v182, v44, v45
  v_mfma_f32_16x16x32_bf16 a[248:251], a[184:187], v[148:151], a[248:251]
  v_mfma_f32_16x16x32_bf16 a[252:255], a[188:191], v[148:151], a[252:255]
  ds_read_b64_tr_b16 a[180:181], v237 offset:57344
  ds_read_b64_tr_b16 a[182:183], v237 offset:58368
  v_cvt_pk_bf16_f32 v183, v46, v47
  v_permlane16_swap_b32 v176, v178
  v_permlane16_swap_b32 v177, v179
  v_permlane16_swap_b32 v180, v182
  v_permlane16_swap_b32 v181, v183
  v_mfma_f32_16x16x32_bf16 a[244:247], a[188:191], v[144:147], a[244:247]
  s_waitcnt lgkmcnt(8)
  v_mfma_f32_16x16x32_bf16 a[192:195], a[160:163], v[152:155], a[192:195]
  ds_read_b64_tr_b16 a[184:185], v238 offset:57344
  ds_read_b64_tr_b16 a[186:187], v238 offset:58368
  v_mul_f32 v48, s42, v48
  v_mul_f32 v49, s42, v49
  v_mul_f32 v50, s42, v50
  v_mul_f32 v51, s42, v51
  v_mfma_f32_16x16x32_bf16 a[200:203], a[160:163], v[156:159], a[200:203]
  v_mfma_f32_16x16x32_bf16 a[204:207], a[164:167], v[156:159], a[204:207]
  ds_read_b64_tr_b16 a[188:189], v239 offset:57344
  ds_read_b64_tr_b16 a[190:191], v239 offset:58368
  v_mul_f32 v52, s42, v52
  v_mul_f32 v53, s42, v53
  v_mul_f32 v54, s42, v54
  v_mul_f32 v55, s42, v55
  v_mul_f32 v56, s42, v56
  v_mfma_f32_16x16x32_bf16 a[196:199], a[164:167], v[152:155], a[196:199]
  s_waitcnt lgkmcnt(8)
  v_mfma_f32_16x16x32_bf16 a[208:211], a[168:171], v[152:155], a[208:211]
  s_barrier
  ds_read_b128 a[160:163], v224 offset:0
  v_mul_f32 v57, s42, v57
  v_mul_f32 v58, s42, v58
  v_mul_f32 v59, s42, v59
  v_mul_f32 v60, s42, v60
  v_mfma_f32_16x16x32_bf16 a[216:219], a[168:171], v[156:159], a[216:219]
  v_mfma_f32_16x16x32_bf16 a[220:223], a[172:175], v[156:159], a[220:223]
  ds_read_b128 a[164:167], v224 offset:4096
  s_add_u32 m0, s41, 98304
  s_nop 0
  buffer_load_dwordx4 v248, s[12:15], s33 offen offset:0 nt lds
  v_mul_f32 v61, s42, v61
  v_mul_f32 v62, s42, v62
  v_mfma_f32_16x16x32_bf16 a[212:215], a[172:175], v[152:155], a[212:215]
  s_waitcnt lgkmcnt(6)
  v_mfma_f32_16x16x32_bf16 a[224:227], a[176:179], v[152:155], a[224:227]
  ds_read_b128 a[168:171], v225 offset:0
  v_mul_f32 v63, s42, v63
  v_cvt_pk_bf16_f32 v184, v48, v49
  v_cvt_pk_bf16_f32 v185, v50, v51
  v_cvt_pk_bf16_f32 v186, v52, v53
  v_cvt_pk_bf16_f32 v187, v54, v55
  v_cvt_pk_bf16_f32 v188, v56, v57
  v_mfma_f32_16x16x32_bf16 a[232:235], a[176:179], v[156:159], a[232:235]
  v_mfma_f32_16x16x32_bf16 a[236:239], a[180:183], v[156:159], a[236:239]
  ds_read_b128 a[172:175], v225 offset:4096
  v_cvt_pk_bf16_f32 v189, v58, v59
  v_cvt_pk_bf16_f32 v190, v60, v61
  v_cvt_pk_bf16_f32 v191, v62, v63
  v_permlane16_swap_b32 v184, v186
  v_permlane16_swap_b32 v185, v187
  v_mfma_f32_16x16x32_bf16 a[228:231], a[180:183], v[152:155], a[228:231]
  s_waitcnt lgkmcnt(4)
  v_mfma_f32_16x16x32_bf16 a[240:243], a[184:187], v[152:155], a[240:243]
  ds_read_b128 a[176:179], v226 offset:0
  buffer_load_dwordx4 v248, s[12:15], s33 offen offset:1024 nt lds
  v_permlane16_swap_b32 v188, v190
  v_permlane16_swap_b32 v189, v191
  v_mfma_f32_16x16x32_bf16 a[248:251], a[184:187], v[156:159], a[248:251]
  v_mfma_f32_16x16x32_bf16 a[252:255], a[188:191], v[156:159], a[252:255]
  ds_read_b128 a[180:183], v226 offset:4096
  v_mfma_f32_16x16x32_bf16 a[244:247], a[188:191], v[152:155], a[244:247]
CST:
  s_waitcnt lgkmcnt(4)
  v_mfma_f32_16x16x32_bf16 v[64:67], a[160:163], v[160:163], 0
  ds_read_b128 a[184:187], v227 offset:0
  v_mov_b32 v216, v249
  v_mov_b32 v217, v254
  s_nop 1
  v_permlane16_swap_b32 v216, v217
  v_add_f32 v216, v216, v217
  v_mov_b32 v217, v216
  v_mfma_f32_16x16x32_bf16 v[72:75], a[160:163], v[164:167], 0
  v_mfma_f32_16x16x32_bf16 v[76:79], a[164:167], v[164:167], 0
  ds_read_b128 a[188:191], v227 offset:4096
  buffer_load_dwordx4 v248, s[12:15], s33 offen offset:2048 nt lds
  v_permlane32_swap_b32 v216, v217
  v_add_f32 v216, v216, v217
  v_mfma_f32_16x16x32_bf16 v[68:71], a[164:167], v[160:163], 0
  s_waitcnt lgkmcnt(4)
  v_mfma_f32_16x16x32_bf16 v[64:67], a[168:171], v[168:171], v[64:67]
  ds_read_b128 a[160:163], v224 offset:2048
  v_rcp_f32 v250, v216
  s_nop 0
  v_mov_b32 v255, v250
  s_nop 1
  v_permlane16_swap_b32 v250, v255
  v_mfma_f32_16x16x32_bf16 v[72:75], a[168:171], v[172:175], v[72:75]
  v_mfma_f32_16x16x32_bf16 v[76:79], a[172:175], v[172:175], v[76:79]
  ds_read_b128 a[164:167], v224 offset:6144
  v_accvgpr_read_b32 v220, a196
  v_accvgpr_read_b32 v221, a197
  v_accvgpr_read_b32 v222, a198
  v_accvgpr_read_b32 v223, a199
  v_accvgpr_read_b32 v216, a192
  v_mfma_f32_16x16x32_bf16 v[68:71], a[172:175], v[168:171], v[68:71]
  s_waitcnt lgkmcnt(4)
  v_mfma_f32_16x16x32_bf16 v[64:67], a[176:179], v[176:179], v[64:67]
  ds_read_b128 a[168:171], v225 offset:2048
  buffer_load_dwordx4 v248, s[12:15], s33 offen offset:3072 nt lds
  s_add_u32 s33, s33, 0x4000
  v_accvgpr_read_b32 v217, a193
  v_accvgpr_read_b32 v218, a194
  v_mfma_f32_16x16x32_bf16 v[72:75], a[176:179], v[180:183], v[72:75]
  v_mfma_f32_16x16x32_bf16 v[76:79], a[180:183], v[180:183], v[76:79]
  ds_read_b128 a[172:175], v225 offset:6144
  v_accvgpr_read_b32 v219, a195
  v_mul_f32 v220, v250, v220
  v_mul_f32 v221, v250, v221
  v_mul_f32 v222, v250, v222
  v_mul_f32 v223, v250, v223
  v_mul_f32 v216, v250, v216
  v_mfma_f32_16x16x32_bf16 v[68:71], a[180:183], v[176:179], v[68:71]
  s_waitcnt lgkmcnt(4)
  v_mfma_f32_16x16x32_bf16 v[64:67], a[184:187], v[184:187], v[64:67]
  ds_read_b128 a[176:179], v226 offset:2048
  v_mul_f32 v217, v250, v217
  v_mul_f32 v218, v250, v218
  v_mul_f32 v219, v250, v219
  v_cvt_pk_bf16_f32 v216, v216, v217
  v_cvt_pk_bf16_f32 v217, v218, v219
  v_mfma_f32_16x16x32_bf16 v[72:75], a[184:187], v[188:191], v[72:75]
  v_mfma_f32_16x16x32_bf16 v[76:79], a[188:191], v[188:191], v[76:79]
  ds_read_b128 a[180:183], v226 offset:6144
  v_cvt_pk_bf16_f32 v218, v220, v221
  v_cvt_pk_bf16_f32 v219, v222, v223
  s_nop 0
  v_permlane16_swap_b32 v216, v218
  v_permlane16_swap_b32 v217, v219
  v_accvgpr_write_b32 a128, v216
  v_mfma_f32_16x16x32_bf16 v[68:71], a[188:191], v[184:187], v[68:71]
  s_waitcnt lgkmcnt(4)
  v_mfma_f32_16x16x32_bf16 v[80:83], a[160:163], v[160:163], 0
  ds_read_b128 a[184:187], v227 offset:2048
  v_accvgpr_write_b32 a129, v217
  v_accvgpr_write_b32 a130, v218
  v_accvgpr_write_b32 a131, v219
  v_accvgpr_read_b32 v220, a204
  v_accvgpr_read_b32 v221, a205
  v_mfma_f32_16x16x32_bf16 v[88:91], a[160:163], v[164:167], 0
  v_mfma_f32_16x16x32_bf16 v[92:95], a[164:167], v[164:167], 0
  ds_read_b128 a[188:191], v227 offset:6144
  v_accvgpr_read_b32 v222, a206
  v_accvgpr_read_b32 v223, a207
  v_accvgpr_read_b32 v216, a200
  v_accvgpr_read_b32 v217, a201
  v_accvgpr_read_b32 v218, a202
  v_accvgpr_read_b32 v219, a203
  v_mfma_f32_16x16x32_bf16 v[84:87], a[164:167], v[160:163], 0
  s_waitcnt lgkmcnt(4)
  v_mfma_f32_16x16x32_bf16 v[80:83], a[168:171], v[168:171], v[80:83]
  s_waitcnt vmcnt(20)
  s_barrier
  ds_read_b64_tr_b16 a[160:161], v232 offset:0
  ds_read_b64_tr_b16 a[162:163], v232 offset:1024
  v_mul_f32 v220, v255, v220
  v_mul_f32 v221, v255, v221
  v_mul_f32 v222, v255, v222
  v_mfma_f32_16x16x32_bf16 v[88:91], a[168:171], v[172:175], v[88:91]
  v_mfma_f32_16x16x32_bf16 v[92:95], a[172:175], v[172:175], v[92:95]
  ds_read_b64_tr_b16 a[164:165], v233 offset:0
  ds_read_b64_tr_b16 a[166:167], v233 offset:1024
  s_add_u32 s34, s76, 327680
  s_add_u32 m0, s41, 114688
  s_nop 0
  buffer_load_dwordx4 v244, s[64:67], s34 offen offset:0 lds
  v_mul_f32 v223, v255, v223
  v_mfma_f32_16x16x32_bf16 v[84:87], a[172:175], v[168:171], v[84:87]
  v_mul_f32 v216, v255, v216
  s_waitcnt lgkmcnt(6)
  v_mfma_f32_16x16x32_bf16 v[80:83], a[176:179], v[176:179], v[80:83]
  ds_read_b64_tr_b16 a[168:169], v234 offset:0
  ds_read_b64_tr_b16 a[170:171], v234 offset:1024
  v_mul_f32 v217, v255, v217
  v_mul_f32 v218, v255, v218
  v_mul_f32 v219, v255, v219
  v_cvt_pk_bf16_f32 v216, v216, v217
  v_cvt_pk_bf16_f32 v217, v218, v219
  v_mfma_f32_16x16x32_bf16 v[88:91], a[176:179], v[180:183], v[88:91]
  v_mfma_f32_16x16x32_bf16 v[92:95], a[180:183], v[180:183], v[92:95]
  ds_read_b64_tr_b16 a[172:173], v235 offset:0
  ds_read_b64_tr_b16 a[174:175], v235 offset:1024
  v_cvt_pk_bf16_f32 v218, v220, v221
  v_cvt_pk_bf16_f32 v219, v222, v223
  s_nop 0
  v_permlane16_swap_b32 v216, v218
  v_mfma_f32_16x16x32_bf16 v[84:87], a[180:183], v[176:179], v[84:87]
  s_waitcnt lgkmcnt(8)
  v_mfma_f32_16x16x32_bf16 v[80:83], a[184:187], v[184:187], v[80:83]
  ds_read_b64_tr_b16 a[176:177], v236 offset:0
  ds_read_b64_tr_b16 a[178:179], v236 offset:1024
  buffer_load_dwordx4 v245, s[64:67], s34 offen offset:1024 lds
  v_permlane16_swap_b32 v217, v219
  v_accvgpr_write_b32 a132, v216
  v_mfma_f32_16x16x32_bf16 v[88:91], a[184:187], v[188:191], v[88:91]
  v_mfma_f32_16x16x32_bf16 v[92:95], a[188:191], v[188:191], v[92:95]
  ds_read_b64_tr_b16 a[180:181], v237 offset:0
  ds_read_b64_tr_b16 a[182:183], v237 offset:1024
  v_accvgpr_write_b32 a133, v217
  v_accvgpr_write_b32 a134, v218
  v_accvgpr_write_b32 a135, v219
  v_accvgpr_read_b32 v220, a212
  v_accvgpr_read_b32 v221, a213
  v_mfma_f32_16x16x32_bf16 v[84:87], a[188:191], v[184:187], v[84:87]
  s_waitcnt lgkmcnt(8)
  v_mfma_f32_16x16x32_bf16 v[0:3], a[160:163], a[32:35], 0
  ds_read_b64_tr_b16 a[184:185], v238 offset:0
  ds_read_b64_tr_b16 a[186:187], v238 offset:1024
  v_accvgpr_read_b32 v222, a214
  v_accvgpr_read_b32 v223, a215
  v_accvgpr_read_b32 v216, a208
  v_accvgpr_read_b32 v217, a209
  v_accvgpr_read_b32 v218, a210
  v_mfma_f32_16x16x32_bf16 v[8:11], a[160:163], a[36:39], 0
  v_mfma_f32_16x16x32_bf16 v[12:15], a[164:167], a[36:39], 0
  ds_read_b64_tr_b16 a[188:189], v239 offset:0
  ds_read_b64_tr_b16 a[190:191], v239 offset:1024
  buffer_load_dwordx4 v246, s[64:67], s34 offen offset:2048 lds
  v_accvgpr_read_b32 v219, a211
  v_mul_f32 v220, v250, v220
  v_mfma_f32_16x16x32_bf16 v[4:7], a[164:167], a[32:35], 0
  s_waitcnt lgkmcnt(8)
  v_mfma_f32_16x16x32_bf16 v[16:19], a[168:171], a[32:35], 0
  ds_read_b64_tr_b16 a[160:161], v232 offset:8192
  ds_read_b64_tr_b16 a[162:163], v232 offset:9216
  v_max3_f32 v214, v64, v65, v66
  v_max3_f32 v215, v72, v73, v74
  v_max3_f32 v214, v214, v67, v68
  v_max3_f32 v215, v215, v75, v76
  v_max3_f32 v214, v214, v69, v70
  v_mfma_f32_16x16x32_bf16 v[24:27], a[168:171], a[36:39], 0
  v_mfma_f32_16x16x32_bf16 v[28:31], a[172:175], a[36:39], 0
  ds_read_b64_tr_b16 a[164:165], v233 offset:8192
  ds_read_b64_tr_b16 a[166:167], v233 offset:9216
  v_max3_f32 v215, v215, v77, v78
  v_max3_f32 v214, v214, v71, v80
  v_max3_f32 v215, v215, v79, v88
  v_max3_f32 v214, v214, v81, v82
  v_mfma_f32_16x16x32_bf16 v[20:23], a[172:175], a[32:35], 0
  s_waitcnt lgkmcnt(8)
  v_mfma_f32_16x16x32_bf16 v[32:35], a[176:179], a[32:35], 0
  ds_read_b64_tr_b16 a[168:169], v234 offset:8192
  ds_read_b64_tr_b16 a[170:171], v234 offset:9216
  buffer_load_dwordx4 v247, s[64:67], s34 offen offset:3072 lds
  v_max3_f32 v215, v215, v89, v90
  v_max3_f32 v214, v214, v83, v84
  v_max3_f32 v215, v215, v91, v92
  v_mfma_f32_16x16x32_bf16 v[40:43], a[176:179], a[36:39], 0
  v_mfma_f32_16x16x32_bf16 v[44:47], a[180:183], a[36:39], 0
  ds_read_b64_tr_b16 a[172:173], v235 offset:8192
  ds_read_b64_tr_b16 a[174:175], v235 offset:9216
  v_max3_f32 v214, v214, v85, v86
  v_max3_f32 v215, v215, v93, v94
  v_max_f32 v214, v214, v87
  v_max_f32 v215, v215, v95
  v_mfma_f32_16x16x32_bf16 v[36:39], a[180:183], a[32:35], 0
  s_waitcnt lgkmcnt(8)
  v_mfma_f32_16x16x32_bf16 v[48:51], a[184:187], a[32:35], 0
  ds_read_b64_tr_b16 a[176:177], v236 offset:8192
  ds_read_b64_tr_b16 a[178:179], v236 offset:9216
  v_permlane16_swap_b32 v214, v215
  v_max_f32 v214, v214, v215
  v_mov_b32 v215, v214
  s_nop 1
  v_permlane32_swap_b32 v214, v215
  v_mfma_f32_16x16x32_bf16 v[56:59], a[184:187], a[36:39], 0
  v_mfma_f32_16x16x32_bf16 v[60:63], a[188:191], a[36:39], 0
  ds_read_b64_tr_b16 a[180:181], v237 offset:8192
  ds_read_b64_tr_b16 a[182:183], v237 offset:9216
  v_min_f32 v192, -v214, -v215
  v_mov_b32 v196, v192
  s_nop 1
  v_permlane16_swap_b32 v192, v196
  v_mfma_f32_16x16x32_bf16 v[52:55], a[188:191], a[32:35], 0
  s_waitcnt lgkmcnt(8)
  v_mfma_f32_16x16x32_bf16 v[0:3], a[160:163], a[40:43], v[0:3]
  ds_read_b64_tr_b16 a[184:185], v238 offset:8192
  ds_read_b64_tr_b16 a[186:187], v238 offset:9216
  v_mov_b32 v193, v192
  v_mov_b32 v194, v192
  v_mov_b32 v195, v192
  v_mfma_f32_16x16x32_bf16 v[8:11], a[160:163], a[44:47], v[8:11]
  v_mfma_f32_16x16x32_bf16 v[12:15], a[164:167], a[44:47], v[12:15]
  ds_read_b64_tr_b16 a[188:189], v239 offset:8192
  ds_read_b64_tr_b16 a[190:191], v239 offset:9216
  v_mov_b32 v197, v196
  v_mov_b32 v198, v196
  v_mov_b32 v199, v196
  v_mul_f32 v221, v250, v221
  v_mul_f32 v222, v250, v222
  v_mfma_f32_16x16x32_bf16 v[4:7], a[164:167], a[40:43], v[4:7]
  s_waitcnt lgkmcnt(8)
  v_mfma_f32_16x16x32_bf16 v[16:19], a[168:171], a[40:43], v[16:19]
  s_waitcnt vmcnt(20)
  s_barrier
  ds_read_b64_tr_b16 a[160:161], v200 offset:0
  ds_read_b64_tr_b16 a[162:163], v200 offset:1024
  v_mul_f32 v223, v250, v223
  v_mul_f32 v216, v250, v216
  v_mul_f32 v217, v250, v217
  v_mfma_f32_16x16x32_bf16 v[24:27], a[168:171], a[44:47], v[24:27]
  v_mfma_f32_16x16x32_bf16 v[28:31], a[172:175], a[44:47], v[28:31]
  ds_read_b64_tr_b16 a[164:165], v201 offset:0
  ds_read_b64_tr_b16 a[166:167], v201 offset:1024
  s_add_u32 m0, s41, 0
  s_nop 0
  buffer_load_dwordx4 v240, s[8:11], s32 offen offset:0 nt lds
  v_mul_f32 v218, v250, v218
  v_mul_f32 v219, v250, v219
  v_mfma_f32_16x16x32_bf16 v[20:23], a[172:175], a[40:43], v[20:23]
  s_waitcnt lgkmcnt(8)
  v_mfma_f32_16x16x32_bf16 v[32:35], a[176:179], a[40:43], v[32:35]
  ds_read_b64_tr_b16 a[168:169], v202 offset:0
  ds_read_b64_tr_b16 a[170:171], v202 offset:1024
  v_cvt_pk_bf16_f32 v216, v216, v217
  v_cvt_pk_bf16_f32 v217, v218, v219
  v_cvt_pk_bf16_f32 v218, v220, v221
  v_cvt_pk_bf16_f32 v219, v222, v223
  s_nop 0
  v_permlane16_swap_b32 v216, v218
  v_mfma_f32_16x16x32_bf16 v[40:43], a[176:179], a[44:47], v[40:43]
  v_mfma_f32_16x16x32_bf16 v[44:47], a[180:183], a[44:47], v[44:47]
  ds_read_b64_tr_b16 a[172:173], v203 offset:0
  ds_read_b64_tr_b16 a[174:175], v203 offset:1024
  v_permlane16_swap_b32 v217, v219
  v_accvgpr_write_b32 a136, v216
  v_accvgpr_write_b32 a137, v217
  v_mfma_f32_16x16x32_bf16 v[36:39], a[180:183], a[40:43], v[36:39]
  s_waitcnt lgkmcnt(8)
  v_mfma_f32_16x16x32_bf16 v[48:51], a[184:187], a[40:43], v[48:51]
  ds_read_b64_tr_b16 a[176:177], v204 offset:0
  ds_read_b64_tr_b16 a[178:179], v204 offset:1024
  buffer_load_dwordx4 v241, s[8:11], s32 offen offset:1024 nt lds
  v_accvgpr_write_b32 a138, v218
  v_accvgpr_write_b32 a139, v219
  v_accvgpr_read_b32 v220, a220
  v_mfma_f32_16x16x32_bf16 v[56:59], a[184:187], a[44:47], v[56:59]
  v_mfma_f32_16x16x32_bf16 v[60:63], a[188:191], a[44:47], v[60:63]
  ds_read_b64_tr_b16 a[180:181], v205 offset:0
  ds_read_b64_tr_b16 a[182:183], v205 offset:1024
  v_accvgpr_read_b32 v221, a221
  v_accvgpr_read_b32 v222, a222
  v_accvgpr_read_b32 v223, a223
  v_accvgpr_read_b32 v216, a216
  v_mfma_f32_16x16x32_bf16 v[52:55], a[188:191], a[40:43], v[52:55]
  s_waitcnt lgkmcnt(8)
  v_mfma_f32_16x16x32_bf16 v[0:3], a[160:163], a[48:51], v[0:3]
  ds_read_b64_tr_b16 a[184:185], v206 offset:0
  ds_read_b64_tr_b16 a[186:187], v206 offset:1024
  v_accvgpr_read_b32 v217, a217
  v_accvgpr_read_b32 v218, a218
  v_accvgpr_read_b32 v219, a219
  v_mul_f32 v220, v255, v220
  v_mul_f32 v221, v255, v221
  v_mfma_f32_16x16x32_bf16 v[8:11], a[160:163], a[52:55], v[8:11]
  v_mfma_f32_16x16x32_bf16 v[12:15], a[164:167], a[52:55], v[12:15]
  ds_read_b64_tr_b16 a[188:189], v207 offset:0
  ds_read_b64_tr_b16 a[190:191], v207 offset:1024
  buffer_load_dwordx4 v242, s[8:11], s32 offen offset:2048 nt lds
  v_mul_f32 v222, v255, v222
  v_mul_f32 v223, v255, v223
  v_mfma_f32_16x16x32_bf16 v[4:7], a[164:167], a[48:51], v[4:7]
  s_waitcnt lgkmcnt(8)
  v_mfma_f32_16x16x32_bf16 v[16:19], a[168:171], a[48:51], v[16:19]
  ds_read_b64_tr_b16 a[160:161], v200 offset:8192
  ds_read_b64_tr_b16 a[162:163], v200 offset:9216
  v_mul_f32 v216, v255, v216
  v_mul_f32 v217, v255, v217
  v_mul_f32 v218, v255, v218
  v_mul_f32 v219, v255, v219
  v_cvt_pk_bf16_f32 v216, v216, v217
  v_mfma_f32_16x16x32_bf16 v[24:27], a[168:171], a[52:55], v[24:27]
  v_mfma_f32_16x16x32_bf16 v[28:31], a[172:175], a[52:55], v[28:31]
  ds_read_b64_tr_b16 a[164:165], v201 offset:8192
  ds_read_b64_tr_b16 a[166:167], v201 offset:9216
  v_cvt_pk_bf16_f32 v217, v218, v219
  v_cvt_pk_bf16_f32 v218, v220, v221
  v_cvt_pk_bf16_f32 v219, v222, v223
  s_nop 0
  v_permlane16_swap_b32 v216, v218
  v_mfma_f32_16x16x32_bf16 v[20:23], a[172:175], a[48:51], v[20:23]
  s_waitcnt lgkmcnt(8)
  v_mfma_f32_16x16x32_bf16 v[32:35], a[176:179], a[48:51], v[32:35]
  ds_read_b64_tr_b16 a[168:169], v202 offset:8192
  ds_read_b64_tr_b16 a[170:171], v202 offset:9216
  buffer_load_dwordx4 v243, s[8:11], s32 offen offset:3072 nt lds
  s_add_u32 s32, s32, 0x4000
  v_permlane16_swap_b32 v217, v219
  v_accvgpr_write_b32 a140, v216
  v_mfma_f32_16x16x32_bf16 v[40:43], a[176:179], a[52:55], v[40:43]
  v_mfma_f32_16x16x32_bf16 v[44:47], a[180:183], a[52:55], v[44:47]
  ds_read_b64_tr_b16 a[172:173], v203 offset:8192
  ds_read_b64_tr_b16 a[174:175], v203 offset:9216
  v_accvgpr_write_b32 a141, v217
  v_accvgpr_write_b32 a142, v218
  v_accvgpr_write_b32 a143, v219
  v_accvgpr_read_b32 v220, a228
  v_accvgpr_read_b32 v221, a229
  v_mfma_f32_16x16x32_bf16 v[36:39], a[180:183], a[48:51], v[36:39]
  s_waitcnt lgkmcnt(8)
  v_mfma_f32_16x16x32_bf16 v[48:51], a[184:187], a[48:51], v[48:51]
  ds_read_b64_tr_b16 a[176:177], v204 offset:8192
  ds_read_b64_tr_b16 a[178:179], v204 offset:9216
  v_accvgpr_read_b32 v222, a230
  v_accvgpr_read_b32 v223, a231
  v_accvgpr_read_b32 v216, a224
  v_accvgpr_read_b32 v217, a225
  v_accvgpr_read_b32 v218, a226
  v_mfma_f32_16x16x32_bf16 v[56:59], a[184:187], a[52:55], v[56:59]
  v_mfma_f32_16x16x32_bf16 v[60:63], a[188:191], a[52:55], v[60:63]
  ds_read_b64_tr_b16 a[180:181], v205 offset:8192
  ds_read_b64_tr_b16 a[182:183], v205 offset:9216
  v_accvgpr_read_b32 v219, a227
  v_mul_f32 v220, v250, v220
  v_mul_f32 v221, v250, v221
  v_mul_f32 v222, v250, v222
  v_mfma_f32_16x16x32_bf16 v[52:55], a[188:191], a[48:51], v[52:55]
  s_waitcnt lgkmcnt(8)
  v_mfma_f32_16x16x32_bf16 v[0:3], a[160:163], a[56:59], v[0:3]
  ds_read_b64_tr_b16 a[184:185], v206 offset:8192
  ds_read_b64_tr_b16 a[186:187], v206 offset:9216
  v_mul_f32 v223, v250, v223
  v_mul_f32 v216, v250, v216
  v_mul_f32 v217, v250, v217
  v_mul_f32 v218, v250, v218
  v_mul_f32 v219, v250, v219
  v_mfma_f32_16x16x32_bf16 v[8:11], a[160:163], a[60:63], v[8:11]
  v_mfma_f32_16x16x32_bf16 v[12:15], a[164:167], a[60:63], v[12:15]
  ds_read_b64_tr_b16 a[188:189], v207 offset:8192
  ds_read_b64_tr_b16 a[190:191], v207 offset:9216
  v_cvt_pk_bf16_f32 v216, v216, v217
  v_cvt_pk_bf16_f32 v217, v218, v219
  v_cvt_pk_bf16_f32 v218, v220, v221
  v_cvt_pk_bf16_f32 v219, v222, v223
  s_nop 0
  v_permlane16_swap_b32 v216, v218
  v_mfma_f32_16x16x32_bf16 v[4:7], a[164:167], a[56:59], v[4:7]
  s_waitcnt lgkmcnt(8)
  v_mfma_f32_16x16x32_bf16 v[16:19], a[168:171], a[56:59], v[16:19]
  s_barrier
  ds_read_b128 a[160:163], v224 offset:16384
  v_permlane16_swap_b32 v217, v219
  v_accvgpr_write_b32 a144, v216
  v_accvgpr_write_b32 a145, v217
  v_accvgpr_write_b32 a146, v218
  v_mfma_f32_16x16x32_bf16 v[24:27], a[168:171], a[60:63], v[24:27]
  v_mfma_f32_16x16x32_bf16 v[28:31], a[172:175], a[60:63], v[28:31]
  ds_read_b128 a[164:167], v224 offset:20480
  s_add_u32 m0, s41, 65536
  s_nop 0
  buffer_load_dwordx4 v248, s[12:15], s33 offen offset:0 nt lds
  v_accvgpr_write_b32 a147, v219
  v_accvgpr_read_b32 v220, a236
  v_mfma_f32_16x16x32_bf16 v[20:23], a[172:175], a[56:59], v[20:23]
  s_waitcnt lgkmcnt(6)
  v_mfma_f32_16x16x32_bf16 v[32:35], a[176:179], a[56:59], v[32:35]
  ds_read_b128 a[168:171], v225 offset:16384
  v_accvgpr_read_b32 v221, a237
  v_accvgpr_read_b32 v222, a238
  v_accvgpr_read_b32 v223, a239
  v_accvgpr_read_b32 v216, a232
  v_accvgpr_read_b32 v217, a233
  v_accvgpr_read_b32 v218, a234
  v_mfma_f32_16x16x32_bf16 v[40:43], a[176:179], a[60:63], v[40:43]
  v_mfma_f32_16x16x32_bf16 v[44:47], a[180:183], a[60:63], v[44:47]
  ds_read_b128 a[172:175], v225 offset:20480
  v_accvgpr_read_b32 v219, a235
  v_mul_f32 v220, v255, v220
  v_mul_f32 v221, v255, v221
  v_mul_f32 v222, v255, v222
  v_mul_f32 v223, v255, v223
  v_mul_f32 v216, v255, v216
  v_mfma_f32_16x16x32_bf16 v[36:39], a[180:183], a[56:59], v[36:39]
  s_waitcnt lgkmcnt(4)
  v_mfma_f32_16x16x32_bf16 v[48:51], a[184:187], a[56:59], v[48:51]
  ds_read_b128 a[176:179], v226 offset:16384
  buffer_load_dwordx4 v248, s[12:15], s33 offen offset:1024 nt lds
  v_mul_f32 v217, v255, v217
  v_mul_f32 v218, v255, v218
  v_mfma_f32_16x16x32_bf16 v[56:59], a[184:187], a[60:63], v[56:59]
  v_mfma_f32_16x16x32_bf16 v[60:63], a[188:191], a[60:63], v[60:63]
  ds_read_b128 a[180:183], v226 offset:20480
  v_mul_f32 v219, v255, v219
  v_cvt_pk_bf16_f32 v216, v216, v217
  v_cvt_pk_bf16_f32 v217, v218, v219
  v_cvt_pk_bf16_f32 v218, v220, v221
  v_cvt_pk_bf16_f32 v219, v222, v223
  s_nop 0
  v_permlane16_swap_b32 v216, v218
  v_mfma_f32_16x16x32_bf16 v[52:55], a[188:191], a[56:59], v[52:55]
  s_waitcnt lgkmcnt(4)
  v_mfma_f32_16x16x32_bf16 v[96:99], a[160:163], v[160:163], v[192:195]
  ds_read_b128 a[184:187], v227 offset:16384
  v_permlane16_swap_b32 v217, v219
  v_accvgpr_write_b32 a148, v216
  v_accvgpr_write_b32 a149, v217
  v_accvgpr_write_b32 a150, v218
  v_mfma_f32_16x16x32_bf16 v[104:107], a[160:163], v[164:167], v[196:199]
  v_mfma_f32_16x16x32_bf16 v[108:111], a[164:167], v[164:167], v[196:199]
  ds_read_b128 a[188:191], v227 offset:20480
  buffer_load_dwordx4 v248, s[12:15], s33 offen offset:2048 nt lds
  v_accvgpr_write_b32 a151, v219
  v_accvgpr_read_b32 v220, a244
  v_accvgpr_read_b32 v221, a245
  v_mfma_f32_16x16x32_bf16 v[100:103], a[164:167], v[160:163], v[192:195]
  s_waitcnt lgkmcnt(4)
  v_mfma_f32_16x16x32_bf16 v[96:99], a[168:171], v[168:171], v[96:99]
  ds_read_b128 a[160:163], v224 offset:18432
  v_accvgpr_read_b32 v222, a246
  v_accvgpr_read_b32 v223, a247
  v_accvgpr_read_b32 v216, a240
  v_accvgpr_read_b32 v217, a241
  v_accvgpr_read_b32 v218, a242
  v_mfma_f32_16x16x32_bf16 v[104:107], a[168:171], v[172:175], v[104:107]
  v_mfma_f32_16x16x32_bf16 v[108:111], a[172:175], v[172:175], v[108:111]
  ds_read_b128 a[164:167], v224 offset:22528
  v_accvgpr_read_b32 v219, a243
  v_mul_f32 v220, v250, v220
  v_mul_f32 v221, v250, v221
  v_mul_f32 v222, v250, v222
  v_mul_f32 v223, v250, v223
  v_mul_f32 v216, v250, v216
  v_mfma_f32_16x16x32_bf16 v[100:103], a[172:175], v[168:171], v[100:103]
  s_waitcnt lgkmcnt(4)
  v_mfma_f32_16x16x32_bf16 v[96:99], a[176:179], v[176:179], v[96:99]
  ds_read_b128 a[168:171], v225 offset:18432
  buffer_load_dwordx4 v248, s[12:15], s33 offen offset:3072 nt lds
  s_add_u32 s33, s33, 0x4000
  v_mul_f32 v217, v250, v217
  v_mul_f32 v218, v250, v218
  v_mul_f32 v219, v250, v219
  v_mfma_f32_16x16x32_bf16 v[104:107], a[176:179], v[180:183], v[104:107]
  v_mfma_f32_16x16x32_bf16 v[108:111], a[180:183], v[180:183], v[108:111]
  ds_read_b128 a[172:175], v225 offset:22528
  v_cvt_pk_bf16_f32 v216, v216, v217
  v_cvt_pk_bf16_f32 v217, v218, v219
  v_cvt_pk_bf16_f32 v218, v220, v221
  v_cvt_pk_bf16_f32 v219, v222, v223
  s_nop 0
  v_permlane16_swap_b32 v216, v218
  v_mfma_f32_16x16x32_bf16 v[100:103], a[180:183], v[176:179], v[100:103]
  s_waitcnt lgkmcnt(4)
  v_mfma_f32_16x16x32_bf16 v[96:99], a[184:187], v[184:187], v[96:99]
  ds_read_b128 a[176:179], v226 offset:18432
  v_permlane16_swap_b32 v217, v219
  v_accvgpr_write_b32 a152, v216
  v_accvgpr_write_b32 a153, v217
  v_accvgpr_write_b32 a154, v218
  v_accvgpr_write_b32 a155, v219
  v_mfma_f32_16x16x32_bf16 v[104:107], a[184:187], v[188:191], v[104:107]
  v_mfma_f32_16x16x32_bf16 v[108:111], a[188:191], v[188:191], v[108:111]
  ds_read_b128 a[180:183], v226 offset:22528
  v_accvgpr_read_b32 v220, a252
  v_accvgpr_read_b32 v221, a253
  v_accvgpr_read_b32 v222, a254
  v_accvgpr_read_b32 v223, a255
  v_accvgpr_read_b32 v216, a248
  v_accvgpr_read_b32 v217, a249
  v_mfma_f32_16x16x32_bf16 v[100:103], a[188:191], v[184:187], v[100:103]
  s_waitcnt lgkmcnt(4)
  v_mfma_f32_16x16x32_bf16 v[112:115], a[160:163], v[160:163], v[192:195]
  ds_read_b128 a[184:187], v227 offset:18432
  v_accvgpr_read_b32 v218, a250
  v_accvgpr_read_b32 v219, a251
  v_mul_f32 v220, v255, v220
  v_mul_f32 v221, v255, v221
  v_mul_f32 v222, v255, v222
  v_mul_f32 v223, v255, v223
  v_mfma_f32_16x16x32_bf16 v[120:123], a[160:163], v[164:167], v[196:199]
  v_mfma_f32_16x16x32_bf16 v[124:127], a[164:167], v[164:167], v[196:199]
  ds_read_b128 a[188:191], v227 offset:22528
  v_mul_f32 v216, v255, v216
  v_mul_f32 v217, v255, v217
  v_mul_f32 v218, v255, v218
  v_mul_f32 v219, v255, v219
  v_cvt_pk_bf16_f32 v216, v216, v217
  v_cvt_pk_bf16_f32 v217, v218, v219
  v_mfma_f32_16x16x32_bf16 v[116:119], a[164:167], v[160:163], v[192:195]
  s_waitcnt lgkmcnt(4)
  v_mfma_f32_16x16x32_bf16 v[112:115], a[168:171], v[168:171], v[112:115]
  s_waitcnt vmcnt(20)
  s_barrier
  ds_read_b64_tr_b16 a[160:161], v200 offset:16384
  ds_read_b64_tr_b16 a[162:163], v200 offset:17408
  v_cvt_pk_bf16_f32 v218, v220, v221
  v_cvt_pk_bf16_f32 v219, v222, v223
  v_mfma_f32_16x16x32_bf16 v[120:123], a[168:171], v[172:175], v[120:123]
  v_mfma_f32_16x16x32_bf16 v[124:127], a[172:175], v[172:175], v[124:127]
  ds_read_b64_tr_b16 a[164:165], v201 offset:16384
  ds_read_b64_tr_b16 a[166:167], v201 offset:17408
  s_add_u32 s34, s76, 409600
  s_add_u32 m0, s41, 131072
  s_nop 0
  buffer_load_dwordx4 v244, s[64:67], s34 offen offset:0 lds
  v_permlane16_swap_b32 v216, v218
  v_mfma_f32_16x16x32_bf16 v[116:119], a[172:175], v[168:171], v[116:119]
  v_permlane16_swap_b32 v217, v219
  v_accvgpr_write_b32 a156, v216
  s_waitcnt lgkmcnt(6)
  v_mfma_f32_16x16x32_bf16 v[112:115], a[176:179], v[176:179], v[112:115]
  ds_read_b64_tr_b16 a[168:169], v202 offset:16384
  ds_read_b64_tr_b16 a[170:171], v202 offset:17408
  v_accvgpr_write_b32 a157, v217
  v_accvgpr_write_b32 a158, v218
  v_accvgpr_write_b32 a159, v219
  v_add_f32 v208, v64, v192
  v_add_f32 v209, v65, v192
  v_mfma_f32_16x16x32_bf16 v[120:123], a[176:179], v[180:183], v[120:123]
  v_mfma_f32_16x16x32_bf16 v[124:127], a[180:183], v[180:183], v[124:127]
  ds_read_b64_tr_b16 a[172:173], v203 offset:16384
  ds_read_b64_tr_b16 a[174:175], v203 offset:17408
  v_exp_f32 v208, v208
  v_exp_f32 v209, v209
  v_mfma_f32_16x16x32_bf16 v[116:119], a[180:183], v[176:179], v[116:119]
  s_waitcnt lgkmcnt(8)
  v_mfma_f32_16x16x32_bf16 v[112:115], a[184:187], v[184:187], v[112:115]
  ds_read_b64_tr_b16 a[176:177], v204 offset:16384
  ds_read_b64_tr_b16 a[178:179], v204 offset:17408
  buffer_load_dwordx4 v245, s[64:67], s34 offen offset:1024 lds
  v_add_f32 v210, v66, v192
  v_add_f32 v211, v67, v192
  v_mfma_f32_16x16x32_bf16 v[120:123], a[184:187], v[188:191], v[120:123]
  v_mfma_f32_16x16x32_bf16 v[124:127], a[188:191], v[188:191], v[124:127]
  ds_read_b64_tr_b16 a[180:181], v205 offset:16384
  ds_read_b64_tr_b16 a[182:183], v205 offset:17408
  v_exp_f32 v210, v210
  v_exp_f32 v211, v211
  v_add_f32 v214, v208, v209
  v_cvt_pk_bf16_f32 v128, v208, v209
  v_mfma_f32_16x16x32_bf16 v[116:119], a[188:191], v[184:187], v[116:119]
  s_waitcnt lgkmcnt(8)
  v_mfma_f32_16x16x32_bf16 v[0:3], a[160:163], a[0:3], v[0:3]
  ds_read_b64_tr_b16 a[184:185], v206 offset:16384
  ds_read_b64_tr_b16 a[186:187], v206 offset:17408
  v_add_f32 v212, v68, v192
  v_add_f32 v213, v69, v192
  v_exp_f32 v212, v212
  v_mfma_f32_16x16x32_bf16 v[8:11], a[160:163], a[4:7], v[8:11]
  v_mfma_f32_16x16x32_bf16 v[12:15], a[164:167], a[4:7], v[12:15]
  ds_read_b64_tr_b16 a[188:189], v207 offset:16384
  ds_read_b64_tr_b16 a[190:191], v207 offset:17408
  buffer_load_dwordx4 v246, s[64:67], s34 offen offset:2048 lds
  v_exp_f32 v213, v213
  v_add_f32 v214, v214, v210
  v_mfma_f32_16x16x32_bf16 v[4:7], a[164:167], a[0:3], v[4:7]
  s_waitcnt lgkmcnt(8)
  v_mfma_f32_16x16x32_bf16 v[16:19], a[168:171], a[0:3], v[16:19]
  ds_read_b64_tr_b16 a[160:161], v200 offset:24576
  ds_read_b64_tr_b16 a[162:163], v200 offset:25600
  v_add_f32 v214, v214, v211
  v_cvt_pk_bf16_f32 v129, v210, v211
  v_add_f32 v208, v70, v192
  v_add_f32 v209, v71, v192
  v_mfma_f32_16x16x32_bf16 v[24:27], a[168:171], a[4:7], v[24:27]
  v_mfma_f32_16x16x32_bf16 v[28:31], a[172:175], a[4:7], v[28:31]
  ds_read_b64_tr_b16 a[164:165], v201 offset:24576
  ds_read_b64_tr_b16 a[166:167], v201 offset:25600
  v_exp_f32 v208, v208
  v_exp_f32 v209, v209
  v_add_f32 v214, v214, v212
  v_mfma_f32_16x16x32_bf16 v[20:23], a[172:175], a[0:3], v[20:23]
  s_waitcnt lgkmcnt(8)
  v_mfma_f32_16x16x32_bf16 v[32:35], a[176:179], a[0:3], v[32:35]
  ds_read_b64_tr_b16 a[168:169], v202 offset:24576
  ds_read_b64_tr_b16 a[170:171], v202 offset:25600
  buffer_load_dwordx4 v247, s[64:67], s34 offen offset:3072 lds
  v_add_f32 v214, v214, v213
  v_cvt_pk_bf16_f32 v130, v212, v213
  v_add_f32 v210, v72, v196
  v_mfma_f32_16x16x32_bf16 v[40:43], a[176:179], a[4:7], v[40:43]
  v_mfma_f32_16x16x32_bf16 v[44:47], a[180:183], a[4:7], v[44:47]
  ds_read_b64_tr_b16 a[172:173], v203 offset:24576
  ds_read_b64_tr_b16 a[174:175], v203 offset:25600
  v_add_f32 v211, v73, v196
  v_exp_f32 v210, v210
  v_exp_f32 v211, v211
  v_mfma_f32_16x16x32_bf16 v[36:39], a[180:183], a[0:3], v[36:39]
  s_waitcnt lgkmcnt(8)
  v_mfma_f32_16x16x32_bf16 v[48:51], a[184:187], a[0:3], v[48:51]
  ds_read_b64_tr_b16 a[176:177], v204 offset:24576
  ds_read_b64_tr_b16 a[178:179], v204 offset:25600
  v_add_f32 v214, v214, v208
  v_add_f32 v214, v214, v209
  v_cvt_pk_bf16_f32 v131, v208, v209
  v_add_f32 v212, v74, v196
  v_mfma_f32_16x16x32_bf16 v[56:59], a[184:187], a[4:7], v[56:59]
  v_mfma_f32_16x16x32_bf16 v[60:63], a[188:191], a[4:7], v[60:63]
  ds_read_b64_tr_b16 a[180:181], v205 offset:24576
  ds_read_b64_tr_b16 a[182:183], v205 offset:25600
  v_add_f32 v213, v75, v196
  v_exp_f32 v212, v212
  v_exp_f32 v213, v213
  v_mfma_f32_16x16x32_bf16 v[52:55], a[188:191], a[0:3], v[52:55]
  s_waitcnt lgkmcnt(8)
  v_mfma_f32_16x16x32_bf16 v[0:3], a[160:163], a[8:11], v[0:3]
  ds_read_b64_tr_b16 a[184:185], v206 offset:24576
  ds_read_b64_tr_b16 a[186:187], v206 offset:25600
  v_add_f32 v215, v210, v211
  v_cvt_pk_bf16_f32 v132, v210, v211
  v_add_f32 v208, v76, v196
  v_add_f32 v209, v77, v196
  v_exp_f32 v208, v208
  v_mfma_f32_16x16x32_bf16 v[8:11], a[160:163], a[12:15], v[8:11]
  v_mfma_f32_16x16x32_bf16 v[12:15], a[164:167], a[12:15], v[12:15]
  ds_read_b64_tr_b16 a[188:189], v207 offset:24576
  ds_read_b64_tr_b16 a[190:191], v207 offset:25600
  v_exp_f32 v209, v209
  v_add_f32 v215, v215, v212
  v_add_f32 v215, v215, v213
  v_mfma_f32_16x16x32_bf16 v[4:7], a[164:167], a[8:11], v[4:7]
  s_waitcnt lgkmcnt(8)
  v_mfma_f32_16x16x32_bf16 v[16:19], a[168:171], a[8:11], v[16:19]
  s_waitcnt vmcnt(20)
  s_barrier
  ds_read_b64_tr_b16 a[160:161], v232 offset:16384
  ds_read_b64_tr_b16 a[162:163], v232 offset:17408
  v_cvt_pk_bf16_f32 v133, v212, v213
  v_add_f32 v210, v78, v196
  v_add_f32 v211, v79, v196
  v_mfma_f32_16x16x32_bf16 v[24:27], a[168:171], a[12:15], v[24:27]
  v_mfma_f32_16x16x32_bf16 v[28:31], a[172:175], a[12:15], v[28:31]
  ds_read_b64_tr_b16 a[164:165], v233 offset:16384
  ds_read_b64_tr_b16 a[166:167], v233 offset:17408
  s_add_u32 m0, s41, 16384
  s_nop 0
  buffer_load_dwordx4 v240, s[8:11], s32 offen offset:0 nt lds
  v_exp_f32 v210, v210
  v_mfma_f32_16x16x32_bf16 v[20:23], a[172:175], a[8:11], v[20:23]
  s_waitcnt lgkmcnt(8)
  v_mfma_f32_16x16x32_bf16 v[32:35], a[176:179], a[8:11], v[32:35]
  ds_read_b64_tr_b16 a[168:169], v234 offset:16384
  ds_read_b64_tr_b16 a[170:171], v234 offset:17408
  v_exp_f32 v211, v211
  v_add_f32 v215, v215, v208
  v_add_f32 v215, v215, v209
  v_cvt_pk_bf16_f32 v134, v208, v209
  v_mfma_f32_16x16x32_bf16 v[40:43], a[176:179], a[12:15], v[40:43]
  v_mfma_f32_16x16x32_bf16 v[44:47], a[180:183], a[12:15], v[44:47]
  ds_read_b64_tr_b16 a[172:173], v235 offset:16384
  ds_read_b64_tr_b16 a[174:175], v235 offset:17408
  v_add_f32 v212, v80, v192
  v_add_f32 v213, v81, v192
  v_exp_f32 v212, v212
  v_mfma_f32_16x16x32_bf16 v[36:39], a[180:183], a[8:11], v[36:39]
  s_waitcnt lgkmcnt(8)
  v_mfma_f32_16x16x32_bf16 v[48:51], a[184:187], a[8:11], v[48:51]
  ds_read_b64_tr_b16 a[176:177], v236 offset:16384
  ds_read_b64_tr_b16 a[178:179], v236 offset:17408
  buffer_load_dwordx4 v241, s[8:11], s32 offen offset:1024 nt lds
  v_exp_f32 v213, v213
  v_add_f32 v215, v215, v210
  v_mfma_f32_16x16x32_bf16 v[56:59], a[184:187], a[12:15], v[56:59]
  v_mfma_f32_16x16x32_bf16 v[60:63], a[188:191], a[12:15], v[60:63]
  ds_read_b64_tr_b16 a[180:181], v237 offset:16384
  ds_read_b64_tr_b16 a[182:183], v237 offset:17408
  v_add_f32 v215, v215, v211
  v_cvt_pk_bf16_f32 v135, v210, v211
  v_add_f32 v208, v82, v192
  v_add_f32 v209, v83, v192
  v_mfma_f32_16x16x32_bf16 v[52:55], a[188:191], a[8:11], v[52:55]
  s_waitcnt lgkmcnt(8)
  v_mfma_f32_16x16x32_bf16 v[0:3], a[160:163], a[16:19], v[0:3]
  ds_read_b64_tr_b16 a[184:185], v238 offset:16384
  ds_read_b64_tr_b16 a[186:187], v238 offset:17408
  v_exp_f32 v208, v208
  v_exp_f32 v209, v209
  v_add_f32 v214, v214, v212
  v_add_f32 v214, v214, v213
  v_mfma_f32_16x16x32_bf16 v[8:11], a[160:163], a[20:23], v[8:11]
  v_mfma_f32_16x16x32_bf16 v[12:15], a[164:167], a[20:23], v[12:15]
  ds_read_b64_tr_b16 a[188:189], v239 offset:16384
  ds_read_b64_tr_b16 a[190:191], v239 offset:17408
  buffer_load_dwordx4 v242, s[8:11], s32 offen offset:2048 nt lds
  v_cvt_pk_bf16_f32 v136, v212, v213
  v_add_f32 v210, v84, v192
  v_mfma_f32_16x16x32_bf16 v[4:7], a[164:167], a[16:19], v[4:7]
  s_waitcnt lgkmcnt(8)
  v_mfma_f32_16x16x32_bf16 v[16:19], a[168:171], a[16:19], v[16:19]
  ds_read_b64_tr_b16 a[160:161], v232 offset:24576
  ds_read_b64_tr_b16 a[162:163], v232 offset:25600
  v_add_f32 v211, v85, v192
  v_exp_f32 v210, v210
  v_exp_f32 v211, v211
  v_mfma_f32_16x16x32_bf16 v[24:27], a[168:171], a[20:23], v[24:27]
  v_mfma_f32_16x16x32_bf16 v[28:31], a[172:175], a[20:23], v[28:31]
  ds_read_b64_tr_b16 a[164:165], v233 offset:24576
  ds_read_b64_tr_b16 a[166:167], v233 offset:25600
  v_add_f32 v214, v214, v208
  v_add_f32 v214, v214, v209
  v_cvt_pk_bf16_f32 v137, v208, v209
  v_add_f32 v212, v86, v192
  v_add_f32 v213, v87, v192
  v_mfma_f32_16x16x32_bf16 v[20:23], a[172:175], a[16:19], v[20:23]
  s_waitcnt lgkmcnt(8)
  v_mfma_f32_16x16x32_bf16 v[32:35], a[176:179], a[16:19], v[32:35]
  ds_read_b64_tr_b16 a[168:169], v234 offset:24576
  ds_read_b64_tr_b16 a[170:171], v234 offset:25600
  buffer_load_dwordx4 v243, s[8:11], s32 offen offset:3072 nt lds
  s_add_u32 s32, s32, 0x4000
  v_exp_f32 v212, v212
  v_mfma_f32_16x16x32_bf16 v[40:43], a[176:179], a[20:23], v[40:43]
  v_mfma_f32_16x16x32_bf16 v[44:47], a[180:183], a[20:23], v[44:47]
  ds_read_b64_tr_b16 a[172:173], v235 offset:24576
  ds_read_b64_tr_b16 a[174:175], v235 offset:25600
  v_exp_f32 v213, v213
  v_add_f32 v214, v214, v210
  v_add_f32 v214, v214, v211
  v_cvt_pk_bf16_f32 v138, v210, v211
  v_mfma_f32_16x16x32_bf16 v[36:39], a[180:183], a[16:19], v[36:39]
  s_waitcnt lgkmcnt(8)
  v_mfma_f32_16x16x32_bf16 v[48:51], a[184:187], a[16:19], v[48:51]
  ds_read_b64_tr_b16 a[176:177], v236 offset:24576
  ds_read_b64_tr_b16 a[178:179], v236 offset:25600
  v_add_f32 v208, v88, v196
  v_add_f32 v209, v89, v196
  v_exp_f32 v208, v208
  v_mfma_f32_16x16x32_bf16 v[56:59], a[184:187], a[20:23], v[56:59]
  v_mfma_f32_16x16x32_bf16 v[60:63], a[188:191], a[20:23], v[60:63]
  ds_read_b64_tr_b16 a[180:181], v237 offset:24576
  ds_read_b64_tr_b16 a[182:183], v237 offset:25600
  v_exp_f32 v209, v209
  v_add_f32 v214, v214, v212
  v_add_f32 v214, v214, v213
  v_cvt_pk_bf16_f32 v139, v212, v213
  v_mfma_f32_16x16x32_bf16 v[52:55], a[188:191], a[16:19], v[52:55]
  s_waitcnt lgkmcnt(8)
  v_mfma_f32_16x16x32_bf16 v[0:3], a[160:163], a[24:27], v[0:3]
  ds_read_b64_tr_b16 a[184:185], v238 offset:24576
  ds_read_b64_tr_b16 a[186:187], v238 offset:25600
  v_add_f32 v210, v90, v196
  v_add_f32 v211, v91, v196
  v_exp_f32 v210, v210
  v_exp_f32 v211, v211
  v_mfma_f32_16x16x32_bf16 v[8:11], a[160:163], a[28:31], v[8:11]
  v_mfma_f32_16x16x32_bf16 v[12:15], a[164:167], a[28:31], v[12:15]
  ds_read_b64_tr_b16 a[188:189], v239 offset:24576
  ds_read_b64_tr_b16 a[190:191], v239 offset:25600
  v_add_f32 v215, v215, v208
  v_add_f32 v215, v215, v209
  v_cvt_pk_bf16_f32 v140, v208, v209
  v_add_f32 v212, v92, v196
  v_mfma_f32_16x16x32_bf16 v[4:7], a[164:167], a[24:27], v[4:7]
  s_waitcnt lgkmcnt(8)
  v_mfma_f32_16x16x32_bf16 v[16:19], a[168:171], a[24:27], v[16:19]
  s_waitcnt vmcnt(20)
  s_barrier
  ds_read_b64_tr_b16 a[160:161], v232 offset:32768
  ds_read_b64_tr_b16 a[162:163], v232 offset:33792
  v_add_f32 v213, v93, v196
  v_exp_f32 v212, v212
  v_mfma_f32_16x16x32_bf16 v[24:27], a[168:171], a[28:31], v[24:27]
  v_mfma_f32_16x16x32_bf16 v[28:31], a[172:175], a[28:31], v[28:31]
  ds_read_b64_tr_b16 a[164:165], v233 offset:32768
  ds_read_b64_tr_b16 a[166:167], v233 offset:33792
  s_add_u32 m0, s41, 147456
  s_nop 0
  buffer_load_dwordx4 v248, s[12:15], s33 offen offset:0 nt lds
  v_exp_f32 v213, v213
  v_mfma_f32_16x16x32_bf16 v[20:23], a[172:175], a[24:27], v[20:23]
  s_waitcnt lgkmcnt(8)
  v_mfma_f32_16x16x32_bf16 v[32:35], a[176:179], a[24:27], v[32:35]
  ds_read_b64_tr_b16 a[168:169], v234 offset:32768
  ds_read_b64_tr_b16 a[170:171], v234 offset:33792
  v_add_f32 v215, v215, v210
  v_add_f32 v215, v215, v211
  v_cvt_pk_bf16_f32 v141, v210, v211
  v_add_f32 v208, v94, v196
  v_add_f32 v209, v95, v196
  v_mfma_f32_16x16x32_bf16 v[40:43], a[176:179], a[28:31], v[40:43]
  v_mfma_f32_16x16x32_bf16 v[44:47], a[180:183], a[28:31], v[44:47]
  ds_read_b64_tr_b16 a[172:173], v235 offset:32768
  ds_read_b64_tr_b16 a[174:175], v235 offset:33792
  v_exp_f32 v208, v208
  v_exp_f32 v209, v209
  v_add_f32 v215, v215, v212
  v_mfma_f32_16x16x32_bf16 v[36:39], a[180:183], a[24:27], v[36:39]
  s_waitcnt lgkmcnt(8)
  v_mfma_f32_16x16x32_bf16 v[48:51], a[184:187], a[24:27], v[48:51]
  ds_read_b64_tr_b16 a[176:177], v236 offset:32768
  ds_read_b64_tr_b16 a[178:179], v236 offset:33792
  buffer_load_dwordx4 v248, s[12:15], s33 offen offset:1024 nt lds
  v_add_f32 v215, v215, v213
  v_cvt_pk_bf16_f32 v142, v212, v213
  v_mfma_f32_16x16x32_bf16 v[56:59], a[184:187], a[28:31], v[56:59]
  v_mfma_f32_16x16x32_bf16 v[60:63], a[188:191], a[28:31], v[60:63]
  ds_read_b64_tr_b16 a[180:181], v237 offset:32768
  ds_read_b64_tr_b16 a[182:183], v237 offset:33792
  v_add_f32 v215, v215, v208
  v_add_f32 v215, v215, v209
  v_cvt_pk_bf16_f32 v143, v208, v209
  v_mov_b32 v249, v214
  v_mov_b32 v254, v215
  v_mfma_f32_16x16x32_bf16 v[52:55], a[188:191], a[24:27], v[52:55]
  s_waitcnt lgkmcnt(8)
  v_mfma_f32_16x16x32_bf16 a[192:195], a[160:163], v[128:131], 0
  ds_read_b64_tr_b16 a[184:185], v238 offset:32768
  ds_read_b64_tr_b16 a[186:187], v238 offset:33792
  v_exp_f32 v208, v96
  v_mfma_f32_16x16x32_bf16 a[200:203], a[160:163], v[132:135], 0
  v_mfma_f32_16x16x32_bf16 a[204:207], a[164:167], v[132:135], 0
  ds_read_b64_tr_b16 a[188:189], v239 offset:32768
  ds_read_b64_tr_b16 a[190:191], v239 offset:33792
  buffer_load_dwordx4 v248, s[12:15], s33 offen offset:2048 nt lds
  v_exp_f32 v209, v97
  v_mfma_f32_16x16x32_bf16 a[196:199], a[164:167], v[128:131], 0
  s_waitcnt lgkmcnt(8)
  v_mfma_f32_16x16x32_bf16 a[208:211], a[168:171], v[128:131], 0
  ds_read_b64_tr_b16 a[160:161], v232 offset:40960
  ds_read_b64_tr_b16 a[162:163], v232 offset:41984
  v_exp_f32 v210, v98
  v_mfma_f32_16x16x32_bf16 a[216:219], a[168:171], v[132:135], 0
  v_mfma_f32_16x16x32_bf16 a[220:223], a[172:175], v[132:135], 0
  ds_read_b64_tr_b16 a[164:165], v233 offset:40960
  ds_read_b64_tr_b16 a[166:167], v233 offset:41984
  v_cvt_pk_bf16_f32 v144, v208, v209
  v_exp_f32 v211, v99
  v_mfma_f32_16x16x32_bf16 a[212:215], a[172:175], v[128:131], 0
  s_waitcnt lgkmcnt(8)
  v_mfma_f32_16x16x32_bf16 a[224:227], a[176:179], v[128:131], 0
  ds_read_b64_tr_b16 a[168:169], v234 offset:40960
  ds_read_b64_tr_b16 a[170:171], v234 offset:41984
  buffer_load_dwordx4 v248, s[12:15], s33 offen offset:3072 nt lds
  s_add_u32 s33, s33, 0x4000
  v_mfma_f32_16x16x32_bf16 a[232:235], a[176:179], v[132:135], 0
  v_mfma_f32_16x16x32_bf16 a[236:239], a[180:183], v[132:135], 0
  ds_read_b64_tr_b16 a[172:173], v235 offset:40960
  ds_read_b64_tr_b16 a[174:175], v235 offset:41984
  v_add_f32 v214, v208, v209
  v_exp_f32 v212, v100
  v_mfma_f32_16x16x32_bf16 a[228:231], a[180:183], v[128:131], 0
  s_waitcnt lgkmcnt(8)
  v_mfma_f32_16x16x32_bf16 a[240:243], a[184:187], v[128:131], 0
  ds_read_b64_tr_b16 a[176:177], v236 offset:40960
  ds_read_b64_tr_b16 a[178:179], v236 offset:41984
  v_add_f32 v214, v214, v210
  v_cvt_pk_bf16_f32 v145, v210, v211
  v_mfma_f32_16x16x32_bf16 a[248:251], a[184:187], v[132:135], 0
  v_mfma_f32_16x16x32_bf16 a[252:255], a[188:191], v[132:135], 0
  ds_read_b64_tr_b16 a[180:181], v237 offset:40960
  ds_read_b64_tr_b16 a[182:183], v237 offset:41984
  v_exp_f32 v213, v101
  v_add_f32 v214, v214, v211
  v_mfma_f32_16x16x32_bf16 a[244:247], a[188:191], v[128:131], 0
  s_waitcnt lgkmcnt(8)
  v_mfma_f32_16x16x32_bf16 a[192:195], a[160:163], v[136:139], a[192:195]
  ds_read_b64_tr_b16 a[184:185], v238 offset:40960
  ds_read_b64_tr_b16 a[186:187], v238 offset:41984
  v_exp_f32 v208, v102
  v_add_f32 v214, v214, v212
  v_cvt_pk_bf16_f32 v146, v212, v213
  v_mfma_f32_16x16x32_bf16 a[200:203], a[160:163], v[140:143], a[200:203]
  v_mfma_f32_16x16x32_bf16 a[204:207], a[164:167], v[140:143], a[204:207]
  ds_read_b64_tr_b16 a[188:189], v239 offset:40960
  ds_read_b64_tr_b16 a[190:191], v239 offset:41984
  v_exp_f32 v209, v103
  v_mfma_f32_16x16x32_bf16 a[196:199], a[164:167], v[136:139], a[196:199]
  s_waitcnt lgkmcnt(8)
  v_mfma_f32_16x16x32_bf16 a[208:211], a[168:171], v[136:139], a[208:211]
  s_barrier
  ds_read_b128 a[160:163], v224 offset:32768
  v_add_f32 v214, v214, v213
  v_exp_f32 v210, v104
  v_mfma_f32_16x16x32_bf16 a[216:219], a[168:171], v[140:143], a[216:219]
  v_mfma_f32_16x16x32_bf16 a[220:223], a[172:175], v[140:143], a[220:223]
  ds_read_b128 a[164:167], v224 offset:36864
  s_add_u32 s34, s77, 0
  s_add_u32 m0, s41, 81920
  s_nop 0
  buffer_load_dwordx4 v244, s[64:67], s34 offen offset:0 lds
  v_add_f32 v214, v214, v208
  v_mfma_f32_16x16x32_bf16 a[212:215], a[172:175], v[136:139], a[212:215]
  s_waitcnt lgkmcnt(6)
  v_mfma_f32_16x16x32_bf16 a[224:227], a[176:179], v[136:139], a[224:227]
  ds_read_b128 a[168:171], v225 offset:32768
  v_cvt_pk_bf16_f32 v147, v208, v209
  v_exp_f32 v211, v105
  v_mfma_f32_16x16x32_bf16 a[232:235], a[176:179], v[140:143], a[232:235]
  v_mfma_f32_16x16x32_bf16 a[236:239], a[180:183], v[140:143], a[236:239]
  ds_read_b128 a[172:175], v225 offset:36864
  v_add_f32 v214, v214, v209
  v_exp_f32 v212, v106
  v_cvt_pk_bf16_f32 v148, v210, v211
  v_mfma_f32_16x16x32_bf16 a[228:231], a[180:183], v[136:139], a[228:231]
  s_waitcnt lgkmcnt(4)
  v_mfma_f32_16x16x32_bf16 a[240:243], a[184:187], v[136:139], a[240:243]
  ds_read_b128 a[176:179], v226 offset:32768
  buffer_load_dwordx4 v245, s[64:67], s34 offen offset:1024 lds
  v_mfma_f32_16x16x32_bf16 a[248:251], a[184:187], v[140:143], a[248:251]
  v_mfma_f32_16x16x32_bf16 a[252:255], a[188:191], v[140:143], a[252:255]
  ds_read_b128 a[180:183], v226 offset:36864
  v_exp_f32 v213, v107
  v_add_f32 v215, v210, v211
  v_exp_f32 v208, v108
  v_mfma_f32_16x16x32_bf16 a[244:247], a[188:191], v[136:139], a[244:247]
  s_waitcnt lgkmcnt(4)
  v_mfma_f32_16x16x32_bf16 v[64:67], a[160:163], v[160:163], v[192:195]
  ds_read_b128 a[184:187], v227 offset:32768
  v_add_f32 v215, v215, v212
  v_cvt_pk_bf16_f32 v149, v212, v213
  v_exp_f32 v209, v109
  v_mfma_f32_16x16x32_bf16 v[72:75], a[160:163], v[164:167], v[196:199]
  v_mfma_f32_16x16x32_bf16 v[76:79], a[164:167], v[164:167], v[196:199]
  ds_read_b128 a[188:191], v227 offset:36864
  buffer_load_dwordx4 v246, s[64:67], s34 offen offset:2048 lds
  v_mfma_f32_16x16x32_bf16 v[68:71], a[164:167], v[160:163], v[192:195]
  s_waitcnt lgkmcnt(4)
  v_mfma_f32_16x16x32_bf16 v[64:67], a[168:171], v[168:171], v[64:67]
  ds_read_b128 a[160:163], v224 offset:34816
  v_add_f32 v215, v215, v213
  v_exp_f32 v210, v110
  v_mfma_f32_16x16x32_bf16 v[72:75], a[168:171], v[172:175], v[72:75]
  v_mfma_f32_16x16x32_bf16 v[76:79], a[172:175], v[172:175], v[76:79]
  ds_read_b128 a[164:167], v224 offset:38912
  v_add_f32 v215, v215, v208
  v_cvt_pk_bf16_f32 v150, v208, v209
  v_exp_f32 v211, v111
  v_mfma_f32_16x16x32_bf16 v[68:71], a[172:175], v[168:171], v[68:71]
  s_waitcnt lgkmcnt(4)
  v_mfma_f32_16x16x32_bf16 v[64:67], a[176:179], v[176:179], v[64:67]
  ds_read_b128 a[168:171], v225 offset:34816
  buffer_load_dwordx4 v247, s[64:67], s34 offen offset:3072 lds
  v_add_f32 v215, v215, v209
  v_mfma_f32_16x16x32_bf16 v[72:75], a[176:179], v[180:183], v[72:75]
  v_mfma_f32_16x16x32_bf16 v[76:79], a[180:183], v[180:183], v[76:79]
  ds_read_b128 a[172:175], v225 offset:38912
  v_exp_f32 v212, v112
  v_add_f32 v215, v215, v210
  v_mfma_f32_16x16x32_bf16 v[68:71], a[180:183], v[176:179], v[68:71]
  s_waitcnt lgkmcnt(4)
  v_mfma_f32_16x16x32_bf16 v[64:67], a[184:187], v[184:187], v[64:67]
  ds_read_b128 a[176:179], v226 offset:34816
  v_cvt_pk_bf16_f32 v151, v210, v211
  v_exp_f32 v213, v113
  v_add_f32 v215, v215, v211
  v_mfma_f32_16x16x32_bf16 v[72:75], a[184:187], v[188:191], v[72:75]
  v_mfma_f32_16x16x32_bf16 v[76:79], a[188:191], v[188:191], v[76:79]
  ds_read_b128 a[180:183], v226 offset:38912
  v_exp_f32 v208, v114
  v_add_f32 v214, v214, v212
  v_cvt_pk_bf16_f32 v152, v212, v213
  v_mfma_f32_16x16x32_bf16 v[68:71], a[188:191], v[184:187], v[68:71]
  s_waitcnt lgkmcnt(4)
  v_mfma_f32_16x16x32_bf16 v[80:83], a[160:163], v[160:163], v[192:195]
  ds_read_b128 a[184:187], v227 offset:34816
  v_exp_f32 v209, v115
  v_add_f32 v214, v214, v213
  v_mfma_f32_16x16x32_bf16 v[88:91], a[160:163], v[164:167], v[196:199]
  v_mfma_f32_16x16x32_bf16 v[92:95], a[164:167], v[164:167], v[196:199]
  ds_read_b128 a[188:191], v227 offset:38912
  v_exp_f32 v210, v116
  v_add_f32 v214, v214, v208
  v_cvt_pk_bf16_f32 v153, v208, v209
  v_mfma_f32_16x16x32_bf16 v[84:87], a[164:167], v[160:163], v[192:195]
  s_waitcnt lgkmcnt(4)
  v_mfma_f32_16x16x32_bf16 v[80:83], a[168:171], v[168:171], v[80:83]
  s_waitcnt vmcnt(24)
  s_barrier
  ds_read_b64_tr_b16 a[160:161], v232 offset:49152
  ds_read_b64_tr_b16 a[162:163], v232 offset:50176
  v_exp_f32 v211, v117
  v_mfma_f32_16x16x32_bf16 v[88:91], a[168:171], v[172:175], v[88:91]
  v_mfma_f32_16x16x32_bf16 v[92:95], a[172:175], v[172:175], v[92:95]
  ds_read_b64_tr_b16 a[164:165], v233 offset:49152
  ds_read_b64_tr_b16 a[166:167], v233 offset:50176
  s_add_u32 m0, s41, 98304
  s_nop 0
  buffer_load_dwordx4 v248, s[12:15], s33 offen offset:0 nt lds
  v_mfma_f32_16x16x32_bf16 v[84:87], a[172:175], v[168:171], v[84:87]
  s_waitcnt lgkmcnt(6)
  v_mfma_f32_16x16x32_bf16 v[80:83], a[176:179], v[176:179], v[80:83]
  ds_read_b64_tr_b16 a[168:169], v234 offset:49152
  ds_read_b64_tr_b16 a[170:171], v234 offset:50176
  v_add_f32 v214, v214, v209
  v_exp_f32 v212, v118
  v_mfma_f32_16x16x32_bf16 v[88:91], a[176:179], v[180:183], v[88:91]
  v_mfma_f32_16x16x32_bf16 v[92:95], a[180:183], v[180:183], v[92:95]
  ds_read_b64_tr_b16 a[172:173], v235 offset:49152
  ds_read_b64_tr_b16 a[174:175], v235 offset:50176
  v_add_f32 v214, v214, v210
  v_cvt_pk_bf16_f32 v154, v210, v211
  v_mfma_f32_16x16x32_bf16 v[84:87], a[180:183], v[176:179], v[84:87]
  s_waitcnt lgkmcnt(8)
  v_mfma_f32_16x16x32_bf16 v[80:83], a[184:187], v[184:187], v[80:83]
  ds_read_b64_tr_b16 a[176:177], v236 offset:49152
  ds_read_b64_tr_b16 a[178:179], v236 offset:50176
  buffer_load_dwordx4 v248, s[12:15], s33 offen offset:1024 nt lds
  v_mfma_f32_16x16x32_bf16 v[88:91], a[184:187], v[188:191], v[88:91]
  v_mfma_f32_16x16x32_bf16 v[92:95], a[188:191], v[188:191], v[92:95]
  ds_read_b64_tr_b16 a[180:181], v237 offset:49152
  ds_read_b64_tr_b16 a[182:183], v237 offset:50176
  v_exp_f32 v213, v119
  v_add_f32 v214, v214, v211
  v_mfma_f32_16x16x32_bf16 v[84:87], a[188:191], v[184:187], v[84:87]
  s_waitcnt lgkmcnt(8)
  v_mfma_f32_16x16x32_bf16 v[0:3], a[160:163], a[128:131], v[0:3]
  ds_read_b64_tr_b16 a[184:185], v238 offset:49152
  ds_read_b64_tr_b16 a[186:187], v238 offset:50176
  v_exp_f32 v208, v120
  v_add_f32 v214, v214, v212
  v_cvt_pk_bf16_f32 v155, v212, v213
  v_mfma_f32_16x16x32_bf16 v[8:11], a[160:163], a[132:135], v[8:11]
  v_mfma_f32_16x16x32_bf16 v[12:15], a[164:167], a[132:135], v[12:15]
  ds_read_b64_tr_b16 a[188:189], v239 offset:49152
  ds_read_b64_tr_b16 a[190:191], v239 offset:50176
  buffer_load_dwordx4 v248, s[12:15], s33 offen offset:2048 nt lds
  v_mfma_f32_16x16x32_bf16 v[4:7], a[164:167], a[128:131], v[4:7]
  s_waitcnt lgkmcnt(8)
  v_mfma_f32_16x16x32_bf16 v[16:19], a[168:171], a[128:131], v[16:19]
  ds_read_b64_tr_b16 a[160:161], v232 offset:57344
  ds_read_b64_tr_b16 a[162:163], v232 offset:58368
  v_exp_f32 v209, v121
  v_add_f32 v214, v214, v213
  v_mfma_f32_16x16x32_bf16 v[24:27], a[168:171], a[132:135], v[24:27]
  v_mfma_f32_16x16x32_bf16 v[28:31], a[172:175], a[132:135], v[28:31]
  ds_read_b64_tr_b16 a[164:165], v233 offset:57344
  ds_read_b64_tr_b16 a[166:167], v233 offset:58368
  v_exp_f32 v210, v122
  v_add_f32 v215, v215, v208
  v_mfma_f32_16x16x32_bf16 v[20:23], a[172:175], a[128:131], v[20:23]
  s_waitcnt lgkmcnt(8)
  v_mfma_f32_16x16x32_bf16 v[32:35], a[176:179], a[128:131], v[32:35]
  ds_read_b64_tr_b16 a[168:169], v234 offset:57344
  ds_read_b64_tr_b16 a[170:171], v234 offset:58368
  buffer_load_dwordx4 v248, s[12:15], s33 offen offset:3072 nt lds
  s_add_u32 s33, s33, 0x4000
  v_mfma_f32_16x16x32_bf16 v[40:43], a[176:179], a[132:135], v[40:43]
  v_mfma_f32_16x16x32_bf16 v[44:47], a[180:183], a[132:135], v[44:47]
  ds_read_b64_tr_b16 a[172:173], v235 offset:57344
  ds_read_b64_tr_b16 a[174:175], v235 offset:58368
  v_cvt_pk_bf16_f32 v156, v208, v209
  v_exp_f32 v211, v123
  v_mfma_f32_16x16x32_bf16 v[36:39], a[180:183], a[128:131], v[36:39]
  s_waitcnt lgkmcnt(8)
  v_mfma_f32_16x16x32_bf16 v[48:51], a[184:187], a[128:131], v[48:51]
  ds_read_b64_tr_b16 a[176:177], v236 offset:57344
  ds_read_b64_tr_b16 a[178:179], v236 offset:58368
  v_add_f32 v215, v215, v209
  v_exp_f32 v212, v124
  v_mfma_f32_16x16x32_bf16 v[56:59], a[184:187], a[132:135], v[56:59]
  v_mfma_f32_16x16x32_bf16 v[60:63], a[188:191], a[132:135], v[60:63]
  ds_read_b64_tr_b16 a[180:181], v237 offset:57344
  ds_read_b64_tr_b16 a[182:183], v237 offset:58368
  v_add_f32 v215, v215, v210
  v_cvt_pk_bf16_f32 v157, v210, v211
  v_mfma_f32_16x16x32_bf16 v[52:55], a[188:191], a[128:131], v[52:55]
  s_waitcnt lgkmcnt(8)
  v_mfma_f32_16x16x32_bf16 v[0:3], a[160:163], a[136:139], v[0:3]
  ds_read_b64_tr_b16 a[184:185], v238 offset:57344
  ds_read_b64_tr_b16 a[186:187], v238 offset:58368
  v_exp_f32 v213, v125
  v_add_f32 v215, v215, v211
  v_mfma_f32_16x16x32_bf16 v[8:11], a[160:163], a[140:143], v[8:11]
  v_mfma_f32_16x16x32_bf16 v[12:15], a[164:167], a[140:143], v[12:15]
  ds_read_b64_tr_b16 a[188:189], v239 offset:57344
  ds_read_b64_tr_b16 a[190:191], v239 offset:58368
  v_exp_f32 v208, v126
  v_add_f32 v215, v215, v212
  v_mfma_f32_16x16x32_bf16 v[4:7], a[164:167], a[136:139], v[4:7]
  s_waitcnt lgkmcnt(8)
  v_mfma_f32_16x16x32_bf16 v[16:19], a[168:171], a[136:139], v[16:19]
  s_waitcnt vmcnt(20)
  s_barrier
  ds_read_b64_tr_b16 a[160:161], v232 offset:0
  ds_read_b64_tr_b16 a[162:163], v232 offset:1024
  v_cvt_pk_bf16_f32 v158, v212, v213
  v_mfma_f32_16x16x32_bf16 v[24:27], a[168:171], a[140:143], v[24:27]
  v_mfma_f32_16x16x32_bf16 v[28:31], a[172:175], a[140:143], v[28:31]
  ds_read_b64_tr_b16 a[164:165], v233 offset:0
  ds_read_b64_tr_b16 a[166:167], v233 offset:1024
  s_add_u32 m0, s41, 32768
  s_nop 0
  buffer_load_dwordx4 v240, s[8:11], s32 offen offset:0 nt lds
  v_mfma_f32_16x16x32_bf16 v[20:23], a[172:175], a[136:139], v[20:23]
  s_waitcnt lgkmcnt(8)
  v_mfma_f32_16x16x32_bf16 v[32:35], a[176:179], a[136:139], v[32:35]
  ds_read_b64_tr_b16 a[168:169], v234 offset:0
  ds_read_b64_tr_b16 a[170:171], v234 offset:1024
  v_exp_f32 v209, v127
  v_add_f32 v215, v215, v213
  v_mfma_f32_16x16x32_bf16 v[40:43], a[176:179], a[140:143], v[40:43]
  v_mfma_f32_16x16x32_bf16 v[44:47], a[180:183], a[140:143], v[44:47]
  ds_read_b64_tr_b16 a[172:173], v235 offset:0
  ds_read_b64_tr_b16 a[174:175], v235 offset:1024
  v_add_f32 v215, v215, v208
  v_cvt_pk_bf16_f32 v159, v208, v209
  v_add_f32 v215, v215, v209
  v_mfma_f32_16x16x32_bf16 v[36:39], a[180:183], a[136:139], v[36:39]
  s_waitcnt lgkmcnt(8)
  v_mfma_f32_16x16x32_bf16 v[48:51], a[184:187], a[136:139], v[48:51]
  ds_read_b64_tr_b16 a[176:177], v236 offset:0
  ds_read_b64_tr_b16 a[178:179], v236 offset:1024
  buffer_load_dwordx4 v241, s[8:11], s32 offen offset:1024 nt lds
  v_mfma_f32_16x16x32_bf16 v[56:59], a[184:187], a[140:143], v[56:59]
  v_mfma_f32_16x16x32_bf16 v[60:63], a[188:191], a[140:143], v[60:63]
  ds_read_b64_tr_b16 a[180:181], v237 offset:0
  ds_read_b64_tr_b16 a[182:183], v237 offset:1024
  v_add_f32 v210, v214, v215
  v_cmp_lt_f32 vcc, s35, v210
  v_mfma_f32_16x16x32_bf16 v[52:55], a[188:191], a[136:139], v[52:55]
  s_cbranch_vccnz SITE97
BACK97:
  s_waitcnt lgkmcnt(8)
  v_mfma_f32_16x16x32_bf16 a[192:195], a[160:163], v[144:147], a[192:195]
  ds_read_b64_tr_b16 a[184:185], v238 offset:0
  ds_read_b64_tr_b16 a[186:187], v238 offset:1024
  v_add_f32 v249, v249, v214
  v_add_f32 v254, v254, v215
  v_exp_f32 v208, v64
  v_mfma_f32_16x16x32_bf16 a[200:203], a[160:163], v[148:151], a[200:203]
  v_mfma_f32_16x16x32_bf16 a[204:207], a[164:167], v[148:151], a[204:207]
  ds_read_b64_tr_b16 a[188:189], v239 offset:0
  ds_read_b64_tr_b16 a[190:191], v239 offset:1024
  buffer_load_dwordx4 v242, s[8:11], s32 offen offset:2048 nt lds
  v_mfma_f32_16x16x32_bf16 a[196:199], a[164:167], v[144:147], a[196:199]
  s_waitcnt lgkmcnt(8)
  v_mfma_f32_16x16x32_bf16 a[208:211], a[168:171], v[144:147], a[208:211]
  ds_read_b64_tr_b16 a[160:161], v232 offset:8192
  ds_read_b64_tr_b16 a[162:163], v232 offset:9216
  v_exp_f32 v209, v65
  v_exp_f32 v210, v66
  v_mfma_f32_16x16x32_bf16 a[216:219], a[168:171], v[148:151], a[216:219]
  v_mfma_f32_16x16x32_bf16 a[220:223], a[172:175], v[148:151], a[220:223]
  ds_read_b64_tr_b16 a[164:165], v233 offset:8192
  ds_read_b64_tr_b16 a[166:167], v233 offset:9216
  v_cvt_pk_bf16_f32 v128, v208, v209
  v_mfma_f32_16x16x32_bf16 a[212:215], a[172:175], v[144:147], a[212:215]
  s_waitcnt lgkmcnt(8)
  v_mfma_f32_16x16x32_bf16 a[224:227], a[176:179], v[144:147], a[224:227]
  ds_read_b64_tr_b16 a[168:169], v234 offset:8192
  ds_read_b64_tr_b16 a[170:171], v234 offset:9216
  buffer_load_dwordx4 v243, s[8:11], s32 offen offset:3072 nt lds
  s_add_u32 s32, s32, 0x4000
  v_exp_f32 v211, v67
  v_mfma_f32_16x16x32_bf16 a[232:235], a[176:179], v[148:151], a[232:235]
  v_mfma_f32_16x16x32_bf16 a[236:239], a[180:183], v[148:151], a[236:239]
  ds_read_b64_tr_b16 a[172:173], v235 offset:8192
  ds_read_b64_tr_b16 a[174:175], v235 offset:9216
  v_add_f32 v214, v208, v209
  v_exp_f32 v212, v68
  v_mfma_f32_16x16x32_bf16 a[228:231], a[180:183], v[144:147], a[228:231]
  s_waitcnt lgkmcnt(8)
  v_mfma_f32_16x16x32_bf16 a[240:243], a[184:187], v[144:147], a[240:243]
  ds_read_b64_tr_b16 a[176:177], v236 offset:8192
  ds_read_b64_tr_b16 a[178:179], v236 offset:9216
  v_add_f32 v214, v214, v210
  v_cvt_pk_bf16_f32 v129, v210, v211
  v_mfma_f32_16x16x32_bf16 a[248:251], a[184:187], v[148:151], a[248:251]
  v_mfma_f32_16x16x32_bf16 a[252:255], a[188:191], v[148:151], a[252:255]
  ds_read_b64_tr_b16 a[180:181], v237 offset:8192
  ds_read_b64_tr_b16 a[182:183], v237 offset:9216
  v_exp_f32 v213, v69
  v_add_f32 v214, v214, v211
  v_mfma_f32_16x16x32_bf16 a[244:247], a[188:191], v[144:147], a[244:247]
  s_waitcnt lgkmcnt(8)
  v_mfma_f32_16x16x32_bf16 a[192:195], a[160:163], v[152:155], a[192:195]
  ds_read_b64_tr_b16 a[184:185], v238 offset:8192
  ds_read_b64_tr_b16 a[186:187], v238 offset:9216
  v_exp_f32 v208, v70
  v_add_f32 v214, v214, v212
  v_mfma_f32_16x16x32_bf16 a[200:203], a[160:163], v[156:159], a[200:203]
  v_mfma_f32_16x16x32_bf16 a[204:207], a[164:167], v[156:159], a[204:207]
  ds_read_b64_tr_b16 a[188:189], v239 offset:8192
  ds_read_b64_tr_b16 a[190:191], v239 offset:9216
  v_cvt_pk_bf16_f32 v130, v212, v213
  v_exp_f32 v209, v71
  v_mfma_f32_16x16x32_bf16 a[196:199], a[164:167], v[152:155], a[196:199]
  s_waitcnt lgkmcnt(8)
  v_mfma_f32_16x16x32_bf16 a[208:211], a[168:171], v[152:155], a[208:211]
  s_barrier
  ds_read_b128 a[160:163], v224 offset:49152
  v_add_f32 v214, v214, v213
  v_exp_f32 v210, v72
  v_mfma_f32_16x16x32_bf16 a[216:219], a[168:171], v[156:159], a[216:219]
  v_mfma_f32_16x16x32_bf16 a[220:223], a[172:175], v[156:159], a[220:223]
  ds_read_b128 a[164:167], v224 offset:53248
  s_add_u32 s34, s77, 81920
  s_add_u32 m0, s41, 114688
  s_nop 0
  buffer_load_dwordx4 v244, s[64:67], s34 offen offset:0 lds
  v_mfma_f32_16x16x32_bf16 a[212:215], a[172:175], v[152:155], a[212:215]
  s_waitcnt lgkmcnt(6)
  v_mfma_f32_16x16x32_bf16 a[224:227], a[176:179], v[152:155], a[224:227]
  ds_read_b128 a[168:171], v225 offset:49152
  v_add_f32 v214, v214, v208
  v_cvt_pk_bf16_f32 v131, v208, v209
  v_exp_f32 v211, v73
  v_mfma_f32_16x16x32_bf16 a[232:235], a[176:179], v[156:159], a[232:235]
  v_mfma_f32_16x16x32_bf16 a[236:239], a[180:183], v[156:159], a[236:239]
  ds_read_b128 a[172:175], v225 offset:53248
  v_add_f32 v214, v214, v209
  v_exp_f32 v212, v74
  v_mfma_f32_16x16x32_bf16 a[228:231], a[180:183], v[152:155], a[228:231]
  s_waitcnt lgkmcnt(4)
  v_mfma_f32_16x16x32_bf16 a[240:243], a[184:187], v[152:155], a[240:243]
  ds_read_b128 a[176:179], v226 offset:49152
  buffer_load_dwordx4 v245, s[64:67], s34 offen offset:1024 lds
  v_mfma_f32_16x16x32_bf16 a[248:251], a[184:187], v[156:159], a[248:251]
  v_mfma_f32_16x16x32_bf16 a[252:255], a[188:191], v[156:159], a[252:255]
  ds_read_b128 a[180:183], v226 offset:53248
  v_cvt_pk_bf16_f32 v132, v210, v211
  v_exp_f32 v213, v75
  v_add_f32 v215, v210, v211
  v_mfma_f32_16x16x32_bf16 a[244:247], a[188:191], v[152:155], a[244:247]
  s_waitcnt lgkmcnt(4)
  v_mfma_f32_16x16x32_bf16 v[96:99], a[160:163], v[160:163], v[192:195]
  ds_read_b128 a[184:187], v227 offset:49152
  v_exp_f32 v208, v76
  v_add_f32 v215, v215, v212
  v_cvt_pk_bf16_f32 v133, v212, v213
  v_mfma_f32_16x16x32_bf16 v[104:107], a[160:163], v[164:167], v[196:199]
  v_mfma_f32_16x16x32_bf16 v[108:111], a[164:167], v[164:167], v[196:199]
  ds_read_b128 a[188:191], v227 offset:53248
  buffer_load_dwordx4 v246, s[64:67], s34 offen offset:2048 lds
  v_mfma_f32_16x16x32_bf16 v[100:103], a[164:167], v[160:163], v[192:195]
  s_waitcnt lgkmcnt(4)
  v_mfma_f32_16x16x32_bf16 v[96:99], a[168:171], v[168:171], v[96:99]
  ds_read_b128 a[160:163], v224 offset:51200
  v_exp_f32 v209, v77
  v_add_f32 v215, v215, v213
  v_exp_f32 v210, v78
  v_mfma_f32_16x16x32_bf16 v[104:107], a[168:171], v[172:175], v[104:107]
  v_mfma_f32_16x16x32_bf16 v[108:111], a[172:175], v[172:175], v[108:111]
  ds_read_b128 a[164:167], v224 offset:55296
  v_add_f32 v215, v215, v208
  v_cvt_pk_bf16_f32 v134, v208, v209
  v_exp_f32 v211, v79
  v_mfma_f32_16x16x32_bf16 v[100:103], a[172:175], v[168:171], v[100:103]
  s_waitcnt lgkmcnt(4)
  v_mfma_f32_16x16x32_bf16 v[96:99], a[176:179], v[176:179], v[96:99]
  ds_read_b128 a[168:171], v225 offset:51200
  buffer_load_dwordx4 v247, s[64:67], s34 offen offset:3072 lds
  v_mfma_f32_16x16x32_bf16 v[104:107], a[176:179], v[180:183], v[104:107]
  v_mfma_f32_16x16x32_bf16 v[108:111], a[180:183], v[180:183], v[108:111]
  ds_read_b128 a[172:175], v225 offset:55296
  v_add_f32 v215, v215, v209
  v_exp_f32 v212, v80
  v_mfma_f32_16x16x32_bf16 v[100:103], a[180:183], v[176:179], v[100:103]
  s_waitcnt lgkmcnt(4)
  v_mfma_f32_16x16x32_bf16 v[96:99], a[184:187], v[184:187], v[96:99]
  ds_read_b128 a[176:179], v226 offset:51200
  v_add_f32 v215, v215, v210
  v_cvt_pk_bf16_f32 v135, v210, v211
  v_exp_f32 v213, v81
  v_mfma_f32_16x16x32_bf16 v[104:107], a[184:187], v[188:191], v[104:107]
  v_mfma_f32_16x16x32_bf16 v[108:111], a[188:191], v[188:191], v[108:111]
  ds_read_b128 a[180:183], v226 offset:55296
  v_add_f32 v215, v215, v211
  v_exp_f32 v208, v82
  v_add_f32 v214, v214, v212
  v_mfma_f32_16x16x32_bf16 v[100:103], a[188:191], v[184:187], v[100:103]
  s_waitcnt lgkmcnt(4)
  v_mfma_f32_16x16x32_bf16 v[112:115], a[160:163], v[160:163], v[192:195]
  ds_read_b128 a[184:187], v227 offset:51200
  v_cvt_pk_bf16_f32 v136, v212, v213
  v_exp_f32 v209, v83
  v_add_f32 v214, v214, v213
  v_mfma_f32_16x16x32_bf16 v[120:123], a[160:163], v[164:167], v[196:199]
  v_mfma_f32_16x16x32_bf16 v[124:127], a[164:167], v[164:167], v[196:199]
  ds_read_b128 a[188:191], v227 offset:55296
  v_exp_f32 v210, v84
  v_add_f32 v214, v214, v208
  v_cvt_pk_bf16_f32 v137, v208, v209
  v_mfma_f32_16x16x32_bf16 v[116:119], a[164:167], v[160:163], v[192:195]
  s_waitcnt lgkmcnt(4)
  v_mfma_f32_16x16x32_bf16 v[112:115], a[168:171], v[168:171], v[112:115]
  s_waitcnt vmcnt(24)
  s_barrier
  ds_read_b64_tr_b16 a[160:161], v200 offset:0
  ds_read_b64_tr_b16 a[162:163], v200 offset:1024
  v_mfma_f32_16x16x32_bf16 v[120:123], a[168:171], v[172:175], v[120:123]
  v_mfma_f32_16x16x32_bf16 v[124:127], a[172:175], v[172:175], v[124:127]
  ds_read_b64_tr_b16 a[164:165], v201 offset:0
  ds_read_b64_tr_b16 a[166:167], v201 offset:1024
  s_add_u32 m0, s41, 65536
  s_nop 0
  buffer_load_dwordx4 v248, s[12:15], s33 offen offset:0 nt lds
  v_mfma_f32_16x16x32_bf16 v[116:119], a[172:175], v[168:171], v[116:119]
  s_waitcnt lgkmcnt(6)
  v_mfma_f32_16x16x32_bf16 v[112:115], a[176:179], v[176:179], v[112:115]
  ds_read_b64_tr_b16 a[168:169], v202 offset:0
  ds_read_b64_tr_b16 a[170:171], v202 offset:1024
  v_exp_f32 v211, v85
  v_add_f32 v214, v214, v209
  v_mfma_f32_16x16x32_bf16 v[120:123], a[176:179], v[180:183], v[120:123]
  v_mfma_f32_16x16x32_bf16 v[124:127], a[180:183], v[180:183], v[124:127]
  ds_read_b64_tr_b16 a[172:173], v203 offset:0
  ds_read_b64_tr_b16 a[174:175], v203 offset:1024
  v_exp_f32 v212, v86
  v_add_f32 v214, v214, v210
  v_cvt_pk_bf16_f32 v138, v210, v211
  v_mfma_f32_16x16x32_bf16 v[116:119], a[180:183], v[176:179], v[116:119]
  s_waitcnt lgkmcnt(8)
  v_mfma_f32_16x16x32_bf16 v[112:115], a[184:187], v[184:187], v[112:115]
  ds_read_b64_tr_b16 a[176:177], v204 offset:0
  ds_read_b64_tr_b16 a[178:179], v204 offset:1024
  buffer_load_dwordx4 v248, s[12:15], s33 offen offset:1024 nt lds
  v_mfma_f32_16x16x32_bf16 v[120:123], a[184:187], v[188:191], v[120:123]
  v_mfma_f32_16x16x32_bf16 v[124:127], a[188:191], v[188:191], v[124:127]
  ds_read_b64_tr_b16 a[180:181], v205 offset:0
  ds_read_b64_tr_b16 a[182:183], v205 offset:1024
  v_exp_f32 v213, v87
  v_add_f32 v214, v214, v211
  v_mfma_f32_16x16x32_bf16 v[116:119], a[188:191], v[184:187], v[116:119]
  s_waitcnt lgkmcnt(8)
  v_mfma_f32_16x16x32_bf16 v[0:3], a[160:163], a[144:147], v[0:3]
  ds_read_b64_tr_b16 a[184:185], v206 offset:0
  ds_read_b64_tr_b16 a[186:187], v206 offset:1024
  v_exp_f32 v208, v88
  v_mfma_f32_16x16x32_bf16 v[8:11], a[160:163], a[148:151], v[8:11]
  v_mfma_f32_16x16x32_bf16 v[12:15], a[164:167], a[148:151], v[12:15]
  ds_read_b64_tr_b16 a[188:189], v207 offset:0
  ds_read_b64_tr_b16 a[190:191], v207 offset:1024
  buffer_load_dwordx4 v248, s[12:15], s33 offen offset:2048 nt lds
  v_add_f32 v214, v214, v212
  v_mfma_f32_16x16x32_bf16 v[4:7], a[164:167], a[144:147], v[4:7]
  s_waitcnt lgkmcnt(8)
  v_mfma_f32_16x16x32_bf16 v[16:19], a[168:171], a[144:147], v[16:19]
  ds_read_b64_tr_b16 a[160:161], v200 offset:8192
  ds_read_b64_tr_b16 a[162:163], v200 offset:9216
  v_cvt_pk_bf16_f32 v139, v212, v213
  v_exp_f32 v209, v89
  v_mfma_f32_16x16x32_bf16 v[24:27], a[168:171], a[148:151], v[24:27]
  v_mfma_f32_16x16x32_bf16 v[28:31], a[172:175], a[148:151], v[28:31]
  ds_read_b64_tr_b16 a[164:165], v201 offset:8192
  ds_read_b64_tr_b16 a[166:167], v201 offset:9216
  v_add_f32 v214, v214, v213
  v_exp_f32 v210, v90
  v_mfma_f32_16x16x32_bf16 v[20:23], a[172:175], a[144:147], v[20:23]
  s_waitcnt lgkmcnt(8)
  v_mfma_f32_16x16x32_bf16 v[32:35], a[176:179], a[144:147], v[32:35]
  ds_read_b64_tr_b16 a[168:169], v202 offset:8192
  ds_read_b64_tr_b16 a[170:171], v202 offset:9216
  buffer_load_dwordx4 v248, s[12:15], s33 offen offset:3072 nt lds
  s_add_u32 s33, s33, 0x4000
  v_mfma_f32_16x16x32_bf16 v[40:43], a[176:179], a[148:151], v[40:43]
  v_mfma_f32_16x16x32_bf16 v[44:47], a[180:183], a[148:151], v[44:47]
  ds_read_b64_tr_b16 a[172:173], v203 offset:8192
  ds_read_b64_tr_b16 a[174:175], v203 offset:9216
  v_add_f32 v215, v215, v208
  v_cvt_pk_bf16_f32 v140, v208, v209
  v_mfma_f32_16x16x32_bf16 v[36:39], a[180:183], a[144:147], v[36:39]
  s_waitcnt lgkmcnt(8)
  v_mfma_f32_16x16x32_bf16 v[48:51], a[184:187], a[144:147], v[48:51]
  ds_read_b64_tr_b16 a[176:177], v204 offset:8192
  ds_read_b64_tr_b16 a[178:179], v204 offset:9216
  v_exp_f32 v211, v91
  v_add_f32 v215, v215, v209
  v_mfma_f32_16x16x32_bf16 v[56:59], a[184:187], a[148:151], v[56:59]
  v_mfma_f32_16x16x32_bf16 v[60:63], a[188:191], a[148:151], v[60:63]
  ds_read_b64_tr_b16 a[180:181], v205 offset:8192
  ds_read_b64_tr_b16 a[182:183], v205 offset:9216
  v_exp_f32 v212, v92
  v_add_f32 v215, v215, v210
  v_mfma_f32_16x16x32_bf16 v[52:55], a[188:191], a[144:147], v[52:55]
  s_waitcnt lgkmcnt(8)
  v_mfma_f32_16x16x32_bf16 v[0:3], a[160:163], a[152:155], v[0:3]
  ds_read_b64_tr_b16 a[184:185], v206 offset:8192
  ds_read_b64_tr_b16 a[186:187], v206 offset:9216
  v_cvt_pk_bf16_f32 v141, v210, v211
  v_exp_f32 v213, v93
  v_mfma_f32_16x16x32_bf16 v[8:11], a[160:163], a[156:159], v[8:11]
  v_mfma_f32_16x16x32_bf16 v[12:15], a[164:167], a[156:159], v[12:15]
  ds_read_b64_tr_b16 a[188:189], v207 offset:8192
  ds_read_b64_tr_b16 a[190:191], v207 offset:9216
  v_add_f32 v215, v215, v211
  v_exp_f32 v208, v94
  v_mfma_f32_16x16x32_bf16 v[4:7], a[164:167], a[152:155], v[4:7]
  s_waitcnt lgkmcnt(8)
  v_mfma_f32_16x16x32_bf16 v[16:19], a[168:171], a[152:155], v[16:19]
  s_waitcnt vmcnt(20)
  s_barrier
  ds_read_b64_tr_b16 a[160:161], v200 offset:16384
  ds_read_b64_tr_b16 a[162:163], v200 offset:17408
  v_add_f32 v215, v215, v212
  v_mfma_f32_16x16x32_bf16 v[24:27], a[168:171], a[156:159], v[24:27]
  v_mfma_f32_16x16x32_bf16 v[28:31], a[172:175], a[156:159], v[28:31]
  ds_read_b64_tr_b16 a[164:165], v201 offset:16384
  ds_read_b64_tr_b16 a[166:167], v201 offset:17408
  s_add_u32 m0, s41, 49152
  s_nop 0
  buffer_load_dwordx4 v240, s[8:11], s32 offen offset:0 nt lds
  v_mfma_f32_16x16x32_bf16 v[20:23], a[172:175], a[152:155], v[20:23]
  s_waitcnt lgkmcnt(8)
  v_mfma_f32_16x16x32_bf16 v[32:35], a[176:179], a[152:155], v[32:35]
  ds_read_b64_tr_b16 a[168:169], v202 offset:16384
  ds_read_b64_tr_b16 a[170:171], v202 offset:17408
  v_cvt_pk_bf16_f32 v142, v212, v213
  v_exp_f32 v209, v95
  v_mfma_f32_16x16x32_bf16 v[40:43], a[176:179], a[156:159], v[40:43]
  v_mfma_f32_16x16x32_bf16 v[44:47], a[180:183], a[156:159], v[44:47]
  ds_read_b64_tr_b16 a[172:173], v203 offset:16384
  ds_read_b64_tr_b16 a[174:175], v203 offset:17408
  v_add_f32 v215, v215, v213
  v_add_f32 v215, v215, v208
  v_cvt_pk_bf16_f32 v143, v208, v209
  v_mfma_f32_16x16x32_bf16 v[36:39], a[180:183], a[152:155], v[36:39]
  s_waitcnt lgkmcnt(8)
  v_mfma_f32_16x16x32_bf16 v[48:51], a[184:187], a[152:155], v[48:51]
  ds_read_b64_tr_b16 a[176:177], v204 offset:16384
  ds_read_b64_tr_b16 a[178:179], v204 offset:17408
  buffer_load_dwordx4 v241, s[8:11], s32 offen offset:1024 nt lds
  v_mfma_f32_16x16x32_bf16 v[56:59], a[184:187], a[156:159], v[56:59]
  v_mfma_f32_16x16x32_bf16 v[60:63], a[188:191], a[156:159], v[60:63]
  ds_read_b64_tr_b16 a[180:181], v205 offset:16384
  ds_read_b64_tr_b16 a[182:183], v205 offset:17408
  v_add_f32 v215, v215, v209
  v_add_f32 v210, v214, v215
  v_cmp_lt_f32 vcc, s35, v210
  v_mfma_f32_16x16x32_bf16 v[52:55], a[188:191], a[152:155], v[52:55]
  s_cbranch_vccnz SITE100
BACK100:
  s_waitcnt lgkmcnt(8)
  v_mfma_f32_16x16x32_bf16 a[192:195], a[160:163], v[128:131], a[192:195]
  ds_read_b64_tr_b16 a[184:185], v206 offset:16384
  ds_read_b64_tr_b16 a[186:187], v206 offset:17408
  v_add_f32 v249, v249, v214
  v_add_f32 v254, v254, v215
  v_mfma_f32_16x16x32_bf16 a[200:203], a[160:163], v[132:135], a[200:203]
  v_mfma_f32_16x16x32_bf16 a[204:207], a[164:167], v[132:135], a[204:207]
  ds_read_b64_tr_b16 a[188:189], v207 offset:16384
  ds_read_b64_tr_b16 a[190:191], v207 offset:17408
  buffer_load_dwordx4 v242, s[8:11], s32 offen offset:2048 nt lds
  v_exp_f32 v208, v96
  v_mfma_f32_16x16x32_bf16 a[196:199], a[164:167], v[128:131], a[196:199]
  s_waitcnt lgkmcnt(8)
  v_mfma_f32_16x16x32_bf16 a[208:211], a[168:171], v[128:131], a[208:211]
  ds_read_b64_tr_b16 a[160:161], v200 offset:24576
  ds_read_b64_tr_b16 a[162:163], v200 offset:25600
  v_exp_f32 v209, v97
  v_mfma_f32_16x16x32_bf16 a[216:219], a[168:171], v[132:135], a[216:219]
  v_mfma_f32_16x16x32_bf16 a[220:223], a[172:175], v[132:135], a[220:223]
  ds_read_b64_tr_b16 a[164:165], v201 offset:24576
  ds_read_b64_tr_b16 a[166:167], v201 offset:25600
  v_exp_f32 v210, v98
  v_cvt_pk_bf16_f32 v144, v208, v209
  v_mfma_f32_16x16x32_bf16 a[212:215], a[172:175], v[128:131], a[212:215]
  s_waitcnt lgkmcnt(8)
  v_mfma_f32_16x16x32_bf16 a[224:227], a[176:179], v[128:131], a[224:227]
  ds_read_b64_tr_b16 a[168:169], v202 offset:24576
  ds_read_b64_tr_b16 a[170:171], v202 offset:25600
  buffer_load_dwordx4 v243, s[8:11], s32 offen offset:3072 nt lds
  s_add_u32 s32, s32, 0x4000
  v_mfma_f32_16x16x32_bf16 a[232:235], a[176:179], v[132:135], a[232:235]
  v_mfma_f32_16x16x32_bf16 a[236:239], a[180:183], v[132:135], a[236:239]
  ds_read_b64_tr_b16 a[172:173], v203 offset:24576
  ds_read_b64_tr_b16 a[174:175], v203 offset:25600
  v_exp_f32 v211, v99
  v_add_f32 v214, v208, v209
  v_mfma_f32_16x16x32_bf16 a[228:231], a[180:183], v[128:131], a[228:231]
  s_waitcnt lgkmcnt(8)
  v_mfma_f32_16x16x32_bf16 a[240:243], a[184:187], v[128:131], a[240:243]
  ds_read_b64_tr_b16 a[176:177], v204 offset:24576
  ds_read_b64_tr_b16 a[178:179], v204 offset:25600
  v_exp_f32 v212, v100
  v_mfma_f32_16x16x32_bf16 a[248:251], a[184:187], v[132:135], a[248:251]
  v_mfma_f32_16x16x32_bf16 a[252:255], a[188:191], v[132:135], a[252:255]
  ds_read_b64_tr_b16 a[180:181], v205 offset:24576
  ds_read_b64_tr_b16 a[182:183], v205 offset:25600
  v_add_f32 v214, v214, v210
  v_cvt_pk_bf16_f32 v145, v210, v211
  v_exp_f32 v213, v101
  v_mfma_f32_16x16x32_bf16 a[244:247], a[188:191], v[128:131], a[244:247]
  s_waitcnt lgkmcnt(8)
  v_mfma_f32_16x16x32_bf16 a[192:195], a[160:163], v[136:139], a[192:195]
  ds_read_b64_tr_b16 a[184:185], v206 offset:24576
  ds_read_b64_tr_b16 a[186:187], v206 offset:25600
  v_add_f32 v214, v214, v211
  v_mfma_f32_16x16x32_bf16 a[200:203], a[160:163], v[140:143], a[200:203]
  v_mfma_f32_16x16x32_bf16 a[204:207], a[164:167], v[140:143], a[204:207]
  ds_read_b64_tr_b16 a[188:189], v207 offset:24576
  ds_read_b64_tr_b16 a[190:191], v207 offset:25600
  v_exp_f32 v208, v102
  v_add_f32 v214, v214, v212
  v_cvt_pk_bf16_f32 v146, v212, v213
  v_mfma_f32_16x16x32_bf16 a[196:199], a[164:167], v[136:139], a[196:199]
  s_waitcnt lgkmcnt(8)
  v_mfma_f32_16x16x32_bf16 a[208:211], a[168:171], v[136:139], a[208:211]
  s_barrier
  ds_read_b128 a[160:163], v224 offset:0
  v_exp_f32 v209, v103
  v_mfma_f32_16x16x32_bf16 a[216:219], a[168:171], v[140:143], a[216:219]
  v_mfma_f32_16x16x32_bf16 a[220:223], a[172:175], v[140:143], a[220:223]
  ds_read_b128 a[164:167], v224 offset:4096
  s_add_u32 s34, s77, 163840
  s_add_u32 m0, s41, 131072
  s_nop 0
  buffer_load_dwordx4 v244, s[64:67], s34 offen offset:0 lds
  v_add_f32 v214, v214, v213
  v_mfma_f32_16x16x32_bf16 a[212:215], a[172:175], v[136:139], a[212:215]
  s_waitcnt lgkmcnt(6)
  v_mfma_f32_16x16x32_bf16 a[224:227], a[176:179], v[136:139], a[224:227]
  ds_read_b128 a[168:171], v225 offset:0
  v_exp_f32 v210, v104
  v_add_f32 v214, v214, v208
  v_mfma_f32_16x16x32_bf16 a[232:235], a[176:179], v[140:143], a[232:235]
  v_mfma_f32_16x16x32_bf16 a[236:239], a[180:183], v[140:143], a[236:239]
  ds_read_b128 a[172:175], v225 offset:4096
  v_cvt_pk_bf16_f32 v147, v208, v209
  v_exp_f32 v211, v105
  v_add_f32 v214, v214, v209
  v_mfma_f32_16x16x32_bf16 a[228:231], a[180:183], v[136:139], a[228:231]
  s_waitcnt lgkmcnt(4)
  v_mfma_f32_16x16x32_bf16 a[240:243], a[184:187], v[136:139], a[240:243]
  ds_read_b128 a[176:179], v226 offset:0
  buffer_load_dwordx4 v245, s[64:67], s34 offen offset:1024 lds
  v_mfma_f32_16x16x32_bf16 a[248:251], a[184:187], v[140:143], a[248:251]
  v_mfma_f32_16x16x32_bf16 a[252:255], a[188:191], v[140:143], a[252:255]
  ds_read_b128 a[180:183], v226 offset:4096
  v_exp_f32 v212, v106
  v_cvt_pk_bf16_f32 v148, v210, v211
  v_exp_f32 v213, v107
  v_mfma_f32_16x16x32_bf16 a[244:247], a[188:191], v[136:139], a[244:247]
  s_waitcnt lgkmcnt(4)
  v_mfma_f32_16x16x32_bf16 v[64:67], a[160:163], v[160:163], v[192:195]
  ds_read_b128 a[184:187], v227 offset:0
  v_add_f32 v215, v210, v211
  v_exp_f32 v208, v108
  v_mfma_f32_16x16x32_bf16 v[72:75], a[160:163], v[164:167], v[196:199]
  v_mfma_f32_16x16x32_bf16 v[76:79], a[164:167], v[164:167], v[196:199]
  ds_read_b128 a[188:191], v227 offset:4096
  buffer_load_dwordx4 v246, s[64:67], s34 offen offset:2048 lds
  v_mfma_f32_16x16x32_bf16 v[68:71], a[164:167], v[160:163], v[192:195]
  s_waitcnt lgkmcnt(4)
  v_mfma_f32_16x16x32_bf16 v[64:67], a[168:171], v[168:171], v[64:67]
  ds_read_b128 a[160:163], v224 offset:2048
  v_add_f32 v215, v215, v212
  v_cvt_pk_bf16_f32 v149, v212, v213
  v_exp_f32 v209, v109
  v_mfma_f32_16x16x32_bf16 v[72:75], a[168:171], v[172:175], v[72:75]
  v_mfma_f32_16x16x32_bf16 v[76:79], a[172:175], v[172:175], v[76:79]
  ds_read_b128 a[164:167], v224 offset:6144
  v_add_f32 v215, v215, v213
  v_exp_f32 v210, v110
  v_add_f32 v215, v215, v208
  v_mfma_f32_16x16x32_bf16 v[68:71], a[172:175], v[168:171], v[68:71]
  s_waitcnt lgkmcnt(4)
  v_mfma_f32_16x16x32_bf16 v[64:67], a[176:179], v[176:179], v[64:67]
  ds_read_b128 a[168:171], v225 offset:2048
  buffer_load_dwordx4 v247, s[64:67], s34 offen offset:3072 lds
  v_mfma_f32_16x16x32_bf16 v[72:75], a[176:179], v[180:183], v[72:75]
  v_mfma_f32_16x16x32_bf16 v[76:79], a[180:183], v[180:183], v[76:79]
  ds_read_b128 a[172:175], v225 offset:6144
  v_cvt_pk_bf16_f32 v150, v208, v209
  v_exp_f32 v211, v111
  v_add_f32 v215, v215, v209
  v_mfma_f32_16x16x32_bf16 v[68:71], a[180:183], v[176:179], v[68:71]
  s_waitcnt lgkmcnt(4)
  v_mfma_f32_16x16x32_bf16 v[64:67], a[184:187], v[184:187], v[64:67]
  ds_read_b128 a[176:179], v226 offset:2048
  v_exp_f32 v212, v112
  v_add_f32 v215, v215, v210
  v_mfma_f32_16x16x32_bf16 v[72:75], a[184:187], v[188:191], v[72:75]
  v_mfma_f32_16x16x32_bf16 v[76:79], a[188:191], v[188:191], v[76:79]
  ds_read_b128 a[180:183], v226 offset:6144
  v_cvt_pk_bf16_f32 v151, v210, v211
  v_exp_f32 v213, v113
  v_add_f32 v215, v215, v211
  v_mfma_f32_16x16x32_bf16 v[68:71], a[188:191], v[184:187], v[68:71]
  s_waitcnt lgkmcnt(4)
  v_mfma_f32_16x16x32_bf16 v[80:83], a[160:163], v[160:163], v[192:195]
  ds_read_b128 a[184:187], v227 offset:2048
  v_exp_f32 v208, v114
  v_add_f32 v214, v214, v212
  v_cvt_pk_bf16_f32 v152, v212, v213
  v_mfma_f32_16x16x32_bf16 v[88:91], a[160:163], v[164:167], v[196:199]
  v_mfma_f32_16x16x32_bf16 v[92:95], a[164:167], v[164:167], v[196:199]
  ds_read_b128 a[188:191], v227 offset:6144
  v_exp_f32 v209, v115
  v_add_f32 v214, v214, v213
  v_mfma_f32_16x16x32_bf16 v[84:87], a[164:167], v[160:163], v[192:195]
  s_waitcnt lgkmcnt(4)
  v_mfma_f32_16x16x32_bf16 v[80:83], a[168:171], v[168:171], v[80:83]
  s_waitcnt vmcnt(24)
  s_barrier
  ds_read_b64_tr_b16 a[160:161], v232 offset:16384
  ds_read_b64_tr_b16 a[162:163], v232 offset:17408
  v_exp_f32 v210, v116
  v_mfma_f32_16x16x32_bf16 v[88:91], a[168:171], v[172:175], v[88:91]
  v_mfma_f32_16x16x32_bf16 v[92:95], a[172:175], v[172:175], v[92:95]
  ds_read_b64_tr_b16 a[164:165], v233 offset:16384
  ds_read_b64_tr_b16 a[166:167], v233 offset:17408
  s_add_u32 m0, s41, 147456
  s_nop 0
  buffer_load_dwordx4 v248, s[12:15], s33 offen offset:0 nt lds
  v_mfma_f32_16x16x32_bf16 v[84:87], a[172:175], v[168:171], v[84:87]
  s_waitcnt lgkmcnt(6)
  v_mfma_f32_16x16x32_bf16 v[80:83], a[176:179], v[176:179], v[80:83]
  ds_read_b64_tr_b16 a[168:169], v234 offset:16384
  ds_read_b64_tr_b16 a[170:171], v234 offset:17408
  v_add_f32 v214, v214, v208
  v_cvt_pk_bf16_f32 v153, v208, v209
  v_mfma_f32_16x16x32_bf16 v[88:91], a[176:179], v[180:183], v[88:91]
  v_mfma_f32_16x16x32_bf16 v[92:95], a[180:183], v[180:183], v[92:95]
  ds_read_b64_tr_b16 a[172:173], v235 offset:16384
  ds_read_b64_tr_b16 a[174:175], v235 offset:17408
  v_exp_f32 v211, v117
  v_add_f32 v214, v214, v209
  v_mfma_f32_16x16x32_bf16 v[84:87], a[180:183], v[176:179], v[84:87]
  s_waitcnt lgkmcnt(8)
  v_mfma_f32_16x16x32_bf16 v[80:83], a[184:187], v[184:187], v[80:83]
  ds_read_b64_tr_b16 a[176:177], v236 offset:16384
  ds_read_b64_tr_b16 a[178:179], v236 offset:17408
  buffer_load_dwordx4 v248, s[12:15], s33 offen offset:1024 nt lds
  v_mfma_f32_16x16x32_bf16 v[88:91], a[184:187], v[188:191], v[88:91]
  v_mfma_f32_16x16x32_bf16 v[92:95], a[188:191], v[188:191], v[92:95]
  ds_read_b64_tr_b16 a[180:181], v237 offset:16384
  ds_read_b64_tr_b16 a[182:183], v237 offset:17408
  v_exp_f32 v212, v118
  v_add_f32 v214, v214, v210
  v_mfma_f32_16x16x32_bf16 v[84:87], a[188:191], v[184:187], v[84:87]
  s_waitcnt lgkmcnt(8)
  v_mfma_f32_16x16x32_bf16 a[64:67], a[160:163], a[32:35], 0
  ds_read_b64_tr_b16 a[184:185], v238 offset:16384
  ds_read_b64_tr_b16 a[186:187], v238 offset:17408
  v_cvt_pk_bf16_f32 v154, v210, v211
  v_exp_f32 v213, v119
  v_mfma_f32_16x16x32_bf16 a[72:75], a[160:163], a[36:39], 0
  v_mfma_f32_16x16x32_bf16 a[76:79], a[164:167], a[36:39], 0
  ds_read_b64_tr_b16 a[188:189], v239 offset:16384
  ds_read_b64_tr_b16 a[190:191], v239 offset:17408
  buffer_load_dwordx4 v248, s[12:15], s33 offen offset:2048 nt lds
  v_mfma_f32_16x16x32_bf16 a[68:71], a[164:167], a[32:35], 0
  s_waitcnt lgkmcnt(8)
  v_mfma_f32_16x16x32_bf16 a[80:83], a[168:171], a[32:35], 0
  ds_read_b64_tr_b16 a[160:161], v232 offset:24576
  ds_read_b64_tr_b16 a[162:163], v232 offset:25600
  v_add_f32 v214, v214, v211
  v_exp_f32 v208, v120
  v_mfma_f32_16x16x32_bf16 a[88:91], a[168:171], a[36:39], 0
  v_mfma_f32_16x16x32_bf16 a[92:95], a[172:175], a[36:39], 0
  ds_read_b64_tr_b16 a[164:165], v233 offset:24576
  ds_read_b64_tr_b16 a[166:167], v233 offset:25600
  v_add_f32 v214, v214, v212
  v_cvt_pk_bf16_f32 v155, v212, v213
  v_mfma_f32_16x16x32_bf16 a[84:87], a[172:175], a[32:35], 0
  s_waitcnt lgkmcnt(8)
  v_mfma_f32_16x16x32_bf16 a[96:99], a[176:179], a[32:35], 0
  ds_read_b64_tr_b16 a[168:169], v234 offset:24576
  ds_read_b64_tr_b16 a[170:171], v234 offset:25600
  buffer_load_dwordx4 v248, s[12:15], s33 offen offset:3072 nt lds
  s_add_u32 s33, s33, 0x4000
  v_mfma_f32_16x16x32_bf16 a[104:107], a[176:179], a[36:39], 0
  v_mfma_f32_16x16x32_bf16 a[108:111], a[180:183], a[36:39], 0
  ds_read_b64_tr_b16 a[172:173], v235 offset:24576
  ds_read_b64_tr_b16 a[174:175], v235 offset:25600
  v_exp_f32 v209, v121
  v_add_f32 v214, v214, v213
  v_mfma_f32_16x16x32_bf16 a[100:103], a[180:183], a[32:35], 0
  s_waitcnt lgkmcnt(8)
  v_mfma_f32_16x16x32_bf16 a[112:115], a[184:187], a[32:35], 0
  ds_read_b64_tr_b16 a[176:177], v236 offset:24576
  ds_read_b64_tr_b16 a[178:179], v236 offset:25600
  v_exp_f32 v210, v122
  v_add_f32 v215, v215, v208
  v_mfma_f32_16x16x32_bf16 a[120:123], a[184:187], a[36:39], 0
  v_mfma_f32_16x16x32_bf16 a[124:127], a[188:191], a[36:39], 0
  ds_read_b64_tr_b16 a[180:181], v237 offset:24576
  ds_read_b64_tr_b16 a[182:183], v237 offset:25600
  v_cvt_pk_bf16_f32 v156, v208, v209
  v_exp_f32 v211, v123
  v_mfma_f32_16x16x32_bf16 a[116:119], a[188:191], a[32:35], 0
  s_waitcnt lgkmcnt(8)
  v_mfma_f32_16x16x32_bf16 a[64:67], a[160:163], a[40:43], a[64:67]
  ds_read_b64_tr_b16 a[184:185], v238 offset:24576
  ds_read_b64_tr_b16 a[186:187], v238 offset:25600
  v_add_f32 v215, v215, v209
  v_exp_f32 v212, v124
  v_mfma_f32_16x16x32_bf16 a[72:75], a[160:163], a[44:47], a[72:75]
  v_mfma_f32_16x16x32_bf16 a[76:79], a[164:167], a[44:47], a[76:79]
  ds_read_b64_tr_b16 a[188:189], v239 offset:24576
  ds_read_b64_tr_b16 a[190:191], v239 offset:25600
  v_add_f32 v215, v215, v210
  v_cvt_pk_bf16_f32 v157, v210, v211
  v_mfma_f32_16x16x32_bf16 a[68:71], a[164:167], a[40:43], a[68:71]
  s_waitcnt lgkmcnt(8)
  v_mfma_f32_16x16x32_bf16 a[80:83], a[168:171], a[40:43], a[80:83]
  s_waitcnt vmcnt(24)
  s_barrier
  ds_read_b64_tr_b16 a[160:161], v232 offset:32768
  ds_read_b64_tr_b16 a[162:163], v232 offset:33792
  v_exp_f32 v213, v125
  v_mfma_f32_16x16x32_bf16 a[88:91], a[168:171], a[44:47], a[88:91]
  v_mfma_f32_16x16x32_bf16 a[92:95], a[172:175], a[44:47], a[92:95]
  ds_read_b64_tr_b16 a[164:165], v233 offset:32768
  ds_read_b64_tr_b16 a[166:167], v233 offset:33792
  v_add_f32 v215, v215, v211
  v_exp_f32 v208, v126
  v_mfma_f32_16x16x32_bf16 a[84:87], a[172:175], a[40:43], a[84:87]
  s_waitcnt lgkmcnt(8)
  v_mfma_f32_16x16x32_bf16 a[96:99], a[176:179], a[40:43], a[96:99]
  ds_read_b64_tr_b16 a[168:169], v234 offset:32768
  ds_read_b64_tr_b16 a[170:171], v234 offset:33792
  v_add_f32 v215, v215, v212
  v_cvt_pk_bf16_f32 v158, v212, v213
  v_mfma_f32_16x16x32_bf16 a[104:107], a[176:179], a[44:47], a[104:107]
  v_mfma_f32_16x16x32_bf16 a[108:111], a[180:183], a[44:47], a[108:111]
  ds_read_b64_tr_b16 a[172:173], v235 offset:32768
  ds_read_b64_tr_b16 a[174:175], v235 offset:33792
  v_exp_f32 v209, v127
  v_mfma_f32_16x16x32_bf16 a[100:103], a[180:183], a[40:43], a[100:103]
  s_waitcnt lgkmcnt(8)
  v_mfma_f32_16x16x32_bf16 a[112:115], a[184:187], a[40:43], a[112:115]
  ds_read_b64_tr_b16 a[176:177], v236 offset:32768
  ds_read_b64_tr_b16 a[178:179], v236 offset:33792
  v_add_f32 v215, v215, v213
  v_add_f32 v215, v215, v208
  v_cvt_pk_bf16_f32 v159, v208, v209
  v_mfma_f32_16x16x32_bf16 a[120:123], a[184:187], a[44:47], a[120:123]
  v_mfma_f32_16x16x32_bf16 a[124:127], a[188:191], a[44:47], a[124:127]
  ds_read_b64_tr_b16 a[180:181], v237 offset:32768
  ds_read_b64_tr_b16 a[182:183], v237 offset:33792
  v_add_f32 v215, v215, v209
  v_add_f32 v210, v214, v215
  v_cmp_lt_f32 vcc, s35, v210
  v_mfma_f32_16x16x32_bf16 a[116:119], a[188:191], a[40:43], a[116:119]
  s_cbranch_vccnz SITE103
BACK103:
  s_waitcnt lgkmcnt(8)
  v_mfma_f32_16x16x32_bf16 a[192:195], a[160:163], v[144:147], a[192:195]
  ds_read_b64_tr_b16 a[184:185], v238 offset:32768
  ds_read_b64_tr_b16 a[186:187], v238 offset:33792
  v_add_f32 v249, v249, v214
  v_add_f32 v254, v254, v215
  v_exp_f32 v208, v64
  v_mfma_f32_16x16x32_bf16 a[200:203], a[160:163], v[148:151], a[200:203]
  v_mfma_f32_16x16x32_bf16 a[204:207], a[164:167], v[148:151], a[204:207]
  ds_read_b64_tr_b16 a[188:189], v239 offset:32768
  ds_read_b64_tr_b16 a[190:191], v239 offset:33792
  v_exp_f32 v209, v65
  v_mfma_f32_16x16x32_bf16 a[196:199], a[164:167], v[144:147], a[196:199]
  s_waitcnt lgkmcnt(8)
  v_mfma_f32_16x16x32_bf16 a[208:211], a[168:171], v[144:147], a[208:211]
  ds_read_b64_tr_b16 a[160:161], v232 offset:40960
  ds_read_b64_tr_b16 a[162:163], v232 offset:41984
  v_exp_f32 v210, v66
  v_mfma_f32_16x16x32_bf16 a[216:219], a[168:171], v[148:151], a[216:219]
  v_mfma_f32_16x16x32_bf16 a[220:223], a[172:175], v[148:151], a[220:223]
  ds_read_b64_tr_b16 a[164:165], v233 offset:40960
  ds_read_b64_tr_b16 a[166:167], v233 offset:41984
  v_cvt_pk_bf16_f32 v128, v208, v209
  v_exp_f32 v211, v67
  v_mfma_f32_16x16x32_bf16 a[212:215], a[172:175], v[144:147], a[212:215]
  s_waitcnt lgkmcnt(8)
  v_mfma_f32_16x16x32_bf16 a[224:227], a[176:179], v[144:147], a[224:227]
  ds_read_b64_tr_b16 a[168:169], v234 offset:40960
  ds_read_b64_tr_b16 a[170:171], v234 offset:41984
  v_add_f32 v214, v208, v209
  v_exp_f32 v212, v68
  v_mfma_f32_16x16x32_bf16 a[232:235], a[176:179], v[148:151], a[232:235]
  v_mfma_f32_16x16x32_bf16 a[236:239], a[180:183], v[148:151], a[236:239]
  ds_read_b64_tr_b16 a[172:173], v235 offset:40960
  ds_read_b64_tr_b16 a[174:175], v235 offset:41984
  v_add_f32 v214, v214, v210
  v_cvt_pk_bf16_f32 v129, v210, v211
  v_mfma_f32_16x16x32_bf16 a[228:231], a[180:183], v[144:147], a[228:231]
  s_waitcnt lgkmcnt(8)
  v_mfma_f32_16x16x32_bf16 a[240:243], a[184:187], v[144:147], a[240:243]
  ds_read_b64_tr_b16 a[176:177], v236 offset:40960
  ds_read_b64_tr_b16 a[178:179], v236 offset:41984
  v_exp_f32 v213, v69
  v_add_f32 v214, v214, v211
  v_mfma_f32_16x16x32_bf16 a[248:251], a[184:187], v[148:151], a[248:251]
  v_mfma_f32_16x16x32_bf16 a[252:255], a[188:191], v[148:151], a[252:255]
  ds_read_b64_tr_b16 a[180:181], v237 offset:40960
  ds_read_b64_tr_b16 a[182:183], v237 offset:41984
  v_exp_f32 v208, v70
  v_add_f32 v214, v214, v212
  v_mfma_f32_16x16x32_bf16 a[244:247], a[188:191], v[144:147], a[244:247]
  s_waitcnt lgkmcnt(8)
  v_mfma_f32_16x16x32_bf16 a[192:195], a[160:163], v[152:155], a[192:195]
  ds_read_b64_tr_b16 a[184:185], v238 offset:40960
  ds_read_b64_tr_b16 a[186:187], v238 offset:41984
  v_cvt_pk_bf16_f32 v130, v212, v213
  v_exp_f32 v209, v71
  v_mfma_f32_16x16x32_bf16 a[200:203], a[160:163], v[156:159], a[200:203]
  v_mfma_f32_16x16x32_bf16 a[204:207], a[164:167], v[156:159], a[204:207]
  ds_read_b64_tr_b16 a[188:189], v239 offset:40960
  ds_read_b64_tr_b16 a[190:191], v239 offset:41984
  v_add_f32 v214, v214, v213
  v_mfma_f32_16x16x32_bf16 a[196:199], a[164:167], v[152:155], a[196:199]
  s_waitcnt lgkmcnt(8)
  v_mfma_f32_16x16x32_bf16 a[208:211], a[168:171], v[152:155], a[208:211]
  s_barrier
  ds_read_b128 a[160:163], v224 offset:16384
  v_exp_f32 v210, v72
  v_add_f32 v214, v214, v208
  v_cvt_pk_bf16_f32 v131, v208, v209
  v_mfma_f32_16x16x32_bf16 a[216:219], a[168:171], v[156:159], a[216:219]
  v_mfma_f32_16x16x32_bf16 a[220:223], a[172:175], v[156:159], a[220:223]
  ds_read_b128 a[164:167], v224 offset:20480
  s_add_u32 s34, s77, 245760
  s_add_u32 m0, s41, 81920
  s_nop 0
  buffer_load_dwordx4 v244, s[64:67], s34 offen offset:0 lds
  v_mfma_f32_16x16x32_bf16 a[212:215], a[172:175], v[152:155], a[212:215]
  s_waitcnt lgkmcnt(6)
  v_mfma_f32_16x16x32_bf16 a[224:227], a[176:179], v[152:155], a[224:227]
  ds_read_b128 a[168:171], v225 offset:16384
  v_exp_f32 v211, v73
  v_add_f32 v214, v214, v209
  v_mfma_f32_16x16x32_bf16 a[232:235], a[176:179], v[156:159], a[232:235]
  v_mfma_f32_16x16x32_bf16 a[236:239], a[180:183], v[156:159], a[236:239]
  ds_read_b128 a[172:175], v225 offset:20480
  v_exp_f32 v212, v74
  v_cvt_pk_bf16_f32 v132, v210, v211
  v_mfma_f32_16x16x32_bf16 a[228:231], a[180:183], v[152:155], a[228:231]
  s_waitcnt lgkmcnt(4)
  v_mfma_f32_16x16x32_bf16 a[240:243], a[184:187], v[152:155], a[240:243]
  ds_read_b128 a[176:179], v226 offset:16384
  buffer_load_dwordx4 v245, s[64:67], s34 offen offset:1024 lds
  v_exp_f32 v213, v75
  v_mfma_f32_16x16x32_bf16 a[248:251], a[184:187], v[156:159], a[248:251]
  v_mfma_f32_16x16x32_bf16 a[252:255], a[188:191], v[156:159], a[252:255]
  ds_read_b128 a[180:183], v226 offset:20480
  v_add_f32 v215, v210, v211
  v_exp_f32 v208, v76
  v_mfma_f32_16x16x32_bf16 a[244:247], a[188:191], v[152:155], a[244:247]
  s_waitcnt lgkmcnt(4)
  v_mfma_f32_16x16x32_bf16 v[96:99], a[160:163], v[160:163], v[192:195]
  ds_read_b128 a[184:187], v227 offset:16384
  v_add_f32 v215, v215, v212
  v_cvt_pk_bf16_f32 v133, v212, v213
  v_exp_f32 v209, v77
  v_mfma_f32_16x16x32_bf16 v[104:107], a[160:163], v[164:167], v[196:199]
  v_mfma_f32_16x16x32_bf16 v[108:111], a[164:167], v[164:167], v[196:199]
  ds_read_b128 a[188:191], v227 offset:20480
  buffer_load_dwordx4 v246, s[64:67], s34 offen offset:2048 lds
  v_mfma_f32_16x16x32_bf16 v[100:103], a[164:167], v[160:163], v[192:195]
  s_waitcnt lgkmcnt(4)
  v_mfma_f32_16x16x32_bf16 v[96:99], a[168:171], v[168:171], v[96:99]
  ds_read_b128 a[160:163], v224 offset:18432
  v_add_f32 v215, v215, v213
  v_exp_f32 v210, v78
  v_mfma_f32_16x16x32_bf16 v[104:107], a[168:171], v[172:175], v[104:107]
  v_mfma_f32_16x16x32_bf16 v[108:111], a[172:175], v[172:175], v[108:111]
  ds_read_b128 a[164:167], v224 offset:22528
  v_add_f32 v215, v215, v208
  v_cvt_pk_bf16_f32 v134, v208, v209
  v_exp_f32 v211, v79
  v_mfma_f32_16x16x32_bf16 v[100:103], a[172:175], v[168:171], v[100:103]
  s_waitcnt lgkmcnt(4)
  v_mfma_f32_16x16x32_bf16 v[96:99], a[176:179], v[176:179], v[96:99]
  ds_read_b128 a[168:171], v225 offset:18432
  buffer_load_dwordx4 v247, s[64:67], s34 offen offset:3072 lds
  v_mfma_f32_16x16x32_bf16 v[104:107], a[176:179], v[180:183], v[104:107]
  v_mfma_f32_16x16x32_bf16 v[108:111], a[180:183], v[180:183], v[108:111]
  ds_read_b128 a[172:175], v225 offset:22528
  v_add_f32 v215, v215, v209
  v_exp_f32 v212, v80
  v_add_f32 v215, v215, v210
  v_mfma_f32_16x16x32_bf16 v[100:103], a[180:183], v[176:179], v[100:103]
  s_waitcnt lgkmcnt(4)
  v_mfma_f32_16x16x32_bf16 v[96:99], a[184:187], v[184:187], v[96:99]
  ds_read_b128 a[176:179], v226 offset:18432
  v_cvt_pk_bf16_f32 v135, v210, v211
  v_exp_f32 v213, v81
  v_mfma_f32_16x16x32_bf16 v[104:107], a[184:187], v[188:191], v[104:107]
  v_mfma_f32_16x16x32_bf16 v[108:111], a[188:191], v[188:191], v[108:111]
  ds_read_b128 a[180:183], v226 offset:22528
  v_add_f32 v215, v215, v211
  v_exp_f32 v208, v82
  v_add_f32 v214, v214, v212
  v_mfma_f32_16x16x32_bf16 v[100:103], a[188:191], v[184:187], v[100:103]
  s_waitcnt lgkmcnt(4)
  v_mfma_f32_16x16x32_bf16 v[112:115], a[160:163], v[160:163], v[192:195]
  ds_read_b128 a[184:187], v227 offset:18432
  v_cvt_pk_bf16_f32 v136, v212, v213
  v_exp_f32 v209, v83
  v_mfma_f32_16x16x32_bf16 v[120:123], a[160:163], v[164:167], v[196:199]
  v_mfma_f32_16x16x32_bf16 v[124:127], a[164:167], v[164:167], v[196:199]
  ds_read_b128 a[188:191], v227 offset:22528
  v_add_f32 v214, v214, v213
  v_exp_f32 v210, v84
  v_add_f32 v214, v214, v208
  v_mfma_f32_16x16x32_bf16 v[116:119], a[164:167], v[160:163], v[192:195]
  s_waitcnt lgkmcnt(4)
  v_mfma_f32_16x16x32_bf16 v[112:115], a[168:171], v[168:171], v[112:115]
  s_waitcnt vmcnt(20)
  s_barrier
  ds_read_b64_tr_b16 a[160:161], v232 offset:49152
  ds_read_b64_tr_b16 a[162:163], v232 offset:50176
  v_cvt_pk_bf16_f32 v137, v208, v209
  v_mfma_f32_16x16x32_bf16 v[120:123], a[168:171], v[172:175], v[120:123]
  v_mfma_f32_16x16x32_bf16 v[124:127], a[172:175], v[172:175], v[124:127]
  ds_read_b64_tr_b16 a[164:165], v233 offset:49152
  ds_read_b64_tr_b16 a[166:167], v233 offset:50176
  s_add_u32 s34, s77, 327680
  s_add_u32 m0, s41, 98304
  s_nop 0
  buffer_load_dwordx4 v244, s[64:67], s34 offen offset:0 lds
  v_mfma_f32_16x16x32_bf16 v[116:119], a[172:175], v[168:171], v[116:119]
  s_waitcnt lgkmcnt(6)
  v_mfma_f32_16x16x32_bf16 v[112:115], a[176:179], v[176:179], v[112:115]
  ds_read_b64_tr_b16 a[168:169], v234 offset:49152
  ds_read_b64_tr_b16 a[170:171], v234 offset:50176
  v_exp_f32 v211, v85
  v_add_f32 v214, v214, v209
  v_mfma_f32_16x16x32_bf16 v[120:123], a[176:179], v[180:183], v[120:123]
  v_mfma_f32_16x16x32_bf16 v[124:127], a[180:183], v[180:183], v[124:127]
  ds_read_b64_tr_b16 a[172:173], v235 offset:49152
  ds_read_b64_tr_b16 a[174:175], v235 offset:50176
  v_exp_f32 v212, v86
  v_mfma_f32_16x16x32_bf16 v[116:119], a[180:183], v[176:179], v[116:119]
  s_waitcnt lgkmcnt(8)
  v_mfma_f32_16x16x32_bf16 v[112:115], a[184:187], v[184:187], v[112:115]
  ds_read_b64_tr_b16 a[176:177], v236 offset:49152
  ds_read_b64_tr_b16 a[178:179], v236 offset:50176
  buffer_load_dwordx4 v245, s[64:67], s34 offen offset:1024 lds
  v_mfma_f32_16x16x32_bf16 v[120:123], a[184:187], v[188:191], v[120:123]
  v_mfma_f32_16x16x32_bf16 v[124:127], a[188:191], v[188:191], v[124:127]
  ds_read_b64_tr_b16 a[180:181], v237 offset:49152
  ds_read_b64_tr_b16 a[182:183], v237 offset:50176
  v_add_f32 v214, v214, v210
  v_cvt_pk_bf16_f32 v138, v210, v211
  v_mfma_f32_16x16x32_bf16 v[116:119], a[188:191], v[184:187], v[116:119]
  s_waitcnt lgkmcnt(8)
  v_mfma_f32_16x16x32_bf16 a[64:67], a[160:163], a[48:51], a[64:67]
  ds_read_b64_tr_b16 a[184:185], v238 offset:49152
  ds_read_b64_tr_b16 a[186:187], v238 offset:50176
  v_exp_f32 v213, v87
  v_add_f32 v214, v214, v211
  v_mfma_f32_16x16x32_bf16 a[72:75], a[160:163], a[52:55], a[72:75]
  v_mfma_f32_16x16x32_bf16 a[76:79], a[164:167], a[52:55], a[76:79]
  ds_read_b64_tr_b16 a[188:189], v239 offset:49152
  ds_read_b64_tr_b16 a[190:191], v239 offset:50176
  buffer_load_dwordx4 v246, s[64:67], s34 offen offset:2048 lds
  v_mfma_f32_16x16x32_bf16 a[68:71], a[164:167], a[48:51], a[68:71]
  s_waitcnt lgkmcnt(8)
  v_mfma_f32_16x16x32_bf16 a[80:83], a[168:171], a[48:51], a[80:83]
  ds_read_b64_tr_b16 a[160:161], v232 offset:57344
  ds_read_b64_tr_b16 a[162:163], v232 offset:58368
  v_exp_f32 v208, v88
  v_add_f32 v214, v214, v212
  v_mfma_f32_16x16x32_bf16 a[88:91], a[168:171], a[52:55], a[88:91]
  v_mfma_f32_16x16x32_bf16 a[92:95], a[172:175], a[52:55], a[92:95]
  ds_read_b64_tr_b16 a[164:165], v233 offset:57344
  ds_read_b64_tr_b16 a[166:167], v233 offset:58368
  v_cvt_pk_bf16_f32 v139, v212, v213
  v_exp_f32 v209, v89
  v_mfma_f32_16x16x32_bf16 a[84:87], a[172:175], a[48:51], a[84:87]
  s_waitcnt lgkmcnt(8)
  v_mfma_f32_16x16x32_bf16 a[96:99], a[176:179], a[48:51], a[96:99]
  ds_read_b64_tr_b16 a[168:169], v234 offset:57344
  ds_read_b64_tr_b16 a[170:171], v234 offset:58368
  buffer_load_dwordx4 v247, s[64:67], s34 offen offset:3072 lds
  v_mfma_f32_16x16x32_bf16 a[104:107], a[176:179], a[52:55], a[104:107]
  v_mfma_f32_16x16x32_bf16 a[108:111], a[180:183], a[52:55], a[108:111]
  ds_read_b64_tr_b16 a[172:173], v235 offset:57344
  ds_read_b64_tr_b16 a[174:175], v235 offset:58368
  v_add_f32 v214, v214, v213
  v_exp_f32 v210, v90
  v_mfma_f32_16x16x32_bf16 a[100:103], a[180:183], a[48:51], a[100:103]
  s_waitcnt lgkmcnt(8)
  v_mfma_f32_16x16x32_bf16 a[112:115], a[184:187], a[48:51], a[112:115]
  ds_read_b64_tr_b16 a[176:177], v236 offset:57344
  ds_read_b64_tr_b16 a[178:179], v236 offset:58368
  v_add_f32 v215, v215, v208
  v_cvt_pk_bf16_f32 v140, v208, v209
  v_mfma_f32_16x16x32_bf16 a[120:123], a[184:187], a[52:55], a[120:123]
  v_mfma_f32_16x16x32_bf16 a[124:127], a[188:191], a[52:55], a[124:127]
  ds_read_b64_tr_b16 a[180:181], v237 offset:57344
  ds_read_b64_tr_b16 a[182:183], v237 offset:58368
  v_exp_f32 v211, v91
  v_add_f32 v215, v215, v209
  v_mfma_f32_16x16x32_bf16 a[116:119], a[188:191], a[48:51], a[116:119]
  s_waitcnt lgkmcnt(8)
  v_mfma_f32_16x16x32_bf16 a[64:67], a[160:163], a[56:59], a[64:67]
  ds_read_b64_tr_b16 a[184:185], v238 offset:57344
  ds_read_b64_tr_b16 a[186:187], v238 offset:58368
  v_exp_f32 v212, v92
  v_add_f32 v215, v215, v210
  v_mfma_f32_16x16x32_bf16 a[72:75], a[160:163], a[60:63], a[72:75]
  v_mfma_f32_16x16x32_bf16 a[76:79], a[164:167], a[60:63], a[76:79]
  ds_read_b64_tr_b16 a[188:189], v239 offset:57344
  ds_read_b64_tr_b16 a[190:191], v239 offset:58368
  v_cvt_pk_bf16_f32 v141, v210, v211
  v_exp_f32 v213, v93
  v_mfma_f32_16x16x32_bf16 a[68:71], a[164:167], a[56:59], a[68:71]
  s_waitcnt lgkmcnt(8)
  v_mfma_f32_16x16x32_bf16 a[80:83], a[168:171], a[56:59], a[80:83]
  s_waitcnt vmcnt(20)
  s_barrier
  ds_read_b64_tr_b16 a[160:161], v232 offset:0
  ds_read_b64_tr_b16 a[162:163], v232 offset:1024
  v_mfma_f32_16x16x32_bf16 a[88:91], a[168:171], a[60:63], a[88:91]
  v_mfma_f32_16x16x32_bf16 a[92:95], a[172:175], a[60:63], a[92:95]
  ds_read_b64_tr_b16 a[164:165], v233 offset:0
  ds_read_b64_tr_b16 a[166:167], v233 offset:1024
  v_add_f32 v215, v215, v211
  v_exp_f32 v208, v94
  v_mfma_f32_16x16x32_bf16 a[84:87], a[172:175], a[56:59], a[84:87]
  s_waitcnt lgkmcnt(8)
  v_mfma_f32_16x16x32_bf16 a[96:99], a[176:179], a[56:59], a[96:99]
  ds_read_b64_tr_b16 a[168:169], v234 offset:0
  ds_read_b64_tr_b16 a[170:171], v234 offset:1024
  v_add_f32 v215, v215, v212
  v_cvt_pk_bf16_f32 v142, v212, v213
  v_mfma_f32_16x16x32_bf16 a[104:107], a[176:179], a[60:63], a[104:107]
  v_mfma_f32_16x16x32_bf16 a[108:111], a[180:183], a[60:63], a[108:111]
  ds_read_b64_tr_b16 a[172:173], v235 offset:0
  ds_read_b64_tr_b16 a[174:175], v235 offset:1024
  v_exp_f32 v209, v95
  v_add_f32 v215, v215, v213
  v_mfma_f32_16x16x32_bf16 a[100:103], a[180:183], a[56:59], a[100:103]
  s_waitcnt lgkmcnt(8)
  v_mfma_f32_16x16x32_bf16 a[112:115], a[184:187], a[56:59], a[112:115]
  ds_read_b64_tr_b16 a[176:177], v236 offset:0
  ds_read_b64_tr_b16 a[178:179], v236 offset:1024
  v_add_f32 v215, v215, v208
  v_cvt_pk_bf16_f32 v143, v208, v209
  v_add_f32 v215, v215, v209
  v_mfma_f32_16x16x32_bf16 a[120:123], a[184:187], a[60:63], a[120:123]
  v_mfma_f32_16x16x32_bf16 a[124:127], a[188:191], a[60:63], a[124:127]
  ds_read_b64_tr_b16 a[180:181], v237 offset:0
  ds_read_b64_tr_b16 a[182:183], v237 offset:1024
  v_add_f32 v210, v214, v215
  v_cmp_lt_f32 vcc, s35, v210
  v_mfma_f32_16x16x32_bf16 a[116:119], a[188:191], a[56:59], a[116:119]
  s_cbranch_vccnz SITE106
BACK106:
  s_waitcnt lgkmcnt(8)
  v_mfma_f32_16x16x32_bf16 a[192:195], a[160:163], v[128:131], a[192:195]
  ds_read_b64_tr_b16 a[184:185], v238 offset:0
  ds_read_b64_tr_b16 a[186:187], v238 offset:1024
  v_add_f32 v249, v249, v214
  v_add_f32 v254, v254, v215
  v_exp_f32 v208, v96
  v_mfma_f32_16x16x32_bf16 a[200:203], a[160:163], v[132:135], a[200:203]
  v_mfma_f32_16x16x32_bf16 a[204:207], a[164:167], v[132:135], a[204:207]
  ds_read_b64_tr_b16 a[188:189], v239 offset:0
  ds_read_b64_tr_b16 a[190:191], v239 offset:1024
  v_exp_f32 v209, v97
  v_mfma_f32_16x16x32_bf16 a[196:199], a[164:167], v[128:131], a[196:199]
  s_waitcnt lgkmcnt(8)
  v_mfma_f32_16x16x32_bf16 a[208:211], a[168:171], v[128:131], a[208:211]
  ds_read_b64_tr_b16 a[160:161], v232 offset:8192
  ds_read_b64_tr_b16 a[162:163], v232 offset:9216
  v_exp_f32 v210, v98
  v_mfma_f32_16x16x32_bf16 a[216:219], a[168:171], v[132:135], a[216:219]
  v_mfma_f32_16x16x32_bf16 a[220:223], a[172:175], v[132:135], a[220:223]
  ds_read_b64_tr_b16 a[164:165], v233 offset:8192
  ds_read_b64_tr_b16 a[166:167], v233 offset:9216
  v_cvt_pk_bf16_f32 v144, v208, v209
  v_exp_f32 v211, v99
  v_mfma_f32_16x16x32_bf16 a[212:215], a[172:175], v[128:131], a[212:215]
  s_waitcnt lgkmcnt(8)
  v_mfma_f32_16x16x32_bf16 a[224:227], a[176:179], v[128:131], a[224:227]
  ds_read_b64_tr_b16 a[168:169], v234 offset:8192
  ds_read_b64_tr_b16 a[170:171], v234 offset:9216
  v_add_f32 v214, v208, v209
  v_exp_f32 v212, v100
  v_mfma_f32_16x16x32_bf16 a[232:235], a[176:179], v[132:135], a[232:235]
  v_mfma_f32_16x16x32_bf16 a[236:239], a[180:183], v[132:135], a[236:239]
  ds_read_b64_tr_b16 a[172:173], v235 offset:8192
  ds_read_b64_tr_b16 a[174:175], v235 offset:9216
  v_add_f32 v214, v214, v210
  v_cvt_pk_bf16_f32 v145, v210, v211
  v_mfma_f32_16x16x32_bf16 a[228:231], a[180:183], v[128:131], a[228:231]
  s_waitcnt lgkmcnt(8)
  v_mfma_f32_16x16x32_bf16 a[240:243], a[184:187], v[128:131], a[240:243]
  ds_read_b64_tr_b16 a[176:177], v236 offset:8192
  ds_read_b64_tr_b16 a[178:179], v236 offset:9216
  v_exp_f32 v213, v101
  v_add_f32 v214, v214, v211
  v_mfma_f32_16x16x32_bf16 a[248:251], a[184:187], v[132:135], a[248:251]
  v_mfma_f32_16x16x32_bf16 a[252:255], a[188:191], v[132:135], a[252:255]
  ds_read_b64_tr_b16 a[180:181], v237 offset:8192
  ds_read_b64_tr_b16 a[182:183], v237 offset:9216
  v_exp_f32 v208, v102
  v_mfma_f32_16x16x32_bf16 a[244:247], a[188:191], v[128:131], a[244:247]
  s_waitcnt lgkmcnt(8)
  v_mfma_f32_16x16x32_bf16 a[192:195], a[160:163], v[136:139], a[192:195]
  ds_read_b64_tr_b16 a[184:185], v238 offset:8192
  ds_read_b64_tr_b16 a[186:187], v238 offset:9216
  v_add_f32 v214, v214, v212
  v_cvt_pk_bf16_f32 v146, v212, v213
  v_exp_f32 v209, v103
  v_mfma_f32_16x16x32_bf16 a[200:203], a[160:163], v[140:143], a[200:203]
  v_mfma_f32_16x16x32_bf16 a[204:207], a[164:167], v[140:143], a[204:207]
  ds_read_b64_tr_b16 a[188:189], v239 offset:8192
  ds_read_b64_tr_b16 a[190:191], v239 offset:9216
  v_add_f32 v214, v214, v213
  v_mfma_f32_16x16x32_bf16 a[196:199], a[164:167], v[136:139], a[196:199]
  s_waitcnt lgkmcnt(8)
  v_mfma_f32_16x16x32_bf16 a[208:211], a[168:171], v[136:139], a[208:211]
  s_barrier
  ds_read_b128 a[160:163], v224 offset:32768
  v_exp_f32 v210, v104
  v_add_f32 v214, v214, v208
  v_mfma_f32_16x16x32_bf16 a[216:219], a[168:171], v[140:143], a[216:219]
  v_mfma_f32_16x16x32_bf16 a[220:223], a[172:175], v[140:143], a[220:223]
  ds_read_b128 a[164:167], v224 offset:36864
  s_add_u32 m0, s41, 114688
  s_nop 0
  buffer_load_dwordx4 v248, s[12:15], s33 offen offset:0 nt lds
  v_cvt_pk_bf16_f32 v147, v208, v209
  v_mfma_f32_16x16x32_bf16 a[212:215], a[172:175], v[136:139], a[212:215]
  s_waitcnt lgkmcnt(6)
  v_mfma_f32_16x16x32_bf16 a[224:227], a[176:179], v[136:139], a[224:227]
  ds_read_b128 a[168:171], v225 offset:32768
  v_exp_f32 v211, v105
  v_add_f32 v214, v214, v209
  v_mfma_f32_16x16x32_bf16 a[232:235], a[176:179], v[140:143], a[232:235]
  v_mfma_f32_16x16x32_bf16 a[236:239], a[180:183], v[140:143], a[236:239]
  ds_read_b128 a[172:175], v225 offset:36864
  v_exp_f32 v212, v106
  v_cvt_pk_bf16_f32 v148, v210, v211
  v_mfma_f32_16x16x32_bf16 a[228:231], a[180:183], v[136:139], a[228:231]
  s_waitcnt lgkmcnt(4)
  v_mfma_f32_16x16x32_bf16 a[240:243], a[184:187], v[136:139], a[240:243]
  ds_read_b128 a[176:179], v226 offset:32768
  buffer_load_dwordx4 v248, s[12:15], s33 offen offset:1024 nt lds
  v_mfma_f32_16x16x32_bf16 a[248:251], a[184:187], v[140:143], a[248:251]
  v_mfma_f32_16x16x32_bf16 a[252:255], a[188:191], v[140:143], a[252:255]
  ds_read_b128 a[180:183], v226 offset:36864
  v_exp_f32 v213, v107
  v_add_f32 v215, v210, v211
  v_exp_f32 v208, v108
  v_mfma_f32_16x16x32_bf16 a[244:247], a[188:191], v[136:139], a[244:247]
  s_waitcnt lgkmcnt(4)
  v_mfma_f32_16x16x32_bf16 v[64:67], a[160:163], v[160:163], v[192:195]
  ds_read_b128 a[184:187], v227 offset:32768
  v_add_f32 v215, v215, v212
  v_cvt_pk_bf16_f32 v149, v212, v213
  v_exp_f32 v209, v109
  v_mfma_f32_16x16x32_bf16 v[72:75], a[160:163], v[164:167], v[196:199]
  v_mfma_f32_16x16x32_bf16 v[76:79], a[164:167], v[164:167], v[196:199]
  ds_read_b128 a[188:191], v227 offset:36864
  buffer_load_dwordx4 v248, s[12:15], s33 offen offset:2048 nt lds
  v_mfma_f32_16x16x32_bf16 v[68:71], a[164:167], v[160:163], v[192:195]
  s_waitcnt lgkmcnt(4)
  v_mfma_f32_16x16x32_bf16 v[64:67], a[168:171], v[168:171], v[64:67]
  ds_read_b128 a[160:163], v224 offset:34816
  v_add_f32 v215, v215, v213
  v_exp_f32 v210, v110
  v_mfma_f32_16x16x32_bf16 v[72:75], a[168:171], v[172:175], v[72:75]
  v_mfma_f32_16x16x32_bf16 v[76:79], a[172:175], v[172:175], v[76:79]
  ds_read_b128 a[164:167], v224 offset:38912
  v_add_f32 v215, v215, v208
  v_cvt_pk_bf16_f32 v150, v208, v209
  v_exp_f32 v211, v111
  v_mfma_f32_16x16x32_bf16 v[68:71], a[172:175], v[168:171], v[68:71]
  s_waitcnt lgkmcnt(4)
  v_mfma_f32_16x16x32_bf16 v[64:67], a[176:179], v[176:179], v[64:67]
  ds_read_b128 a[168:171], v225 offset:34816
  buffer_load_dwordx4 v248, s[12:15], s33 offen offset:3072 nt lds
  s_add_u32 s33, s33, 0x4000
  v_mfma_f32_16x16x32_bf16 v[72:75], a[176:179], v[180:183], v[72:75]
  v_mfma_f32_16x16x32_bf16 v[76:79], a[180:183], v[180:183], v[76:79]
  ds_read_b128 a[172:175], v225 offset:38912
  v_add_f32 v215, v215, v209
  v_exp_f32 v212, v112
  v_mfma_f32_16x16x32_bf16 v[68:71], a[180:183], v[176:179], v[68:71]
  s_waitcnt lgkmcnt(4)
  v_mfma_f32_16x16x32_bf16 v[64:67], a[184:187], v[184:187], v[64:67]
  ds_read_b128 a[176:179], v226 offset:34816
  v_add_f32 v215, v215, v210
  v_cvt_pk_bf16_f32 v151, v210, v211
  v_exp_f32 v213, v113
  v_mfma_f32_16x16x32_bf16 v[72:75], a[184:187], v[188:191], v[72:75]
  v_mfma_f32_16x16x32_bf16 v[76:79], a[188:191], v[188:191], v[76:79]
  ds_read_b128 a[180:183], v226 offset:38912
  v_add_f32 v215, v215, v211
  v_exp_f32 v208, v114
  v_add_f32 v214, v214, v212
  v_mfma_f32_16x16x32_bf16 v[68:71], a[188:191], v[184:187], v[68:71]
  s_waitcnt lgkmcnt(4)
  v_mfma_f32_16x16x32_bf16 v[80:83], a[160:163], v[160:163], v[192:195]
  ds_read_b128 a[184:187], v227 offset:34816
  v_cvt_pk_bf16_f32 v152, v212, v213
  v_exp_f32 v209, v115
  v_mfma_f32_16x16x32_bf16 v[88:91], a[160:163], v[164:167], v[196:199]
  v_mfma_f32_16x16x32_bf16 v[92:95], a[164:167], v[164:167], v[196:199]
  ds_read_b128 a[188:191], v227 offset:38912
  v_add_f32 v214, v214, v213
  v_exp_f32 v210, v116
  v_add_f32 v214, v214, v208
  v_mfma_f32_16x16x32_bf16 v[84:87], a[164:167], v[160:163], v[192:195]
  s_waitcnt lgkmcnt(4)
  v_mfma_f32_16x16x32_bf16 v[80:83], a[168:171], v[168:171], v[80:83]
  s_waitcnt vmcnt(16)
  s_barrier
  ds_read_b64_tr_b16 a[160:161], v200 offset:0
  ds_read_b64_tr_b16 a[162:163], v200 offset:1024
  v_cvt_pk_bf16_f32 v153, v208, v209
  v_mfma_f32_16x16x32_bf16 v[88:91], a[168:171], v[172:175], v[88:91]
  v_mfma_f32_16x16x32_bf16 v[92:95], a[172:175], v[172:175], v[92:95]
  ds_read_b64_tr_b16 a[164:165], v201 offset:0
  ds_read_b64_tr_b16 a[166:167], v201 offset:1024
  s_add_u32 s34, s77, 409600
  s_add_u32 m0, s41, 65536
  s_nop 0
  buffer_load_dwordx4 v244, s[64:67], s34 offen offset:0 lds
  v_mfma_f32_16x16x32_bf16 v[84:87], a[172:175], v[168:171], v[84:87]
  s_waitcnt lgkmcnt(6)
  v_mfma_f32_16x16x32_bf16 v[80:83], a[176:179], v[176:179], v[80:83]
  ds_read_b64_tr_b16 a[168:169], v202 offset:0
  ds_read_b64_tr_b16 a[170:171], v202 offset:1024
  v_exp_f32 v211, v117
  v_mfma_f32_16x16x32_bf16 v[88:91], a[176:179], v[180:183], v[88:91]
  v_mfma_f32_16x16x32_bf16 v[92:95], a[180:183], v[180:183], v[92:95]
  ds_read_b64_tr_b16 a[172:173], v203 offset:0
  ds_read_b64_tr_b16 a[174:175], v203 offset:1024
  v_add_f32 v214, v214, v209
  v_exp_f32 v212, v118
  v_mfma_f32_16x16x32_bf16 v[84:87], a[180:183], v[176:179], v[84:87]
  s_waitcnt lgkmcnt(8)
  v_mfma_f32_16x16x32_bf16 v[80:83], a[184:187], v[184:187], v[80:83]
  ds_read_b64_tr_b16 a[176:177], v204 offset:0
  ds_read_b64_tr_b16 a[178:179], v204 offset:1024
  buffer_load_dwordx4 v245, s[64:67], s34 offen offset:1024 lds
  v_mfma_f32_16x16x32_bf16 v[88:91], a[184:187], v[188:191], v[88:91]
  v_mfma_f32_16x16x32_bf16 v[92:95], a[188:191], v[188:191], v[92:95]
  ds_read_b64_tr_b16 a[180:181], v205 offset:0
  ds_read_b64_tr_b16 a[182:183], v205 offset:1024
  v_add_f32 v214, v214, v210
  v_cvt_pk_bf16_f32 v154, v210, v211
  v_mfma_f32_16x16x32_bf16 v[84:87], a[188:191], v[184:187], v[84:87]
  s_waitcnt lgkmcnt(8)
  v_mfma_f32_16x16x32_bf16 a[64:67], a[160:163], a[0:3], a[64:67]
  ds_read_b64_tr_b16 a[184:185], v206 offset:0
  ds_read_b64_tr_b16 a[186:187], v206 offset:1024
  v_exp_f32 v213, v119
  v_add_f32 v214, v214, v211
  v_mfma_f32_16x16x32_bf16 a[72:75], a[160:163], a[4:7], a[72:75]
  v_mfma_f32_16x16x32_bf16 a[76:79], a[164:167], a[4:7], a[76:79]
  ds_read_b64_tr_b16 a[188:189], v207 offset:0
  ds_read_b64_tr_b16 a[190:191], v207 offset:1024
  buffer_load_dwordx4 v246, s[64:67], s34 offen offset:2048 lds
  v_mfma_f32_16x16x32_bf16 a[68:71], a[164:167], a[0:3], a[68:71]
  s_waitcnt lgkmcnt(8)
  v_mfma_f32_16x16x32_bf16 a[80:83], a[168:171], a[0:3], a[80:83]
  ds_read_b64_tr_b16 a[160:161], v200 offset:8192
  ds_read_b64_tr_b16 a[162:163], v200 offset:9216
  v_exp_f32 v208, v120
  v_add_f32 v214, v214, v212
  v_mfma_f32_16x16x32_bf16 a[88:91], a[168:171], a[4:7], a[88:91]
  v_mfma_f32_16x16x32_bf16 a[92:95], a[172:175], a[4:7], a[92:95]
  ds_read_b64_tr_b16 a[164:165], v201 offset:8192
  ds_read_b64_tr_b16 a[166:167], v201 offset:9216
  v_cvt_pk_bf16_f32 v155, v212, v213
  v_exp_f32 v209, v121
  v_mfma_f32_16x16x32_bf16 a[84:87], a[172:175], a[0:3], a[84:87]
  s_waitcnt lgkmcnt(8)
  v_mfma_f32_16x16x32_bf16 a[96:99], a[176:179], a[0:3], a[96:99]
  ds_read_b64_tr_b16 a[168:169], v202 offset:8192
  ds_read_b64_tr_b16 a[170:171], v202 offset:9216
  buffer_load_dwordx4 v247, s[64:67], s34 offen offset:3072 lds
  v_mfma_f32_16x16x32_bf16 a[104:107], a[176:179], a[4:7], a[104:107]
  v_mfma_f32_16x16x32_bf16 a[108:111], a[180:183], a[4:7], a[108:111]
  ds_read_b64_tr_b16 a[172:173], v203 offset:8192
  ds_read_b64_tr_b16 a[174:175], v203 offset:9216
  v_add_f32 v214, v214, v213
  v_exp_f32 v210, v122
  v_mfma_f32_16x16x32_bf16 a[100:103], a[180:183], a[0:3], a[100:103]
  s_waitcnt lgkmcnt(8)
  v_mfma_f32_16x16x32_bf16 a[112:115], a[184:187], a[0:3], a[112:115]
  ds_read_b64_tr_b16 a[176:177], v204 offset:8192
  ds_read_b64_tr_b16 a[178:179], v204 offset:9216
  v_add_f32 v215, v215, v208
  v_cvt_pk_bf16_f32 v156, v208, v209
  v_mfma_f32_16x16x32_bf16 a[120:123], a[184:187], a[4:7], a[120:123]
  v_mfma_f32_16x16x32_bf16 a[124:127], a[188:191], a[4:7], a[124:127]
  ds_read_b64_tr_b16 a[180:181], v205 offset:8192
  ds_read_b64_tr_b16 a[182:183], v205 offset:9216
  v_exp_f32 v211, v123
  v_add_f32 v215, v215, v209
  v_mfma_f32_16x16x32_bf16 a[116:119], a[188:191], a[0:3], a[116:119]
  s_waitcnt lgkmcnt(8)
  v_mfma_f32_16x16x32_bf16 a[64:67], a[160:163], a[8:11], a[64:67]
  ds_read_b64_tr_b16 a[184:185], v206 offset:8192
  ds_read_b64_tr_b16 a[186:187], v206 offset:9216
  v_exp_f32 v212, v124
  v_add_f32 v215, v215, v210
  v_mfma_f32_16x16x32_bf16 a[72:75], a[160:163], a[12:15], a[72:75]
  v_mfma_f32_16x16x32_bf16 a[76:79], a[164:167], a[12:15], a[76:79]
  ds_read_b64_tr_b16 a[188:189], v207 offset:8192
  ds_read_b64_tr_b16 a[190:191], v207 offset:9216
  v_cvt_pk_bf16_f32 v157, v210, v211
  v_exp_f32 v213, v125
  v_mfma_f32_16x16x32_bf16 a[68:71], a[164:167], a[8:11], a[68:71]
  s_waitcnt lgkmcnt(8)
  v_mfma_f32_16x16x32_bf16 a[80:83], a[168:171], a[8:11], a[80:83]
  s_waitcnt vmcnt(16)
  s_barrier
  ds_read_b64_tr_b16 a[160:161], v200 offset:16384
  ds_read_b64_tr_b16 a[162:163], v200 offset:17408
  v_mfma_f32_16x16x32_bf16 a[88:91], a[168:171], a[12:15], a[88:91]
  v_mfma_f32_16x16x32_bf16 a[92:95], a[172:175], a[12:15], a[92:95]
  ds_read_b64_tr_b16 a[164:165], v201 offset:16384
  ds_read_b64_tr_b16 a[166:167], v201 offset:17408
  v_add_f32 v215, v215, v211
  v_exp_f32 v208, v126
  v_mfma_f32_16x16x32_bf16 a[84:87], a[172:175], a[8:11], a[84:87]
  s_waitcnt lgkmcnt(8)
  v_mfma_f32_16x16x32_bf16 a[96:99], a[176:179], a[8:11], a[96:99]
  ds_read_b64_tr_b16 a[168:169], v202 offset:16384
  ds_read_b64_tr_b16 a[170:171], v202 offset:17408
  v_add_f32 v215, v215, v212
  v_cvt_pk_bf16_f32 v158, v212, v213
  v_mfma_f32_16x16x32_bf16 a[104:107], a[176:179], a[12:15], a[104:107]
  v_mfma_f32_16x16x32_bf16 a[108:111], a[180:183], a[12:15], a[108:111]
  ds_read_b64_tr_b16 a[172:173], v203 offset:16384
  ds_read_b64_tr_b16 a[174:175], v203 offset:17408
  v_exp_f32 v209, v127
  v_mfma_f32_16x16x32_bf16 a[100:103], a[180:183], a[8:11], a[100:103]
  s_waitcnt lgkmcnt(8)
  v_mfma_f32_16x16x32_bf16 a[112:115], a[184:187], a[8:11], a[112:115]
  ds_read_b64_tr_b16 a[176:177], v204 offset:16384
  ds_read_b64_tr_b16 a[178:179], v204 offset:17408
  v_add_f32 v215, v215, v213
  v_add_f32 v215, v215, v208
  v_cvt_pk_bf16_f32 v159, v208, v209
  v_mfma_f32_16x16x32_bf16 a[120:123], a[184:187], a[12:15], a[120:123]
  v_mfma_f32_16x16x32_bf16 a[124:127], a[188:191], a[12:15], a[124:127]
  ds_read_b64_tr_b16 a[180:181], v205 offset:16384
  ds_read_b64_tr_b16 a[182:183], v205 offset:17408
  v_add_f32 v215, v215, v209
  v_add_f32 v210, v214, v215
  v_cmp_lt_f32 vcc, s35, v210
  v_mfma_f32_16x16x32_bf16 a[116:119], a[188:191], a[8:11], a[116:119]
  s_cbranch_vccnz SITE109
BACK109:
  s_waitcnt lgkmcnt(8)
  v_mfma_f32_16x16x32_bf16 a[192:195], a[160:163], v[144:147], a[192:195]
  ds_read_b64_tr_b16 a[184:185], v206 offset:16384
  ds_read_b64_tr_b16 a[186:187], v206 offset:17408
  v_add_f32 v249, v249, v214
  v_add_f32 v254, v254, v215
  v_exp_f32 v208, v64
  v_mfma_f32_16x16x32_bf16 a[200:203], a[160:163], v[148:151], a[200:203]
  v_mfma_f32_16x16x32_bf16 a[204:207], a[164:167], v[148:151], a[204:207]
  ds_read_b64_tr_b16 a[188:189], v207 offset:16384
  ds_read_b64_tr_b16 a[190:191], v207 offset:17408
  v_exp_f32 v209, v65
  v_mfma_f32_16x16x32_bf16 a[196:199], a[164:167], v[144:147], a[196:199]
  s_waitcnt lgkmcnt(8)
  v_mfma_f32_16x16x32_bf16 a[208:211], a[168:171], v[144:147], a[208:211]
  ds_read_b64_tr_b16 a[160:161], v200 offset:24576
  ds_read_b64_tr_b16 a[162:163], v200 offset:25600
  v_exp_f32 v210, v66
  v_cvt_pk_bf16_f32 v128, v208, v209
  v_mfma_f32_16x16x32_bf16 a[216:219], a[168:171], v[148:151], a[216:219]
  v_mfma_f32_16x16x32_bf16 a[220:223], a[172:175], v[148:151], a[220:223]
  ds_read_b64_tr_b16 a[164:165], v201 offset:24576
  ds_read_b64_tr_b16 a[166:167], v201 offset:25600
  v_exp_f32 v211, v67
  v_add_f32 v214, v208, v209
  v_mfma_f32_16x16x32_bf16 a[212:215], a[172:175], v[144:147], a[212:215]
  s_waitcnt lgkmcnt(8)
  v_mfma_f32_16x16x32_bf16 a[224:227], a[176:179], v[144:147], a[224:227]
  ds_read_b64_tr_b16 a[168:169], v202 offset:24576
  ds_read_b64_tr_b16 a[170:171], v202 offset:25600
  v_exp_f32 v212, v68
  v_add_f32 v214, v214, v210
  v_mfma_f32_16x16x32_bf16 a[232:235], a[176:179], v[148:151], a[232:235]
  v_mfma_f32_16x16x32_bf16 a[236:239], a[180:183], v[148:151], a[236:239]
  ds_read_b64_tr_b16 a[172:173], v203 offset:24576
  ds_read_b64_tr_b16 a[174:175], v203 offset:25600
  v_cvt_pk_bf16_f32 v129, v210, v211
  v_exp_f32 v213, v69
  v_mfma_f32_16x16x32_bf16 a[228:231], a[180:183], v[144:147], a[228:231]
  s_waitcnt lgkmcnt(8)
  v_mfma_f32_16x16x32_bf16 a[240:243], a[184:187], v[144:147], a[240:243]
  ds_read_b64_tr_b16 a[176:177], v204 offset:24576
  ds_read_b64_tr_b16 a[178:179], v204 offset:25600
  v_add_f32 v214, v214, v211
  v_exp_f32 v208, v70
  v_mfma_f32_16x16x32_bf16 a[248:251], a[184:187], v[148:151], a[248:251]
  v_mfma_f32_16x16x32_bf16 a[252:255], a[188:191], v[148:151], a[252:255]
  ds_read_b64_tr_b16 a[180:181], v205 offset:24576
  ds_read_b64_tr_b16 a[182:183], v205 offset:25600
  v_add_f32 v214, v214, v212
  v_cvt_pk_bf16_f32 v130, v212, v213
  v_mfma_f32_16x16x32_bf16 a[244:247], a[188:191], v[144:147], a[244:247]
  s_waitcnt lgkmcnt(8)
  v_mfma_f32_16x16x32_bf16 a[192:195], a[160:163], v[152:155], a[192:195]
  ds_read_b64_tr_b16 a[184:185], v206 offset:24576
  ds_read_b64_tr_b16 a[186:187], v206 offset:25600
  v_exp_f32 v209, v71
  v_add_f32 v214, v214, v213
  v_mfma_f32_16x16x32_bf16 a[200:203], a[160:163], v[156:159], a[200:203]
  v_mfma_f32_16x16x32_bf16 a[204:207], a[164:167], v[156:159], a[204:207]
  ds_read_b64_tr_b16 a[188:189], v207 offset:24576
  ds_read_b64_tr_b16 a[190:191], v207 offset:25600
  v_exp_f32 v210, v72
  v_add_f32 v214, v214, v208
  v_mfma_f32_16x16x32_bf16 a[196:199], a[164:167], v[152:155], a[196:199]
  s_waitcnt lgkmcnt(8)
  v_mfma_f32_16x16x32_bf16 a[208:211], a[168:171], v[152:155], a[208:211]
  s_barrier
  ds_read_b128 a[160:163], v224 offset:49152
  v_cvt_pk_bf16_f32 v131, v208, v209
  v_exp_f32 v211, v73
  v_mfma_f32_16x16x32_bf16 a[216:219], a[168:171], v[156:159], a[216:219]
  v_mfma_f32_16x16x32_bf16 a[220:223], a[172:175], v[156:159], a[220:223]
  ds_read_b128 a[164:167], v224 offset:53248
  s_add_u32 m0, s41, 131072
  s_nop 0
  buffer_load_dwordx4 v248, s[12:15], s33 offen offset:0 nt lds
  v_mfma_f32_16x16x32_bf16 a[212:215], a[172:175], v[152:155], a[212:215]
  s_waitcnt lgkmcnt(6)
  v_mfma_f32_16x16x32_bf16 a[224:227], a[176:179], v[152:155], a[224:227]
  ds_read_b128 a[168:171], v225 offset:49152
  v_add_f32 v214, v214, v209
  v_exp_f32 v212, v74
  v_cvt_pk_bf16_f32 v132, v210, v211
  v_mfma_f32_16x16x32_bf16 a[232:235], a[176:179], v[156:159], a[232:235]
  v_mfma_f32_16x16x32_bf16 a[236:239], a[180:183], v[156:159], a[236:239]
  ds_read_b128 a[172:175], v225 offset:53248
  v_exp_f32 v213, v75
  v_add_f32 v215, v210, v211
  v_mfma_f32_16x16x32_bf16 a[228:231], a[180:183], v[152:155], a[228:231]
  s_waitcnt lgkmcnt(4)
  v_mfma_f32_16x16x32_bf16 a[240:243], a[184:187], v[152:155], a[240:243]
  ds_read_b128 a[176:179], v226 offset:49152
  buffer_load_dwordx4 v248, s[12:15], s33 offen offset:1024 nt lds
  v_mfma_f32_16x16x32_bf16 a[248:251], a[184:187], v[156:159], a[248:251]
  v_mfma_f32_16x16x32_bf16 a[252:255], a[188:191], v[156:159], a[252:255]
  ds_read_b128 a[180:183], v226 offset:53248
  v_exp_f32 v208, v76
  v_add_f32 v215, v215, v212
  v_cvt_pk_bf16_f32 v133, v212, v213
  v_mfma_f32_16x16x32_bf16 a[244:247], a[188:191], v[152:155], a[244:247]
  s_waitcnt lgkmcnt(4)
  v_mfma_f32_16x16x32_bf16 v[96:99], a[160:163], v[160:163], v[192:195]
  ds_read_b128 a[184:187], v227 offset:49152
  v_exp_f32 v209, v77
  v_add_f32 v215, v215, v213
  v_exp_f32 v210, v78
  v_mfma_f32_16x16x32_bf16 v[104:107], a[160:163], v[164:167], v[196:199]
  v_mfma_f32_16x16x32_bf16 v[108:111], a[164:167], v[164:167], v[196:199]
  ds_read_b128 a[188:191], v227 offset:53248
  buffer_load_dwordx4 v248, s[12:15], s33 offen offset:2048 nt lds
  v_mfma_f32_16x16x32_bf16 v[100:103], a[164:167], v[160:163], v[192:195]
  s_waitcnt lgkmcnt(4)
  v_mfma_f32_16x16x32_bf16 v[96:99], a[168:171], v[168:171], v[96:99]
  ds_read_b128 a[160:163], v224 offset:51200
  v_add_f32 v215, v215, v208
  v_cvt_pk_bf16_f32 v134, v208, v209
  v_exp_f32 v211, v79
  v_mfma_f32_16x16x32_bf16 v[104:107], a[168:171], v[172:175], v[104:107]
  v_mfma_f32_16x16x32_bf16 v[108:111], a[172:175], v[172:175], v[108:111]
  ds_read_b128 a[164:167], v224 offset:55296
  v_add_f32 v215, v215, v209
  v_exp_f32 v212, v80
  v_mfma_f32_16x16x32_bf16 v[100:103], a[172:175], v[168:171], v[100:103]
  s_waitcnt lgkmcnt(4)
  v_mfma_f32_16x16x32_bf16 v[96:99], a[176:179], v[176:179], v[96:99]
  ds_read_b128 a[168:171], v225 offset:51200
  buffer_load_dwordx4 v248, s[12:15], s33 offen offset:3072 nt lds
  s_add_u32 s33, s33, 0x4000
  v_add_f32 v215, v215, v210
  v_mfma_f32_16x16x32_bf16 v[104:107], a[176:179], v[180:183], v[104:107]
  v_mfma_f32_16x16x32_bf16 v[108:111], a[180:183], v[180:183], v[108:111]
  ds_read_b128 a[172:175], v225 offset:55296
  v_cvt_pk_bf16_f32 v135, v210, v211
  v_exp_f32 v213, v81
  v_add_f32 v215, v215, v211
  v_mfma_f32_16x16x32_bf16 v[100:103], a[180:183], v[176:179], v[100:103]
  s_waitcnt lgkmcnt(4)
  v_mfma_f32_16x16x32_bf16 v[96:99], a[184:187], v[184:187], v[96:99]
  ds_read_b128 a[176:179], v226 offset:51200
  v_exp_f32 v208, v82
  v_add_f32 v214, v214, v212
  v_mfma_f32_16x16x32_bf16 v[104:107], a[184:187], v[188:191], v[104:107]
  v_mfma_f32_16x16x32_bf16 v[108:111], a[188:191], v[188:191], v[108:111]
  ds_read_b128 a[180:183], v226 offset:55296
  v_cvt_pk_bf16_f32 v136, v212, v213
  v_exp_f32 v209, v83
  v_add_f32 v214, v214, v213
  v_mfma_f32_16x16x32_bf16 v[100:103], a[188:191], v[184:187], v[100:103]
  s_waitcnt lgkmcnt(4)
  v_mfma_f32_16x16x32_bf16 v[112:115], a[160:163], v[160:163], v[192:195]
  ds_read_b128 a[184:187], v227 offset:51200
  v_exp_f32 v210, v84
  v_add_f32 v214, v214, v208
  v_cvt_pk_bf16_f32 v137, v208, v209
  v_mfma_f32_16x16x32_bf16 v[120:123], a[160:163], v[164:167], v[196:199]
  v_mfma_f32_16x16x32_bf16 v[124:127], a[164:167], v[164:167], v[196:199]
  ds_read_b128 a[188:191], v227 offset:55296
  v_exp_f32 v211, v85
  v_add_f32 v214, v214, v209
  v_mfma_f32_16x16x32_bf16 v[116:119], a[164:167], v[160:163], v[192:195]
  s_waitcnt lgkmcnt(4)
  v_mfma_f32_16x16x32_bf16 v[112:115], a[168:171], v[168:171], v[112:115]
  s_waitcnt vmcnt(16)
  s_barrier
  ds_read_b64_tr_b16 a[160:161], v232 offset:16384
  ds_read_b64_tr_b16 a[162:163], v232 offset:17408
  v_exp_f32 v212, v86
  v_mfma_f32_16x16x32_bf16 v[120:123], a[168:171], v[172:175], v[120:123]
  v_mfma_f32_16x16x32_bf16 v[124:127], a[172:175], v[172:175], v[124:127]
  ds_read_b64_tr_b16 a[164:165], v233 offset:16384
  ds_read_b64_tr_b16 a[166:167], v233 offset:17408
  s_add_u32 s34, s78, 0
  s_add_u32 m0, s41, 147456
  s_nop 0
  buffer_load_dwordx4 v244, s[64:67], s34 offen offset:0 lds
  v_mfma_f32_16x16x32_bf16 v[116:119], a[172:175], v[168:171], v[116:119]
  s_waitcnt lgkmcnt(6)
  v_mfma_f32_16x16x32_bf16 v[112:115], a[176:179], v[176:179], v[112:115]
  ds_read_b64_tr_b16 a[168:169], v234 offset:16384
  ds_read_b64_tr_b16 a[170:171], v234 offset:17408
  v_add_f32 v214, v214, v210
  v_cvt_pk_bf16_f32 v138, v210, v211
  v_mfma_f32_16x16x32_bf16 v[120:123], a[176:179], v[180:183], v[120:123]
  v_mfma_f32_16x16x32_bf16 v[124:127], a[180:183], v[180:183], v[124:127]
  ds_read_b64_tr_b16 a[172:173], v235 offset:16384
  ds_read_b64_tr_b16 a[174:175], v235 offset:17408
  v_exp_f32 v213, v87
  v_add_f32 v214, v214, v211
  v_mfma_f32_16x16x32_bf16 v[116:119], a[180:183], v[176:179], v[116:119]
  s_waitcnt lgkmcnt(8)
  v_mfma_f32_16x16x32_bf16 v[112:115], a[184:187], v[184:187], v[112:115]
  ds_read_b64_tr_b16 a[176:177], v236 offset:16384
  ds_read_b64_tr_b16 a[178:179], v236 offset:17408
  buffer_load_dwordx4 v245, s[64:67], s34 offen offset:1024 lds
  v_exp_f32 v208, v88
  v_mfma_f32_16x16x32_bf16 v[120:123], a[184:187], v[188:191], v[120:123]
  v_mfma_f32_16x16x32_bf16 v[124:127], a[188:191], v[188:191], v[124:127]
  ds_read_b64_tr_b16 a[180:181], v237 offset:16384
  ds_read_b64_tr_b16 a[182:183], v237 offset:17408
  v_add_f32 v214, v214, v212
  v_cvt_pk_bf16_f32 v139, v212, v213
  v_mfma_f32_16x16x32_bf16 v[116:119], a[188:191], v[184:187], v[116:119]
  s_waitcnt lgkmcnt(8)
  v_mfma_f32_16x16x32_bf16 a[64:67], a[160:163], a[16:19], a[64:67]
  ds_read_b64_tr_b16 a[184:185], v238 offset:16384
  ds_read_b64_tr_b16 a[186:187], v238 offset:17408
  v_exp_f32 v209, v89
  v_add_f32 v214, v214, v213
  v_mfma_f32_16x16x32_bf16 a[72:75], a[160:163], a[20:23], a[72:75]
  v_mfma_f32_16x16x32_bf16 a[76:79], a[164:167], a[20:23], a[76:79]
  ds_read_b64_tr_b16 a[188:189], v239 offset:16384
  ds_read_b64_tr_b16 a[190:191], v239 offset:17408
  buffer_load_dwordx4 v246, s[64:67], s34 offen offset:2048 lds
  v_mfma_f32_16x16x32_bf16 a[68:71], a[164:167], a[16:19], a[68:71]
  s_waitcnt lgkmcnt(8)
  v_mfma_f32_16x16x32_bf16 a[80:83], a[168:171], a[16:19], a[80:83]
  ds_read_b64_tr_b16 a[160:161], v232 offset:24576
  ds_read_b64_tr_b16 a[162:163], v232 offset:25600
  v_exp_f32 v210, v90
  v_add_f32 v215, v215, v208
  v_mfma_f32_16x16x32_bf16 a[88:91], a[168:171], a[20:23], a[88:91]
  v_mfma_f32_16x16x32_bf16 a[92:95], a[172:175], a[20:23], a[92:95]
  ds_read_b64_tr_b16 a[164:165], v233 offset:24576
  ds_read_b64_tr_b16 a[166:167], v233 offset:25600
  v_cvt_pk_bf16_f32 v140, v208, v209
  v_exp_f32 v211, v91
  v_mfma_f32_16x16x32_bf16 a[84:87], a[172:175], a[16:19], a[84:87]
  s_waitcnt lgkmcnt(8)
  v_mfma_f32_16x16x32_bf16 a[96:99], a[176:179], a[16:19], a[96:99]
  ds_read_b64_tr_b16 a[168:169], v234 offset:24576
  ds_read_b64_tr_b16 a[170:171], v234 offset:25600
  buffer_load_dwordx4 v247, s[64:67], s34 offen offset:3072 lds
  v_mfma_f32_16x16x32_bf16 a[104:107], a[176:179], a[20:23], a[104:107]
  v_mfma_f32_16x16x32_bf16 a[108:111], a[180:183], a[20:23], a[108:111]
  ds_read_b64_tr_b16 a[172:173], v235 offset:24576
  ds_read_b64_tr_b16 a[174:175], v235 offset:25600
  v_add_f32 v215, v215, v209
  v_exp_f32 v212, v92
  v_mfma_f32_16x16x32_bf16 a[100:103], a[180:183], a[16:19], a[100:103]
  s_waitcnt lgkmcnt(8)
  v_mfma_f32_16x16x32_bf16 a[112:115], a[184:187], a[16:19], a[112:115]
  ds_read_b64_tr_b16 a[176:177], v236 offset:24576
  ds_read_b64_tr_b16 a[178:179], v236 offset:25600
  v_add_f32 v215, v215, v210
  v_cvt_pk_bf16_f32 v141, v210, v211
  v_mfma_f32_16x16x32_bf16 a[120:123], a[184:187], a[20:23], a[120:123]
  v_mfma_f32_16x16x32_bf16 a[124:127], a[188:191], a[20:23], a[124:127]
  ds_read_b64_tr_b16 a[180:181], v237 offset:24576
  ds_read_b64_tr_b16 a[182:183], v237 offset:25600
  v_exp_f32 v213, v93
  v_add_f32 v215, v215, v211
  v_mfma_f32_16x16x32_bf16 a[116:119], a[188:191], a[16:19], a[116:119]
  s_waitcnt lgkmcnt(8)
  v_mfma_f32_16x16x32_bf16 a[64:67], a[160:163], a[24:27], a[64:67]
  ds_read_b64_tr_b16 a[184:185], v238 offset:24576
  ds_read_b64_tr_b16 a[186:187], v238 offset:25600
  v_exp_f32 v208, v94
  v_add_f32 v215, v215, v212
  v_mfma_f32_16x16x32_bf16 a[72:75], a[160:163], a[28:31], a[72:75]
  v_mfma_f32_16x16x32_bf16 a[76:79], a[164:167], a[28:31], a[76:79]
  ds_read_b64_tr_b16 a[188:189], v239 offset:24576
  ds_read_b64_tr_b16 a[190:191], v239 offset:25600
  v_cvt_pk_bf16_f32 v142, v212, v213
  v_exp_f32 v209, v95
  v_mfma_f32_16x16x32_bf16 a[68:71], a[164:167], a[24:27], a[68:71]
  s_waitcnt lgkmcnt(8)
  v_mfma_f32_16x16x32_bf16 a[80:83], a[168:171], a[24:27], a[80:83]
  s_waitcnt vmcnt(16)
  s_barrier
  ds_read_b64_tr_b16 a[160:161], v232 offset:32768
  ds_read_b64_tr_b16 a[162:163], v232 offset:33792
  v_add_f32 v215, v215, v213
  v_mfma_f32_16x16x32_bf16 a[88:91], a[168:171], a[28:31], a[88:91]
  v_mfma_f32_16x16x32_bf16 a[92:95], a[172:175], a[28:31], a[92:95]
  ds_read_b64_tr_b16 a[164:165], v233 offset:32768
  ds_read_b64_tr_b16 a[166:167], v233 offset:33792
  v_add_f32 v215, v215, v208
  v_cvt_pk_bf16_f32 v143, v208, v209
  v_add_f32 v215, v215, v209
  v_mfma_f32_16x16x32_bf16 a[84:87], a[172:175], a[24:27], a[84:87]
  s_waitcnt lgkmcnt(8)
  v_mfma_f32_16x16x32_bf16 a[96:99], a[176:179], a[24:27], a[96:99]
  ds_read_b64_tr_b16 a[168:169], v234 offset:32768
  ds_read_b64_tr_b16 a[170:171], v234 offset:33792
  v_add_f32 v210, v214, v215
  v_cmp_lt_f32 vcc, s35, v210
  v_mfma_f32_16x16x32_bf16 a[104:107], a[176:179], a[28:31], a[104:107]
  v_mfma_f32_16x16x32_bf16 a[108:111], a[180:183], a[28:31], a[108:111]
  ds_read_b64_tr_b16 a[172:173], v235 offset:32768
  ds_read_b64_tr_b16 a[174:175], v235 offset:33792
  v_mfma_f32_16x16x32_bf16 a[100:103], a[180:183], a[24:27], a[100:103]
  s_waitcnt lgkmcnt(8)
  v_mfma_f32_16x16x32_bf16 a[112:115], a[184:187], a[24:27], a[112:115]
  ds_read_b64_tr_b16 a[176:177], v236 offset:32768
  ds_read_b64_tr_b16 a[178:179], v236 offset:33792
  v_mfma_f32_16x16x32_bf16 a[120:123], a[184:187], a[28:31], a[120:123]
  v_mfma_f32_16x16x32_bf16 a[124:127], a[188:191], a[28:31], a[124:127]
  ds_read_b64_tr_b16 a[180:181], v237 offset:32768
  ds_read_b64_tr_b16 a[182:183], v237 offset:33792
  v_mfma_f32_16x16x32_bf16 a[116:119], a[188:191], a[24:27], a[116:119]
  s_waitcnt lgkmcnt(8)
  v_mfma_f32_16x16x32_bf16 a[64:67], a[160:163], a[128:131], a[64:67]
  ds_read_b64_tr_b16 a[184:185], v238 offset:32768
  ds_read_b64_tr_b16 a[186:187], v238 offset:33792
  v_mfma_f32_16x16x32_bf16 a[72:75], a[160:163], a[132:135], a[72:75]
  v_mfma_f32_16x16x32_bf16 a[76:79], a[164:167], a[132:135], a[76:79]
  ds_read_b64_tr_b16 a[188:189], v239 offset:32768
  ds_read_b64_tr_b16 a[190:191], v239 offset:33792
  v_mfma_f32_16x16x32_bf16 a[68:71], a[164:167], a[128:131], a[68:71]
  s_waitcnt lgkmcnt(8)
  v_mfma_f32_16x16x32_bf16 a[80:83], a[168:171], a[128:131], a[80:83]
  ds_read_b64_tr_b16 a[160:161], v232 offset:40960
  ds_read_b64_tr_b16 a[162:163], v232 offset:41984
  v_mfma_f32_16x16x32_bf16 a[88:91], a[168:171], a[132:135], a[88:91]
  v_mfma_f32_16x16x32_bf16 a[92:95], a[172:175], a[132:135], a[92:95]
  ds_read_b64_tr_b16 a[164:165], v233 offset:40960
  ds_read_b64_tr_b16 a[166:167], v233 offset:41984
  v_mfma_f32_16x16x32_bf16 a[84:87], a[172:175], a[128:131], a[84:87]
  s_waitcnt lgkmcnt(8)
  v_mfma_f32_16x16x32_bf16 a[96:99], a[176:179], a[128:131], a[96:99]
  ds_read_b64_tr_b16 a[168:169], v234 offset:40960
  ds_read_b64_tr_b16 a[170:171], v234 offset:41984
  v_mfma_f32_16x16x32_bf16 a[104:107], a[176:179], a[132:135], a[104:107]
  v_mfma_f32_16x16x32_bf16 a[108:111], a[180:183], a[132:135], a[108:111]
  ds_read_b64_tr_b16 a[172:173], v235 offset:40960
  ds_read_b64_tr_b16 a[174:175], v235 offset:41984
  v_mfma_f32_16x16x32_bf16 a[100:103], a[180:183], a[128:131], a[100:103]
  s_waitcnt lgkmcnt(8)
  v_mfma_f32_16x16x32_bf16 a[112:115], a[184:187], a[128:131], a[112:115]
  ds_read_b64_tr_b16 a[176:177], v236 offset:40960
  ds_read_b64_tr_b16 a[178:179], v236 offset:41984
  v_mfma_f32_16x16x32_bf16 a[120:123], a[184:187], a[132:135], a[120:123]
  v_mfma_f32_16x16x32_bf16 a[124:127], a[188:191], a[132:135], a[124:127]
  ds_read_b64_tr_b16 a[180:181], v237 offset:40960
  ds_read_b64_tr_b16 a[182:183], v237 offset:41984
  v_mfma_f32_16x16x32_bf16 a[116:119], a[188:191], a[128:131], a[116:119]
  s_waitcnt lgkmcnt(8)
  v_mfma_f32_16x16x32_bf16 a[64:67], a[160:163], a[136:139], a[64:67]
  ds_read_b64_tr_b16 a[184:185], v238 offset:40960
  ds_read_b64_tr_b16 a[186:187], v238 offset:41984
  v_mfma_f32_16x16x32_bf16 a[72:75], a[160:163], a[140:143], a[72:75]
  v_mfma_f32_16x16x32_bf16 a[76:79], a[164:167], a[140:143], a[76:79]
  ds_read_b64_tr_b16 a[188:189], v239 offset:40960
  ds_read_b64_tr_b16 a[190:191], v239 offset:41984
  v_mfma_f32_16x16x32_bf16 a[68:71], a[164:167], a[136:139], a[68:71]
  s_waitcnt lgkmcnt(8)
  v_mfma_f32_16x16x32_bf16 a[80:83], a[168:171], a[136:139], a[80:83]
  s_waitcnt vmcnt(12)
  s_barrier
  ds_read_b64_tr_b16 a[160:161], v232 offset:49152
  ds_read_b64_tr_b16 a[162:163], v232 offset:50176
  v_mfma_f32_16x16x32_bf16 a[88:91], a[168:171], a[140:143], a[88:91]
  v_mfma_f32_16x16x32_bf16 a[92:95], a[172:175], a[140:143], a[92:95]
  ds_read_b64_tr_b16 a[164:165], v233 offset:49152
  ds_read_b64_tr_b16 a[166:167], v233 offset:50176
  s_add_u32 s34, s76, 491520
  s_add_u32 m0, s41, 81920
  s_nop 0
  buffer_load_dwordx4 v244, s[64:67], s34 offen offset:0 lds
  v_mfma_f32_16x16x32_bf16 a[84:87], a[172:175], a[136:139], a[84:87]
  s_waitcnt lgkmcnt(8)
  v_mfma_f32_16x16x32_bf16 a[96:99], a[176:179], a[136:139], a[96:99]
  ds_read_b64_tr_b16 a[168:169], v234 offset:49152
  ds_read_b64_tr_b16 a[170:171], v234 offset:50176
  v_mfma_f32_16x16x32_bf16 a[104:107], a[176:179], a[140:143], a[104:107]
  v_mfma_f32_16x16x32_bf16 a[108:111], a[180:183], a[140:143], a[108:111]
  ds_read_b64_tr_b16 a[172:173], v235 offset:49152
  ds_read_b64_tr_b16 a[174:175], v235 offset:50176
  v_mfma_f32_16x16x32_bf16 a[100:103], a[180:183], a[136:139], a[100:103]
  s_waitcnt lgkmcnt(8)
  v_mfma_f32_16x16x32_bf16 a[112:115], a[184:187], a[136:139], a[112:115]
  ds_read_b64_tr_b16 a[176:177], v236 offset:49152
  ds_read_b64_tr_b16 a[178:179], v236 offset:50176
  buffer_load_dwordx4 v245, s[64:67], s34 offen offset:1024 lds
  v_mfma_f32_16x16x32_bf16 a[120:123], a[184:187], a[140:143], a[120:123]
  v_mfma_f32_16x16x32_bf16 a[124:127], a[188:191], a[140:143], a[124:127]
  ds_read_b64_tr_b16 a[180:181], v237 offset:49152
  ds_read_b64_tr_b16 a[182:183], v237 offset:50176
  v_mfma_f32_16x16x32_bf16 a[116:119], a[188:191], a[136:139], a[116:119]
  s_cbranch_vccnz SITE113
BACK113:
  s_waitcnt lgkmcnt(8)
  v_mfma_f32_16x16x32_bf16 a[192:195], a[160:163], v[128:131], a[192:195]
  ds_read_b64_tr_b16 a[184:185], v238 offset:49152
  ds_read_b64_tr_b16 a[186:187], v238 offset:50176
  v_add_f32 v249, v249, v214
  v_add_f32 v254, v254, v215
  v_exp_f32 v208, v96
  v_exp_f32 v209, v97
  v_mfma_f32_16x16x32_bf16 a[200:203], a[160:163], v[132:135], a[200:203]
  v_mfma_f32_16x16x32_bf16 a[204:207], a[164:167], v[132:135], a[204:207]
  ds_read_b64_tr_b16 a[188:189], v239 offset:49152
  ds_read_b64_tr_b16 a[190:191], v239 offset:50176
  buffer_load_dwordx4 v246, s[64:67], s34 offen offset:2048 lds
  v_exp_f32 v210, v98
  v_cvt_pk_bf16_f32 v144, v208, v209
  v_mfma_f32_16x16x32_bf16 a[196:199], a[164:167], v[128:131], a[196:199]
  s_waitcnt lgkmcnt(8)
  v_mfma_f32_16x16x32_bf16 a[208:211], a[168:171], v[128:131], a[208:211]
  ds_read_b64_tr_b16 a[160:161], v232 offset:57344
  ds_read_b64_tr_b16 a[162:163], v232 offset:58368
  v_exp_f32 v211, v99
  v_add_f32 v214, v208, v209
  v_exp_f32 v212, v100
  v_mfma_f32_16x16x32_bf16 a[216:219], a[168:171], v[132:135], a[216:219]
  v_mfma_f32_16x16x32_bf16 a[220:223], a[172:175], v[132:135], a[220:223]
  ds_read_b64_tr_b16 a[164:165], v233 offset:57344
  ds_read_b64_tr_b16 a[166:167], v233 offset:58368
  v_add_f32 v214, v214, v210
  v_cvt_pk_bf16_f32 v145, v210, v211
  v_exp_f32 v213, v101
  v_mfma_f32_16x16x32_bf16 a[212:215], a[172:175], v[128:131], a[212:215]
  s_waitcnt lgkmcnt(8)
  v_mfma_f32_16x16x32_bf16 a[224:227], a[176:179], v[128:131], a[224:227]
  ds_read_b64_tr_b16 a[168:169], v234 offset:57344
  ds_read_b64_tr_b16 a[170:171], v234 offset:58368
  buffer_load_dwordx4 v247, s[64:67], s34 offen offset:3072 lds
  v_add_f32 v214, v214, v211
  v_exp_f32 v208, v102
  v_mfma_f32_16x16x32_bf16 a[232:235], a[176:179], v[132:135], a[232:235]
  v_mfma_f32_16x16x32_bf16 a[236:239], a[180:183], v[132:135], a[236:239]
  ds_read_b64_tr_b16 a[172:173], v235 offset:57344
  ds_read_b64_tr_b16 a[174:175], v235 offset:58368
  v_add_f32 v214, v214, v212
  v_cvt_pk_bf16_f32 v146, v212, v213
  v_exp_f32 v209, v103
  v_add_f32 v214, v214, v213
  v_mfma_f32_16x16x32_bf16 a[228:231], a[180:183], v[128:131], a[228:231]
  s_waitcnt lgkmcnt(8)
  v_mfma_f32_16x16x32_bf16 a[240:243], a[184:187], v[128:131], a[240:243]
  ds_read_b64_tr_b16 a[176:177], v236 offset:57344
  ds_read_b64_tr_b16 a[178:179], v236 offset:58368
  v_exp_f32 v210, v104
  v_add_f32 v214, v214, v208
  v_cvt_pk_bf16_f32 v147, v208, v209
  v_mfma_f32_16x16x32_bf16 a[248:251], a[184:187], v[132:135], a[248:251]
  v_mfma_f32_16x16x32_bf16 a[252:255], a[188:191], v[132:135], a[252:255]
  ds_read_b64_tr_b16 a[180:181], v237 offset:57344
  ds_read_b64_tr_b16 a[182:183], v237 offset:58368
  v_exp_f32 v211, v105
  v_add_f32 v214, v214, v209
  v_exp_f32 v212, v106
  v_mfma_f32_16x16x32_bf16 a[244:247], a[188:191], v[128:131], a[244:247]
  s_waitcnt lgkmcnt(8)
  v_mfma_f32_16x16x32_bf16 a[192:195], a[160:163], v[136:139], a[192:195]
  ds_read_b64_tr_b16 a[184:185], v238 offset:57344
  ds_read_b64_tr_b16 a[186:187], v238 offset:58368
  v_cvt_pk_bf16_f32 v148, v210, v211
  v_exp_f32 v213, v107
  v_add_f32 v215, v210, v211
  v_mfma_f32_16x16x32_bf16 a[200:203], a[160:163], v[140:143], a[200:203]
  v_mfma_f32_16x16x32_bf16 a[204:207], a[164:167], v[140:143], a[204:207]
  ds_read_b64_tr_b16 a[188:189], v239 offset:57344
  ds_read_b64_tr_b16 a[190:191], v239 offset:58368
  v_exp_f32 v208, v108
  v_add_f32 v215, v215, v212
  v_cvt_pk_bf16_f32 v149, v212, v213
  v_exp_f32 v209, v109
  v_mfma_f32_16x16x32_bf16 a[196:199], a[164:167], v[136:139], a[196:199]
  s_waitcnt lgkmcnt(8)
  v_mfma_f32_16x16x32_bf16 a[208:211], a[168:171], v[136:139], a[208:211]
  s_waitcnt vmcnt(12)
  s_barrier
  ds_read_b64_tr_b16 a[160:161], v232 offset:0
  ds_read_b64_tr_b16 a[162:163], v232 offset:1024
  v_add_f32 v215, v215, v213
  v_exp_f32 v210, v110
  v_mfma_f32_16x16x32_bf16 a[216:219], a[168:171], v[140:143], a[216:219]
  v_mfma_f32_16x16x32_bf16 a[220:223], a[172:175], v[140:143], a[220:223]
  ds_read_b64_tr_b16 a[164:165], v233 offset:0
  ds_read_b64_tr_b16 a[166:167], v233 offset:1024
  s_add_u32 s34, s76, 573440
  s_add_u32 m0, s41, 98304
  s_nop 0
  buffer_load_dwordx4 v244, s[64:67], s34 offen offset:0 lds
  v_add_f32 v215, v215, v208
  v_mfma_f32_16x16x32_bf16 a[212:215], a[172:175], v[136:139], a[212:215]
  v_cvt_pk_bf16_f32 v150, v208, v209
  s_waitcnt lgkmcnt(8)
  v_mfma_f32_16x16x32_bf16 a[224:227], a[176:179], v[136:139], a[224:227]
  ds_read_b64_tr_b16 a[168:169], v234 offset:0
  ds_read_b64_tr_b16 a[170:171], v234 offset:1024
  v_exp_f32 v211, v111
  v_add_f32 v215, v215, v209
  v_exp_f32 v212, v112
  v_mfma_f32_16x16x32_bf16 a[232:235], a[176:179], v[140:143], a[232:235]
  v_mfma_f32_16x16x32_bf16 a[236:239], a[180:183], v[140:143], a[236:239]
  ds_read_b64_tr_b16 a[172:173], v235 offset:0
  ds_read_b64_tr_b16 a[174:175], v235 offset:1024
  v_add_f32 v215, v215, v210
  v_cvt_pk_bf16_f32 v151, v210, v211
  v_exp_f32 v213, v113
  v_mfma_f32_16x16x32_bf16 a[228:231], a[180:183], v[136:139], a[228:231]
  s_waitcnt lgkmcnt(8)
  v_mfma_f32_16x16x32_bf16 a[240:243], a[184:187], v[136:139], a[240:243]
  ds_read_b64_tr_b16 a[176:177], v236 offset:0
  ds_read_b64_tr_b16 a[178:179], v236 offset:1024
  buffer_load_dwordx4 v245, s[64:67], s34 offen offset:1024 lds
  v_add_f32 v215, v215, v211
  v_exp_f32 v208, v114
  v_mfma_f32_16x16x32_bf16 a[248:251], a[184:187], v[140:143], a[248:251]
  v_mfma_f32_16x16x32_bf16 a[252:255], a[188:191], v[140:143], a[252:255]
  ds_read_b64_tr_b16 a[180:181], v237 offset:0
  ds_read_b64_tr_b16 a[182:183], v237 offset:1024
  v_add_f32 v214, v214, v212
  v_cvt_pk_bf16_f32 v152, v212, v213
  v_exp_f32 v209, v115
  v_mfma_f32_16x16x32_bf16 a[244:247], a[188:191], v[136:139], a[244:247]
  s_waitcnt lgkmcnt(8)
  v_mfma_f32_16x16x32_bf16 a[64:67], a[160:163], a[144:147], a[64:67]
  ds_read_b64_tr_b16 a[184:185], v238 offset:0
  ds_read_b64_tr_b16 a[186:187], v238 offset:1024
  v_add_f32 v214, v214, v213
  v_exp_f32 v210, v116
  v_add_f32 v214, v214, v208
  v_cvt_pk_bf16_f32 v153, v208, v209
  v_mfma_f32_16x16x32_bf16 a[72:75], a[160:163], a[148:151], a[72:75]
  v_mfma_f32_16x16x32_bf16 a[76:79], a[164:167], a[148:151], a[76:79]
  ds_read_b64_tr_b16 a[188:189], v239 offset:0
  ds_read_b64_tr_b16 a[190:191], v239 offset:1024
  buffer_load_dwordx4 v246, s[64:67], s34 offen offset:2048 lds
  v_exp_f32 v211, v117
  v_mfma_f32_16x16x32_bf16 a[68:71], a[164:167], a[144:147], a[68:71]
  s_waitcnt lgkmcnt(8)
  v_mfma_f32_16x16x32_bf16 a[80:83], a[168:171], a[144:147], a[80:83]
  ds_read_b64_tr_b16 a[160:161], v232 offset:8192
  ds_read_b64_tr_b16 a[162:163], v232 offset:9216
  v_add_f32 v214, v214, v209
  v_exp_f32 v212, v118
  v_add_f32 v214, v214, v210
  v_cvt_pk_bf16_f32 v154, v210, v211
  v_mfma_f32_16x16x32_bf16 a[88:91], a[168:171], a[148:151], a[88:91]
  v_mfma_f32_16x16x32_bf16 a[92:95], a[172:175], a[148:151], a[92:95]
  ds_read_b64_tr_b16 a[164:165], v233 offset:8192
  ds_read_b64_tr_b16 a[166:167], v233 offset:9216
  v_exp_f32 v213, v119
  v_add_f32 v214, v214, v211
  v_exp_f32 v208, v120
  v_mfma_f32_16x16x32_bf16 a[84:87], a[172:175], a[144:147], a[84:87]
  s_waitcnt lgkmcnt(8)
  v_mfma_f32_16x16x32_bf16 a[96:99], a[176:179], a[144:147], a[96:99]
  ds_read_b64_tr_b16 a[168:169], v234 offset:8192
  ds_read_b64_tr_b16 a[170:171], v234 offset:9216
  buffer_load_dwordx4 v247, s[64:67], s34 offen offset:3072 lds
  v_add_f32 v214, v214, v212
  v_cvt_pk_bf16_f32 v155, v212, v213
  v_mfma_f32_16x16x32_bf16 a[104:107], a[176:179], a[148:151], a[104:107]
  v_mfma_f32_16x16x32_bf16 a[108:111], a[180:183], a[148:151], a[108:111]
  ds_read_b64_tr_b16 a[172:173], v235 offset:8192
  ds_read_b64_tr_b16 a[174:175], v235 offset:9216
  v_exp_f32 v209, v121
  v_add_f32 v214, v214, v213
  v_exp_f32 v210, v122
  v_mfma_f32_16x16x32_bf16 a[100:103], a[180:183], a[144:147], a[100:103]
  s_waitcnt lgkmcnt(8)
  v_mfma_f32_16x16x32_bf16 a[112:115], a[184:187], a[144:147], a[112:115]
  ds_read_b64_tr_b16 a[176:177], v236 offset:8192
  ds_read_b64_tr_b16 a[178:179], v236 offset:9216
  v_add_f32 v215, v215, v208
  v_cvt_pk_bf16_f32 v156, v208, v209
  v_exp_f32 v211, v123
  v_add_f32 v215, v215, v209
  v_mfma_f32_16x16x32_bf16 a[120:123], a[184:187], a[148:151], a[120:123]
  v_mfma_f32_16x16x32_bf16 a[124:127], a[188:191], a[148:151], a[124:127]
  ds_read_b64_tr_b16 a[180:181], v237 offset:8192
  ds_read_b64_tr_b16 a[182:183], v237 offset:9216
  v_exp_f32 v212, v124
  v_add_f32 v215, v215, v210
  v_cvt_pk_bf16_f32 v157, v210, v211
  v_mfma_f32_16x16x32_bf16 a[116:119], a[188:191], a[144:147], a[116:119]
  s_waitcnt lgkmcnt(8)
  v_mfma_f32_16x16x32_bf16 a[64:67], a[160:163], a[152:155], a[64:67]
  ds_read_b64_tr_b16 a[184:185], v238 offset:8192
  ds_read_b64_tr_b16 a[186:187], v238 offset:9216
  v_exp_f32 v213, v125
  v_add_f32 v215, v215, v211
  v_exp_f32 v208, v126
  v_add_f32 v215, v215, v212
  v_mfma_f32_16x16x32_bf16 a[72:75], a[160:163], a[156:159], a[72:75]
  v_mfma_f32_16x16x32_bf16 a[76:79], a[164:167], a[156:159], a[76:79]
  ds_read_b64_tr_b16 a[188:189], v239 offset:8192
  ds_read_b64_tr_b16 a[190:191], v239 offset:9216
  v_cvt_pk_bf16_f32 v158, v212, v213
  v_exp_f32 v209, v127
  v_add_f32 v215, v215, v213
  v_mfma_f32_16x16x32_bf16 a[68:71], a[164:167], a[152:155], a[68:71]
  s_waitcnt lgkmcnt(8)
  v_mfma_f32_16x16x32_bf16 a[80:83], a[168:171], a[152:155], a[80:83]
  s_waitcnt vmcnt(12)
  s_barrier
  ds_read_b64_tr_b16 a[160:161], v200 offset:0
  ds_read_b64_tr_b16 a[162:163], v200 offset:1024
  v_add_f32 v215, v215, v208
  v_cvt_pk_bf16_f32 v159, v208, v209
  v_add_f32 v215, v215, v209
  v_mfma_f32_16x16x32_bf16 a[88:91], a[168:171], a[156:159], a[88:91]
  v_mfma_f32_16x16x32_bf16 a[92:95], a[172:175], a[156:159], a[92:95]
  ds_read_b64_tr_b16 a[164:165], v201 offset:0
  ds_read_b64_tr_b16 a[166:167], v201 offset:1024
  s_add_u32 s34, s77, 491520
  s_add_u32 m0, s41, 114688
  s_nop 0
  buffer_load_dwordx4 v244, s[64:67], s34 offen offset:0 lds
  v_add_f32 v210, v214, v215
  v_mfma_f32_16x16x32_bf16 a[84:87], a[172:175], a[152:155], a[84:87]
  v_cmp_lt_f32 vcc, s35, v210
  s_waitcnt lgkmcnt(8)
  v_mfma_f32_16x16x32_bf16 a[96:99], a[176:179], a[152:155], a[96:99]
  ds_read_b64_tr_b16 a[168:169], v202 offset:0
  ds_read_b64_tr_b16 a[170:171], v202 offset:1024
  v_mfma_f32_16x16x32_bf16 a[104:107], a[176:179], a[156:159], a[104:107]
  v_mfma_f32_16x16x32_bf16 a[108:111], a[180:183], a[156:159], a[108:111]
  ds_read_b64_tr_b16 a[172:173], v203 offset:0
  ds_read_b64_tr_b16 a[174:175], v203 offset:1024
  v_mfma_f32_16x16x32_bf16 a[100:103], a[180:183], a[152:155], a[100:103]
  s_waitcnt lgkmcnt(8)
  v_mfma_f32_16x16x32_bf16 a[112:115], a[184:187], a[152:155], a[112:115]
  ds_read_b64_tr_b16 a[176:177], v204 offset:0
  ds_read_b64_tr_b16 a[178:179], v204 offset:1024
  buffer_load_dwordx4 v245, s[64:67], s34 offen offset:1024 lds
  v_mfma_f32_16x16x32_bf16 a[120:123], a[184:187], a[156:159], a[120:123]
  v_mfma_f32_16x16x32_bf16 a[124:127], a[188:191], a[156:159], a[124:127]
  ds_read_b64_tr_b16 a[180:181], v205 offset:0
  ds_read_b64_tr_b16 a[182:183], v205 offset:1024
  v_mfma_f32_16x16x32_bf16 a[116:119], a[188:191], a[152:155], a[116:119]
  s_lshr_b32 s6, s37, 3
  s_lshl_b32 s7, s6, 10
  s_lshl_b32 s47, s5, 2
  s_add_u32 s7, s7, s47
  s_add_u32 s7, s7, 67108864
  s_add_u32 s12, s52, s7
  s_addc_u32 s13, s53, 0
  s_mov_b32 s14, 0
  s_mov_b32 s15, 0x20000
  s_mul_i32 s14, s86, 225
  s_mul_i32 s6, s6, 1310720
  s_lshr_b32 s7, s5, 1
  s_mul_i32 s7, s7, 40960
  s_add_u32 s6, s6, s7
  s_and_b32 s7, s5, 1
  s_lshl_b32 s7, s7, 12
  s_add_u32 s6, s6, s7
  s_add_u32 s8, s52, s6
  s_addc_u32 s9, s53, 0
  s_mov_b32 s10, 1183744
  s_mov_b32 s11, 0x20000
  s_mul_i32 s6, s4, 327680
  s_mul_i32 s7, s3, 1280
  s_add_u32 s6, s6, s7
  s_lshr_b32 s7, s5, 1
  s_mul_i32 s7, s7, 81920
  s_add_u32 s6, s6, s7
  s_and_b32 s7, s5, 1
  s_lshl_b32 s7, s7, 7
  s_add_u32 s6, s6, s7
  s_add_u32 s16, s88, s6
  s_addc_u32 s17, s89, 0
  s_mov_b32 s18, 80512
  s_mov_b32 s19, 0x20000
  s_mov_b32 s68, 0
  s_mov_b32 s69, 163840
  s_mov_b32 s70, 327680
  s_mov_b32 s71, 491520
  s_mov_b32 s72, 655360
  s_mov_b32 s73, 819200
  s_mov_b32 s74, 983040
  s_mov_b32 s75, 1146880
  s_cbranch_vccnz SITE115
BACK115:
  s_waitcnt lgkmcnt(8)
  v_mfma_f32_16x16x32_bf16 a[192:195], a[160:163], v[144:147], a[192:195]
  ds_read_b64_tr_b16 a[184:185], v206 offset:0
  ds_read_b64_tr_b16 a[186:187], v206 offset:1024
  v_add_f32 v249, v249, v214
  v_add_f32 v254, v254, v215
  v_and_b32 v225, 0x3ff, v251
  v_lshrrev_b32 v226, 13, v251
  v_lshl_add_u32 v224, v226, 10, v225
  v_lshlrev_b32 v231, 3, v225
  v_bfe_u32 v230, v251, 4, 3
  v_mfma_f32_16x16x32_bf16 a[200:203], a[160:163], v[148:151], a[200:203]
  v_mfma_f32_16x16x32_bf16 a[204:207], a[164:167], v[148:151], a[204:207]
  ds_read_b64_tr_b16 a[188:189], v207 offset:0
  ds_read_b64_tr_b16 a[190:191], v207 offset:1024
  buffer_load_dwordx4 v246, s[64:67], s34 offen offset:2048 lds
  v_lshlrev_b32 v230, 2, v230
  v_bfe_u32 v227, v251, 4, 4
  v_and_b32 v228, 1, v226
  v_mfma_f32_16x16x32_bf16 a[196:199], a[164:167], v[144:147], a[196:199]
  s_waitcnt lgkmcnt(8)
  v_mfma_f32_16x16x32_bf16 a[208:211], a[168:171], v[144:147], a[208:211]
  ds_read_b64_tr_b16 a[160:161], v200 offset:8192
  ds_read_b64_tr_b16 a[162:163], v200 offset:9216
  v_lshl_add_u32 v227, v228, 4, v227
  v_mul_u32_u24 v227, 2560, v227
  v_lshrrev_b32 v228, 1, v226
  v_lshl_add_u32 v227, v228, 6, v227
  v_bfe_u32 v228, v251, 8, 1
  v_mfma_f32_16x16x32_bf16 a[216:219], a[168:171], v[148:151], a[216:219]
  v_mfma_f32_16x16x32_bf16 a[220:223], a[172:175], v[148:151], a[220:223]
  ds_read_b64_tr_b16 a[164:165], v201 offset:8192
  ds_read_b64_tr_b16 a[166:167], v201 offset:9216
  v_lshl_add_u32 v227, v228, 5, v227
  v_bfe_u32 v228, v251, 9, 1
  v_lshl_add_u32 v229, v228, 4, v227
  v_add_u32 v225, 8192, v224
  v_add_u32 v226, 16384, v224
  v_mfma_f32_16x16x32_bf16 a[212:215], a[172:175], v[144:147], a[212:215]
  s_waitcnt lgkmcnt(8)
  v_mfma_f32_16x16x32_bf16 a[224:227], a[176:179], v[144:147], a[224:227]
  ds_read_b64_tr_b16 a[168:169], v202 offset:8192
  ds_read_b64_tr_b16 a[170:171], v202 offset:9216
  buffer_load_dwordx4 v247, s[64:67], s34 offen offset:3072 lds
  v_add_u32 v227, 24576, v224
  v_add_u32 v228, 32768, v224
  v_mfma_f32_16x16x32_bf16 a[232:235], a[176:179], v[148:151], a[232:235]
  v_mfma_f32_16x16x32_bf16 a[236:239], a[180:183], v[148:151], a[236:239]
  ds_read_b64_tr_b16 a[172:173], v203 offset:8192
  ds_read_b64_tr_b16 a[174:175], v203 offset:9216
  buffer_load_dword v248, v231, s[84:87], 0 offen sc1
  v_mfma_f32_16x16x32_bf16 a[228:231], a[180:183], v[144:147], a[228:231]
  s_waitcnt lgkmcnt(8)
  v_mfma_f32_16x16x32_bf16 a[240:243], a[184:187], v[144:147], a[240:243]
  ds_read_b64_tr_b16 a[176:177], v204 offset:8192
  ds_read_b64_tr_b16 a[178:179], v204 offset:9216
  v_mfma_f32_16x16x32_bf16 a[248:251], a[184:187], v[148:151], a[248:251]
  v_mfma_f32_16x16x32_bf16 a[252:255], a[188:191], v[148:151], a[252:255]
  ds_read_b64_tr_b16 a[180:181], v205 offset:8192
  ds_read_b64_tr_b16 a[182:183], v205 offset:9216
  v_mfma_f32_16x16x32_bf16 a[244:247], a[188:191], v[144:147], a[244:247]
  s_waitcnt lgkmcnt(8)
  v_mfma_f32_16x16x32_bf16 a[192:195], a[160:163], v[152:155], a[192:195]
  ds_read_b64_tr_b16 a[184:185], v206 offset:8192
  ds_read_b64_tr_b16 a[186:187], v206 offset:9216
  v_mfma_f32_16x16x32_bf16 a[200:203], a[160:163], v[156:159], a[200:203]
  v_mfma_f32_16x16x32_bf16 a[204:207], a[164:167], v[156:159], a[204:207]
  ds_read_b64_tr_b16 a[188:189], v207 offset:8192
  ds_read_b64_tr_b16 a[190:191], v207 offset:9216
  v_mfma_f32_16x16x32_bf16 a[196:199], a[164:167], v[152:155], a[196:199]
  s_waitcnt lgkmcnt(8)
  v_mfma_f32_16x16x32_bf16 a[208:211], a[168:171], v[152:155], a[208:211]
  s_waitcnt vmcnt(13)
  s_barrier
  ds_read_b64_tr_b16 a[160:161], v200 offset:16384
  ds_read_b64_tr_b16 a[162:163], v200 offset:17408
  v_mfma_f32_16x16x32_bf16 a[216:219], a[168:171], v[156:159], a[216:219]
  v_mfma_f32_16x16x32_bf16 a[220:223], a[172:175], v[156:159], a[220:223]
  ds_read_b64_tr_b16 a[164:165], v201 offset:16384
  ds_read_b64_tr_b16 a[166:167], v201 offset:17408
  s_add_u32 s34, s77, 573440
  s_add_u32 m0, s41, 65536
  s_nop 0
  buffer_load_dwordx4 v244, s[64:67], s34 offen offset:0 lds
  v_mfma_f32_16x16x32_bf16 a[212:215], a[172:175], v[152:155], a[212:215]
  s_waitcnt lgkmcnt(8)
  v_mfma_f32_16x16x32_bf16 a[224:227], a[176:179], v[152:155], a[224:227]
  ds_read_b64_tr_b16 a[168:169], v202 offset:16384
  ds_read_b64_tr_b16 a[170:171], v202 offset:17408
  v_mfma_f32_16x16x32_bf16 a[232:235], a[176:179], v[156:159], a[232:235]
  v_mfma_f32_16x16x32_bf16 a[236:239], a[180:183], v[156:159], a[236:239]
  ds_read_b64_tr_b16 a[172:173], v203 offset:16384
  ds_read_b64_tr_b16 a[174:175], v203 offset:17408
  v_mfma_f32_16x16x32_bf16 a[228:231], a[180:183], v[152:155], a[228:231]
  s_waitcnt lgkmcnt(8)
  v_mfma_f32_16x16x32_bf16 a[240:243], a[184:187], v[152:155], a[240:243]
  ds_read_b64_tr_b16 a[176:177], v204 offset:16384
  ds_read_b64_tr_b16 a[178:179], v204 offset:17408
  buffer_load_dwordx4 v245, s[64:67], s34 offen offset:1024 lds
  v_mfma_f32_16x16x32_bf16 a[248:251], a[184:187], v[156:159], a[248:251]
  v_mfma_f32_16x16x32_bf16 a[252:255], a[188:191], v[156:159], a[252:255]
  ds_read_b64_tr_b16 a[180:181], v205 offset:16384
  ds_read_b64_tr_b16 a[182:183], v205 offset:17408
  v_mfma_f32_16x16x32_bf16 a[244:247], a[188:191], v[152:155], a[244:247]
  s_waitcnt lgkmcnt(8)
  v_mfma_f32_16x16x32_bf16 v[64:67], a[160:163], a[32:35], 0
  ds_read_b64_tr_b16 a[184:185], v206 offset:16384
  v_mfma_f32_16x16x32_bf16 v[72:75], a[160:163], a[36:39], 0
  ds_read_b64_tr_b16 a[186:187], v206 offset:17408
  v_mfma_f32_16x16x32_bf16 v[76:79], a[164:167], a[36:39], 0
  ds_read_b64_tr_b16 a[188:189], v207 offset:16384
  ds_read_b64_tr_b16 a[190:191], v207 offset:17408
  v_mfma_f32_16x16x32_bf16 v[68:71], a[164:167], a[32:35], 0
  buffer_load_dwordx4 v246, s[64:67], s34 offen offset:2048 lds
  s_waitcnt lgkmcnt(8)
  v_mfma_f32_16x16x32_bf16 v[80:83], a[168:171], a[32:35], 0
  ds_read_b64_tr_b16 a[160:161], v200 offset:24576
  v_mov_b32 v216, v249
  v_mov_b32 v217, v254
  v_mfma_f32_16x16x32_bf16 v[88:91], a[168:171], a[36:39], 0
  ds_read_b64_tr_b16 a[162:163], v200 offset:25600
  v_permlane16_swap_b32 v216, v217
  v_add_f32 v216, v216, v217
  v_mov_b32 v217, v216
  s_nop 1
  v_permlane32_swap_b32 v216, v217
  v_add_f32 v216, v216, v217
  v_mfma_f32_16x16x32_bf16 v[92:95], a[172:175], a[36:39], 0
  ds_read_b64_tr_b16 a[164:165], v201 offset:24576
  v_rcp_f32 v250, v216
  v_mfma_f32_16x16x32_bf16 v[84:87], a[172:175], a[32:35], 0
  ds_read_b64_tr_b16 a[166:167], v201 offset:25600
  v_mov_b32 v255, v250
  s_nop 1
  v_permlane16_swap_b32 v250, v255
  v_accvgpr_read_b32 v220, a196
  v_accvgpr_read_b32 v221, a197
  s_waitcnt lgkmcnt(8)
  v_mfma_f32_16x16x32_bf16 v[96:99], a[176:179], a[32:35], 0
  ds_read_b64_tr_b16 a[168:169], v202 offset:24576
  ds_read_b64_tr_b16 a[170:171], v202 offset:25600
  v_accvgpr_read_b32 v222, a198
  v_mfma_f32_16x16x32_bf16 v[104:107], a[176:179], a[36:39], 0
  buffer_load_dwordx4 v247, s[64:67], s34 offen offset:3072 lds
  v_accvgpr_read_b32 v223, a199
  v_accvgpr_read_b32 v216, a192
  v_accvgpr_read_b32 v217, a193
  v_accvgpr_read_b32 v218, a194
  v_accvgpr_read_b32 v219, a195
  v_mfma_f32_16x16x32_bf16 v[108:111], a[180:183], a[36:39], 0
  ds_read_b64_tr_b16 a[172:173], v203 offset:24576
  v_mul_f32 v220, v250, v220
  v_mul_f32 v221, v250, v221
  v_mfma_f32_16x16x32_bf16 v[100:103], a[180:183], a[32:35], 0
  ds_read_b64_tr_b16 a[174:175], v203 offset:25600
  v_mul_f32 v222, v250, v222
  v_mul_f32 v223, v250, v223
  v_mul_f32 v216, v250, v216
  v_mul_f32 v217, v250, v217
  v_mul_f32 v218, v250, v218
  v_mul_f32 v219, v250, v219
  s_waitcnt lgkmcnt(8)
  v_mfma_f32_16x16x32_bf16 v[112:115], a[184:187], a[32:35], 0
  ds_read_b64_tr_b16 a[176:177], v204 offset:24576
  v_cvt_pk_bf16_f32 v160, v216, v217
  v_cvt_pk_bf16_f32 v161, v218, v219
  v_mfma_f32_16x16x32_bf16 v[120:123], a[184:187], a[36:39], 0
  ds_read_b64_tr_b16 a[178:179], v204 offset:25600
  v_cvt_pk_bf16_f32 v162, v220, v221
  v_cvt_pk_bf16_f32 v163, v222, v223
  s_nop 0
  v_permlane16_swap_b32 v160, v162
  v_permlane16_swap_b32 v161, v163
  v_accvgpr_read_b32 v220, a204
  v_mfma_f32_16x16x32_bf16 v[124:127], a[188:191], a[36:39], 0
  ds_read_b64_tr_b16 a[180:181], v205 offset:24576
  v_accvgpr_read_b32 v221, a205
  v_accvgpr_read_b32 v222, a206
  v_mfma_f32_16x16x32_bf16 v[116:119], a[188:191], a[32:35], 0
  ds_read_b64_tr_b16 a[182:183], v205 offset:25600
  v_accvgpr_read_b32 v223, a207
  v_accvgpr_read_b32 v216, a200
  v_accvgpr_read_b32 v217, a201
  v_accvgpr_read_b32 v218, a202
  v_accvgpr_read_b32 v219, a203
  v_mul_f32 v220, v255, v220
  s_waitcnt lgkmcnt(8)
  v_mfma_f32_16x16x32_bf16 v[64:67], a[160:163], a[40:43], v[64:67]
  ds_read_b64_tr_b16 a[184:185], v206 offset:24576
  v_mul_f32 v221, v255, v221
  v_mul_f32 v222, v255, v222
  v_mfma_f32_16x16x32_bf16 v[72:75], a[160:163], a[44:47], v[72:75]
  ds_read_b64_tr_b16 a[186:187], v206 offset:25600
  v_mul_f32 v223, v255, v223
  v_mul_f32 v216, v255, v216
  v_mul_f32 v217, v255, v217
  v_mul_f32 v218, v255, v218
  v_mul_f32 v219, v255, v219
  v_cvt_pk_bf16_f32 v164, v216, v217
  v_mfma_f32_16x16x32_bf16 v[76:79], a[164:167], a[44:47], v[76:79]
  ds_read_b64_tr_b16 a[188:189], v207 offset:24576
  v_cvt_pk_bf16_f32 v165, v218, v219
  v_cvt_pk_bf16_f32 v166, v220, v221
  v_mfma_f32_16x16x32_bf16 v[68:71], a[164:167], a[40:43], v[68:71]
  ds_read_b64_tr_b16 a[190:191], v207 offset:25600
  v_cvt_pk_bf16_f32 v167, v222, v223
  v_permlane16_swap_b32 v164, v166
  s_nop 0
  v_permlane16_swap_b32 v165, v167
  v_accvgpr_read_b32 v220, a212
  v_accvgpr_read_b32 v221, a213
  s_waitcnt lgkmcnt(8)
  v_mfma_f32_16x16x32_bf16 v[80:83], a[168:171], a[40:43], v[80:83]
  s_waitcnt vmcnt(13)
  s_barrier
  ds_read_b64_tr_b16 a[160:161], v232 offset:16384
  v_mfma_f32_16x16x32_bf16 v[88:91], a[168:171], a[44:47], v[88:91]
  ds_read_b64_tr_b16 a[162:163], v232 offset:17408
  v_accvgpr_read_b32 v222, a214
  v_accvgpr_read_b32 v223, a215
  v_accvgpr_read_b32 v216, a208
  v_accvgpr_read_b32 v217, a209
  v_accvgpr_read_b32 v218, a210
  v_accvgpr_read_b32 v219, a211
  v_mfma_f32_16x16x32_bf16 v[92:95], a[172:175], a[44:47], v[92:95]
  ds_read_b64_tr_b16 a[164:165], v233 offset:16384
  ds_read_b64_tr_b16 a[166:167], v233 offset:17408
  v_mul_f32 v220, v250, v220
  v_mfma_f32_16x16x32_bf16 v[84:87], a[172:175], a[40:43], v[84:87]
  s_add_u32 s34, s78, 81920
  s_add_u32 m0, s41, 131072
  s_nop 0
  buffer_load_dwordx4 v244, s[64:67], s34 offen offset:0 lds
  v_mul_f32 v221, v250, v221
  v_mul_f32 v222, v250, v222
  v_mul_f32 v223, v250, v223
  v_mul_f32 v216, v250, v216
  s_waitcnt lgkmcnt(8)
  v_mfma_f32_16x16x32_bf16 v[96:99], a[176:179], a[40:43], v[96:99]
  ds_read_b64_tr_b16 a[168:169], v234 offset:16384
  v_mul_f32 v217, v250, v217
  v_mul_f32 v218, v250, v218
  v_mfma_f32_16x16x32_bf16 v[104:107], a[176:179], a[44:47], v[104:107]
  ds_read_b64_tr_b16 a[170:171], v234 offset:17408
  v_mul_f32 v219, v250, v219
  v_cvt_pk_bf16_f32 v168, v216, v217
  v_cvt_pk_bf16_f32 v169, v218, v219
  v_cvt_pk_bf16_f32 v170, v220, v221
  v_cvt_pk_bf16_f32 v171, v222, v223
  s_nop 0
  v_permlane16_swap_b32 v168, v170
  v_mfma_f32_16x16x32_bf16 v[108:111], a[180:183], a[44:47], v[108:111]
  ds_read_b64_tr_b16 a[172:173], v235 offset:16384
  v_permlane16_swap_b32 v169, v171
  v_accvgpr_read_b32 v220, a220
  v_mfma_f32_16x16x32_bf16 v[100:103], a[180:183], a[40:43], v[100:103]
  ds_read_b64_tr_b16 a[174:175], v235 offset:17408
  v_accvgpr_read_b32 v221, a221
  v_accvgpr_read_b32 v222, a222
  v_accvgpr_read_b32 v223, a223
  v_accvgpr_read_b32 v216, a216
  v_accvgpr_read_b32 v217, a217
  v_accvgpr_read_b32 v218, a218
  s_waitcnt lgkmcnt(8)
  v_mfma_f32_16x16x32_bf16 v[112:115], a[184:187], a[40:43], v[112:115]
  ds_read_b64_tr_b16 a[176:177], v236 offset:16384
  ds_read_b64_tr_b16 a[178:179], v236 offset:17408
  v_accvgpr_read_b32 v219, a219
  v_mfma_f32_16x16x32_bf16 v[120:123], a[184:187], a[44:47], v[120:123]
  buffer_load_dwordx4 v245, s[64:67], s34 offen offset:1024 lds
  v_mul_f32 v220, v255, v220
  v_mul_f32 v221, v255, v221
  v_mul_f32 v222, v255, v222
  v_mul_f32 v223, v255, v223
  v_mul_f32 v216, v255, v216
  v_mul_f32 v217, v255, v217
  v_mfma_f32_16x16x32_bf16 v[124:127], a[188:191], a[44:47], v[124:127]
  ds_read_b64_tr_b16 a[180:181], v237 offset:16384
  v_mul_f32 v218, v255, v218
  v_mul_f32 v219, v255, v219
  v_mfma_f32_16x16x32_bf16 v[116:119], a[188:191], a[40:43], v[116:119]
  ds_read_b64_tr_b16 a[182:183], v237 offset:17408
  v_cvt_pk_bf16_f32 v172, v216, v217
  v_cvt_pk_bf16_f32 v173, v218, v219
  v_cvt_pk_bf16_f32 v174, v220, v221
  v_cvt_pk_bf16_f32 v175, v222, v223
  s_nop 0
  v_permlane16_swap_b32 v172, v174
  v_permlane16_swap_b32 v173, v175
  s_waitcnt lgkmcnt(8)
  v_mfma_f32_16x16x32_bf16 v[0:3], a[160:163], v[160:163], v[0:3]
  ds_read_b64_tr_b16 a[184:185], v238 offset:16384
  v_accvgpr_read_b32 v220, a228
  v_accvgpr_read_b32 v221, a229
  v_mfma_f32_16x16x32_bf16 v[8:11], a[160:163], v[164:167], v[8:11]
  ds_read_b64_tr_b16 a[186:187], v238 offset:17408
  v_accvgpr_read_b32 v222, a230
  v_accvgpr_read_b32 v223, a231
  v_accvgpr_read_b32 v216, a224
  v_mfma_f32_16x16x32_bf16 v[12:15], a[164:167], v[164:167], v[12:15]
  ds_read_b64_tr_b16 a[188:189], v239 offset:16384
  ds_read_b64_tr_b16 a[190:191], v239 offset:17408
  v_accvgpr_read_b32 v217, a225
  v_mfma_f32_16x16x32_bf16 v[4:7], a[164:167], v[160:163], v[4:7]
  buffer_load_dwordx4 v246, s[64:67], s34 offen offset:2048 lds
  v_accvgpr_read_b32 v218, a226
  v_accvgpr_read_b32 v219, a227
  v_mul_f32 v220, v250, v220
  s_waitcnt lgkmcnt(8)
  v_mfma_f32_16x16x32_bf16 v[16:19], a[168:171], v[160:163], v[16:19]
  ds_read_b64_tr_b16 a[160:161], v232 offset:24576
  v_mul_f32 v221, v250, v221
  v_mul_f32 v222, v250, v222
  v_mfma_f32_16x16x32_bf16 v[24:27], a[168:171], v[164:167], v[24:27]
  ds_read_b64_tr_b16 a[162:163], v232 offset:25600
  v_mul_f32 v223, v250, v223
  v_mul_f32 v216, v250, v216
  v_mul_f32 v217, v250, v217
  v_mul_f32 v218, v250, v218
  v_mfma_f32_16x16x32_bf16 v[28:31], a[172:175], v[164:167], v[28:31]
  ds_read_b64_tr_b16 a[164:165], v233 offset:24576
  v_mul_f32 v219, v250, v219
  v_cvt_pk_bf16_f32 v176, v216, v217
  v_mfma_f32_16x16x32_bf16 v[20:23], a[172:175], v[160:163], v[20:23]
  ds_read_b64_tr_b16 a[166:167], v233 offset:25600
  v_cvt_pk_bf16_f32 v177, v218, v219
  v_cvt_pk_bf16_f32 v178, v220, v221
  v_cvt_pk_bf16_f32 v179, v222, v223
  s_nop 0
  v_permlane16_swap_b32 v176, v178
  s_waitcnt lgkmcnt(8)
  v_mfma_f32_16x16x32_bf16 v[32:35], a[176:179], v[160:163], v[32:35]
  ds_read_b64_tr_b16 a[168:169], v234 offset:24576
  ds_read_b64_tr_b16 a[170:171], v234 offset:25600
  v_permlane16_swap_b32 v177, v179
  v_mfma_f32_16x16x32_bf16 v[40:43], a[176:179], v[164:167], v[40:43]
  buffer_load_dwordx4 v247, s[64:67], s34 offen offset:3072 lds
  v_accvgpr_read_b32 v220, a236
  v_accvgpr_read_b32 v221, a237
  v_mfma_f32_16x16x32_bf16 v[44:47], a[180:183], v[164:167], v[44:47]
  ds_read_b64_tr_b16 a[172:173], v235 offset:24576
  v_accvgpr_read_b32 v222, a238
  v_accvgpr_read_b32 v223, a239
  v_mfma_f32_16x16x32_bf16 v[36:39], a[180:183], v[160:163], v[36:39]
  ds_read_b64_tr_b16 a[174:175], v235 offset:25600
  v_accvgpr_read_b32 v216, a232
  v_accvgpr_read_b32 v217, a233
  v_accvgpr_read_b32 v218, a234
  v_accvgpr_read_b32 v219, a235
  v_mul_f32 v220, v255, v220
  s_waitcnt lgkmcnt(8)
  v_mfma_f32_16x16x32_bf16 v[48:51], a[184:187], v[160:163], v[48:51]
  ds_read_b64_tr_b16 a[176:177], v236 offset:24576
  v_mul_f32 v221, v255, v221
  v_mul_f32 v222, v255, v222
  v_mfma_f32_16x16x32_bf16 v[56:59], a[184:187], v[164:167], v[56:59]
  ds_read_b64_tr_b16 a[178:179], v236 offset:25600
  v_mul_f32 v223, v255, v223
  v_mul_f32 v216, v255, v216
  v_mul_f32 v217, v255, v217
  v_mul_f32 v218, v255, v218
  v_mfma_f32_16x16x32_bf16 v[60:63], a[188:191], v[164:167], v[60:63]
  ds_read_b64_tr_b16 a[180:181], v237 offset:24576
  v_mul_f32 v219, v255, v219
  v_cvt_pk_bf16_f32 v180, v216, v217
  v_mfma_f32_16x16x32_bf16 v[52:55], a[188:191], v[160:163], v[52:55]
  ds_read_b64_tr_b16 a[182:183], v237 offset:25600
  v_cvt_pk_bf16_f32 v181, v218, v219
  v_cvt_pk_bf16_f32 v182, v220, v221
  v_cvt_pk_bf16_f32 v183, v222, v223
  s_nop 0
  v_permlane16_swap_b32 v180, v182
  s_waitcnt lgkmcnt(8)
  v_mfma_f32_16x16x32_bf16 v[0:3], a[160:163], v[168:171], v[0:3]
  ds_read_b64_tr_b16 a[184:185], v238 offset:24576
  v_permlane16_swap_b32 v181, v183
  v_accvgpr_read_b32 v220, a244
  v_mfma_f32_16x16x32_bf16 v[8:11], a[160:163], v[172:175], v[8:11]
  ds_read_b64_tr_b16 a[186:187], v238 offset:25600
  v_accvgpr_read_b32 v221, a245
  v_accvgpr_read_b32 v222, a246
  v_accvgpr_read_b32 v223, a247
  v_accvgpr_read_b32 v216, a240
  v_mfma_f32_16x16x32_bf16 v[12:15], a[164:167], v[172:175], v[12:15]
  ds_read_b64_tr_b16 a[188:189], v239 offset:24576
  v_accvgpr_read_b32 v217, a241
  v_accvgpr_read_b32 v218, a242
  v_mfma_f32_16x16x32_bf16 v[4:7], a[164:167], v[168:171], v[4:7]
  ds_read_b64_tr_b16 a[190:191], v239 offset:25600
  v_accvgpr_read_b32 v219, a243
  v_mul_f32 v220, v250, v220
  v_mul_f32 v221, v250, v221
  v_mul_f32 v222, v250, v222
  v_mul_f32 v223, v250, v223
  s_waitcnt lgkmcnt(8)
  v_mfma_f32_16x16x32_bf16 v[16:19], a[168:171], v[168:171], v[16:19]
  s_waitcnt vmcnt(13)
  s_barrier
  ds_read_b64_tr_b16 a[160:161], v232 offset:32768
  v_mfma_f32_16x16x32_bf16 v[24:27], a[168:171], v[172:175], v[24:27]
  ds_read_b64_tr_b16 a[162:163], v232 offset:33792
  v_mul_f32 v216, v250, v216
  v_mul_f32 v217, v250, v217
  v_mul_f32 v218, v250, v218
  v_mul_f32 v219, v250, v219
  v_mfma_f32_16x16x32_bf16 v[28:31], a[172:175], v[172:175], v[28:31]
  ds_read_b64_tr_b16 a[164:165], v233 offset:32768
  ds_read_b64_tr_b16 a[166:167], v233 offset:33792
  v_cvt_pk_bf16_f32 v184, v216, v217
  v_mfma_f32_16x16x32_bf16 v[20:23], a[172:175], v[168:171], v[20:23]
  s_add_u32 s34, s78, 163840
  s_add_u32 m0, s41, 147456
  s_nop 0
  buffer_load_dwordx4 v244, s[64:67], s34 offen offset:0 lds
  v_cvt_pk_bf16_f32 v185, v218, v219
  v_cvt_pk_bf16_f32 v186, v220, v221
  v_cvt_pk_bf16_f32 v187, v222, v223
  s_waitcnt lgkmcnt(8)
  v_mfma_f32_16x16x32_bf16 v[32:35], a[176:179], v[168:171], v[32:35]
  ds_read_b64_tr_b16 a[168:169], v234 offset:32768
  v_permlane16_swap_b32 v184, v186
  v_permlane16_swap_b32 v185, v187
  v_mfma_f32_16x16x32_bf16 v[40:43], a[176:179], v[172:175], v[40:43]
  ds_read_b64_tr_b16 a[170:171], v234 offset:33792
  v_accvgpr_read_b32 v220, a252
  v_accvgpr_read_b32 v221, a253
  v_accvgpr_read_b32 v222, a254
  v_accvgpr_read_b32 v223, a255
  v_accvgpr_read_b32 v216, a248
  v_mfma_f32_16x16x32_bf16 v[44:47], a[180:183], v[172:175], v[44:47]
  ds_read_b64_tr_b16 a[172:173], v235 offset:32768
  v_accvgpr_read_b32 v217, a249
  v_accvgpr_read_b32 v218, a250
  v_mfma_f32_16x16x32_bf16 v[36:39], a[180:183], v[168:171], v[36:39]
  ds_read_b64_tr_b16 a[174:175], v235 offset:33792
  v_accvgpr_read_b32 v219, a251
  v_mul_f32 v220, v255, v220
  v_mul_f32 v221, v255, v221
  v_mul_f32 v222, v255, v222
  s_waitcnt lgkmcnt(8)
  v_mfma_f32_16x16x32_bf16 v[48:51], a[184:187], v[168:171], v[48:51]
  ds_read_b64_tr_b16 a[176:177], v236 offset:32768
  ds_read_b64_tr_b16 a[178:179], v236 offset:33792
  v_mul_f32 v223, v255, v223
  v_mfma_f32_16x16x32_bf16 v[56:59], a[184:187], v[172:175], v[56:59]
  buffer_load_dwordx4 v245, s[64:67], s34 offen offset:1024 lds
  v_mul_f32 v216, v255, v216
  v_mul_f32 v217, v255, v217
  v_mul_f32 v218, v255, v218
  v_mul_f32 v219, v255, v219
  v_mfma_f32_16x16x32_bf16 v[60:63], a[188:191], v[172:175], v[60:63]
  ds_read_b64_tr_b16 a[180:181], v237 offset:32768
  v_cvt_pk_bf16_f32 v188, v216, v217
  v_cvt_pk_bf16_f32 v189, v218, v219
  v_mfma_f32_16x16x32_bf16 v[52:55], a[188:191], v[168:171], v[52:55]
  ds_read_b64_tr_b16 a[182:183], v237 offset:33792
  v_cvt_pk_bf16_f32 v190, v220, v221
  v_cvt_pk_bf16_f32 v191, v222, v223
  s_nop 0
  v_permlane16_swap_b32 v188, v190
  v_permlane16_swap_b32 v189, v191
  s_waitcnt lgkmcnt(8)
  v_mfma_f32_16x16x32_bf16 v[0:3], a[160:163], v[176:179], v[0:3]
  ds_read_b64_tr_b16 a[184:185], v238 offset:32768
  v_mfma_f32_16x16x32_bf16 v[8:11], a[160:163], v[180:183], v[8:11]
  ds_read_b64_tr_b16 a[186:187], v238 offset:33792
  v_mfma_f32_16x16x32_bf16 v[12:15], a[164:167], v[180:183], v[12:15]
  ds_read_b64_tr_b16 a[188:189], v239 offset:32768
  ds_read_b64_tr_b16 a[190:191], v239 offset:33792
  v_mfma_f32_16x16x32_bf16 v[4:7], a[164:167], v[176:179], v[4:7]
  buffer_load_dwordx4 v246, s[64:67], s34 offen offset:2048 lds
  s_waitcnt lgkmcnt(8)
  v_mfma_f32_16x16x32_bf16 v[16:19], a[168:171], v[176:179], v[16:19]
  ds_read_b64_tr_b16 a[160:161], v232 offset:40960
  v_mfma_f32_16x16x32_bf16 v[24:27], a[168:171], v[180:183], v[24:27]
  ds_read_b64_tr_b16 a[162:163], v232 offset:41984
  v_mfma_f32_16x16x32_bf16 v[28:31], a[172:175], v[180:183], v[28:31]
  ds_read_b64_tr_b16 a[164:165], v233 offset:40960
  v_mfma_f32_16x16x32_bf16 v[20:23], a[172:175], v[176:179], v[20:23]
  ds_read_b64_tr_b16 a[166:167], v233 offset:41984
  s_waitcnt lgkmcnt(8)
  v_mfma_f32_16x16x32_bf16 v[32:35], a[176:179], v[176:179], v[32:35]
  ds_read_b64_tr_b16 a[168:169], v234 offset:40960
  ds_read_b64_tr_b16 a[170:171], v234 offset:41984
  v_mfma_f32_16x16x32_bf16 v[40:43], a[176:179], v[180:183], v[40:43]
  buffer_load_dwordx4 v247, s[64:67], s34 offen offset:3072 lds
  v_mfma_f32_16x16x32_bf16 v[44:47], a[180:183], v[180:183], v[44:47]
  ds_read_b64_tr_b16 a[172:173], v235 offset:40960
  v_mfma_f32_16x16x32_bf16 v[36:39], a[180:183], v[176:179], v[36:39]
  ds_read_b64_tr_b16 a[174:175], v235 offset:41984
  s_waitcnt lgkmcnt(8)
  v_mfma_f32_16x16x32_bf16 v[48:51], a[184:187], v[176:179], v[48:51]
  ds_read_b64_tr_b16 a[176:177], v236 offset:40960
  v_mfma_f32_16x16x32_bf16 v[56:59], a[184:187], v[180:183], v[56:59]
  ds_read_b64_tr_b16 a[178:179], v236 offset:41984
  v_mfma_f32_16x16x32_bf16 v[60:63], a[188:191], v[180:183], v[60:63]
  ds_read_b64_tr_b16 a[180:181], v237 offset:40960
  v_mfma_f32_16x16x32_bf16 v[52:55], a[188:191], v[176:179], v[52:55]
  ds_read_b64_tr_b16 a[182:183], v237 offset:41984
  s_waitcnt lgkmcnt(8)
  v_mfma_f32_16x16x32_bf16 v[0:3], a[160:163], v[184:187], v[0:3]
  ds_read_b64_tr_b16 a[184:185], v238 offset:40960
  v_mfma_f32_16x16x32_bf16 v[8:11], a[160:163], v[188:191], v[8:11]
  ds_read_b64_tr_b16 a[186:187], v238 offset:41984
  v_mfma_f32_16x16x32_bf16 v[12:15], a[164:167], v[188:191], v[12:15]
  ds_read_b64_tr_b16 a[188:189], v239 offset:40960
  v_mfma_f32_16x16x32_bf16 v[4:7], a[164:167], v[184:187], v[4:7]
  ds_read_b64_tr_b16 a[190:191], v239 offset:41984
  s_waitcnt lgkmcnt(8)
  v_mfma_f32_16x16x32_bf16 v[16:19], a[168:171], v[184:187], v[16:19]
  s_waitcnt vmcnt(13)
  s_barrier
  ds_read_b64_tr_b16 a[160:161], v232 offset:49152
  v_mfma_f32_16x16x32_bf16 v[24:27], a[168:171], v[188:191], v[24:27]
  ds_read_b64_tr_b16 a[162:163], v232 offset:50176
  v_mfma_f32_16x16x32_bf16 v[28:31], a[172:175], v[188:191], v[28:31]
  ds_read_b64_tr_b16 a[164:165], v233 offset:49152
  ds_read_b64_tr_b16 a[166:167], v233 offset:50176
  v_mfma_f32_16x16x32_bf16 v[20:23], a[172:175], v[184:187], v[20:23]
  s_add_u32 s34, s78, 245760
  s_add_u32 m0, s41, 81920
  s_nop 0
  buffer_load_dwordx4 v244, s[64:67], s34 offen offset:0 lds
  s_waitcnt lgkmcnt(8)
  v_mfma_f32_16x16x32_bf16 v[32:35], a[176:179], v[184:187], v[32:35]
  ds_read_b64_tr_b16 a[168:169], v234 offset:49152
  v_mfma_f32_16x16x32_bf16 v[40:43], a[176:179], v[188:191], v[40:43]
  ds_read_b64_tr_b16 a[170:171], v234 offset:50176
  v_mfma_f32_16x16x32_bf16 v[44:47], a[180:183], v[188:191], v[44:47]
  ds_read_b64_tr_b16 a[172:173], v235 offset:49152
  v_mfma_f32_16x16x32_bf16 v[36:39], a[180:183], v[184:187], v[36:39]
  ds_read_b64_tr_b16 a[174:175], v235 offset:50176
  s_waitcnt lgkmcnt(8)
  v_mfma_f32_16x16x32_bf16 v[48:51], a[184:187], v[184:187], v[48:51]
  ds_read_b64_tr_b16 a[176:177], v236 offset:49152
  ds_read_b64_tr_b16 a[178:179], v236 offset:50176
  v_mfma_f32_16x16x32_bf16 v[56:59], a[184:187], v[188:191], v[56:59]
  buffer_load_dwordx4 v245, s[64:67], s34 offen offset:1024 lds
  v_mfma_f32_16x16x32_bf16 v[60:63], a[188:191], v[188:191], v[60:63]
  ds_read_b64_tr_b16 a[180:181], v237 offset:49152
  v_mfma_f32_16x16x32_bf16 v[52:55], a[188:191], v[184:187], v[52:55]
  ds_read_b64_tr_b16 a[182:183], v237 offset:50176
  s_waitcnt lgkmcnt(8)
  v_mfma_f32_16x16x32_bf16 a[64:67], a[160:163], v[160:163], a[64:67]
  ds_read_b64_tr_b16 a[184:185], v238 offset:49152
  v_mfma_f32_16x16x32_bf16 a[72:75], a[160:163], v[164:167], a[72:75]
  ds_read_b64_tr_b16 a[186:187], v238 offset:50176
  v_mfma_f32_16x16x32_bf16 a[76:79], a[164:167], v[164:167], a[76:79]
  ds_read_b64_tr_b16 a[188:189], v239 offset:49152
  ds_read_b64_tr_b16 a[190:191], v239 offset:50176
  v_mfma_f32_16x16x32_bf16 a[68:71], a[164:167], v[160:163], a[68:71]
  buffer_load_dwordx4 v246, s[64:67], s34 offen offset:2048 lds
  s_waitcnt lgkmcnt(8)
  v_mfma_f32_16x16x32_bf16 a[80:83], a[168:171], v[160:163], a[80:83]
  ds_read_b64_tr_b16 a[160:161], v232 offset:57344
  s_mov_b32 s46, 0
  v_cvt_pk_bf16_f32 v0, v0, v1
  v_mfma_f32_16x16x32_bf16 a[88:91], a[168:171], v[164:167], a[88:91]
  ds_read_b64_tr_b16 a[162:163], v232 offset:58368
  v_cvt_pk_bf16_f32 v1, v2, v3
  v_cvt_pk_bf16_f32 v2, v4, v5
  v_cvt_pk_bf16_f32 v3, v6, v7
  v_mfma_f32_16x16x32_bf16 a[92:95], a[172:175], v[164:167], a[92:95]
  ds_read_b64_tr_b16 a[164:165], v233 offset:57344
  buffer_store_dwordx4 v[0:3], v252, s[28:31], s46 offen offset:0 sc1
  v_mfma_f32_16x16x32_bf16 a[84:87], a[172:175], v[160:163], a[84:87]
  ds_read_b64_tr_b16 a[166:167], v233 offset:58368
  v_cvt_pk_bf16_f32 v8, v8, v9
  v_cvt_pk_bf16_f32 v9, v10, v11
  s_waitcnt lgkmcnt(8)
  v_mfma_f32_16x16x32_bf16 a[96:99], a[176:179], v[160:163], a[96:99]
  ds_read_b64_tr_b16 a[168:169], v234 offset:57344
  ds_read_b64_tr_b16 a[170:171], v234 offset:58368
  v_cvt_pk_bf16_f32 v10, v12, v13
  v_mfma_f32_16x16x32_bf16 a[104:107], a[176:179], v[164:167], a[104:107]
  buffer_load_dwordx4 v247, s[64:67], s34 offen offset:3072 lds
  v_mfma_f32_16x16x32_bf16 a[108:111], a[180:183], v[164:167], a[108:111]
  ds_read_b64_tr_b16 a[172:173], v235 offset:57344
  v_cvt_pk_bf16_f32 v11, v14, v15
  buffer_store_dwordx4 v[8:11], v252, s[28:31], s46 offen offset:1024 sc1
  v_mfma_f32_16x16x32_bf16 a[100:103], a[180:183], v[160:163], a[100:103]
  ds_read_b64_tr_b16 a[174:175], v235 offset:58368
  s_waitcnt lgkmcnt(8)
  v_mfma_f32_16x16x32_bf16 a[112:115], a[184:187], v[160:163], a[112:115]
  ds_read_b64_tr_b16 a[176:177], v236 offset:57344
  v_cvt_pk_bf16_f32 v16, v16, v17
  v_cvt_pk_bf16_f32 v17, v18, v19
  v_mfma_f32_16x16x32_bf16 a[120:123], a[184:187], v[164:167], a[120:123]
  ds_read_b64_tr_b16 a[178:179], v236 offset:58368
  v_cvt_pk_bf16_f32 v18, v20, v21
  v_mfma_f32_16x16x32_bf16 a[124:127], a[188:191], v[164:167], a[124:127]
  ds_read_b64_tr_b16 a[180:181], v237 offset:57344
  v_cvt_pk_bf16_f32 v19, v22, v23
  buffer_store_dwordx4 v[16:19], v252, s[28:31], s46 offen offset:2048 sc1
  v_mfma_f32_16x16x32_bf16 a[116:119], a[188:191], v[160:163], a[116:119]
  ds_read_b64_tr_b16 a[182:183], v237 offset:58368
  v_cvt_pk_bf16_f32 v24, v24, v25
  s_waitcnt lgkmcnt(8)
  v_mfma_f32_16x16x32_bf16 a[64:67], a[160:163], v[168:171], a[64:67]
  ds_read_b64_tr_b16 a[184:185], v238 offset:57344
  v_cvt_pk_bf16_f32 v25, v26, v27
  v_cvt_pk_bf16_f32 v26, v28, v29
  v_mfma_f32_16x16x32_bf16 a[72:75], a[160:163], v[172:175], a[72:75]
  ds_read_b64_tr_b16 a[186:187], v238 offset:58368
  v_cvt_pk_bf16_f32 v27, v30, v31
  v_mfma_f32_16x16x32_bf16 a[76:79], a[164:167], v[172:175], a[76:79]
  ds_read_b64_tr_b16 a[188:189], v239 offset:57344
  buffer_store_dwordx4 v[24:27], v252, s[28:31], s46 offen offset:3072 sc1
  v_mfma_f32_16x16x32_bf16 a[68:71], a[164:167], v[168:171], a[68:71]
  ds_read_b64_tr_b16 a[190:191], v239 offset:58368
  s_mov_b32 s46, 4096
  v_cvt_pk_bf16_f32 v32, v32, v33
  s_waitcnt lgkmcnt(8)
  v_mfma_f32_16x16x32_bf16 a[80:83], a[168:171], v[168:171], a[80:83]
  s_waitcnt vmcnt(16)
  s_barrier
  ds_read_b64_tr_b16 a[160:161], v232 offset:0
  v_mfma_f32_16x16x32_bf16 a[88:91], a[168:171], v[172:175], a[88:91]
  ds_read_b64_tr_b16 a[162:163], v232 offset:1024
  v_cvt_pk_bf16_f32 v33, v34, v35
  v_mfma_f32_16x16x32_bf16 a[92:95], a[172:175], v[172:175], a[92:95]
  ds_read_b64_tr_b16 a[164:165], v233 offset:0
  ds_read_b64_tr_b16 a[166:167], v233 offset:1024
  v_cvt_pk_bf16_f32 v34, v36, v37
  v_mfma_f32_16x16x32_bf16 a[84:87], a[172:175], v[168:171], a[84:87]
  s_add_u32 s34, s78, 327680
  s_add_u32 m0, s41, 98304
  s_nop 0
  buffer_load_dwordx4 v244, s[64:67], s34 offen offset:0 lds
  s_waitcnt lgkmcnt(8)
  v_mfma_f32_16x16x32_bf16 a[96:99], a[176:179], v[168:171], a[96:99]
  ds_read_b64_tr_b16 a[168:169], v234 offset:0
  v_cvt_pk_bf16_f32 v35, v38, v39
  buffer_store_dwordx4 v[32:35], v252, s[28:31], s46 offen offset:0 sc1
  v_mfma_f32_16x16x32_bf16 a[104:107], a[176:179], v[172:175], a[104:107]
  ds_read_b64_tr_b16 a[170:171], v234 offset:1024
  v_mfma_f32_16x16x32_bf16 a[108:111], a[180:183], v[172:175], a[108:111]
  ds_read_b64_tr_b16 a[172:173], v235 offset:0
  v_cvt_pk_bf16_f32 v40, v40, v41
  v_cvt_pk_bf16_f32 v41, v42, v43
  v_mfma_f32_16x16x32_bf16 a[100:103], a[180:183], v[168:171], a[100:103]
  ds_read_b64_tr_b16 a[174:175], v235 offset:1024
  v_cvt_pk_bf16_f32 v42, v44, v45
  v_cvt_pk_bf16_f32 v43, v46, v47
  s_waitcnt lgkmcnt(8)
  v_mfma_f32_16x16x32_bf16 a[112:115], a[184:187], v[168:171], a[112:115]
  ds_read_b64_tr_b16 a[176:177], v236 offset:0
  ds_read_b64_tr_b16 a[178:179], v236 offset:1024
  v_mfma_f32_16x16x32_bf16 a[120:123], a[184:187], v[172:175], a[120:123]
  buffer_load_dwordx4 v245, s[64:67], s34 offen offset:1024 lds
  v_mfma_f32_16x16x32_bf16 a[124:127], a[188:191], v[172:175], a[124:127]
  ds_read_b64_tr_b16 a[180:181], v237 offset:0
  buffer_store_dwordx4 v[40:43], v252, s[28:31], s46 offen offset:1024 sc1
  v_mfma_f32_16x16x32_bf16 a[116:119], a[188:191], v[168:171], a[116:119]
  ds_read_b64_tr_b16 a[182:183], v237 offset:1024
  v_cvt_pk_bf16_f32 v48, v48, v49
  v_cvt_pk_bf16_f32 v49, v50, v51
  s_waitcnt lgkmcnt(8)
  v_mfma_f32_16x16x32_bf16 a[64:67], a[160:163], v[176:179], a[64:67]
  ds_read_b64_tr_b16 a[184:185], v238 offset:0
  v_cvt_pk_bf16_f32 v50, v52, v53
  v_cvt_pk_bf16_f32 v51, v54, v55
  v_mfma_f32_16x16x32_bf16 a[72:75], a[160:163], v[180:183], a[72:75]
  ds_read_b64_tr_b16 a[186:187], v238 offset:1024
  buffer_store_dwordx4 v[48:51], v252, s[28:31], s46 offen offset:2048 sc1
  v_mfma_f32_16x16x32_bf16 a[76:79], a[164:167], v[180:183], a[76:79]
  ds_read_b64_tr_b16 a[188:189], v239 offset:0
  ds_read_b64_tr_b16 a[190:191], v239 offset:1024
  v_mfma_f32_16x16x32_bf16 a[68:71], a[164:167], v[176:179], a[68:71]
  buffer_load_dwordx4 v246, s[64:67], s34 offen offset:2048 lds
  s_waitcnt lgkmcnt(8)
  v_mfma_f32_16x16x32_bf16 a[80:83], a[168:171], v[176:179], a[80:83]
  ds_read_b64_tr_b16 a[160:161], v232 offset:8192
  v_cvt_pk_bf16_f32 v56, v56, v57
  v_cvt_pk_bf16_f32 v57, v58, v59
  v_mfma_f32_16x16x32_bf16 a[88:91], a[168:171], v[180:183], a[88:91]
  ds_read_b64_tr_b16 a[162:163], v232 offset:9216
  v_cvt_pk_bf16_f32 v58, v60, v61
  v_cvt_pk_bf16_f32 v59, v62, v63
  v_mfma_f32_16x16x32_bf16 a[92:95], a[172:175], v[180:183], a[92:95]
  ds_read_b64_tr_b16 a[164:165], v233 offset:8192
  buffer_store_dwordx4 v[56:59], v252, s[28:31], s46 offen offset:3072 sc1
  v_mfma_f32_16x16x32_bf16 a[84:87], a[172:175], v[176:179], a[84:87]
  ds_read_b64_tr_b16 a[166:167], v233 offset:9216
  s_waitcnt lgkmcnt(8)
  v_mfma_f32_16x16x32_bf16 a[96:99], a[176:179], v[176:179], a[96:99]
  ds_read_b64_tr_b16 a[168:169], v234 offset:8192
  ds_read_b64_tr_b16 a[170:171], v234 offset:9216
  v_mfma_f32_16x16x32_bf16 a[104:107], a[176:179], v[180:183], a[104:107]
  buffer_load_dwordx4 v247, s[64:67], s34 offen offset:3072 lds
  v_mfma_f32_16x16x32_bf16 a[108:111], a[180:183], v[180:183], a[108:111]
  ds_read_b64_tr_b16 a[172:173], v235 offset:8192
  v_mfma_f32_16x16x32_bf16 a[100:103], a[180:183], v[176:179], a[100:103]
  ds_read_b64_tr_b16 a[174:175], v235 offset:9216
  s_waitcnt lgkmcnt(8)
  v_mfma_f32_16x16x32_bf16 a[112:115], a[184:187], v[176:179], a[112:115]
  ds_read_b64_tr_b16 a[176:177], v236 offset:8192
  v_mfma_f32_16x16x32_bf16 a[120:123], a[184:187], v[180:183], a[120:123]
  ds_read_b64_tr_b16 a[178:179], v236 offset:9216
  v_mfma_f32_16x16x32_bf16 a[124:127], a[188:191], v[180:183], a[124:127]
  ds_read_b64_tr_b16 a[180:181], v237 offset:8192
  v_mfma_f32_16x16x32_bf16 a[116:119], a[188:191], v[176:179], a[116:119]
  ds_read_b64_tr_b16 a[182:183], v237 offset:9216
  s_waitcnt lgkmcnt(8)
  v_mfma_f32_16x16x32_bf16 a[64:67], a[160:163], v[184:187], a[64:67]
  ds_read_b64_tr_b16 a[184:185], v238 offset:8192
  v_mfma_f32_16x16x32_bf16 a[72:75], a[160:163], v[188:191], a[72:75]
  ds_read_b64_tr_b16 a[186:187], v238 offset:9216
  v_mfma_f32_16x16x32_bf16 a[76:79], a[164:167], v[188:191], a[76:79]
  ds_read_b64_tr_b16 a[188:189], v239 offset:8192
  v_mfma_f32_16x16x32_bf16 a[68:71], a[164:167], v[184:187], a[68:71]
  ds_read_b64_tr_b16 a[190:191], v239 offset:9216
  s_waitcnt lgkmcnt(8)
  v_mfma_f32_16x16x32_bf16 a[80:83], a[168:171], v[184:187], a[80:83]
  s_waitcnt vmcnt(20)
  s_barrier
  ds_read_b64_tr_b16 a[160:161], v200 offset:0
  v_mfma_f32_16x16x32_bf16 a[88:91], a[168:171], v[188:191], a[88:91]
  ds_read_b64_tr_b16 a[162:163], v200 offset:1024
  v_mfma_f32_16x16x32_bf16 a[92:95], a[172:175], v[188:191], a[92:95]
  ds_read_b64_tr_b16 a[164:165], v201 offset:0
  ds_read_b64_tr_b16 a[166:167], v201 offset:1024
  v_mfma_f32_16x16x32_bf16 a[84:87], a[172:175], v[184:187], a[84:87]
  s_add_u32 s34, s78, 409600
  s_add_u32 m0, s41, 114688
  s_nop 0
  buffer_load_dwordx4 v244, s[64:67], s34 offen offset:0 lds
  s_waitcnt lgkmcnt(8)
  v_mfma_f32_16x16x32_bf16 a[96:99], a[176:179], v[184:187], a[96:99]
  ds_read_b64_tr_b16 a[168:169], v202 offset:0
  v_mfma_f32_16x16x32_bf16 a[104:107], a[176:179], v[188:191], a[104:107]
  ds_read_b64_tr_b16 a[170:171], v202 offset:1024
  v_mfma_f32_16x16x32_bf16 a[108:111], a[180:183], v[188:191], a[108:111]
  ds_read_b64_tr_b16 a[172:173], v203 offset:0
  v_mfma_f32_16x16x32_bf16 a[100:103], a[180:183], v[184:187], a[100:103]
  ds_read_b64_tr_b16 a[174:175], v203 offset:1024
  s_waitcnt lgkmcnt(8)
  v_mfma_f32_16x16x32_bf16 a[112:115], a[184:187], v[184:187], a[112:115]
  ds_read_b64_tr_b16 a[176:177], v204 offset:0
  ds_read_b64_tr_b16 a[178:179], v204 offset:1024
  v_mfma_f32_16x16x32_bf16 a[120:123], a[184:187], v[188:191], a[120:123]
  buffer_load_dwordx4 v245, s[64:67], s34 offen offset:1024 lds
  v_mfma_f32_16x16x32_bf16 a[124:127], a[188:191], v[188:191], a[124:127]
  ds_read_b64_tr_b16 a[180:181], v205 offset:0
  v_mfma_f32_16x16x32_bf16 a[116:119], a[188:191], v[184:187], a[116:119]
  ds_read_b64_tr_b16 a[182:183], v205 offset:1024
  s_waitcnt lgkmcnt(8)
  v_mfma_f32_16x16x32_bf16 v[64:67], a[160:163], a[48:51], v[64:67]
  ds_read_b64_tr_b16 a[184:185], v206 offset:0
  v_readfirstlane_b32 s49, v248
  s_nop 3
  s_cmp_lt_u32 s49, s44
  s_cbranch_scc1 PSA
PBA:
  v_mfma_f32_16x16x32_bf16 v[72:75], a[160:163], a[52:55], v[72:75]
  ds_read_b64_tr_b16 a[186:187], v206 offset:1024
  v_mfma_f32_16x16x32_bf16 v[76:79], a[164:167], a[52:55], v[76:79]
  ds_read_b64_tr_b16 a[188:189], v207 offset:0
  ds_read_b64_tr_b16 a[190:191], v207 offset:1024
  v_mfma_f32_16x16x32_bf16 v[68:71], a[164:167], a[48:51], v[68:71]
  buffer_load_dwordx4 v246, s[64:67], s34 offen offset:2048 lds
  s_waitcnt lgkmcnt(8)
  v_mfma_f32_16x16x32_bf16 v[80:83], a[168:171], a[48:51], v[80:83]
  ds_read_b64_tr_b16 a[160:161], v200 offset:8192
  s_mov_b32 s46, 8192
  v_accvgpr_read_b32 v220, a68
  v_mfma_f32_16x16x32_bf16 v[88:91], a[168:171], a[52:55], v[88:91]
  ds_read_b64_tr_b16 a[162:163], v200 offset:9216
  v_accvgpr_read_b32 v221, a69
  v_accvgpr_read_b32 v222, a70
  v_accvgpr_read_b32 v223, a71
  v_accvgpr_read_b32 v216, a64
  v_mfma_f32_16x16x32_bf16 v[92:95], a[172:175], a[52:55], v[92:95]
  ds_read_b64_tr_b16 a[164:165], v201 offset:8192
  v_accvgpr_read_b32 v217, a65
  v_accvgpr_read_b32 v218, a66
  v_mfma_f32_16x16x32_bf16 v[84:87], a[172:175], a[48:51], v[84:87]
  ds_read_b64_tr_b16 a[166:167], v201 offset:9216
  v_accvgpr_read_b32 v219, a67
  v_cvt_pk_bf16_f32 v216, v216, v217
  v_cvt_pk_bf16_f32 v217, v218, v219
  s_waitcnt lgkmcnt(8)
  v_mfma_f32_16x16x32_bf16 v[96:99], a[176:179], a[48:51], v[96:99]
  ds_read_b64_tr_b16 a[168:169], v202 offset:8192
  ds_read_b64_tr_b16 a[170:171], v202 offset:9216
  v_cvt_pk_bf16_f32 v218, v220, v221
  v_mfma_f32_16x16x32_bf16 v[104:107], a[176:179], a[52:55], v[104:107]
  buffer_load_dwordx4 v247, s[64:67], s34 offen offset:3072 lds
  v_cvt_pk_bf16_f32 v219, v222, v223
  v_mfma_f32_16x16x32_bf16 v[108:111], a[180:183], a[52:55], v[108:111]
  ds_read_b64_tr_b16 a[172:173], v203 offset:8192
  buffer_store_dwordx4 v[216:219], v252, s[28:31], s46 offen offset:0 sc1
  v_mfma_f32_16x16x32_bf16 v[100:103], a[180:183], a[48:51], v[100:103]
  ds_read_b64_tr_b16 a[174:175], v203 offset:9216
  v_accvgpr_read_b32 v220, a76
  v_accvgpr_read_b32 v221, a77
  s_waitcnt lgkmcnt(8)
  v_mfma_f32_16x16x32_bf16 v[112:115], a[184:187], a[48:51], v[112:115]
  ds_read_b64_tr_b16 a[176:177], v204 offset:8192
  v_accvgpr_read_b32 v222, a78
  v_accvgpr_read_b32 v223, a79
  v_mfma_f32_16x16x32_bf16 v[120:123], a[184:187], a[52:55], v[120:123]
  ds_read_b64_tr_b16 a[178:179], v204 offset:9216
  v_accvgpr_read_b32 v216, a72
  v_accvgpr_read_b32 v217, a73
  v_accvgpr_read_b32 v218, a74
  v_mfma_f32_16x16x32_bf16 v[124:127], a[188:191], a[52:55], v[124:127]
  ds_read_b64_tr_b16 a[180:181], v205 offset:8192
  v_accvgpr_read_b32 v219, a75
  v_cvt_pk_bf16_f32 v216, v216, v217
  v_mfma_f32_16x16x32_bf16 v[116:119], a[188:191], a[48:51], v[116:119]
  ds_read_b64_tr_b16 a[182:183], v205 offset:9216
  v_cvt_pk_bf16_f32 v217, v218, v219
  v_cvt_pk_bf16_f32 v218, v220, v221
  s_waitcnt lgkmcnt(8)
  v_mfma_f32_16x16x32_bf16 v[64:67], a[160:163], a[56:59], v[64:67]
  ds_read_b64_tr_b16 a[184:185], v206 offset:8192
  v_cvt_pk_bf16_f32 v219, v222, v223
  buffer_store_dwordx4 v[216:219], v252, s[28:31], s46 offen offset:1024 sc1
  v_mfma_f32_16x16x32_bf16 v[72:75], a[160:163], a[60:63], v[72:75]
  ds_read_b64_tr_b16 a[186:187], v206 offset:9216
  v_accvgpr_read_b32 v220, a84
  v_mfma_f32_16x16x32_bf16 v[76:79], a[164:167], a[60:63], v[76:79]
  ds_read_b64_tr_b16 a[188:189], v207 offset:8192
  v_accvgpr_read_b32 v221, a85
  v_accvgpr_read_b32 v222, a86
  v_mfma_f32_16x16x32_bf16 v[68:71], a[164:167], a[56:59], v[68:71]
  ds_read_b64_tr_b16 a[190:191], v207 offset:9216
  v_accvgpr_read_b32 v223, a87
  v_accvgpr_read_b32 v216, a80
  v_accvgpr_read_b32 v217, a81
  s_waitcnt lgkmcnt(8)
  v_mfma_f32_16x16x32_bf16 v[80:83], a[168:171], a[56:59], v[80:83]
  s_waitcnt vmcnt(22)
  s_barrier
  ds_read_b64_tr_b16 a[160:161], v200 offset:16384
  v_mfma_f32_16x16x32_bf16 v[88:91], a[168:171], a[60:63], v[88:91]
  ds_read_b64_tr_b16 a[162:163], v200 offset:17408
  v_accvgpr_read_b32 v218, a82
  v_accvgpr_read_b32 v219, a83
  v_mfma_f32_16x16x32_bf16 v[92:95], a[172:175], a[60:63], v[92:95]
  ds_read_b64_tr_b16 a[164:165], v201 offset:16384
  ds_read_b64_tr_b16 a[166:167], v201 offset:17408
  v_cvt_pk_bf16_f32 v216, v216, v217
  v_mfma_f32_16x16x32_bf16 v[84:87], a[172:175], a[56:59], v[84:87]
  s_add_u32 s34, s78, 491520
  s_add_u32 m0, s41, 65536
  s_nop 0
  buffer_load_dwordx4 v244, s[64:67], s34 offen offset:0 lds
  v_cvt_pk_bf16_f32 v217, v218, v219
  s_waitcnt lgkmcnt(8)
  v_mfma_f32_16x16x32_bf16 v[96:99], a[176:179], a[56:59], v[96:99]
  ds_read_b64_tr_b16 a[168:169], v202 offset:16384
  v_cvt_pk_bf16_f32 v218, v220, v221
  v_cvt_pk_bf16_f32 v219, v222, v223
  v_mfma_f32_16x16x32_bf16 v[104:107], a[176:179], a[60:63], v[104:107]
  ds_read_b64_tr_b16 a[170:171], v202 offset:17408
  buffer_store_dwordx4 v[216:219], v252, s[28:31], s46 offen offset:2048 sc1
  v_accvgpr_read_b32 v220, a92
  v_mfma_f32_16x16x32_bf16 v[108:111], a[180:183], a[60:63], v[108:111]
  ds_read_b64_tr_b16 a[172:173], v203 offset:16384
  v_accvgpr_read_b32 v221, a93
  v_accvgpr_read_b32 v222, a94
  v_mfma_f32_16x16x32_bf16 v[100:103], a[180:183], a[56:59], v[100:103]
  ds_read_b64_tr_b16 a[174:175], v203 offset:17408
  v_accvgpr_read_b32 v223, a95
  v_accvgpr_read_b32 v216, a88
  s_waitcnt lgkmcnt(8)
  v_mfma_f32_16x16x32_bf16 v[112:115], a[184:187], a[56:59], v[112:115]
  ds_read_b64_tr_b16 a[176:177], v204 offset:16384
  ds_read_b64_tr_b16 a[178:179], v204 offset:17408
  v_accvgpr_read_b32 v217, a89
  v_mfma_f32_16x16x32_bf16 v[120:123], a[184:187], a[60:63], v[120:123]
  buffer_load_dwordx4 v245, s[64:67], s34 offen offset:1024 lds
  v_accvgpr_read_b32 v218, a90
  v_mfma_f32_16x16x32_bf16 v[124:127], a[188:191], a[60:63], v[124:127]
  ds_read_b64_tr_b16 a[180:181], v205 offset:16384
  v_accvgpr_read_b32 v219, a91
  v_cvt_pk_bf16_f32 v216, v216, v217
  v_mfma_f32_16x16x32_bf16 v[116:119], a[188:191], a[56:59], v[116:119]
  ds_read_b64_tr_b16 a[182:183], v205 offset:17408
  v_cvt_pk_bf16_f32 v217, v218, v219
  v_cvt_pk_bf16_f32 v218, v220, v221
  v_cvt_pk_bf16_f32 v219, v222, v223
  s_waitcnt lgkmcnt(8)
  v_mfma_f32_16x16x32_bf16 v[64:67], a[160:163], a[0:3], v[64:67]
  ds_read_b64_tr_b16 a[184:185], v206 offset:16384
  buffer_store_dwordx4 v[216:219], v252, s[28:31], s46 offen offset:3072 sc1
  v_mfma_f32_16x16x32_bf16 v[72:75], a[160:163], a[4:7], v[72:75]
  ds_read_b64_tr_b16 a[186:187], v206 offset:17408
  s_mov_b32 s46, 12288
  v_accvgpr_read_b32 v220, a100
  v_mfma_f32_16x16x32_bf16 v[76:79], a[164:167], a[4:7], v[76:79]
  ds_read_b64_tr_b16 a[188:189], v207 offset:16384
  ds_read_b64_tr_b16 a[190:191], v207 offset:17408
  v_accvgpr_read_b32 v221, a101
  v_mfma_f32_16x16x32_bf16 v[68:71], a[164:167], a[0:3], v[68:71]
  buffer_load_dwordx4 v246, s[64:67], s34 offen offset:2048 lds
  v_accvgpr_read_b32 v222, a102
  s_waitcnt lgkmcnt(8)
  v_mfma_f32_16x16x32_bf16 v[80:83], a[168:171], a[0:3], v[80:83]
  ds_read_b64_tr_b16 a[160:161], v200 offset:24576
  v_accvgpr_read_b32 v223, a103
  v_accvgpr_read_b32 v216, a96
  v_mfma_f32_16x16x32_bf16 v[88:91], a[168:171], a[4:7], v[88:91]
  ds_read_b64_tr_b16 a[162:163], v200 offset:25600
  v_accvgpr_read_b32 v217, a97
  v_accvgpr_read_b32 v218, a98
  v_accvgpr_read_b32 v219, a99
  v_mfma_f32_16x16x32_bf16 v[92:95], a[172:175], a[4:7], v[92:95]
  ds_read_b64_tr_b16 a[164:165], v201 offset:24576
  v_cvt_pk_bf16_f32 v216, v216, v217
  v_cvt_pk_bf16_f32 v217, v218, v219
  v_mfma_f32_16x16x32_bf16 v[84:87], a[172:175], a[0:3], v[84:87]
  ds_read_b64_tr_b16 a[166:167], v201 offset:25600
  v_cvt_pk_bf16_f32 v218, v220, v221
  v_cvt_pk_bf16_f32 v219, v222, v223
  s_waitcnt lgkmcnt(8)
  v_mfma_f32_16x16x32_bf16 v[96:99], a[176:179], a[0:3], v[96:99]
  ds_read_b64_tr_b16 a[168:169], v202 offset:24576
  ds_read_b64_tr_b16 a[170:171], v202 offset:25600
  buffer_store_dwordx4 v[216:219], v252, s[28:31], s46 offen offset:0 sc1
  v_mfma_f32_16x16x32_bf16 v[104:107], a[176:179], a[4:7], v[104:107]
  buffer_load_dwordx4 v247, s[64:67], s34 offen offset:3072 lds
  v_mfma_f32_16x16x32_bf16 v[108:111], a[180:183], a[4:7], v[108:111]
  ds_read_b64_tr_b16 a[172:173], v203 offset:24576
  v_accvgpr_read_b32 v220, a108
  v_accvgpr_read_b32 v221, a109
  v_mfma_f32_16x16x32_bf16 v[100:103], a[180:183], a[0:3], v[100:103]
  ds_read_b64_tr_b16 a[174:175], v203 offset:25600
  v_accvgpr_read_b32 v222, a110
  v_accvgpr_read_b32 v223, a111
  s_waitcnt lgkmcnt(8)
  v_mfma_f32_16x16x32_bf16 v[112:115], a[184:187], a[0:3], v[112:115]
  ds_read_b64_tr_b16 a[176:177], v204 offset:24576
  v_accvgpr_read_b32 v216, a104
  v_accvgpr_read_b32 v217, a105
  v_mfma_f32_16x16x32_bf16 v[120:123], a[184:187], a[4:7], v[120:123]
  ds_read_b64_tr_b16 a[178:179], v204 offset:25600
  v_accvgpr_read_b32 v218, a106
  v_accvgpr_read_b32 v219, a107
  v_cvt_pk_bf16_f32 v216, v216, v217
  v_mfma_f32_16x16x32_bf16 v[124:127], a[188:191], a[4:7], v[124:127]
  ds_read_b64_tr_b16 a[180:181], v205 offset:24576
  v_cvt_pk_bf16_f32 v217, v218, v219
  v_cvt_pk_bf16_f32 v218, v220, v221
  v_mfma_f32_16x16x32_bf16 v[116:119], a[188:191], a[0:3], v[116:119]
  ds_read_b64_tr_b16 a[182:183], v205 offset:25600
  v_cvt_pk_bf16_f32 v219, v222, v223
  buffer_store_dwordx4 v[216:219], v252, s[28:31], s46 offen offset:1024 sc1
  s_waitcnt lgkmcnt(8)
  v_mfma_f32_16x16x32_bf16 v[64:67], a[160:163], a[8:11], v[64:67]
  ds_read_b64_tr_b16 a[184:185], v206 offset:24576
  v_accvgpr_read_b32 v220, a116
  v_accvgpr_read_b32 v221, a117
  v_mfma_f32_16x16x32_bf16 v[72:75], a[160:163], a[12:15], v[72:75]
  ds_read_b64_tr_b16 a[186:187], v206 offset:25600
  v_accvgpr_read_b32 v222, a118
  v_accvgpr_read_b32 v223, a119
  v_mfma_f32_16x16x32_bf16 v[76:79], a[164:167], a[12:15], v[76:79]
  ds_read_b64_tr_b16 a[188:189], v207 offset:24576
  v_accvgpr_read_b32 v216, a112
  v_accvgpr_read_b32 v217, a113
  v_mfma_f32_16x16x32_bf16 v[68:71], a[164:167], a[8:11], v[68:71]
  ds_read_b64_tr_b16 a[190:191], v207 offset:25600
  v_accvgpr_read_b32 v218, a114
  v_accvgpr_read_b32 v219, a115
  s_waitcnt lgkmcnt(8)
  v_mfma_f32_16x16x32_bf16 v[80:83], a[168:171], a[8:11], v[80:83]
  s_waitcnt vmcnt(25)
  s_barrier
  ds_read_b64_tr_b16 a[160:161], v232 offset:16384
  v_mfma_f32_16x16x32_bf16 v[88:91], a[168:171], a[12:15], v[88:91]
  ds_read_b64_tr_b16 a[162:163], v232 offset:17408
  v_cvt_pk_bf16_f32 v216, v216, v217
  v_cvt_pk_bf16_f32 v217, v218, v219
  v_cvt_pk_bf16_f32 v218, v220, v221
  v_mfma_f32_16x16x32_bf16 v[92:95], a[172:175], a[12:15], v[92:95]
  ds_read_b64_tr_b16 a[164:165], v233 offset:16384
  ds_read_b64_tr_b16 a[166:167], v233 offset:17408
  v_cvt_pk_bf16_f32 v219, v222, v223
  v_mfma_f32_16x16x32_bf16 v[84:87], a[172:175], a[8:11], v[84:87]
  s_add_u32 s34, s78, 573440
  s_add_u32 m0, s41, 131072
  s_nop 0
  buffer_load_dwordx4 v244, s[64:67], s34 offen offset:0 lds
  s_waitcnt lgkmcnt(8)
  v_mfma_f32_16x16x32_bf16 v[96:99], a[176:179], a[8:11], v[96:99]
  ds_read_b64_tr_b16 a[168:169], v234 offset:16384
  buffer_store_dwordx4 v[216:219], v252, s[28:31], s46 offen offset:2048 sc1
  v_mfma_f32_16x16x32_bf16 v[104:107], a[176:179], a[12:15], v[104:107]
  ds_read_b64_tr_b16 a[170:171], v234 offset:17408
  v_accvgpr_read_b32 v220, a124
  v_accvgpr_read_b32 v221, a125
  v_accvgpr_read_b32 v222, a126
  v_mfma_f32_16x16x32_bf16 v[108:111], a[180:183], a[12:15], v[108:111]
  ds_read_b64_tr_b16 a[172:173], v235 offset:16384
  v_accvgpr_read_b32 v223, a127
  v_accvgpr_read_b32 v216, a120
  v_mfma_f32_16x16x32_bf16 v[100:103], a[180:183], a[8:11], v[100:103]
  ds_read_b64_tr_b16 a[174:175], v235 offset:17408
  v_accvgpr_read_b32 v217, a121
  v_accvgpr_read_b32 v218, a122
  v_accvgpr_read_b32 v219, a123
  s_waitcnt lgkmcnt(8)
  v_mfma_f32_16x16x32_bf16 v[112:115], a[184:187], a[8:11], v[112:115]
  ds_read_b64_tr_b16 a[176:177], v236 offset:16384
  ds_read_b64_tr_b16 a[178:179], v236 offset:17408
  v_cvt_pk_bf16_f32 v216, v216, v217
  v_mfma_f32_16x16x32_bf16 v[120:123], a[184:187], a[12:15], v[120:123]
  buffer_load_dwordx4 v245, s[64:67], s34 offen offset:1024 lds
  v_mfma_f32_16x16x32_bf16 v[124:127], a[188:191], a[12:15], v[124:127]
  ds_read_b64_tr_b16 a[180:181], v237 offset:16384
  v_cvt_pk_bf16_f32 v217, v218, v219
  v_cvt_pk_bf16_f32 v218, v220, v221
  v_mfma_f32_16x16x32_bf16 v[116:119], a[188:191], a[8:11], v[116:119]
  ds_read_b64_tr_b16 a[182:183], v237 offset:17408
  v_cvt_pk_bf16_f32 v219, v222, v223
  buffer_store_dwordx4 v[216:219], v252, s[28:31], s46 offen offset:3072 sc1
  s_waitcnt lgkmcnt(8)
  v_mfma_f32_16x16x32_bf16 v[64:67], a[160:163], a[16:19], v[64:67]
  ds_read_b64_tr_b16 a[184:185], v238 offset:16384
  v_mfma_f32_16x16x32_bf16 v[72:75], a[160:163], a[20:23], v[72:75]
  ds_read_b64_tr_b16 a[186:187], v238 offset:17408
  v_mfma_f32_16x16x32_bf16 v[76:79], a[164:167], a[20:23], v[76:79]
  ds_read_b64_tr_b16 a[188:189], v239 offset:16384
  ds_read_b64_tr_b16 a[190:191], v239 offset:17408
  v_mfma_f32_16x16x32_bf16 v[68:71], a[164:167], a[16:19], v[68:71]
  buffer_load_dwordx4 v246, s[64:67], s34 offen offset:2048 lds
  s_waitcnt lgkmcnt(8)
  v_mfma_f32_16x16x32_bf16 v[80:83], a[168:171], a[16:19], v[80:83]
  ds_read_b64_tr_b16 a[160:161], v232 offset:24576
  v_mfma_f32_16x16x32_bf16 v[88:91], a[168:171], a[20:23], v[88:91]
  ds_read_b64_tr_b16 a[162:163], v232 offset:25600
  v_mfma_f32_16x16x32_bf16 v[92:95], a[172:175], a[20:23], v[92:95]
  ds_read_b64_tr_b16 a[164:165], v233 offset:24576
  v_mfma_f32_16x16x32_bf16 v[84:87], a[172:175], a[16:19], v[84:87]
  ds_read_b64_tr_b16 a[166:167], v233 offset:25600
  s_waitcnt lgkmcnt(8)
  v_mfma_f32_16x16x32_bf16 v[96:99], a[176:179], a[16:19], v[96:99]
  ds_read_b64_tr_b16 a[168:169], v234 offset:24576
  ds_read_b64_tr_b16 a[170:171], v234 offset:25600
  v_mfma_f32_16x16x32_bf16 v[104:107], a[176:179], a[20:23], v[104:107]
  buffer_load_dwordx4 v247, s[64:67], s34 offen offset:3072 lds
  v_mfma_f32_16x16x32_bf16 v[108:111], a[180:183], a[20:23], v[108:111]
  ds_read_b64_tr_b16 a[172:173], v235 offset:24576
  v_mfma_f32_16x16x32_bf16 v[100:103], a[180:183], a[16:19], v[100:103]
  ds_read_b64_tr_b16 a[174:175], v235 offset:25600
  s_waitcnt lgkmcnt(8)
  v_mfma_f32_16x16x32_bf16 v[112:115], a[184:187], a[16:19], v[112:115]
  ds_read_b64_tr_b16 a[176:177], v236 offset:24576
  v_mfma_f32_16x16x32_bf16 v[120:123], a[184:187], a[20:23], v[120:123]
  ds_read_b64_tr_b16 a[178:179], v236 offset:25600
  v_mfma_f32_16x16x32_bf16 v[124:127], a[188:191], a[20:23], v[124:127]
  ds_read_b64_tr_b16 a[180:181], v237 offset:24576
  v_mfma_f32_16x16x32_bf16 v[116:119], a[188:191], a[16:19], v[116:119]
  ds_read_b64_tr_b16 a[182:183], v237 offset:25600
  s_waitcnt lgkmcnt(8)
  v_mfma_f32_16x16x32_bf16 v[64:67], a[160:163], a[24:27], v[64:67]
  ds_read_b64_tr_b16 a[184:185], v238 offset:24576
  v_mfma_f32_16x16x32_bf16 v[72:75], a[160:163], a[28:31], v[72:75]
  ds_read_b64_tr_b16 a[186:187], v238 offset:25600
  v_mfma_f32_16x16x32_bf16 v[76:79], a[164:167], a[28:31], v[76:79]
  ds_read_b64_tr_b16 a[188:189], v239 offset:24576
  v_mfma_f32_16x16x32_bf16 v[68:71], a[164:167], a[24:27], v[68:71]
  ds_read_b64_tr_b16 a[190:191], v239 offset:25600
  s_waitcnt lgkmcnt(8)
  v_mfma_f32_16x16x32_bf16 v[80:83], a[168:171], a[24:27], v[80:83]
  s_waitcnt vmcnt(20)
  s_barrier
  v_mov_b32 v208, 1
  buffer_store_dword v208, v231, s[12:15], 0 offen sc1
  ds_read_b64_tr_b16 a[160:161], v232 offset:32768
  v_mfma_f32_16x16x32_bf16 v[88:91], a[168:171], a[28:31], v[88:91]
  ds_read_b64_tr_b16 a[162:163], v232 offset:33792
  v_mfma_f32_16x16x32_bf16 v[92:95], a[172:175], a[28:31], v[92:95]
  ds_read_b64_tr_b16 a[164:165], v233 offset:32768
  ds_read_b64_tr_b16 a[166:167], v233 offset:33792
  v_mfma_f32_16x16x32_bf16 v[84:87], a[172:175], a[24:27], v[84:87]
  s_add_u32 s34, s79, 0
  s_add_u32 m0, s41, 147456
  s_nop 0
  buffer_load_dwordx4 v244, s[64:67], s34 offen offset:0 lds
  s_waitcnt lgkmcnt(8)
  v_mfma_f32_16x16x32_bf16 v[96:99], a[176:179], a[24:27], v[96:99]
  ds_read_b64_tr_b16 a[168:169], v234 offset:32768
  v_mfma_f32_16x16x32_bf16 v[104:107], a[176:179], a[28:31], v[104:107]
  ds_read_b64_tr_b16 a[170:171], v234 offset:33792
  v_mfma_f32_16x16x32_bf16 v[108:111], a[180:183], a[28:31], v[108:111]
  ds_read_b64_tr_b16 a[172:173], v235 offset:32768
  v_mfma_f32_16x16x32_bf16 v[100:103], a[180:183], a[24:27], v[100:103]
  ds_read_b64_tr_b16 a[174:175], v235 offset:33792
  s_waitcnt lgkmcnt(8)
  v_mfma_f32_16x16x32_bf16 v[112:115], a[184:187], a[24:27], v[112:115]
  ds_read_b64_tr_b16 a[176:177], v236 offset:32768
  ds_read_b64_tr_b16 a[178:179], v236 offset:33792
  v_mfma_f32_16x16x32_bf16 v[120:123], a[184:187], a[28:31], v[120:123]
  buffer_load_dwordx4 v245, s[64:67], s34 offen offset:1024 lds
  v_mfma_f32_16x16x32_bf16 v[124:127], a[188:191], a[28:31], v[124:127]
  ds_read_b64_tr_b16 a[180:181], v237 offset:32768
  v_mfma_f32_16x16x32_bf16 v[116:119], a[188:191], a[24:27], v[116:119]
  ds_read_b64_tr_b16 a[182:183], v237 offset:33792
  s_waitcnt lgkmcnt(8)
  v_mfma_f32_16x16x32_bf16 v[64:67], a[160:163], a[128:131], v[64:67]
  ds_read_b64_tr_b16 a[184:185], v238 offset:32768
  v_mfma_f32_16x16x32_bf16 v[72:75], a[160:163], a[132:135], v[72:75]
  ds_read_b64_tr_b16 a[186:187], v238 offset:33792
  v_mfma_f32_16x16x32_bf16 v[76:79], a[164:167], a[132:135], v[76:79]
  ds_read_b64_tr_b16 a[188:189], v239 offset:32768
  ds_read_b64_tr_b16 a[190:191], v239 offset:33792
  v_mfma_f32_16x16x32_bf16 v[68:71], a[164:167], a[128:131], v[68:71]
  buffer_load_dwordx4 v246, s[64:67], s34 offen offset:2048 lds
  s_waitcnt lgkmcnt(8)
  v_mfma_f32_16x16x32_bf16 v[80:83], a[168:171], a[128:131], v[80:83]
  ds_read_b64_tr_b16 a[160:161], v232 offset:40960
  v_mfma_f32_16x16x32_bf16 v[88:91], a[168:171], a[132:135], v[88:91]
  ds_read_b64_tr_b16 a[162:163], v232 offset:41984
  v_mfma_f32_16x16x32_bf16 v[92:95], a[172:175], a[132:135], v[92:95]
  ds_read_b64_tr_b16 a[164:165], v233 offset:40960
  v_mfma_f32_16x16x32_bf16 v[84:87], a[172:175], a[128:131], v[84:87]
  ds_read_b64_tr_b16 a[166:167], v233 offset:41984
  s_waitcnt lgkmcnt(8)
  v_mfma_f32_16x16x32_bf16 v[96:99], a[176:179], a[128:131], v[96:99]
  ds_read_b64_tr_b16 a[168:169], v234 offset:40960
  ds_read_b64_tr_b16 a[170:171], v234 offset:41984
  v_mfma_f32_16x16x32_bf16 v[104:107], a[176:179], a[132:135], v[104:107]
  buffer_load_dwordx4 v247, s[64:67], s34 offen offset:3072 lds
  v_mfma_f32_16x16x32_bf16 v[108:111], a[180:183], a[132:135], v[108:111]
  ds_read_b64_tr_b16 a[172:173], v235 offset:40960
  v_mfma_f32_16x16x32_bf16 v[100:103], a[180:183], a[128:131], v[100:103]
  ds_read_b64_tr_b16 a[174:175], v235 offset:41984
  s_waitcnt lgkmcnt(8)
  v_mfma_f32_16x16x32_bf16 v[112:115], a[184:187], a[128:131], v[112:115]
  ds_read_b64_tr_b16 a[176:177], v236 offset:40960
  v_mfma_f32_16x16x32_bf16 v[120:123], a[184:187], a[132:135], v[120:123]
  ds_read_b64_tr_b16 a[178:179], v236 offset:41984
  v_mfma_f32_16x16x32_bf16 v[124:127], a[188:191], a[132:135], v[124:127]
  ds_read_b64_tr_b16 a[180:181], v237 offset:40960
  v_mfma_f32_16x16x32_bf16 v[116:119], a[188:191], a[128:131], v[116:119]
  ds_read_b64_tr_b16 a[182:183], v237 offset:41984
  s_waitcnt lgkmcnt(8)
  v_mfma_f32_16x16x32_bf16 v[64:67], a[160:163], a[136:139], v[64:67]
  ds_read_b64_tr_b16 a[184:185], v238 offset:40960
  v_mfma_f32_16x16x32_bf16 v[72:75], a[160:163], a[140:143], v[72:75]
  ds_read_b64_tr_b16 a[186:187], v238 offset:41984
  v_mfma_f32_16x16x32_bf16 v[76:79], a[164:167], a[140:143], v[76:79]
  ds_read_b64_tr_b16 a[188:189], v239 offset:40960
  v_mfma_f32_16x16x32_bf16 v[68:71], a[164:167], a[136:139], v[68:71]
  ds_read_b64_tr_b16 a[190:191], v239 offset:41984
  s_waitcnt lgkmcnt(8)
  v_mfma_f32_16x16x32_bf16 v[80:83], a[168:171], a[136:139], v[80:83]
  s_waitcnt vmcnt(21)
  s_barrier
  ds_read_b64_tr_b16 a[160:161], v232 offset:49152
  v_mfma_f32_16x16x32_bf16 v[88:91], a[168:171], a[140:143], v[88:91]
  ds_read_b64_tr_b16 a[162:163], v232 offset:50176
  v_mfma_f32_16x16x32_bf16 v[92:95], a[172:175], a[140:143], v[92:95]
  ds_read_b64_tr_b16 a[164:165], v233 offset:49152
  ds_read_b64_tr_b16 a[166:167], v233 offset:50176
  v_mfma_f32_16x16x32_bf16 v[84:87], a[172:175], a[136:139], v[84:87]
  s_add_u32 s34, s79, 81920
  s_add_u32 m0, s41, 81920
  s_nop 0
  buffer_load_dwordx4 v244, s[64:67], s34 offen offset:0 lds
  s_waitcnt lgkmcnt(8)
  v_mfma_f32_16x16x32_bf16 v[96:99], a[176:179], a[136:139], v[96:99]
  ds_read_b64_tr_b16 a[168:169], v234 offset:49152
  v_mfma_f32_16x16x32_bf16 v[104:107], a[176:179], a[140:143], v[104:107]
  ds_read_b64_tr_b16 a[170:171], v234 offset:50176
  v_mfma_f32_16x16x32_bf16 v[108:111], a[180:183], a[140:143], v[108:111]
  ds_read_b64_tr_b16 a[172:173], v235 offset:49152
  v_mfma_f32_16x16x32_bf16 v[100:103], a[180:183], a[136:139], v[100:103]
  ds_read_b64_tr_b16 a[174:175], v235 offset:50176
  s_waitcnt lgkmcnt(8)
  v_mfma_f32_16x16x32_bf16 v[112:115], a[184:187], a[136:139], v[112:115]
  ds_read_b64_tr_b16 a[176:177], v236 offset:49152
  ds_read_b64_tr_b16 a[178:179], v236 offset:50176
  v_mfma_f32_16x16x32_bf16 v[120:123], a[184:187], a[140:143], v[120:123]
  buffer_load_dwordx4 v245, s[64:67], s34 offen offset:1024 lds
  v_mfma_f32_16x16x32_bf16 v[124:127], a[188:191], a[140:143], v[124:127]
  ds_read_b64_tr_b16 a[180:181], v237 offset:49152
  v_mfma_f32_16x16x32_bf16 v[116:119], a[188:191], a[136:139], v[116:119]
  ds_read_b64_tr_b16 a[182:183], v237 offset:50176
  s_waitcnt lgkmcnt(8)
  v_mfma_f32_16x16x32_bf16 v[64:67], a[160:163], a[144:147], v[64:67]
  ds_read_b64_tr_b16 a[184:185], v238 offset:49152
  v_mfma_f32_16x16x32_bf16 v[72:75], a[160:163], a[148:151], v[72:75]
  ds_read_b64_tr_b16 a[186:187], v238 offset:50176
  v_mfma_f32_16x16x32_bf16 v[76:79], a[164:167], a[148:151], v[76:79]
  ds_read_b64_tr_b16 a[188:189], v239 offset:49152
  ds_read_b64_tr_b16 a[190:191], v239 offset:50176
  v_mfma_f32_16x16x32_bf16 v[68:71], a[164:167], a[144:147], v[68:71]
  buffer_load_dwordx4 v246, s[64:67], s34 offen offset:2048 lds
  s_waitcnt lgkmcnt(8)
  v_mfma_f32_16x16x32_bf16 v[80:83], a[168:171], a[144:147], v[80:83]
  ds_read_b64_tr_b16 a[160:161], v232 offset:57344
  v_mfma_f32_16x16x32_bf16 v[88:91], a[168:171], a[148:151], v[88:91]
  ds_read_b64_tr_b16 a[162:163], v232 offset:58368
  v_mfma_f32_16x16x32_bf16 v[92:95], a[172:175], a[148:151], v[92:95]
  ds_read_b64_tr_b16 a[164:165], v233 offset:57344
  v_mfma_f32_16x16x32_bf16 v[84:87], a[172:175], a[144:147], v[84:87]
  ds_read_b64_tr_b16 a[166:167], v233 offset:58368
  s_waitcnt lgkmcnt(8)
  v_mfma_f32_16x16x32_bf16 v[96:99], a[176:179], a[144:147], v[96:99]
  ds_read_b64_tr_b16 a[168:169], v234 offset:57344
  ds_read_b64_tr_b16 a[170:171], v234 offset:58368
  v_mfma_f32_16x16x32_bf16 v[104:107], a[176:179], a[148:151], v[104:107]
  buffer_load_dwordx4 v247, s[64:67], s34 offen offset:3072 lds
  v_mfma_f32_16x16x32_bf16 v[108:111], a[180:183], a[148:151], v[108:111]
  ds_read_b64_tr_b16 a[172:173], v235 offset:57344
  v_mfma_f32_16x16x32_bf16 v[100:103], a[180:183], a[144:147], v[100:103]
  ds_read_b64_tr_b16 a[174:175], v235 offset:58368
  s_waitcnt lgkmcnt(8)
  v_mfma_f32_16x16x32_bf16 v[112:115], a[184:187], a[144:147], v[112:115]
  ds_read_b64_tr_b16 a[176:177], v236 offset:57344
  v_mfma_f32_16x16x32_bf16 v[120:123], a[184:187], a[148:151], v[120:123]
  ds_read_b64_tr_b16 a[178:179], v236 offset:58368
  v_mfma_f32_16x16x32_bf16 v[124:127], a[188:191], a[148:151], v[124:127]
  ds_read_b64_tr_b16 a[180:181], v237 offset:57344
  v_mfma_f32_16x16x32_bf16 v[116:119], a[188:191], a[144:147], v[116:119]
  ds_read_b64_tr_b16 a[182:183], v237 offset:58368
  s_waitcnt lgkmcnt(8)
  v_mfma_f32_16x16x32_bf16 v[64:67], a[160:163], a[152:155], v[64:67]
  ds_read_b64_tr_b16 a[184:185], v238 offset:57344
  v_mfma_f32_16x16x32_bf16 v[72:75], a[160:163], a[156:159], v[72:75]
  ds_read_b64_tr_b16 a[186:187], v238 offset:58368
  v_mfma_f32_16x16x32_bf16 v[76:79], a[164:167], a[156:159], v[76:79]
  ds_read_b64_tr_b16 a[188:189], v239 offset:57344
  v_mfma_f32_16x16x32_bf16 v[68:71], a[164:167], a[152:155], v[68:71]
  ds_read_b64_tr_b16 a[190:191], v239 offset:58368
  s_waitcnt lgkmcnt(8)
  v_mfma_f32_16x16x32_bf16 v[80:83], a[168:171], a[152:155], v[80:83]
  s_waitcnt vmcnt(16)
  s_barrier
  ds_read_b64_tr_b16 a[160:161], v232 offset:0
  v_mfma_f32_16x16x32_bf16 v[88:91], a[168:171], a[156:159], v[88:91]
  ds_read_b64_tr_b16 a[162:163], v232 offset:1024
  v_mfma_f32_16x16x32_bf16 v[92:95], a[172:175], a[156:159], v[92:95]
  ds_read_b64_tr_b16 a[164:165], v233 offset:0
  ds_read_b64_tr_b16 a[166:167], v233 offset:1024
  v_mfma_f32_16x16x32_bf16 v[84:87], a[172:175], a[152:155], v[84:87]
  s_add_u32 s34, s79, 163840
  s_add_u32 m0, s41, 98304
  s_nop 0
  buffer_load_dwordx4 v244, s[64:67], s34 offen offset:0 lds
  s_waitcnt lgkmcnt(8)
  v_mfma_f32_16x16x32_bf16 v[96:99], a[176:179], a[152:155], v[96:99]
  ds_read_b64_tr_b16 a[168:169], v234 offset:0
  v_mfma_f32_16x16x32_bf16 v[104:107], a[176:179], a[156:159], v[104:107]
  ds_read_b64_tr_b16 a[170:171], v234 offset:1024
  v_mfma_f32_16x16x32_bf16 v[108:111], a[180:183], a[156:159], v[108:111]
  ds_read_b64_tr_b16 a[172:173], v235 offset:0
  v_mfma_f32_16x16x32_bf16 v[100:103], a[180:183], a[152:155], v[100:103]
  ds_read_b64_tr_b16 a[174:175], v235 offset:1024
  s_waitcnt lgkmcnt(8)
  v_mfma_f32_16x16x32_bf16 v[112:115], a[184:187], a[152:155], v[112:115]
  ds_read_b64_tr_b16 a[176:177], v236 offset:0
  ds_read_b64_tr_b16 a[178:179], v236 offset:1024
  v_mfma_f32_16x16x32_bf16 v[120:123], a[184:187], a[156:159], v[120:123]
  buffer_load_dwordx4 v245, s[64:67], s34 offen offset:1024 lds
  v_mfma_f32_16x16x32_bf16 v[124:127], a[188:191], a[156:159], v[124:127]
  ds_read_b64_tr_b16 a[180:181], v237 offset:0
  v_mfma_f32_16x16x32_bf16 v[116:119], a[188:191], a[152:155], v[116:119]
  ds_read_b64_tr_b16 a[182:183], v237 offset:1024
  s_waitcnt lgkmcnt(8)
  v_mfma_f32_16x16x32_bf16 v[64:67], a[160:163], v[160:163], v[64:67]
  ds_read_b64_tr_b16 a[184:185], v238 offset:0
  v_mfma_f32_16x16x32_bf16 v[72:75], a[160:163], v[164:167], v[72:75]
  ds_read_b64_tr_b16 a[186:187], v238 offset:1024
  v_mfma_f32_16x16x32_bf16 v[76:79], a[164:167], v[164:167], v[76:79]
  ds_read_b64_tr_b16 a[188:189], v239 offset:0
  ds_read_b64_tr_b16 a[190:191], v239 offset:1024
  v_mfma_f32_16x16x32_bf16 v[68:71], a[164:167], v[160:163], v[68:71]
  buffer_load_dwordx4 v246, s[64:67], s34 offen offset:2048 lds
  s_waitcnt lgkmcnt(8)
  v_mfma_f32_16x16x32_bf16 v[80:83], a[168:171], v[160:163], v[80:83]
  ds_read_b64_tr_b16 a[160:161], v232 offset:8192
  v_mfma_f32_16x16x32_bf16 v[88:91], a[168:171], v[164:167], v[88:91]
  ds_read_b64_tr_b16 a[162:163], v232 offset:9216
  v_mfma_f32_16x16x32_bf16 v[92:95], a[172:175], v[164:167], v[92:95]
  ds_read_b64_tr_b16 a[164:165], v233 offset:8192
  v_mfma_f32_16x16x32_bf16 v[84:87], a[172:175], v[160:163], v[84:87]
  ds_read_b64_tr_b16 a[166:167], v233 offset:9216
  s_waitcnt lgkmcnt(8)
  v_mfma_f32_16x16x32_bf16 v[96:99], a[176:179], v[160:163], v[96:99]
  ds_read_b64_tr_b16 a[168:169], v234 offset:8192
  ds_read_b64_tr_b16 a[170:171], v234 offset:9216
  v_mfma_f32_16x16x32_bf16 v[104:107], a[176:179], v[164:167], v[104:107]
  buffer_load_dwordx4 v247, s[64:67], s34 offen offset:3072 lds
  v_mfma_f32_16x16x32_bf16 v[108:111], a[180:183], v[164:167], v[108:111]
  ds_read_b64_tr_b16 a[172:173], v235 offset:8192
  v_mfma_f32_16x16x32_bf16 v[100:103], a[180:183], v[160:163], v[100:103]
  ds_read_b64_tr_b16 a[174:175], v235 offset:9216
  s_waitcnt lgkmcnt(8)
  v_mfma_f32_16x16x32_bf16 v[112:115], a[184:187], v[160:163], v[112:115]
  ds_read_b64_tr_b16 a[176:177], v236 offset:8192
  v_mfma_f32_16x16x32_bf16 v[120:123], a[184:187], v[164:167], v[120:123]
  ds_read_b64_tr_b16 a[178:179], v236 offset:9216
  v_mfma_f32_16x16x32_bf16 v[124:127], a[188:191], v[164:167], v[124:127]
  ds_read_b64_tr_b16 a[180:181], v237 offset:8192
  v_mfma_f32_16x16x32_bf16 v[116:119], a[188:191], v[160:163], v[116:119]
  ds_read_b64_tr_b16 a[182:183], v237 offset:9216
  s_waitcnt lgkmcnt(8)
  v_mfma_f32_16x16x32_bf16 v[64:67], a[160:163], v[168:171], v[64:67]
  ds_read_b64_tr_b16 a[184:185], v238 offset:8192
  v_mfma_f32_16x16x32_bf16 v[72:75], a[160:163], v[172:175], v[72:75]
  ds_read_b64_tr_b16 a[186:187], v238 offset:9216
  v_mfma_f32_16x16x32_bf16 v[76:79], a[164:167], v[172:175], v[76:79]
  ds_read_b64_tr_b16 a[188:189], v239 offset:8192
  v_mfma_f32_16x16x32_bf16 v[68:71], a[164:167], v[168:171], v[68:71]
  ds_read_b64_tr_b16 a[190:191], v239 offset:9216
  s_waitcnt lgkmcnt(8)
  v_mfma_f32_16x16x32_bf16 v[80:83], a[168:171], v[168:171], v[80:83]
  s_waitcnt vmcnt(13)
  s_barrier
  v_mov_b32 v208, 2
  buffer_store_dword v208, v231, s[12:15], 0 offen sc1
  ds_read_b64_tr_b16 a[160:161], v200 offset:0
  v_mfma_f32_16x16x32_bf16 v[88:91], a[168:171], v[172:175], v[88:91]
  ds_read_b64_tr_b16 a[162:163], v200 offset:1024
  v_mfma_f32_16x16x32_bf16 v[92:95], a[172:175], v[172:175], v[92:95]
  ds_read_b64_tr_b16 a[164:165], v201 offset:0
  ds_read_b64_tr_b16 a[166:167], v201 offset:1024
  v_mfma_f32_16x16x32_bf16 v[84:87], a[172:175], v[168:171], v[84:87]
  s_add_u32 s34, s79, 245760
  s_add_u32 m0, s41, 114688
  s_nop 0
  buffer_load_dwordx4 v244, s[64:67], s34 offen offset:0 lds
  s_waitcnt lgkmcnt(8)
  v_mfma_f32_16x16x32_bf16 v[96:99], a[176:179], v[168:171], v[96:99]
  ds_read_b64_tr_b16 a[168:169], v202 offset:0
  v_mfma_f32_16x16x32_bf16 v[104:107], a[176:179], v[172:175], v[104:107]
  ds_read_b64_tr_b16 a[170:171], v202 offset:1024
  v_mfma_f32_16x16x32_bf16 v[108:111], a[180:183], v[172:175], v[108:111]
  ds_read_b64_tr_b16 a[172:173], v203 offset:0
  v_mfma_f32_16x16x32_bf16 v[100:103], a[180:183], v[168:171], v[100:103]
  ds_read_b64_tr_b16 a[174:175], v203 offset:1024
  s_waitcnt lgkmcnt(8)
  v_mfma_f32_16x16x32_bf16 v[112:115], a[184:187], v[168:171], v[112:115]
  ds_read_b64_tr_b16 a[176:177], v204 offset:0
  ds_read_b64_tr_b16 a[178:179], v204 offset:1024
  v_mfma_f32_16x16x32_bf16 v[120:123], a[184:187], v[172:175], v[120:123]
  buffer_load_dwordx4 v245, s[64:67], s34 offen offset:1024 lds
  v_mfma_f32_16x16x32_bf16 v[124:127], a[188:191], v[172:175], v[124:127]
  ds_read_b64_tr_b16 a[180:181], v205 offset:0
  v_mfma_f32_16x16x32_bf16 v[116:119], a[188:191], v[168:171], v[116:119]
  ds_read_b64_tr_b16 a[182:183], v205 offset:1024
  s_waitcnt lgkmcnt(8)
  v_mfma_f32_16x16x32_bf16 v[64:67], a[160:163], v[176:179], v[64:67]
  ds_read_b64_tr_b16 a[184:185], v206 offset:0
  v_mfma_f32_16x16x32_bf16 v[72:75], a[160:163], v[180:183], v[72:75]
  ds_read_b64_tr_b16 a[186:187], v206 offset:1024
  v_mfma_f32_16x16x32_bf16 v[76:79], a[164:167], v[180:183], v[76:79]
  ds_read_b64_tr_b16 a[188:189], v207 offset:0
  ds_read_b64_tr_b16 a[190:191], v207 offset:1024
  v_mfma_f32_16x16x32_bf16 v[68:71], a[164:167], v[176:179], v[68:71]
  buffer_load_dwordx4 v246, s[64:67], s34 offen offset:2048 lds
  s_waitcnt lgkmcnt(8)
  v_mfma_f32_16x16x32_bf16 v[80:83], a[168:171], v[176:179], v[80:83]
  ds_read_b64_tr_b16 a[160:161], v200 offset:8192
  v_mfma_f32_16x16x32_bf16 v[88:91], a[168:171], v[180:183], v[88:91]
  ds_read_b64_tr_b16 a[162:163], v200 offset:9216
  v_mfma_f32_16x16x32_bf16 v[92:95], a[172:175], v[180:183], v[92:95]
  ds_read_b64_tr_b16 a[164:165], v201 offset:8192
  v_mfma_f32_16x16x32_bf16 v[84:87], a[172:175], v[176:179], v[84:87]
  ds_read_b64_tr_b16 a[166:167], v201 offset:9216
  s_waitcnt lgkmcnt(8)
  v_mfma_f32_16x16x32_bf16 v[96:99], a[176:179], v[176:179], v[96:99]
  ds_read_b64_tr_b16 a[168:169], v202 offset:8192
  ds_read_b64_tr_b16 a[170:171], v202 offset:9216
  v_mfma_f32_16x16x32_bf16 v[104:107], a[176:179], v[180:183], v[104:107]
  buffer_load_dwordx4 v247, s[64:67], s34 offen offset:3072 lds
  v_mfma_f32_16x16x32_bf16 v[108:111], a[180:183], v[180:183], v[108:111]
  ds_read_b64_tr_b16 a[172:173], v203 offset:8192
  v_mfma_f32_16x16x32_bf16 v[100:103], a[180:183], v[176:179], v[100:103]
  ds_read_b64_tr_b16 a[174:175], v203 offset:9216
  s_waitcnt lgkmcnt(8)
  v_mfma_f32_16x16x32_bf16 v[112:115], a[184:187], v[176:179], v[112:115]
  ds_read_b64_tr_b16 a[176:177], v204 offset:8192
  v_mfma_f32_16x16x32_bf16 v[120:123], a[184:187], v[180:183], v[120:123]
  ds_read_b64_tr_b16 a[178:179], v204 offset:9216
  v_mfma_f32_16x16x32_bf16 v[124:127], a[188:191], v[180:183], v[124:127]
  ds_read_b64_tr_b16 a[180:181], v205 offset:8192
  v_mfma_f32_16x16x32_bf16 v[116:119], a[188:191], v[176:179], v[116:119]
  ds_read_b64_tr_b16 a[182:183], v205 offset:9216
  s_waitcnt lgkmcnt(8)
  v_mfma_f32_16x16x32_bf16 v[64:67], a[160:163], v[184:187], v[64:67]
  ds_read_b64_tr_b16 a[184:185], v206 offset:8192
  v_mfma_f32_16x16x32_bf16 v[72:75], a[160:163], v[188:191], v[72:75]
  ds_read_b64_tr_b16 a[186:187], v206 offset:9216
  v_mfma_f32_16x16x32_bf16 v[76:79], a[164:167], v[188:191], v[76:79]
  ds_read_b64_tr_b16 a[188:189], v207 offset:8192
  v_mfma_f32_16x16x32_bf16 v[68:71], a[164:167], v[184:187], v[68:71]
  ds_read_b64_tr_b16 a[190:191], v207 offset:9216
  s_waitcnt lgkmcnt(8)
  v_mfma_f32_16x16x32_bf16 v[80:83], a[168:171], v[184:187], v[80:83]
  s_waitcnt vmcnt(13)
  s_barrier
  ds_read_b64_tr_b16 a[160:161], v200 offset:16384
  v_mfma_f32_16x16x32_bf16 v[88:91], a[168:171], v[188:191], v[88:91]
  ds_read_b64_tr_b16 a[162:163], v200 offset:17408
  v_mfma_f32_16x16x32_bf16 v[92:95], a[172:175], v[188:191], v[92:95]
  ds_read_b64_tr_b16 a[164:165], v201 offset:16384
  ds_read_b64_tr_b16 a[166:167], v201 offset:17408
  v_mfma_f32_16x16x32_bf16 v[84:87], a[172:175], v[184:187], v[84:87]
  s_add_u32 s34, s79, 327680
  s_add_u32 m0, s41, 65536
  s_nop 0
  buffer_load_dwordx4 v244, s[64:67], s34 offen offset:0 lds
  s_waitcnt lgkmcnt(8)
  v_mfma_f32_16x16x32_bf16 v[96:99], a[176:179], v[184:187], v[96:99]
  ds_read_b64_tr_b16 a[168:169], v202 offset:16384
  v_mfma_f32_16x16x32_bf16 v[104:107], a[176:179], v[188:191], v[104:107]
  ds_read_b64_tr_b16 a[170:171], v202 offset:17408
  v_mfma_f32_16x16x32_bf16 v[108:111], a[180:183], v[188:191], v[108:111]
  ds_read_b64_tr_b16 a[172:173], v203 offset:16384
  v_mfma_f32_16x16x32_bf16 v[100:103], a[180:183], v[184:187], v[100:103]
  ds_read_b64_tr_b16 a[174:175], v203 offset:17408
  s_waitcnt lgkmcnt(8)
  v_mfma_f32_16x16x32_bf16 v[112:115], a[184:187], v[184:187], v[112:115]
  ds_read_b64_tr_b16 a[176:177], v204 offset:16384
  ds_read_b64_tr_b16 a[178:179], v204 offset:17408
  v_mfma_f32_16x16x32_bf16 v[120:123], a[184:187], v[188:191], v[120:123]
  buffer_load_dwordx4 v245, s[64:67], s34 offen offset:1024 lds
  v_mfma_f32_16x16x32_bf16 v[124:127], a[188:191], v[188:191], v[124:127]
  ds_read_b64_tr_b16 a[180:181], v205 offset:16384
  v_mfma_f32_16x16x32_bf16 v[116:119], a[188:191], v[184:187], v[116:119]
  ds_read_b64_tr_b16 a[182:183], v205 offset:17408
  s_waitcnt lgkmcnt(8)
  v_mfma_f32_16x16x32_bf16 a[192:195], a[160:163], a[32:35], 0
  ds_read_b64_tr_b16 a[184:185], v206 offset:16384
  v_mfma_f32_16x16x32_bf16 a[200:203], a[160:163], a[36:39], 0
  ds_read_b64_tr_b16 a[186:187], v206 offset:17408
  v_mfma_f32_16x16x32_bf16 a[204:207], a[164:167], a[36:39], 0
  ds_read_b64_tr_b16 a[188:189], v207 offset:16384
  ds_read_b64_tr_b16 a[190:191], v207 offset:17408
  v_mfma_f32_16x16x32_bf16 a[196:199], a[164:167], a[32:35], 0
  buffer_load_dwordx4 v246, s[64:67], s34 offen offset:2048 lds
  s_waitcnt lgkmcnt(8)
  v_mfma_f32_16x16x32_bf16 a[208:211], a[168:171], a[32:35], 0
  ds_read_b64_tr_b16 a[160:161], v200 offset:24576
  s_mov_b32 s46, 16384
  v_cvt_pk_bf16_f32 v64, v64, v65
  v_mfma_f32_16x16x32_bf16 a[216:219], a[168:171], a[36:39], 0
  ds_read_b64_tr_b16 a[162:163], v200 offset:25600
  v_cvt_pk_bf16_f32 v65, v66, v67
  v_mfma_f32_16x16x32_bf16 a[220:223], a[172:175], a[36:39], 0
  ds_read_b64_tr_b16 a[164:165], v201 offset:24576
  v_cvt_pk_bf16_f32 v66, v68, v69
  v_cvt_pk_bf16_f32 v67, v70, v71
  v_mfma_f32_16x16x32_bf16 a[212:215], a[172:175], a[32:35], 0
  ds_read_b64_tr_b16 a[166:167], v201 offset:25600
  s_waitcnt lgkmcnt(8)
  v_mfma_f32_16x16x32_bf16 a[224:227], a[176:179], a[32:35], 0
  ds_read_b64_tr_b16 a[168:169], v202 offset:24576
  ds_read_b64_tr_b16 a[170:171], v202 offset:25600
  v_mfma_f32_16x16x32_bf16 a[232:235], a[176:179], a[36:39], 0
  buffer_load_dwordx4 v247, s[64:67], s34 offen offset:3072 lds
  v_mfma_f32_16x16x32_bf16 a[236:239], a[180:183], a[36:39], 0
  ds_read_b64_tr_b16 a[172:173], v203 offset:24576
  buffer_store_dwordx4 v[64:67], v252, s[28:31], s46 offen offset:0 sc1
  v_mfma_f32_16x16x32_bf16 a[228:231], a[180:183], a[32:35], 0
  ds_read_b64_tr_b16 a[174:175], v203 offset:25600
  v_cvt_pk_bf16_f32 v72, v72, v73
  s_waitcnt lgkmcnt(8)
  v_mfma_f32_16x16x32_bf16 a[240:243], a[184:187], a[32:35], 0
  ds_read_b64_tr_b16 a[176:177], v204 offset:24576
  v_cvt_pk_bf16_f32 v73, v74, v75
  v_cvt_pk_bf16_f32 v74, v76, v77
  v_mfma_f32_16x16x32_bf16 a[248:251], a[184:187], a[36:39], 0
  ds_read_b64_tr_b16 a[178:179], v204 offset:25600
  v_cvt_pk_bf16_f32 v75, v78, v79
  v_mfma_f32_16x16x32_bf16 a[252:255], a[188:191], a[36:39], 0
  ds_read_b64_tr_b16 a[180:181], v205 offset:24576
  buffer_store_dwordx4 v[72:75], v252, s[28:31], s46 offen offset:1024 sc1
  v_mfma_f32_16x16x32_bf16 a[244:247], a[188:191], a[32:35], 0
  ds_read_b64_tr_b16 a[182:183], v205 offset:25600
  s_waitcnt lgkmcnt(8)
  v_mfma_f32_16x16x32_bf16 a[192:195], a[160:163], a[40:43], a[192:195]
  ds_read_b64_tr_b16 a[184:185], v206 offset:24576
  v_cvt_pk_bf16_f32 v80, v80, v81
  v_cvt_pk_bf16_f32 v81, v82, v83
  v_mfma_f32_16x16x32_bf16 a[200:203], a[160:163], a[44:47], a[200:203]
  ds_read_b64_tr_b16 a[186:187], v206 offset:25600
  v_cvt_pk_bf16_f32 v82, v84, v85
  v_mfma_f32_16x16x32_bf16 a[204:207], a[164:167], a[44:47], a[204:207]
  ds_read_b64_tr_b16 a[188:189], v207 offset:24576
  v_cvt_pk_bf16_f32 v83, v86, v87
  buffer_store_dwordx4 v[80:83], v252, s[28:31], s46 offen offset:2048 sc1
  v_mfma_f32_16x16x32_bf16 a[196:199], a[164:167], a[40:43], a[196:199]
  ds_read_b64_tr_b16 a[190:191], v207 offset:25600
  s_waitcnt lgkmcnt(8)
  v_mfma_f32_16x16x32_bf16 a[208:211], a[168:171], a[40:43], a[208:211]
  s_waitcnt vmcnt(16)
  s_barrier
  ds_read_b64_tr_b16 a[160:161], v232 offset:16384
  v_mfma_f32_16x16x32_bf16 a[216:219], a[168:171], a[44:47], a[216:219]
  ds_read_b64_tr_b16 a[162:163], v232 offset:17408
  v_mfma_f32_16x16x32_bf16 a[220:223], a[172:175], a[44:47], a[220:223]
  ds_read_b64_tr_b16 a[164:165], v233 offset:16384
  ds_read_b64_tr_b16 a[166:167], v233 offset:17408
  v_mfma_f32_16x16x32_bf16 a[212:215], a[172:175], a[40:43], a[212:215]
  s_add_u32 s34, s79, 409600
  s_add_u32 m0, s41, 131072
  s_nop 0
  buffer_load_dwordx4 v244, s[64:67], s34 offen offset:0 lds
  s_waitcnt lgkmcnt(8)
  v_mfma_f32_16x16x32_bf16 a[224:227], a[176:179], a[40:43], a[224:227]
  ds_read_b64_tr_b16 a[168:169], v234 offset:16384
  v_cvt_pk_bf16_f32 v88, v88, v89
  v_cvt_pk_bf16_f32 v89, v90, v91
  v_mfma_f32_16x16x32_bf16 a[232:235], a[176:179], a[44:47], a[232:235]
  ds_read_b64_tr_b16 a[170:171], v234 offset:17408
  v_mfma_f32_16x16x32_bf16 a[236:239], a[180:183], a[44:47], a[236:239]
  ds_read_b64_tr_b16 a[172:173], v235 offset:16384
  v_cvt_pk_bf16_f32 v90, v92, v93
  v_cvt_pk_bf16_f32 v91, v94, v95
  v_mfma_f32_16x16x32_bf16 a[228:231], a[180:183], a[40:43], a[228:231]
  ds_read_b64_tr_b16 a[174:175], v235 offset:17408
  s_waitcnt lgkmcnt(8)
  v_mfma_f32_16x16x32_bf16 a[240:243], a[184:187], a[40:43], a[240:243]
  ds_read_b64_tr_b16 a[176:177], v236 offset:16384
  ds_read_b64_tr_b16 a[178:179], v236 offset:17408
  v_mfma_f32_16x16x32_bf16 a[248:251], a[184:187], a[44:47], a[248:251]
  buffer_load_dwordx4 v245, s[64:67], s34 offen offset:1024 lds
  v_mfma_f32_16x16x32_bf16 a[252:255], a[188:191], a[44:47], a[252:255]
  ds_read_b64_tr_b16 a[180:181], v237 offset:16384
  buffer_store_dwordx4 v[88:91], v252, s[28:31], s46 offen offset:3072 sc1
  v_mfma_f32_16x16x32_bf16 a[244:247], a[188:191], a[40:43], a[244:247]
  ds_read_b64_tr_b16 a[182:183], v237 offset:17408
  s_mov_b32 s46, 20480
  s_waitcnt lgkmcnt(8)
  v_mfma_f32_16x16x32_bf16 a[192:195], a[160:163], a[48:51], a[192:195]
  ds_read_b64_tr_b16 a[184:185], v238 offset:16384
  v_cvt_pk_bf16_f32 v96, v96, v97
  v_cvt_pk_bf16_f32 v97, v98, v99
  v_mfma_f32_16x16x32_bf16 a[200:203], a[160:163], a[52:55], a[200:203]
  ds_read_b64_tr_b16 a[186:187], v238 offset:17408
  v_cvt_pk_bf16_f32 v98, v100, v101
  v_mfma_f32_16x16x32_bf16 a[204:207], a[164:167], a[52:55], a[204:207]
  ds_read_b64_tr_b16 a[188:189], v239 offset:16384
  ds_read_b64_tr_b16 a[190:191], v239 offset:17408
  v_mfma_f32_16x16x32_bf16 a[196:199], a[164:167], a[48:51], a[196:199]
  buffer_load_dwordx4 v246, s[64:67], s34 offen offset:2048 lds
  s_waitcnt lgkmcnt(8)
  v_mfma_f32_16x16x32_bf16 a[208:211], a[168:171], a[48:51], a[208:211]
  ds_read_b64_tr_b16 a[160:161], v232 offset:24576
  v_cvt_pk_bf16_f32 v99, v102, v103
  buffer_store_dwordx4 v[96:99], v252, s[28:31], s46 offen offset:0 sc1
  v_mfma_f32_16x16x32_bf16 a[216:219], a[168:171], a[52:55], a[216:219]
  ds_read_b64_tr_b16 a[162:163], v232 offset:25600
  v_mfma_f32_16x16x32_bf16 a[220:223], a[172:175], a[52:55], a[220:223]
  ds_read_b64_tr_b16 a[164:165], v233 offset:24576
  v_cvt_pk_bf16_f32 v104, v104, v105
  v_cvt_pk_bf16_f32 v105, v106, v107
  v_mfma_f32_16x16x32_bf16 a[212:215], a[172:175], a[48:51], a[212:215]
  ds_read_b64_tr_b16 a[166:167], v233 offset:25600
  s_waitcnt lgkmcnt(8)
  v_mfma_f32_16x16x32_bf16 a[224:227], a[176:179], a[48:51], a[224:227]
  ds_read_b64_tr_b16 a[168:169], v234 offset:24576
  ds_read_b64_tr_b16 a[170:171], v234 offset:25600
  v_mfma_f32_16x16x32_bf16 a[232:235], a[176:179], a[52:55], a[232:235]
  buffer_load_dwordx4 v247, s[64:67], s34 offen offset:3072 lds
  v_mfma_f32_16x16x32_bf16 a[236:239], a[180:183], a[52:55], a[236:239]
  ds_read_b64_tr_b16 a[172:173], v235 offset:24576
  v_cvt_pk_bf16_f32 v106, v108, v109
  v_cvt_pk_bf16_f32 v107, v110, v111
  v_mfma_f32_16x16x32_bf16 a[228:231], a[180:183], a[48:51], a[228:231]
  ds_read_b64_tr_b16 a[174:175], v235 offset:25600
  s_waitcnt lgkmcnt(8)
  v_mfma_f32_16x16x32_bf16 a[240:243], a[184:187], a[48:51], a[240:243]
  ds_read_b64_tr_b16 a[176:177], v236 offset:24576
  buffer_store_dwordx4 v[104:107], v252, s[28:31], s46 offen offset:1024 sc1
  v_mfma_f32_16x16x32_bf16 a[248:251], a[184:187], a[52:55], a[248:251]
  ds_read_b64_tr_b16 a[178:179], v236 offset:25600
  v_cvt_pk_bf16_f32 v112, v112, v113
  v_mfma_f32_16x16x32_bf16 a[252:255], a[188:191], a[52:55], a[252:255]
  ds_read_b64_tr_b16 a[180:181], v237 offset:24576
  v_cvt_pk_bf16_f32 v113, v114, v115
  v_cvt_pk_bf16_f32 v114, v116, v117
  v_mfma_f32_16x16x32_bf16 a[244:247], a[188:191], a[48:51], a[244:247]
  ds_read_b64_tr_b16 a[182:183], v237 offset:25600
  s_waitcnt lgkmcnt(8)
  v_mfma_f32_16x16x32_bf16 a[192:195], a[160:163], a[56:59], a[192:195]
  ds_read_b64_tr_b16 a[184:185], v238 offset:24576
  v_cvt_pk_bf16_f32 v115, v118, v119
  buffer_store_dwordx4 v[112:115], v252, s[28:31], s46 offen offset:2048 sc1
  v_mfma_f32_16x16x32_bf16 a[200:203], a[160:163], a[60:63], a[200:203]
  ds_read_b64_tr_b16 a[186:187], v238 offset:25600
  v_mfma_f32_16x16x32_bf16 a[204:207], a[164:167], a[60:63], a[204:207]
  ds_read_b64_tr_b16 a[188:189], v239 offset:24576
  v_cvt_pk_bf16_f32 v120, v120, v121
  v_cvt_pk_bf16_f32 v121, v122, v123
  v_mfma_f32_16x16x32_bf16 a[196:199], a[164:167], a[56:59], a[196:199]
  ds_read_b64_tr_b16 a[190:191], v239 offset:25600
  s_waitcnt lgkmcnt(8)
  v_mfma_f32_16x16x32_bf16 a[208:211], a[168:171], a[56:59], a[208:211]
  s_waitcnt vmcnt(20)
  s_barrier
  ds_read_b64_tr_b16 a[160:161], v232 offset:32768
  v_mfma_f32_16x16x32_bf16 a[216:219], a[168:171], a[60:63], a[216:219]
  ds_read_b64_tr_b16 a[162:163], v232 offset:33792
  v_cvt_pk_bf16_f32 v122, v124, v125
  v_mfma_f32_16x16x32_bf16 a[220:223], a[172:175], a[60:63], a[220:223]
  ds_read_b64_tr_b16 a[164:165], v233 offset:32768
  ds_read_b64_tr_b16 a[166:167], v233 offset:33792
  v_mfma_f32_16x16x32_bf16 a[212:215], a[172:175], a[56:59], a[212:215]
  s_add_u32 s34, s79, 491520
  s_add_u32 m0, s41, 147456
  s_nop 0
  buffer_load_dwordx4 v244, s[64:67], s34 offen offset:0 lds
  s_waitcnt lgkmcnt(8)
  v_mfma_f32_16x16x32_bf16 a[224:227], a[176:179], a[56:59], a[224:227]
  ds_read_b64_tr_b16 a[168:169], v234 offset:32768
  v_cvt_pk_bf16_f32 v123, v126, v127
  buffer_store_dwordx4 v[120:123], v252, s[28:31], s46 offen offset:3072 sc1
  v_mfma_f32_16x16x32_bf16 a[232:235], a[176:179], a[60:63], a[232:235]
  ds_read_b64_tr_b16 a[170:171], v234 offset:33792
  v_mfma_f32_16x16x32_bf16 a[236:239], a[180:183], a[60:63], a[236:239]
  ds_read_b64_tr_b16 a[172:173], v235 offset:32768
  v_mfma_f32_16x16x32_bf16 a[228:231], a[180:183], a[56:59], a[228:231]
  ds_read_b64_tr_b16 a[174:175], v235 offset:33792
  s_waitcnt lgkmcnt(8)
  v_mfma_f32_16x16x32_bf16 a[240:243], a[184:187], a[56:59], a[240:243]
  ds_read_b64_tr_b16 a[176:177], v236 offset:32768
  ds_read_b64_tr_b16 a[178:179], v236 offset:33792
  v_mfma_f32_16x16x32_bf16 a[248:251], a[184:187], a[60:63], a[248:251]
  buffer_load_dwordx4 v245, s[64:67], s34 offen offset:1024 lds
  v_mfma_f32_16x16x32_bf16 a[252:255], a[188:191], a[60:63], a[252:255]
  ds_read_b64_tr_b16 a[180:181], v237 offset:32768
  v_mfma_f32_16x16x32_bf16 a[244:247], a[188:191], a[56:59], a[244:247]
  ds_read_b64_tr_b16 a[182:183], v237 offset:33792
  s_waitcnt lgkmcnt(8)
  v_mfma_f32_16x16x32_bf16 a[192:195], a[160:163], a[0:3], a[192:195]
  ds_read_b64_tr_b16 a[184:185], v238 offset:32768
  v_mfma_f32_16x16x32_bf16 a[200:203], a[160:163], a[4:7], a[200:203]
  ds_read_b64_tr_b16 a[186:187], v238 offset:33792
  v_mfma_f32_16x16x32_bf16 a[204:207], a[164:167], a[4:7], a[204:207]
  ds_read_b64_tr_b16 a[188:189], v239 offset:32768
  ds_read_b64_tr_b16 a[190:191], v239 offset:33792
  v_mfma_f32_16x16x32_bf16 a[196:199], a[164:167], a[0:3], a[196:199]
  buffer_load_dwordx4 v246, s[64:67], s34 offen offset:2048 lds
  s_waitcnt lgkmcnt(8)
  v_mfma_f32_16x16x32_bf16 a[208:211], a[168:171], a[0:3], a[208:211]
  ds_read_b64_tr_b16 a[160:161], v232 offset:40960
  v_mfma_f32_16x16x32_bf16 a[216:219], a[168:171], a[4:7], a[216:219]
  ds_read_b64_tr_b16 a[162:163], v232 offset:41984
  v_mfma_f32_16x16x32_bf16 a[220:223], a[172:175], a[4:7], a[220:223]
  ds_read_b64_tr_b16 a[164:165], v233 offset:40960
  v_mfma_f32_16x16x32_bf16 a[212:215], a[172:175], a[0:3], a[212:215]
  ds_read_b64_tr_b16 a[166:167], v233 offset:41984
  s_waitcnt lgkmcnt(8)
  v_mfma_f32_16x16x32_bf16 a[224:227], a[176:179], a[0:3], a[224:227]
  ds_read_b64_tr_b16 a[168:169], v234 offset:40960
  ds_read_b64_tr_b16 a[170:171], v234 offset:41984
  v_mfma_f32_16x16x32_bf16 a[232:235], a[176:179], a[4:7], a[232:235]
  buffer_load_dwordx4 v247, s[64:67], s34 offen offset:3072 lds
  v_mfma_f32_16x16x32_bf16 a[236:239], a[180:183], a[4:7], a[236:239]
  ds_read_b64_tr_b16 a[172:173], v235 offset:40960
  v_mfma_f32_16x16x32_bf16 a[228:231], a[180:183], a[0:3], a[228:231]
  ds_read_b64_tr_b16 a[174:175], v235 offset:41984
  s_waitcnt lgkmcnt(8)
  v_mfma_f32_16x16x32_bf16 a[240:243], a[184:187], a[0:3], a[240:243]
  ds_read_b64_tr_b16 a[176:177], v236 offset:40960
  v_mfma_f32_16x16x32_bf16 a[248:251], a[184:187], a[4:7], a[248:251]
  ds_read_b64_tr_b16 a[178:179], v236 offset:41984
  v_mfma_f32_16x16x32_bf16 a[252:255], a[188:191], a[4:7], a[252:255]
  ds_read_b64_tr_b16 a[180:181], v237 offset:40960
  v_mfma_f32_16x16x32_bf16 a[244:247], a[188:191], a[0:3], a[244:247]
  ds_read_b64_tr_b16 a[182:183], v237 offset:41984
  s_waitcnt lgkmcnt(8)
  v_mfma_f32_16x16x32_bf16 a[192:195], a[160:163], a[8:11], a[192:195]
  ds_read_b64_tr_b16 a[184:185], v238 offset:40960
  v_mfma_f32_16x16x32_bf16 a[200:203], a[160:163], a[12:15], a[200:203]
  ds_read_b64_tr_b16 a[186:187], v238 offset:41984
  v_mfma_f32_16x16x32_bf16 a[204:207], a[164:167], a[12:15], a[204:207]
  ds_read_b64_tr_b16 a[188:189], v239 offset:40960
  v_mfma_f32_16x16x32_bf16 a[196:199], a[164:167], a[8:11], a[196:199]
  ds_read_b64_tr_b16 a[190:191], v239 offset:41984
  s_waitcnt lgkmcnt(8)
  v_mfma_f32_16x16x32_bf16 a[208:211], a[168:171], a[8:11], a[208:211]
  s_waitcnt vmcnt(20)
  s_barrier
  ds_read_b64_tr_b16 a[160:161], v232 offset:49152
  v_mfma_f32_16x16x32_bf16 a[216:219], a[168:171], a[12:15], a[216:219]
  ds_read_b64_tr_b16 a[162:163], v232 offset:50176
  v_mfma_f32_16x16x32_bf16 a[220:223], a[172:175], a[12:15], a[220:223]
  ds_read_b64_tr_b16 a[164:165], v233 offset:49152
  ds_read_b64_tr_b16 a[166:167], v233 offset:50176
  v_mfma_f32_16x16x32_bf16 a[212:215], a[172:175], a[8:11], a[212:215]
  s_add_u32 s34, s79, 573440
  s_add_u32 m0, s41, 81920
  s_nop 0
  buffer_load_dwordx4 v244, s[64:67], s34 offen offset:0 lds
  s_waitcnt lgkmcnt(8)
  v_mfma_f32_16x16x32_bf16 a[224:227], a[176:179], a[8:11], a[224:227]
  ds_read_b64_tr_b16 a[168:169], v234 offset:49152
  v_mfma_f32_16x16x32_bf16 a[232:235], a[176:179], a[12:15], a[232:235]
  ds_read_b64_tr_b16 a[170:171], v234 offset:50176
  v_mfma_f32_16x16x32_bf16 a[236:239], a[180:183], a[12:15], a[236:239]
  ds_read_b64_tr_b16 a[172:173], v235 offset:49152
  v_mfma_f32_16x16x32_bf16 a[228:231], a[180:183], a[8:11], a[228:231]
  ds_read_b64_tr_b16 a[174:175], v235 offset:50176
  s_waitcnt lgkmcnt(8)
  v_mfma_f32_16x16x32_bf16 a[240:243], a[184:187], a[8:11], a[240:243]
  ds_read_b64_tr_b16 a[176:177], v236 offset:49152
  ds_read_b64_tr_b16 a[178:179], v236 offset:50176
  v_mfma_f32_16x16x32_bf16 a[248:251], a[184:187], a[12:15], a[248:251]
  buffer_load_dwordx4 v245, s[64:67], s34 offen offset:1024 lds
  v_mfma_f32_16x16x32_bf16 a[252:255], a[188:191], a[12:15], a[252:255]
  ds_read_b64_tr_b16 a[180:181], v237 offset:49152
  v_mfma_f32_16x16x32_bf16 a[244:247], a[188:191], a[8:11], a[244:247]
  ds_read_b64_tr_b16 a[182:183], v237 offset:50176
  s_waitcnt lgkmcnt(8)
  v_mfma_f32_16x16x32_bf16 a[192:195], a[160:163], a[16:19], a[192:195]
  ds_read_b64_tr_b16 a[184:185], v238 offset:49152
  v_mfma_f32_16x16x32_bf16 a[200:203], a[160:163], a[20:23], a[200:203]
  ds_read_b64_tr_b16 a[186:187], v238 offset:50176
  v_mfma_f32_16x16x32_bf16 a[204:207], a[164:167], a[20:23], a[204:207]
  ds_read_b64_tr_b16 a[188:189], v239 offset:49152
  ds_read_b64_tr_b16 a[190:191], v239 offset:50176
  v_mfma_f32_16x16x32_bf16 a[196:199], a[164:167], a[16:19], a[196:199]
  buffer_load_dwordx4 v246, s[64:67], s34 offen offset:2048 lds
  s_waitcnt lgkmcnt(8)
  v_mfma_f32_16x16x32_bf16 a[208:211], a[168:171], a[16:19], a[208:211]
  ds_read_b64_tr_b16 a[160:161], v232 offset:57344
  v_mfma_f32_16x16x32_bf16 a[216:219], a[168:171], a[20:23], a[216:219]
  ds_read_b64_tr_b16 a[162:163], v232 offset:58368
  v_mfma_f32_16x16x32_bf16 a[220:223], a[172:175], a[20:23], a[220:223]
  ds_read_b64_tr_b16 a[164:165], v233 offset:57344
  v_mfma_f32_16x16x32_bf16 a[212:215], a[172:175], a[16:19], a[212:215]
  ds_read_b64_tr_b16 a[166:167], v233 offset:58368
  s_waitcnt lgkmcnt(8)
  v_mfma_f32_16x16x32_bf16 a[224:227], a[176:179], a[16:19], a[224:227]
  ds_read_b64_tr_b16 a[168:169], v234 offset:57344
  ds_read_b64_tr_b16 a[170:171], v234 offset:58368
  v_mfma_f32_16x16x32_bf16 a[232:235], a[176:179], a[20:23], a[232:235]
  buffer_load_dwordx4 v247, s[64:67], s34 offen offset:3072 lds
  v_mfma_f32_16x16x32_bf16 a[236:239], a[180:183], a[20:23], a[236:239]
  ds_read_b64_tr_b16 a[172:173], v235 offset:57344
  v_mfma_f32_16x16x32_bf16 a[228:231], a[180:183], a[16:19], a[228:231]
  ds_read_b64_tr_b16 a[174:175], v235 offset:58368
  s_waitcnt lgkmcnt(8)
  v_mfma_f32_16x16x32_bf16 a[240:243], a[184:187], a[16:19], a[240:243]
  ds_read_b64_tr_b16 a[176:177], v236 offset:57344
  v_mfma_f32_16x16x32_bf16 a[248:251], a[184:187], a[20:23], a[248:251]
  ds_read_b64_tr_b16 a[178:179], v236 offset:58368
  v_mfma_f32_16x16x32_bf16 a[252:255], a[188:191], a[20:23], a[252:255]
  ds_read_b64_tr_b16 a[180:181], v237 offset:57344
  v_mfma_f32_16x16x32_bf16 a[244:247], a[188:191], a[16:19], a[244:247]
  ds_read_b64_tr_b16 a[182:183], v237 offset:58368
  s_waitcnt lgkmcnt(8)
  v_mfma_f32_16x16x32_bf16 a[192:195], a[160:163], a[24:27], a[192:195]
  ds_read_b64_tr_b16 a[184:185], v238 offset:57344
  v_mfma_f32_16x16x32_bf16 a[200:203], a[160:163], a[28:31], a[200:203]
  ds_read_b64_tr_b16 a[186:187], v238 offset:58368
  v_mfma_f32_16x16x32_bf16 a[204:207], a[164:167], a[28:31], a[204:207]
  ds_read_b64_tr_b16 a[188:189], v239 offset:57344
  v_mfma_f32_16x16x32_bf16 a[196:199], a[164:167], a[24:27], a[196:199]
  ds_read_b64_tr_b16 a[190:191], v239 offset:58368
  s_waitcnt lgkmcnt(8)
  v_mfma_f32_16x16x32_bf16 a[208:211], a[168:171], a[24:27], a[208:211]
  s_waitcnt vmcnt(20)
  s_barrier
  ds_read_b64_tr_b16 a[160:161], v232 offset:0
  v_mfma_f32_16x16x32_bf16 a[216:219], a[168:171], a[28:31], a[216:219]
  ds_read_b64_tr_b16 a[162:163], v232 offset:1024
  v_mfma_f32_16x16x32_bf16 a[220:223], a[172:175], a[28:31], a[220:223]
  ds_read_b64_tr_b16 a[164:165], v233 offset:0
  ds_read_b64_tr_b16 a[166:167], v233 offset:1024
  v_mfma_f32_16x16x32_bf16 a[212:215], a[172:175], a[24:27], a[212:215]
  s_add_u32 s34, s80, 0
  s_add_u32 m0, s41, 98304
  s_nop 0
  buffer_load_dwordx4 v244, s[64:67], s34 offen offset:0 lds
  s_waitcnt lgkmcnt(8)
  v_mfma_f32_16x16x32_bf16 a[224:227], a[176:179], a[24:27], a[224:227]
  ds_read_b64_tr_b16 a[168:169], v234 offset:0
  v_mfma_f32_16x16x32_bf16 a[232:235], a[176:179], a[28:31], a[232:235]
  ds_read_b64_tr_b16 a[170:171], v234 offset:1024
  v_mfma_f32_16x16x32_bf16 a[236:239], a[180:183], a[28:31], a[236:239]
  ds_read_b64_tr_b16 a[172:173], v235 offset:0
  v_mfma_f32_16x16x32_bf16 a[228:231], a[180:183], a[24:27], a[228:231]
  ds_read_b64_tr_b16 a[174:175], v235 offset:1024
  s_waitcnt lgkmcnt(8)
  v_mfma_f32_16x16x32_bf16 a[240:243], a[184:187], a[24:27], a[240:243]
  ds_read_b64_tr_b16 a[176:177], v236 offset:0
  ds_read_b64_tr_b16 a[178:179], v236 offset:1024
  v_mfma_f32_16x16x32_bf16 a[248:251], a[184:187], a[28:31], a[248:251]
  buffer_load_dwordx4 v245, s[64:67], s34 offen offset:1024 lds
  v_mfma_f32_16x16x32_bf16 a[252:255], a[188:191], a[28:31], a[252:255]
  ds_read_b64_tr_b16 a[180:181], v237 offset:0
  v_mfma_f32_16x16x32_bf16 a[244:247], a[188:191], a[24:27], a[244:247]
  ds_read_b64_tr_b16 a[182:183], v237 offset:1024
  s_waitcnt lgkmcnt(8)
  v_mfma_f32_16x16x32_bf16 a[192:195], a[160:163], a[128:131], a[192:195]
  ds_read_b64_tr_b16 a[184:185], v238 offset:0
  buffer_load_dword v210, v230, s[24:27], 0 offen sc1
  v_mfma_f32_16x16x32_bf16 a[200:203], a[160:163], a[132:135], a[200:203]
  ds_read_b64_tr_b16 a[186:187], v238 offset:1024
  v_mfma_f32_16x16x32_bf16 a[204:207], a[164:167], a[132:135], a[204:207]
  ds_read_b64_tr_b16 a[188:189], v239 offset:0
  ds_read_b64_tr_b16 a[190:191], v239 offset:1024
  v_mfma_f32_16x16x32_bf16 a[196:199], a[164:167], a[128:131], a[196:199]
  buffer_load_dwordx4 v246, s[64:67], s34 offen offset:2048 lds
  s_waitcnt lgkmcnt(8)
  v_mfma_f32_16x16x32_bf16 a[208:211], a[168:171], a[128:131], a[208:211]
  ds_read_b64_tr_b16 a[160:161], v232 offset:8192
  v_mfma_f32_16x16x32_bf16 a[216:219], a[168:171], a[132:135], a[216:219]
  ds_read_b64_tr_b16 a[162:163], v232 offset:9216
  v_mfma_f32_16x16x32_bf16 a[220:223], a[172:175], a[132:135], a[220:223]
  ds_read_b64_tr_b16 a[164:165], v233 offset:8192
  v_mfma_f32_16x16x32_bf16 a[212:215], a[172:175], a[128:131], a[212:215]
  ds_read_b64_tr_b16 a[166:167], v233 offset:9216
  s_waitcnt lgkmcnt(8)
  v_mfma_f32_16x16x32_bf16 a[224:227], a[176:179], a[128:131], a[224:227]
  ds_read_b64_tr_b16 a[168:169], v234 offset:8192
  ds_read_b64_tr_b16 a[170:171], v234 offset:9216
  v_mfma_f32_16x16x32_bf16 a[232:235], a[176:179], a[132:135], a[232:235]
  buffer_load_dwordx4 v247, s[64:67], s34 offen offset:3072 lds
  v_mfma_f32_16x16x32_bf16 a[236:239], a[180:183], a[132:135], a[236:239]
  ds_read_b64_tr_b16 a[172:173], v235 offset:8192
  v_mfma_f32_16x16x32_bf16 a[228:231], a[180:183], a[128:131], a[228:231]
  ds_read_b64_tr_b16 a[174:175], v235 offset:9216
  s_waitcnt lgkmcnt(8)
  v_mfma_f32_16x16x32_bf16 a[240:243], a[184:187], a[128:131], a[240:243]
  ds_read_b64_tr_b16 a[176:177], v236 offset:8192
  v_mfma_f32_16x16x32_bf16 a[248:251], a[184:187], a[132:135], a[248:251]
  ds_read_b64_tr_b16 a[178:179], v236 offset:9216
  v_mfma_f32_16x16x32_bf16 a[252:255], a[188:191], a[132:135], a[252:255]
  ds_read_b64_tr_b16 a[180:181], v237 offset:8192
  v_mfma_f32_16x16x32_bf16 a[244:247], a[188:191], a[128:131], a[244:247]
  ds_read_b64_tr_b16 a[182:183], v237 offset:9216
  s_waitcnt lgkmcnt(8)
  v_mfma_f32_16x16x32_bf16 a[192:195], a[160:163], a[136:139], a[192:195]
  ds_read_b64_tr_b16 a[184:185], v238 offset:8192
  v_mfma_f32_16x16x32_bf16 a[200:203], a[160:163], a[140:143], a[200:203]
  ds_read_b64_tr_b16 a[186:187], v238 offset:9216
  v_mfma_f32_16x16x32_bf16 a[204:207], a[164:167], a[140:143], a[204:207]
  ds_read_b64_tr_b16 a[188:189], v239 offset:8192
  v_mfma_f32_16x16x32_bf16 a[196:199], a[164:167], a[136:139], a[196:199]
  ds_read_b64_tr_b16 a[190:191], v239 offset:9216
  s_waitcnt lgkmcnt(8)
  v_mfma_f32_16x16x32_bf16 a[208:211], a[168:171], a[136:139], a[208:211]
  s_waitcnt vmcnt(16)
  s_barrier
  ds_read_b64_tr_b16 a[160:161], v200 offset:0
  v_mfma_f32_16x16x32_bf16 a[216:219], a[168:171], a[140:143], a[216:219]
  ds_read_b64_tr_b16 a[162:163], v200 offset:1024
  v_mfma_f32_16x16x32_bf16 a[220:223], a[172:175], a[140:143], a[220:223]
  ds_read_b64_tr_b16 a[164:165], v201 offset:0
  ds_read_b64_tr_b16 a[166:167], v201 offset:1024
  v_mfma_f32_16x16x32_bf16 a[212:215], a[172:175], a[136:139], a[212:215]
  s_add_u32 s34, s80, 81920
  s_add_u32 m0, s41, 114688
  s_nop 0
  buffer_load_dwordx4 v244, s[64:67], s34 offen offset:0 lds
  s_waitcnt lgkmcnt(8)
  v_mfma_f32_16x16x32_bf16 a[224:227], a[176:179], a[136:139], a[224:227]
  ds_read_b64_tr_b16 a[168:169], v202 offset:0
  v_mfma_f32_16x16x32_bf16 a[232:235], a[176:179], a[140:143], a[232:235]
  ds_read_b64_tr_b16 a[170:171], v202 offset:1024
  v_mfma_f32_16x16x32_bf16 a[236:239], a[180:183], a[140:143], a[236:239]
  ds_read_b64_tr_b16 a[172:173], v203 offset:0
  v_mfma_f32_16x16x32_bf16 a[228:231], a[180:183], a[136:139], a[228:231]
  ds_read_b64_tr_b16 a[174:175], v203 offset:1024
  s_waitcnt lgkmcnt(8)
  v_mfma_f32_16x16x32_bf16 a[240:243], a[184:187], a[136:139], a[240:243]
  ds_read_b64_tr_b16 a[176:177], v204 offset:0
  ds_read_b64_tr_b16 a[178:179], v204 offset:1024
  v_mfma_f32_16x16x32_bf16 a[248:251], a[184:187], a[140:143], a[248:251]
  buffer_load_dwordx4 v245, s[64:67], s34 offen offset:1024 lds
  v_mfma_f32_16x16x32_bf16 a[252:255], a[188:191], a[140:143], a[252:255]
  ds_read_b64_tr_b16 a[180:181], v205 offset:0
  v_mfma_f32_16x16x32_bf16 a[244:247], a[188:191], a[136:139], a[244:247]
  ds_read_b64_tr_b16 a[182:183], v205 offset:1024
  s_waitcnt lgkmcnt(8)
  v_mfma_f32_16x16x32_bf16 a[192:195], a[160:163], a[144:147], a[192:195]
  ds_read_b64_tr_b16 a[184:185], v206 offset:0
  v_mfma_f32_16x16x32_bf16 a[200:203], a[160:163], a[148:151], a[200:203]
  ds_read_b64_tr_b16 a[186:187], v206 offset:1024
  v_mfma_f32_16x16x32_bf16 a[204:207], a[164:167], a[148:151], a[204:207]
  ds_read_b64_tr_b16 a[188:189], v207 offset:0
  ds_read_b64_tr_b16 a[190:191], v207 offset:1024
  v_mfma_f32_16x16x32_bf16 a[196:199], a[164:167], a[144:147], a[196:199]
  buffer_load_dwordx4 v246, s[64:67], s34 offen offset:2048 lds
  s_waitcnt lgkmcnt(8)
  v_mfma_f32_16x16x32_bf16 a[208:211], a[168:171], a[144:147], a[208:211]
  ds_read_b64_tr_b16 a[160:161], v200 offset:8192
  v_mfma_f32_16x16x32_bf16 a[216:219], a[168:171], a[148:151], a[216:219]
  ds_read_b64_tr_b16 a[162:163], v200 offset:9216
  v_mfma_f32_16x16x32_bf16 a[220:223], a[172:175], a[148:151], a[220:223]
  ds_read_b64_tr_b16 a[164:165], v201 offset:8192
  v_mfma_f32_16x16x32_bf16 a[212:215], a[172:175], a[144:147], a[212:215]
  ds_read_b64_tr_b16 a[166:167], v201 offset:9216
  s_waitcnt lgkmcnt(8)
  v_mfma_f32_16x16x32_bf16 a[224:227], a[176:179], a[144:147], a[224:227]
  ds_read_b64_tr_b16 a[168:169], v202 offset:8192
  ds_read_b64_tr_b16 a[170:171], v202 offset:9216
  v_mfma_f32_16x16x32_bf16 a[232:235], a[176:179], a[148:151], a[232:235]
  buffer_load_dwordx4 v247, s[64:67], s34 offen offset:3072 lds
  v_mfma_f32_16x16x32_bf16 a[236:239], a[180:183], a[148:151], a[236:239]
  ds_read_b64_tr_b16 a[172:173], v203 offset:8192
  v_mfma_f32_16x16x32_bf16 a[228:231], a[180:183], a[144:147], a[228:231]
  ds_read_b64_tr_b16 a[174:175], v203 offset:9216
  s_waitcnt lgkmcnt(8)
  v_mfma_f32_16x16x32_bf16 a[240:243], a[184:187], a[144:147], a[240:243]
  ds_read_b64_tr_b16 a[176:177], v204 offset:8192
  v_mfma_f32_16x16x32_bf16 a[248:251], a[184:187], a[148:151], a[248:251]
  ds_read_b64_tr_b16 a[178:179], v204 offset:9216
  v_mfma_f32_16x16x32_bf16 a[252:255], a[188:191], a[148:151], a[252:255]
  ds_read_b64_tr_b16 a[180:181], v205 offset:8192
  v_mfma_f32_16x16x32_bf16 a[244:247], a[188:191], a[144:147], a[244:247]
  ds_read_b64_tr_b16 a[182:183], v205 offset:9216
  s_waitcnt lgkmcnt(8)
  v_mfma_f32_16x16x32_bf16 a[192:195], a[160:163], a[152:155], a[192:195]
  ds_read_b64_tr_b16 a[184:185], v206 offset:8192
  v_mfma_f32_16x16x32_bf16 a[200:203], a[160:163], a[156:159], a[200:203]
  ds_read_b64_tr_b16 a[186:187], v206 offset:9216
  v_mfma_f32_16x16x32_bf16 a[204:207], a[164:167], a[156:159], a[204:207]
  ds_read_b64_tr_b16 a[188:189], v207 offset:8192
  v_mfma_f32_16x16x32_bf16 a[196:199], a[164:167], a[152:155], a[196:199]
  ds_read_b64_tr_b16 a[190:191], v207 offset:9216
  s_waitcnt lgkmcnt(8)
  v_mfma_f32_16x16x32_bf16 a[208:211], a[168:171], a[152:155], a[208:211]
  s_waitcnt vmcnt(13)
  s_barrier
  v_mov_b32 v208, 3
  buffer_store_dword v208, v231, s[12:15], 0 offen sc1
  ds_read_b64_tr_b16 a[160:161], v200 offset:16384
  v_mfma_f32_16x16x32_bf16 a[216:219], a[168:171], a[156:159], a[216:219]
  ds_read_b64_tr_b16 a[162:163], v200 offset:17408
  v_mfma_f32_16x16x32_bf16 a[220:223], a[172:175], a[156:159], a[220:223]
  ds_read_b64_tr_b16 a[164:165], v201 offset:16384
  ds_read_b64_tr_b16 a[166:167], v201 offset:17408
  v_mfma_f32_16x16x32_bf16 a[212:215], a[172:175], a[152:155], a[212:215]
  s_add_u32 s34, s80, 163840
  s_add_u32 m0, s41, 65536
  s_nop 0
  buffer_load_dwordx4 v244, s[64:67], s34 offen offset:0 lds
  s_waitcnt lgkmcnt(8)
  v_mfma_f32_16x16x32_bf16 a[224:227], a[176:179], a[152:155], a[224:227]
  ds_read_b64_tr_b16 a[168:169], v202 offset:16384
  v_mfma_f32_16x16x32_bf16 a[232:235], a[176:179], a[156:159], a[232:235]
  ds_read_b64_tr_b16 a[170:171], v202 offset:17408
  v_mfma_f32_16x16x32_bf16 a[236:239], a[180:183], a[156:159], a[236:239]
  ds_read_b64_tr_b16 a[172:173], v203 offset:16384
  v_mfma_f32_16x16x32_bf16 a[228:231], a[180:183], a[152:155], a[228:231]
  ds_read_b64_tr_b16 a[174:175], v203 offset:17408
  s_waitcnt lgkmcnt(8)
  v_mfma_f32_16x16x32_bf16 a[240:243], a[184:187], a[152:155], a[240:243]
  ds_read_b64_tr_b16 a[176:177], v204 offset:16384
  ds_read_b64_tr_b16 a[178:179], v204 offset:17408
  v_mfma_f32_16x16x32_bf16 a[248:251], a[184:187], a[156:159], a[248:251]
  buffer_load_dwordx4 v245, s[64:67], s34 offen offset:1024 lds
  v_mfma_f32_16x16x32_bf16 a[252:255], a[188:191], a[156:159], a[252:255]
  ds_read_b64_tr_b16 a[180:181], v205 offset:16384
  v_mfma_f32_16x16x32_bf16 a[244:247], a[188:191], a[152:155], a[244:247]
  ds_read_b64_tr_b16 a[182:183], v205 offset:17408
  s_waitcnt lgkmcnt(8)
  v_mfma_f32_16x16x32_bf16 a[192:195], a[160:163], v[160:163], a[192:195]
  ds_read_b64_tr_b16 a[184:185], v206 offset:16384
  v_mfma_f32_16x16x32_bf16 a[200:203], a[160:163], v[164:167], a[200:203]
  ds_read_b64_tr_b16 a[186:187], v206 offset:17408
  v_mfma_f32_16x16x32_bf16 a[204:207], a[164:167], v[164:167], a[204:207]
  ds_read_b64_tr_b16 a[188:189], v207 offset:16384
  ds_read_b64_tr_b16 a[190:191], v207 offset:17408
  v_mfma_f32_16x16x32_bf16 a[196:199], a[164:167], v[160:163], a[196:199]
  buffer_load_dwordx4 v246, s[64:67], s34 offen offset:2048 lds
  s_waitcnt lgkmcnt(8)
  v_mfma_f32_16x16x32_bf16 a[208:211], a[168:171], v[160:163], a[208:211]
  ds_read_b64_tr_b16 a[160:161], v200 offset:24576
  v_mfma_f32_16x16x32_bf16 a[216:219], a[168:171], v[164:167], a[216:219]
  ds_read_b64_tr_b16 a[162:163], v200 offset:25600
  v_mfma_f32_16x16x32_bf16 a[220:223], a[172:175], v[164:167], a[220:223]
  ds_read_b64_tr_b16 a[164:165], v201 offset:24576
  v_mfma_f32_16x16x32_bf16 a[212:215], a[172:175], v[160:163], a[212:215]
  ds_read_b64_tr_b16 a[166:167], v201 offset:25600
  s_waitcnt lgkmcnt(8)
  v_mfma_f32_16x16x32_bf16 a[224:227], a[176:179], v[160:163], a[224:227]
  ds_read_b64_tr_b16 a[168:169], v202 offset:24576
  ds_read_b64_tr_b16 a[170:171], v202 offset:25600
  v_mfma_f32_16x16x32_bf16 a[232:235], a[176:179], v[164:167], a[232:235]
  buffer_load_dwordx4 v247, s[64:67], s34 offen offset:3072 lds
  v_mfma_f32_16x16x32_bf16 a[236:239], a[180:183], v[164:167], a[236:239]
  ds_read_b64_tr_b16 a[172:173], v203 offset:24576
  v_mfma_f32_16x16x32_bf16 a[228:231], a[180:183], v[160:163], a[228:231]
  ds_read_b64_tr_b16 a[174:175], v203 offset:25600
  s_waitcnt lgkmcnt(8)
  v_mfma_f32_16x16x32_bf16 a[240:243], a[184:187], v[160:163], a[240:243]
  ds_read_b64_tr_b16 a[176:177], v204 offset:24576
  v_mfma_f32_16x16x32_bf16 a[248:251], a[184:187], v[164:167], a[248:251]
  ds_read_b64_tr_b16 a[178:179], v204 offset:25600
  v_mfma_f32_16x16x32_bf16 a[252:255], a[188:191], v[164:167], a[252:255]
  ds_read_b64_tr_b16 a[180:181], v205 offset:24576
  v_mfma_f32_16x16x32_bf16 a[244:247], a[188:191], v[160:163], a[244:247]
  ds_read_b64_tr_b16 a[182:183], v205 offset:25600
  s_waitcnt lgkmcnt(8)
  v_mfma_f32_16x16x32_bf16 a[192:195], a[160:163], v[168:171], a[192:195]
  ds_read_b64_tr_b16 a[184:185], v206 offset:24576
  v_mfma_f32_16x16x32_bf16 a[200:203], a[160:163], v[172:175], a[200:203]
  ds_read_b64_tr_b16 a[186:187], v206 offset:25600
  v_mfma_f32_16x16x32_bf16 a[204:207], a[164:167], v[172:175], a[204:207]
  ds_read_b64_tr_b16 a[188:189], v207 offset:24576
  v_mfma_f32_16x16x32_bf16 a[196:199], a[164:167], v[168:171], a[196:199]
  ds_read_b64_tr_b16 a[190:191], v207 offset:25600
  s_waitcnt lgkmcnt(8)
  v_mfma_f32_16x16x32_bf16 a[208:211], a[168:171], v[168:171], a[208:211]
  s_waitcnt vmcnt(14)
  s_barrier
  ds_read_b64_tr_b16 a[160:161], v232 offset:16384
  v_mfma_f32_16x16x32_bf16 a[216:219], a[168:171], v[172:175], a[216:219]
  ds_read_b64_tr_b16 a[162:163], v232 offset:17408
  v_mfma_f32_16x16x32_bf16 a[220:223], a[172:175], v[172:175], a[220:223]
  ds_read_b64_tr_b16 a[164:165], v233 offset:16384
  ds_read_b64_tr_b16 a[166:167], v233 offset:17408
  v_mfma_f32_16x16x32_bf16 a[212:215], a[172:175], v[168:171], a[212:215]
  s_add_u32 s34, s80, 245760
  s_add_u32 m0, s41, 131072
  s_nop 0
  buffer_load_dwordx4 v244, s[64:67], s34 offen offset:0 lds
  s_waitcnt lgkmcnt(8)
  v_mfma_f32_16x16x32_bf16 a[224:227], a[176:179], v[168:171], a[224:227]
  ds_read_b64_tr_b16 a[168:169], v234 offset:16384
  v_mfma_f32_16x16x32_bf16 a[232:235], a[176:179], v[172:175], a[232:235]
  ds_read_b64_tr_b16 a[170:171], v234 offset:17408
  v_mfma_f32_16x16x32_bf16 a[236:239], a[180:183], v[172:175], a[236:239]
  ds_read_b64_tr_b16 a[172:173], v235 offset:16384
  v_mfma_f32_16x16x32_bf16 a[228:231], a[180:183], v[168:171], a[228:231]
  ds_read_b64_tr_b16 a[174:175], v235 offset:17408
  s_waitcnt lgkmcnt(8)
  v_mfma_f32_16x16x32_bf16 a[240:243], a[184:187], v[168:171], a[240:243]
  ds_read_b64_tr_b16 a[176:177], v236 offset:16384
  ds_read_b64_tr_b16 a[178:179], v236 offset:17408
  v_mfma_f32_16x16x32_bf16 a[248:251], a[184:187], v[172:175], a[248:251]
  buffer_load_dwordx4 v245, s[64:67], s34 offen offset:1024 lds
  v_mfma_f32_16x16x32_bf16 a[252:255], a[188:191], v[172:175], a[252:255]
  ds_read_b64_tr_b16 a[180:181], v237 offset:16384
  v_mfma_f32_16x16x32_bf16 a[244:247], a[188:191], v[168:171], a[244:247]
  ds_read_b64_tr_b16 a[182:183], v237 offset:17408
  s_waitcnt lgkmcnt(8)
  v_mfma_f32_16x16x32_bf16 a[192:195], a[160:163], v[176:179], a[192:195]
  ds_read_b64_tr_b16 a[184:185], v238 offset:16384
  s_waitcnt vmcnt(13)
  v_cmp_gt_u32 vcc, 2, v210
  s_nop 1
  s_cbranch_vccnz PS1
PB1:
  v_mfma_f32_16x16x32_bf16 a[200:203], a[160:163], v[180:183], a[200:203]
  ds_read_b64_tr_b16 a[186:187], v238 offset:17408
  buffer_load_dwordx4 v[0:3], v224, s[8:11], s68 offen sc1
  v_mfma_f32_16x16x32_bf16 a[204:207], a[164:167], v[180:183], a[204:207]
  ds_read_b64_tr_b16 a[188:189], v239 offset:16384
  ds_read_b64_tr_b16 a[190:191], v239 offset:17408
  buffer_load_dwordx4 v[4:7], v224, s[8:11], s69 offen sc1
  v_mfma_f32_16x16x32_bf16 a[196:199], a[164:167], v[176:179], a[196:199]
  buffer_load_dwordx4 v246, s[64:67], s34 offen offset:2048 lds
  s_waitcnt lgkmcnt(8)
  v_mfma_f32_16x16x32_bf16 a[208:211], a[168:171], v[176:179], a[208:211]
  ds_read_b64_tr_b16 a[160:161], v232 offset:24576
  buffer_load_dwordx4 v[8:11], v224, s[8:11], s70 offen sc1
  v_mfma_f32_16x16x32_bf16 a[216:219], a[168:171], v[180:183], a[216:219]
  ds_read_b64_tr_b16 a[162:163], v232 offset:25600
  buffer_load_dwordx4 v[12:15], v224, s[8:11], s71 offen sc1
  v_mfma_f32_16x16x32_bf16 a[220:223], a[172:175], v[180:183], a[220:223]
  ds_read_b64_tr_b16 a[164:165], v233 offset:24576
  buffer_load_dwordx4 v[16:19], v224, s[8:11], s72 offen sc1
  v_mfma_f32_16x16x32_bf16 a[212:215], a[172:175], v[176:179], a[212:215]
  ds_read_b64_tr_b16 a[166:167], v233 offset:25600
  buffer_load_dwordx4 v[20:23], v224, s[8:11], s73 offen sc1
  s_waitcnt lgkmcnt(8)
  v_mfma_f32_16x16x32_bf16 a[224:227], a[176:179], v[176:179], a[224:227]
  ds_read_b64_tr_b16 a[168:169], v234 offset:24576
  ds_read_b64_tr_b16 a[170:171], v234 offset:25600
  buffer_load_dwordx4 v[24:27], v224, s[8:11], s74 offen sc1
  v_mfma_f32_16x16x32_bf16 a[232:235], a[176:179], v[180:183], a[232:235]
  buffer_load_dwordx4 v247, s[64:67], s34 offen offset:3072 lds
  v_mfma_f32_16x16x32_bf16 a[236:239], a[180:183], v[180:183], a[236:239]
  ds_read_b64_tr_b16 a[172:173], v235 offset:24576
  buffer_load_dwordx4 v[28:31], v224, s[8:11], s75 offen sc1
  v_mfma_f32_16x16x32_bf16 a[228:231], a[180:183], v[176:179], a[228:231]
  ds_read_b64_tr_b16 a[174:175], v235 offset:25600
  buffer_load_dwordx4 v[32:35], v225, s[8:11], s68 offen sc1
  s_waitcnt lgkmcnt(8)
  v_mfma_f32_16x16x32_bf16 a[240:243], a[184:187], v[176:179], a[240:243]
  ds_read_b64_tr_b16 a[176:177], v236 offset:24576
  buffer_load_dwordx4 v[36:39], v225, s[8:11], s69 offen sc1
  v_mfma_f32_16x16x32_bf16 a[248:251], a[184:187], v[180:183], a[248:251]
  ds_read_b64_tr_b16 a[178:179], v236 offset:25600
  buffer_load_dwordx4 v[40:43], v225, s[8:11], s70 offen sc1
  v_mfma_f32_16x16x32_bf16 a[252:255], a[188:191], v[180:183], a[252:255]
  ds_read_b64_tr_b16 a[180:181], v237 offset:24576
  buffer_load_dwordx4 v[44:47], v225, s[8:11], s71 offen sc1
  v_mfma_f32_16x16x32_bf16 a[244:247], a[188:191], v[176:179], a[244:247]
  ds_read_b64_tr_b16 a[182:183], v237 offset:25600
  buffer_load_dwordx4 v[48:51], v225, s[8:11], s72 offen sc1
  s_waitcnt lgkmcnt(8)
  v_mfma_f32_16x16x32_bf16 a[192:195], a[160:163], v[184:187], a[192:195]
  ds_read_b64_tr_b16 a[184:185], v238 offset:24576
  buffer_load_dwordx4 v[52:55], v225, s[8:11], s73 offen sc1
  v_mfma_f32_16x16x32_bf16 a[200:203], a[160:163], v[188:191], a[200:203]
  ds_read_b64_tr_b16 a[186:187], v238 offset:25600
  buffer_load_dwordx4 v[56:59], v225, s[8:11], s74 offen sc1
  v_mfma_f32_16x16x32_bf16 a[204:207], a[164:167], v[188:191], a[204:207]
  ds_read_b64_tr_b16 a[188:189], v239 offset:24576
  buffer_load_dwordx4 v[60:63], v225, s[8:11], s75 offen sc1
  v_mfma_f32_16x16x32_bf16 a[196:199], a[164:167], v[184:187], a[196:199]
  ds_read_b64_tr_b16 a[190:191], v239 offset:25600
  s_waitcnt lgkmcnt(8)
  v_mfma_f32_16x16x32_bf16 a[208:211], a[168:171], v[184:187], a[208:211]
  s_waitcnt vmcnt(29)
  s_barrier
  ds_read_b64_tr_b16 a[160:161], v232 offset:32768
  v_mfma_f32_16x16x32_bf16 a[216:219], a[168:171], v[188:191], a[216:219]
  ds_read_b64_tr_b16 a[162:163], v232 offset:33792
  v_mfma_f32_16x16x32_bf16 a[220:223], a[172:175], v[188:191], a[220:223]
  ds_read_b64_tr_b16 a[164:165], v233 offset:32768
  ds_read_b64_tr_b16 a[166:167], v233 offset:33792
  v_mfma_f32_16x16x32_bf16 a[212:215], a[172:175], v[184:187], a[212:215]
  s_add_u32 s34, s80, 327680
  s_add_u32 m0, s41, 147456
  s_nop 0
  buffer_load_dwordx4 v244, s[64:67], s34 offen offset:0 lds
  s_waitcnt lgkmcnt(8)
  v_mfma_f32_16x16x32_bf16 a[224:227], a[176:179], v[184:187], a[224:227]
  ds_read_b64_tr_b16 a[168:169], v234 offset:32768
  v_mfma_f32_16x16x32_bf16 a[232:235], a[176:179], v[188:191], a[232:235]
  ds_read_b64_tr_b16 a[170:171], v234 offset:33792
  v_mfma_f32_16x16x32_bf16 a[236:239], a[180:183], v[188:191], a[236:239]
  ds_read_b64_tr_b16 a[172:173], v235 offset:32768
  v_mfma_f32_16x16x32_bf16 a[228:231], a[180:183], v[184:187], a[228:231]
  ds_read_b64_tr_b16 a[174:175], v235 offset:33792
  s_waitcnt lgkmcnt(8)
  v_mfma_f32_16x16x32_bf16 a[240:243], a[184:187], v[184:187], a[240:243]
  ds_read_b64_tr_b16 a[176:177], v236 offset:32768
  ds_read_b64_tr_b16 a[178:179], v236 offset:33792
  v_mfma_f32_16x16x32_bf16 a[248:251], a[184:187], v[188:191], a[248:251]
  buffer_load_dwordx4 v245, s[64:67], s34 offen offset:1024 lds
  v_mfma_f32_16x16x32_bf16 a[252:255], a[188:191], v[188:191], a[252:255]
  ds_read_b64_tr_b16 a[180:181], v237 offset:32768
  v_mfma_f32_16x16x32_bf16 a[244:247], a[188:191], v[184:187], a[244:247]
  ds_read_b64_tr_b16 a[182:183], v237 offset:33792
  s_waitcnt lgkmcnt(8)
  v_mfma_f32_16x16x32_bf16 v[64:67], a[160:163], a[32:35], 0
  ds_read_b64_tr_b16 a[184:185], v238 offset:32768
  v_mfma_f32_16x16x32_bf16 v[72:75], a[160:163], a[36:39], 0
  ds_read_b64_tr_b16 a[186:187], v238 offset:33792
  v_mfma_f32_16x16x32_bf16 v[76:79], a[164:167], a[36:39], 0
  ds_read_b64_tr_b16 a[188:189], v239 offset:32768
  ds_read_b64_tr_b16 a[190:191], v239 offset:33792
  v_mfma_f32_16x16x32_bf16 v[68:71], a[164:167], a[32:35], 0
  buffer_load_dwordx4 v246, s[64:67], s34 offen offset:2048 lds
  s_waitcnt lgkmcnt(8)
  v_mfma_f32_16x16x32_bf16 v[80:83], a[168:171], a[32:35], 0
  ds_read_b64_tr_b16 a[160:161], v232 offset:40960
  s_mov_b32 s46, 24576
  v_accvgpr_read_b32 v220, a196
  v_mfma_f32_16x16x32_bf16 v[88:91], a[168:171], a[36:39], 0
  ds_read_b64_tr_b16 a[162:163], v232 offset:41984
  v_accvgpr_read_b32 v221, a197
  v_accvgpr_read_b32 v222, a198
  v_accvgpr_read_b32 v223, a199
  v_accvgpr_read_b32 v216, a192
  v_mfma_f32_16x16x32_bf16 v[92:95], a[172:175], a[36:39], 0
  ds_read_b64_tr_b16 a[164:165], v233 offset:40960
  v_accvgpr_read_b32 v217, a193
  v_accvgpr_read_b32 v218, a194
  v_mfma_f32_16x16x32_bf16 v[84:87], a[172:175], a[32:35], 0
  ds_read_b64_tr_b16 a[166:167], v233 offset:41984
  v_accvgpr_read_b32 v219, a195
  v_cvt_pk_bf16_f32 v216, v216, v217
  v_cvt_pk_bf16_f32 v217, v218, v219
  s_waitcnt lgkmcnt(8)
  v_mfma_f32_16x16x32_bf16 v[96:99], a[176:179], a[32:35], 0
  ds_read_b64_tr_b16 a[168:169], v234 offset:40960
  ds_read_b64_tr_b16 a[170:171], v234 offset:41984
  v_cvt_pk_bf16_f32 v218, v220, v221
  v_mfma_f32_16x16x32_bf16 v[104:107], a[176:179], a[36:39], 0
  buffer_load_dwordx4 v247, s[64:67], s34 offen offset:3072 lds
  v_cvt_pk_bf16_f32 v219, v222, v223
  v_mfma_f32_16x16x32_bf16 v[108:111], a[180:183], a[36:39], 0
  ds_read_b64_tr_b16 a[172:173], v235 offset:40960
  buffer_store_dwordx4 v[216:219], v252, s[28:31], s46 offen offset:0 sc1
  v_mfma_f32_16x16x32_bf16 v[100:103], a[180:183], a[32:35], 0
  ds_read_b64_tr_b16 a[174:175], v235 offset:41984
  v_accvgpr_read_b32 v220, a204
  v_accvgpr_read_b32 v221, a205
  v_accvgpr_read_b32 v222, a206
  s_waitcnt lgkmcnt(8)
  v_mfma_f32_16x16x32_bf16 v[112:115], a[184:187], a[32:35], 0
  ds_read_b64_tr_b16 a[176:177], v236 offset:40960
  v_accvgpr_read_b32 v223, a207
  v_accvgpr_read_b32 v216, a200
  v_mfma_f32_16x16x32_bf16 v[120:123], a[184:187], a[36:39], 0
  ds_read_b64_tr_b16 a[178:179], v236 offset:41984
  v_accvgpr_read_b32 v217, a201
  v_accvgpr_read_b32 v218, a202
  v_mfma_f32_16x16x32_bf16 v[124:127], a[188:191], a[36:39], 0
  ds_read_b64_tr_b16 a[180:181], v237 offset:40960
  v_accvgpr_read_b32 v219, a203
  v_cvt_pk_bf16_f32 v216, v216, v217
  v_mfma_f32_16x16x32_bf16 v[116:119], a[188:191], a[32:35], 0
  ds_read_b64_tr_b16 a[182:183], v237 offset:41984
  v_cvt_pk_bf16_f32 v217, v218, v219
  v_cvt_pk_bf16_f32 v218, v220, v221
  v_cvt_pk_bf16_f32 v219, v222, v223
  s_waitcnt lgkmcnt(8)
  v_mfma_f32_16x16x32_bf16 v[64:67], a[160:163], a[40:43], v[64:67]
  ds_read_b64_tr_b16 a[184:185], v238 offset:40960
  buffer_store_dwordx4 v[216:219], v252, s[28:31], s46 offen offset:1024 sc1
  v_mfma_f32_16x16x32_bf16 v[72:75], a[160:163], a[44:47], v[72:75]
  ds_read_b64_tr_b16 a[186:187], v238 offset:41984
  v_accvgpr_read_b32 v220, a212
  v_accvgpr_read_b32 v221, a213
  v_mfma_f32_16x16x32_bf16 v[76:79], a[164:167], a[44:47], v[76:79]
  ds_read_b64_tr_b16 a[188:189], v239 offset:40960
  v_accvgpr_read_b32 v222, a214
  v_accvgpr_read_b32 v223, a215
  v_mfma_f32_16x16x32_bf16 v[68:71], a[164:167], a[40:43], v[68:71]
  ds_read_b64_tr_b16 a[190:191], v239 offset:41984
  v_accvgpr_read_b32 v216, a208
  v_accvgpr_read_b32 v217, a209
  v_accvgpr_read_b32 v218, a210
  s_waitcnt lgkmcnt(8)
  v_mfma_f32_16x16x32_bf16 v[80:83], a[168:171], a[40:43], v[80:83]
  s_waitcnt vmcnt(31)
  s_barrier
  ds_read_b64_tr_b16 a[160:161], v232 offset:49152
  v_mfma_f32_16x16x32_bf16 v[88:91], a[168:171], a[44:47], v[88:91]
  ds_read_b64_tr_b16 a[162:163], v232 offset:50176
  v_accvgpr_read_b32 v219, a211
  v_cvt_pk_bf16_f32 v216, v216, v217
  v_mfma_f32_16x16x32_bf16 v[92:95], a[172:175], a[44:47], v[92:95]
  ds_read_b64_tr_b16 a[164:165], v233 offset:49152
  ds_read_b64_tr_b16 a[166:167], v233 offset:50176
  v_cvt_pk_bf16_f32 v217, v218, v219
  v_mfma_f32_16x16x32_bf16 v[84:87], a[172:175], a[40:43], v[84:87]
  s_add_u32 s34, s80, 409600
  s_add_u32 m0, s41, 81920
  s_nop 0
  buffer_load_dwordx4 v244, s[64:67], s34 offen offset:0 lds
  v_cvt_pk_bf16_f32 v218, v220, v221
  s_waitcnt lgkmcnt(8)
  v_mfma_f32_16x16x32_bf16 v[96:99], a[176:179], a[40:43], v[96:99]
  ds_read_b64_tr_b16 a[168:169], v234 offset:49152
  v_cvt_pk_bf16_f32 v219, v222, v223
  buffer_store_dwordx4 v[216:219], v252, s[28:31], s46 offen offset:2048 sc1
  v_mfma_f32_16x16x32_bf16 v[104:107], a[176:179], a[44:47], v[104:107]
  ds_read_b64_tr_b16 a[170:171], v234 offset:50176
  v_accvgpr_read_b32 v220, a220
  v_accvgpr_read_b32 v221, a221
  v_mfma_f32_16x16x32_bf16 v[108:111], a[180:183], a[44:47], v[108:111]
  ds_read_b64_tr_b16 a[172:173], v235 offset:49152
  v_accvgpr_read_b32 v222, a222
  v_accvgpr_read_b32 v223, a223
  v_mfma_f32_16x16x32_bf16 v[100:103], a[180:183], a[40:43], v[100:103]
  ds_read_b64_tr_b16 a[174:175], v235 offset:50176
  v_accvgpr_read_b32 v216, a216
  v_accvgpr_read_b32 v217, a217
  s_waitcnt lgkmcnt(8)
  v_mfma_f32_16x16x32_bf16 v[112:115], a[184:187], a[40:43], v[112:115]
  ds_read_b64_tr_b16 a[176:177], v236 offset:49152
  ds_read_b64_tr_b16 a[178:179], v236 offset:50176
  v_accvgpr_read_b32 v218, a218
  v_mfma_f32_16x16x32_bf16 v[120:123], a[184:187], a[44:47], v[120:123]
  buffer_load_dwordx4 v245, s[64:67], s34 offen offset:1024 lds
  v_accvgpr_read_b32 v219, a219
  v_cvt_pk_bf16_f32 v216, v216, v217
  v_mfma_f32_16x16x32_bf16 v[124:127], a[188:191], a[44:47], v[124:127]
  ds_read_b64_tr_b16 a[180:181], v237 offset:49152
  v_cvt_pk_bf16_f32 v217, v218, v219
  v_cvt_pk_bf16_f32 v218, v220, v221
  v_mfma_f32_16x16x32_bf16 v[116:119], a[188:191], a[40:43], v[116:119]
  ds_read_b64_tr_b16 a[182:183], v237 offset:50176
  v_cvt_pk_bf16_f32 v219, v222, v223
  buffer_store_dwordx4 v[216:219], v252, s[28:31], s46 offen offset:3072 sc1
  s_waitcnt lgkmcnt(8)
  v_mfma_f32_16x16x32_bf16 v[64:67], a[160:163], a[48:51], v[64:67]
  ds_read_b64_tr_b16 a[184:185], v238 offset:49152
  s_mov_b32 s46, 28672
  v_accvgpr_read_b32 v220, a228
  v_mfma_f32_16x16x32_bf16 v[72:75], a[160:163], a[52:55], v[72:75]
  ds_read_b64_tr_b16 a[186:187], v238 offset:50176
  v_accvgpr_read_b32 v221, a229
  v_accvgpr_read_b32 v222, a230
  v_mfma_f32_16x16x32_bf16 v[76:79], a[164:167], a[52:55], v[76:79]
  ds_read_b64_tr_b16 a[188:189], v239 offset:49152
  ds_read_b64_tr_b16 a[190:191], v239 offset:50176
  v_accvgpr_read_b32 v223, a231
  v_mfma_f32_16x16x32_bf16 v[68:71], a[164:167], a[48:51], v[68:71]
  buffer_load_dwordx4 v246, s[64:67], s34 offen offset:2048 lds
  v_accvgpr_read_b32 v216, a224
  s_waitcnt lgkmcnt(8)
  v_mfma_f32_16x16x32_bf16 v[80:83], a[168:171], a[48:51], v[80:83]
  ds_read_b64_tr_b16 a[160:161], v232 offset:57344
  v_accvgpr_read_b32 v217, a225
  v_accvgpr_read_b32 v218, a226
  v_mfma_f32_16x16x32_bf16 v[88:91], a[168:171], a[52:55], v[88:91]
  ds_read_b64_tr_b16 a[162:163], v232 offset:58368
  v_accvgpr_read_b32 v219, a227
  v_cvt_pk_bf16_f32 v216, v216, v217
  v_mfma_f32_16x16x32_bf16 v[92:95], a[172:175], a[52:55], v[92:95]
  ds_read_b64_tr_b16 a[164:165], v233 offset:57344
  v_cvt_pk_bf16_f32 v217, v218, v219
  v_cvt_pk_bf16_f32 v218, v220, v221
  v_mfma_f32_16x16x32_bf16 v[84:87], a[172:175], a[48:51], v[84:87]
  ds_read_b64_tr_b16 a[166:167], v233 offset:58368
  v_cvt_pk_bf16_f32 v219, v222, v223
  buffer_store_dwordx4 v[216:219], v252, s[28:31], s46 offen offset:0 sc1
  s_waitcnt lgkmcnt(8)
  v_mfma_f32_16x16x32_bf16 v[96:99], a[176:179], a[48:51], v[96:99]
  ds_read_b64_tr_b16 a[168:169], v234 offset:57344
  ds_read_b64_tr_b16 a[170:171], v234 offset:58368
  v_accvgpr_read_b32 v220, a236
  v_mfma_f32_16x16x32_bf16 v[104:107], a[176:179], a[52:55], v[104:107]
  buffer_load_dwordx4 v247, s[64:67], s34 offen offset:3072 lds
  v_accvgpr_read_b32 v221, a237
  v_mfma_f32_16x16x32_bf16 v[108:111], a[180:183], a[52:55], v[108:111]
  ds_read_b64_tr_b16 a[172:173], v235 offset:57344
  v_accvgpr_read_b32 v222, a238
  v_accvgpr_read_b32 v223, a239
  v_mfma_f32_16x16x32_bf16 v[100:103], a[180:183], a[48:51], v[100:103]
  ds_read_b64_tr_b16 a[174:175], v235 offset:58368
  v_accvgpr_read_b32 v216, a232
  v_accvgpr_read_b32 v217, a233
  s_waitcnt lgkmcnt(8)
  v_mfma_f32_16x16x32_bf16 v[112:115], a[184:187], a[48:51], v[112:115]
  ds_read_b64_tr_b16 a[176:177], v236 offset:57344
  v_accvgpr_read_b32 v218, a234
  v_accvgpr_read_b32 v219, a235
  v_mfma_f32_16x16x32_bf16 v[120:123], a[184:187], a[52:55], v[120:123]
  ds_read_b64_tr_b16 a[178:179], v236 offset:58368
  v_cvt_pk_bf16_f32 v216, v216, v217
  v_cvt_pk_bf16_f32 v217, v218, v219
  v_cvt_pk_bf16_f32 v218, v220, v221
  v_mfma_f32_16x16x32_bf16 v[124:127], a[188:191], a[52:55], v[124:127]
  ds_read_b64_tr_b16 a[180:181], v237 offset:57344
  v_cvt_pk_bf16_f32 v219, v222, v223
  buffer_store_dwordx4 v[216:219], v252, s[28:31], s46 offen offset:1024 sc1
  v_mfma_f32_16x16x32_bf16 v[116:119], a[188:191], a[48:51], v[116:119]
  ds_read_b64_tr_b16 a[182:183], v237 offset:58368
  v_accvgpr_read_b32 v220, a244
  v_accvgpr_read_b32 v221, a245
  s_waitcnt lgkmcnt(8)
  v_mfma_f32_16x16x32_bf16 v[64:67], a[160:163], a[56:59], v[64:67]
  ds_read_b64_tr_b16 a[184:185], v238 offset:57344
  v_accvgpr_read_b32 v222, a246
  v_accvgpr_read_b32 v223, a247
  v_mfma_f32_16x16x32_bf16 v[72:75], a[160:163], a[60:63], v[72:75]
  ds_read_b64_tr_b16 a[186:187], v238 offset:58368
  v_accvgpr_read_b32 v216, a240
  v_accvgpr_read_b32 v217, a241
  v_mfma_f32_16x16x32_bf16 v[76:79], a[164:167], a[60:63], v[76:79]
  ds_read_b64_tr_b16 a[188:189], v239 offset:57344
  v_accvgpr_read_b32 v218, a242
  v_accvgpr_read_b32 v219, a243
  v_mfma_f32_16x16x32_bf16 v[68:71], a[164:167], a[56:59], v[68:71]
  ds_read_b64_tr_b16 a[190:191], v239 offset:58368
  v_cvt_pk_bf16_f32 v216, v216, v217
  v_cvt_pk_bf16_f32 v217, v218, v219
  v_cvt_pk_bf16_f32 v218, v220, v221
  s_waitcnt lgkmcnt(8)
  v_mfma_f32_16x16x32_bf16 v[80:83], a[168:171], a[56:59], v[80:83]
  s_waitcnt vmcnt(34)
  s_barrier
  ds_read_b64_tr_b16 a[160:161], v232 offset:0
  v_mfma_f32_16x16x32_bf16 v[88:91], a[168:171], a[60:63], v[88:91]
  ds_read_b64_tr_b16 a[162:163], v232 offset:1024
  v_cvt_pk_bf16_f32 v219, v222, v223
  buffer_store_dwordx4 v[216:219], v252, s[28:31], s46 offen offset:2048 sc1
  v_mfma_f32_16x16x32_bf16 v[92:95], a[172:175], a[60:63], v[92:95]
  ds_read_b64_tr_b16 a[164:165], v233 offset:0
  ds_read_b64_tr_b16 a[166:167], v233 offset:1024
  v_accvgpr_read_b32 v220, a252
  v_mfma_f32_16x16x32_bf16 v[84:87], a[172:175], a[56:59], v[84:87]
  s_add_u32 s34, s80, 491520
  s_add_u32 m0, s41, 98304
  s_nop 0
  buffer_load_dwordx4 v244, s[64:67], s34 offen offset:0 lds
  s_waitcnt lgkmcnt(8)
  v_mfma_f32_16x16x32_bf16 v[96:99], a[176:179], a[56:59], v[96:99]
  ds_read_b64_tr_b16 a[168:169], v234 offset:0
  v_accvgpr_read_b32 v221, a253
  v_accvgpr_read_b32 v222, a254
  v_mfma_f32_16x16x32_bf16 v[104:107], a[176:179], a[60:63], v[104:107]
  ds_read_b64_tr_b16 a[170:171], v234 offset:1024
  v_accvgpr_read_b32 v223, a255
  v_accvgpr_read_b32 v216, a248
  v_accvgpr_read_b32 v217, a249
  v_mfma_f32_16x16x32_bf16 v[108:111], a[180:183], a[60:63], v[108:111]
  ds_read_b64_tr_b16 a[172:173], v235 offset:0
  v_accvgpr_read_b32 v218, a250
  v_accvgpr_read_b32 v219, a251
  v_mfma_f32_16x16x32_bf16 v[100:103], a[180:183], a[56:59], v[100:103]
  ds_read_b64_tr_b16 a[174:175], v235 offset:1024
  v_cvt_pk_bf16_f32 v216, v216, v217
  v_cvt_pk_bf16_f32 v217, v218, v219
  s_waitcnt lgkmcnt(8)
  v_mfma_f32_16x16x32_bf16 v[112:115], a[184:187], a[56:59], v[112:115]
  ds_read_b64_tr_b16 a[176:177], v236 offset:0
  ds_read_b64_tr_b16 a[178:179], v236 offset:1024
  v_cvt_pk_bf16_f32 v218, v220, v221
  v_mfma_f32_16x16x32_bf16 v[120:123], a[184:187], a[60:63], v[120:123]
  buffer_load_dwordx4 v245, s[64:67], s34 offen offset:1024 lds
  v_cvt_pk_bf16_f32 v219, v222, v223
  v_mfma_f32_16x16x32_bf16 v[124:127], a[188:191], a[60:63], v[124:127]
  ds_read_b64_tr_b16 a[180:181], v237 offset:0
  buffer_store_dwordx4 v[216:219], v252, s[28:31], s46 offen offset:3072 sc1
  v_mfma_f32_16x16x32_bf16 v[116:119], a[188:191], a[56:59], v[116:119]
  ds_read_b64_tr_b16 a[182:183], v237 offset:1024
  s_waitcnt lgkmcnt(8)
  v_mfma_f32_16x16x32_bf16 v[64:67], a[160:163], a[0:3], v[64:67]
  ds_read_b64_tr_b16 a[184:185], v238 offset:0
  buffer_load_dword v211, v230, s[24:27], 0 offen sc1
  v_mfma_f32_16x16x32_bf16 v[72:75], a[160:163], a[4:7], v[72:75]
  ds_read_b64_tr_b16 a[186:187], v238 offset:1024
  s_waitcnt vmcnt(36)
  v_lshlrev_b32 v192, 16, v0
  v_and_b32 v193, s43, v0
  v_lshlrev_b32 v194, 16, v1
  v_mfma_f32_16x16x32_bf16 v[76:79], a[164:167], a[4:7], v[76:79]
  ds_read_b64_tr_b16 a[188:189], v239 offset:0
  ds_read_b64_tr_b16 a[190:191], v239 offset:1024
  v_and_b32 v195, s43, v1
  v_mfma_f32_16x16x32_bf16 v[68:71], a[164:167], a[0:3], v[68:71]
  buffer_load_dwordx4 v246, s[64:67], s34 offen offset:2048 lds
  v_lshlrev_b32 v196, 16, v2
  v_and_b32 v197, s43, v2
  s_waitcnt lgkmcnt(8)
  v_mfma_f32_16x16x32_bf16 v[80:83], a[168:171], a[0:3], v[80:83]
  ds_read_b64_tr_b16 a[160:161], v232 offset:8192
  v_lshlrev_b32 v198, 16, v3
  v_and_b32 v199, s43, v3
  v_mfma_f32_16x16x32_bf16 v[88:91], a[168:171], a[4:7], v[88:91]
  ds_read_b64_tr_b16 a[162:163], v232 offset:9216
  s_waitcnt vmcnt(36)
  v_lshlrev_b32 v214, 16, v4
  v_mfma_f32_16x16x32_bf16 v[92:95], a[172:175], a[4:7], v[92:95]
  ds_read_b64_tr_b16 a[164:165], v233 offset:8192
  v_and_b32 v215, s43, v4
  v_add_f32 v192, v192, v214
  v_mfma_f32_16x16x32_bf16 v[84:87], a[172:175], a[0:3], v[84:87]
  ds_read_b64_tr_b16 a[166:167], v233 offset:9216
  v_add_f32 v193, v193, v215
  v_lshlrev_b32 v214, 16, v5
  v_and_b32 v215, s43, v5
  s_waitcnt lgkmcnt(8)
  v_mfma_f32_16x16x32_bf16 v[96:99], a[176:179], a[0:3], v[96:99]
  ds_read_b64_tr_b16 a[168:169], v234 offset:8192
  ds_read_b64_tr_b16 a[170:171], v234 offset:9216
  v_add_f32 v194, v194, v214
  v_mfma_f32_16x16x32_bf16 v[104:107], a[176:179], a[4:7], v[104:107]
  buffer_load_dwordx4 v247, s[64:67], s34 offen offset:3072 lds
  v_add_f32 v195, v195, v215
  v_mfma_f32_16x16x32_bf16 v[108:111], a[180:183], a[4:7], v[108:111]
  ds_read_b64_tr_b16 a[172:173], v235 offset:8192
  v_lshlrev_b32 v214, 16, v6
  v_and_b32 v215, s43, v6
  v_mfma_f32_16x16x32_bf16 v[100:103], a[180:183], a[0:3], v[100:103]
  ds_read_b64_tr_b16 a[174:175], v235 offset:9216
  v_add_f32 v196, v196, v214
  v_add_f32 v197, v197, v215
  v_lshlrev_b32 v214, 16, v7
  s_waitcnt lgkmcnt(8)
  v_mfma_f32_16x16x32_bf16 v[112:115], a[184:187], a[0:3], v[112:115]
  ds_read_b64_tr_b16 a[176:177], v236 offset:8192
  v_and_b32 v215, s43, v7
  v_add_f32 v198, v198, v214
  v_mfma_f32_16x16x32_bf16 v[120:123], a[184:187], a[4:7], v[120:123]
  ds_read_b64_tr_b16 a[178:179], v236 offset:9216
  v_add_f32 v199, v199, v215
  s_waitcnt vmcnt(35)
  v_lshlrev_b32 v214, 16, v8
  v_mfma_f32_16x16x32_bf16 v[124:127], a[188:191], a[4:7], v[124:127]
  ds_read_b64_tr_b16 a[180:181], v237 offset:8192
  v_and_b32 v215, s43, v8
  v_add_f32 v192, v192, v214
  v_mfma_f32_16x16x32_bf16 v[116:119], a[188:191], a[0:3], v[116:119]
  ds_read_b64_tr_b16 a[182:183], v237 offset:9216
  v_add_f32 v193, v193, v215
  v_lshlrev_b32 v214, 16, v9
  s_waitcnt lgkmcnt(8)
  v_mfma_f32_16x16x32_bf16 v[64:67], a[160:163], a[8:11], v[64:67]
  ds_read_b64_tr_b16 a[184:185], v238 offset:8192
  v_and_b32 v215, s43, v9
  v_add_f32 v194, v194, v214
  v_mfma_f32_16x16x32_bf16 v[72:75], a[160:163], a[12:15], v[72:75]
  ds_read_b64_tr_b16 a[186:187], v238 offset:9216
  v_add_f32 v195, v195, v215
  v_lshlrev_b32 v214, 16, v10
  v_and_b32 v215, s43, v10
  v_mfma_f32_16x16x32_bf16 v[76:79], a[164:167], a[12:15], v[76:79]
  ds_read_b64_tr_b16 a[188:189], v239 offset:8192
  v_add_f32 v196, v196, v214
  v_add_f32 v197, v197, v215
  v_mfma_f32_16x16x32_bf16 v[68:71], a[164:167], a[8:11], v[68:71]
  ds_read_b64_tr_b16 a[190:191], v239 offset:9216
  v_lshlrev_b32 v214, 16, v11
  v_and_b32 v215, s43, v11
  s_waitcnt lgkmcnt(8)
  v_mfma_f32_16x16x32_bf16 v[80:83], a[168:171], a[8:11], v[80:83]
  s_waitcnt vmcnt(30)
  s_barrier
  ds_read_b64_tr_b16 a[160:161], v200 offset:0
  v_mfma_f32_16x16x32_bf16 v[88:91], a[168:171], a[12:15], v[88:91]
  ds_read_b64_tr_b16 a[162:163], v200 offset:1024
  v_add_f32 v198, v198, v214
  v_add_f32 v199, v199, v215
  v_lshlrev_b32 v214, 16, v12
  v_mfma_f32_16x16x32_bf16 v[92:95], a[172:175], a[12:15], v[92:95]
  ds_read_b64_tr_b16 a[164:165], v201 offset:0
  ds_read_b64_tr_b16 a[166:167], v201 offset:1024
  v_and_b32 v215, s43, v12
  v_mfma_f32_16x16x32_bf16 v[84:87], a[172:175], a[8:11], v[84:87]
  s_add_u32 s34, s80, 573440
  s_add_u32 m0, s41, 114688
  s_nop 0
  buffer_load_dwordx4 v244, s[64:67], s34 offen offset:0 lds
  v_add_f32 v192, v192, v214
  s_waitcnt lgkmcnt(8)
  v_mfma_f32_16x16x32_bf16 v[96:99], a[176:179], a[8:11], v[96:99]
  ds_read_b64_tr_b16 a[168:169], v202 offset:0
  v_add_f32 v193, v193, v215
  v_lshlrev_b32 v214, 16, v13
  v_mfma_f32_16x16x32_bf16 v[104:107], a[176:179], a[12:15], v[104:107]
  ds_read_b64_tr_b16 a[170:171], v202 offset:1024
  v_and_b32 v215, s43, v13
  v_add_f32 v194, v194, v214
  v_add_f32 v195, v195, v215
  v_mfma_f32_16x16x32_bf16 v[108:111], a[180:183], a[12:15], v[108:111]
  ds_read_b64_tr_b16 a[172:173], v203 offset:0
  v_lshlrev_b32 v214, 16, v14
  v_and_b32 v215, s43, v14
  v_mfma_f32_16x16x32_bf16 v[100:103], a[180:183], a[8:11], v[100:103]
  ds_read_b64_tr_b16 a[174:175], v203 offset:1024
  v_add_f32 v196, v196, v214
  v_add_f32 v197, v197, v215
  v_lshlrev_b32 v214, 16, v15
  s_waitcnt lgkmcnt(8)
  v_mfma_f32_16x16x32_bf16 v[112:115], a[184:187], a[8:11], v[112:115]
  ds_read_b64_tr_b16 a[176:177], v204 offset:0
  ds_read_b64_tr_b16 a[178:179], v204 offset:1024
  v_and_b32 v215, s43, v15
  v_mfma_f32_16x16x32_bf16 v[120:123], a[184:187], a[12:15], v[120:123]
  buffer_load_dwordx4 v245, s[64:67], s34 offen offset:1024 lds
  v_add_f32 v198, v198, v214
  v_mfma_f32_16x16x32_bf16 v[124:127], a[188:191], a[12:15], v[124:127]
  ds_read_b64_tr_b16 a[180:181], v205 offset:0
  v_add_f32 v199, v199, v215
  v_lshlrev_b32 v214, 16, v16
  v_mfma_f32_16x16x32_bf16 v[116:119], a[188:191], a[8:11], v[116:119]
  ds_read_b64_tr_b16 a[182:183], v205 offset:1024
  v_and_b32 v215, s43, v16
  v_add_f32 v192, v192, v214
  v_add_f32 v193, v193, v215
  s_waitcnt lgkmcnt(8)
  v_mfma_f32_16x16x32_bf16 v[64:67], a[160:163], a[16:19], v[64:67]
  ds_read_b64_tr_b16 a[184:185], v206 offset:0
  v_lshlrev_b32 v214, 16, v17
  v_and_b32 v215, s43, v17
  v_mfma_f32_16x16x32_bf16 v[72:75], a[160:163], a[20:23], v[72:75]
  ds_read_b64_tr_b16 a[186:187], v206 offset:1024
  v_add_f32 v194, v194, v214
  v_add_f32 v195, v195, v215
  v_mfma_f32_16x16x32_bf16 v[76:79], a[164:167], a[20:23], v[76:79]
  ds_read_b64_tr_b16 a[188:189], v207 offset:0
  ds_read_b64_tr_b16 a[190:191], v207 offset:1024
  v_lshlrev_b32 v214, 16, v18
  v_mfma_f32_16x16x32_bf16 v[68:71], a[164:167], a[16:19], v[68:71]
  buffer_load_dwordx4 v246, s[64:67], s34 offen offset:2048 lds
  v_and_b32 v215, s43, v18
  v_add_f32 v196, v196, v214
  s_waitcnt lgkmcnt(8)
  v_mfma_f32_16x16x32_bf16 v[80:83], a[168:171], a[16:19], v[80:83]
  ds_read_b64_tr_b16 a[160:161], v200 offset:8192
  v_add_f32 v197, v197, v215
  v_lshlrev_b32 v214, 16, v19
  v_mfma_f32_16x16x32_bf16 v[88:91], a[168:171], a[20:23], v[88:91]
  ds_read_b64_tr_b16 a[162:163], v200 offset:9216
  v_and_b32 v215, s43, v19
  v_add_f32 v198, v198, v214
  v_mfma_f32_16x16x32_bf16 v[92:95], a[172:175], a[20:23], v[92:95]
  ds_read_b64_tr_b16 a[164:165], v201 offset:8192
  v_add_f32 v199, v199, v215
  v_lshlrev_b32 v214, 16, v20
  v_mfma_f32_16x16x32_bf16 v[84:87], a[172:175], a[16:19], v[84:87]
  ds_read_b64_tr_b16 a[166:167], v201 offset:9216
  v_and_b32 v215, s43, v20
  v_add_f32 v192, v192, v214
  v_add_f32 v193, v193, v215
  s_waitcnt lgkmcnt(8)
  v_mfma_f32_16x16x32_bf16 v[96:99], a[176:179], a[16:19], v[96:99]
  ds_read_b64_tr_b16 a[168:169], v202 offset:8192
  ds_read_b64_tr_b16 a[170:171], v202 offset:9216
  v_lshlrev_b32 v214, 16, v21
  v_mfma_f32_16x16x32_bf16 v[104:107], a[176:179], a[20:23], v[104:107]
  buffer_load_dwordx4 v247, s[64:67], s34 offen offset:3072 lds
  v_and_b32 v215, s43, v21
  v_mfma_f32_16x16x32_bf16 v[108:111], a[180:183], a[20:23], v[108:111]
  ds_read_b64_tr_b16 a[172:173], v203 offset:8192
  v_add_f32 v194, v194, v214
  v_add_f32 v195, v195, v215
  v_mfma_f32_16x16x32_bf16 v[100:103], a[180:183], a[16:19], v[100:103]
  ds_read_b64_tr_b16 a[174:175], v203 offset:9216
  v_lshlrev_b32 v214, 16, v22
  v_and_b32 v215, s43, v22
  v_add_f32 v196, v196, v214
  s_waitcnt lgkmcnt(8)
  v_mfma_f32_16x16x32_bf16 v[112:115], a[184:187], a[16:19], v[112:115]
  ds_read_b64_tr_b16 a[176:177], v204 offset:8192
  v_add_f32 v197, v197, v215
  v_lshlrev_b32 v214, 16, v23
  v_mfma_f32_16x16x32_bf16 v[120:123], a[184:187], a[20:23], v[120:123]
  ds_read_b64_tr_b16 a[178:179], v204 offset:9216
  v_and_b32 v215, s43, v23
  v_add_f32 v198, v198, v214
  v_add_f32 v199, v199, v215
  v_mfma_f32_16x16x32_bf16 v[124:127], a[188:191], a[20:23], v[124:127]
  ds_read_b64_tr_b16 a[180:181], v205 offset:8192
  v_lshlrev_b32 v214, 16, v24
  v_and_b32 v215, s43, v24
  v_mfma_f32_16x16x32_bf16 v[116:119], a[188:191], a[16:19], v[116:119]
  ds_read_b64_tr_b16 a[182:183], v205 offset:9216
  v_add_f32 v192, v192, v214
  v_add_f32 v193, v193, v215
  s_waitcnt lgkmcnt(8)
  v_mfma_f32_16x16x32_bf16 v[64:67], a[160:163], a[24:27], v[64:67]
  ds_read_b64_tr_b16 a[184:185], v206 offset:8192
  v_lshlrev_b32 v214, 16, v25
  v_and_b32 v215, s43, v25
  v_mfma_f32_16x16x32_bf16 v[72:75], a[160:163], a[28:31], v[72:75]
  ds_read_b64_tr_b16 a[186:187], v206 offset:9216
  v_add_f32 v194, v194, v214
  v_add_f32 v195, v195, v215
  v_lshlrev_b32 v214, 16, v26
  v_mfma_f32_16x16x32_bf16 v[76:79], a[164:167], a[28:31], v[76:79]
  ds_read_b64_tr_b16 a[188:189], v207 offset:8192
  v_and_b32 v215, s43, v26
  v_add_f32 v196, v196, v214
  v_mfma_f32_16x16x32_bf16 v[68:71], a[164:167], a[24:27], v[68:71]
  ds_read_b64_tr_b16 a[190:191], v207 offset:9216
  v_add_f32 v197, v197, v215
  v_lshlrev_b32 v214, 16, v27
  v_and_b32 v215, s43, v27
  s_waitcnt lgkmcnt(8)
  v_mfma_f32_16x16x32_bf16 v[80:83], a[168:171], a[24:27], v[80:83]
  s_waitcnt vmcnt(21)
  s_barrier
  ds_read_b64_tr_b16 a[160:161], v200 offset:16384
  v_mfma_f32_16x16x32_bf16 v[88:91], a[168:171], a[28:31], v[88:91]
  ds_read_b64_tr_b16 a[162:163], v200 offset:17408
  v_add_f32 v198, v198, v214
  v_add_f32 v199, v199, v215
  v_mfma_f32_16x16x32_bf16 v[92:95], a[172:175], a[28:31], v[92:95]
  ds_read_b64_tr_b16 a[164:165], v201 offset:16384
  v_lshlrev_b32 v214, 16, v28
  v_and_b32 v215, s43, v28
  v_mfma_f32_16x16x32_bf16 v[84:87], a[172:175], a[24:27], v[84:87]
  ds_read_b64_tr_b16 a[166:167], v201 offset:17408
  v_add_f32 v192, v192, v214
  v_add_f32 v193, v193, v215
  v_lshlrev_b32 v214, 16, v29
  s_waitcnt lgkmcnt(8)
  v_mfma_f32_16x16x32_bf16 v[96:99], a[176:179], a[24:27], v[96:99]
  ds_read_b64_tr_b16 a[168:169], v202 offset:16384
  v_and_b32 v215, s43, v29
  v_add_f32 v194, v194, v214
  v_mfma_f32_16x16x32_bf16 v[104:107], a[176:179], a[28:31], v[104:107]
  ds_read_b64_tr_b16 a[170:171], v202 offset:17408
  v_add_f32 v195, v195, v215
  v_lshlrev_b32 v214, 16, v30
  v_and_b32 v215, s43, v30
  v_mfma_f32_16x16x32_bf16 v[108:111], a[180:183], a[28:31], v[108:111]
  ds_read_b64_tr_b16 a[172:173], v203 offset:16384
  v_add_f32 v196, v196, v214
  v_add_f32 v197, v197, v215
  v_mfma_f32_16x16x32_bf16 v[100:103], a[180:183], a[24:27], v[100:103]
  ds_read_b64_tr_b16 a[174:175], v203 offset:17408
  v_lshlrev_b32 v214, 16, v31
  v_and_b32 v215, s43, v31
  v_add_f32 v198, v198, v214
  s_waitcnt lgkmcnt(8)
  v_mfma_f32_16x16x32_bf16 v[112:115], a[184:187], a[24:27], v[112:115]
  ds_read_b64_tr_b16 a[176:177], v204 offset:16384
  v_add_f32 v199, v199, v215
  v_cvt_pk_bf16_f32 v192, v192, v193
  v_mfma_f32_16x16x32_bf16 v[120:123], a[184:187], a[28:31], v[120:123]
  ds_read_b64_tr_b16 a[178:179], v204 offset:17408
  v_cvt_pk_bf16_f32 v193, v194, v195
  v_cvt_pk_bf16_f32 v194, v196, v197
  v_mfma_f32_16x16x32_bf16 v[124:127], a[188:191], a[28:31], v[124:127]
  ds_read_b64_tr_b16 a[180:181], v205 offset:16384
  v_cvt_pk_bf16_f32 v195, v198, v199
  v_permlane16_swap_b32 v192, v194
  v_mfma_f32_16x16x32_bf16 v[116:119], a[188:191], a[24:27], v[116:119]
  ds_read_b64_tr_b16 a[182:183], v205 offset:17408
  v_permlane16_swap_b32 v193, v195
  buffer_store_dwordx4 v[192:195], v229, s[16:19], s76 offen
  s_waitcnt lgkmcnt(8)
  v_mfma_f32_16x16x32_bf16 v[64:67], a[160:163], a[128:131], v[64:67]
  ds_read_b64_tr_b16 a[184:185], v206 offset:16384
  v_lshlrev_b32 v192, 16, v32
  v_and_b32 v193, s43, v32
  v_mfma_f32_16x16x32_bf16 v[72:75], a[160:163], a[132:135], v[72:75]
  ds_read_b64_tr_b16 a[186:187], v206 offset:17408
  v_lshlrev_b32 v194, 16, v33
  v_and_b32 v195, s43, v33
  v_lshlrev_b32 v196, 16, v34
  v_mfma_f32_16x16x32_bf16 v[76:79], a[164:167], a[132:135], v[76:79]
  ds_read_b64_tr_b16 a[188:189], v207 offset:16384
  v_and_b32 v197, s43, v34
  v_lshlrev_b32 v198, 16, v35
  v_mfma_f32_16x16x32_bf16 v[68:71], a[164:167], a[128:131], v[68:71]
  ds_read_b64_tr_b16 a[190:191], v207 offset:17408
  v_and_b32 v199, s43, v35
  v_lshlrev_b32 v214, 16, v36
  v_and_b32 v215, s43, v36
  s_waitcnt lgkmcnt(8)
  v_mfma_f32_16x16x32_bf16 v[80:83], a[168:171], a[128:131], v[80:83]
  ds_read_b64_tr_b16 a[160:161], v200 offset:24576
  v_add_f32 v192, v192, v214
  v_add_f32 v193, v193, v215
  v_mfma_f32_16x16x32_bf16 v[88:91], a[168:171], a[132:135], v[88:91]
  ds_read_b64_tr_b16 a[162:163], v200 offset:25600
  v_lshlrev_b32 v214, 16, v37
  v_and_b32 v215, s43, v37
  v_add_f32 v194, v194, v214
  v_mfma_f32_16x16x32_bf16 v[92:95], a[172:175], a[132:135], v[92:95]
  ds_read_b64_tr_b16 a[164:165], v201 offset:24576
  v_add_f32 v195, v195, v215
  v_lshlrev_b32 v214, 16, v38
  v_mfma_f32_16x16x32_bf16 v[84:87], a[172:175], a[128:131], v[84:87]
  ds_read_b64_tr_b16 a[166:167], v201 offset:25600
  v_and_b32 v215, s43, v38
  v_add_f32 v196, v196, v214
  v_add_f32 v197, v197, v215
  s_waitcnt lgkmcnt(8)
  v_mfma_f32_16x16x32_bf16 v[96:99], a[176:179], a[128:131], v[96:99]
  ds_read_b64_tr_b16 a[168:169], v202 offset:24576
  v_lshlrev_b32 v214, 16, v39
  v_and_b32 v215, s43, v39
  v_mfma_f32_16x16x32_bf16 v[104:107], a[176:179], a[132:135], v[104:107]
  ds_read_b64_tr_b16 a[170:171], v202 offset:25600
  v_add_f32 v198, v198, v214
  v_add_f32 v199, v199, v215
  v_lshlrev_b32 v214, 16, v40
  v_mfma_f32_16x16x32_bf16 v[108:111], a[180:183], a[132:135], v[108:111]
  ds_read_b64_tr_b16 a[172:173], v203 offset:24576
  v_and_b32 v215, s43, v40
  v_add_f32 v192, v192, v214
  v_mfma_f32_16x16x32_bf16 v[100:103], a[180:183], a[128:131], v[100:103]
  ds_read_b64_tr_b16 a[174:175], v203 offset:25600
  v_add_f32 v193, v193, v215
  v_lshlrev_b32 v214, 16, v41
  v_and_b32 v215, s43, v41
  s_waitcnt lgkmcnt(8)
  v_mfma_f32_16x16x32_bf16 v[112:115], a[184:187], a[128:131], v[112:115]
  ds_read_b64_tr_b16 a[176:177], v204 offset:24576
  v_add_f32 v194, v194, v214
  v_add_f32 v195, v195, v215
  v_mfma_f32_16x16x32_bf16 v[120:123], a[184:187], a[132:135], v[120:123]
  ds_read_b64_tr_b16 a[178:179], v204 offset:25600
  v_lshlrev_b32 v214, 16, v42
  v_and_b32 v215, s43, v42
  v_mfma_f32_16x16x32_bf16 v[124:127], a[188:191], a[132:135], v[124:127]
  ds_read_b64_tr_b16 a[180:181], v205 offset:24576
  v_add_f32 v196, v196, v214
  v_add_f32 v197, v197, v215
  v_mfma_f32_16x16x32_bf16 v[116:119], a[188:191], a[128:131], v[116:119]
  ds_read_b64_tr_b16 a[182:183], v205 offset:25600
  v_lshlrev_b32 v214, 16, v43
  v_and_b32 v215, s43, v43
  v_add_f32 v198, v198, v214
  s_waitcnt lgkmcnt(8)
  v_mfma_f32_16x16x32_bf16 v[64:67], a[160:163], a[136:139], v[64:67]
  ds_read_b64_tr_b16 a[184:185], v206 offset:24576
  v_add_f32 v199, v199, v215
  v_lshlrev_b32 v214, 16, v44
  v_mfma_f32_16x16x32_bf16 v[72:75], a[160:163], a[140:143], v[72:75]
  ds_read_b64_tr_b16 a[186:187], v206 offset:25600
  v_and_b32 v215, s43, v44
  v_add_f32 v192, v192, v214
  v_add_f32 v193, v193, v215
  v_mfma_f32_16x16x32_bf16 v[76:79], a[164:167], a[140:143], v[76:79]
  ds_read_b64_tr_b16 a[188:189], v207 offset:24576
  v_lshlrev_b32 v214, 16, v45
  v_and_b32 v215, s43, v45
  v_mfma_f32_16x16x32_bf16 v[68:71], a[164:167], a[136:139], v[68:71]
  ds_read_b64_tr_b16 a[190:191], v207 offset:25600
  v_add_f32 v194, v194, v214
  v_add_f32 v195, v195, v215
  v_lshlrev_b32 v214, 16, v46
  s_waitcnt lgkmcnt(8)
  v_mfma_f32_16x16x32_bf16 v[80:83], a[168:171], a[136:139], v[80:83]
  s_waitcnt vmcnt(13)
  s_barrier
  ds_read_b64_tr_b16 a[160:161], v232 offset:16384
  v_mfma_f32_16x16x32_bf16 v[88:91], a[168:171], a[140:143], v[88:91]
  ds_read_b64_tr_b16 a[162:163], v232 offset:17408
  v_and_b32 v215, s43, v46
  v_add_f32 v196, v196, v214
  v_add_f32 v197, v197, v215
  v_mfma_f32_16x16x32_bf16 v[92:95], a[172:175], a[140:143], v[92:95]
  ds_read_b64_tr_b16 a[164:165], v233 offset:16384
  v_lshlrev_b32 v214, 16, v47
  v_and_b32 v215, s43, v47
  v_mfma_f32_16x16x32_bf16 v[84:87], a[172:175], a[136:139], v[84:87]
  ds_read_b64_tr_b16 a[166:167], v233 offset:17408
  v_add_f32 v198, v198, v214
  v_add_f32 v199, v199, v215
  v_lshlrev_b32 v214, 16, v48
  s_waitcnt lgkmcnt(8)
  v_mfma_f32_16x16x32_bf16 v[96:99], a[176:179], a[136:139], v[96:99]
  ds_read_b64_tr_b16 a[168:169], v234 offset:16384
  v_and_b32 v215, s43, v48
  v_add_f32 v192, v192, v214
  v_mfma_f32_16x16x32_bf16 v[104:107], a[176:179], a[140:143], v[104:107]
  ds_read_b64_tr_b16 a[170:171], v234 offset:17408
  v_add_f32 v193, v193, v215
  v_lshlrev_b32 v214, 16, v49
  v_and_b32 v215, s43, v49
  v_mfma_f32_16x16x32_bf16 v[108:111], a[180:183], a[140:143], v[108:111]
  ds_read_b64_tr_b16 a[172:173], v235 offset:16384
  v_add_f32 v194, v194, v214
  v_add_f32 v195, v195, v215
  v_mfma_f32_16x16x32_bf16 v[100:103], a[180:183], a[136:139], v[100:103]
  ds_read_b64_tr_b16 a[174:175], v235 offset:17408
  v_lshlrev_b32 v214, 16, v50
  v_and_b32 v215, s43, v50
  v_add_f32 v196, v196, v214
  s_waitcnt lgkmcnt(8)
  v_mfma_f32_16x16x32_bf16 v[112:115], a[184:187], a[136:139], v[112:115]
  ds_read_b64_tr_b16 a[176:177], v236 offset:16384
  v_add_f32 v197, v197, v215
  v_lshlrev_b32 v214, 16, v51
  v_mfma_f32_16x16x32_bf16 v[120:123], a[184:187], a[140:143], v[120:123]
  ds_read_b64_tr_b16 a[178:179], v236 offset:17408
  v_and_b32 v215, s43, v51
  v_add_f32 v198, v198, v214
  v_add_f32 v199, v199, v215
  v_mfma_f32_16x16x32_bf16 v[124:127], a[188:191], a[140:143], v[124:127]
  ds_read_b64_tr_b16 a[180:181], v237 offset:16384
  v_lshlrev_b32 v214, 16, v52
  v_and_b32 v215, s43, v52
  v_mfma_f32_16x16x32_bf16 v[116:119], a[188:191], a[136:139], v[116:119]
  ds_read_b64_tr_b16 a[182:183], v237 offset:17408
  v_add_f32 v192, v192, v214
  v_add_f32 v193, v193, v215
  v_lshlrev_b32 v214, 16, v53
  s_waitcnt lgkmcnt(8)
  v_mfma_f32_16x16x32_bf16 v[64:67], a[160:163], a[144:147], v[64:67]
  ds_read_b64_tr_b16 a[184:185], v238 offset:16384
  s_waitcnt vmcnt(7)
  v_cmp_gt_u32 vcc, 3, v211
  s_nop 1
  s_cbranch_vccnz PS2
PB2:
  v_mfma_f32_16x16x32_bf16 v[72:75], a[160:163], a[148:151], v[72:75]
  ds_read_b64_tr_b16 a[186:187], v238 offset:17408
  buffer_load_dwordx4 v[128:131], v226, s[8:11], s68 offen sc1
  v_mfma_f32_16x16x32_bf16 v[76:79], a[164:167], a[148:151], v[76:79]
  ds_read_b64_tr_b16 a[188:189], v239 offset:16384
  buffer_load_dwordx4 v[132:135], v226, s[8:11], s69 offen sc1
  v_mfma_f32_16x16x32_bf16 v[68:71], a[164:167], a[144:147], v[68:71]
  ds_read_b64_tr_b16 a[190:191], v239 offset:17408
  buffer_load_dwordx4 v[136:139], v226, s[8:11], s70 offen sc1
  s_waitcnt lgkmcnt(8)
  v_mfma_f32_16x16x32_bf16 v[80:83], a[168:171], a[144:147], v[80:83]
  ds_read_b64_tr_b16 a[160:161], v232 offset:24576
  buffer_load_dwordx4 v[140:143], v226, s[8:11], s71 offen sc1
  v_mfma_f32_16x16x32_bf16 v[88:91], a[168:171], a[148:151], v[88:91]
  ds_read_b64_tr_b16 a[162:163], v232 offset:25600
  buffer_load_dwordx4 v[144:147], v226, s[8:11], s72 offen sc1
  buffer_load_dwordx4 v[148:151], v226, s[8:11], s73 offen sc1
  v_mfma_f32_16x16x32_bf16 v[92:95], a[172:175], a[148:151], v[92:95]
  ds_read_b64_tr_b16 a[164:165], v233 offset:24576
  buffer_load_dwordx4 v[152:155], v226, s[8:11], s74 offen sc1
  v_mfma_f32_16x16x32_bf16 v[84:87], a[172:175], a[144:147], v[84:87]
  ds_read_b64_tr_b16 a[166:167], v233 offset:25600
  buffer_load_dwordx4 v[156:159], v226, s[8:11], s75 offen sc1
  s_waitcnt lgkmcnt(8)
  v_mfma_f32_16x16x32_bf16 v[96:99], a[176:179], a[144:147], v[96:99]
  ds_read_b64_tr_b16 a[168:169], v234 offset:24576
  v_and_b32 v215, s43, v53
  v_add_f32 v194, v194, v214
  v_mfma_f32_16x16x32_bf16 v[104:107], a[176:179], a[148:151], v[104:107]
  ds_read_b64_tr_b16 a[170:171], v234 offset:25600
  v_add_f32 v195, v195, v215
  v_lshlrev_b32 v214, 16, v54
  v_and_b32 v215, s43, v54
  v_mfma_f32_16x16x32_bf16 v[108:111], a[180:183], a[148:151], v[108:111]
  ds_read_b64_tr_b16 a[172:173], v235 offset:24576
  v_add_f32 v196, v196, v214
  v_add_f32 v197, v197, v215
  v_mfma_f32_16x16x32_bf16 v[100:103], a[180:183], a[144:147], v[100:103]
  ds_read_b64_tr_b16 a[174:175], v235 offset:25600
  v_lshlrev_b32 v214, 16, v55
  v_and_b32 v215, s43, v55
  v_add_f32 v198, v198, v214
  s_waitcnt lgkmcnt(8)
  v_mfma_f32_16x16x32_bf16 v[112:115], a[184:187], a[144:147], v[112:115]
  ds_read_b64_tr_b16 a[176:177], v236 offset:24576
  v_add_f32 v199, v199, v215
  v_lshlrev_b32 v214, 16, v56
  v_mfma_f32_16x16x32_bf16 v[120:123], a[184:187], a[148:151], v[120:123]
  ds_read_b64_tr_b16 a[178:179], v236 offset:25600
  v_and_b32 v215, s43, v56
  v_add_f32 v192, v192, v214
  v_add_f32 v193, v193, v215
  v_mfma_f32_16x16x32_bf16 v[124:127], a[188:191], a[148:151], v[124:127]
  ds_read_b64_tr_b16 a[180:181], v237 offset:24576
  v_lshlrev_b32 v214, 16, v57
  v_and_b32 v215, s43, v57
  v_mfma_f32_16x16x32_bf16 v[116:119], a[188:191], a[144:147], v[116:119]
  ds_read_b64_tr_b16 a[182:183], v237 offset:25600
  v_add_f32 v194, v194, v214
  v_add_f32 v195, v195, v215
  v_lshlrev_b32 v214, 16, v58
  s_waitcnt lgkmcnt(8)
  v_mfma_f32_16x16x32_bf16 v[64:67], a[160:163], a[152:155], v[64:67]
  ds_read_b64_tr_b16 a[184:185], v238 offset:24576
  v_and_b32 v215, s43, v58
  v_add_f32 v196, v196, v214
  v_mfma_f32_16x16x32_bf16 v[72:75], a[160:163], a[156:159], v[72:75]
  ds_read_b64_tr_b16 a[186:187], v238 offset:25600
  v_add_f32 v197, v197, v215
  v_lshlrev_b32 v214, 16, v59
  v_and_b32 v215, s43, v59
  v_mfma_f32_16x16x32_bf16 v[76:79], a[164:167], a[156:159], v[76:79]
  ds_read_b64_tr_b16 a[188:189], v239 offset:24576
  v_add_f32 v198, v198, v214
  v_add_f32 v199, v199, v215
  v_mfma_f32_16x16x32_bf16 v[68:71], a[164:167], a[152:155], v[68:71]
  ds_read_b64_tr_b16 a[190:191], v239 offset:25600
  v_lshlrev_b32 v214, 16, v60
  v_and_b32 v215, s43, v60
  v_add_f32 v192, v192, v214
  s_waitcnt lgkmcnt(8)
  v_mfma_f32_16x16x32_bf16 v[80:83], a[168:171], a[152:155], v[80:83]
  s_waitcnt vmcnt(13)
  s_barrier
  v_mov_b32 v208, 4
  buffer_store_dword v208, v231, s[12:15], 0 offen sc1
  ds_read_b64_tr_b16 a[160:161], v232 offset:32768
  v_mfma_f32_16x16x32_bf16 v[88:91], a[168:171], a[156:159], v[88:91]
  ds_read_b64_tr_b16 a[162:163], v232 offset:33792
  v_add_f32 v193, v193, v215
  v_lshlrev_b32 v214, 16, v61
  v_mfma_f32_16x16x32_bf16 v[92:95], a[172:175], a[156:159], v[92:95]
  ds_read_b64_tr_b16 a[164:165], v233 offset:32768
  v_and_b32 v215, s43, v61
  v_add_f32 v194, v194, v214
  v_mfma_f32_16x16x32_bf16 v[84:87], a[172:175], a[152:155], v[84:87]
  ds_read_b64_tr_b16 a[166:167], v233 offset:33792
  v_add_f32 v195, v195, v215
  v_lshlrev_b32 v214, 16, v62
  v_and_b32 v215, s43, v62
  s_waitcnt lgkmcnt(8)
  v_mfma_f32_16x16x32_bf16 v[96:99], a[176:179], a[152:155], v[96:99]
  ds_read_b64_tr_b16 a[168:169], v234 offset:32768
  v_add_f32 v196, v196, v214
  v_add_f32 v197, v197, v215
  v_mfma_f32_16x16x32_bf16 v[104:107], a[176:179], a[156:159], v[104:107]
  ds_read_b64_tr_b16 a[170:171], v234 offset:33792
  v_lshlrev_b32 v214, 16, v63
  v_and_b32 v215, s43, v63
  v_add_f32 v198, v198, v214
  v_mfma_f32_16x16x32_bf16 v[108:111], a[180:183], a[156:159], v[108:111]
  ds_read_b64_tr_b16 a[172:173], v235 offset:32768
  v_add_f32 v199, v199, v215
  v_cvt_pk_bf16_f32 v192, v192, v193
  v_mfma_f32_16x16x32_bf16 v[100:103], a[180:183], a[152:155], v[100:103]
  ds_read_b64_tr_b16 a[174:175], v235 offset:33792
  v_cvt_pk_bf16_f32 v193, v194, v195
  v_cvt_pk_bf16_f32 v194, v196, v197
  v_cvt_pk_bf16_f32 v195, v198, v199
  s_waitcnt lgkmcnt(8)
  v_mfma_f32_16x16x32_bf16 v[112:115], a[184:187], a[152:155], v[112:115]
  ds_read_b64_tr_b16 a[176:177], v236 offset:32768
  v_permlane16_swap_b32 v192, v194
  v_permlane16_swap_b32 v193, v195
  v_mfma_f32_16x16x32_bf16 v[120:123], a[184:187], a[156:159], v[120:123]
  ds_read_b64_tr_b16 a[178:179], v236 offset:33792
  buffer_store_dwordx4 v[192:195], v229, s[16:19], s77 offen
  v_mfma_f32_16x16x32_bf16 v[124:127], a[188:191], a[156:159], v[124:127]
  ds_read_b64_tr_b16 a[180:181], v237 offset:32768
  v_mfma_f32_16x16x32_bf16 v[116:119], a[188:191], a[152:155], v[116:119]
  ds_read_b64_tr_b16 a[182:183], v237 offset:33792
  s_waitcnt lgkmcnt(8)
  v_mfma_f32_16x16x32_bf16 v[64:67], a[160:163], v[160:163], v[64:67]
  ds_read_b64_tr_b16 a[184:185], v238 offset:32768
  v_mfma_f32_16x16x32_bf16 v[72:75], a[160:163], v[164:167], v[72:75]
  ds_read_b64_tr_b16 a[186:187], v238 offset:33792
  v_mfma_f32_16x16x32_bf16 v[76:79], a[164:167], v[164:167], v[76:79]
  ds_read_b64_tr_b16 a[188:189], v239 offset:32768
  v_mfma_f32_16x16x32_bf16 v[68:71], a[164:167], v[160:163], v[68:71]
  ds_read_b64_tr_b16 a[190:191], v239 offset:33792
  s_waitcnt lgkmcnt(8)
  v_mfma_f32_16x16x32_bf16 v[80:83], a[168:171], v[160:163], v[80:83]
  ds_read_b64_tr_b16 a[160:161], v232 offset:40960
  v_mfma_f32_16x16x32_bf16 v[88:91], a[168:171], v[164:167], v[88:91]
  ds_read_b64_tr_b16 a[162:163], v232 offset:41984
  v_mfma_f32_16x16x32_bf16 v[92:95], a[172:175], v[164:167], v[92:95]
  ds_read_b64_tr_b16 a[164:165], v233 offset:40960
  v_mfma_f32_16x16x32_bf16 v[84:87], a[172:175], v[160:163], v[84:87]
  ds_read_b64_tr_b16 a[166:167], v233 offset:41984
  s_waitcnt lgkmcnt(8)
  v_mfma_f32_16x16x32_bf16 v[96:99], a[176:179], v[160:163], v[96:99]
  ds_read_b64_tr_b16 a[168:169], v234 offset:40960
  v_mfma_f32_16x16x32_bf16 v[104:107], a[176:179], v[164:167], v[104:107]
  ds_read_b64_tr_b16 a[170:171], v234 offset:41984
  v_mfma_f32_16x16x32_bf16 v[108:111], a[180:183], v[164:167], v[108:111]
  ds_read_b64_tr_b16 a[172:173], v235 offset:40960
  v_mfma_f32_16x16x32_bf16 v[100:103], a[180:183], v[160:163], v[100:103]
  ds_read_b64_tr_b16 a[174:175], v235 offset:41984
  s_waitcnt lgkmcnt(8)
  v_mfma_f32_16x16x32_bf16 v[112:115], a[184:187], v[160:163], v[112:115]
  ds_read_b64_tr_b16 a[176:177], v236 offset:40960
  v_mfma_f32_16x16x32_bf16 v[120:123], a[184:187], v[164:167], v[120:123]
  ds_read_b64_tr_b16 a[178:179], v236 offset:41984
  v_mfma_f32_16x16x32_bf16 v[124:127], a[188:191], v[164:167], v[124:127]
  ds_read_b64_tr_b16 a[180:181], v237 offset:40960
  v_mfma_f32_16x16x32_bf16 v[116:119], a[188:191], v[160:163], v[116:119]
  ds_read_b64_tr_b16 a[182:183], v237 offset:41984
  s_waitcnt lgkmcnt(8)
  v_mfma_f32_16x16x32_bf16 v[64:67], a[160:163], v[168:171], v[64:67]
  ds_read_b64_tr_b16 a[184:185], v238 offset:40960
  v_mfma_f32_16x16x32_bf16 v[72:75], a[160:163], v[172:175], v[72:75]
  ds_read_b64_tr_b16 a[186:187], v238 offset:41984
  v_mfma_f32_16x16x32_bf16 v[76:79], a[164:167], v[172:175], v[76:79]
  ds_read_b64_tr_b16 a[188:189], v239 offset:40960
  v_mfma_f32_16x16x32_bf16 v[68:71], a[164:167], v[168:171], v[68:71]
  ds_read_b64_tr_b16 a[190:191], v239 offset:41984
  s_waitcnt lgkmcnt(8)
  v_mfma_f32_16x16x32_bf16 v[80:83], a[168:171], v[168:171], v[80:83]
  s_waitcnt vmcnt(11)
  s_barrier
  ds_read_b64_tr_b16 a[160:161], v232 offset:49152
  v_mfma_f32_16x16x32_bf16 v[88:91], a[168:171], v[172:175], v[88:91]
  ds_read_b64_tr_b16 a[162:163], v232 offset:50176
  v_mfma_f32_16x16x32_bf16 v[92:95], a[172:175], v[172:175], v[92:95]
  ds_read_b64_tr_b16 a[164:165], v233 offset:49152
  v_mfma_f32_16x16x32_bf16 v[84:87], a[172:175], v[168:171], v[84:87]
  ds_read_b64_tr_b16 a[166:167], v233 offset:50176
  s_waitcnt lgkmcnt(8)
  v_mfma_f32_16x16x32_bf16 v[96:99], a[176:179], v[168:171], v[96:99]
  ds_read_b64_tr_b16 a[168:169], v232 offset:57344
  v_mfma_f32_16x16x32_bf16 v[104:107], a[176:179], v[172:175], v[104:107]
  ds_read_b64_tr_b16 a[170:171], v232 offset:58368
  v_mfma_f32_16x16x32_bf16 v[108:111], a[180:183], v[172:175], v[108:111]
  ds_read_b64_tr_b16 a[172:173], v233 offset:57344
  v_mfma_f32_16x16x32_bf16 v[100:103], a[180:183], v[168:171], v[100:103]
  ds_read_b64_tr_b16 a[174:175], v233 offset:58368
  s_waitcnt lgkmcnt(8)
  v_mfma_f32_16x16x32_bf16 v[112:115], a[184:187], v[168:171], v[112:115]
  ds_read_b64_tr_b16 a[176:177], v234 offset:49152
  v_mfma_f32_16x16x32_bf16 v[120:123], a[184:187], v[172:175], v[120:123]
  ds_read_b64_tr_b16 a[178:179], v234 offset:50176
  v_mfma_f32_16x16x32_bf16 v[124:127], a[188:191], v[172:175], v[124:127]
  ds_read_b64_tr_b16 a[180:181], v235 offset:49152
  v_mfma_f32_16x16x32_bf16 v[116:119], a[188:191], v[168:171], v[116:119]
  ds_read_b64_tr_b16 a[182:183], v235 offset:50176
  s_waitcnt lgkmcnt(8)
  v_mfma_f32_16x16x32_bf16 v[64:67], a[160:163], v[176:179], v[64:67]
  ds_read_b64_tr_b16 a[184:185], v234 offset:57344
  v_mfma_f32_16x16x32_bf16 v[72:75], a[160:163], v[180:183], v[72:75]
  ds_read_b64_tr_b16 a[186:187], v234 offset:58368
  v_mfma_f32_16x16x32_bf16 v[76:79], a[164:167], v[180:183], v[76:79]
  ds_read_b64_tr_b16 a[188:189], v235 offset:57344
  v_mfma_f32_16x16x32_bf16 v[68:71], a[164:167], v[176:179], v[68:71]
  ds_read_b64_tr_b16 a[190:191], v235 offset:58368
  s_waitcnt lgkmcnt(8)
  v_mfma_f32_16x16x32_bf16 v[64:67], a[168:171], v[184:187], v[64:67]
  ds_read_b64_tr_b16 a[160:161], v236 offset:49152
  v_mfma_f32_16x16x32_bf16 v[72:75], a[168:171], v[188:191], v[72:75]
  ds_read_b64_tr_b16 a[162:163], v236 offset:50176
  v_mfma_f32_16x16x32_bf16 v[76:79], a[172:175], v[188:191], v[76:79]
  ds_read_b64_tr_b16 a[164:165], v237 offset:49152
  v_mfma_f32_16x16x32_bf16 v[68:71], a[172:175], v[184:187], v[68:71]
  ds_read_b64_tr_b16 a[166:167], v237 offset:50176
  s_waitcnt lgkmcnt(8)
  v_mfma_f32_16x16x32_bf16 v[80:83], a[176:179], v[176:179], v[80:83]
  ds_read_b64_tr_b16 a[168:169], v236 offset:57344
  v_mfma_f32_16x16x32_bf16 v[88:91], a[176:179], v[180:183], v[88:91]
  ds_read_b64_tr_b16 a[170:171], v236 offset:58368
  v_mfma_f32_16x16x32_bf16 v[92:95], a[180:183], v[180:183], v[92:95]
  ds_read_b64_tr_b16 a[172:173], v237 offset:57344
  v_mfma_f32_16x16x32_bf16 v[84:87], a[180:183], v[176:179], v[84:87]
  ds_read_b64_tr_b16 a[174:175], v237 offset:58368
  s_waitcnt lgkmcnt(8)
  v_mfma_f32_16x16x32_bf16 v[80:83], a[184:187], v[184:187], v[80:83]
  ds_read_b64_tr_b16 a[176:177], v238 offset:49152
  s_mov_b32 s46, 32768
  v_cvt_pk_bf16_f32 v64, v64, v65
  v_mfma_f32_16x16x32_bf16 v[88:91], a[184:187], v[188:191], v[88:91]
  ds_read_b64_tr_b16 a[178:179], v238 offset:50176
  v_cvt_pk_bf16_f32 v65, v66, v67
  v_cvt_pk_bf16_f32 v66, v68, v69
  v_cvt_pk_bf16_f32 v67, v70, v71
  buffer_store_dwordx4 v[64:67], v252, s[28:31], s46 offen offset:0 sc1
  v_cvt_pk_bf16_f32 v72, v72, v73
  v_cvt_pk_bf16_f32 v73, v74, v75
  v_cvt_pk_bf16_f32 v74, v76, v77
  v_cvt_pk_bf16_f32 v75, v78, v79
  buffer_store_dwordx4 v[72:75], v252, s[28:31], s46 offen offset:1024 sc1
  v_mfma_f32_16x16x32_bf16 v[92:95], a[188:191], v[188:191], v[92:95]
  ds_read_b64_tr_b16 a[180:181], v239 offset:49152
  v_mfma_f32_16x16x32_bf16 v[84:87], a[188:191], v[184:187], v[84:87]
  ds_read_b64_tr_b16 a[182:183], v239 offset:50176
  s_waitcnt lgkmcnt(8)
  v_mfma_f32_16x16x32_bf16 v[96:99], a[160:163], v[176:179], v[96:99]
  ds_read_b64_tr_b16 a[184:185], v238 offset:57344
  v_mfma_f32_16x16x32_bf16 v[104:107], a[160:163], v[180:183], v[104:107]
  ds_read_b64_tr_b16 a[186:187], v238 offset:58368
  v_mfma_f32_16x16x32_bf16 v[108:111], a[164:167], v[180:183], v[108:111]
  ds_read_b64_tr_b16 a[188:189], v239 offset:57344
  v_mfma_f32_16x16x32_bf16 v[100:103], a[164:167], v[176:179], v[100:103]
  ds_read_b64_tr_b16 a[190:191], v239 offset:58368
  s_waitcnt lgkmcnt(8)
  v_mfma_f32_16x16x32_bf16 v[96:99], a[168:171], v[184:187], v[96:99]
  v_cvt_pk_bf16_f32 v80, v80, v81
  v_cvt_pk_bf16_f32 v81, v82, v83
  v_cvt_pk_bf16_f32 v82, v84, v85
  v_mfma_f32_16x16x32_bf16 v[104:107], a[168:171], v[188:191], v[104:107]
  v_cvt_pk_bf16_f32 v83, v86, v87
  buffer_store_dwordx4 v[80:83], v252, s[28:31], s46 offen offset:2048 sc1
  v_cvt_pk_bf16_f32 v88, v88, v89
  v_cvt_pk_bf16_f32 v89, v90, v91
  v_cvt_pk_bf16_f32 v90, v92, v93
  v_cvt_pk_bf16_f32 v91, v94, v95
  buffer_store_dwordx4 v[88:91], v252, s[28:31], s46 offen offset:3072 sc1
  v_mfma_f32_16x16x32_bf16 v[108:111], a[172:175], v[188:191], v[108:111]
  v_mfma_f32_16x16x32_bf16 v[100:103], a[172:175], v[184:187], v[100:103]
  s_waitcnt lgkmcnt(4)
  v_mfma_f32_16x16x32_bf16 v[112:115], a[176:179], v[176:179], v[112:115]
  v_mfma_f32_16x16x32_bf16 v[120:123], a[176:179], v[180:183], v[120:123]
  v_mfma_f32_16x16x32_bf16 v[124:127], a[180:183], v[180:183], v[124:127]
  v_mfma_f32_16x16x32_bf16 v[116:119], a[180:183], v[176:179], v[116:119]
  s_waitcnt lgkmcnt(0)
  v_mfma_f32_16x16x32_bf16 v[112:115], a[184:187], v[184:187], v[112:115]
  s_mov_b32 s46, 36864
  v_cvt_pk_bf16_f32 v96, v96, v97
  v_cvt_pk_bf16_f32 v97, v98, v99
  v_mfma_f32_16x16x32_bf16 v[120:123], a[184:187], v[188:191], v[120:123]
  v_cvt_pk_bf16_f32 v98, v100, v101
  v_cvt_pk_bf16_f32 v99, v102, v103
  buffer_store_dwordx4 v[96:99], v252, s[28:31], s46 offen offset:0 sc1
  v_cvt_pk_bf16_f32 v104, v104, v105
  v_cvt_pk_bf16_f32 v105, v106, v107
  v_cvt_pk_bf16_f32 v106, v108, v109
  v_cvt_pk_bf16_f32 v107, v110, v111
  buffer_store_dwordx4 v[104:107], v252, s[28:31], s46 offen offset:1024 sc1
  v_mfma_f32_16x16x32_bf16 v[124:127], a[188:191], v[188:191], v[124:127]
  v_mfma_f32_16x16x32_bf16 v[116:119], a[188:191], v[184:187], v[116:119]
  v_cvt_pk_bf16_f32 v112, v112, v113
  v_cvt_pk_bf16_f32 v113, v114, v115
  s_nop 5
  v_cvt_pk_bf16_f32 v114, v116, v117
  v_cvt_pk_bf16_f32 v115, v118, v119
  buffer_store_dwordx4 v[112:115], v252, s[28:31], s46 offen offset:2048 sc1
  v_cvt_pk_bf16_f32 v120, v120, v121
  v_cvt_pk_bf16_f32 v121, v122, v123
  v_cvt_pk_bf16_f32 v122, v124, v125
  v_cvt_pk_bf16_f32 v123, v126, v127
  buffer_store_dwordx4 v[120:123], v252, s[28:31], s46 offen offset:3072 sc1
  s_waitcnt vmcnt(17)
  v_lshlrev_b32 v192, 16, v128
  v_and_b32 v193, s43, v128
  v_lshlrev_b32 v194, 16, v129
  v_and_b32 v195, s43, v129
  v_lshlrev_b32 v196, 16, v130
  v_and_b32 v197, s43, v130
  v_lshlrev_b32 v198, 16, v131
  v_and_b32 v199, s43, v131
  s_waitcnt vmcnt(16)
  v_lshlrev_b32 v214, 16, v132
  v_and_b32 v215, s43, v132
  v_add_f32 v192, v192, v214
  v_add_f32 v193, v193, v215
  v_lshlrev_b32 v214, 16, v133
  v_and_b32 v215, s43, v133
  v_add_f32 v194, v194, v214
  v_add_f32 v195, v195, v215
  v_lshlrev_b32 v214, 16, v134
  v_and_b32 v215, s43, v134
  v_add_f32 v196, v196, v214
  v_add_f32 v197, v197, v215
  v_lshlrev_b32 v214, 16, v135
  v_and_b32 v215, s43, v135
  v_add_f32 v198, v198, v214
  v_add_f32 v199, v199, v215
  s_waitcnt vmcnt(15)
  v_lshlrev_b32 v214, 16, v136
  v_and_b32 v215, s43, v136
  v_add_f32 v192, v192, v214
  v_add_f32 v193, v193, v215
  v_lshlrev_b32 v214, 16, v137
  v_and_b32 v215, s43, v137
  v_add_f32 v194, v194, v214
  v_add_f32 v195, v195, v215
  v_lshlrev_b32 v214, 16, v138
  v_and_b32 v215, s43, v138
  v_add_f32 v196, v196, v214
  v_add_f32 v197, v197, v215
  v_lshlrev_b32 v214, 16, v139
  v_and_b32 v215, s43, v139
  v_add_f32 v198, v198, v214
  v_add_f32 v199, v199, v215
  s_waitcnt vmcnt(14)
  v_lshlrev_b32 v214, 16, v140
  v_and_b32 v215, s43, v140
  v_add_f32 v192, v192, v214
  v_add_f32 v193, v193, v215
  v_lshlrev_b32 v214, 16, v141
  v_and_b32 v215, s43, v141
  v_add_f32 v194, v194, v214
  v_add_f32 v195, v195, v215
  v_lshlrev_b32 v214, 16, v142
  v_and_b32 v215, s43, v142
  v_add_f32 v196, v196, v214
  v_add_f32 v197, v197, v215
  v_lshlrev_b32 v214, 16, v143
  v_and_b32 v215, s43, v143
  v_add_f32 v198, v198, v214
  v_add_f32 v199, v199, v215
  s_waitcnt vmcnt(13)
  v_lshlrev_b32 v214, 16, v144
  v_and_b32 v215, s43, v144
  v_add_f32 v192, v192, v214
  v_add_f32 v193, v193, v215
  v_lshlrev_b32 v214, 16, v145
  v_and_b32 v215, s43, v145
  v_add_f32 v194, v194, v214
  v_add_f32 v195, v195, v215
  v_lshlrev_b32 v214, 16, v146
  v_and_b32 v215, s43, v146
  v_add_f32 v196, v196, v214
  v_add_f32 v197, v197, v215
  v_lshlrev_b32 v214, 16, v147
  v_and_b32 v215, s43, v147
  v_add_f32 v198, v198, v214
  v_add_f32 v199, v199, v215
  s_waitcnt vmcnt(12)
  v_lshlrev_b32 v214, 16, v148
  v_and_b32 v215, s43, v148
  v_add_f32 v192, v192, v214
  v_add_f32 v193, v193, v215
  v_lshlrev_b32 v214, 16, v149
  v_and_b32 v215, s43, v149
  v_add_f32 v194, v194, v214
  v_add_f32 v195, v195, v215
  v_lshlrev_b32 v214, 16, v150
  v_and_b32 v215, s43, v150
  v_add_f32 v196, v196, v214
  v_add_f32 v197, v197, v215
  v_lshlrev_b32 v214, 16, v151
  v_and_b32 v215, s43, v151
  v_add_f32 v198, v198, v214
  v_add_f32 v199, v199, v215
  s_waitcnt vmcnt(11)
  v_lshlrev_b32 v214, 16, v152
  v_and_b32 v215, s43, v152
  v_add_f32 v192, v192, v214
  v_add_f32 v193, v193, v215
  v_lshlrev_b32 v214, 16, v153
  v_and_b32 v215, s43, v153
  v_add_f32 v194, v194, v214
  v_add_f32 v195, v195, v215
  v_lshlrev_b32 v214, 16, v154
  v_and_b32 v215, s43, v154
  v_add_f32 v196, v196, v214
  v_add_f32 v197, v197, v215
  v_lshlrev_b32 v214, 16, v155
  v_and_b32 v215, s43, v155
  v_add_f32 v198, v198, v214
  v_add_f32 v199, v199, v215
  s_waitcnt vmcnt(10)
  v_lshlrev_b32 v214, 16, v156
  v_and_b32 v215, s43, v156
  v_add_f32 v192, v192, v214
  v_add_f32 v193, v193, v215
  v_lshlrev_b32 v214, 16, v157
  v_and_b32 v215, s43, v157
  v_add_f32 v194, v194, v214
  v_add_f32 v195, v195, v215
  v_lshlrev_b32 v214, 16, v158
  v_and_b32 v215, s43, v158
  v_add_f32 v196, v196, v214
  v_add_f32 v197, v197, v215
  v_lshlrev_b32 v214, 16, v159
  v_and_b32 v215, s43, v159
  v_add_f32 v198, v198, v214
  v_add_f32 v199, v199, v215
  v_cvt_pk_bf16_f32 v192, v192, v193
  v_cvt_pk_bf16_f32 v193, v194, v195
  v_cvt_pk_bf16_f32 v194, v196, v197
  v_cvt_pk_bf16_f32 v195, v198, v199
  s_nop 0
  v_permlane16_swap_b32 v192, v194
  v_permlane16_swap_b32 v193, v195
  buffer_store_dwordx4 v[192:195], v229, s[16:19], s78 offen
  s_waitcnt vmcnt(1)
  s_barrier
  v_mov_b32 v208, 5
  buffer_store_dword v208, v231, s[12:15], 0 offen sc1
  buffer_load_dword v212, v230, s[24:27], 0 offen sc1
  s_waitcnt vmcnt(0)
  v_cmp_gt_u32 vcc, 4, v212
  s_nop 1
  s_cbranch_vccnz PS3
PB3:
  buffer_load_dwordx4 v[0:3], v227, s[8:11], s68 offen sc1
  buffer_load_dwordx4 v[4:7], v227, s[8:11], s69 offen sc1
  buffer_load_dwordx4 v[8:11], v227, s[8:11], s70 offen sc1
  buffer_load_dwordx4 v[12:15], v227, s[8:11], s71 offen sc1
  buffer_load_dwordx4 v[16:19], v227, s[8:11], s72 offen sc1
  buffer_load_dwordx4 v[20:23], v227, s[8:11], s73 offen sc1
  buffer_load_dwordx4 v[24:27], v227, s[8:11], s74 offen sc1
  buffer_load_dwordx4 v[28:31], v227, s[8:11], s75 offen sc1
  buffer_load_dword v213, v230, s[24:27], 0 offen sc1
  s_waitcnt vmcnt(0)
  v_cmp_gt_u32 vcc, 5, v213
  s_nop 1
  s_cbranch_vccnz PS4
PB4:
  buffer_load_dwordx4 v[32:35], v228, s[8:11], s68 offen sc1
  buffer_load_dwordx4 v[36:39], v228, s[8:11], s69 offen sc1
  buffer_load_dwordx4 v[40:43], v228, s[8:11], s70 offen sc1
  buffer_load_dwordx4 v[44:47], v228, s[8:11], s71 offen sc1
  buffer_load_dwordx4 v[48:51], v228, s[8:11], s72 offen sc1
  buffer_load_dwordx4 v[52:55], v228, s[8:11], s73 offen sc1
  buffer_load_dwordx4 v[56:59], v228, s[8:11], s74 offen sc1
  buffer_load_dwordx4 v[60:63], v228, s[8:11], s75 offen sc1
  v_lshlrev_b32 v192, 16, v0
  v_and_b32 v193, s43, v0
  v_lshlrev_b32 v194, 16, v1
  v_and_b32 v195, s43, v1
  v_lshlrev_b32 v196, 16, v2
  v_and_b32 v197, s43, v2
  v_lshlrev_b32 v198, 16, v3
  v_and_b32 v199, s43, v3
  v_lshlrev_b32 v200, 16, v4
  v_and_b32 v201, s43, v4
  v_lshlrev_b32 v202, 16, v5
  v_and_b32 v203, s43, v5
  v_lshlrev_b32 v204, 16, v6
  v_and_b32 v205, s43, v6
  v_lshlrev_b32 v206, 16, v7
  v_and_b32 v207, s43, v7
  v_pk_add_f32 v[192:193], v[192:193], v[200:201]
  v_pk_add_f32 v[194:195], v[194:195], v[202:203]
  v_pk_add_f32 v[196:197], v[196:197], v[204:205]
  v_pk_add_f32 v[198:199], v[198:199], v[206:207]
  v_lshlrev_b32 v200, 16, v8
  v_and_b32 v201, s43, v8
  v_lshlrev_b32 v202, 16, v9
  v_and_b32 v203, s43, v9
  v_lshlrev_b32 v204, 16, v10
  v_and_b32 v205, s43, v10
  v_lshlrev_b32 v206, 16, v11
  v_and_b32 v207, s43, v11
  v_pk_add_f32 v[192:193], v[192:193], v[200:201]
  v_pk_add_f32 v[194:195], v[194:195], v[202:203]
  v_pk_add_f32 v[196:197], v[196:197], v[204:205]
  v_pk_add_f32 v[198:199], v[198:199], v[206:207]
  v_lshlrev_b32 v200, 16, v12
  v_and_b32 v201, s43, v12
  v_lshlrev_b32 v202, 16, v13
  v_and_b32 v203, s43, v13
  v_lshlrev_b32 v204, 16, v14
  v_and_b32 v205, s43, v14
  v_lshlrev_b32 v206, 16, v15
  v_and_b32 v207, s43, v15
  v_pk_add_f32 v[192:193], v[192:193], v[200:201]
  v_pk_add_f32 v[194:195], v[194:195], v[202:203]
  v_pk_add_f32 v[196:197], v[196:197], v[204:205]
  v_pk_add_f32 v[198:199], v[198:199], v[206:207]
  v_lshlrev_b32 v200, 16, v16
  v_and_b32 v201, s43, v16
  v_lshlrev_b32 v202, 16, v17
  v_and_b32 v203, s43, v17
  v_lshlrev_b32 v204, 16, v18
  v_and_b32 v205, s43, v18
  v_lshlrev_b32 v206, 16, v19
  v_and_b32 v207, s43, v19
  v_pk_add_f32 v[192:193], v[192:193], v[200:201]
  v_pk_add_f32 v[194:195], v[194:195], v[202:203]
  v_pk_add_f32 v[196:197], v[196:197], v[204:205]
  v_pk_add_f32 v[198:199], v[198:199], v[206:207]
  v_lshlrev_b32 v200, 16, v20
  v_and_b32 v201, s43, v20
  v_lshlrev_b32 v202, 16, v21
  v_and_b32 v203, s43, v21
  v_lshlrev_b32 v204, 16, v22
  v_and_b32 v205, s43, v22
  v_lshlrev_b32 v206, 16, v23
  v_and_b32 v207, s43, v23
  v_pk_add_f32 v[192:193], v[192:193], v[200:201]
  v_pk_add_f32 v[194:195], v[194:195], v[202:203]
  v_pk_add_f32 v[196:197], v[196:197], v[204:205]
  v_pk_add_f32 v[198:199], v[198:199], v[206:207]
  v_lshlrev_b32 v200, 16, v24
  v_and_b32 v201, s43, v24
  v_lshlrev_b32 v202, 16, v25
  v_and_b32 v203, s43, v25
  v_lshlrev_b32 v204, 16, v26
  v_and_b32 v205, s43, v26
  v_lshlrev_b32 v206, 16, v27
  v_and_b32 v207, s43, v27
  v_pk_add_f32 v[192:193], v[192:193], v[200:201]
  v_pk_add_f32 v[194:195], v[194:195], v[202:203]
  v_pk_add_f32 v[196:197], v[196:197], v[204:205]
  v_pk_add_f32 v[198:199], v[198:199], v[206:207]
  v_lshlrev_b32 v200, 16, v28
  v_and_b32 v201, s43, v28
  v_lshlrev_b32 v202, 16, v29
  v_and_b32 v203, s43, v29
  v_lshlrev_b32 v204, 16, v30
  v_and_b32 v205, s43, v30
  v_lshlrev_b32 v206, 16, v31
  v_and_b32 v207, s43, v31
  v_pk_add_f32 v[192:193], v[192:193], v[200:201]
  v_pk_add_f32 v[194:195], v[194:195], v[202:203]
  v_pk_add_f32 v[196:197], v[196:197], v[204:205]
  v_pk_add_f32 v[198:199], v[198:199], v[206:207]
  v_cvt_pk_bf16_f32 v192, v192, v193
  v_cvt_pk_bf16_f32 v193, v194, v195
  v_cvt_pk_bf16_f32 v194, v196, v197
  v_cvt_pk_bf16_f32 v195, v198, v199
  s_nop 0
  v_permlane16_swap_b32 v192, v194
  v_permlane16_swap_b32 v193, v195
  buffer_store_dwordx4 v[192:195], v229, s[16:19], s79 offen
  s_waitcnt vmcnt(8)
  s_nop 0
  v_lshlrev_b32 v192, 16, v32
  v_and_b32 v193, s43, v32
  v_lshlrev_b32 v194, 16, v33
  v_and_b32 v195, s43, v33
  v_lshlrev_b32 v196, 16, v34
  v_and_b32 v197, s43, v34
  v_lshlrev_b32 v198, 16, v35
  v_and_b32 v199, s43, v35
  s_waitcnt vmcnt(7)
  v_lshlrev_b32 v200, 16, v36
  v_and_b32 v201, s43, v36
  v_lshlrev_b32 v202, 16, v37
  v_and_b32 v203, s43, v37
  v_lshlrev_b32 v204, 16, v38
  v_and_b32 v205, s43, v38
  v_lshlrev_b32 v206, 16, v39
  v_and_b32 v207, s43, v39
  v_pk_add_f32 v[192:193], v[192:193], v[200:201]
  v_pk_add_f32 v[194:195], v[194:195], v[202:203]
  v_pk_add_f32 v[196:197], v[196:197], v[204:205]
  v_pk_add_f32 v[198:199], v[198:199], v[206:207]
  s_waitcnt vmcnt(6)
  v_lshlrev_b32 v200, 16, v40
  v_and_b32 v201, s43, v40
  v_lshlrev_b32 v202, 16, v41
  v_and_b32 v203, s43, v41
  v_lshlrev_b32 v204, 16, v42
  v_and_b32 v205, s43, v42
  v_lshlrev_b32 v206, 16, v43
  v_and_b32 v207, s43, v43
  v_pk_add_f32 v[192:193], v[192:193], v[200:201]
  v_pk_add_f32 v[194:195], v[194:195], v[202:203]
  v_pk_add_f32 v[196:197], v[196:197], v[204:205]
  v_pk_add_f32 v[198:199], v[198:199], v[206:207]
  s_waitcnt vmcnt(5)
  v_lshlrev_b32 v200, 16, v44
  v_and_b32 v201, s43, v44
  v_lshlrev_b32 v202, 16, v45
  v_and_b32 v203, s43, v45
  v_lshlrev_b32 v204, 16, v46
  v_and_b32 v205, s43, v46
  v_lshlrev_b32 v206, 16, v47
  v_and_b32 v207, s43, v47
  v_pk_add_f32 v[192:193], v[192:193], v[200:201]
  v_pk_add_f32 v[194:195], v[194:195], v[202:203]
  v_pk_add_f32 v[196:197], v[196:197], v[204:205]
  v_pk_add_f32 v[198:199], v[198:199], v[206:207]
  s_waitcnt vmcnt(4)
  v_lshlrev_b32 v200, 16, v48
  v_and_b32 v201, s43, v48
  v_lshlrev_b32 v202, 16, v49
  v_and_b32 v203, s43, v49
  v_lshlrev_b32 v204, 16, v50
  v_and_b32 v205, s43, v50
  v_lshlrev_b32 v206, 16, v51
  v_and_b32 v207, s43, v51
  v_pk_add_f32 v[192:193], v[192:193], v[200:201]
  v_pk_add_f32 v[194:195], v[194:195], v[202:203]
  v_pk_add_f32 v[196:197], v[196:197], v[204:205]
  v_pk_add_f32 v[198:199], v[198:199], v[206:207]
  s_waitcnt vmcnt(3)
  v_lshlrev_b32 v200, 16, v52
  v_and_b32 v201, s43, v52
  v_lshlrev_b32 v202, 16, v53
  v_and_b32 v203, s43, v53
  v_lshlrev_b32 v204, 16, v54
  v_and_b32 v205, s43, v54
  v_lshlrev_b32 v206, 16, v55
  v_and_b32 v207, s43, v55
  v_pk_add_f32 v[192:193], v[192:193], v[200:201]
  v_pk_add_f32 v[194:195], v[194:195], v[202:203]
  v_pk_add_f32 v[196:197], v[196:197], v[204:205]
  v_pk_add_f32 v[198:199], v[198:199], v[206:207]
  s_waitcnt vmcnt(2)
  v_lshlrev_b32 v200, 16, v56
  v_and_b32 v201, s43, v56
  v_lshlrev_b32 v202, 16, v57
  v_and_b32 v203, s43, v57
  v_lshlrev_b32 v204, 16, v58
  v_and_b32 v205, s43, v58
  v_lshlrev_b32 v206, 16, v59
  v_and_b32 v207, s43, v59
  v_pk_add_f32 v[192:193], v[192:193], v[200:201]
  v_pk_add_f32 v[194:195], v[194:195], v[202:203]
  v_pk_add_f32 v[196:197], v[196:197], v[204:205]
  v_pk_add_f32 v[198:199], v[198:199], v[206:207]
  s_waitcnt vmcnt(1)
  v_lshlrev_b32 v200, 16, v60
  v_and_b32 v201, s43, v60
  v_lshlrev_b32 v202, 16, v61
  v_and_b32 v203, s43, v61
  v_lshlrev_b32 v204, 16, v62
  v_and_b32 v205, s43, v62
  v_lshlrev_b32 v206, 16, v63
  v_and_b32 v207, s43, v63
  v_pk_add_f32 v[192:193], v[192:193], v[200:201]
  v_pk_add_f32 v[194:195], v[194:195], v[202:203]
  v_pk_add_f32 v[196:197], v[196:197], v[204:205]
  v_pk_add_f32 v[198:199], v[198:199], v[206:207]
  v_cvt_pk_bf16_f32 v192, v192, v193
  v_cvt_pk_bf16_f32 v193, v194, v195
  v_cvt_pk_bf16_f32 v194, v196, v197
  v_cvt_pk_bf16_f32 v195, v198, v199
  s_nop 0
  v_permlane16_swap_b32 v192, v194
  v_permlane16_swap_b32 v193, v195
  buffer_store_dwordx4 v[192:195], v229, s[16:19], s80 offen
STOUT:
KEND:
  s_endpgm
SITE22:
  s_mov_b32 s36, 22
  s_branch RARE0
SITE27:
  s_mov_b32 s36, 27
  s_branch RARE0
SITE32:
  s_mov_b32 s36, 32
  s_branch RARE0
SITE48:
  s_mov_b32 s36, 48
  s_branch RARE0
SITE53:
  s_mov_b32 s36, 53
  s_branch RARE0
SITE58:
  s_mov_b32 s36, 58
  s_branch RARE0
SITE74:
  s_mov_b32 s36, 74
  s_branch RARE0
SITE79:
  s_mov_b32 s36, 79
  s_branch RARE0
SITE84:
  s_mov_b32 s36, 84
  s_branch RARE0
SITE100:
  s_mov_b32 s36, 100
  s_branch RARE0
SITE106:
  s_mov_b32 s36, 106
  s_branch RARE0
SITE113:
  s_mov_b32 s36, 113
  s_branch RARE0
SITE19:
  s_mov_b32 s36, 19
  s_branch RARE1
SITE25:
  s_mov_b32 s36, 25
  s_branch RARE1
SITE30:
  s_mov_b32 s36, 30
  s_branch RARE1
SITE35:
  s_mov_b32 s36, 35
  s_branch RARE1
SITE45:
  s_mov_b32 s36, 45
  s_branch RARE1
SITE51:
  s_mov_b32 s36, 51
  s_branch RARE1
SITE56:
  s_mov_b32 s36, 56
  s_branch RARE1
SITE61:
  s_mov_b32 s36, 61
  s_branch RARE1
SITE71:
  s_mov_b32 s36, 71
  s_branch RARE1
SITE77:
  s_mov_b32 s36, 77
  s_branch RARE1
SITE82:
  s_mov_b32 s36, 82
  s_branch RARE1
SITE87:
  s_mov_b32 s36, 87
  s_branch RARE1
SITE97:
  s_mov_b32 s36, 97
  s_branch RARE1
SITE103:
  s_mov_b32 s36, 103
  s_branch RARE1
SITE109:
  s_mov_b32 s36, 109
  s_branch RARE1
SITE115:
  s_mov_b32 s36, 115
  s_branch RARE1
PS1:
  buffer_load_dword v210, v230, s[24:27], 0 offen sc1
  s_waitcnt vmcnt(0)
  v_cmp_gt_u32 vcc, 2, v210
  s_nop 4
  s_cbranch_vccnz PS1
  s_branch PB1
PS2:
  buffer_load_dword v211, v230, s[24:27], 0 offen sc1
  s_waitcnt vmcnt(0)
  v_cmp_gt_u32 vcc, 3, v211
  s_nop 4
  s_cbranch_vccnz PS2
  s_branch PB2
PS3:
  buffer_load_dword v212, v230, s[24:27], 0 offen sc1
  s_waitcnt vmcnt(0)
  v_cmp_gt_u32 vcc, 4, v212
  s_nop 4
  s_cbranch_vccnz PS3
  s_branch PB3
PS4:
  buffer_load_dword v213, v230, s[24:27], 0 offen sc1
  s_waitcnt vmcnt(0)
  v_cmp_gt_u32 vcc, 5, v213
  s_nop 4
  s_cbranch_vccnz PS4
  s_branch PB4
PSA:
  buffer_load_dword v248, v231, s[84:87], 0 offen sc1
  s_waitcnt vmcnt(0)
  v_readfirstlane_b32 s49, v248
  s_nop 3
  s_cmp_lt_u32 s49, s44
  s_cbranch_scc1 PSA
  s_branch PBA
CEND:
RARE0:
  s_nop 7
  s_nop 4
  s_nop 7
  s_nop 4
  v_max3_f32 v214, v64, v65, v66
  v_max3_f32 v215, v72, v73, v74
  v_max3_f32 v214, v214, v67, v68
  v_max3_f32 v215, v215, v75, v76
  v_max3_f32 v214, v214, v69, v70
  v_max3_f32 v215, v215, v77, v78
  v_max3_f32 v214, v214, v71, v80
  v_max3_f32 v215, v215, v79, v88
  v_max3_f32 v214, v214, v81, v82
  v_max3_f32 v215, v215, v89, v90
  v_max3_f32 v214, v214, v83, v84
  v_max3_f32 v215, v215, v91, v92
  v_max3_f32 v214, v214, v85, v86
  v_max3_f32 v215, v215, v93, v94
  v_max_f32 v214, v214, v87
  v_max_f32 v215, v215, v95
  s_nop 1
  v_permlane16_swap_b32 v214, v215
  v_max_f32 v214, v214, v215
  v_mov_b32 v215, v214
  s_nop 1
  v_permlane32_swap_b32 v214, v215
  v_max3_f32 v214, v214, v215, 0
  v_mov_b32 v215, v214
  s_nop 1
  v_permlane16_swap_b32 v214, v215
  v_sub_f32 v64, v64, v214
  v_sub_f32 v96, v96, v214
  v_sub_f32 v65, v65, v214
  v_sub_f32 v97, v97, v214
  v_sub_f32 v66, v66, v214
  v_sub_f32 v98, v98, v214
  v_sub_f32 v67, v67, v214
  v_sub_f32 v99, v99, v214
  v_sub_f32 v68, v68, v214
  v_sub_f32 v100, v100, v214
  v_sub_f32 v69, v69, v214
  v_sub_f32 v101, v101, v214
  v_sub_f32 v70, v70, v214
  v_sub_f32 v102, v102, v214
  v_sub_f32 v71, v71, v214
  v_sub_f32 v103, v103, v214
  v_sub_f32 v72, v72, v215
  v_sub_f32 v104, v104, v215
  v_sub_f32 v73, v73, v215
  v_sub_f32 v105, v105, v215
  v_sub_f32 v74, v74, v215
  v_sub_f32 v106, v106, v215
  v_sub_f32 v75, v75, v215
  v_sub_f32 v107, v107, v215
  v_sub_f32 v76, v76, v215
  v_sub_f32 v108, v108, v215
  v_sub_f32 v77, v77, v215
  v_sub_f32 v109, v109, v215
  v_sub_f32 v78, v78, v215
  v_sub_f32 v110, v110, v215
  v_sub_f32 v79, v79, v215
  v_sub_f32 v111, v111, v215
  v_sub_f32 v80, v80, v214
  v_sub_f32 v112, v112, v214
  v_sub_f32 v81, v81, v214
  v_sub_f32 v113, v113, v214
  v_sub_f32 v82, v82, v214
  v_sub_f32 v114, v114, v214
  v_sub_f32 v83, v83, v214
  v_sub_f32 v115, v115, v214
  v_sub_f32 v84, v84, v214
  v_sub_f32 v116, v116, v214
  v_sub_f32 v85, v85, v214
  v_sub_f32 v117, v117, v214
  v_sub_f32 v86, v86, v214
  v_sub_f32 v118, v118, v214
  v_sub_f32 v87, v87, v214
  v_sub_f32 v119, v119, v214
  v_sub_f32 v88, v88, v215
  v_sub_f32 v120, v120, v215
  v_sub_f32 v89, v89, v215
  v_sub_f32 v121, v121, v215
  v_sub_f32 v90, v90, v215
  v_sub_f32 v122, v122, v215
  v_sub_f32 v91, v91, v215
  v_sub_f32 v123, v123, v215
  v_sub_f32 v92, v92, v215
  v_sub_f32 v124, v124, v215
  v_sub_f32 v93, v93, v215
  v_sub_f32 v125, v125, v215
  v_sub_f32 v94, v94, v215
  v_sub_f32 v126, v126, v215
  v_sub_f32 v95, v95, v215
  v_sub_f32 v127, v127, v215
  v_sub_f32 v192, v192, v214
  v_sub_f32 v193, v193, v214
  v_sub_f32 v194, v194, v214
  v_sub_f32 v195, v195, v214
  v_sub_f32 v196, v196, v215
  v_sub_f32 v197, v197, v215
  v_sub_f32 v198, v198, v215
  v_sub_f32 v199, v199, v215
  v_exp_f32 v214, -v214
  v_exp_f32 v215, -v215
  v_mul_f32 v249, v249, v214
  v_mul_f32 v254, v254, v215
  v_accvgpr_read_b32 v208, a192
  v_accvgpr_read_b32 v209, a193
  v_accvgpr_read_b32 v210, a194
  v_accvgpr_read_b32 v211, a195
  v_mul_f32 v208, v208, v214
  v_mul_f32 v209, v209, v214
  v_mul_f32 v210, v210, v214
  v_mul_f32 v211, v211, v214
  v_accvgpr_write_b32 a192, v208
  v_accvgpr_write_b32 a193, v209
  v_accvgpr_write_b32 a194, v210
  v_accvgpr_write_b32 a195, v211
  v_accvgpr_read_b32 v208, a196
  v_accvgpr_read_b32 v209, a197
  v_accvgpr_read_b32 v210, a198
  v_accvgpr_read_b32 v211, a199
  v_mul_f32 v208, v208, v214
  v_mul_f32 v209, v209, v214
  v_mul_f32 v210, v210, v214
  v_mul_f32 v211, v211, v214
  v_accvgpr_write_b32 a196, v208
  v_accvgpr_write_b32 a197, v209
  v_accvgpr_write_b32 a198, v210
  v_accvgpr_write_b32 a199, v211
  v_accvgpr_read_b32 v208, a200
  v_accvgpr_read_b32 v209, a201
  v_accvgpr_read_b32 v210, a202
  v_accvgpr_read_b32 v211, a203
  v_mul_f32 v208, v208, v215
  v_mul_f32 v209, v209, v215
  v_mul_f32 v210, v210, v215
  v_mul_f32 v211, v211, v215
  v_accvgpr_write_b32 a200, v208
  v_accvgpr_write_b32 a201, v209
  v_accvgpr_write_b32 a202, v210
  v_accvgpr_write_b32 a203, v211
  v_accvgpr_read_b32 v208, a204
  v_accvgpr_read_b32 v209, a205
  v_accvgpr_read_b32 v210, a206
  v_accvgpr_read_b32 v211, a207
  v_mul_f32 v208, v208, v215
  v_mul_f32 v209, v209, v215
  v_mul_f32 v210, v210, v215
  v_mul_f32 v211, v211, v215
  v_accvgpr_write_b32 a204, v208
  v_accvgpr_write_b32 a205, v209
  v_accvgpr_write_b32 a206, v210
  v_accvgpr_write_b32 a207, v211
  v_accvgpr_read_b32 v208, a208
  v_accvgpr_read_b32 v209, a209
  v_accvgpr_read_b32 v210, a210
  v_accvgpr_read_b32 v211, a211
  v_mul_f32 v208, v208, v214
  v_mul_f32 v209, v209, v214
  v_mul_f32 v210, v210, v214
  v_mul_f32 v211, v211, v214
  v_accvgpr_write_b32 a208, v208
  v_accvgpr_write_b32 a209, v209
  v_accvgpr_write_b32 a210, v210
  v_accvgpr_write_b32 a211, v211
  v_accvgpr_read_b32 v208, a212
  v_accvgpr_read_b32 v209, a213
  v_accvgpr_read_b32 v210, a214
  v_accvgpr_read_b32 v211, a215
  v_mul_f32 v208, v208, v214
  v_mul_f32 v209, v209, v214
  v_mul_f32 v210, v210, v214
  v_mul_f32 v211, v211, v214
  v_accvgpr_write_b32 a212, v208
  v_accvgpr_write_b32 a213, v209
  v_accvgpr_write_b32 a214, v210
  v_accvgpr_write_b32 a215, v211
  v_accvgpr_read_b32 v208, a216
  v_accvgpr_read_b32 v209, a217
  v_accvgpr_read_b32 v210, a218
  v_accvgpr_read_b32 v211, a219
  v_mul_f32 v208, v208, v215
  v_mul_f32 v209, v209, v215
  v_mul_f32 v210, v210, v215
  v_mul_f32 v211, v211, v215
  v_accvgpr_write_b32 a216, v208
  v_accvgpr_write_b32 a217, v209
  v_accvgpr_write_b32 a218, v210
  v_accvgpr_write_b32 a219, v211
  v_accvgpr_read_b32 v208, a220
  v_accvgpr_read_b32 v209, a221
  v_accvgpr_read_b32 v210, a222
  v_accvgpr_read_b32 v211, a223
  v_mul_f32 v208, v208, v215
  v_mul_f32 v209, v209, v215
  v_mul_f32 v210, v210, v215
  v_mul_f32 v211, v211, v215
  v_accvgpr_write_b32 a220, v208
  v_accvgpr_write_b32 a221, v209
  v_accvgpr_write_b32 a222, v210
  v_accvgpr_write_b32 a223, v211
  v_accvgpr_read_b32 v208, a224
  v_accvgpr_read_b32 v209, a225
  v_accvgpr_read_b32 v210, a226
  v_accvgpr_read_b32 v211, a227
  v_mul_f32 v208, v208, v214
  v_mul_f32 v209, v209, v214
  v_mul_f32 v210, v210, v214
  v_mul_f32 v211, v211, v214
  v_accvgpr_write_b32 a224, v208
  v_accvgpr_write_b32 a225, v209
  v_accvgpr_write_b32 a226, v210
  v_accvgpr_write_b32 a227, v211
  v_accvgpr_read_b32 v208, a228
  v_accvgpr_read_b32 v209, a229
  v_accvgpr_read_b32 v210, a230
  v_accvgpr_read_b32 v211, a231
  v_mul_f32 v208, v208, v214
  v_mul_f32 v209, v209, v214
  v_mul_f32 v210, v210, v214
  v_mul_f32 v211, v211, v214
  v_accvgpr_write_b32 a228, v208
  v_accvgpr_write_b32 a229, v209
  v_accvgpr_write_b32 a230, v210
  v_accvgpr_write_b32 a231, v211
  v_accvgpr_read_b32 v208, a232
  v_accvgpr_read_b32 v209, a233
  v_accvgpr_read_b32 v210, a234
  v_accvgpr_read_b32 v211, a235
  v_mul_f32 v208, v208, v215
  v_mul_f32 v209, v209, v215
  v_mul_f32 v210, v210, v215
  v_mul_f32 v211, v211, v215
  v_accvgpr_write_b32 a232, v208
  v_accvgpr_write_b32 a233, v209
  v_accvgpr_write_b32 a234, v210
  v_accvgpr_write_b32 a235, v211
  v_accvgpr_read_b32 v208, a236
  v_accvgpr_read_b32 v209, a237
  v_accvgpr_read_b32 v210, a238
  v_accvgpr_read_b32 v211, a239
  v_mul_f32 v208, v208, v215
  v_mul_f32 v209, v209, v215
  v_mul_f32 v210, v210, v215
  v_mul_f32 v211, v211, v215
  v_accvgpr_write_b32 a236, v208
  v_accvgpr_write_b32 a237, v209
  v_accvgpr_write_b32 a238, v210
  v_accvgpr_write_b32 a239, v211
  v_accvgpr_read_b32 v208, a240
  v_accvgpr_read_b32 v209, a241
  v_accvgpr_read_b32 v210, a242
  v_accvgpr_read_b32 v211, a243
  v_mul_f32 v208, v208, v214
  v_mul_f32 v209, v209, v214
  v_mul_f32 v210, v210, v214
  v_mul_f32 v211, v211, v214
  v_accvgpr_write_b32 a240, v208
  v_accvgpr_write_b32 a241, v209
  v_accvgpr_write_b32 a242, v210
  v_accvgpr_write_b32 a243, v211
  v_accvgpr_read_b32 v208, a244
  v_accvgpr_read_b32 v209, a245
  v_accvgpr_read_b32 v210, a246
  v_accvgpr_read_b32 v211, a247
  v_mul_f32 v208, v208, v214
  v_mul_f32 v209, v209, v214
  v_mul_f32 v210, v210, v214
  v_mul_f32 v211, v211, v214
  v_accvgpr_write_b32 a244, v208
  v_accvgpr_write_b32 a245, v209
  v_accvgpr_write_b32 a246, v210
  v_accvgpr_write_b32 a247, v211
  v_accvgpr_read_b32 v208, a248
  v_accvgpr_read_b32 v209, a249
  v_accvgpr_read_b32 v210, a250
  v_accvgpr_read_b32 v211, a251
  v_mul_f32 v208, v208, v215
  v_mul_f32 v209, v209, v215
  v_mul_f32 v210, v210, v215
  v_mul_f32 v211, v211, v215
  v_accvgpr_write_b32 a248, v208
  v_accvgpr_write_b32 a249, v209
  v_accvgpr_write_b32 a250, v210
  v_accvgpr_write_b32 a251, v211
  v_accvgpr_read_b32 v208, a252
  v_accvgpr_read_b32 v209, a253
  v_accvgpr_read_b32 v210, a254
  v_accvgpr_read_b32 v211, a255
  v_mul_f32 v208, v208, v215
  v_mul_f32 v209, v209, v215
  v_mul_f32 v210, v210, v215
  v_mul_f32 v211, v211, v215
  v_accvgpr_write_b32 a252, v208
  v_accvgpr_write_b32 a253, v209
  v_accvgpr_write_b32 a254, v210
  v_accvgpr_write_b32 a255, v211
  v_exp_f32 v208, v64
  v_exp_f32 v209, v65
  v_exp_f32 v210, v66
  v_cvt_pk_bf16_f32 v128, v208, v209
  v_exp_f32 v211, v67
  v_add_f32 v214, v208, v209
  v_exp_f32 v212, v68
  v_add_f32 v214, v214, v210
  v_cvt_pk_bf16_f32 v129, v210, v211
  v_exp_f32 v213, v69
  v_add_f32 v214, v214, v211
  v_exp_f32 v208, v70
  v_add_f32 v214, v214, v212
  v_cvt_pk_bf16_f32 v130, v212, v213
  v_exp_f32 v209, v71
  v_add_f32 v214, v214, v213
  v_exp_f32 v210, v72
  v_add_f32 v214, v214, v208
  v_cvt_pk_bf16_f32 v131, v208, v209
  v_exp_f32 v211, v73
  v_add_f32 v214, v214, v209
  v_exp_f32 v212, v74
  v_cvt_pk_bf16_f32 v132, v210, v211
  v_exp_f32 v213, v75
  v_add_f32 v215, v210, v211
  v_exp_f32 v208, v76
  v_add_f32 v215, v215, v212
  v_cvt_pk_bf16_f32 v133, v212, v213
  v_exp_f32 v209, v77
  v_add_f32 v215, v215, v213
  v_exp_f32 v210, v78
  v_add_f32 v215, v215, v208
  v_cvt_pk_bf16_f32 v134, v208, v209
  v_exp_f32 v211, v79
  v_add_f32 v215, v215, v209
  v_exp_f32 v212, v80
  v_add_f32 v215, v215, v210
  v_cvt_pk_bf16_f32 v135, v210, v211
  v_exp_f32 v213, v81
  v_add_f32 v215, v215, v211
  v_exp_f32 v208, v82
  v_add_f32 v214, v214, v212
  v_cvt_pk_bf16_f32 v136, v212, v213
  v_exp_f32 v209, v83
  v_add_f32 v214, v214, v213
  v_exp_f32 v210, v84
  v_add_f32 v214, v214, v208
  v_cvt_pk_bf16_f32 v137, v208, v209
  v_exp_f32 v211, v85
  v_add_f32 v214, v214, v209
  v_exp_f32 v212, v86
  v_add_f32 v214, v214, v210
  v_cvt_pk_bf16_f32 v138, v210, v211
  v_exp_f32 v213, v87
  v_add_f32 v214, v214, v211
  v_exp_f32 v208, v88
  v_add_f32 v214, v214, v212
  v_cvt_pk_bf16_f32 v139, v212, v213
  v_exp_f32 v209, v89
  v_add_f32 v214, v214, v213
  v_exp_f32 v210, v90
  v_add_f32 v215, v215, v208
  v_cvt_pk_bf16_f32 v140, v208, v209
  v_exp_f32 v211, v91
  v_add_f32 v215, v215, v209
  v_exp_f32 v212, v92
  v_add_f32 v215, v215, v210
  v_cvt_pk_bf16_f32 v141, v210, v211
  v_exp_f32 v213, v93
  v_add_f32 v215, v215, v211
  v_exp_f32 v208, v94
  v_add_f32 v215, v215, v212
  v_cvt_pk_bf16_f32 v142, v212, v213
  v_exp_f32 v209, v95
  v_add_f32 v215, v215, v213
  v_add_f32 v215, v215, v208
  v_cvt_pk_bf16_f32 v143, v208, v209
  v_add_f32 v215, v215, v209
  s_nop 7
  s_nop 4
  s_cmp_eq_u32 s36, 22
  s_cbranch_scc1 BACK22
  s_cmp_eq_u32 s36, 27
  s_cbranch_scc1 BACK27
  s_cmp_eq_u32 s36, 32
  s_cbranch_scc1 BACK32
  s_cmp_eq_u32 s36, 48
  s_cbranch_scc1 BACK48
  s_cmp_eq_u32 s36, 53
  s_cbranch_scc1 BACK53
  s_cmp_eq_u32 s36, 58
  s_cbranch_scc1 BACK58
  s_cmp_eq_u32 s36, 74
  s_cbranch_scc1 BACK74
  s_cmp_eq_u32 s36, 79
  s_cbranch_scc1 BACK79
  s_cmp_eq_u32 s36, 84
  s_cbranch_scc1 BACK84
  s_cmp_eq_u32 s36, 100
  s_cbranch_scc1 BACK100
  s_cmp_eq_u32 s36, 106
  s_cbranch_scc1 BACK106
  s_branch BACK113
RARE1:
  s_nop 7
  s_nop 4
  s_nop 7
  s_nop 4
  v_max3_f32 v214, v96, v97, v98
  v_max3_f32 v215, v104, v105, v106
  v_max3_f32 v214, v214, v99, v100
  v_max3_f32 v215, v215, v107, v108
  v_max3_f32 v214, v214, v101, v102
  v_max3_f32 v215, v215, v109, v110
  v_max3_f32 v214, v214, v103, v112
  v_max3_f32 v215, v215, v111, v120
  v_max3_f32 v214, v214, v113, v114
  v_max3_f32 v215, v215, v121, v122
  v_max3_f32 v214, v214, v115, v116
  v_max3_f32 v215, v215, v123, v124
  v_max3_f32 v214, v214, v117, v118
  v_max3_f32 v215, v215, v125, v126
  v_max_f32 v214, v214, v119
  v_max_f32 v215, v215, v127
  s_nop 1
  v_permlane16_swap_b32 v214, v215
  v_max_f32 v214, v214, v215
  v_mov_b32 v215, v214
  s_nop 1
  v_permlane32_swap_b32 v214, v215
  v_max3_f32 v214, v214, v215, 0
  v_mov_b32 v215, v214
  s_nop 1
  v_permlane16_swap_b32 v214, v215
  v_sub_f32 v96, v96, v214
  v_sub_f32 v64, v64, v214
  v_sub_f32 v97, v97, v214
  v_sub_f32 v65, v65, v214
  v_sub_f32 v98, v98, v214
  v_sub_f32 v66, v66, v214
  v_sub_f32 v99, v99, v214
  v_sub_f32 v67, v67, v214
  v_sub_f32 v100, v100, v214
  v_sub_f32 v68, v68, v214
  v_sub_f32 v101, v101, v214
  v_sub_f32 v69, v69, v214
  v_sub_f32 v102, v102, v214
  v_sub_f32 v70, v70, v214
  v_sub_f32 v103, v103, v214
  v_sub_f32 v71, v71, v214
  v_sub_f32 v104, v104, v215
  v_sub_f32 v72, v72, v215
  v_sub_f32 v105, v105, v215
  v_sub_f32 v73, v73, v215
  v_sub_f32 v106, v106, v215
  v_sub_f32 v74, v74, v215
  v_sub_f32 v107, v107, v215
  v_sub_f32 v75, v75, v215
  v_sub_f32 v108, v108, v215
  v_sub_f32 v76, v76, v215
  v_sub_f32 v109, v109, v215
  v_sub_f32 v77, v77, v215
  v_sub_f32 v110, v110, v215
  v_sub_f32 v78, v78, v215
  v_sub_f32 v111, v111, v215
  v_sub_f32 v79, v79, v215
  v_sub_f32 v112, v112, v214
  v_sub_f32 v80, v80, v214
  v_sub_f32 v113, v113, v214
  v_sub_f32 v81, v81, v214
  v_sub_f32 v114, v114, v214
  v_sub_f32 v82, v82, v214
  v_sub_f32 v115, v115, v214
  v_sub_f32 v83, v83, v214
  v_sub_f32 v116, v116, v214
  v_sub_f32 v84, v84, v214
  v_sub_f32 v117, v117, v214
  v_sub_f32 v85, v85, v214
  v_sub_f32 v118, v118, v214
  v_sub_f32 v86, v86, v214
  v_sub_f32 v119, v119, v214
  v_sub_f32 v87, v87, v214
  v_sub_f32 v120, v120, v215
  v_sub_f32 v88, v88, v215
  v_sub_f32 v121, v121, v215
  v_sub_f32 v89, v89, v215
  v_sub_f32 v122, v122, v215
  v_sub_f32 v90, v90, v215
  v_sub_f32 v123, v123, v215
  v_sub_f32 v91, v91, v215
  v_sub_f32 v124, v124, v215
  v_sub_f32 v92, v92, v215
  v_sub_f32 v125, v125, v215
  v_sub_f32 v93, v93, v215
  v_sub_f32 v126, v126, v215
  v_sub_f32 v94, v94, v215
  v_sub_f32 v127, v127, v215
  v_sub_f32 v95, v95, v215
  v_sub_f32 v192, v192, v214
  v_sub_f32 v193, v193, v214
  v_sub_f32 v194, v194, v214
  v_sub_f32 v195, v195, v214
  v_sub_f32 v196, v196, v215
  v_sub_f32 v197, v197, v215
  v_sub_f32 v198, v198, v215
  v_sub_f32 v199, v199, v215
  v_exp_f32 v214, -v214
  v_exp_f32 v215, -v215
  v_mul_f32 v249, v249, v214
  v_mul_f32 v254, v254, v215
  v_accvgpr_read_b32 v208, a192
  v_accvgpr_read_b32 v209, a193
  v_accvgpr_read_b32 v210, a194
  v_accvgpr_read_b32 v211, a195
  v_mul_f32 v208, v208, v214
  v_mul_f32 v209, v209, v214
  v_mul_f32 v210, v210, v214
  v_mul_f32 v211, v211, v214
  v_accvgpr_write_b32 a192, v208
  v_accvgpr_write_b32 a193, v209
  v_accvgpr_write_b32 a194, v210
  v_accvgpr_write_b32 a195, v211
  v_accvgpr_read_b32 v208, a196
  v_accvgpr_read_b32 v209, a197
  v_accvgpr_read_b32 v210, a198
  v_accvgpr_read_b32 v211, a199
  v_mul_f32 v208, v208, v214
  v_mul_f32 v209, v209, v214
  v_mul_f32 v210, v210, v214
  v_mul_f32 v211, v211, v214
  v_accvgpr_write_b32 a196, v208
  v_accvgpr_write_b32 a197, v209
  v_accvgpr_write_b32 a198, v210
  v_accvgpr_write_b32 a199, v211
  v_accvgpr_read_b32 v208, a200
  v_accvgpr_read_b32 v209, a201
  v_accvgpr_read_b32 v210, a202
  v_accvgpr_read_b32 v211, a203
  v_mul_f32 v208, v208, v215
  v_mul_f32 v209, v209, v215
  v_mul_f32 v210, v210, v215
  v_mul_f32 v211, v211, v215
  v_accvgpr_write_b32 a200, v208
  v_accvgpr_write_b32 a201, v209
  v_accvgpr_write_b32 a202, v210
  v_accvgpr_write_b32 a203, v211
  v_accvgpr_read_b32 v208, a204
  v_accvgpr_read_b32 v209, a205
  v_accvgpr_read_b32 v210, a206
  v_accvgpr_read_b32 v211, a207
  v_mul_f32 v208, v208, v215
  v_mul_f32 v209, v209, v215
  v_mul_f32 v210, v210, v215
  v_mul_f32 v211, v211, v215
  v_accvgpr_write_b32 a204, v208
  v_accvgpr_write_b32 a205, v209
  v_accvgpr_write_b32 a206, v210
  v_accvgpr_write_b32 a207, v211
  v_accvgpr_read_b32 v208, a208
  v_accvgpr_read_b32 v209, a209
  v_accvgpr_read_b32 v210, a210
  v_accvgpr_read_b32 v211, a211
  v_mul_f32 v208, v208, v214
  v_mul_f32 v209, v209, v214
  v_mul_f32 v210, v210, v214
  v_mul_f32 v211, v211, v214
  v_accvgpr_write_b32 a208, v208
  v_accvgpr_write_b32 a209, v209
  v_accvgpr_write_b32 a210, v210
  v_accvgpr_write_b32 a211, v211
  v_accvgpr_read_b32 v208, a212
  v_accvgpr_read_b32 v209, a213
  v_accvgpr_read_b32 v210, a214
  v_accvgpr_read_b32 v211, a215
  v_mul_f32 v208, v208, v214
  v_mul_f32 v209, v209, v214
  v_mul_f32 v210, v210, v214
  v_mul_f32 v211, v211, v214
  v_accvgpr_write_b32 a212, v208
  v_accvgpr_write_b32 a213, v209
  v_accvgpr_write_b32 a214, v210
  v_accvgpr_write_b32 a215, v211
  v_accvgpr_read_b32 v208, a216
  v_accvgpr_read_b32 v209, a217
  v_accvgpr_read_b32 v210, a218
  v_accvgpr_read_b32 v211, a219
  v_mul_f32 v208, v208, v215
  v_mul_f32 v209, v209, v215
  v_mul_f32 v210, v210, v215
  v_mul_f32 v211, v211, v215
  v_accvgpr_write_b32 a216, v208
  v_accvgpr_write_b32 a217, v209
  v_accvgpr_write_b32 a218, v210
  v_accvgpr_write_b32 a219, v211
  v_accvgpr_read_b32 v208, a220
  v_accvgpr_read_b32 v209, a221
  v_accvgpr_read_b32 v210, a222
  v_accvgpr_read_b32 v211, a223
  v_mul_f32 v208, v208, v215
  v_mul_f32 v209, v209, v215
  v_mul_f32 v210, v210, v215
  v_mul_f32 v211, v211, v215
  v_accvgpr_write_b32 a220, v208
  v_accvgpr_write_b32 a221, v209
  v_accvgpr_write_b32 a222, v210
  v_accvgpr_write_b32 a223, v211
  v_accvgpr_read_b32 v208, a224
  v_accvgpr_read_b32 v209, a225
  v_accvgpr_read_b32 v210, a226
  v_accvgpr_read_b32 v211, a227
  v_mul_f32 v208, v208, v214
  v_mul_f32 v209, v209, v214
  v_mul_f32 v210, v210, v214
  v_mul_f32 v211, v211, v214
  v_accvgpr_write_b32 a224, v208
  v_accvgpr_write_b32 a225, v209
  v_accvgpr_write_b32 a226, v210
  v_accvgpr_write_b32 a227, v211
  v_accvgpr_read_b32 v208, a228
  v_accvgpr_read_b32 v209, a229
  v_accvgpr_read_b32 v210, a230
  v_accvgpr_read_b32 v211, a231
  v_mul_f32 v208, v208, v214
  v_mul_f32 v209, v209, v214
  v_mul_f32 v210, v210, v214
  v_mul_f32 v211, v211, v214
  v_accvgpr_write_b32 a228, v208
  v_accvgpr_write_b32 a229, v209
  v_accvgpr_write_b32 a230, v210
  v_accvgpr_write_b32 a231, v211
  v_accvgpr_read_b32 v208, a232
  v_accvgpr_read_b32 v209, a233
  v_accvgpr_read_b32 v210, a234
  v_accvgpr_read_b32 v211, a235
  v_mul_f32 v208, v208, v215
  v_mul_f32 v209, v209, v215
  v_mul_f32 v210, v210, v215
  v_mul_f32 v211, v211, v215
  v_accvgpr_write_b32 a232, v208
  v_accvgpr_write_b32 a233, v209
  v_accvgpr_write_b32 a234, v210
  v_accvgpr_write_b32 a235, v211
  v_accvgpr_read_b32 v208, a236
  v_accvgpr_read_b32 v209, a237
  v_accvgpr_read_b32 v210, a238
  v_accvgpr_read_b32 v211, a239
  v_mul_f32 v208, v208, v215
  v_mul_f32 v209, v209, v215
  v_mul_f32 v210, v210, v215
  v_mul_f32 v211, v211, v215
  v_accvgpr_write_b32 a236, v208
  v_accvgpr_write_b32 a237, v209
  v_accvgpr_write_b32 a238, v210
  v_accvgpr_write_b32 a239, v211
  v_accvgpr_read_b32 v208, a240
  v_accvgpr_read_b32 v209, a241
  v_accvgpr_read_b32 v210, a242
  v_accvgpr_read_b32 v211, a243
  v_mul_f32 v208, v208, v214
  v_mul_f32 v209, v209, v214
  v_mul_f32 v210, v210, v214
  v_mul_f32 v211, v211, v214
  v_accvgpr_write_b32 a240, v208
  v_accvgpr_write_b32 a241, v209
  v_accvgpr_write_b32 a242, v210
  v_accvgpr_write_b32 a243, v211
  v_accvgpr_read_b32 v208, a244
  v_accvgpr_read_b32 v209, a245
  v_accvgpr_read_b32 v210, a246
  v_accvgpr_read_b32 v211, a247
  v_mul_f32 v208, v208, v214
  v_mul_f32 v209, v209, v214
  v_mul_f32 v210, v210, v214
  v_mul_f32 v211, v211, v214
  v_accvgpr_write_b32 a244, v208
  v_accvgpr_write_b32 a245, v209
  v_accvgpr_write_b32 a246, v210
  v_accvgpr_write_b32 a247, v211
  v_accvgpr_read_b32 v208, a248
  v_accvgpr_read_b32 v209, a249
  v_accvgpr_read_b32 v210, a250
  v_accvgpr_read_b32 v211, a251
  v_mul_f32 v208, v208, v215
  v_mul_f32 v209, v209, v215
  v_mul_f32 v210, v210, v215
  v_mul_f32 v211, v211, v215
  v_accvgpr_write_b32 a248, v208
  v_accvgpr_write_b32 a249, v209
  v_accvgpr_write_b32 a250, v210
  v_accvgpr_write_b32 a251, v211
  v_accvgpr_read_b32 v208, a252
  v_accvgpr_read_b32 v209, a253
  v_accvgpr_read_b32 v210, a254
  v_accvgpr_read_b32 v211, a255
  v_mul_f32 v208, v208, v215
  v_mul_f32 v209, v209, v215
  v_mul_f32 v210, v210, v215
  v_mul_f32 v211, v211, v215
  v_accvgpr_write_b32 a252, v208
  v_accvgpr_write_b32 a253, v209
  v_accvgpr_write_b32 a254, v210
  v_accvgpr_write_b32 a255, v211
  v_exp_f32 v208, v96
  v_exp_f32 v209, v97
  v_exp_f32 v210, v98
  v_cvt_pk_bf16_f32 v144, v208, v209
  v_exp_f32 v211, v99
  v_add_f32 v214, v208, v209
  v_exp_f32 v212, v100
  v_add_f32 v214, v214, v210
  v_cvt_pk_bf16_f32 v145, v210, v211
  v_exp_f32 v213, v101
  v_add_f32 v214, v214, v211
  v_exp_f32 v208, v102
  v_add_f32 v214, v214, v212
  v_cvt_pk_bf16_f32 v146, v212, v213
  v_exp_f32 v209, v103
  v_add_f32 v214, v214, v213
  v_exp_f32 v210, v104
  v_add_f32 v214, v214, v208
  v_cvt_pk_bf16_f32 v147, v208, v209
  v_exp_f32 v211, v105
  v_add_f32 v214, v214, v209
  v_exp_f32 v212, v106
  v_cvt_pk_bf16_f32 v148, v210, v211
  v_exp_f32 v213, v107
  v_add_f32 v215, v210, v211
  v_exp_f32 v208, v108
  v_add_f32 v215, v215, v212
  v_cvt_pk_bf16_f32 v149, v212, v213
  v_exp_f32 v209, v109
  v_add_f32 v215, v215, v213
  v_exp_f32 v210, v110
  v_add_f32 v215, v215, v208
  v_cvt_pk_bf16_f32 v150, v208, v209
  v_exp_f32 v211, v111
  v_add_f32 v215, v215, v209
  v_exp_f32 v212, v112
  v_add_f32 v215, v215, v210
  v_cvt_pk_bf16_f32 v151, v210, v211
  v_exp_f32 v213, v113
  v_add_f32 v215, v215, v211
  v_exp_f32 v208, v114
  v_add_f32 v214, v214, v212
  v_cvt_pk_bf16_f32 v152, v212, v213
  v_exp_f32 v209, v115
  v_add_f32 v214, v214, v213
  v_exp_f32 v210, v116
  v_add_f32 v214, v214, v208
  v_cvt_pk_bf16_f32 v153, v208, v209
  v_exp_f32 v211, v117
  v_add_f32 v214, v214, v209
  v_exp_f32 v212, v118
  v_add_f32 v214, v214, v210
  v_cvt_pk_bf16_f32 v154, v210, v211
  v_exp_f32 v213, v119
  v_add_f32 v214, v214, v211
  v_exp_f32 v208, v120
  v_add_f32 v214, v214, v212
  v_cvt_pk_bf16_f32 v155, v212, v213
  v_exp_f32 v209, v121
  v_add_f32 v214, v214, v213
  v_exp_f32 v210, v122
  v_add_f32 v215, v215, v208
  v_cvt_pk_bf16_f32 v156, v208, v209
  v_exp_f32 v211, v123
  v_add_f32 v215, v215, v209
  v_exp_f32 v212, v124
  v_add_f32 v215, v215, v210
  v_cvt_pk_bf16_f32 v157, v210, v211
  v_exp_f32 v213, v125
  v_add_f32 v215, v215, v211
  v_exp_f32 v208, v126
  v_add_f32 v215, v215, v212
  v_cvt_pk_bf16_f32 v158, v212, v213
  v_exp_f32 v209, v127
  v_add_f32 v215, v215, v213
  v_add_f32 v215, v215, v208
  v_cvt_pk_bf16_f32 v159, v208, v209
  v_add_f32 v215, v215, v209
  s_nop 7
  s_nop 4
  s_cmp_eq_u32 s36, 19
  s_cbranch_scc1 BACK19
  s_cmp_eq_u32 s36, 25
  s_cbranch_scc1 BACK25
  s_cmp_eq_u32 s36, 30
  s_cbranch_scc1 BACK30
  s_cmp_eq_u32 s36, 35
  s_cbranch_scc1 BACK35
  s_cmp_eq_u32 s36, 45
  s_cbranch_scc1 BACK45
  s_cmp_eq_u32 s36, 51
  s_cbranch_scc1 BACK51
  s_cmp_eq_u32 s36, 56
  s_cbranch_scc1 BACK56
  s_cmp_eq_u32 s36, 61
  s_cbranch_scc1 BACK61
  s_cmp_eq_u32 s36, 71
  s_cbranch_scc1 BACK71
  s_cmp_eq_u32 s36, 77
  s_cbranch_scc1 BACK77
  s_cmp_eq_u32 s36, 82
  s_cbranch_scc1 BACK82
  s_cmp_eq_u32 s36, 87
  s_cbranch_scc1 BACK87
  s_cmp_eq_u32 s36, 97
  s_cbranch_scc1 BACK97
  s_cmp_eq_u32 s36, 103
  s_cbranch_scc1 BACK103
  s_cmp_eq_u32 s36, 109
  s_cbranch_scc1 BACK109
  s_branch BACK115
.section .rodata,"a"
.p2align 6
.amdhsa_kernel concat_heads__mha_block_cached__mha_block_cached__near_ridge_kernel
  .amdhsa_next_free_vgpr 512
  .amdhsa_next_free_sgpr 102
  .amdhsa_accum_offset 256
  .amdhsa_group_segment_fixed_size 0
  .amdhsa_kernarg_size 104
  .amdhsa_user_sgpr_count 2
  .amdhsa_user_sgpr_kernarg_segment_ptr 1
  .amdhsa_system_sgpr_workgroup_id_x 1
.end_amdhsa_kernel
```
